```python
import torch

def _softmax(x, axis=-1):
    return torch.softmax(x, dim=axis)
def _gelu(x):
    return torch.nn.functional.gelu(x, approximate="tanh")
def _silu(x):
    return torch.nn.functional.silu(x)
def _sigmoid(x):
    return torch.sigmoid(x)
def _layernorm(x, axis=-1, eps=1e-5):
    m = x.mean(dim=axis, keepdim=True)
    v = x.var(dim=axis, keepdim=True, unbiased=False)
    return (x - m) / torch.sqrt(v + eps)
def _scatter_add(tgt, idx, src, axis=0):
    return tgt.clone().index_add_(axis, idx, src)
def _segment_sum(src, seg, n):
    out = torch.zeros((n,) + src.shape[1:], dtype=src.dtype)
    return out.index_add_(0, seg, src)
def _pad(x, pw):
    flat = tuple(v for pair in reversed(pw) for v in pair)
    return torch.nn.functional.pad(x, flat)

kernel_name = 'gated_mix__ssm_conv_h3__sliding_local_dilated__prompt'

def setup_inputs():

    _w = (lambda a: (lambda t: t.to(torch.bfloat16) if t.is_floating_point() else t)(torch.as_tensor(a)))
    def _A_setup():
        B, S, D = 1, 2048, 640
        ks = 4
        return {
            "q": _w((lambda *s: torch.randn(*s, dtype=torch.bfloat16) * 0.05)(B, S, D)),
            "k": _w((lambda *s: torch.randn(*s, dtype=torch.bfloat16) * 0.8)(B, S, D)),
            "v": _w((lambda *s: torch.randn(*s, dtype=torch.bfloat16) * 0.8)(B, S, D)),
            "shift_k": _w((lambda *s: torch.randn(*s, dtype=torch.bfloat16) * 0.8)(D, ks) * 0.5),
            "ssm_k": _w((lambda *s: torch.randn(*s, dtype=torch.bfloat16) * 3.2)(D, S) * (1.0 / S ** 0.5)),
            "ssm_D": _w((lambda *s: torch.randn(*s, dtype=torch.bfloat16) * 0.8)(D)),
        }
    _A_in = _A_setup()

    def _B_setup():
        B, S, D = 1, 2048, 640
        return {
            "x": _w((lambda *s: torch.randn(*s, dtype=torch.bfloat16) * 0.05)(B, S, D)),
            "wqkv": _w((lambda *s: torch.randn(*s, dtype=torch.bfloat16) * 0.8)(D, 3 * D)),
            "wo": _w((lambda *s: torch.randn(*s, dtype=torch.bfloat16) * 0.05)(D, D)),
        }
    _B_in = _B_setup()

    return {
        "A_q": _A_in["q"],
        "A_k": _A_in["k"],
        "A_v": _A_in["v"],
        "A_shift_k": _A_in["shift_k"],
        "A_ssm_k": _A_in["ssm_k"],
        "A_ssm_D": _A_in["ssm_D"],
        "B_x": _B_in["x"],
        "B_wqkv": _B_in["wqkv"],
        "B_wo": _B_in["wo"],
        "gate_w": _w((lambda *s: torch.randn(*s, dtype=torch.bfloat16) * 0.05)(640) * 16.0),
    }

def reference(A_q, A_k, A_v, A_shift_k, A_ssm_k, A_ssm_D, B_x, B_wqkv, B_wo, gate_w):
    def _A_ref(q, k, v, shift_k, ssm_k, ssm_D):
        B, S, D = q.shape
        ks = shift_k.shape[-1]
        k_pad = _pad(k, ((0, 0), (ks - 1, 0), (0, 0)))
        k_shift = torch.zeros_like(k)
        for t in range(ks):
            k_shift = k_shift + k_pad[:, t:t + S, :] * shift_k[:, ks - 1 - t][None, None, :]
        kv = k_shift * v
        L = 2 * S
        kv_pad = _pad(kv, ((0, 0), (0, S), (0, 0)))
        kf_pad = _pad(ssm_k, ((0, 0), (0, S)))
        kv_f = (lambda x, axes=(-2,-1): torch.fft.rfft2(x.float(), dim=axes))(kv_pad[:, None, :, :], axes=(1, 2))
        kf_f = (lambda x, axes=(-2,-1): torch.fft.rfft2(x.float(), dim=axes))(kf_pad[:, None, :], axes=(1, 2))
        kf_f = (lambda x, *d: x.permute(*d))(kf_f, 1, 2, 0)
        y_f = kv_f * kf_f[None, :, :, :]
        y = (lambda x, s, axes=(-2,-1): torch.fft.irfft2(x, s=s, dim=axes).to(torch.bfloat16))(y_f, (1, L), axes=(1, 2))[:, 0, :S, :]
        y = y + kv * ssm_D[None, None, :]
        return q * y

    def _B_ref(x, wqkv, wo):
        B, S, D = x.shape
        H = 32; Dh = D // H
        W, dil = 8, 2
        qkv = (lambda x, *d: x.permute(*d))((x @ wqkv).reshape(B, S, 3, H, Dh), 2, 0, 3, 1, 4)
        q, k, v = qkv[0], qkv[1], qkv[2]
        scale = Dh ** -0.5
        pos = torch.arange(S)
        off = torch.arange(W) * dil
        idx = pos[:, None] - off[None, :]
        mask = idx >= 0
        idx_c = torch.where(mask, idx, 0).reshape(-1)
        kg = k[:, :, idx_c, :].reshape(B, H, S, W, Dh)
        vg = v[:, :, idx_c, :].reshape(B, H, S, W, Dh)
        logits = torch.einsum("bhsd,bhswd->bhsw", q, kg) * scale
        logits = torch.where(mask[None, None, :, :], logits, -1e9)
        attn = _softmax(logits, axis=-1)
        o = torch.einsum("bhsw,bhswd->bhsd", attn, vg)
        return (lambda x, *d: x.permute(*d))(o, 0, 2, 1, 3).reshape(B, S, D) @ wo

    x = A_q
    g = _sigmoid((x * gate_w).sum(-1, keepdims=True))
    a = _A_ref(x, A_k, A_v, A_shift_k, A_ssm_k, A_ssm_D)
    b = _B_ref(x, B_wqkv, B_wo)
    return g * a + (1 - g) * b
```

```asm
; @launch grid=(256,1,1) block=(768,1,1) lds=163840
.amdgcn_target "amdgcn-amd-amdhsa--gfx950"
.text
.globl gated_mix__ssm_conv_h3__sliding_local_dilated__prompt_kernel
.p2align 8
.type gated_mix__ssm_conv_h3__sliding_local_dilated__prompt_kernel,@function
gated_mix__ssm_conv_h3__sliding_local_dilated__prompt_kernel:
L_entry:
    s_load_dwordx16 s[4:19], s[0:1], 0
    s_load_dwordx8 s[20:27], s[0:1], 64
    s_load_dwordx2 s[28:29], s[0:1], 96
    s_cmp_ge_u32 s2, 256
    s_cbranch_scc1 L_end
    v_lshrrev_b32 v4, 6, v0
    v_and_b32 v0, 63, v0
    v_readfirstlane_b32 s32, v4
    s_getpc_b64 s[46:47]
L_pc:
    s_lshr_b32 s31, s2, 3
    s_mul_i32 s96, s31, 896
    s_cmp_lg_u32 s32, 2
    s_cbranch_scc1 L_nopf
    v_lshl_add_u32 v4, v0, 7, s96
    v_min_u32 v4, L_codeend-L_pc-4, v4
    s_mov_b64 exec, 0x7f
    global_load_dword v20, v4, s[46:47]
    s_mov_b64 exec, -1
L_nopf:
    v_mov_b32 v3, 160768
    v_lshl_add_u32 v5, v0, 3, v3
    v_mov_b32 v6, 0
    v_mov_b32 v7, 0
    ds_write_b64 v5, v[6:7]
    v_lshrrev_b32 v2, 4, v0
    v_and_b32 v1, 15, v0
    s_and_b32 s30, s2, 7
    s_and_b32 s36, s31, 7
    s_lshr_b32 s35, s31, 3
    s_lshl2_add_u32 s35, s30, s35
    s_cmp_ge_u32 s31, 20
    s_cselect_b32 s34, 1, 0
    s_cselect_b32 s96, 20, 0
    s_cselect_b32 s97, 5, 10
    s_sub_u32 s38, s31, s96
    s_cmp_ge_u32 s38, s97
    s_cselect_b32 s97, s97, 0
    s_cselect_b32 s96, 1, 0
    s_sub_u32 s38, s38, s97
    s_lshl1_add_u32 s37, s30, s96
    s_mul_i32 s39, s37, 163840
    s_setprio 3
    s_cmp_lt_u32 s32, 4
    s_cbranch_scc1 L_service
    s_cmp_lg_u32 s34, 0
    s_cbranch_scc1 L_awave
    s_branch L_compute
L_padb0:
    s_branch L_padb8
L_service:
    s_cmp_lg_u32 s34, 0
    s_cbranch_scc1 L_aserv
    s_setprio 3
    v_lshrrev_b32 v4, 3, v0
    v_and_b32 v5, 7, v0
    s_add_u32 s65, s30, s38
    s_mul_i32 s96, s65, 52
    s_lshr_b32 s96, s96, 8
    s_mul_i32 s96, s96, 5
    s_sub_u32 s65, s65, s96
    s_mul_i32 s65, s65, 512
    s_lshr_b32 s65, s65, 8
    s_and_b32 s96, s32, 1
    s_cmp_ge_u32 s32, 2
    s_cbranch_scc1 L_lw
    v_mul_u32_u24 v6, 1280, v4
    v_xor_b32 v7, v5, v2
    v_lshl_add_u32 v13, v7, 4, v6
    s_lshl_b32 s97, s96, 6
    v_xor_b32 v13, s97, v13
    v_xor_b32 v14, 64, v13
    s_sub_u32 s52, s39, 20480
    s_cmp_eq_u32 s37, 0
    s_cselect_b32 s52, 0, s52
    s_add_u32 s97, s39, 71680
    s_add_u32 s98, s39, 92160
    s_cmp_eq_u32 s96, 0
    s_cselect_b32 s52, s52, s97
    s_cselect_b32 s53, s39, s98
    s_mul_i32 s54, s96, 9216
    s_add_u32 s54, s54, 86016
    s_lshl_b32 s68, s65, 7
    s_add_u32 s52, s52, s68
    s_add_u32 s53, s53, s68
    s_waitcnt lgkmcnt(0)
    s_mov_b32 s40, s4
    s_and_b32 s41, s5, 0xffff
    s_mov_b32 s42, 2621440
    s_mov_b32 s43, 0x00020000
    s_load_dword s33, s[28:29], 0
    s_cmp_lg_u32 s32, 0
    s_cbranch_scc1 L_nogw
    s_mov_b32 s48, s22
    s_and_b32 s49, s23, 0xffff
    s_mov_b32 s50, 1280
    s_mov_b32 s51, 0x00020000
    v_lshlrev_b32 v4, 4, v0
    s_mov_b32 m0, 162048
    s_nop 0
    buffer_load_dwordx4 v4, s[48:51], 0 offen lds
    s_mov_b64 exec, 0xffff
    buffer_load_dwordx4 v4, s[48:51], 0 offen offset:1024 lds
    s_mov_b64 exec, -1
L_nogw:
    s_mov_b32 m0, s54
    s_mov_b32 s59, s52
    buffer_load_dwordx4 v13, s[40:43], s59 offen lds
    s_add_u32 m0, m0, 1024
    s_add_u32 s59, s59, 10240
    buffer_load_dwordx4 v14, s[40:43], s59 offen lds
    s_add_u32 m0, m0, 1024
    s_mov_b32 s59, s53
    buffer_load_dwordx4 v13, s[40:43], s59 offen lds
    s_add_u32 m0, m0, 1024
    s_add_u32 s59, s59, 10240
    buffer_load_dwordx4 v14, s[40:43], s59 offen lds
    s_add_u32 m0, m0, 1024
    s_add_u32 s59, s59, 10240
    buffer_load_dwordx4 v13, s[40:43], s59 offen lds
    s_add_u32 m0, m0, 1024
    s_add_u32 s59, s59, 10240
    buffer_load_dwordx4 v14, s[40:43], s59 offen lds
    s_add_u32 m0, m0, 1024
    s_add_u32 s59, s59, 10240
    buffer_load_dwordx4 v13, s[40:43], s59 offen lds
    s_add_u32 m0, m0, 1024
    s_add_u32 s59, s59, 10240
    buffer_load_dwordx4 v14, s[40:43], s59 offen lds
    s_add_u32 m0, m0, 1024
    s_add_u32 s59, s59, 10240
    buffer_load_dwordx4 v13, s[40:43], s59 offen lds
    s_add_u32 s65, s65, 1
    s_cmp_eq_u32 s65, 10
    s_cselect_b32 s59, -9, 1
    s_lshl_b32 s59, s59, 7
    s_add_u32 s52, s52, s59
    s_add_u32 s53, s53, s59
    s_add_u32 s62, s54, 43008
    s_sub_u32 s54, s54, 86016
    s_mov_b32 s61, s54
    s_mov_b32 s55, 1
    s_mul_i32 s96, s36, 102400
    s_add_u32 s96, s96, 9437184
    s_add_u32 s48, s28, s96
    s_addc_u32 s49, s29, 0
    s_and_b32 s49, s49, 0xffff
    s_mov_b32 s50, 102400
    s_mov_b32 s51, 0x00020000
    v_lshlrev_b32 v19, 4, v0
    s_lshl_b32 s66, s30, 5
    s_add_u32 s66, s66, s31
    s_lshl_b32 s66, s66, 8
    s_add_u32 s66, s66, 65536
    s_add_u32 s66, s66, 128
    v_lshrrev_b32 v5, 1, v1
    v_xor_b32 v5, v5, v2
    v_lshlrev_b32 v5, 4, v5
    v_lshl_add_u32 v5, v1, 7, v5
    s_lshl_b32 s97, s32, 6
    v_xor_b32 v5, s97, v5
    s_and_b32 s96, s38, 7
    s_lshl_b32 s96, s96, 11
    s_add_u32 s96, s96, 2048
    v_add_u32 v18, s96, v5
    s_add_u32 s97, s97, 162048
    v_lshl_add_u32 v17, v2, 4, s97
    s_mov_b32 s64, 86016
    v_mov_b64 v[20:21], 0
    v_mov_b64 v[22:23], 0
    v_mov_b64 v[24:25], 0
    v_mov_b64 v[26:27], 0
    v_mov_b64 v[28:29], 0
    v_mov_b64 v[30:31], 0
    s_lshl1_add_u32 s96, s35, s32
    s_mul_i32 s96, s96, 40960
    s_mul_i32 s97, s36, 160
    s_add_u32 s96, s96, s97
    v_add_u32 v4, 0, v0
    v_mul_u32_u24 v8, 6554, v4
    v_lshrrev_b32 v8, 16, v8
    v_mul_u32_u24 v8, 1120, v8
    v_lshl_add_u32 v4, v4, 4, s96
    v_add_u32 v8, v8, v4
    v_add_u32 v4, 64, v0
    v_mul_u32_u24 v9, 6554, v4
    v_lshrrev_b32 v9, 16, v9
    v_mul_u32_u24 v9, 1120, v9
    v_lshl_add_u32 v4, v4, 4, s96
    v_add_u32 v9, v9, v4
    v_add_u32 v4, 128, v0
    v_mul_u32_u24 v10, 6554, v4
    v_lshrrev_b32 v10, 16, v10
    v_mul_u32_u24 v10, 1120, v10
    v_lshl_add_u32 v4, v4, 4, s96
    v_add_u32 v10, v10, v4
    v_add_u32 v4, 192, v0
    v_mul_u32_u24 v11, 6554, v4
    v_lshrrev_b32 v11, 16, v11
    v_mul_u32_u24 v11, 1120, v11
    v_lshl_add_u32 v4, v4, 4, s96
    v_add_u32 v11, v11, v4
    v_add_u32 v4, 256, v0
    v_mul_u32_u24 v12, 6554, v4
    v_lshrrev_b32 v12, 16, v12
    v_mul_u32_u24 v12, 1120, v12
    v_lshl_add_u32 v4, v4, 4, s96
    v_add_u32 v12, v12, v4
    s_waitcnt lgkmcnt(0)
    s_mul_i32 s33, s33, 1664525
    s_add_u32 s33, s33, 1013904223
    s_branch L_ld_x_i
L_padb1:
    s_branch L_padb9
L_ld_x:
    v_add_u32 v15, s64, v18
    v_add_u32 v16, s68, v17
    ds_read_b128 v[24:27], v15
    ds_read_b128 v[28:31], v16
    s_add_u32 s68, s68, 128
    s_cmp_eq_u32 s68, 1280
    s_cselect_b32 s68, 0, s68
    s_add_u32 s64, s64, 43008
    s_cmp_eq_u32 s64, 129024
    s_cselect_b32 s64, 0, s64
L_ld_x_i:
    s_mov_b32 m0, s54
    s_mov_b32 s59, s52
    buffer_load_dwordx4 v13, s[40:43], s59 offen lds
    s_add_u32 m0, m0, 1024
    s_add_u32 s59, s59, 10240
    buffer_load_dwordx4 v14, s[40:43], s59 offen lds
    s_add_u32 m0, m0, 1024
    s_mov_b32 s59, s53
    buffer_load_dwordx4 v13, s[40:43], s59 offen lds
    s_add_u32 m0, m0, 1024
    s_add_u32 s59, s59, 10240
    buffer_load_dwordx4 v14, s[40:43], s59 offen lds
    s_add_u32 m0, m0, 1024
    s_add_u32 s59, s59, 10240
    buffer_load_dwordx4 v13, s[40:43], s59 offen lds
    s_add_u32 m0, m0, 1024
    s_add_u32 s59, s59, 10240
    s_waitcnt lgkmcnt(0)
    v_mfma_f32_16x16x32_bf16 v[20:23], v[28:31], v[24:27], v[20:23]
    s_load_dwordx4 s[88:91], s[28:29], s66 glc
    buffer_load_dwordx4 v14, s[40:43], s59 offen lds
    s_add_u32 m0, m0, 1024
    s_add_u32 s59, s59, 10240
    buffer_load_dwordx4 v13, s[40:43], s59 offen lds
    s_add_u32 m0, m0, 1024
    s_add_u32 s59, s59, 10240
    buffer_load_dwordx4 v14, s[40:43], s59 offen lds
    s_add_u32 m0, m0, 1024
    s_add_u32 s59, s59, 10240
    buffer_load_dwordx4 v13, s[40:43], s59 offen lds
    s_add_u32 s65, s65, 1
    s_cmp_eq_u32 s65, 10
    s_cselect_b32 s59, -9, 1
    s_lshl_b32 s59, s59, 7
    s_add_u32 s52, s52, s59
    s_add_u32 s53, s53, s59
    s_add_u32 s54, s54, 43008
    s_cmp_eq_u32 s54, s62
    s_cselect_b32 s54, s61, s54
    s_add_u32 s55, s55, 1
    s_mul_i32 s96, s55, s32
    s_cmp_eq_u32 s96, 2
    s_cbranch_scc1 L_pk0
    s_cmp_eq_u32 s96, 4
    s_cbranch_scc1 L_pk1
    s_cmp_eq_u32 s96, 6
    s_cbranch_scc1 L_pk2
    s_waitcnt vmcnt(9)
L_ld_x_b:
    s_barrier
    s_cmp_lt_u32 s55, 10
    s_cbranch_scc1 L_ld_x
    v_add_u32 v15, s64, v18
    v_add_u32 v16, s68, v17
    ds_read_b128 v[24:27], v15
    ds_read_b128 v[28:31], v16
    s_add_u32 s68, s68, 128
    s_cmp_eq_u32 s68, 1280
    s_cselect_b32 s68, 0, s68
    s_add_u32 s64, s64, 43008
    s_cmp_eq_u32 s64, 129024
    s_cselect_b32 s64, 0, s64
    s_waitcnt lgkmcnt(0)
    v_mfma_f32_16x16x32_bf16 v[20:23], v[28:31], v[24:27], v[20:23]
    s_branch L_ld_end
L_padb2:
    s_branch L_padb10
L_pk0:
    s_mov_b32 s44, s20
    s_and_b32 s45, s21, 0xffff
    s_mov_b32 s46, 819200
    s_mov_b32 s47, 0x00020000
    s_sub_u32 s98, s38, 5
    s_cselect_b32 s98, s38, s98
    s_mov_b32 s97, 0xf900af56
    s_cmp_eq_u32 s98, 1
    s_cselect_b32 s97, 0xfe00ab55, s97
    s_cmp_eq_u32 s98, 2
    s_cselect_b32 s97, 0xff00aa55, s97
    s_cmp_eq_u32 s98, 3
    s_cselect_b32 s97, 0xff40aa15, s97
    s_cmp_eq_u32 s98, 4
    s_cselect_b32 s97, 0xff906a05, s97
    s_lshl_b32 s98, s37, 4
    s_lshr_b32 s97, s97, s98
    s_mul_i32 s96, s30, 160
    s_mul_i32 s59, s38, 81920
    s_mov_b32 m0, 129024
    v_add_u32 v4, 0, v0
    v_mul_u32_u24 v5, 6554, v4
    v_lshrrev_b32 v5, 16, v5
    v_mul_u32_u24 v6, 160, v5
    v_lshl_add_u32 v4, v4, 4, s96
    v_sub_u32 v4, v4, v6
    v_lshrrev_b32 v6, 2, v5
    v_lshlrev_b32 v6, 1, v6
    v_bfe_u32 v6, s97, v6, 2
    v_and_b32 v5, 15, v5
    v_lshl_add_u32 v5, v6, 4, v5
    v_mul_u32_u24 v5, 1280, v5
    v_add_u32 v4, v4, v5
    buffer_load_dwordx4 v4, s[44:47], s59 offen lds
    s_add_u32 m0, m0, 1024
    v_add_u32 v4, 64, v0
    v_mul_u32_u24 v5, 6554, v4
    v_lshrrev_b32 v5, 16, v5
    v_mul_u32_u24 v6, 160, v5
    v_lshl_add_u32 v4, v4, 4, s96
    v_sub_u32 v4, v4, v6
    v_lshrrev_b32 v6, 2, v5
    v_lshlrev_b32 v6, 1, v6
    v_bfe_u32 v6, s97, v6, 2
    v_and_b32 v5, 15, v5
    v_lshl_add_u32 v5, v6, 4, v5
    v_mul_u32_u24 v5, 1280, v5
    v_add_u32 v4, v4, v5
    buffer_load_dwordx4 v4, s[44:47], s59 offen lds
    s_add_u32 m0, m0, 1024
    v_add_u32 v4, 128, v0
    v_mul_u32_u24 v5, 6554, v4
    v_lshrrev_b32 v5, 16, v5
    v_mul_u32_u24 v6, 160, v5
    v_lshl_add_u32 v4, v4, 4, s96
    v_sub_u32 v4, v4, v6
    v_lshrrev_b32 v6, 2, v5
    v_lshlrev_b32 v6, 1, v6
    v_bfe_u32 v6, s97, v6, 2
    v_and_b32 v5, 15, v5
    v_lshl_add_u32 v5, v6, 4, v5
    v_mul_u32_u24 v5, 1280, v5
    v_add_u32 v4, v4, v5
    buffer_load_dwordx4 v4, s[44:47], s59 offen lds
    s_add_u32 m0, m0, 1024
    v_add_u32 v4, 192, v0
    v_mul_u32_u24 v5, 6554, v4
    v_lshrrev_b32 v5, 16, v5
    v_mul_u32_u24 v6, 160, v5
    v_lshl_add_u32 v4, v4, 4, s96
    v_sub_u32 v4, v4, v6
    v_lshrrev_b32 v6, 2, v5
    v_lshlrev_b32 v6, 1, v6
    v_bfe_u32 v6, s97, v6, 2
    v_and_b32 v5, 15, v5
    v_lshl_add_u32 v5, v6, 4, v5
    v_mul_u32_u24 v5, 1280, v5
    v_add_u32 v4, v4, v5
    buffer_load_dwordx4 v4, s[44:47], s59 offen lds
    s_add_u32 m0, m0, 1024
    v_add_u32 v4, 256, v0
    v_mul_u32_u24 v5, 6554, v4
    v_lshrrev_b32 v5, 16, v5
    v_mul_u32_u24 v6, 160, v5
    v_lshl_add_u32 v4, v4, 4, s96
    v_sub_u32 v4, v4, v6
    v_lshrrev_b32 v6, 2, v5
    v_lshlrev_b32 v6, 1, v6
    v_bfe_u32 v6, s97, v6, 2
    v_and_b32 v5, 15, v5
    v_lshl_add_u32 v5, v6, 4, v5
    v_mul_u32_u24 v5, 1280, v5
    v_add_u32 v4, v4, v5
    buffer_load_dwordx4 v4, s[44:47], s59 offen lds
    s_waitcnt vmcnt(14)
    s_branch L_ld_x_b
L_pk1:
    v_lshrrev_b32 v5, 2, v0
    v_mul_u32_u24 v5, 160, v5
    v_and_b32 v6, 3, v0
    v_lshl_add_u32 v5, v6, 3, v5
    v_add_u32 v5, 129024, v5
    ds_read_b64_tr_b16 v[40:41], v5 offset:0
    ds_read_b64_tr_b16 v[42:43], v5 offset:2560
    ds_read_b64_tr_b16 v[44:45], v5 offset:32
    ds_read_b64_tr_b16 v[46:47], v5 offset:2592
    ds_read_b64_tr_b16 v[48:49], v5 offset:64
    ds_read_b64_tr_b16 v[50:51], v5 offset:2624
    ds_read_b64_tr_b16 v[52:53], v5 offset:96
    ds_read_b64_tr_b16 v[54:55], v5 offset:2656
    ds_read_b64_tr_b16 v[56:57], v5 offset:128
    ds_read_b64_tr_b16 v[58:59], v5 offset:2688
    s_mul_i32 s96, s37, 51200
    s_mul_i32 s97, s38, 5120
    s_add_u32 s96, s96, s97
    s_add_u32 s96, s96, 9439232
    v_add_u32 v6, s96, v19
    s_waitcnt lgkmcnt(0)
    global_store_dwordx4 v6, v[40:43], s[28:29] offset:-2048 sc1
    global_store_dwordx4 v6, v[44:47], s[28:29] offset:-1024 sc1
    global_store_dwordx4 v6, v[48:51], s[28:29] offset:0 sc1
    global_store_dwordx4 v6, v[52:55], s[28:29] offset:1024 sc1
    global_store_dwordx4 v6, v[56:59], s[28:29] offset:2048 sc1
    s_waitcnt vmcnt(14)
    s_branch L_ld_x_b
L_padb3:
    s_branch L_padb11
L_pk2:
    s_lshl_b32 s96, s30, 5
    s_add_u32 s96, s96, s31
    s_lshl_b32 s96, s96, 8
    s_add_u32 s96, s96, 65536
    v_lshl_add_u32 v4, v0, 3, s96
    v_mov_b32 v6, 0
    s_and_b32 s97, s33, 0xffffff00
    v_mov_b32 v7, s97
    s_getreg_b32 s97, hwreg(HW_REG_XCC_ID, 0, 4)
    v_writelane_b32 v6, s33, 3
    v_writelane_b32 v7, s97, 3
    s_mov_b64 exec, 0xffff
    global_store_dwordx2 v4, v[6:7], s[28:29] sc1
    s_mov_b64 exec, -1
    s_lshl_b32 s96, s2, 7
    s_add_u32 s96, s96, 0x1F8000
    v_lshl_add_u32 v4, v0, 21, s96
    s_add_u32 s96, s96, 10518528
    v_writelane_b32 v4, s96, 6
    v_mov_b32 v5, 0
    s_mov_b64 exec, 0xde
    global_atomic_or v4, v5, s[28:29] sc1
    s_mul_i32 s96, s35, 81920
    s_mul_i32 s97, s36, 160
    s_add_u32 s96, s96, s97
    s_mov_b64 exec, 1
    v_mov_b32 v4, s96
    global_atomic_or v4, v5, s[24:25] sc1
    s_mov_b64 exec, -1
    s_waitcnt vmcnt(12)
    s_branch L_ld_x_b
L_lw:
    v_and_b32 v7, 2, v4
    v_xor_b32 v7, v7, v5
    v_mul_u32_u24 v6, 3840, v4
    v_lshl_add_u32 v13, v7, 4, v6
    s_lshl_b32 s97, s38, 7
    v_add_u32 v13, s97, v13
    v_xor_b32 v14, 64, v13
    s_mul_i32 s54, s96, 12288
    s_add_u32 s54, s54, 104448
    s_lshl1_add_u32 s59, s65, s96
    s_mul_i32 s59, s59, 122880
    s_waitcnt lgkmcnt(0)
    s_mov_b32 s44, s18
    s_and_b32 s45, s19, 0xffff
    s_mov_b32 s46, 2457600
    s_mov_b32 s47, 0x00020000
    s_load_dword s33, s[28:29], 0
    s_mov_b32 m0, s54
    s_nop 0
    buffer_load_dwordx4 v13, s[44:47], s59 offen lds
    s_add_u32 m0, m0, 1024
    s_add_u32 s59, s59, 1280
    buffer_load_dwordx4 v13, s[44:47], s59 offen lds
    s_add_u32 m0, m0, 1024
    s_add_u32 s59, s59, 1280
    buffer_load_dwordx4 v13, s[44:47], s59 offen lds
    s_add_u32 m0, m0, 1024
    s_add_u32 s59, s59, 28160
    buffer_load_dwordx4 v14, s[44:47], s59 offen lds
    s_add_u32 m0, m0, 1024
    s_add_u32 s59, s59, 1280
    buffer_load_dwordx4 v14, s[44:47], s59 offen lds
    s_add_u32 m0, m0, 1024
    s_add_u32 s59, s59, 1280
    buffer_load_dwordx4 v14, s[44:47], s59 offen lds
    s_add_u32 m0, m0, 1024
    s_add_u32 s59, s59, 28160
    buffer_load_dwordx4 v13, s[44:47], s59 offen lds
    s_add_u32 m0, m0, 1024
    s_add_u32 s59, s59, 1280
    buffer_load_dwordx4 v13, s[44:47], s59 offen lds
    s_add_u32 m0, m0, 1024
    s_add_u32 s59, s59, 1280
    buffer_load_dwordx4 v13, s[44:47], s59 offen lds
    s_add_u32 m0, m0, 1024
    s_add_u32 s59, s59, 28160
    buffer_load_dwordx4 v14, s[44:47], s59 offen lds
    s_add_u32 m0, m0, 1024
    s_add_u32 s59, s59, 1280
    buffer_load_dwordx4 v14, s[44:47], s59 offen lds
    s_add_u32 m0, m0, 1024
    s_add_u32 s59, s59, 1280
    buffer_load_dwordx4 v14, s[44:47], s59 offen lds
    s_add_u32 s59, s59, 151040
    s_sub_u32 s96, s59, 2457600
    s_cselect_b32 s59, s59, s96
    s_add_u32 s62, s54, 43008
    s_sub_u32 s54, s54, 86016
    s_mov_b32 s61, s54
    s_mov_b32 s55, 1
    s_mul_i32 s96, s36, 102400
    s_add_u32 s96, s96, 9437184
    s_add_u32 s48, s28, s96
    s_addc_u32 s49, s29, 0
    s_and_b32 s49, s49, 0xffff
    s_mov_b32 s50, 102400
    s_mov_b32 s51, 0x00020000
    v_lshlrev_b32 v19, 4, v0
    s_lshl_b32 s66, s30, 5
    s_add_u32 s66, s66, s31
    s_lshl_b32 s66, s66, 8
    s_add_u32 s66, s66, 65536
    s_add_u32 s66, s66, 128
    v_mov_b32 v8, 0
    v_mov_b32 v9, 0
    v_mov_b32 v10, 0
    v_mov_b32 v11, 0
    v_mov_b32 v12, 0
    s_mov_b32 s40, s4
    s_and_b32 s41, s5, 0xffff
    s_mov_b32 s42, 2621440
    s_mov_b32 s43, 0x00020000
    s_waitcnt lgkmcnt(0)
    s_mul_i32 s33, s33, 1664525
    s_add_u32 s33, s33, 1013904223
L_ld_w:
    s_load_dwordx4 s[88:91], s[28:29], s66 glc
    s_mov_b32 m0, s54
    s_nop 0
    buffer_load_dwordx4 v13, s[44:47], s59 offen lds
    s_add_u32 m0, m0, 1024
    s_add_u32 s59, s59, 1280
    buffer_load_dwordx4 v13, s[44:47], s59 offen lds
    s_add_u32 m0, m0, 1024
    s_add_u32 s59, s59, 1280
    buffer_load_dwordx4 v13, s[44:47], s59 offen lds
    s_add_u32 m0, m0, 1024
    s_add_u32 s59, s59, 28160
    buffer_load_dwordx4 v14, s[44:47], s59 offen lds
    s_add_u32 m0, m0, 1024
    s_add_u32 s59, s59, 1280
    buffer_load_dwordx4 v14, s[44:47], s59 offen lds
    s_add_u32 m0, m0, 1024
    s_add_u32 s59, s59, 1280
    buffer_load_dwordx4 v14, s[44:47], s59 offen lds
    s_add_u32 m0, m0, 1024
    s_add_u32 s59, s59, 28160
    buffer_load_dwordx4 v13, s[44:47], s59 offen lds
    s_add_u32 m0, m0, 1024
    s_add_u32 s59, s59, 1280
    buffer_load_dwordx4 v13, s[44:47], s59 offen lds
    s_branch L_skip558
L_padb4:
    s_branch L_padb12
L_skip558:
    s_add_u32 m0, m0, 1024
    s_add_u32 s59, s59, 1280
    buffer_load_dwordx4 v13, s[44:47], s59 offen lds
    s_add_u32 m0, m0, 1024
    s_add_u32 s59, s59, 28160
    buffer_load_dwordx4 v14, s[44:47], s59 offen lds
    s_add_u32 m0, m0, 1024
    s_add_u32 s59, s59, 1280
    buffer_load_dwordx4 v14, s[44:47], s59 offen lds
    s_add_u32 m0, m0, 1024
    s_add_u32 s59, s59, 1280
    buffer_load_dwordx4 v14, s[44:47], s59 offen lds
    s_add_u32 s59, s59, 151040
    s_sub_u32 s96, s59, 2457600
    s_cselect_b32 s59, s59, s96
    s_add_u32 s54, s54, 43008
    s_cmp_eq_u32 s54, s62
    s_cselect_b32 s54, s61, s54
    s_add_u32 s55, s55, 1
    s_waitcnt vmcnt(12)
L_ld_w_b:
    s_barrier
    s_cmp_lt_u32 s55, 10
    s_cbranch_scc1 L_ld_w
L_ld_end:
    s_waitcnt lgkmcnt(0)
    s_xor_b32 s96, s88, s33
    s_xor_b32 s97, s90, s33
    s_or_b32 s96, s96, s97
    s_cmp_eq_u32 s96, 0
    s_cbranch_scc1 L_wo_mk
    s_lshl_b32 s98, s30, 5
    s_add_u32 s98, s98, s31
    s_lshl_b32 s98, s98, 8
    s_add_u32 s98, s98, 65536
    s_add_u32 s98, s98, 128
    s_mov_b32 s100, 0
Lc_1:
    s_load_dwordx4 s[88:91], s[28:29], s98 glc
    s_waitcnt lgkmcnt(0)
    s_xor_b32 s96, s88, s33
    s_xor_b32 s97, s90, s33
    s_or_b32 s96, s96, s97
    s_cmp_eq_u32 s96, 0
    s_cbranch_scc1 Lcd_2
    s_sleep 2
    s_add_u32 s100, s100, 1
    s_cmp_lt_u32 s100, 1048576
    s_cbranch_scc1 Lc_1
    s_mov_b32 s91, 2
Lcd_2:
L_wo_mk:
    s_cmp_eq_u32 s91, 1
    s_cselect_b32 s99, 0, 15728640
    s_add_u32 s16, s28, s99
    s_addc_u32 s17, s29, 0
    s_cmp_lg_u32 s32, 2
    s_cbranch_scc1 L_wo_nc
    s_mov_b32 s44, s28
    s_and_b32 s45, s29, 0xffff
    s_mov_b32 s46, 1048576
    s_mov_b32 s47, 0x00020000
    v_lshlrev_b32 v4, 2, v0
    s_mov_b32 m0, 161152
    s_mov_b64 exec, 3
    s_add_u32 s66, s66, 8
    buffer_load_dword v4, s[44:47], s66 offen sc1 lds
    s_mov_b64 exec, -1
L_wo_nc:
    s_cmp_ge_u32 s32, 2
    s_cbranch_scc1 L_wo_a2
    s_mul_i32 m0, s32, 5120
    s_nop 0
    buffer_load_dwordx4 v8, s[40:43], 0 offen lds
    s_add_u32 m0, m0, 1024
    s_nop 0
    buffer_load_dwordx4 v9, s[40:43], 0 offen lds
    s_add_u32 m0, m0, 1024
    s_nop 0
    buffer_load_dwordx4 v10, s[40:43], 0 offen lds
    s_add_u32 m0, m0, 1024
    s_nop 0
    buffer_load_dwordx4 v11, s[40:43], 0 offen lds
    s_add_u32 m0, m0, 1024
    s_nop 0
    buffer_load_dwordx4 v12, s[40:43], 0 offen lds
    s_mov_b32 s59, 24576
    s_cmp_eq_u32 s32, 1
    s_cselect_b32 s59, 28672, s59
    s_add_u32 m0, s59, 10240
    s_nop 0
    buffer_load_dwordx4 v19, s[48:51], s59 offen offset:0 sc1 lds
    buffer_load_dwordx4 v19, s[48:51], s59 offen offset:1024 sc1 lds
    buffer_load_dwordx4 v19, s[48:51], s59 offen offset:2048 sc1 lds
    buffer_load_dwordx4 v19, s[48:51], s59 offen offset:3072 sc1 lds
    s_waitcnt vmcnt(9)
    s_branch L_wo_a3
L_padb5:
    s_branch L_padb13
L_wo_a2:
    s_mov_b32 s59, 0
    s_cmp_eq_u32 s32, 1
    s_cselect_b32 s59, 0, s59
    s_cmp_eq_u32 s32, 2
    s_cselect_b32 s59, 0, s59
    s_cmp_eq_u32 s32, 3
    s_cselect_b32 s59, 12288, s59
    s_add_u32 m0, s59, 10240
    s_nop 0
    buffer_load_dwordx4 v19, s[48:51], s59 offen offset:0 sc1 lds
    buffer_load_dwordx4 v19, s[48:51], s59 offen offset:1024 sc1 lds
    buffer_load_dwordx4 v19, s[48:51], s59 offen offset:2048 sc1 lds
    buffer_load_dwordx4 v19, s[48:51], s59 offen offset:3072 sc1 lds
    s_add_u32 m0, m0, 4096
    s_add_u32 s59, s59, 4096
    buffer_load_dwordx4 v19, s[48:51], s59 offen offset:0 sc1 lds
    buffer_load_dwordx4 v19, s[48:51], s59 offen offset:1024 sc1 lds
    buffer_load_dwordx4 v19, s[48:51], s59 offen offset:2048 sc1 lds
    buffer_load_dwordx4 v19, s[48:51], s59 offen offset:3072 sc1 lds
    s_add_u32 m0, m0, 4096
    s_add_u32 s59, s59, 4096
    buffer_load_dwordx4 v19, s[48:51], s59 offen offset:0 sc1 lds
    buffer_load_dwordx4 v19, s[48:51], s59 offen offset:1024 sc1 lds
    buffer_load_dwordx4 v19, s[48:51], s59 offen offset:2048 sc1 lds
    buffer_load_dwordx4 v19, s[48:51], s59 offen offset:3072 sc1 lds
    s_waitcnt vmcnt(12)
L_wo_a3:
    s_barrier
    s_cmp_ge_u32 s32, 2
    s_cbranch_scc1 L_wo_n9
    v_add_u32 v15, s64, v18
    v_add_u32 v16, s68, v17
    ds_read_b128 v[24:27], v15
    ds_read_b128 v[28:31], v16
    s_add_u32 s68, s68, 128
    s_cmp_eq_u32 s68, 1280
    s_cselect_b32 s68, 0, s68
    s_add_u32 s64, s64, 43008
    s_cmp_eq_u32 s64, 129024
    s_cselect_b32 s64, 0, s64
L_wo_n9:
    s_mov_b32 s59, 32768
    s_cmp_eq_u32 s32, 1
    s_cselect_b32 s59, 36864, s59
    s_cmp_eq_u32 s32, 2
    s_cselect_b32 s59, 41984, s59
    s_cmp_eq_u32 s32, 3
    s_cselect_b32 s59, 46080, s59
    s_add_u32 s96, s59, 10240
    v_add_u32 v32, s96, v19
    buffer_load_dwordx4 v[40:43], v19, s[48:51], s59 offen offset:0 sc1
    buffer_load_dwordx4 v[44:47], v19, s[48:51], s59 offen offset:1024 sc1
    buffer_load_dwordx4 v[48:51], v19, s[48:51], s59 offen offset:2048 sc1
    buffer_load_dwordx4 v[52:55], v19, s[48:51], s59 offen offset:3072 sc1
    s_add_u32 s59, s59, 4096
    buffer_load_dwordx4 v[56:59], v19, s[48:51], s59 offen offset:0 sc1
    s_mov_b32 s59, 51200
    s_cmp_eq_u32 s32, 1
    s_cselect_b32 s59, 63488, s59
    s_cmp_eq_u32 s32, 2
    s_cselect_b32 s59, 76800, s59
    s_cmp_eq_u32 s32, 3
    s_cselect_b32 s59, 89088, s59
    s_add_u32 s96, s59, 10240
    v_add_u32 v33, s96, v19
    buffer_load_dwordx4 v[60:63], v19, s[48:51], s59 offen offset:0 sc1
    buffer_load_dwordx4 v[64:67], v19, s[48:51], s59 offen offset:1024 sc1
    buffer_load_dwordx4 v[68:71], v19, s[48:51], s59 offen offset:2048 sc1
    buffer_load_dwordx4 v[72:75], v19, s[48:51], s59 offen offset:3072 sc1
    s_add_u32 s59, s59, 4096
    buffer_load_dwordx4 v[76:79], v19, s[48:51], s59 offen offset:0 sc1
    buffer_load_dwordx4 v[80:83], v19, s[48:51], s59 offen offset:1024 sc1
    buffer_load_dwordx4 v[84:87], v19, s[48:51], s59 offen offset:2048 sc1
    buffer_load_dwordx4 v[88:91], v19, s[48:51], s59 offen offset:3072 sc1
    s_add_u32 s59, s59, 4096
    buffer_load_dwordx4 v[92:95], v19, s[48:51], s59 offen offset:0 sc1
    buffer_load_dwordx4 v[96:99], v19, s[48:51], s59 offen offset:1024 sc1
    buffer_load_dwordx4 v[100:103], v19, s[48:51], s59 offen offset:2048 sc1
    buffer_load_dwordx4 v[104:107], v19, s[48:51], s59 offen offset:3072 sc1
    s_add_u32 s59, s59, 4096
    buffer_load_dwordx4 v[108:111], v19, s[48:51], s59 offen offset:0 sc1
    s_waitcnt vmcnt(18)
    s_cmp_lt_u32 s32, 2
    s_cbranch_scc1 L_wo_g
    v_mov_b32 v4, 16
    s_mov_b64 exec, 1
    ds_add_u32 v3, v4 offset:268
    s_mov_b64 exec, -1
    s_branch L_wo_ng
L_wo_g:
    s_waitcnt lgkmcnt(0)
    v_mfma_f32_16x16x32_bf16 v[20:23], v[28:31], v[24:27], v[20:23]
    v_lshlrev_b32 v5, 2, v0
    v_add_u32 v5, 161792, v5
    s_cmp_eq_u32 s32, 0
    s_cbranch_scc1 L_wo_g0
    s_nop 3
    ds_write_b32 v5, v20
    v_mov_b32 v4, 1
    ds_write_b32 v3, v4 offset:172
    v_mov_b32 v4, 16
    s_mov_b64 exec, 1
    ds_add_u32 v3, v4 offset:268
    s_mov_b64 exec, -1
    s_branch L_wo_ng
L_wo_g0:
    v_mov_b32 v4, 16
    s_mov_b64 exec, 1
    ds_add_u32 v3, v4 offset:268
    s_mov_b64 exec, -1
    s_mov_b32 s100, 0
Lw_3:
    ds_read_b32 v4, v3 offset:172
    s_waitcnt lgkmcnt(0)
    v_readfirstlane_b32 s99, v4
    s_cmp_ge_u32 s99, 1
    s_cbranch_scc1 Lwd_4
    s_add_u32 s100, s100, 1
    s_cmp_lt_u32 s100, 1048576
    s_cbranch_scc1 Lw_3
Lwd_4:
    ds_read_b32 v21, v5
    s_waitcnt lgkmcnt(0)
    v_add_f32 v20, v20, v21
    v_cvt_pk_bf16_f32 v20, v20, v20
    v_and_b32 v20, 0xffff0000, v20
    v_mul_f32 v20, 0xbfb8aa3b, v20
    v_exp_f32 v20, v20
    s_nop 0
    v_add_f32 v20, 1.0, v20
    v_rcp_f32 v20, v20
    s_nop 0
    v_cvt_pk_bf16_f32 v20, v20, v20
    v_and_b32 v21, 0xffff0000, v20
    v_mov_b32 v20, s33
    s_and_b32 s96, s37, 1
    s_lshl3_add_u32 s96, s96, s38
    s_lshl_b32 s96, s96, 7
    s_mul_i32 s97, s30, 262144
    s_add_u32 s96, s96, s97
    s_add_u32 s96, s96, 7537664
    v_lshl_add_u32 v5, v1, 3, s96
    s_cmp_ge_u32 s38, 8
    s_cbranch_scc1 L_wo_ng
    s_mov_b64 exec, 0xffff
    s_cmp_lg_u32 s91, 1
    s_cbranch_scc1 Ldg_5
    global_store_dwordx2 v5, v[20:21], s[16:17]
    s_branch Ldd_6
L_pada0:
    s_branch L_pada8
L_padb6:
    s_branch L_padb14
Ldg_5:
    global_store_dwordx2 v5, v[20:21], s[16:17] sc1
Ldd_6:
    s_mov_b64 exec, -1
L_wo_ng:
    s_waitcnt vmcnt(0)
    s_cmp_eq_u32 s32, 3
    s_cbranch_scc1 L_help
L_wo_fl:
    s_lshl_b32 s96, s30, 5
    s_add_u32 s96, s96, s31
    s_lshl_b32 s96, s96, 8
    s_add_u32 s96, s96, 65536
    s_lshl3_add_u32 s96, s32, s96
    s_add_u32 s40, s28, s96
    s_addc_u32 s41, s29, 0
    s_mul_i32 s96, s36, 327680
    s_mul_i32 s97, s32, 163840
    s_add_u32 s96, s96, s97
    s_lshl_b32 s97, s35, 7
    s_add_u32 s96, s96, s97
    s_add_u32 s96, s96, 4194304
    v_lshrrev_b32 v126, 3, v0
    v_and_b32 v127, 7, v0
    v_and_b32 v125, 6, v126
    v_xor_b32 v125, v125, v127
    v_lshlrev_b32 v125, 4, v125
    v_lshl_add_u32 v125, v126, 7, v125
    s_mul_i32 s97, s32, 5120
    s_add_u32 s97, s97, 112640
    v_add_u32 v125, s97, v125
    v_lshlrev_b32 v126, 12, v126
    v_lshl_add_u32 v126, v127, 4, v126
    v_add_u32 v120, s96, v126
    v_add_u32 v121, 32768, v120
    v_add_u32 v122, 65536, v120
    v_add_u32 v123, 98304, v120
    v_add_u32 v124, 131072, v120
    s_and_b32 s44, s33, 0xffffff00
    s_add_u32 s44, s44, 0x600
    s_mov_b32 s100, 0
Lw_7:
    ds_read_b32 v4, v3 offset:196
    s_waitcnt lgkmcnt(0)
    v_readfirstlane_b32 s99, v4
    s_cmp_ge_u32 s99, 0
    s_cbranch_scc1 Lwd_8
    s_sleep 2
    s_add_u32 s100, s100, 1
    s_cmp_lt_u32 s100, 1048576
    s_cbranch_scc1 Lw_7
Lwd_8:
    ds_write_b128 v32, v[40:43] offset:0
    ds_write_b128 v32, v[44:47] offset:1024
    ds_write_b128 v32, v[48:51] offset:2048
    ds_write_b128 v32, v[52:55] offset:3072
    s_waitcnt lgkmcnt(4)
    ds_write_b128 v32, v[56:59] offset:4096
    v_mov_b32 v4, 1
    s_mov_b64 exec, 1
    ds_add_u32 v3, v4 offset:200
    s_mov_b64 exec, -1
    s_mov_b32 s100, 0
Lw_9:
    ds_read_b32 v4, v3 offset:196
    s_waitcnt lgkmcnt(0)
    v_readfirstlane_b32 s99, v4
    s_cmp_ge_u32 s99, 8
    s_cbranch_scc1 Lwd_10
    s_sleep 2
    s_add_u32 s100, s100, 1
    s_cmp_lt_u32 s100, 1048576
    s_cbranch_scc1 Lw_9
Lwd_10:
    s_mov_b32 s100, 0
Lw_11:
    ds_read_b32 v4, v3 offset:268
    s_waitcnt lgkmcnt(0)
    v_readfirstlane_b32 s99, v4
    s_cmp_ge_u32 s99, 72
    s_cbranch_scc1 Lwd_12
    s_sleep 1
    s_add_u32 s100, s100, 1
    s_cmp_lt_u32 s100, 1048576
    s_cbranch_scc1 Lw_11
Lwd_12:
    ds_write_b128 v33, v[60:63] offset:0
    ds_write_b128 v33, v[64:67] offset:1024
    ds_write_b128 v33, v[68:71] offset:2048
    ds_write_b128 v33, v[72:75] offset:3072
    s_waitcnt lgkmcnt(4)
    ds_write_b128 v33, v[76:79] offset:4096
    ds_write_b128 v33, v[80:83] offset:5120
    ds_write_b128 v33, v[84:87] offset:6144
    ds_write_b128 v33, v[88:91] offset:7168
    s_waitcnt lgkmcnt(4)
    ds_write_b128 v33, v[92:95] offset:8192
    ds_write_b128 v33, v[96:99] offset:9216
    ds_write_b128 v33, v[100:103] offset:10240
    ds_write_b128 v33, v[104:107] offset:11264
    s_waitcnt lgkmcnt(4)
    ds_write_b128 v33, v[108:111] offset:12288
    v_mov_b32 v4, 1
    s_mov_b64 exec, 1
    ds_add_u32 v3, v4 offset:204
    s_mov_b64 exec, -1
    s_cmp_lt_u32 s32, 2
    s_cbranch_scc1 L_aux
    s_endpgm
L_help:
    s_and_b32 s96, s35, 3
    s_lshl_b32 s96, s96, 9
    s_mul_i32 s97, s30, 262144
    s_add_u32 s96, s96, s97
    s_add_u32 s96, s96, 7537664
    v_lshl_add_u32 v14, v0, 3, s96
    v_lshl_add_u32 v13, v0, 2, v3
    s_mov_b32 s100, 0
L_gchk:
    global_load_dwordx2 v[18:19], v14, s[16:17] sc1
    s_waitcnt vmcnt(0)
    v_cmp_ne_u32 vcc, s33, v18
    s_cbranch_vccz L_gok
    s_sleep 4
    s_add_u32 s100, s100, 1
    s_cmp_lt_u32 s100, 1048576
    s_cbranch_scc1 L_gchk
L_gok:
    v_sub_f32 v18, 1.0, v19
    ds_write_b32 v13, v19 offset:768
    ds_write_b32 v13, v18 offset:512
    v_mov_b32 v4, 1
    s_mov_b64 exec, 1
    ds_add_u32 v3, v4 offset:208
    s_mov_b64 exec, -1
    s_cmp_eq_u32 s34, 0
    s_cbranch_scc1 L_wo_fl
    s_mul_i32 s96, s30, 262144
    s_and_b32 s97, s35, 3
    s_lshl_b32 s97, s97, 8
    s_add_u32 s96, s96, s97
    s_add_u32 s96, s96, 7536640
    v_lshl_add_u32 v12, v0, 2, s96
    s_mov_b32 exec_hi, 1048575
    s_mov_b32 exec_lo, 0xfffff
    s_mov_b32 s100, 0
L_rl1:
    global_load_dword v5, v12, s[16:17] sc1
    s_waitcnt vmcnt(0)
    v_cmp_ne_u32 vcc, s33, v5
    s_cbranch_vccz L_rd1
    s_sleep 2
    s_add_u32 s100, s100, 1
    s_cmp_lt_u32 s100, 1048576
    s_cbranch_scc1 L_rl1
L_rd1:
    s_mov_b64 exec, -1
    v_mov_b32 v4, 1
    ds_write_b32 v3, v4 offset:276
    s_cmp_lg_u32 s2, 240
    s_cbranch_scc1 L_th_exit
    v_lshlrev_b32 v20, 8, v0
    v_add_u32 v20, 65536, v20
    v_mov_b32 v24, 0
    v_mov_b32 v25, 0
    s_mov_b32 s52, 0
L_epl:
    s_mov_b64 exec, -1
    s_mov_b32 s100, 0
L_hpe:
    global_atomic_or_x2 v[26:27], v20, v[24:25], s[28:29] offset:24 sc0 sc1
    s_waitcnt vmcnt(0)
    v_cmp_ne_u32 vcc, s33, v26
    s_cbranch_vccz L_hde
    s_mov_b64 exec, vcc
    s_sleep 8
    s_add_u32 s100, s100, 1
    s_cmp_lt_u32 s100, 1048576
    s_cbranch_scc1 L_hpe
L_hde:
    s_mov_b64 exec, -1
    v_add_u32 v20, 0x4000, v20
    s_add_u32 s52, s52, 1
    s_cmp_lt_u32 s52, 4
    s_cbranch_scc1 L_epl
    v_mov_b32 v4, 0
    v_mov_b32 v5, s33
    s_mov_b64 exec, 1
    global_store_dword v4, v5, s[28:29] sc1
    s_mov_b64 exec, -1
L_th_exit:
    s_endpgm
L_pada1:
    s_branch L_pada9
L_aserv:
    v_mul_u32_u24 v5, 1280, v2
    v_lshl_add_u32 v4, v1, 4, v5
    s_lshl_b32 s96, s38, 8
    v_add_u32 v4, s96, v4
    s_lshl_b32 s97, s32, 6
    v_xor_b32 v13, s97, v4
    v_xor_b32 v14, 16, v13
    v_xor_b32 v15, 32, v13
    v_xor_b32 v16, 48, v13
    s_mul_i32 s96, s32, 40960
    s_add_u32 s52, s39, s96
    s_lshl_b32 s53, s32, 13
    s_sub_u32 s96, s39, 5120
    v_xor_b32 v4, 0xf0, v4
    v_add_u32 v17, s96, v4
    s_waitcnt lgkmcnt(0)
    s_mov_b32 s84, s6
    s_and_b32 s85, s7, 0xffff
    s_mov_b32 s86, 2621440
    s_mov_b32 s87, 0x00020000
    s_mov_b32 s80, s8
    s_and_b32 s81, s9, 0xffff
    s_mov_b32 s82, 2621440
    s_mov_b32 s83, 0x00020000
    s_load_dword s33, s[28:29], 0
    s_cmp_ge_u32 s38, 5
    s_cbranch_scc1 L_as_nokv
    s_cmp_lg_u32 s32, 0
    s_cbranch_scc1 L_as_nohalo
    s_mov_b32 m0, 90496
    s_nop 0
    buffer_load_dwordx4 v17, s[84:87], 0 offen lds
L_as_nohalo:
    s_add_u32 m0, s53, 91520
    s_mov_b32 s59, s52
    buffer_load_dwordx4 v13, s[84:87], s59 offen lds
    s_add_u32 m0, m0, 1024
    s_add_u32 s59, s59, 5120
    buffer_load_dwordx4 v13, s[84:87], s59 offen lds
    s_add_u32 m0, m0, 1024
    s_add_u32 s59, s59, 5120
    buffer_load_dwordx4 v14, s[84:87], s59 offen lds
    s_add_u32 m0, m0, 1024
    s_add_u32 s59, s59, 5120
    buffer_load_dwordx4 v14, s[84:87], s59 offen lds
    s_add_u32 m0, m0, 1024
    s_add_u32 s59, s59, 5120
    buffer_load_dwordx4 v15, s[84:87], s59 offen lds
    s_add_u32 m0, m0, 1024
    s_add_u32 s59, s59, 5120
    buffer_load_dwordx4 v15, s[84:87], s59 offen lds
    s_add_u32 m0, m0, 1024
    s_add_u32 s59, s59, 5120
    buffer_load_dwordx4 v16, s[84:87], s59 offen lds
    s_add_u32 m0, m0, 1024
    s_add_u32 s59, s59, 5120
    buffer_load_dwordx4 v16, s[84:87], s59 offen lds
    s_add_u32 m0, s53, 124288
    s_nop 0
    buffer_load_dwordx4 v13, s[80:83], s52 offen lds
    s_add_u32 m0, m0, 1024
    s_add_u32 s52, s52, 5120
    buffer_load_dwordx4 v13, s[80:83], s52 offen lds
    s_add_u32 m0, m0, 1024
    s_add_u32 s52, s52, 5120
    buffer_load_dwordx4 v14, s[80:83], s52 offen lds
    s_add_u32 m0, m0, 1024
    s_add_u32 s52, s52, 5120
    buffer_load_dwordx4 v14, s[80:83], s52 offen lds
    s_add_u32 m0, m0, 1024
    s_add_u32 s52, s52, 5120
    buffer_load_dwordx4 v15, s[80:83], s52 offen lds
    s_add_u32 m0, m0, 1024
    s_add_u32 s52, s52, 5120
    buffer_load_dwordx4 v15, s[80:83], s52 offen lds
    s_add_u32 m0, m0, 1024
    s_add_u32 s52, s52, 5120
    buffer_load_dwordx4 v16, s[80:83], s52 offen lds
    s_add_u32 m0, m0, 1024
    s_add_u32 s52, s52, 5120
    buffer_load_dwordx4 v16, s[80:83], s52 offen lds
L_as_nokv:
    s_sub_u32 s96, s31, 20
    s_mul_i32 s97, s96, 43
    s_lshr_b32 s97, s97, 7
    s_mul_i32 s98, s96, 7
    s_sub_u32 s98, s98, s97
    s_lshr_b32 s96, 0x924, s96
    s_and_b32 s96, s96, 1
    s_sub_u32 s64, 7, s96
    s_mul_i32 s97, s30, 80
    s_add_u32 s98, s98, s97
    s_lshl_b32 s98, s98, 12
    s_add_u32 s80, s12, s98
    s_addc_u32 s81, s13, 0
    s_and_b32 s81, s81, 0xffff
    s_lshl_b32 s82, s64, 12
    s_lshl_b32 s52, s32, 12
    s_add_u32 s53, s52, 16384
    v_lshlrev_b32 v18, 4, v0
    buffer_load_dwordx4 v[24:27], v18, s[80:83], s52 offen offset:0
    buffer_load_dwordx4 v[28:31], v18, s[80:83], s52 offen offset:1024
    buffer_load_dwordx4 v[32:35], v18, s[80:83], s52 offen offset:2048
    buffer_load_dwordx4 v[36:39], v18, s[80:83], s52 offen offset:3072
    buffer_load_dwordx4 v[40:43], v18, s[80:83], s53 offen offset:0
    buffer_load_dwordx4 v[44:47], v18, s[80:83], s53 offen offset:1024
    buffer_load_dwordx4 v[48:51], v18, s[80:83], s53 offen offset:2048
    buffer_load_dwordx4 v[52:55], v18, s[80:83], s53 offen offset:3072
    s_waitcnt vmcnt(8) lgkmcnt(0)
    s_barrier
    s_mul_i32 s33, s33, 1664525
    s_add_u32 s33, s33, 1013904223
    s_mul_i32 s54, s32, 8320
    s_add_u32 s96, s54, 1008
    v_sub_u32 v19, s96, v18
    v_lshl_add_u32 v20, v1, 2, s54
    s_lshl_b32 s96, s32, 2
    v_add_u32 v21, s96, v3
    v_mov_b32 v22, 0
    s_mov_b32 s100, 0
Lw_13:
    ds_read_b32 v4, v3 offset:256
    s_waitcnt lgkmcnt(0)
    v_readfirstlane_b32 s99, v4
    s_cmp_ge_u32 s99, 8
    s_cbranch_scc1 Lwd_14
    s_sleep 1
    s_add_u32 s100, s100, 1
    s_cmp_lt_u32 s100, 1048576
    s_cbranch_scc1 Lw_13
Lwd_14:
    s_mov_b32 s98, 0xffff
    s_waitcnt vmcnt(4)
    v_readlane_b32 s60, v27, 63
    v_readlane_b32 s61, v31, 63
    v_readlane_b32 s62, v35, 63
    v_mov_b32_dpp v56, v27 wave_shr:1 row_mask:0xf bank_mask:0xf
    v_mov_b32_dpp v57, v31 wave_shr:1 row_mask:0xf bank_mask:0xf
    v_mov_b32_dpp v58, v35 wave_shr:1 row_mask:0xf bank_mask:0xf
    v_mov_b32_dpp v59, v39 wave_shr:1 row_mask:0xf bank_mask:0xf
    v_writelane_b32 v56, 0, 0
    v_writelane_b32 v57, s60, 0
    v_writelane_b32 v58, s61, 0
    v_writelane_b32 v59, s62, 0
    v_alignbit_b32 v60, v27, v27, 16
    v_bfi_b32 v76, s98, v27, v26
    v_alignbit_b32 v61, v26, v26, 16
    v_bfi_b32 v77, s98, v26, v25
    s_branch L_skip1146
L_pada2:
    s_branch L_pada10
L_skip1146:
    v_alignbit_b32 v62, v25, v25, 16
    v_bfi_b32 v78, s98, v25, v24
    v_alignbit_b32 v63, v24, v24, 16
    v_bfi_b32 v79, s98, v24, v56
    ds_write_b128 v19, v[60:63] offset:3072
    ds_write_b128 v19, v[76:79] offset:7232
    v_alignbit_b32 v64, v31, v31, 16
    v_bfi_b32 v80, s98, v31, v30
    v_alignbit_b32 v65, v30, v30, 16
    v_bfi_b32 v81, s98, v30, v29
    v_alignbit_b32 v66, v29, v29, 16
    v_bfi_b32 v82, s98, v29, v28
    v_alignbit_b32 v67, v28, v28, 16
    v_bfi_b32 v83, s98, v28, v57
    ds_write_b128 v19, v[64:67] offset:2048
    ds_write_b128 v19, v[80:83] offset:6208
    v_alignbit_b32 v68, v35, v35, 16
    v_bfi_b32 v84, s98, v35, v34
    v_alignbit_b32 v69, v34, v34, 16
    v_bfi_b32 v85, s98, v34, v33
    v_alignbit_b32 v70, v33, v33, 16
    v_bfi_b32 v86, s98, v33, v32
    v_alignbit_b32 v71, v32, v32, 16
    v_bfi_b32 v87, s98, v32, v58
    ds_write_b128 v19, v[68:71] offset:1024
    ds_write_b128 v19, v[84:87] offset:5184
    v_alignbit_b32 v72, v39, v39, 16
    v_bfi_b32 v88, s98, v39, v38
    v_alignbit_b32 v73, v38, v38, 16
    v_bfi_b32 v89, s98, v38, v37
    v_alignbit_b32 v74, v37, v37, 16
    v_bfi_b32 v90, s98, v37, v36
    v_alignbit_b32 v75, v36, v36, 16
    v_bfi_b32 v91, s98, v36, v59
    ds_write_b128 v19, v[72:75] offset:0
    ds_write_b128 v19, v[88:91] offset:4160
    ds_write_b32 v20, v22 offset:4096
    ds_write_b32 v20, v22 offset:8256
    v_mov_b32 v4, 1
    ds_write_b32 v21, v4 offset:312
    s_waitcnt lgkmcnt(0)
    s_add_u32 s96, s32, 4
    s_cmp_ge_u32 s96, s64
    s_cbranch_scc1 L_hb1
    s_waitcnt vmcnt(0)
    v_readlane_b32 s60, v43, 63
    v_readlane_b32 s61, v47, 63
    v_readlane_b32 s62, v51, 63
    v_mov_b32_dpp v56, v43 wave_shr:1 row_mask:0xf bank_mask:0xf
    v_mov_b32_dpp v57, v47 wave_shr:1 row_mask:0xf bank_mask:0xf
    v_mov_b32_dpp v58, v51 wave_shr:1 row_mask:0xf bank_mask:0xf
    v_mov_b32_dpp v59, v55 wave_shr:1 row_mask:0xf bank_mask:0xf
    v_writelane_b32 v56, 0, 0
    v_writelane_b32 v57, s60, 0
    v_writelane_b32 v58, s61, 0
    v_writelane_b32 v59, s62, 0
    v_alignbit_b32 v60, v43, v43, 16
    v_bfi_b32 v76, s98, v43, v42
    v_alignbit_b32 v61, v42, v42, 16
    v_bfi_b32 v77, s98, v42, v41
    v_alignbit_b32 v62, v41, v41, 16
    v_bfi_b32 v78, s98, v41, v40
    v_alignbit_b32 v63, v40, v40, 16
    v_bfi_b32 v79, s98, v40, v56
    ds_write_b128 v19, v[60:63] offset:36352
    ds_write_b128 v19, v[76:79] offset:40512
    v_alignbit_b32 v64, v47, v47, 16
    v_bfi_b32 v80, s98, v47, v46
    v_alignbit_b32 v65, v46, v46, 16
    v_bfi_b32 v81, s98, v46, v45
    v_alignbit_b32 v66, v45, v45, 16
    v_bfi_b32 v82, s98, v45, v44
    v_alignbit_b32 v67, v44, v44, 16
    v_bfi_b32 v83, s98, v44, v57
    ds_write_b128 v19, v[64:67] offset:35328
    ds_write_b128 v19, v[80:83] offset:39488
    v_alignbit_b32 v68, v51, v51, 16
    v_bfi_b32 v84, s98, v51, v50
    v_alignbit_b32 v69, v50, v50, 16
    v_bfi_b32 v85, s98, v50, v49
    v_alignbit_b32 v70, v49, v49, 16
    v_bfi_b32 v86, s98, v49, v48
    v_alignbit_b32 v71, v48, v48, 16
    v_bfi_b32 v87, s98, v48, v58
    ds_write_b128 v19, v[68:71] offset:34304
    ds_write_b128 v19, v[84:87] offset:38464
    v_alignbit_b32 v72, v55, v55, 16
    v_bfi_b32 v88, s98, v55, v54
    v_alignbit_b32 v73, v54, v54, 16
    v_bfi_b32 v89, s98, v54, v53
    v_alignbit_b32 v74, v53, v53, 16
    v_bfi_b32 v90, s98, v53, v52
    v_alignbit_b32 v75, v52, v52, 16
    v_bfi_b32 v91, s98, v52, v59
    ds_write_b128 v19, v[72:75] offset:33280
    ds_write_b128 v19, v[88:91] offset:37440
    ds_write_b32 v20, v22 offset:37376
    ds_write_b32 v20, v22 offset:41536
    v_mov_b32 v4, 1
    ds_write_b32 v21, v4 offset:328
    s_waitcnt lgkmcnt(0)
L_hb1:
    s_cmp_eq_u32 s32, 3
    s_cbranch_scc1 L_ahelp
    s_setprio 1
    s_mul_i32 s96, s36, 102400
    s_add_u32 s96, s96, 9437184
    s_add_u32 s48, s28, s96
    s_addc_u32 s49, s29, 0
    s_and_b32 s49, s49, 0xffff
    s_mov_b32 s50, 102400
    s_mov_b32 s51, 0x00020000
    v_lshlrev_b32 v19, 4, v0
    s_lshl1_add_u32 s96, s35, s32
    s_mul_i32 s96, s96, 40960
    s_mul_i32 s97, s36, 160
    s_add_u32 s96, s96, s97
    v_add_u32 v4, 0, v0
    v_mul_u32_u24 v8, 6554, v4
    v_lshrrev_b32 v8, 16, v8
    v_mul_u32_u24 v8, 1120, v8
    v_lshl_add_u32 v4, v4, 4, s96
    v_add_u32 v8, v8, v4
    v_add_u32 v4, 64, v0
    v_mul_u32_u24 v9, 6554, v4
    v_lshrrev_b32 v9, 16, v9
    v_mul_u32_u24 v9, 1120, v9
    v_lshl_add_u32 v4, v4, 4, s96
    v_add_u32 v9, v9, v4
    v_add_u32 v4, 128, v0
    v_mul_u32_u24 v10, 6554, v4
    v_lshrrev_b32 v10, 16, v10
    s_branch L_skip1278
L_pada3:
    s_branch L_pada11
L_skip1278:
    v_mul_u32_u24 v10, 1120, v10
    v_lshl_add_u32 v4, v4, 4, s96
    v_add_u32 v10, v10, v4
    v_add_u32 v4, 192, v0
    v_mul_u32_u24 v11, 6554, v4
    v_lshrrev_b32 v11, 16, v11
    v_mul_u32_u24 v11, 1120, v11
    v_lshl_add_u32 v4, v4, 4, s96
    v_add_u32 v11, v11, v4
    v_add_u32 v4, 256, v0
    v_mul_u32_u24 v12, 6554, v4
    v_lshrrev_b32 v12, 16, v12
    v_mul_u32_u24 v12, 1120, v12
    v_lshl_add_u32 v4, v4, 4, s96
    v_add_u32 v12, v12, v4
    s_mul_i32 s96, s32, 5120
    s_add_u32 s96, s96, 48128
    v_add_u32 v21, s96, v19
    s_mul_i32 s59, s32, 15360
    s_add_u32 s96, s59, 58368
    v_add_u32 v20, s96, v19
    s_add_u32 s59, s59, 51200
    s_setprio 3
    s_mov_b32 s100, 0
Lw_15:
    ds_read_b32 v4, v3 offset:280
    s_waitcnt lgkmcnt(0)
    v_readfirstlane_b32 s99, v4
    s_cmp_ge_u32 s99, 8
    s_cbranch_scc1 Lwd_16
    s_sleep 4
    s_add_u32 s100, s100, 1
    s_cmp_lt_u32 s100, 1048576
    s_cbranch_scc1 Lw_15
Lwd_16:
    s_mov_b32 s100, 0
Lw_17:
    ds_read_b32 v4, v3 offset:192
    s_waitcnt lgkmcnt(0)
    v_readfirstlane_b32 s99, v4
    s_cmp_ge_u32 s99, 1
    s_cbranch_scc1 Lwd_18
    s_sleep 4
    s_add_u32 s100, s100, 1
    s_cmp_lt_u32 s100, 1048576
    s_cbranch_scc1 Lw_17
Lwd_18:
    buffer_load_dwordx4 v[24:27], v19, s[48:51], s59 offen offset:0 sc1
    buffer_load_dwordx4 v[28:31], v19, s[48:51], s59 offen offset:1024 sc1
    buffer_load_dwordx4 v[32:35], v19, s[48:51], s59 offen offset:2048 sc1
    buffer_load_dwordx4 v[36:39], v19, s[48:51], s59 offen offset:3072 sc1
    s_add_u32 s59, s59, 4096
    buffer_load_dwordx4 v[40:43], v19, s[48:51], s59 offen offset:0 sc1
    buffer_load_dwordx4 v[44:47], v19, s[48:51], s59 offen offset:1024 sc1
    buffer_load_dwordx4 v[48:51], v19, s[48:51], s59 offen offset:2048 sc1
    buffer_load_dwordx4 v[52:55], v19, s[48:51], s59 offen offset:3072 sc1
    s_add_u32 s59, s59, 4096
    buffer_load_dwordx4 v[56:59], v19, s[48:51], s59 offen offset:0 sc1
    buffer_load_dwordx4 v[60:63], v19, s[48:51], s59 offen offset:1024 sc1
    buffer_load_dwordx4 v[64:67], v19, s[48:51], s59 offen offset:2048 sc1
    buffer_load_dwordx4 v[68:71], v19, s[48:51], s59 offen offset:3072 sc1
    s_add_u32 s59, s59, 4096
    buffer_load_dwordx4 v[72:75], v19, s[48:51], s59 offen offset:0 sc1
    buffer_load_dwordx4 v[76:79], v19, s[48:51], s59 offen offset:1024 sc1
    buffer_load_dwordx4 v[80:83], v19, s[48:51], s59 offen offset:2048 sc1
    s_cmp_lt_u32 s32, 2
    s_cbranch_scc1 L_ai_x
    s_add_u32 s59, s59, 3072
    buffer_load_dwordx4 v[84:87], v19, s[48:51], s59 offen offset:0 sc1
    buffer_load_dwordx4 v[88:91], v19, s[48:51], s59 offen offset:1024 sc1
    buffer_load_dwordx4 v[92:95], v19, s[48:51], s59 offen offset:2048 sc1
    buffer_load_dwordx4 v[96:99], v19, s[48:51], s59 offen offset:3072 sc1
    s_add_u32 s59, s59, 4096
    buffer_load_dwordx4 v[100:103], v19, s[48:51], s59 offen offset:0 sc1
    v_add_u32 v21, 15360, v20
    s_branch L_ai_d
L_pada4:
    s_branch L_pada12
L_ai_x:
    global_load_dwordx4 v[84:87], v8, s[4:5]
    global_load_dwordx4 v[88:91], v9, s[4:5]
    global_load_dwordx4 v[92:95], v10, s[4:5]
    global_load_dwordx4 v[96:99], v11, s[4:5]
    global_load_dwordx4 v[100:103], v12, s[4:5]
L_ai_d:
    s_mov_b32 s100, 0
Lw_19:
    ds_read_b32 v4, v3 offset:248
    s_waitcnt lgkmcnt(0)
    v_readfirstlane_b32 s99, v4
    s_cmp_ge_u32 s99, 1
    s_cbranch_scc1 Lwd_20
    s_sleep 8
    s_add_u32 s100, s100, 1
    s_cmp_lt_u32 s100, 1048576
    s_cbranch_scc1 Lw_19
Lwd_20:
    s_mov_b32 s59, 0
    s_cmp_eq_u32 s32, 1
    s_cselect_b32 s59, 17408, s59
    s_cmp_eq_u32 s32, 2
    s_cselect_b32 s59, 33792, s59
    s_add_u32 m0, s59, 109568
    s_nop 0
    buffer_load_dwordx4 v19, s[48:51], s59 offen offset:0 sc1 lds
    s_waitcnt vmcnt(2)
    buffer_load_dwordx4 v19, s[48:51], s59 offen offset:1024 sc1 lds
    s_waitcnt vmcnt(2)
    buffer_load_dwordx4 v19, s[48:51], s59 offen offset:2048 sc1 lds
    s_waitcnt vmcnt(2)
    buffer_load_dwordx4 v19, s[48:51], s59 offen offset:3072 sc1 lds
    s_add_u32 m0, m0, 4096
    s_add_u32 s59, s59, 4096
    s_waitcnt vmcnt(2)
    buffer_load_dwordx4 v19, s[48:51], s59 offen offset:0 sc1 lds
    s_waitcnt vmcnt(2)
    buffer_load_dwordx4 v19, s[48:51], s59 offen offset:1024 sc1 lds
    s_waitcnt vmcnt(2)
    buffer_load_dwordx4 v19, s[48:51], s59 offen offset:2048 sc1 lds
    s_waitcnt vmcnt(2)
    buffer_load_dwordx4 v19, s[48:51], s59 offen offset:3072 sc1 lds
    s_add_u32 m0, m0, 4096
    s_add_u32 s59, s59, 4096
    s_waitcnt vmcnt(2)
    buffer_load_dwordx4 v19, s[48:51], s59 offen offset:0 sc1 lds
    s_waitcnt vmcnt(2)
    buffer_load_dwordx4 v19, s[48:51], s59 offen offset:1024 sc1 lds
    s_waitcnt vmcnt(2)
    buffer_load_dwordx4 v19, s[48:51], s59 offen offset:2048 sc1 lds
    s_waitcnt vmcnt(2)
    buffer_load_dwordx4 v19, s[48:51], s59 offen offset:3072 sc1 lds
    s_add_u32 m0, m0, 4096
    s_add_u32 s59, s59, 4096
    s_waitcnt vmcnt(2)
    buffer_load_dwordx4 v19, s[48:51], s59 offen offset:0 sc1 lds
    s_waitcnt vmcnt(2)
    buffer_load_dwordx4 v19, s[48:51], s59 offen offset:1024 sc1 lds
    s_waitcnt vmcnt(2)
    buffer_load_dwordx4 v19, s[48:51], s59 offen offset:2048 sc1 lds
    s_waitcnt vmcnt(2)
    buffer_load_dwordx4 v19, s[48:51], s59 offen offset:3072 sc1 lds
    s_add_u32 m0, m0, 4096
    s_add_u32 s59, s59, 4096
    s_waitcnt vmcnt(2)
    buffer_load_dwordx4 v19, s[48:51], s59 offen offset:0 sc1 lds
    s_waitcnt vmcnt(2)
    s_waitcnt vmcnt(0)
    v_mov_b32 v4, 1
    s_mov_b64 exec, 1
    ds_add_u32 v3, v4 offset:200
    s_mov_b64 exec, -1
    s_lshl_b32 s96, s30, 5
    s_add_u32 s96, s96, s31
    s_lshl_b32 s96, s96, 8
    s_add_u32 s96, s96, 65536
    s_lshl3_add_u32 s96, s32, s96
    s_add_u32 s40, s28, s96
    s_addc_u32 s41, s29, 0
    s_mul_i32 s96, s36, 327680
    s_mul_i32 s97, s32, 163840
    s_add_u32 s96, s96, s97
    s_lshl_b32 s97, s35, 7
    s_add_u32 s96, s96, s97
    s_add_u32 s96, s96, 4194304
    v_lshrrev_b32 v126, 3, v0
    v_and_b32 v127, 7, v0
    v_and_b32 v125, 6, v126
    v_xor_b32 v125, v125, v127
    v_lshlrev_b32 v125, 4, v125
    v_lshl_add_u32 v125, v126, 7, v125
    s_mul_i32 s97, s32, 5120
    s_add_u32 s97, s97, 0
    v_add_u32 v125, s97, v125
    v_lshlrev_b32 v126, 12, v126
    v_lshl_add_u32 v126, v127, 4, v126
    v_add_u32 v120, s96, v126
    v_add_u32 v121, 32768, v120
    v_add_u32 v122, 65536, v120
    v_add_u32 v123, 98304, v120
    v_add_u32 v124, 131072, v120
    s_and_b32 s44, s33, 0xffffff00
    s_add_u32 s44, s44, 0x600
    s_mov_b32 s100, 0
Lw_21:
    ds_read_b32 v4, v3 offset:304
    s_waitcnt lgkmcnt(0)
    v_readfirstlane_b32 s99, v4
    s_cmp_ge_u32 s99, 1
    s_cbranch_scc1 Lwd_22
    s_sleep 8
    s_add_u32 s100, s100, 1
    s_cmp_lt_u32 s100, 1048576
    s_cbranch_scc1 Lw_21
Lwd_22:
    s_mov_b32 s100, 0
Lw_23:
    ds_read_b32 v4, v3 offset:196
    s_waitcnt lgkmcnt(0)
    v_readfirstlane_b32 s99, v4
    s_cmp_ge_u32 s99, 8
    s_cbranch_scc1 Lwd_24
    s_sleep 1
    s_add_u32 s100, s100, 1
    s_cmp_lt_u32 s100, 1048576
    s_cbranch_scc1 Lw_23
Lwd_24:
    ds_write_b128 v21, v[84:87] offset:0
    ds_write_b128 v21, v[88:91] offset:1024
    ds_write_b128 v21, v[92:95] offset:2048
    ds_write_b128 v21, v[96:99] offset:3072
    s_waitcnt lgkmcnt(4)
    ds_write_b128 v21, v[100:103] offset:4096
    ds_write_b128 v20, v[24:27] offset:0
    ds_write_b128 v20, v[28:31] offset:1024
    ds_write_b128 v20, v[32:35] offset:2048
    ds_write_b128 v20, v[36:39] offset:3072
    s_waitcnt lgkmcnt(4)
    ds_write_b128 v20, v[40:43] offset:4096
    ds_write_b128 v20, v[44:47] offset:5120
    ds_write_b128 v20, v[48:51] offset:6144
    ds_write_b128 v20, v[52:55] offset:7168
    s_waitcnt lgkmcnt(4)
    ds_write_b128 v20, v[56:59] offset:8192
    ds_write_b128 v20, v[60:63] offset:9216
    ds_write_b128 v20, v[64:67] offset:10240
    ds_write_b128 v20, v[68:71] offset:11264
    s_waitcnt lgkmcnt(4)
    ds_write_b128 v20, v[72:75] offset:12288
    ds_write_b128 v20, v[76:79] offset:13312
    ds_write_b128 v20, v[80:83] offset:14336
    v_mov_b32 v4, 1
    s_mov_b64 exec, 1
    ds_add_u32 v3, v4 offset:204
    s_mov_b64 exec, -1
    s_cmp_lt_u32 s32, 2
    s_cbranch_scc1 L_aux
    s_endpgm
L_pada5:
    s_branch L_pada13
L_ahelp:
    v_lshlrev_b32 v4, 2, v0
    v_add_u32 v4, 161792, v4
    v_mov_b32 v5, 0
    ds_write_b32 v4, v5
    s_lshl_b32 s96, s30, 5
    s_add_u32 s96, s96, s31
    s_lshl_b32 s96, s96, 8
    s_add_u32 s96, s96, 65536
    v_lshl_add_u32 v4, v0, 3, s96
    v_mov_b32 v6, 0
    s_and_b32 s97, s33, 0xffffff00
    v_mov_b32 v7, s97
    s_getreg_b32 s97, hwreg(HW_REG_XCC_ID, 0, 4)
    v_writelane_b32 v6, s33, 3
    v_writelane_b32 v7, s97, 3
    s_mov_b64 exec, 0xffff
    global_store_dwordx2 v4, v[6:7], s[28:29] sc1
    s_mov_b64 exec, -1
    s_cmp_lg_u32 s31, 30
    s_cbranch_scc1 L_nocen
    s_sleep 8
    s_lshl_b32 s96, s30, 13
    s_add_u32 s96, s96, 65536
    v_and_b32 v4, 31, v0
    v_lshl_add_u32 v20, v4, 8, s96
    v_mov_b32 v24, 0
    v_mov_b32 v25, 0
    s_mov_b64 exec, 0xffffffff
    s_mov_b32 s100, 0
L_hpg:
    global_atomic_or_x2 v[26:27], v20, v[24:25], s[28:29] offset:24 sc0 sc1
    s_waitcnt vmcnt(0)
    v_cmp_ne_u32 vcc, s33, v26
    s_cbranch_vccz L_hdg
    s_mov_b64 exec, vcc
    s_sleep 2
    s_add_u32 s100, s100, 1
    s_cmp_lt_u32 s100, 1048576
    s_cbranch_scc1 L_hpg
L_hdg:
    s_mov_b64 exec, -1
    v_readfirstlane_b32 s96, v27
    s_nop 1
    v_cmp_ne_u32 vcc, s96, v27
    s_cmp_eq_u32 vcc_lo, 0
    s_cselect_b32 s96, 1, 2
    v_mov_b32 v22, s33
    v_mov_b32 v23, s96
    s_mov_b64 exec, 0xffffffff
    global_store_dwordx2 v20, v[22:23], s[28:29] offset:136 sc1
    s_lshl_b32 s96, s30, 8
    s_add_u32 s96, s96, 65536
    v_lshl_add_u32 v21, v0, 11, s96
    global_store_dword v21, v22, s[28:29] offset:128 sc1
    s_mov_b64 exec, -1
L_nocen:
    s_sub_u32 s52, s31, 20
    s_mul_i32 s96, s30, 262144
    s_mul_i32 s97, s52, 16640
    s_add_u32 s96, s96, s97
    s_add_u32 s53, s96, 7340032
    s_mul_i32 s96, s30, 327680
    s_mul_i32 s97, s52, 27392
    s_min_u32 s97, s97, 300288
    s_add_u32 s96, s96, s97
    s_add_u32 s54, s96, 13107200
    s_mul_i32 s55, s36, 102400
    s_add_u32 s55, s55, 9437184
    v_lshlrev_b32 v15, 7, v0
    s_mov_b32 s44, s28
    s_and_b32 s45, s29, 0xffff
    s_mov_b32 s46, 16777216
    s_mov_b32 s47, 0x00020000
    s_mov_b32 s100, 0
Lw_25:
    ds_read_b32 v4, v3 offset:280
    s_waitcnt lgkmcnt(0)
    v_readfirstlane_b32 s99, v4
    s_cmp_ge_u32 s99, 8
    s_cbranch_scc1 Lwd_26
    s_sleep 2
    s_add_u32 s100, s100, 1
    s_cmp_lt_u32 s100, 1048576
    s_cbranch_scc1 Lw_25
Lwd_26:
    buffer_load_dword v18, v15, s[44:47], s53 offen sc1
    s_add_u32 s53, s53, 8192
    buffer_load_dword v18, v15, s[44:47], s53 offen sc1
    s_add_u32 s53, s53, 8192
    s_mov_b64 exec, 0x3
    buffer_load_dword v18, v15, s[44:47], s53 offen sc1
    s_add_u32 s53, s53, 8192
    s_mov_b64 exec, -1
    s_lshl_b32 s98, s30, 5
    s_add_u32 s98, s98, s31
    s_lshl_b32 s98, s98, 8
    s_add_u32 s98, s98, 65536
    s_add_u32 s98, s98, 128
    s_mov_b32 s100, 0
Lc_27:
    s_load_dwordx4 s[88:91], s[28:29], s98 glc
    s_waitcnt lgkmcnt(0)
    s_xor_b32 s96, s88, s33
    s_xor_b32 s97, s90, s33
    s_or_b32 s96, s96, s97
    s_cmp_eq_u32 s96, 0
    s_cbranch_scc1 Lcd_28
    s_sleep 2
    s_add_u32 s100, s100, 1
    s_cmp_lt_u32 s100, 1048576
    s_cbranch_scc1 Lc_27
    s_mov_b32 s91, 2
Lcd_28:
    s_cmp_eq_u32 s91, 1
    s_cselect_b32 s99, 0, 15728640
    s_add_u32 s16, s28, s99
    s_addc_u32 s17, s29, 0
    v_mov_b32 v4, s91
    ds_write_b32 v3, v4 offset:192
    buffer_load_dword v18, v15, s[44:47], s55 offen sc1
    s_add_u32 s55, s55, 8192
    buffer_load_dword v18, v15, s[44:47], s55 offen sc1
    s_add_u32 s55, s55, 8192
    buffer_load_dword v18, v15, s[44:47], s55 offen sc1
    s_add_u32 s55, s55, 8192
    buffer_load_dword v18, v15, s[44:47], s55 offen sc1
    s_add_u32 s55, s55, 8192
    buffer_load_dword v18, v15, s[44:47], s55 offen sc1
    s_add_u32 s55, s55, 8192
    buffer_load_dword v18, v15, s[44:47], s55 offen sc1
    s_add_u32 s55, s55, 8192
    s_mov_b64 exec, 0xffff
    buffer_load_dword v18, v15, s[44:47], s55 offen sc1
    s_add_u32 s55, s55, 8192
    s_mov_b64 exec, -1
    buffer_load_dword v18, v15, s[44:47], s54 offen sc1
    s_add_u32 s54, s54, 8192
    buffer_load_dword v18, v15, s[44:47], s54 offen sc1
    s_add_u32 s54, s54, 8192
    buffer_load_dword v18, v15, s[44:47], s54 offen sc1
    s_add_u32 s54, s54, 8192
    s_mov_b64 exec, 0x3fffff
    buffer_load_dword v18, v15, s[44:47], s54 offen sc1
    s_add_u32 s54, s54, 8192
    s_mov_b64 exec, -1
    s_lshl_b32 s96, s2, 7
    s_add_u32 s96, s96, 0x1F8000
    v_lshl_add_u32 v4, v0, 21, s96
    s_add_u32 s96, s96, 10518528
    v_writelane_b32 v4, s96, 6
    v_mov_b32 v5, 0
    s_mov_b64 exec, 0xde
    global_atomic_or v4, v5, s[28:29] sc1
    s_mul_i32 s96, s35, 81920
    s_mul_i32 s97, s36, 160
    s_add_u32 s96, s96, s97
    s_mov_b64 exec, 1
    v_mov_b32 v4, s96
    global_atomic_or v4, v5, s[24:25] sc1
    s_mov_b64 exec, -1
    s_waitcnt vmcnt(0)
    v_mov_b32 v4, 1
    ds_write_b32 v3, v4 offset:248
    v_mov_b32 v4, 1
    s_mov_b64 exec, 1
    ds_add_u32 v3, v4 offset:200
    s_mov_b64 exec, -1
    s_branch L_skip1681
L_pada6:
    s_branch L_pada14
L_padb7:
    s_branch L_padb15
L_skip1681:
    v_mov_b32 v4, 1
    s_mov_b64 exec, 1
    ds_add_u32 v3, v4 offset:204
    s_mov_b64 exec, -1
    s_mov_b32 s100, 0
Lw_29:
    ds_read_b32 v4, v3 offset:304
    s_waitcnt lgkmcnt(0)
    v_readfirstlane_b32 s99, v4
    s_cmp_ge_u32 s99, 1
    s_cbranch_scc1 Lwd_30
    s_sleep 8
    s_add_u32 s100, s100, 1
    s_cmp_lt_u32 s100, 1048576
    s_cbranch_scc1 Lw_29
Lwd_30:
    s_branch L_help
L_aux:
    s_mov_b32 s100, 0
L_yp:
    s_load_dwordx2 s[42:43], s[40:41], 0 glc
    s_waitcnt lgkmcnt(0)
    s_and_b32 s43, s43, 0xffffff00
    s_cmp_eq_u32 s43, s44
    s_cbranch_scc1 L_ypd
    s_sleep 1
    s_add_u32 s100, s100, 1
    s_cmp_lt_u32 s100, 1048576
    s_cbranch_scc1 L_yp
L_ypd:
    s_mov_b32 s100, 0
L_yretry:
    global_load_dwordx4 v[128:131], v120, s[28:29] sc1
    global_load_dwordx4 v[132:135], v121, s[28:29] sc1
    global_load_dwordx4 v[136:139], v122, s[28:29] sc1
    global_load_dwordx4 v[140:143], v123, s[28:29] sc1
    global_load_dwordx4 v[144:147], v124, s[28:29] sc1
    v_mov_b32 v16, 0
    s_waitcnt vmcnt(4)
    ds_write_b128 v125, v[128:131] offset:0
    v_add3_u32 v16, v16, v128, v129
    v_add3_u32 v16, v16, v130, v131
    s_waitcnt vmcnt(3)
    ds_write_b128 v125, v[132:135] offset:1024
    v_add3_u32 v16, v16, v132, v133
    v_add3_u32 v16, v16, v134, v135
    s_waitcnt vmcnt(2)
    ds_write_b128 v125, v[136:139] offset:2048
    v_add3_u32 v16, v16, v136, v137
    v_add3_u32 v16, v16, v138, v139
    s_waitcnt vmcnt(1)
    ds_write_b128 v125, v[140:143] offset:3072
    v_add3_u32 v16, v16, v140, v141
    v_add3_u32 v16, v16, v142, v143
    s_waitcnt vmcnt(0)
    ds_write_b128 v125, v[144:147] offset:4096
    v_add3_u32 v16, v16, v144, v145
    v_add3_u32 v16, v16, v146, v147
    s_nop 1
    v_add_u32_dpp v16, v16, v16 row_ror:8 row_mask:0xf bank_mask:0xf
    s_nop 1
    v_add_u32_dpp v16, v16, v16 row_ror:4 row_mask:0xf bank_mask:0xf
    s_nop 1
    v_add_u32_dpp v16, v16, v16 row_ror:2 row_mask:0xf bank_mask:0xf
    s_nop 1
    v_add_u32_dpp v16, v16, v16 row_ror:1 row_mask:0xf bank_mask:0xf
    s_nop 0
    v_readlane_b32 s96, v16, 0
    v_readlane_b32 s97, v16, 16
    v_readlane_b32 s98, v16, 32
    v_readlane_b32 s99, v16, 48
    s_add_u32 s96, s96, s97
    s_add_u32 s98, s98, s99
    s_add_u32 s96, s96, s98
    s_cmp_eq_u32 s96, s42
    s_cbranch_scc1 L_yok
    s_sleep 2
    s_add_u32 s100, s100, 1
    s_cmp_lt_u32 s100, 1048576
    s_cbranch_scc1 L_yretry
L_yok:
    v_mov_b32 v4, 1
    s_mov_b64 exec, 1
    ds_add_u32 v3, v4 offset:212
    s_mov_b64 exec, -1
    s_endpgm
L_compute:
    s_waitcnt lgkmcnt(0)
    s_load_dword s33, s[28:29], 0
    s_setprio 2
    s_sub_u32 s40, s32, 4
    s_lshr_b32 s42, s40, 2
    s_and_b32 s56, s40, 3
    s_xor_b32 s41, s56, s42
    s_sub_u32 s46, s38, 5
    s_cselect_b32 s46, s38, s46
    s_mov_b32 s96, 0xf9af5600
    s_mov_b32 s45, 0x886f5f4f
    s_cmp_eq_u32 s46, 1
    s_cselect_b32 s96, 0xfeab5500, s96
    s_cselect_b32 s45, 0x8c5f4f8f, s45
    s_cmp_eq_u32 s46, 2
    s_cselect_b32 s96, 0xffaa5500, s96
    s_cselect_b32 s45, 0x8e4f3f87, s45
    s_cmp_eq_u32 s46, 3
    s_cselect_b32 s96, 0xffaa1540, s96
    s_cselect_b32 s45, 0x8f3f2f83, s45
    s_cmp_eq_u32 s46, 4
    s_cselect_b32 s96, 0xff6a0590, s96
    s_cselect_b32 s45, 0x3f2f1f81, s45
    s_lshl_b32 s97, s41, 3
    s_lshr_b32 s96, s96, s97
    s_lshr_b32 s45, s45, s97
    s_and_b32 s45, s45, 0xff
    v_lshrrev_b32 v5, 1, v1
    v_xor_b32 v5, v5, v2
    v_lshlrev_b32 v5, 4, v5
    v_lshl_add_u32 v132, v1, 7, v5
    s_lshl_b32 s97, s42, 13
    v_add_u32 v132, s97, v132
    v_and_b32 v4, 3, v0
    v_lshlrev_b32 v5, 1, v4
    v_bfe_u32 v5, s96, v5, 2
    v_bfe_u32 v6, v0, 3, 2
    v_xor_b32 v5, v5, v6
    v_lshl_add_u32 v5, v5, 2, v4
    v_bfe_u32 v6, v0, 2, 2
    v_mad_u32_u24 v6, v2, 24, v6
    v_lshlrev_b32 v6, 7, v6
    v_lshl_add_u32 v133, v5, 3, v6
    v_add_u32 v133, 18432, v133
    v_mov_b32 v8, 0
    v_mov_b32 v9, 0
    v_mov_b32 v10, 0
    v_mov_b32 v11, 0
    v_mov_b32 v12, 0
    v_mov_b32 v13, 0
    v_mov_b32 v14, 0
    v_mov_b32 v15, 0
    v_mov_b32 v16, 0
    v_mov_b32 v17, 0
    v_mov_b32 v18, 0
    v_mov_b32 v19, 0
    v_mov_b32 v20, 0
    v_mov_b32 v21, 0
    v_mov_b32 v22, 0
    v_mov_b32 v23, 0
    v_mov_b32 v24, 0
    v_mov_b32 v25, 0
    v_mov_b32 v26, 0
    v_mov_b32 v27, 0
    v_mov_b32 v28, 0
    v_mov_b32 v29, 0
    v_mov_b32 v30, 0
    v_mov_b32 v31, 0
    v_mov_b32 v32, 0
    v_mov_b32 v33, 0
    v_mov_b32 v34, 0
    v_mov_b32 v35, 0
    v_mov_b32 v36, 0
    v_mov_b32 v37, 0
    v_mov_b32 v38, 0
    v_mov_b32 v39, 0
    v_mov_b32 v40, 0
    v_mov_b32 v41, 0
    v_mov_b32 v42, 0
    v_mov_b32 v43, 0
    v_mov_b32 v44, 0
    v_mov_b32 v45, 0
    v_mov_b32 v46, 0
    v_mov_b32 v47, 0
    v_mov_b32 v48, 0
    v_mov_b32 v49, 0
    v_mov_b32 v50, 0
    v_mov_b32 v51, 0
    v_mov_b32 v52, 0
    v_mov_b32 v53, 0
    v_mov_b32 v54, 0
    v_mov_b32 v55, 0
    v_mov_b32 v56, 0
    v_mov_b32 v57, 0
    v_mov_b32 v58, 0
    v_mov_b32 v59, 0
    v_mov_b32 v60, 0
    v_mov_b32 v61, 0
    v_mov_b32 v62, 0
    v_mov_b32 v63, 0
    v_mov_b32 v64, 0
    v_mov_b32 v65, 0
    v_mov_b32 v66, 0
    v_mov_b32 v67, 0
    s_mov_b32 s43, 0
    s_mov_b32 s44, 86016
    v_add_u32 v134, 86016, v132
    v_xor_b32 v135, 64, v134
    v_add_u32 v136, 86016, v133
    v_mov_b32 v7, 0xf149f2ca
    v_lshlrev_b32 v4, 2, v2
    v_sub_u32 v4, v1, v4
    v_subrev_u32 v5, 0, v4
    v_and_b32 v5, 0x80000001, v5
    v_cmp_eq_u32 vcc, 0, v5
    s_nop 1
    v_cndmask_b32 v144, v7, 0, vcc
    v_cmp_eq_u32 vcc, 0x80000000, v5
    s_nop 1
    v_cndmask_b32 v148, v7, 0, vcc
    v_subrev_u32 v5, 1, v4
    v_and_b32 v5, 0x80000001, v5
    v_cmp_eq_u32 vcc, 0, v5
    s_nop 1
    v_cndmask_b32 v145, v7, 0, vcc
    v_cmp_eq_u32 vcc, 0x80000000, v5
    s_nop 1
    v_cndmask_b32 v149, v7, 0, vcc
    v_subrev_u32 v5, 2, v4
    v_and_b32 v5, 0x80000001, v5
    v_cmp_eq_u32 vcc, 0, v5
    s_nop 1
    v_cndmask_b32 v146, v7, 0, vcc
    v_cmp_eq_u32 vcc, 0x80000000, v5
    s_nop 1
    v_cndmask_b32 v150, v7, 0, vcc
    v_subrev_u32 v5, 3, v4
    v_and_b32 v5, 0x80000001, v5
    v_cmp_eq_u32 vcc, 0, v5
    s_nop 1
    v_cndmask_b32 v147, v7, 0, vcc
    v_cmp_eq_u32 vcc, 0x80000000, v5
    s_nop 1
    v_cndmask_b32 v151, v7, 0, vcc
    v_and_b32 v5, 1, v1
    v_lshlrev_b32 v6, 4, v5
    v_mov_b32 v7, 0xffff
    v_lshlrev_b32 v7, v6, v7
    v_sub_u32 v5, v4, v5
    v_cmp_le_i32 vcc, 0, v5
    s_nop 1
    v_cndmask_b32 v152, 0, v7, vcc
    v_cndmask_b32 v154, v7, 0, vcc
    v_cmp_le_i32 vcc, 2, v5
    s_nop 1
    v_cndmask_b32 v153, 0, v7, vcc
    v_cndmask_b32 v155, v7, 0, vcc
    v_mov_b32 v7, 0x0c0c0c0c
    s_mov_b32 s96, 0x1000100
    v_bfi_b32 v152, v152, s96, v7
    s_mov_b32 s96, 0x3020302
    v_bfi_b32 v153, v153, s96, v7
    s_mov_b32 s96, 0x1000100
    v_bfi_b32 v154, v154, s96, v7
    s_mov_b32 s96, 0x3020302
    v_bfi_b32 v155, v155, s96, v7
    s_or_b32 s96, s37, s42
    s_cmp_eq_u32 s96, 0
    s_cselect_b32 s96, 0xf149f2ca, 0
    v_add_f32 v140, s96, v148
    v_add_f32 v141, s96, v149
    v_add_f32 v142, s96, v150
    v_add_f32 v143, s96, v151
    s_mov_b32 s54, 0x3ea52b5c
    v_bfe_i32 v157, s45, v2, 1
    v_cmp_ne_u32 s[50:51], 0, v157
    s_bfe_u32 s60, s45, 131076
    v_cmp_eq_u32 s[52:53], s60, v2
    s_bfe_u32 s61, s45, 65542
    s_lshr_b32 s62, s41, 1
    s_add_u32 s96, s41, 1
    s_bfe_u32 s96, s96, 65537
    s_xor_b32 s57, s96, 1
    s_bitcmp1_b32 s45, 7
    s_cselect_b32 s63, s62, s61
    s_mul_i32 s96, s63, 13824
    s_lshl_b32 s97, s42, 11
    s_add_u32 s96, s96, s97
    s_add_u32 s96, s96, 129024
    v_lshl_add_u32 v156, v0, 3, s96
    v_and_b32 v4, 0x33, v0
    s_lshl_b32 s97, s60, 5
    s_add_u32 s96, s96, s97
    v_lshl_add_u32 v162, v4, 3, s96
    s_lshl_b32 s96, s41, 10
    s_add_u32 s96, s96, 156672
    v_lshl_add_u32 v164, v0, 3, s96
    v_min_u32 v4, 16, v0
    v_lshl_add_u32 v163, v4, 2, v3
    v_add_u32 v163, 128, v163
    s_lshl1_add_u32 s96, s41, s42
    s_lshl_b32 s96, s96, 2
    v_add_u32 v165, s96, v3
    s_lshl_b32 s96, s41, 1
    s_lshl_b32 s96, s42, s96
    s_lshl1_add_u32 s97, s42, 1
    s_mul_i32 s98, s61, 6
    s_lshl_b32 s97, s97, s98
    s_or_b32 s98, s96, s97
    s_bitcmp1_b32 s45, 7
    s_cselect_b32 s48, s96, s98
    s_cselect_b32 s49, s96, s97
    s_lshl_b32 s49, s49, 8
    s_and_b32 s64, s37, 1
    s_lshl1_add_u32 s65, s64, s42
    s_mul_i32 s96, s65, 81920
    s_mul_i32 s97, s30, 327680
    s_add_u32 s96, s96, s97
    s_lshl_b32 s97, s38, 11
    s_add_u32 s96, s96, s97
    s_add_u32 s96, s96, 13107200
    s_mul_i32 s97, s57, 20480
    s_lshl3_add_u32 s97, s62, s97
    s_add_u32 s97, s97, s96
    v_lshl_add_u32 v160, v0, 4, s97
    s_lshl_b32 s97, s60, 8
    s_lshl3_add_u32 s97, s61, s97
    s_add_u32 s97, s97, 20480
    s_add_u32 s97, s97, s96
    v_lshrrev_b32 v4, 1, v2
    v_mul_u32_u24 v4, 38912, v4
    v_lshl_add_u32 v4, v2, 10, v4
    v_lshl_add_u32 v4, v1, 4, v4
    v_add_u32 v161, s97, v4
    s_mul_i32 s66, s30, 262144
    s_add_u32 s66, s66, 7340032
    s_lshl_b32 s96, s65, 8
    s_lshl_b32 s97, s57, 7
    s_add_u32 s96, s96, s97
    s_lshl1_add_u32 s97, s38, s62
    s_lshl2_add_u32 s96, s97, s96
    s_add_u32 s96, s96, s66
    s_add_u32 s55, s96, 196608
    s_cmp_ge_u32 s38, 5
    s_cselect_b32 s96, 3, -1
    s_add_u32 s96, s96, s46
    s_add_u32 s96, s96, s62
    s_and_b32 s96, s96, 7
    s_lshl3_add_u32 s96, s64, s96
    s_lshl1_add_u32 s96, s96, s62
    s_lshl1_add_u32 s96, s96, s42
    s_xor_b32 s97, s96, 2
    s_mul_i32 s96, s96, 3072
    s_mul_i32 s97, s97, 3072
    s_add_u32 s96, s96, s66
    s_add_u32 s97, s97, s66
    v_lshl_add_u32 v159, v0, 4, s96
    v_lshl_add_u32 v158, v0, 4, s97
    v_add_u32 v157, 40960, v160
    s_mul_i32 s96, s57, 51200
    s_add_u32 s80, s96, 10240
    s_mul_i32 s81, s56, 2560
    s_add_u32 s81, s81, 0
    s_mov_b32 s93, 112640
    s_and_b32 s98, s35, 3
    s_lshr_b32 s96, s56, 1
    s_lshl1_add_u32 s96, s98, s96
    s_lshl1_add_u32 s96, s96, s57
    s_mul_i32 s96, s96, 20480
    s_and_b32 s97, s56, 1
    s_lshl_b32 s97, s97, 10
    s_add_u32 s96, s96, s97
    s_mul_i32 s97, s30, 327680
    s_add_u32 s96, s96, s97
    s_add_u32 s82, s96, 13111296
    s_mul_i32 s96, s30, 262144
    s_lshl_b32 s98, s98, 8
    s_add_u32 s96, s96, s98
    s_add_u32 s83, s96, 7536640
    s_mul_i32 s84, s56, 5120
    s_add_u32 s84, s84, 129024
    s_lshl2_add_u32 s96, s35, s56
    s_mul_i32 s96, s96, 20480
    s_mul_i32 s97, s36, 160
    s_add_u32 s85, s96, s97
    v_lshl_add_u32 v138, v0, 4, s80
    v_lshl_add_u32 v139, v0, 4, s82
    v_lshl_add_u32 v166, v0, 2, s83
    s_waitcnt lgkmcnt(0)
    s_mul_i32 s33, s33, 1664525
    s_add_u32 s33, s33, 1013904223
    s_cmp_eq_u32 s32, 4
    s_cbranch_scc1 L_padb0
    s_cmp_eq_u32 s32, 5
    s_cbranch_scc1 L_padb1
    s_cmp_eq_u32 s32, 6
    s_cbranch_scc1 L_padb2
    s_cmp_eq_u32 s32, 7
    s_cbranch_scc1 L_padb3
    s_cmp_eq_u32 s32, 8
    s_cbranch_scc1 L_padb4
    s_cmp_eq_u32 s32, 9
    s_cbranch_scc1 L_padb5
    s_cmp_eq_u32 s32, 10
    s_cbranch_scc1 L_padb6
    s_branch L_padb7
L_padb8:
    s_branch L_padb16
L_warmed_b:
    s_cmp_lg_u32 s42, 0
    s_cbranch_scc1 L_gemm_40
L_gemm_50:
    s_barrier
    ds_read_b128 v[68:71], v134 offset:0
    ds_read_b64_tr_b16 v[112:113], v136 offset:1024
    ds_read_b64_tr_b16 v[114:115], v136 offset:1536
    ds_read_b64_tr_b16 v[116:117], v136 offset:2048
    ds_read_b64_tr_b16 v[118:119], v136 offset:2560
    ds_read_b128 v[72:75], v134 offset:2048
    ds_read_b64_tr_b16 v[108:109], v136 offset:0
    ds_read_b64_tr_b16 v[110:111], v136 offset:512
    ds_read_b128 v[76:79], v134 offset:4096
    ds_read_b128 v[80:83], v134 offset:6144
    ds_read_b128 v[84:87], v134 offset:8192
L_gemm_5:
    s_waitcnt lgkmcnt(0)
    v_mfma_f32_16x16x32_bf16 v[28:31], v[112:115], v[68:71], v[28:31]
    s_setprio 2
    ds_read_b128 v[88:91], v135 offset:0
    ds_read_b64_tr_b16 v[124:125], v136 offset:13312
    v_mfma_f32_16x16x32_bf16 v[48:51], v[68:71], v[116:119], v[48:51]
    ds_read_b64_tr_b16 v[126:127], v136 offset:13824
    ds_read_b64_tr_b16 v[128:129], v136 offset:14336
    v_mfma_f32_16x16x32_bf16 v[32:35], v[112:115], v[72:75], v[32:35]
    ds_read_b64_tr_b16 v[130:131], v136 offset:14848
    ds_read_b128 v[92:95], v135 offset:2048
    v_mfma_f32_16x16x32_bf16 v[52:55], v[72:75], v[116:119], v[52:55]
    ds_read_b64_tr_b16 v[120:121], v136 offset:12288
    ds_read_b64_tr_b16 v[122:123], v136 offset:12800
    v_mfma_f32_16x16x32_bf16 v[12:15], v[108:111], v[72:75], v[12:15]
    ds_read_b128 v[96:99], v135 offset:4096
    ds_read_b128 v[100:103], v135 offset:6144
    v_mfma_f32_16x16x32_bf16 v[36:39], v[112:115], v[76:79], v[36:39]
    ds_read_b128 v[104:107], v135 offset:8192
    v_mfma_f32_16x16x32_bf16 v[56:59], v[76:79], v[116:119], v[56:59]
    v_mfma_f32_16x16x32_bf16 v[16:19], v[108:111], v[76:79], v[16:19]
    v_mfma_f32_16x16x32_bf16 v[40:43], v[112:115], v[80:83], v[40:43]
    v_mfma_f32_16x16x32_bf16 v[60:63], v[80:83], v[116:119], v[60:63]
    v_mfma_f32_16x16x32_bf16 v[20:23], v[108:111], v[80:83], v[20:23]
    v_mfma_f32_16x16x32_bf16 v[44:47], v[112:115], v[84:87], v[44:47]
    v_mfma_f32_16x16x32_bf16 v[64:67], v[84:87], v[116:119], v[64:67]
    v_mfma_f32_16x16x32_bf16 v[24:27], v[108:111], v[84:87], v[24:27]
    s_waitcnt lgkmcnt(0)
    v_mfma_f32_16x16x32_bf16 v[28:31], v[124:127], v[88:91], v[28:31]
    s_add_u32 s44, s44, 43008
    s_cmp_eq_u32 s44, 129024
    s_cselect_b32 s44, 0, s44
    v_add_u32 v134, s44, v132
    v_add_u32 v136, s44, v133
    v_mfma_f32_16x16x32_bf16 v[48:51], v[88:91], v[128:131], v[48:51]
    s_barrier
    s_setprio 1
    ds_read_b128 v[68:71], v134 offset:0
    ds_read_b64_tr_b16 v[112:113], v136 offset:1024
    v_mfma_f32_16x16x32_bf16 v[32:35], v[124:127], v[92:95], v[32:35]
    ds_read_b64_tr_b16 v[114:115], v136 offset:1536
    ds_read_b64_tr_b16 v[116:117], v136 offset:2048
    v_mfma_f32_16x16x32_bf16 v[52:55], v[92:95], v[128:131], v[52:55]
    v_xor_b32 v135, 64, v134
    ds_read_b64_tr_b16 v[118:119], v136 offset:2560
    ds_read_b128 v[72:75], v134 offset:2048
    v_mfma_f32_16x16x32_bf16 v[12:15], v[120:123], v[92:95], v[12:15]
    ds_read_b64_tr_b16 v[108:109], v136 offset:0
    ds_read_b64_tr_b16 v[110:111], v136 offset:512
    v_mfma_f32_16x16x32_bf16 v[36:39], v[124:127], v[96:99], v[36:39]
    ds_read_b128 v[76:79], v134 offset:4096
    ds_read_b128 v[80:83], v134 offset:6144
    v_mfma_f32_16x16x32_bf16 v[56:59], v[96:99], v[128:131], v[56:59]
    ds_read_b128 v[84:87], v134 offset:8192
    v_mfma_f32_16x16x32_bf16 v[16:19], v[120:123], v[96:99], v[16:19]
    v_mfma_f32_16x16x32_bf16 v[40:43], v[124:127], v[100:103], v[40:43]
    v_mfma_f32_16x16x32_bf16 v[60:63], v[100:103], v[128:131], v[60:63]
    v_mfma_f32_16x16x32_bf16 v[20:23], v[120:123], v[100:103], v[20:23]
    v_mfma_f32_16x16x32_bf16 v[44:47], v[124:127], v[104:107], v[44:47]
    s_add_u32 s43, s43, 1
    v_mfma_f32_16x16x32_bf16 v[64:67], v[104:107], v[128:131], v[64:67]
    s_cmp_lt_u32 s43, 9
    v_mfma_f32_16x16x32_bf16 v[24:27], v[120:123], v[104:107], v[24:27]
    s_cbranch_scc1 L_gemm_5
    s_waitcnt lgkmcnt(0)
    v_mfma_f32_16x16x32_bf16 v[28:31], v[112:115], v[68:71], v[28:31]
    s_bitcmp1_b32 s45, 7
    s_setprio 3
    s_cbranch_scc1 Llp_31
    s_setprio 1
Llp_31:
    ds_read_b128 v[88:91], v135 offset:0
    ds_read_b64_tr_b16 v[124:125], v136 offset:13312
    v_mfma_f32_16x16x32_bf16 v[48:51], v[68:71], v[116:119], v[48:51]
    ds_read_b64_tr_b16 v[126:127], v136 offset:13824
    ds_read_b64_tr_b16 v[128:129], v136 offset:14336
    v_mfma_f32_16x16x32_bf16 v[32:35], v[112:115], v[72:75], v[32:35]
    ds_read_b64_tr_b16 v[130:131], v136 offset:14848
    ds_read_b128 v[92:95], v135 offset:2048
    v_mfma_f32_16x16x32_bf16 v[52:55], v[72:75], v[116:119], v[52:55]
    ds_read_b64_tr_b16 v[120:121], v136 offset:12288
    ds_read_b64_tr_b16 v[122:123], v136 offset:12800
    v_mfma_f32_16x16x32_bf16 v[12:15], v[108:111], v[72:75], v[12:15]
    ds_read_b128 v[96:99], v135 offset:4096
    ds_read_b128 v[100:103], v135 offset:6144
    v_mfma_f32_16x16x32_bf16 v[36:39], v[112:115], v[76:79], v[36:39]
    ds_read_b128 v[104:107], v135 offset:8192
    ds_read_b64 v[6:7], v3 offset:384
    v_mfma_f32_16x16x32_bf16 v[56:59], v[76:79], v[116:119], v[56:59]
    v_mfma_f32_16x16x32_bf16 v[16:19], v[108:111], v[76:79], v[16:19]
    v_mfma_f32_16x16x32_bf16 v[40:43], v[112:115], v[80:83], v[40:43]
    v_mfma_f32_16x16x32_bf16 v[60:63], v[80:83], v[116:119], v[60:63]
    v_mfma_f32_16x16x32_bf16 v[20:23], v[108:111], v[80:83], v[20:23]
    v_mfma_f32_16x16x32_bf16 v[44:47], v[112:115], v[84:87], v[44:47]
    v_mfma_f32_16x16x32_bf16 v[64:67], v[84:87], v[116:119], v[64:67]
    v_mfma_f32_16x16x32_bf16 v[24:27], v[108:111], v[84:87], v[24:27]
    s_waitcnt lgkmcnt(0)
    v_mfma_f32_16x16x32_bf16 v[44:47], v[124:127], v[104:107], v[44:47]
    v_readfirstlane_b32 s90, v6
    v_readfirstlane_b32 s91, v7
    v_mfma_f32_16x16x32_bf16 v[24:27], v[120:123], v[104:107], v[24:27]
    v_mov_b64 v[70:71], 0
    v_mov_b64 v[74:75], 0
    v_mfma_f32_16x16x32_bf16 v[40:43], v[124:127], v[100:103], v[40:43]
    v_mov_b64 v[78:79], 0
    v_mov_b64 v[82:83], 0
    v_mfma_f32_16x16x32_bf16 v[20:23], v[120:123], v[100:103], v[20:23]
    v_mov_b32 v111, s33
    v_mov_b32 v115, s33
    v_mfma_f32_16x16x32_bf16 v[36:39], v[124:127], v[96:99], v[36:39]
    v_mov_b32 v119, s33
    v_mfma_f32_16x16x32_bf16 v[16:19], v[120:123], v[96:99], v[16:19]
    v_mfma_f32_16x16x32_bf16 v[32:35], v[124:127], v[92:95], v[32:35]
    v_mfma_f32_16x16x32_bf16 v[12:15], v[120:123], v[92:95], v[12:15]
    v_mfma_f32_16x16x32_bf16 v[28:31], v[124:127], v[88:91], v[28:31]
    s_branch L_gdone
L_padb9:
    s_branch L_padb17
L_gemm_40:
    s_barrier
    ds_read_b128 v[72:75], v134 offset:2048
    ds_read_b64_tr_b16 v[112:113], v136 offset:1024
    ds_read_b64_tr_b16 v[114:115], v136 offset:1536
    ds_read_b64_tr_b16 v[116:117], v136 offset:2048
    ds_read_b64_tr_b16 v[118:119], v136 offset:2560
    ds_read_b128 v[76:79], v134 offset:4096
    ds_read_b64_tr_b16 v[108:109], v136 offset:0
    ds_read_b64_tr_b16 v[110:111], v136 offset:512
    ds_read_b128 v[80:83], v134 offset:6144
    ds_read_b128 v[84:87], v134 offset:8192
L_gemm_4:
    s_waitcnt lgkmcnt(0)
    v_mfma_f32_16x16x32_bf16 v[32:35], v[112:115], v[72:75], v[32:35]
    s_setprio 1
    ds_read_b128 v[92:95], v135 offset:2048
    ds_read_b64_tr_b16 v[124:125], v136 offset:13312
    v_mfma_f32_16x16x32_bf16 v[52:55], v[72:75], v[116:119], v[52:55]
    ds_read_b64_tr_b16 v[126:127], v136 offset:13824
    ds_read_b64_tr_b16 v[128:129], v136 offset:14336
    v_mfma_f32_16x16x32_bf16 v[12:15], v[108:111], v[72:75], v[12:15]
    ds_read_b64_tr_b16 v[130:131], v136 offset:14848
    ds_read_b128 v[96:99], v135 offset:4096
    v_mfma_f32_16x16x32_bf16 v[36:39], v[112:115], v[76:79], v[36:39]
    ds_read_b64_tr_b16 v[120:121], v136 offset:12288
    ds_read_b64_tr_b16 v[122:123], v136 offset:12800
    v_mfma_f32_16x16x32_bf16 v[56:59], v[76:79], v[116:119], v[56:59]
    ds_read_b128 v[100:103], v135 offset:6144
    ds_read_b128 v[104:107], v135 offset:8192
    v_mfma_f32_16x16x32_bf16 v[16:19], v[108:111], v[76:79], v[16:19]
    v_mfma_f32_16x16x32_bf16 v[40:43], v[112:115], v[80:83], v[40:43]
    v_mfma_f32_16x16x32_bf16 v[60:63], v[80:83], v[116:119], v[60:63]
    v_mfma_f32_16x16x32_bf16 v[20:23], v[108:111], v[80:83], v[20:23]
    v_mfma_f32_16x16x32_bf16 v[44:47], v[112:115], v[84:87], v[44:47]
    v_mfma_f32_16x16x32_bf16 v[64:67], v[84:87], v[116:119], v[64:67]
    v_mfma_f32_16x16x32_bf16 v[24:27], v[108:111], v[84:87], v[24:27]
    s_waitcnt lgkmcnt(0)
    v_mfma_f32_16x16x32_bf16 v[32:35], v[124:127], v[92:95], v[32:35]
    s_add_u32 s44, s44, 43008
    s_cmp_eq_u32 s44, 129024
    s_cselect_b32 s44, 0, s44
    v_add_u32 v134, s44, v132
    v_add_u32 v136, s44, v133
    v_mfma_f32_16x16x32_bf16 v[52:55], v[92:95], v[128:131], v[52:55]
    s_barrier
    s_setprio 2
    ds_read_b128 v[72:75], v134 offset:2048
    ds_read_b64_tr_b16 v[112:113], v136 offset:1024
    v_mfma_f32_16x16x32_bf16 v[12:15], v[120:123], v[92:95], v[12:15]
    ds_read_b64_tr_b16 v[114:115], v136 offset:1536
    ds_read_b64_tr_b16 v[116:117], v136 offset:2048
    v_mfma_f32_16x16x32_bf16 v[36:39], v[124:127], v[96:99], v[36:39]
    v_xor_b32 v135, 64, v134
    ds_read_b64_tr_b16 v[118:119], v136 offset:2560
    ds_read_b128 v[76:79], v134 offset:4096
    v_mfma_f32_16x16x32_bf16 v[56:59], v[96:99], v[128:131], v[56:59]
    ds_read_b64_tr_b16 v[108:109], v136 offset:0
    ds_read_b64_tr_b16 v[110:111], v136 offset:512
    v_mfma_f32_16x16x32_bf16 v[16:19], v[120:123], v[96:99], v[16:19]
    ds_read_b128 v[80:83], v134 offset:6144
    ds_read_b128 v[84:87], v134 offset:8192
    v_mfma_f32_16x16x32_bf16 v[40:43], v[124:127], v[100:103], v[40:43]
    v_mfma_f32_16x16x32_bf16 v[60:63], v[100:103], v[128:131], v[60:63]
    v_mfma_f32_16x16x32_bf16 v[20:23], v[120:123], v[100:103], v[20:23]
    v_mfma_f32_16x16x32_bf16 v[44:47], v[124:127], v[104:107], v[44:47]
    s_add_u32 s43, s43, 1
    v_mfma_f32_16x16x32_bf16 v[64:67], v[104:107], v[128:131], v[64:67]
    s_cmp_lt_u32 s43, 9
    v_mfma_f32_16x16x32_bf16 v[24:27], v[120:123], v[104:107], v[24:27]
    s_cbranch_scc1 L_gemm_4
    s_waitcnt lgkmcnt(0)
    v_mfma_f32_16x16x32_bf16 v[32:35], v[112:115], v[72:75], v[32:35]
    s_bitcmp1_b32 s45, 7
    s_setprio 3
    s_cbranch_scc1 Llp_32
    s_setprio 1
Llp_32:
    ds_read_b128 v[92:95], v135 offset:2048
    ds_read_b64_tr_b16 v[124:125], v136 offset:13312
    v_mfma_f32_16x16x32_bf16 v[52:55], v[72:75], v[116:119], v[52:55]
    ds_read_b64_tr_b16 v[126:127], v136 offset:13824
    ds_read_b64_tr_b16 v[128:129], v136 offset:14336
    v_mfma_f32_16x16x32_bf16 v[12:15], v[108:111], v[72:75], v[12:15]
    ds_read_b64_tr_b16 v[130:131], v136 offset:14848
    ds_read_b128 v[96:99], v135 offset:4096
    v_mfma_f32_16x16x32_bf16 v[36:39], v[112:115], v[76:79], v[36:39]
    ds_read_b64_tr_b16 v[120:121], v136 offset:12288
    ds_read_b64_tr_b16 v[122:123], v136 offset:12800
    v_mfma_f32_16x16x32_bf16 v[56:59], v[76:79], v[116:119], v[56:59]
    ds_read_b128 v[100:103], v135 offset:6144
    ds_read_b128 v[104:107], v135 offset:8192
    v_mfma_f32_16x16x32_bf16 v[16:19], v[108:111], v[76:79], v[16:19]
    ds_read_b64 v[6:7], v3 offset:384
    v_mfma_f32_16x16x32_bf16 v[40:43], v[112:115], v[80:83], v[40:43]
    v_mfma_f32_16x16x32_bf16 v[60:63], v[80:83], v[116:119], v[60:63]
    v_mfma_f32_16x16x32_bf16 v[20:23], v[108:111], v[80:83], v[20:23]
    v_mfma_f32_16x16x32_bf16 v[44:47], v[112:115], v[84:87], v[44:47]
    v_mfma_f32_16x16x32_bf16 v[64:67], v[84:87], v[116:119], v[64:67]
    v_mfma_f32_16x16x32_bf16 v[24:27], v[108:111], v[84:87], v[24:27]
    s_waitcnt lgkmcnt(0)
    v_mfma_f32_16x16x32_bf16 v[44:47], v[124:127], v[104:107], v[44:47]
    v_readfirstlane_b32 s90, v6
    v_readfirstlane_b32 s91, v7
    v_mfma_f32_16x16x32_bf16 v[24:27], v[120:123], v[104:107], v[24:27]
    v_mov_b64 v[70:71], 0
    v_mov_b64 v[74:75], 0
    v_mfma_f32_16x16x32_bf16 v[40:43], v[124:127], v[100:103], v[40:43]
    v_mov_b64 v[78:79], 0
    v_mov_b64 v[82:83], 0
    v_mfma_f32_16x16x32_bf16 v[20:23], v[120:123], v[100:103], v[20:23]
    v_mov_b32 v111, s33
    v_mov_b32 v115, s33
    v_mfma_f32_16x16x32_bf16 v[36:39], v[124:127], v[96:99], v[36:39]
    v_mov_b32 v119, s33
    v_mfma_f32_16x16x32_bf16 v[16:19], v[120:123], v[96:99], v[16:19]
    v_mfma_f32_16x16x32_bf16 v[32:35], v[124:127], v[92:95], v[32:35]
    v_mfma_f32_16x16x32_bf16 v[12:15], v[120:123], v[92:95], v[12:15]
L_gdone:
    s_cmp_lg_u32 s90, s33
    s_cbranch_scc1 L_mslow
L_mback:
    s_cmp_eq_u32 s91, 1
    s_cselect_b32 s99, 0, 15728640
    s_add_u32 s16, s28, s99
    s_addc_u32 s17, s29, 0
    s_bitcmp0_b32 s45, 7
    s_cbranch_scc1 L_full
    v_mov_b32 v5, 1
    v_cvt_pk_bf16_f32 v84, v44, v45
    v_cvt_pk_bf16_f32 v85, v46, v47
    ds_write_b64 v156, v[84:85] offset:6656
    ds_write_b32 v165, v5 offset:344
    v_cvt_pk_bf16_f32 v80, v40, v41
    v_cvt_pk_bf16_f32 v81, v42, v43
    v_cvt_pk_bf16_f32 v76, v36, v37
    v_cvt_pk_bf16_f32 v77, v38, v39
    v_cvt_pk_bf16_f32 v72, v32, v33
    v_cvt_pk_bf16_f32 v73, v34, v35
    s_mov_b32 s100, 0
    s_cmp_eq_u32 s42, 0
    s_cbranch_scc1 L_l_k0
    ds_read_b32 v4, v165 offset:340
    ds_read_b64 v[68:69], v156 offset:4608
    s_branch L_l_k1
L_padb10:
    s_branch L_padb18
L_l_k0:
    v_cvt_pk_bf16_f32 v68, v28, v29
    v_cvt_pk_bf16_f32 v69, v30, v31
    v_mov_b32 v4, 1
L_l_k1:
    s_mov_b64 exec, s[50:51]
    v_cvt_pk_bf16_f32 v82, v24, v25
    v_cvt_pk_bf16_f32 v83, v26, v27
    v_cvt_pk_bf16_f32 v78, v20, v21
    v_cvt_pk_bf16_f32 v79, v22, v23
    v_cvt_pk_bf16_f32 v74, v16, v17
    v_cvt_pk_bf16_f32 v75, v18, v19
    v_cvt_pk_bf16_f32 v70, v12, v13
    v_cvt_pk_bf16_f32 v71, v14, v15
    s_mov_b64 exec, -1
    v_mfma_f32_16x16x16_bf16 v[40:43], v[84:85], v[82:83], v[144:147]
    v_mfma_f32_16x16x16_bf16 v[124:127], v[80:81], v[82:83], v[148:151]
    v_mfma_f32_16x16x16_bf16 v[36:39], v[80:81], v[78:79], v[144:147]
    v_mfma_f32_16x16x16_bf16 v[120:123], v[76:77], v[78:79], v[148:151]
    v_mfma_f32_16x16x16_bf16 v[32:35], v[76:77], v[74:75], v[144:147]
    v_mfma_f32_16x16x16_bf16 v[8:11], v[72:73], v[74:75], v[148:151]
    v_mfma_f32_16x16x16_bf16 v[28:31], v[72:73], v[70:71], v[144:147]
L_l_kw:
    s_waitcnt lgkmcnt(0)
    v_readfirstlane_b32 s96, v4
    s_cmp_eq_u32 s96, 0
    s_cbranch_scc1 L_l_kslow
L_l_kok:
    v_mfma_f32_16x16x16_bf16 v[44:47], v[68:69], v[70:71], v[140:143]
    v_max3_f32 v110, v40, v41, v124
    v_max3_f32 v114, v42, v43, v126
    v_max_f32 v110, v110, v125
    v_max_f32 v114, v114, v127
    v_max3_f32 v116, v36, v37, v120
    v_max3_f32 v117, v38, v39, v122
    v_max_f32 v116, v116, v121
    v_max_f32 v117, v117, v123
    v_max3_f32 v112, v32, v33, v8
    v_max3_f32 v113, v34, v35, v10
    v_max_f32 v112, v112, v9
    v_max_f32 v113, v113, v11
    v_max3_f32 v108, v28, v29, v44
    v_max3_f32 v109, v30, v31, v46
    v_max_f32 v108, v108, v45
    v_max_f32 v109, v109, v47
    s_cmp_lg_u32 s91, 1
    s_cbranch_scc1 Ldg_33
    global_store_dwordx4 v158, v[116:119], s[16:17] offset:2048
    global_store_dwordx4 v158, v[112:115], s[16:17] offset:1024
    global_store_dwordx4 v158, v[108:111], s[16:17] offset:0
    s_branch Ldd_34
Ldg_33:
    global_store_dwordx4 v158, v[116:119], s[16:17] offset:2048 sc1
    global_store_dwordx4 v158, v[112:115], s[16:17] offset:1024 sc1
    global_store_dwordx4 v158, v[108:111], s[16:17] offset:0 sc1
Ldd_34:
    v_mfma_f32_16x16x32_bf16 v[64:67], v[104:107], v[128:131], v[64:67]
    v_mfma_f32_16x16x32_bf16 v[60:63], v[100:103], v[128:131], v[60:63]
    v_mfma_f32_16x16x32_bf16 v[56:59], v[96:99], v[128:131], v[56:59]
    v_mfma_f32_16x16x32_bf16 v[52:55], v[92:95], v[128:131], v[52:55]
    s_cmp_lg_u32 s42, 0
    s_cbranch_scc1 L_nv_l
    v_mfma_f32_16x16x32_bf16 v[48:51], v[88:91], v[128:131], v[48:51]
L_nv_l:
    ds_write_b64 v156, v[80:81] offset:6144
    ds_write_b64 v156, v[76:77] offset:5632
    ds_write_b64 v156, v[72:73] offset:5120
    ds_write_b64 v156, v[68:69] offset:4608
    v_cvt_pk_bf16_f32 v70, v12, v13
    v_cvt_pk_bf16_f32 v71, v14, v15
    ds_write_b64 v156, v[70:71] offset:512
    v_cvt_pk_bf16_f32 v74, v16, v17
    v_cvt_pk_bf16_f32 v75, v18, v19
    ds_write_b64 v156, v[74:75] offset:1024
    v_cvt_pk_bf16_f32 v78, v20, v21
    v_cvt_pk_bf16_f32 v79, v22, v23
    ds_write_b64 v156, v[78:79] offset:1536
    v_cvt_pk_bf16_f32 v82, v24, v25
    v_cvt_pk_bf16_f32 v83, v26, v27
    ds_write_b64 v156, v[82:83] offset:2048
    ds_write_b32 v165, v5 offset:128
    v_cvt_pk_bf16_f32 v88, v64, v65
    v_cvt_pk_bf16_f32 v89, v66, v67
    s_waitcnt lgkmcnt(6)
    ds_write_b64 v156, v[88:89] offset:11264
    v_cvt_pk_bf16_f32 v90, v60, v61
    v_cvt_pk_bf16_f32 v91, v62, v63
    ds_write_b64 v156, v[90:91] offset:10752
    v_cvt_pk_bf16_f32 v92, v56, v57
    v_cvt_pk_bf16_f32 v93, v58, v59
    ds_write_b64 v156, v[92:93] offset:10240
    v_cvt_pk_bf16_f32 v94, v52, v53
    v_cvt_pk_bf16_f32 v95, v54, v55
    ds_write_b64 v156, v[94:95] offset:9728
    s_cmp_lg_u32 s42, 0
    s_cbranch_scc1 L_l_nv0
    v_cvt_pk_bf16_f32 v96, v48, v49
    v_cvt_pk_bf16_f32 v97, v50, v51
    ds_write_b64 v156, v[96:97] offset:9216
    ds_write_b32 v165, v5 offset:160
    s_branch L_l_v0
L_l_nv0:
    ds_write_b32 v165, v5 offset:160
    s_mov_b32 s100, 0
Lm_35:
    ds_read_b32 v4, v163
    s_waitcnt lgkmcnt(0)
    v_cmp_eq_u32 vcc, 0, v4
    s_and_b32 s99, vcc_lo, s49
    s_cbranch_scc0 Lmd_36
    s_add_u32 s100, s100, 1
    s_cmp_lt_u32 s100, 1048576
    s_cbranch_scc1 Lm_35
Lmd_36:
    ds_read_b64 v[96:97], v156 offset:9216
L_l_v0:
    s_setprio 0
    s_mov_b32 s100, 0
L_xp:
    global_load_dwordx4 v[28:31], v159, s[16:17] offset:0 sc1
    global_load_dwordx4 v[32:35], v159, s[16:17] offset:1024 sc1
    global_load_dwordx4 v[36:39], v159, s[16:17] offset:2048 sc1
    s_waitcnt vmcnt(0)
    v_cmp_ne_u32 vcc, s33, v31
    v_cmp_ne_u32 s[60:61], s33, v35
    v_cmp_ne_u32 s[62:63], s33, v39
    s_or_b64 vcc, vcc, s[60:61]
    s_or_b64 vcc, vcc, s[62:63]
    s_cbranch_scc0 L_xpd
    s_add_u32 s100, s100, 1
    s_cmp_lt_u32 s100, 1048576
    s_cbranch_scc1 L_xp
L_xpd:
    s_setprio 3
    v_pk_add_f32 v[68:69], v[108:109], v[28:29]
    v_pk_add_f32 v[70:71], v[112:113], v[32:33]
    v_pk_add_f32 v[72:73], v[116:117], v[36:37]
    v_add_f32 v74, v110, v30
    v_add_f32 v75, v114, v34
    s_branch L_soft
L_l_kslow:
    ds_read_b32 v4, v165 offset:340
    ds_read_b64 v[68:69], v156 offset:4608
    s_add_u32 s100, s100, 1
    s_cmp_lt_u32 s100, 1048576
    s_cbranch_scc1 L_l_kw
    s_waitcnt lgkmcnt(0)
    s_branch L_l_kok
L_mslow:
    s_lshl_b32 s98, s30, 5
    s_add_u32 s98, s98, s31
    s_lshl_b32 s98, s98, 8
    s_add_u32 s98, s98, 65536
    s_add_u32 s98, s98, 128
    s_mov_b32 s100, 0
Lc_37:
    s_load_dwordx4 s[88:91], s[28:29], s98 glc
    s_waitcnt lgkmcnt(0)
    s_cmp_eq_u32 s90, s33
    s_cbranch_scc1 Lcd_38
    s_sleep 2
    s_add_u32 s100, s100, 1
    s_cmp_lt_u32 s100, 1048576
    s_cbranch_scc1 Lc_37
    s_mov_b32 s91, 2
Lcd_38:
    s_branch L_mback
L_padb11:
    s_branch L_warmed_b
L_full:
    v_mfma_f32_16x16x32_bf16 v[64:67], v[104:107], v[128:131], v[64:67]
    v_mfma_f32_16x16x32_bf16 v[60:63], v[100:103], v[128:131], v[60:63]
    v_mfma_f32_16x16x32_bf16 v[56:59], v[96:99], v[128:131], v[56:59]
    v_mfma_f32_16x16x32_bf16 v[52:55], v[92:95], v[128:131], v[52:55]
    s_cmp_lg_u32 s42, 0
    s_cbranch_scc1 L_nv_f
    v_mfma_f32_16x16x32_bf16 v[48:51], v[88:91], v[128:131], v[48:51]
L_nv_f:
    s_setprio 2
    v_cvt_pk_bf16_f32 v124, v44, v45
    v_cvt_pk_bf16_f32 v125, v46, v47
    v_cvt_pk_bf16_f32 v120, v40, v41
    v_cvt_pk_bf16_f32 v121, v42, v43
    v_cvt_pk_bf16_f32 v116, v36, v37
    v_cvt_pk_bf16_f32 v117, v38, v39
    v_cvt_pk_bf16_f32 v112, v32, v33
    v_cvt_pk_bf16_f32 v113, v34, v35
    v_cvt_pk_bf16_f32 v68, v12, v13
    v_cvt_pk_bf16_f32 v69, v14, v15
    v_cvt_pk_bf16_f32 v72, v16, v17
    v_cvt_pk_bf16_f32 v73, v18, v19
    v_cvt_pk_bf16_f32 v76, v20, v21
    v_cvt_pk_bf16_f32 v77, v22, v23
    v_cvt_pk_bf16_f32 v80, v24, v25
    v_cvt_pk_bf16_f32 v81, v26, v27
    v_cvt_pk_bf16_f32 v88, v64, v65
    v_cvt_pk_bf16_f32 v89, v66, v67
    s_cmp_lg_u32 s42, 0
    s_cbranch_scc1 L_f_nb
    ds_write_b64 v164, v[124:125]
    ds_write_b64 v164, v[88:89] offset:512
    v_mov_b32 v5, 1
    ds_write_b32 v165, v5 offset:128
    v_cvt_pk_bf16_f32 v108, v28, v29
    v_cvt_pk_bf16_f32 v109, v30, v31
    v_cvt_pk_bf16_f32 v96, v48, v49
    v_cvt_pk_bf16_f32 v97, v50, v51
L_f_nb:
    v_cvt_pk_bf16_f32 v94, v52, v53
    v_cvt_pk_bf16_f32 v95, v54, v55
    v_cvt_pk_bf16_f32 v92, v56, v57
    v_cvt_pk_bf16_f32 v93, v58, v59
    v_cvt_pk_bf16_f32 v90, v60, v61
    v_cvt_pk_bf16_f32 v91, v62, v63
    s_mov_b32 s100, 0
Lm_39:
    ds_read_b32 v4, v163
    s_waitcnt lgkmcnt(0)
    v_cmp_eq_u32 vcc, 0, v4
    s_and_b32 s99, vcc_lo, s48
    s_cbranch_scc0 Lmd_40
    s_add_u32 s100, s100, 1
    s_cmp_lt_u32 s100, 1048576
    s_cbranch_scc1 Lm_39
Lmd_40:
    s_cmp_eq_u32 s42, 0
    s_cbranch_scc1 L_f_nr
    ds_read_b64 v[108:109], v164
    ds_read_b64 v[96:97], v164 offset:512
L_f_nr:
    s_mov_b64 exec, s[52:53]
    ds_read_b64 v[70:71], v156 offset:512
    ds_read_b64 v[74:75], v156 offset:1024
    ds_read_b64 v[78:79], v156 offset:1536
    ds_read_b64 v[82:83], v156 offset:2048
    s_mov_b64 exec, -1
    ds_read_b64 v[110:111], v156 offset:4608
    ds_read_b64 v[114:115], v156 offset:5120
    ds_read_b64 v[118:119], v156 offset:5632
    ds_read_b64 v[122:123], v156 offset:6144
    ds_read_b64 v[126:127], v156 offset:6656
    s_waitcnt lgkmcnt(3)
    v_mfma_f32_16x16x32_bf16 v[8:11], v[112:115], v[68:71], v[144:147]
    v_mfma_f32_16x16x32_bf16 v[24:27], v[108:111], v[68:71], v[140:143]
    s_waitcnt lgkmcnt(2)
    v_mfma_f32_16x16x32_bf16 v[12:15], v[116:119], v[72:75], v[144:147]
    v_mfma_f32_16x16x32_bf16 v[28:31], v[112:115], v[72:75], v[148:151]
    s_waitcnt lgkmcnt(1)
    v_mfma_f32_16x16x32_bf16 v[16:19], v[120:123], v[76:79], v[144:147]
    v_mfma_f32_16x16x32_bf16 v[32:35], v[116:119], v[76:79], v[148:151]
    s_waitcnt lgkmcnt(0)
    v_mfma_f32_16x16x32_bf16 v[20:23], v[124:127], v[80:83], v[144:147]
    v_mfma_f32_16x16x32_bf16 v[36:39], v[120:123], v[80:83], v[148:151]
    s_mov_b32 s100, 0
Lm_41:
    ds_read_b32 v4, v163
    s_waitcnt lgkmcnt(0)
    v_cmp_eq_u32 vcc, 0, v4
    s_and_b32 s99, vcc_lo, s49
    s_cbranch_scc0 Lmd_42
    s_add_u32 s100, s100, 1
    s_cmp_lt_u32 s100, 1048576
    s_cbranch_scc1 Lm_41
Lmd_42:
    ds_read_b64 v[106:107], v162 offset:9216
    ds_read_b64 v[104:105], v162 offset:9728
    ds_read_b64 v[102:103], v162 offset:10240
    ds_read_b64 v[100:101], v162 offset:10752
    ds_read_b64 v[98:99], v162 offset:11264
    v_max3_f32 v68, v8, v9, v24
    v_max3_f32 v69, v10, v11, v26
    v_max_f32 v68, v68, v25
    v_max_f32 v69, v69, v27
    v_max3_f32 v70, v12, v13, v28
    v_max3_f32 v71, v14, v15, v30
    v_max_f32 v70, v70, v29
    v_max_f32 v71, v71, v31
    v_max3_f32 v72, v16, v17, v32
    v_max3_f32 v73, v18, v19, v34
    v_max_f32 v72, v72, v33
    v_max_f32 v73, v73, v35
    v_max3_f32 v74, v20, v21, v36
    v_max3_f32 v75, v22, v23, v38
    v_max_f32 v74, v74, v37
    v_max_f32 v75, v75, v39
L_soft:
    v_max_f32 v76, v68, v69
    v_max_f32 v77, v70, v71
    v_max_f32 v78, v72, v73
    v_max_f32 v79, v74, v75
    v_mov_b32 v84, 0x3f803f80
    v_permlane32_swap_b32 v76, v77
    v_permlane32_swap_b32 v78, v79
    v_max_f32 v76, v76, v77
    v_max_f32 v78, v78, v79
    v_mov_b32 v85, 0x3f803f80
    v_mov_b32 v86, 0x3f803f80
    v_permlane16_swap_b32 v76, v78
    v_max_f32 v76, v76, v78
    v_mul_f32 v78, s54, v76
    v_mul_f32 v76, s54, v76
    v_mov_b32 v87, 0x3f803f80
    v_mov_b32 v4, 1
    v_permlane16_swap_b32 v76, v78
    v_mov_b32 v77, v76
    v_mov_b32 v79, v78
    s_waitcnt lgkmcnt(0)
    v_permlane32_swap_b32 v76, v77
    v_permlane32_swap_b32 v78, v79
    v_fma_f32 v68, v68, s54, -v76
    v_fma_f32 v69, v69, s54, -v76
    v_fma_f32 v70, v70, s54, -v77
    v_fma_f32 v71, v71, s54, -v77
    v_fma_f32 v72, v72, s54, -v78
    v_fma_f32 v73, v73, s54, -v78
    v_fma_f32 v74, v74, s54, -v79
    v_fma_f32 v75, v75, s54, -v79
    v_exp_f32 v68, v68
    v_exp_f32 v69, v69
    v_exp_f32 v70, v70
    v_exp_f32 v71, v71
    v_exp_f32 v72, v72
    v_exp_f32 v73, v73
    v_exp_f32 v74, v74
    v_exp_f32 v75, v75
    s_mov_b64 exec, 1
    ds_add_u32 v3, v4 offset:196
    s_mov_b64 exec, -1
    v_cvt_pk_bf16_f32 v80, v68, v69
    v_perm_b32 v108, v80, v80, v152
    s_branch L_skip2680
L_padb12:
    s_branch L_warmed_b
L_skip2680:
    v_perm_b32 v109, v80, v80, v153
    v_perm_b32 v110, v80, v80, v154
    v_perm_b32 v111, v80, v80, v155
    v_cvt_pk_bf16_f32 v81, v70, v71
    v_perm_b32 v112, v81, v81, v152
    v_perm_b32 v113, v81, v81, v153
    v_perm_b32 v114, v81, v81, v154
    v_perm_b32 v115, v81, v81, v155
    v_mfma_f32_16x16x32_bf16 v[24:27], v[84:87], v[108:111], 0
    v_mfma_f32_16x16x32_bf16 v[8:11], v[94:97], v[108:111], 0
    v_cvt_pk_bf16_f32 v82, v72, v73
    v_perm_b32 v116, v82, v82, v152
    v_perm_b32 v117, v82, v82, v153
    v_perm_b32 v118, v82, v82, v154
    v_perm_b32 v119, v82, v82, v155
    v_mfma_f32_16x16x32_bf16 v[28:31], v[84:87], v[112:115], 0
    v_mfma_f32_16x16x32_bf16 v[12:15], v[92:95], v[112:115], 0
    v_cvt_pk_bf16_f32 v83, v74, v75
    v_perm_b32 v120, v83, v83, v152
    v_perm_b32 v121, v83, v83, v153
    v_perm_b32 v122, v83, v83, v154
    v_perm_b32 v123, v83, v83, v155
    v_mfma_f32_16x16x32_bf16 v[32:35], v[84:87], v[116:119], 0
    v_mfma_f32_16x16x32_bf16 v[16:19], v[90:93], v[116:119], 0
    s_bitcmp1_b32 s45, 7
    v_mfma_f32_16x16x32_bf16 v[36:39], v[84:87], v[120:123], 0
    v_mfma_f32_16x16x32_bf16 v[20:23], v[88:91], v[120:123], 0
    s_cbranch_scc1 L_norem
    v_mfma_f32_16x16x32_bf16 v[40:43], v[104:107], v[108:111], 0
    v_mfma_f32_16x16x32_bf16 v[44:47], v[102:105], v[112:115], 0
    v_mfma_f32_16x16x32_bf16 v[48:51], v[100:103], v[116:119], 0
    v_mfma_f32_16x16x32_bf16 v[52:55], v[98:101], v[120:123], 0
L_norem:
    v_rcp_f32 v24, v24
    v_rcp_f32 v28, v28
    s_nop 0
    v_rcp_f32 v32, v32
    s_nop 1
    v_rcp_f32 v36, v36
    v_pk_mul_f32 v[8:9], v[8:9], v[24:25] op_sel_hi:[1,0]
    v_pk_mul_f32 v[10:11], v[10:11], v[24:25] op_sel_hi:[1,0]
    v_pk_mul_f32 v[12:13], v[12:13], v[28:29] op_sel_hi:[1,0]
    v_pk_mul_f32 v[14:15], v[14:15], v[28:29] op_sel_hi:[1,0]
    v_pk_mul_f32 v[16:17], v[16:17], v[32:33] op_sel_hi:[1,0]
    v_pk_mul_f32 v[18:19], v[18:19], v[32:33] op_sel_hi:[1,0]
    v_pk_mul_f32 v[20:21], v[20:21], v[36:37] op_sel_hi:[1,0]
    v_pk_mul_f32 v[22:23], v[22:23], v[36:37] op_sel_hi:[1,0]
    v_cvt_pk_bf16_f32 v56, v8, v9
    v_cvt_pk_bf16_f32 v57, v10, v11
    v_cvt_pk_bf16_f32 v58, v12, v13
    v_cvt_pk_bf16_f32 v59, v14, v15
    v_cvt_pk_bf16_f32 v60, v16, v17
    v_cvt_pk_bf16_f32 v61, v18, v19
    v_cvt_pk_bf16_f32 v62, v20, v21
    v_cvt_pk_bf16_f32 v63, v22, v23
    s_mov_b64 exec, s[50:51]
    s_cmp_lg_u32 s91, 1
    s_cbranch_scc1 Ldg_43
    global_store_dwordx2 v160, v[56:57], s[16:17] offset:0
    global_store_dwordx2 v160, v[58:59], s[16:17] offset:1024
    global_store_dwordx2 v157, v[60:61], s[16:17] offset:0
    global_store_dwordx2 v157, v[62:63], s[16:17] offset:1024
    s_branch Ldd_44
Ldg_43:
    global_store_dwordx2 v160, v[56:57], s[16:17] offset:0 sc1
    global_store_dwordx2 v160, v[58:59], s[16:17] offset:1024 sc1
    global_store_dwordx2 v157, v[60:61], s[16:17] offset:0 sc1
    global_store_dwordx2 v157, v[62:63], s[16:17] offset:1024 sc1
Ldd_44:
    s_mov_b64 exec, -1
    s_bitcmp1_b32 s45, 7
    s_cbranch_scc1 L_norem2
    v_pk_mul_f32 v[64:65], v[40:41], v[24:25] op_sel_hi:[1,0]
    v_pk_mul_f32 v[66:67], v[42:43], v[24:25] op_sel_hi:[1,0]
    s_mov_b32 exec_lo, 0xffff0000
    v_pk_mul_f32 v[64:65], v[44:45], v[28:29] op_sel_hi:[1,0]
    v_pk_mul_f32 v[66:67], v[46:47], v[28:29] op_sel_hi:[1,0]
    s_mov_b32 exec_lo, 0
    v_pk_mul_f32 v[64:65], v[48:49], v[32:33] op_sel_hi:[1,0]
    v_pk_mul_f32 v[66:67], v[50:51], v[32:33] op_sel_hi:[1,0]
    s_mov_b32 exec_hi, 0xffff0000
    v_pk_mul_f32 v[64:65], v[52:53], v[36:37] op_sel_hi:[1,0]
    v_pk_mul_f32 v[66:67], v[54:55], v[36:37] op_sel_hi:[1,0]
    s_mov_b64 exec, -1
    v_cvt_pk_bf16_f32 v64, v64, v65
    v_cvt_pk_bf16_f32 v65, v66, v67
    s_cmp_lg_u32 s91, 1
    s_cbranch_scc1 Ldg_45
    global_store_dwordx2 v161, v[64:65], s[16:17]
    s_branch Ldd_46
Ldg_45:
    global_store_dwordx2 v161, v[64:65], s[16:17] sc1
Ldd_46:
L_norem2:
    v_mov_b32 v6, s55
    v_mov_b32 v5, s33
    s_mov_b64 exec, 1
    ds_add_u32 v3, v4 offset:268
    s_waitcnt vmcnt(0)
    s_cmp_lg_u32 s91, 1
    s_cbranch_scc1 Ldg_47
    global_store_dword v6, v5, s[16:17]
    s_branch Ldd_48
L_pada7:
    s_branch L_pada15
L_padb13:
    s_branch L_warmed_b
Ldg_47:
    global_store_dword v6, v5, s[16:17] sc1
Ldd_48:
    s_mov_b64 exec, -1
L_tail:
    s_lshl_b32 s96, s57, 2
    v_add_u32 v136, s96, v3
    s_add_u32 s62, s16, 8192
    s_addc_u32 s63, s17, 0
    s_add_u32 s64, s16, 16384
    s_addc_u32 s65, s17, 0
    s_setprio 2
    s_cmp_eq_u32 s57, 0
    s_cbranch_scc1 L_tp
    s_setprio 1
L_tp:
    v_mov_b32 v135, 0
    v_lshl_add_u32 v137, v0, 4, s84
    s_lshl_b32 s96, s56, 2
    v_add_u32 v160, s96, v3
    s_cmp_lg_u32 s34, 0
    s_cbranch_scc1 L_opa
    s_mov_b32 s100, 0
Lw_49:
    ds_read_b32 v4, v3 offset:268
    s_waitcnt lgkmcnt(0)
    v_readfirstlane_b32 s99, v4
    s_cmp_ge_u32 s99, 64
    s_cbranch_scc1 Lwd_50
    s_add_u32 s100, s100, 1
    s_cmp_lt_u32 s100, 1048576
    s_cbranch_scc1 Lw_49
Lwd_50:
    s_cmp_lg_u32 s57, 0
    s_cbranch_scc1 L_prep
L_opb:
    s_mov_b32 s100, 0
Lw_51:
    ds_read_b32 v4, v136 offset:200
    s_waitcnt lgkmcnt(0)
    v_readfirstlane_b32 s99, v4
    s_cmp_ge_u32 s99, 4
    s_cbranch_scc1 Lwd_52
    s_sleep 1
    s_add_u32 s100, s100, 1
    s_cmp_lt_u32 s100, 1048576
    s_cbranch_scc1 Lw_51
Lwd_52:
    ds_read_b128 v[68:71], v138 offset:0
    ds_read_b128 v[72:75], v138 offset:1024
    ds_read_b128 v[76:79], v138 offset:2048
    ds_read_b128 v[80:83], v138 offset:3072
    ds_read_b128 v[84:87], v138 offset:4096
    ds_read_b128 v[88:91], v138 offset:5120
    ds_read_b128 v[92:95], v138 offset:6144
    ds_read_b128 v[96:99], v138 offset:7168
    ds_read_b128 v[100:103], v138 offset:8192
    ds_read_b128 v[104:107], v138 offset:9216
    ds_read_b128 v[108:111], v138 offset:10240
    ds_read_b128 v[112:115], v138 offset:11264
    s_waitcnt lgkmcnt(8)
    ds_read_b128 v[116:119], v138 offset:12288
    ds_read_b128 v[120:123], v138 offset:13312
    ds_read_b128 v[124:127], v138 offset:14336
    ds_read_b128 v[128:131], v138 offset:15360
    s_cmp_eq_u32 s57, 0
    s_cbranch_scc1 L_opp
L_lgo:
    s_mov_b32 s100, 0
Lw_53:
    ds_read_b32 v4, v160 offset:216
    s_waitcnt lgkmcnt(0)
    v_readfirstlane_b32 s99, v4
    s_cmp_ge_u32 s99, 1
    s_cbranch_scc1 Lwd_54
    s_sleep 1
    s_add_u32 s100, s100, 1
    s_cmp_lt_u32 s100, 1048576
    s_cbranch_scc1 Lw_53
Lwd_54:
    s_branch L_late
L_opp:
    s_mov_b32 exec_hi, 0xfffff
    s_mov_b32 exec_lo, 0xfffff
    s_mov_b32 s100, 0
L_op:
    global_load_dword v4, v166, s[16:17] sc1
    s_waitcnt vmcnt(0)
    v_cmp_ne_u32 vcc, s33, v4
    s_cbranch_vccz L_opd
    s_add_u32 s100, s100, 1
    s_cmp_lt_u32 s100, 1048576
    s_cbranch_scc1 L_op
    s_branch L_opd
L_pada8:
    s_branch L_pada16
L_padb14:
    s_branch L_warmed_b
L_opa:
    s_cmp_lg_u32 s57, 0
    s_cbranch_scc1 L_lgo
    s_mov_b32 s100, 0
Lw_55:
    ds_read_b32 v4, v3 offset:276
    s_waitcnt lgkmcnt(0)
    v_readfirstlane_b32 s99, v4
    s_cmp_ge_u32 s99, 1
    s_cbranch_scc1 Lwd_56
    s_sleep 1
    s_add_u32 s100, s100, 1
    s_cmp_lt_u32 s100, 1048576
    s_cbranch_scc1 Lw_55
Lwd_56:
L_opd:
    s_mov_b64 exec, -1
    s_cmp_eq_u32 s57, 0
    s_cbranch_scc1 L_early
L_late:
    global_load_dwordx4 v[28:31], v139, s[16:17] offset:-4096 sc1
    global_load_dwordx4 v[32:35], v139, s[16:17] offset:-2048 sc1
    global_load_dwordx4 v[36:39], v139, s[16:17] offset:0 sc1
    global_load_dwordx4 v[40:43], v139, s[16:17] offset:2048 sc1
    global_load_dwordx4 v[44:47], v139, s[62:63] offset:-4096 sc1
    global_load_dwordx4 v[48:51], v139, s[62:63] offset:-2048 sc1
    global_load_dwordx4 v[52:55], v139, s[62:63] offset:0 sc1
    global_load_dwordx4 v[56:59], v139, s[62:63] offset:2048 sc1
    global_load_dwordx4 v[60:63], v139, s[64:65] offset:-4096 sc1
    global_load_dwordx4 v[64:67], v139, s[64:65] offset:-2048 sc1
    s_cmp_eq_u32 s34, 0
    s_cbranch_scc1 L_nogq
    s_mov_b32 s100, 0
Lw_57:
    ds_read_b32 v4, v3 offset:204
    s_waitcnt lgkmcnt(0)
    v_readfirstlane_b32 s99, v4
    s_cmp_ge_u32 s99, 4
    s_cbranch_scc1 Lwd_58
    s_sleep 1
    s_add_u32 s100, s100, 1
    s_cmp_lt_u32 s100, 1048576
    s_cbranch_scc1 Lw_57
Lwd_58:
    ds_read_b128 v[68:71], v138 offset:0
    ds_read_b128 v[72:75], v138 offset:1024
    ds_read_b128 v[76:79], v138 offset:2048
    ds_read_b128 v[80:83], v138 offset:3072
    ds_read_b128 v[84:87], v138 offset:4096
    ds_read_b128 v[88:91], v138 offset:5120
    ds_read_b128 v[92:95], v138 offset:6144
    ds_read_b128 v[96:99], v138 offset:7168
    ds_read_b128 v[100:103], v138 offset:8192
    ds_read_b128 v[104:107], v138 offset:9216
    ds_read_b128 v[108:111], v138 offset:10240
    ds_read_b128 v[112:115], v138 offset:11264
    s_waitcnt lgkmcnt(8)
    ds_read_b128 v[116:119], v138 offset:12288
    ds_read_b128 v[120:123], v138 offset:13312
    ds_read_b128 v[124:127], v138 offset:14336
    ds_read_b128 v[128:131], v138 offset:15360
    s_setprio 3
    s_waitcnt lgkmcnt(6)
L_prep:
    s_lshl_b32 s96, s56, 6
    s_add_u32 s96, s96, 161280
    v_lshl_add_u32 v164, v1, 2, s96
    s_mov_b32 s100, 0
Lw_59:
    ds_read_b32 v4, v3 offset:208
    s_waitcnt lgkmcnt(0)
    v_readfirstlane_b32 s99, v4
    s_cmp_ge_u32 s99, 1
    s_cbranch_scc1 Lwd_60
    s_add_u32 s100, s100, 1
    s_cmp_lt_u32 s100, 1048576
    s_cbranch_scc1 Lw_59
Lwd_60:
    ds_read2st64_b32 v[162:163], v164 offset0:0 offset1:1
    v_mul_u32_u24 v161, 160, v1
    v_lshl_add_u32 v161, v2, 3, v161
    v_add_u32 v5, s81, v161
    ds_read_b64 v[8:9], v5 offset:0
    ds_read_b64 v[10:11], v5 offset:32
    ds_read_b64 v[12:13], v5 offset:64
    ds_read_b64 v[14:15], v5 offset:96
    ds_read_b64 v[16:17], v5 offset:128
    v_add_u32 v161, s84, v161
    v_add_u32 v5, 0, v0
    v_mul_u32_u24 v165, 6554, v5
    v_lshrrev_b32 v165, 16, v165
    v_mul_u32_u24 v165, 1120, v165
    v_lshl_add_u32 v5, v5, 4, s85
    v_add_u32 v165, v165, v5
    v_add_u32 v5, 64, v0
    v_mul_u32_u24 v7, 6554, v5
    v_lshrrev_b32 v7, 16, v7
    v_mul_u32_u24 v7, 1120, v7
    v_lshl_add_u32 v5, v5, 4, s85
    v_add_u32 v7, v7, v5
    v_add_u32 v5, 128, v0
    v_mul_u32_u24 v135, 6554, v5
    v_lshrrev_b32 v135, 16, v135
    v_mul_u32_u24 v135, 1120, v135
    v_lshl_add_u32 v5, v5, 4, s85
    v_add_u32 v135, v135, v5
    v_bfe_u32 v5, v0, 2, 3
    v_and_b32 v5, 6, v5
    v_bfe_u32 v6, v0, 1, 1
    s_lshl_b32 s96, s56, 1
    v_or_b32 v6, s96, v6
    v_xor_b32 v5, v5, v6
    v_lshlrev_b32 v5, 4, v5
    v_lshrrev_b32 v6, 2, v0
    v_lshl_add_u32 v5, v6, 7, v5
    v_and_b32 v6, 1, v0
    v_lshl_add_u32 v5, v6, 3, v5
    v_add_u32 v164, s93, v5
    s_waitcnt lgkmcnt(0)
    v_lshlrev_b32 v140, 16, v8
    v_and_b32 v141, 0xffff0000, v8
    v_pk_mul_f32 v[140:141], v[140:141], v[162:163] op_sel:[0,1] op_sel_hi:[1,1]
    v_lshlrev_b32 v142, 16, v9
    v_and_b32 v143, 0xffff0000, v9
    v_pk_mul_f32 v[142:143], v[142:143], v[162:163] op_sel:[0,1] op_sel_hi:[1,1]
    v_lshlrev_b32 v144, 16, v10
    v_and_b32 v145, 0xffff0000, v10
    v_pk_mul_f32 v[144:145], v[144:145], v[162:163] op_sel:[0,1] op_sel_hi:[1,1]
    v_lshlrev_b32 v146, 16, v11
    v_and_b32 v147, 0xffff0000, v11
    v_pk_mul_f32 v[146:147], v[146:147], v[162:163] op_sel:[0,1] op_sel_hi:[1,1]
    v_lshlrev_b32 v148, 16, v12
    v_and_b32 v149, 0xffff0000, v12
    v_pk_mul_f32 v[148:149], v[148:149], v[162:163] op_sel:[0,1] op_sel_hi:[1,1]
    v_lshlrev_b32 v150, 16, v13
    v_and_b32 v151, 0xffff0000, v13
    v_pk_mul_f32 v[150:151], v[150:151], v[162:163] op_sel:[0,1] op_sel_hi:[1,1]
    v_lshlrev_b32 v152, 16, v14
    v_and_b32 v153, 0xffff0000, v14
    v_pk_mul_f32 v[152:153], v[152:153], v[162:163] op_sel:[0,1] op_sel_hi:[1,1]
    v_lshlrev_b32 v154, 16, v15
    v_and_b32 v155, 0xffff0000, v15
    v_pk_mul_f32 v[154:155], v[154:155], v[162:163] op_sel:[0,1] op_sel_hi:[1,1]
    v_lshlrev_b32 v156, 16, v16
    v_and_b32 v157, 0xffff0000, v16
    v_pk_mul_f32 v[156:157], v[156:157], v[162:163] op_sel:[0,1] op_sel_hi:[1,1]
    v_lshlrev_b32 v158, 16, v17
    v_and_b32 v159, 0xffff0000, v17
    v_pk_mul_f32 v[158:159], v[158:159], v[162:163] op_sel:[0,1] op_sel_hi:[1,1]
    s_setprio 1
    s_cmp_lg_u32 s34, 0
    s_cbranch_scc0 L_opb
L_nogq:
    s_waitcnt lgkmcnt(0)
    s_waitcnt vmcnt(9)
    v_mfma_f32_16x16x32_bf16 v[8:11], v[68:71], v[28:31], 0
    ds_read_b128 v[68:71], v138 offset:16384
    v_mfma_f32_16x16x32_bf16 v[12:15], v[72:75], v[28:31], 0
    ds_read_b128 v[72:75], v138 offset:17408
    v_mfma_f32_16x16x32_bf16 v[16:19], v[76:79], v[28:31], 0
    ds_read_b128 v[76:79], v138 offset:18432
    v_mfma_f32_16x16x32_bf16 v[20:23], v[80:83], v[28:31], 0
    ds_read_b128 v[80:83], v138 offset:19456
    v_mfma_f32_16x16x32_bf16 v[24:27], v[84:87], v[28:31], 0
    ds_read_b128 v[84:87], v138 offset:20480
    s_branch L_skip3042
L_pada9:
    s_branch L_pada17
L_padb15:
    s_branch L_warmed_b
L_skip3042:
    s_waitcnt vmcnt(8)
    v_mfma_f32_16x16x32_bf16 v[8:11], v[88:91], v[32:35], v[8:11]
    ds_read_b128 v[88:91], v138 offset:21504
    v_mfma_f32_16x16x32_bf16 v[12:15], v[92:95], v[32:35], v[12:15]
    ds_read_b128 v[92:95], v138 offset:22528
    v_mfma_f32_16x16x32_bf16 v[16:19], v[96:99], v[32:35], v[16:19]
    ds_read_b128 v[96:99], v138 offset:23552
    v_mfma_f32_16x16x32_bf16 v[20:23], v[100:103], v[32:35], v[20:23]
    ds_read_b128 v[100:103], v138 offset:24576
    v_mfma_f32_16x16x32_bf16 v[24:27], v[104:107], v[32:35], v[24:27]
    ds_read_b128 v[104:107], v138 offset:25600
    s_waitcnt vmcnt(7)
    v_mfma_f32_16x16x32_bf16 v[8:11], v[108:111], v[36:39], v[8:11]
    ds_read_b128 v[108:111], v138 offset:26624
    v_mfma_f32_16x16x32_bf16 v[12:15], v[112:115], v[36:39], v[12:15]
    ds_read_b128 v[112:115], v138 offset:27648
    v_mfma_f32_16x16x32_bf16 v[16:19], v[116:119], v[36:39], v[16:19]
    s_waitcnt lgkmcnt(10)
    ds_read_b128 v[116:119], v138 offset:28672
    v_mfma_f32_16x16x32_bf16 v[20:23], v[120:123], v[36:39], v[20:23]
    ds_read_b128 v[120:123], v138 offset:29696
    v_mfma_f32_16x16x32_bf16 v[24:27], v[124:127], v[36:39], v[24:27]
    s_waitcnt lgkmcnt(10)
    ds_read_b128 v[124:127], v138 offset:30720
    s_waitcnt vmcnt(6)
    v_mfma_f32_16x16x32_bf16 v[8:11], v[128:131], v[40:43], v[8:11]
    ds_read_b128 v[128:131], v138 offset:31744
    v_mfma_f32_16x16x32_bf16 v[12:15], v[68:71], v[40:43], v[12:15]
    s_waitcnt lgkmcnt(10)
    ds_read_b128 v[68:71], v138 offset:32768
    v_mfma_f32_16x16x32_bf16 v[16:19], v[72:75], v[40:43], v[16:19]
    ds_read_b128 v[72:75], v138 offset:33792
    v_mfma_f32_16x16x32_bf16 v[20:23], v[76:79], v[40:43], v[20:23]
    s_waitcnt lgkmcnt(10)
    ds_read_b128 v[76:79], v138 offset:34816
    v_mfma_f32_16x16x32_bf16 v[24:27], v[80:83], v[40:43], v[24:27]
    ds_read_b128 v[80:83], v138 offset:35840
    s_waitcnt vmcnt(5)
    v_mfma_f32_16x16x32_bf16 v[8:11], v[84:87], v[44:47], v[8:11]
    s_waitcnt lgkmcnt(10)
    ds_read_b128 v[84:87], v138 offset:36864
    v_mfma_f32_16x16x32_bf16 v[12:15], v[88:91], v[44:47], v[12:15]
    ds_read_b128 v[88:91], v138 offset:37888
    v_mfma_f32_16x16x32_bf16 v[16:19], v[92:95], v[44:47], v[16:19]
    s_waitcnt lgkmcnt(10)
    ds_read_b128 v[92:95], v138 offset:38912
    v_mfma_f32_16x16x32_bf16 v[20:23], v[96:99], v[44:47], v[20:23]
    ds_read_b128 v[96:99], v138 offset:39936
    v_mfma_f32_16x16x32_bf16 v[24:27], v[100:103], v[44:47], v[24:27]
    s_waitcnt lgkmcnt(10)
    ds_read_b128 v[100:103], v138 offset:40960
    s_waitcnt vmcnt(4)
    v_mfma_f32_16x16x32_bf16 v[8:11], v[104:107], v[48:51], v[8:11]
    ds_read_b128 v[104:107], v138 offset:41984
    v_mfma_f32_16x16x32_bf16 v[12:15], v[108:111], v[48:51], v[12:15]
    s_waitcnt lgkmcnt(10)
    ds_read_b128 v[108:111], v138 offset:43008
    v_mfma_f32_16x16x32_bf16 v[16:19], v[112:115], v[48:51], v[16:19]
    ds_read_b128 v[112:115], v138 offset:44032
    v_mfma_f32_16x16x32_bf16 v[20:23], v[116:119], v[48:51], v[20:23]
    s_waitcnt lgkmcnt(10)
    ds_read_b128 v[116:119], v138 offset:45056
    v_mfma_f32_16x16x32_bf16 v[24:27], v[120:123], v[48:51], v[24:27]
    ds_read_b128 v[120:123], v138 offset:46080
    s_waitcnt vmcnt(3)
    v_mfma_f32_16x16x32_bf16 v[8:11], v[124:127], v[52:55], v[8:11]
    s_waitcnt lgkmcnt(10)
    ds_read_b128 v[124:127], v138 offset:47104
    v_mfma_f32_16x16x32_bf16 v[12:15], v[128:131], v[52:55], v[12:15]
    ds_read_b128 v[128:131], v138 offset:48128
    v_mfma_f32_16x16x32_bf16 v[16:19], v[68:71], v[52:55], v[16:19]
    s_waitcnt lgkmcnt(10)
    ds_read_b128 v[68:71], v138 offset:49152
    v_mfma_f32_16x16x32_bf16 v[20:23], v[72:75], v[52:55], v[20:23]
    ds_read_b128 v[72:75], v138 offset:50176
    v_mfma_f32_16x16x32_bf16 v[24:27], v[76:79], v[52:55], v[24:27]
    s_waitcnt vmcnt(2)
    v_mfma_f32_16x16x32_bf16 v[8:11], v[80:83], v[56:59], v[8:11]
    v_mfma_f32_16x16x32_bf16 v[12:15], v[84:87], v[56:59], v[12:15]
    v_mfma_f32_16x16x32_bf16 v[16:19], v[88:91], v[56:59], v[16:19]
    s_waitcnt lgkmcnt(11)
    v_mfma_f32_16x16x32_bf16 v[20:23], v[92:95], v[56:59], v[20:23]
    s_waitcnt lgkmcnt(10)
    v_mfma_f32_16x16x32_bf16 v[24:27], v[96:99], v[56:59], v[24:27]
    s_waitcnt lgkmcnt(9)
    s_waitcnt vmcnt(1)
    v_mfma_f32_16x16x32_bf16 v[8:11], v[100:103], v[60:63], v[8:11]
    s_waitcnt lgkmcnt(8)
    v_mfma_f32_16x16x32_bf16 v[12:15], v[104:107], v[60:63], v[12:15]
    s_waitcnt lgkmcnt(7)
    v_mfma_f32_16x16x32_bf16 v[16:19], v[108:111], v[60:63], v[16:19]
    s_waitcnt lgkmcnt(6)
    v_mfma_f32_16x16x32_bf16 v[20:23], v[112:115], v[60:63], v[20:23]
    s_waitcnt lgkmcnt(5)
    v_mfma_f32_16x16x32_bf16 v[24:27], v[116:119], v[60:63], v[24:27]
    s_waitcnt lgkmcnt(4)
    s_waitcnt vmcnt(0)
    v_mfma_f32_16x16x32_bf16 v[8:11], v[120:123], v[64:67], v[8:11]
    s_waitcnt lgkmcnt(3)
    v_mfma_f32_16x16x32_bf16 v[12:15], v[124:127], v[64:67], v[12:15]
    s_waitcnt lgkmcnt(2)
    v_mfma_f32_16x16x32_bf16 v[16:19], v[128:131], v[64:67], v[16:19]
    s_waitcnt lgkmcnt(1)
    v_mfma_f32_16x16x32_bf16 v[20:23], v[68:71], v[64:67], v[20:23]
    s_waitcnt lgkmcnt(0)
    v_mfma_f32_16x16x32_bf16 v[24:27], v[72:75], v[64:67], v[24:27]
    s_setprio 3
    s_mov_b32 s100, 0
L_fb:
    ds_read_b32 v4, v160 offset:232
    ds_read_b32 v5, v3 offset:212
    ds_read_b128 v[28:31], v137 offset:0
    ds_read_b64_tr_b16 v[48:49], v164 offset:0
    ds_read_b128 v[32:35], v137 offset:1024
    ds_read_b64_tr_b16 v[50:51], v164 offset:2048
    ds_read_b128 v[36:39], v137 offset:2048
    ds_read_b64_tr_b16 v[52:53], v164 offset:4096
    ds_read_b128 v[40:43], v137 offset:3072
    ds_read_b64_tr_b16 v[54:55], v164 offset:6144
    ds_read_b128 v[44:47], v137 offset:4096
    ds_read_b64_tr_b16 v[56:57], v164 offset:8192
    s_waitcnt lgkmcnt(10)
    v_and_b32 v4, v4, v5
    s_nop 0
    v_readfirstlane_b32 s96, v4
    s_cmp_eq_u32 s96, 2
    s_cbranch_scc1 L_fin
    s_waitcnt lgkmcnt(0)
    s_add_u32 s100, s100, 1
    s_cmp_lt_u32 s100, 1048576
    s_cbranch_scc1 L_fb
L_fin:
    s_waitcnt lgkmcnt(8)
    v_pk_add_f32 v[28:29], v[28:29], v[8:9]
    v_lshlrev_b32 v60, 16, v48
    v_and_b32 v61, 0xffff0000, v48
    v_pk_add_f32 v[30:31], v[30:31], v[10:11]
    v_lshlrev_b32 v62, 16, v49
    v_and_b32 v63, 0xffff0000, v49
    v_pk_mul_f32 v[60:61], v[60:61], v[140:141]
    v_pk_mul_f32 v[62:63], v[62:63], v[142:143]
    v_pk_fma_f32 v[28:29], v[28:29], v[162:163], v[60:61] op_sel_hi:[1,0,1]
    v_pk_fma_f32 v[30:31], v[30:31], v[162:163], v[62:63] op_sel_hi:[1,0,1]
    v_cvt_pk_bf16_f32 v48, v28, v29
    v_cvt_pk_bf16_f32 v49, v30, v31
    s_branch L_skip3187
L_pada10:
    s_branch L_pada18
L_padb16:
    s_branch L_warmed_b
L_skip3187:
    s_waitcnt lgkmcnt(6)
    v_pk_add_f32 v[32:33], v[32:33], v[12:13]
    v_lshlrev_b32 v60, 16, v50
    v_and_b32 v61, 0xffff0000, v50
    v_pk_add_f32 v[34:35], v[34:35], v[14:15]
    v_lshlrev_b32 v62, 16, v51
    v_and_b32 v63, 0xffff0000, v51
    v_pk_mul_f32 v[60:61], v[60:61], v[144:145]
    v_pk_mul_f32 v[62:63], v[62:63], v[146:147]
    v_pk_fma_f32 v[32:33], v[32:33], v[162:163], v[60:61] op_sel_hi:[1,0,1]
    v_pk_fma_f32 v[34:35], v[34:35], v[162:163], v[62:63] op_sel_hi:[1,0,1]
    v_cvt_pk_bf16_f32 v50, v32, v33
    v_cvt_pk_bf16_f32 v51, v34, v35
    s_waitcnt lgkmcnt(4)
    v_pk_add_f32 v[36:37], v[36:37], v[16:17]
    v_lshlrev_b32 v60, 16, v52
    v_and_b32 v61, 0xffff0000, v52
    v_pk_add_f32 v[38:39], v[38:39], v[18:19]
    v_lshlrev_b32 v62, 16, v53
    v_and_b32 v63, 0xffff0000, v53
    v_pk_mul_f32 v[60:61], v[60:61], v[148:149]
    v_pk_mul_f32 v[62:63], v[62:63], v[150:151]
    v_pk_fma_f32 v[36:37], v[36:37], v[162:163], v[60:61] op_sel_hi:[1,0,1]
    v_pk_fma_f32 v[38:39], v[38:39], v[162:163], v[62:63] op_sel_hi:[1,0,1]
    v_cvt_pk_bf16_f32 v52, v36, v37
    v_cvt_pk_bf16_f32 v53, v38, v39
    s_waitcnt lgkmcnt(2)
    v_pk_add_f32 v[40:41], v[40:41], v[20:21]
    v_lshlrev_b32 v60, 16, v54
    v_and_b32 v61, 0xffff0000, v54
    v_pk_add_f32 v[42:43], v[42:43], v[22:23]
    v_lshlrev_b32 v62, 16, v55
    v_and_b32 v63, 0xffff0000, v55
    v_pk_mul_f32 v[60:61], v[60:61], v[152:153]
    v_pk_mul_f32 v[62:63], v[62:63], v[154:155]
    v_pk_fma_f32 v[40:41], v[40:41], v[162:163], v[60:61] op_sel_hi:[1,0,1]
    v_pk_fma_f32 v[42:43], v[42:43], v[162:163], v[62:63] op_sel_hi:[1,0,1]
    v_cvt_pk_bf16_f32 v54, v40, v41
    v_cvt_pk_bf16_f32 v55, v42, v43
    s_waitcnt lgkmcnt(0)
    v_pk_add_f32 v[44:45], v[44:45], v[24:25]
    v_lshlrev_b32 v60, 16, v56
    v_and_b32 v61, 0xffff0000, v56
    v_pk_add_f32 v[46:47], v[46:47], v[26:27]
    v_lshlrev_b32 v62, 16, v57
    v_and_b32 v63, 0xffff0000, v57
    v_pk_mul_f32 v[60:61], v[60:61], v[156:157]
    v_pk_mul_f32 v[62:63], v[62:63], v[158:159]
    v_pk_fma_f32 v[44:45], v[44:45], v[162:163], v[60:61] op_sel_hi:[1,0,1]
    v_pk_fma_f32 v[46:47], v[46:47], v[162:163], v[62:63] op_sel_hi:[1,0,1]
    v_cvt_pk_bf16_f32 v56, v44, v45
    v_cvt_pk_bf16_f32 v57, v46, v47
    ds_write_b64 v161, v[48:49] offset:0
    ds_write_b64 v161, v[50:51] offset:32
    ds_write_b64 v161, v[52:53] offset:64
    ds_write_b64 v161, v[54:55] offset:96
    ds_write_b64 v161, v[56:57] offset:128
    ds_read_b128 v[72:75], v137 offset:0
    ds_read_b128 v[76:79], v137 offset:1024
    ds_read_b128 v[80:83], v137 offset:2048
    s_waitcnt lgkmcnt(2)
    global_store_dwordx4 v165, v[72:75], s[24:25]
    s_waitcnt lgkmcnt(1)
    global_store_dwordx4 v7, v[76:79], s[24:25]
    s_waitcnt lgkmcnt(0)
    s_mov_b64 exec, 0xffffffff
    global_store_dwordx4 v135, v[80:83], s[24:25]
    s_endpgm
L_pada11:
    s_branch L_warmed_a
L_padb17:
    s_branch L_warmed_b
L_early:
    global_load_dwordx4 v[28:31], v139, s[16:17] offset:-4096 sc1
    global_load_dwordx4 v[32:35], v139, s[16:17] offset:-2048 sc1
    global_load_dwordx4 v[36:39], v139, s[16:17] offset:0 sc1
    v_mov_b32 v5, 1
    s_cmp_eq_u32 s34, 0
    s_cbranch_scc1 L_early1
    s_mov_b32 s100, 0
Lw_61:
    ds_read_b32 v4, v3 offset:200
    s_waitcnt lgkmcnt(0)
    v_readfirstlane_b32 s99, v4
    s_cmp_ge_u32 s99, 4
    s_cbranch_scc1 Lwd_62
    s_sleep 1
    s_add_u32 s100, s100, 1
    s_cmp_lt_u32 s100, 1048576
    s_cbranch_scc1 Lw_61
Lwd_62:
    ds_read_b128 v[68:71], v138 offset:0
    ds_read_b128 v[72:75], v138 offset:1024
    ds_read_b128 v[76:79], v138 offset:2048
    ds_read_b128 v[80:83], v138 offset:3072
    ds_read_b128 v[84:87], v138 offset:4096
    ds_read_b128 v[88:91], v138 offset:5120
    ds_read_b128 v[92:95], v138 offset:6144
    ds_read_b128 v[96:99], v138 offset:7168
    ds_read_b128 v[100:103], v138 offset:8192
    ds_read_b128 v[104:107], v138 offset:9216
    ds_read_b128 v[108:111], v138 offset:10240
    ds_read_b128 v[112:115], v138 offset:11264
    s_waitcnt lgkmcnt(8)
    ds_read_b128 v[116:119], v138 offset:12288
    ds_read_b128 v[120:123], v138 offset:13312
    ds_read_b128 v[124:127], v138 offset:14336
    ds_read_b128 v[128:131], v138 offset:15360
L_early1:
    s_waitcnt lgkmcnt(0)
    s_waitcnt vmcnt(2)
    v_mfma_f32_16x16x32_bf16 v[8:11], v[68:71], v[28:31], 0
    ds_read_b128 v[68:71], v138 offset:16384
    v_mfma_f32_16x16x32_bf16 v[12:15], v[72:75], v[28:31], 0
    global_load_dwordx4 v[40:43], v139, s[16:17] offset:2048 sc1
    ds_read_b128 v[72:75], v138 offset:17408
    v_mfma_f32_16x16x32_bf16 v[16:19], v[76:79], v[28:31], 0
    ds_read_b128 v[76:79], v138 offset:18432
    v_mfma_f32_16x16x32_bf16 v[20:23], v[80:83], v[28:31], 0
    global_load_dwordx4 v[44:47], v139, s[62:63] offset:-4096 sc1
    ds_read_b128 v[80:83], v138 offset:19456
    v_mfma_f32_16x16x32_bf16 v[24:27], v[84:87], v[28:31], 0
    ds_read_b128 v[84:87], v138 offset:20480
    s_waitcnt vmcnt(3)
    v_mfma_f32_16x16x32_bf16 v[8:11], v[88:91], v[32:35], v[8:11]
    ds_read_b128 v[88:91], v138 offset:21504
    v_mfma_f32_16x16x32_bf16 v[12:15], v[92:95], v[32:35], v[12:15]
    global_load_dwordx4 v[48:51], v139, s[62:63] offset:-2048 sc1
    ds_read_b128 v[92:95], v138 offset:22528
    v_mfma_f32_16x16x32_bf16 v[16:19], v[96:99], v[32:35], v[16:19]
    ds_read_b128 v[96:99], v138 offset:23552
    v_mfma_f32_16x16x32_bf16 v[20:23], v[100:103], v[32:35], v[20:23]
    global_load_dwordx4 v[52:55], v139, s[62:63] offset:0 sc1
    ds_read_b128 v[100:103], v138 offset:24576
    v_mfma_f32_16x16x32_bf16 v[24:27], v[104:107], v[32:35], v[24:27]
    ds_read_b128 v[104:107], v138 offset:25600
    s_waitcnt vmcnt(4)
    v_mfma_f32_16x16x32_bf16 v[8:11], v[108:111], v[36:39], v[8:11]
    ds_read_b128 v[108:111], v138 offset:26624
    v_mfma_f32_16x16x32_bf16 v[12:15], v[112:115], v[36:39], v[12:15]
    global_load_dwordx4 v[56:59], v139, s[62:63] offset:2048 sc1
    s_waitcnt lgkmcnt(9)
    ds_read_b128 v[112:115], v138 offset:27648
    v_mfma_f32_16x16x32_bf16 v[16:19], v[116:119], v[36:39], v[16:19]
    ds_read_b128 v[116:119], v138 offset:28672
    v_mfma_f32_16x16x32_bf16 v[20:23], v[120:123], v[36:39], v[20:23]
    global_load_dwordx4 v[60:63], v139, s[64:65] offset:-4096 sc1
    ds_write_b32 v160, v5 offset:216
    s_waitcnt lgkmcnt(9)
    ds_read_b128 v[120:123], v138 offset:29696
    v_mfma_f32_16x16x32_bf16 v[24:27], v[124:127], v[36:39], v[24:27]
    ds_read_b128 v[124:127], v138 offset:30720
    s_waitcnt vmcnt(5)
    v_mfma_f32_16x16x32_bf16 v[8:11], v[128:131], v[40:43], v[8:11]
    s_waitcnt lgkmcnt(9)
    ds_read_b128 v[128:131], v138 offset:31744
    v_mfma_f32_16x16x32_bf16 v[12:15], v[68:71], v[40:43], v[12:15]
    global_load_dwordx4 v[64:67], v139, s[64:65] offset:-2048 sc1
    ds_read_b128 v[68:71], v138 offset:32768
    v_mfma_f32_16x16x32_bf16 v[16:19], v[72:75], v[40:43], v[16:19]
    s_waitcnt lgkmcnt(9)
    ds_read_b128 v[72:75], v138 offset:33792
    v_mfma_f32_16x16x32_bf16 v[20:23], v[76:79], v[40:43], v[20:23]
    ds_read_b128 v[76:79], v138 offset:34816
    v_mfma_f32_16x16x32_bf16 v[24:27], v[80:83], v[40:43], v[24:27]
    s_waitcnt lgkmcnt(9)
    ds_read_b128 v[80:83], v138 offset:35840
    s_waitcnt vmcnt(5)
    v_mfma_f32_16x16x32_bf16 v[8:11], v[84:87], v[44:47], v[8:11]
    ds_read_b128 v[84:87], v138 offset:36864
    v_mfma_f32_16x16x32_bf16 v[12:15], v[88:91], v[44:47], v[12:15]
    s_waitcnt lgkmcnt(9)
    ds_read_b128 v[88:91], v138 offset:37888
    v_mfma_f32_16x16x32_bf16 v[16:19], v[92:95], v[44:47], v[16:19]
    ds_read_b128 v[92:95], v138 offset:38912
    v_mfma_f32_16x16x32_bf16 v[20:23], v[96:99], v[44:47], v[20:23]
    s_waitcnt lgkmcnt(9)
    ds_read_b128 v[96:99], v138 offset:39936
    v_mfma_f32_16x16x32_bf16 v[24:27], v[100:103], v[44:47], v[24:27]
    ds_read_b128 v[100:103], v138 offset:40960
    s_waitcnt vmcnt(4)
    v_mfma_f32_16x16x32_bf16 v[8:11], v[104:107], v[48:51], v[8:11]
    s_waitcnt lgkmcnt(9)
    ds_read_b128 v[104:107], v138 offset:41984
    v_mfma_f32_16x16x32_bf16 v[12:15], v[108:111], v[48:51], v[12:15]
    ds_read_b128 v[108:111], v138 offset:43008
    v_mfma_f32_16x16x32_bf16 v[16:19], v[112:115], v[48:51], v[16:19]
    s_waitcnt lgkmcnt(9)
    ds_read_b128 v[112:115], v138 offset:44032
    v_mfma_f32_16x16x32_bf16 v[20:23], v[116:119], v[48:51], v[20:23]
    ds_read_b128 v[116:119], v138 offset:45056
    v_mfma_f32_16x16x32_bf16 v[24:27], v[120:123], v[48:51], v[24:27]
    s_waitcnt lgkmcnt(9)
    ds_read_b128 v[120:123], v138 offset:46080
    s_waitcnt vmcnt(3)
    v_mfma_f32_16x16x32_bf16 v[8:11], v[124:127], v[52:55], v[8:11]
    ds_read_b128 v[124:127], v138 offset:47104
    v_mfma_f32_16x16x32_bf16 v[12:15], v[128:131], v[52:55], v[12:15]
    s_waitcnt lgkmcnt(9)
    ds_read_b128 v[128:131], v138 offset:48128
    v_mfma_f32_16x16x32_bf16 v[16:19], v[68:71], v[52:55], v[16:19]
    ds_read_b128 v[68:71], v138 offset:49152
    v_mfma_f32_16x16x32_bf16 v[20:23], v[72:75], v[52:55], v[20:23]
    s_waitcnt lgkmcnt(9)
    ds_read_b128 v[72:75], v138 offset:50176
    v_mfma_f32_16x16x32_bf16 v[24:27], v[76:79], v[52:55], v[24:27]
    s_waitcnt vmcnt(2)
    v_mfma_f32_16x16x32_bf16 v[8:11], v[80:83], v[56:59], v[8:11]
    v_mfma_f32_16x16x32_bf16 v[12:15], v[84:87], v[56:59], v[12:15]
    v_mfma_f32_16x16x32_bf16 v[16:19], v[88:91], v[56:59], v[16:19]
    v_mfma_f32_16x16x32_bf16 v[20:23], v[92:95], v[56:59], v[20:23]
    v_mfma_f32_16x16x32_bf16 v[24:27], v[96:99], v[56:59], v[24:27]
    s_waitcnt lgkmcnt(9)
    s_branch L_skip3396
L_pada12:
    s_branch L_warmed_a
L_padb18:
    s_branch L_warmed_b
L_skip3396:
    s_waitcnt vmcnt(1)
    v_mfma_f32_16x16x32_bf16 v[8:11], v[100:103], v[60:63], v[8:11]
    s_waitcnt lgkmcnt(8)
    v_mfma_f32_16x16x32_bf16 v[12:15], v[104:107], v[60:63], v[12:15]
    s_waitcnt lgkmcnt(7)
    v_mfma_f32_16x16x32_bf16 v[16:19], v[108:111], v[60:63], v[16:19]
    s_waitcnt lgkmcnt(6)
    v_mfma_f32_16x16x32_bf16 v[20:23], v[112:115], v[60:63], v[20:23]
    s_waitcnt lgkmcnt(5)
    v_mfma_f32_16x16x32_bf16 v[24:27], v[116:119], v[60:63], v[24:27]
    s_waitcnt lgkmcnt(4)
    s_waitcnt vmcnt(0)
    v_mfma_f32_16x16x32_bf16 v[8:11], v[120:123], v[64:67], v[8:11]
    s_waitcnt lgkmcnt(3)
    v_mfma_f32_16x16x32_bf16 v[12:15], v[124:127], v[64:67], v[12:15]
    s_waitcnt lgkmcnt(2)
    v_mfma_f32_16x16x32_bf16 v[16:19], v[128:131], v[64:67], v[16:19]
    s_waitcnt lgkmcnt(1)
    v_mfma_f32_16x16x32_bf16 v[20:23], v[68:71], v[64:67], v[20:23]
    s_waitcnt lgkmcnt(0)
    v_mfma_f32_16x16x32_bf16 v[24:27], v[72:75], v[64:67], v[24:27]
    s_setprio 0
    s_mov_b32 s100, 0
Lw_63:
    ds_read_b32 v4, v3 offset:196
    s_waitcnt lgkmcnt(0)
    v_readfirstlane_b32 s99, v4
    s_cmp_ge_u32 s99, 8
    s_cbranch_scc1 Lwd_64
    s_add_u32 s100, s100, 1
    s_cmp_lt_u32 s100, 1048576
    s_cbranch_scc1 Lw_63
Lwd_64:
    ds_write_b128 v137, v[8:11] offset:0
    ds_write_b128 v137, v[12:15] offset:1024
    ds_write_b128 v137, v[16:19] offset:2048
    ds_write_b128 v137, v[20:23] offset:3072
    ds_write_b128 v137, v[24:27] offset:4096
    v_mov_b32 v4, 2
    ds_write_b32 v160, v4 offset:232
    s_endpgm
L_awave:
    s_sub_u32 s40, s32, 4
    s_min_u32 s99, s38, 4
    s_lshl3_add_u32 s58, s99, s40
    s_lshl_b32 s96, s58, 7
    s_add_u32 s97, s96, 64
    v_sub_u32 v4, v1, v2
    v_and_b32 v4, 3, v4
    v_and_or_b32 v4, v1, 12, v4
    v_lshrrev_b32 v5, 1, v4
    v_lshlrev_b32 v4, 4, v4
    s_waitcnt lgkmcnt(0)
    s_load_dwordx16 s[40:55], s[10:11], s96
    s_load_dwordx16 s[76:91], s[10:11], s97
    s_setprio 2
    s_waitcnt lgkmcnt(0)
    v_cmp_eq_u32 vcc, 0, v5
    s_mov_b64 exec, vcc
    v_bfe_u32 v42, s40, v4, 16
    v_bfe_u32 v43, s48, v4, 16
    v_bfe_u32 v44, s76, v4, 16
    v_bfe_u32 v45, s84, v4, 16
    s_mov_b64 exec, -1
    v_cmp_eq_u32 vcc, 1, v5
    s_mov_b64 exec, vcc
    v_bfe_u32 v42, s41, v4, 16
    v_bfe_u32 v43, s49, v4, 16
    v_bfe_u32 v44, s77, v4, 16
    v_bfe_u32 v45, s85, v4, 16
    s_mov_b64 exec, -1
    v_cmp_eq_u32 vcc, 2, v5
    s_mov_b64 exec, vcc
    v_bfe_u32 v42, s42, v4, 16
    v_bfe_u32 v43, s50, v4, 16
    v_bfe_u32 v44, s78, v4, 16
    v_bfe_u32 v45, s86, v4, 16
    s_mov_b64 exec, -1
    v_cmp_eq_u32 vcc, 3, v5
    s_mov_b64 exec, vcc
    v_bfe_u32 v42, s43, v4, 16
    v_bfe_u32 v43, s51, v4, 16
    v_bfe_u32 v44, s79, v4, 16
    v_bfe_u32 v45, s87, v4, 16
    s_mov_b64 exec, -1
    v_cmp_eq_u32 vcc, 4, v5
    s_mov_b64 exec, vcc
    v_bfe_u32 v42, s44, v4, 16
    v_bfe_u32 v43, s52, v4, 16
    v_bfe_u32 v44, s80, v4, 16
    v_bfe_u32 v45, s88, v4, 16
    s_mov_b64 exec, -1
    v_cmp_eq_u32 vcc, 5, v5
    s_mov_b64 exec, vcc
    v_bfe_u32 v42, s45, v4, 16
    v_bfe_u32 v43, s53, v4, 16
    v_bfe_u32 v44, s81, v4, 16
    v_bfe_u32 v45, s89, v4, 16
    s_mov_b64 exec, -1
    v_cmp_eq_u32 vcc, 6, v5
    s_mov_b64 exec, vcc
    v_bfe_u32 v42, s46, v4, 16
    v_bfe_u32 v43, s54, v4, 16
    v_bfe_u32 v44, s82, v4, 16
    v_bfe_u32 v45, s90, v4, 16
    s_mov_b64 exec, -1
    v_cmp_eq_u32 vcc, 7, v5
    s_mov_b64 exec, vcc
    v_bfe_u32 v42, s47, v4, 16
    v_bfe_u32 v43, s55, v4, 16
    v_bfe_u32 v44, s83, v4, 16
    v_bfe_u32 v45, s91, v4, 16
    s_mov_b64 exec, -1
    s_sub_u32 s40, s32, 4
    s_load_dword s33, s[28:29], 0
    s_setprio 2
    s_and_b32 s56, s40, 3
    s_lshr_b32 s57, s40, 2
    s_sub_u32 s96, s31, 20
    s_mul_i32 s97, s96, 43
    s_lshr_b32 s97, s97, 7
    s_mul_i32 s41, s96, 7
    s_sub_u32 s41, s41, s97
    s_mul_i32 s97, s97, 3
    s_sub_u32 s97, s96, s97
    s_cmp_eq_u32 s97, 2
    s_cselect_b32 s64, 6, 7
    s_mul_i32 s97, s30, 80
    s_add_u32 s41, s41, s97
    s_cmp_lt_u32 s40, s64
    s_cselect_b32 s52, 1, 0
    s_cselect_b32 s98, s40, 0
    s_cselect_b32 s44, 7, s64
    s_cselect_b32 s54, 0, 448
    s_add_u32 s41, s41, s98
    s_mul_i32 s42, s98, 8320
    s_mul_i32 s43, s98, 4608
    s_add_u32 s43, s43, 58240
    s_lshl_b32 s55, s41, 12
    s_lshr_b32 s96, s41, 1
    s_lshl_b32 s96, s96, 2
    s_load_dword s53, s[14:15], s96
    v_lshlrev_b32 v8, 4, v0
    v_lshl_add_u32 v5, v1, 3, v2
    v_lshlrev_b32 v5, 8, v5
    v_add_u32 v5, 90496, v5
    s_lshl_b32 s96, s40, 1
    v_xor_b32 v6, s96, v1
    v_lshl_add_u32 v9, v6, 4, v5
    v_add_u32 v6, 15, v1
    v_and_b32 v6, 15, v6
    v_xor_b32 v6, s96, v6
    v_lshl_add_u32 v11, v6, 4, v5
    v_xor_b32 v10, 16, v9
    v_xor_b32 v12, 16, v11
    s_lshl_b32 s96, s58, 16
    s_lshl_b32 s97, s37, 8
    s_add_u32 s96, s96, s97
    s_add_u32 s96, s96, 1048576
    v_lshlrev_b32 v5, 12, v2
    v_lshl_add_u32 v5, v1, 4, v5
    v_add_u32 v14, s96, v5
    s_add_u32 s60, s28, 16384
    s_addc_u32 s61, s29, 0
    s_add_u32 s62, s28, 32768
    s_addc_u32 s63, s29, 0
    s_add_u32 s66, s28, 49152
    s_addc_u32 s67, s29, 0
    s_lshl4_add_u32 s96, s58, s37
    s_lshl_b32 s96, s96, 7
    s_add_u32 s96, s96, 262144
    v_add_u32 v5, v1, v2
    v_lshl_add_u32 v148, v5, 3, s96
    s_lshr_b32 s96, s41, 4
    s_lshl_b32 s96, s96, 11
    s_and_b32 s97, s41, 15
    s_lshl3_add_u32 s96, s97, s96
    s_add_u32 s96, s96, 262144
    v_lshl_add_u32 v149, v1, 7, s96
    s_add_u32 s96, s55, 1048576
    s_add_u32 s76, s28, s96
    s_addc_u32 s77, s29, 0
    s_and_b32 s77, s77, 0xffff
    s_mov_b32 s78, 4096
    s_mov_b32 s79, 0x00020000
    v_sub_u32 v5, 2031, v1
    v_and_b32 v6, 1, v5
    v_lshrrev_b32 v5, 1, v5
    v_lshl_add_u32 v5, v2, 2, v5
    v_lshlrev_b32 v5, 2, v5
    v_mul_u32_u24 v6, 4160, v6
    s_sub_u32 s96, s42, s54
    v_add3_u32 v5, v5, v6, s96
    v_subrev_u32 v154, 3584, v5
    v_subrev_u32 v155, 2560, v5
    v_subrev_u32 v156, 1536, v5
    v_subrev_u32 v157, 512, v5
    v_lshlrev_b32 v5, 5, v1
    v_lshl_add_u32 v5, v2, 4, v5
    s_sub_u32 s96, s43, s54
    s_add_u32 s96, s96, 480
    v_add_u32 v158, s96, v5
    v_and_b32 v5, 1, v2
    v_lshlrev_b32 v5, 9, v5
    v_lshl_add_u32 v5, v1, 5, v5
    v_lshrrev_b32 v6, 1, v2
    v_lshl_add_u32 v5, v6, 4, v5
    s_add_u32 s96, s55, 4194304
    v_add_u32 v153, s96, v5
    v_and_b32 v5, 1, v1
    v_lshl_add_u32 v5, v5, 2, v2
    v_lshrrev_b32 v6, 2, v1
    v_lshl_add_u32 v5, v5, 2, v6
    v_lshlrev_b32 v5, 2, v5
    v_add_u32 v159, 161792, v5
    s_cmp_ge_u32 s31, 26
    s_cselect_b32 s96, 8, 0
    s_lshl_b32 s97, s30, 8
    s_add_u32 s96, s96, s97
    s_add_u32 s96, s96, 65536
    v_and_b32 v5, 31, v0
    v_lshl_add_u32 v160, v5, 11, s96
    s_mul_i32 s96, s98, 2048
    s_add_u32 s96, s96, 88448
    v_add_u32 v161, s96, v8
    s_lshl_b32 s96, s98, 2
    v_add_u32 v162, s96, v3
    s_mul_i32 s96, s57, 51200
    s_sub_u32 s80, 109568, s96
    s_mul_i32 s81, s56, 2560
    s_add_u32 s81, s81, 48128
    s_mov_b32 s93, 0
    s_and_b32 s98, s35, 3
    s_lshr_b32 s96, s56, 1
    s_lshl1_add_u32 s96, s98, s96
    s_lshl1_add_u32 s96, s96, s57
    s_mul_i32 s96, s96, 20480
    s_and_b32 s97, s56, 1
    s_lshl_b32 s97, s97, 10
    s_add_u32 s96, s96, s97
    s_mul_i32 s97, s30, 327680
    s_add_u32 s96, s96, s97
    s_add_u32 s82, s96, 13111296
    s_mul_i32 s96, s30, 262144
    s_lshl_b32 s98, s98, 8
    s_add_u32 s96, s96, s98
    s_add_u32 s83, s96, 7536640
    s_mul_i32 s84, s56, 5120
    s_add_u32 s84, s84, 10240
    s_lshl2_add_u32 s96, s35, s56
    s_mul_i32 s96, s96, 20480
    s_mul_i32 s97, s36, 160
    s_add_u32 s85, s96, s97
    v_and_b32 v5, 1, v1
    v_lshlrev_b32 v5, 4, v5
    v_mov_b32 v6, 0x3f80
    v_lshlrev_b32 v6, v5, v6
    v_lshrrev_b32 v7, 1, v1
    v_lshlrev_b32 v4, 1, v2
    v_sub_u32 v4, v7, v4
    v_cmp_eq_u32 vcc, 0, v4
    s_nop 1
    v_cndmask_b32 v164, 0, v6, vcc
    v_cmp_eq_u32 vcc, 1, v4
    s_nop 1
    v_cndmask_b32 v165, 0, v6, vcc
    s_waitcnt lgkmcnt(0)
    s_mul_i32 s33, s33, 1664525
    s_add_u32 s33, s33, 1013904223
    s_lshl_b32 s96, s41, 4
    s_lshr_b32 s53, s53, s96
    s_and_b32 s53, s53, 0xffff
    v_lshlrev_b32 v6, v5, s53
    v_lshlrev_b32 v4, 2, v2
    v_sub_u32 v4, v7, v4
    v_cmp_eq_u32 vcc, -8, v4
    s_nop 1
    v_cndmask_b32 v144, 0, v6, vcc
    v_cmp_eq_u32 vcc, -7, v4
    s_nop 1
    v_cndmask_b32 v145, 0, v6, vcc
    v_cmp_eq_u32 vcc, -6, v4
    s_nop 1
    v_cndmask_b32 v146, 0, v6, vcc
    v_cmp_eq_u32 vcc, -5, v4
    s_nop 1
    v_cndmask_b32 v147, 0, v6, vcc
    v_bfe_u32 v5, v1, 2, 1
    v_lshlrev_b32 v5, 4, v5
    v_and_b32 v6, 3, v1
    v_lshrrev_b32 v7, 3, v1
    v_mov_b32 v4, 0x3f80
    v_lshlrev_b32 v4, v5, v4
    v_cmp_eq_u32 vcc, v6, v2
    s_nop 1
    v_cndmask_b32 v4, 0, v4, vcc
    v_cmp_eq_u32 vcc, 0, v7
    s_nop 1
    v_cndmask_b32 v40, 0, v4, vcc
    v_cndmask_b32 v41, v4, 0, vcc
    v_or_b32 v4, 2, v7
    v_cmp_ge_u32 vcc, v6, v2
    s_nop 1
    v_cndmask_b32 v7, v7, v4, vcc
    v_lshlrev_b32 v42, v5, v42
    v_lshlrev_b32 v43, v5, v43
    v_lshlrev_b32 v44, v5, v44
    v_lshlrev_b32 v45, v5, v45
    v_cmp_eq_u32 vcc, 0, v7
    s_nop 1
    v_cndmask_b32 v16, 0, v42, vcc
    v_cndmask_b32 v20, 0, v42, vcc
    v_cndmask_b32 v22, 0, v43, vcc
    v_cndmask_b32 v26, 0, v43, vcc
    v_cndmask_b32 v28, 0, v44, vcc
    v_cndmask_b32 v32, 0, v44, vcc
    v_cndmask_b32 v34, 0, v45, vcc
    v_cndmask_b32 v38, 0, v45, vcc
    v_cmp_eq_u32 vcc, 1, v7
    s_nop 1
    v_cndmask_b32 v17, 0, v42, vcc
    v_cndmask_b32 v21, 0, v42, vcc
    v_cndmask_b32 v23, 0, v43, vcc
    v_cndmask_b32 v27, 0, v43, vcc
    v_cndmask_b32 v29, 0, v44, vcc
    v_cndmask_b32 v33, 0, v44, vcc
    v_cndmask_b32 v35, 0, v45, vcc
    v_cndmask_b32 v39, 0, v45, vcc
    v_cmp_eq_u32 vcc, 2, v7
    s_nop 1
    v_cndmask_b32 v18, 0, v42, vcc
    v_cndmask_b32 v24, 0, v43, vcc
    v_cndmask_b32 v30, 0, v44, vcc
    v_cndmask_b32 v36, 0, v45, vcc
    v_cmp_eq_u32 vcc, 3, v7
    s_nop 1
    v_cndmask_b32 v19, 0, v42, vcc
    v_cndmask_b32 v25, 0, v43, vcc
    v_cndmask_b32 v31, 0, v44, vcc
    v_cndmask_b32 v37, 0, v45, vcc
    s_cmp_eq_u32 s32, 4
    s_cbranch_scc1 L_pada0
    s_cmp_eq_u32 s32, 5
    s_cbranch_scc1 L_pada1
    s_cmp_eq_u32 s32, 6
    s_cbranch_scc1 L_pada2
    s_cmp_eq_u32 s32, 7
    s_cbranch_scc1 L_pada3
    s_cmp_eq_u32 s32, 8
    s_cbranch_scc1 L_pada4
    s_cmp_eq_u32 s32, 9
    s_cbranch_scc1 L_pada5
    s_cmp_eq_u32 s32, 10
    s_cbranch_scc1 L_pada6
    s_branch L_pada7
L_pada13:
    s_branch L_warmed_a
L_warmed_a:
    s_barrier
    s_cmp_ge_u32 s38, 5
    s_cbranch_scc1 L_nokv
    ds_read_b128 v[48:51], v11
    ds_read_b128 v[52:55], v9 offset:1024
    ds_read_b128 v[56:59], v9 offset:2048
    ds_read_b128 v[60:63], v9 offset:33792
    ds_read_b128 v[64:67], v9 offset:34816
    ds_read_b128 v[68:71], v12
    ds_read_b128 v[72:75], v10 offset:1024
    ds_read_b128 v[76:79], v10 offset:2048
    ds_read_b128 v[80:83], v10 offset:33792
    ds_read_b128 v[84:87], v10 offset:34816
    s_waitcnt lgkmcnt(8)
    v_swap_b32 v50, v52
    v_swap_b32 v51, v53
    s_nop 1
    v_mfma_f32_16x16x32_bf16 v[88:91], v[16:19], v[48:51], 0
    v_mfma_f32_16x16x32_bf16 v[96:99], v[22:25], v[52:55], 0
    s_waitcnt lgkmcnt(7)
    v_mov_b64 v[48:49], v[56:57]
    v_mov_b64 v[52:53], v[58:59]
    s_nop 0
    v_mfma_f32_16x16x32_bf16 v[92:95], v[18:21], v[48:51], 0
    v_mfma_f32_16x16x32_bf16 v[100:103], v[24:27], v[52:55], 0
    s_waitcnt lgkmcnt(5)
    v_mfma_f32_16x16x16_bf16 v[104:107], v[40:41], v[60:61], 0
    v_mfma_f32_16x16x16_bf16 v[108:111], v[40:41], v[64:65], 0
    v_mfma_f32_16x16x16_bf16 v[112:115], v[40:41], v[62:63], 0
    v_mfma_f32_16x16x16_bf16 v[116:119], v[40:41], v[66:67], 0
    s_waitcnt lgkmcnt(3)
    v_swap_b32 v70, v72
    v_swap_b32 v71, v73
    s_nop 1
    v_mfma_f32_16x16x32_bf16 v[48:51], v[28:31], v[68:71], 0
    v_mfma_f32_16x16x32_bf16 v[56:59], v[34:37], v[72:75], 0
    s_waitcnt lgkmcnt(2)
    v_mov_b64 v[68:69], v[76:77]
    v_mov_b64 v[72:73], v[78:79]
    s_nop 0
    v_mfma_f32_16x16x32_bf16 v[52:55], v[30:33], v[68:71], 0
    v_mfma_f32_16x16x32_bf16 v[60:63], v[36:39], v[72:75], 0
    v_pk_mul_f32 v[88:89], v[88:89], v[104:105]
    v_pk_mul_f32 v[90:91], v[90:91], v[106:107]
    v_pk_mul_f32 v[92:93], v[92:93], v[108:109]
    v_pk_mul_f32 v[94:95], v[94:95], v[110:111]
    v_pk_mul_f32 v[96:97], v[96:97], v[112:113]
    v_pk_mul_f32 v[98:99], v[98:99], v[114:115]
    v_pk_mul_f32 v[100:101], v[100:101], v[116:117]
    v_pk_mul_f32 v[102:103], v[102:103], v[118:119]
    s_waitcnt lgkmcnt(0)
    v_mfma_f32_16x16x16_bf16 v[104:107], v[40:41], v[80:81], 0
    v_mfma_f32_16x16x16_bf16 v[108:111], v[40:41], v[84:85], 0
    v_mfma_f32_16x16x16_bf16 v[112:115], v[40:41], v[82:83], 0
    v_mfma_f32_16x16x16_bf16 v[116:119], v[40:41], v[86:87], 0
    v_cvt_pk_bf16_f32 v120, v88, v89
    v_cvt_pk_bf16_f32 v121, v90, v91
    v_cvt_pk_bf16_f32 v122, v92, v93
    v_cvt_pk_bf16_f32 v123, v94, v95
    global_store_dwordx4 v14, v[120:123], s[28:29] sc1
    v_cvt_pk_bf16_f32 v124, v96, v97
    v_cvt_pk_bf16_f32 v125, v98, v99
    v_cvt_pk_bf16_f32 v126, v100, v101
    v_cvt_pk_bf16_f32 v127, v102, v103
    global_store_dwordx4 v14, v[124:127], s[60:61] sc1
    v_add_u32 v76, v120, v121
    v_add3_u32 v76, v76, v122, v123
    v_add_u32 v77, v124, v125
    v_add3_u32 v77, v77, v126, v127
    v_pk_mul_f32 v[48:49], v[48:49], v[104:105]
    v_pk_mul_f32 v[50:51], v[50:51], v[106:107]
    v_pk_mul_f32 v[52:53], v[52:53], v[108:109]
    v_pk_mul_f32 v[54:55], v[54:55], v[110:111]
    v_pk_mul_f32 v[56:57], v[56:57], v[112:113]
    v_pk_mul_f32 v[58:59], v[58:59], v[114:115]
    v_pk_mul_f32 v[60:61], v[60:61], v[116:117]
    v_pk_mul_f32 v[62:63], v[62:63], v[118:119]
    v_cvt_pk_bf16_f32 v68, v48, v49
    v_cvt_pk_bf16_f32 v69, v50, v51
    v_cvt_pk_bf16_f32 v70, v52, v53
    v_cvt_pk_bf16_f32 v71, v54, v55
    global_store_dwordx4 v14, v[68:71], s[62:63] sc1
    v_cvt_pk_bf16_f32 v72, v56, v57
    v_cvt_pk_bf16_f32 v73, v58, v59
    v_cvt_pk_bf16_f32 v74, v60, v61
    v_cvt_pk_bf16_f32 v75, v62, v63
    global_store_dwordx4 v14, v[72:75], s[66:67] sc1
    v_add_u32 v78, v68, v69
    v_add3_u32 v78, v78, v70, v71
    v_add_u32 v79, v72, v73
    v_add3_u32 v79, v79, v74, v75
    v_add_u32_dpp v80, v76, v76 row_ror:8 row_mask:0xf bank_mask:0xf
    v_add_u32_dpp v81, v77, v77 row_ror:8 row_mask:0xf bank_mask:0xf
    s_nop 0
    v_add_u32_dpp v80, v78, v78 row_ror:8 row_mask:0xf bank_mask:0xc
    v_add_u32_dpp v81, v79, v79 row_ror:8 row_mask:0xf bank_mask:0xc
    v_mov_b32 v76, s33
    v_add_u32_dpp v77, v80, v80 row_half_mirror row_mask:0xf bank_mask:0xf
    s_nop 1
    v_add_u32_dpp v77, v81, v81 row_half_mirror row_mask:0xf bank_mask:0xa
    s_nop 1
    v_add_u32_dpp v77, v77, v77 quad_perm:[1,0,3,2] row_mask:0xf bank_mask:0xf
    s_nop 1
    v_add_u32_dpp v77, v77, v77 quad_perm:[2,3,0,1] row_mask:0xf bank_mask:0xf
    s_mov_b32 exec_lo, 0x11111111
    s_mov_b32 exec_hi, 0x11111111
    global_store_dwordx2 v148, v[76:77], s[28:29] sc1
    s_mov_b64 exec, -1
L_nokv:
    v_mov_b32 v4, 1
    s_mov_b64 exec, 1
    ds_add_u32 v3, v4 offset:256
    s_mov_b64 exec, -1
    s_cmp_lg_u32 s52, 0
    s_cbranch_scc1 L_owner
    s_waitcnt vmcnt(0)
    v_mov_b32 v4, 1
    s_mov_b64 exec, 1
    ds_add_u32 v3, v4 offset:280
    s_mov_b64 exec, -1
    s_cmp_lg_u32 s40, 7
    s_cbranch_scc1 L_cdone
    s_mov_b32 s100, 0
Lw_65:
    ds_read_b32 v4, v3 offset:312
    s_waitcnt lgkmcnt(0)
    v_readfirstlane_b32 s99, v4
    s_cmp_ge_u32 s99, 1
    s_cbranch_scc1 Lwd_66
    s_add_u32 s100, s100, 1
    s_cmp_lt_u32 s100, 1048576
    s_cbranch_scc1 Lw_65
Lwd_66:
    ds_read2_b32 v[48:49], v157 offset0:128 offset1:129
    ds_read2_b32 v[50:51], v157 offset0:130 offset1:131
    ds_read2_b32 v[52:53], v157 offset0:0 offset1:1
    ds_read2_b32 v[54:55], v157 offset0:2 offset1:3
    ds_read2_b32 v[56:57], v156 offset0:128 offset1:129
    ds_read2_b32 v[58:59], v156 offset0:130 offset1:131
    ds_read2_b32 v[60:61], v156 offset0:0 offset1:1
    ds_read2_b32 v[62:63], v156 offset0:2 offset1:3
    ds_read2_b32 v[64:65], v155 offset0:128 offset1:129
    ds_read2_b32 v[66:67], v155 offset0:130 offset1:131
    ds_read2_b32 v[68:69], v155 offset0:0 offset1:1
    ds_read2_b32 v[70:71], v155 offset0:2 offset1:3
    s_waitcnt lgkmcnt(6)
    ds_read2_b32 v[72:73], v154 offset0:128 offset1:129
    ds_read2_b32 v[74:75], v154 offset0:130 offset1:131
    s_branch L_skip3900
L_pada14:
    s_branch L_warmed_a
L_skip3900:
    ds_read2_b32 v[76:77], v154 offset0:0 offset1:1
    ds_read2_b32 v[78:79], v154 offset0:2 offset1:3
    s_setprio 3
    v_mov_b32 v5, 1
    s_mov_b32 s100, 0
Lw_67:
    ds_read_b32 v4, v3 offset:280
    s_waitcnt lgkmcnt(0)
    v_readfirstlane_b32 s99, v4
    s_cmp_ge_u32 s99, 8
    s_cbranch_scc1 Lwd_68
    s_add_u32 s100, s100, 1
    s_cmp_lt_u32 s100, 1048576
    s_cbranch_scc1 Lw_67
Lwd_68:
    ds_read_b128 v[80:83], v158 offset:0
    ds_read_b128 v[84:87], v158 offset:512
    ds_read_b128 v[88:91], v158 offset:1024
    ds_read_b128 v[92:95], v158 offset:1536
    ds_read_b128 v[96:99], v158 offset:2048
    ds_read_b128 v[100:103], v158 offset:2560
    ds_read_b128 v[104:107], v158 offset:3072
    ds_read_b128 v[108:111], v158 offset:3584
    s_waitcnt lgkmcnt(0)
    s_setprio 3
    s_branch L_hloop
L_owner:
    v_mov_b32 v44, 0
    v_mov_b32 v45, 0
    v_lshl_add_u32 v5, v0, 3, s43
    ds_write_b64 v5, v[44:45]
    s_sleep 12
    s_mov_b64 exec, 0xffff
    s_mov_b32 s100, 0
L_ep:
    global_atomic_or_x2 v[46:47], v149, v[44:45], s[28:29] sc0 sc1
    s_waitcnt vmcnt(0)
    v_cmp_ne_u32 vcc, s33, v46
    s_cbranch_vccz L_epd
    s_mov_b64 exec, vcc
    s_add_u32 s100, s100, 1
    s_cmp_lt_u32 s100, 1048576
    s_cbranch_scc1 L_ep
L_epd:
    s_mov_b64 exec, -1
    s_setprio 3
    s_mov_b32 s100, 0
    s_add_u32 m0, s43, 512
    s_nop 0
    buffer_load_dwordx4 v8, s[76:79], 0 offen offset:0 sc1 lds
    buffer_load_dwordx4 v8, s[76:79], 0 offen offset:1024 sc1 lds
    buffer_load_dwordx4 v8, s[76:79], 0 offen offset:2048 sc1 lds
    buffer_load_dwordx4 v8, s[76:79], 0 offen offset:3072 sc1 lds
    v_add_u32_dpp v47, v47, v47 row_ror:8 row_mask:0xf bank_mask:0xf
    s_nop 1
    v_add_u32_dpp v47, v47, v47 row_ror:4 row_mask:0xf bank_mask:0xf
    s_nop 1
    v_add_u32_dpp v47, v47, v47 row_ror:2 row_mask:0xf bank_mask:0xf
    s_nop 1
    v_add_u32_dpp v47, v47, v47 row_ror:1 row_mask:0xf bank_mask:0xf
    s_nop 0
    v_readfirstlane_b32 s60, v47
    s_mov_b32 s100, 0
Lw_69:
    ds_read_b32 v4, v162 offset:312
    s_waitcnt lgkmcnt(0)
    v_readfirstlane_b32 s99, v4
    s_cmp_ge_u32 s99, 1
    s_cbranch_scc1 Lwd_70
    s_add_u32 s100, s100, 1
    s_cmp_lt_u32 s100, 1048576
    s_cbranch_scc1 Lw_69
Lwd_70:
    ds_read2_b32 v[48:49], v157 offset0:128 offset1:129
    ds_read2_b32 v[50:51], v157 offset0:130 offset1:131
    ds_read2_b32 v[52:53], v157 offset0:0 offset1:1
    ds_read2_b32 v[54:55], v157 offset0:2 offset1:3
    ds_read2_b32 v[56:57], v156 offset0:128 offset1:129
    ds_read2_b32 v[58:59], v156 offset0:130 offset1:131
    ds_read2_b32 v[60:61], v156 offset0:0 offset1:1
    ds_read2_b32 v[62:63], v156 offset0:2 offset1:3
    ds_read2_b32 v[64:65], v155 offset0:128 offset1:129
    ds_read2_b32 v[66:67], v155 offset0:130 offset1:131
    ds_read2_b32 v[68:69], v155 offset0:0 offset1:1
    ds_read2_b32 v[70:71], v155 offset0:2 offset1:3
    s_waitcnt lgkmcnt(6)
    ds_read2_b32 v[72:73], v154 offset0:128 offset1:129
    ds_read2_b32 v[74:75], v154 offset0:130 offset1:131
    ds_read2_b32 v[76:77], v154 offset0:0 offset1:1
    ds_read2_b32 v[78:79], v154 offset0:2 offset1:3
    s_mov_b32 s100, 0
L_uretry:
    s_waitcnt vmcnt(0) lgkmcnt(0)
    ds_read_b128 v[108:111], v158 offset:3584
    ds_read_b128 v[104:107], v158 offset:3072
    ds_read_b128 v[100:103], v158 offset:2560
    ds_read_b128 v[96:99], v158 offset:2048
    ds_read_b128 v[92:95], v158 offset:1536
    ds_read_b128 v[88:91], v158 offset:1024
    ds_read_b128 v[84:87], v158 offset:512
    ds_read_b128 v[80:83], v158 offset:0
    s_waitcnt lgkmcnt(7)
    v_mfma_f32_16x16x32_bf16 v[44:47], v[144:147], v[108:111], 0
    v_add_u32 v9, v108, v109
    v_add3_u32 v9, v9, v110, v111
    s_waitcnt lgkmcnt(6)
    v_mfma_f32_16x16x32_bf16 v[40:43], v[144:147], v[104:107], 0
    v_add3_u32 v9, v9, v104, v105
    v_add3_u32 v9, v9, v106, v107
    s_waitcnt lgkmcnt(5)
    v_mfma_f32_16x16x32_bf16 v[36:39], v[144:147], v[100:103], 0
    v_add3_u32 v9, v9, v100, v101
    v_add3_u32 v9, v9, v102, v103
    s_waitcnt lgkmcnt(4)
    v_mfma_f32_16x16x32_bf16 v[32:35], v[144:147], v[96:99], 0
    v_add3_u32 v9, v9, v96, v97
    v_add3_u32 v9, v9, v98, v99
    s_waitcnt lgkmcnt(3)
    v_mfma_f32_16x16x32_bf16 v[28:31], v[144:147], v[92:95], 0
    v_add3_u32 v9, v9, v92, v93
    v_add3_u32 v9, v9, v94, v95
    s_waitcnt lgkmcnt(2)
    v_mfma_f32_16x16x32_bf16 v[24:27], v[144:147], v[88:91], 0
    v_add3_u32 v9, v9, v88, v89
    v_add3_u32 v9, v9, v90, v91
    s_waitcnt lgkmcnt(1)
    v_mfma_f32_16x16x32_bf16 v[20:23], v[144:147], v[84:87], 0
    v_add3_u32 v9, v9, v84, v85
    v_add3_u32 v9, v9, v86, v87
    s_waitcnt lgkmcnt(0)
    v_mfma_f32_16x16x32_bf16 v[16:19], v[144:147], v[80:83], 0
    v_add3_u32 v9, v9, v80, v81
    v_add3_u32 v9, v9, v82, v83
    s_nop 1
    v_add_u32_dpp v9, v9, v9 row_ror:8 row_mask:0xf bank_mask:0xf
    s_nop 1
    v_add_u32_dpp v9, v9, v9 row_ror:4 row_mask:0xf bank_mask:0xf
    s_nop 1
    v_add_u32_dpp v9, v9, v9 row_ror:2 row_mask:0xf bank_mask:0xf
    s_nop 1
    v_add_u32_dpp v9, v9, v9 row_ror:1 row_mask:0xf bank_mask:0xf
    s_nop 0
    v_readlane_b32 s96, v9, 32
    v_readlane_b32 s97, v9, 48
    v_mov_b32 v4, 1
    s_add_u32 s96, s96, s97
    s_cmp_eq_u32 s96, s60
    s_cbranch_scc1 L_uok
    buffer_load_dwordx4 v8, s[76:79], 0 offen offset:0 sc1 lds
    buffer_load_dwordx4 v8, s[76:79], 0 offen offset:1024 sc1 lds
    buffer_load_dwordx4 v8, s[76:79], 0 offen offset:2048 sc1 lds
    buffer_load_dwordx4 v8, s[76:79], 0 offen offset:3072 sc1 lds
    s_add_u32 s100, s100, 1
    s_cmp_lt_u32 s100, 1048576
    s_cbranch_scc1 L_uretry
L_uok:
    s_mov_b64 exec, 1
    ds_add_u32 v3, v4 offset:280
    s_mov_b64 exec, -1
    s_branch L_skip4059
L_pada15:
    s_branch L_warmed_a
L_skip4059:
L_cloop:
    s_setprio 2
    s_cmp_gt_u32 s44, 4
    s_cbranch_scc1 Lcp_71
    s_setprio 1
    s_cmp_gt_u32 s44, 2
    s_cbranch_scc1 Lcp_71
    s_setprio 0
Lcp_71:
    v_subrev_u32 v154, 64, v154
    v_subrev_u32 v155, 64, v155
    v_subrev_u32 v156, 64, v156
    v_subrev_u32 v157, 64, v157
    v_subrev_u32 v158, 64, v158
    s_waitcnt lgkmcnt(15)
    v_mfma_f32_16x16x32_bf16 v[44:47], v[48:51], v[108:111], v[44:47]
    v_mfma_f32_16x16x32_bf16 v[40:43], v[48:51], v[104:107], v[40:43]
    s_waitcnt lgkmcnt(12)
    ds_read_b128 v[140:143], v158 offset:3584
    v_mfma_f32_16x16x32_bf16 v[36:39], v[48:51], v[100:103], v[36:39]
    v_mfma_f32_16x16x32_bf16 v[32:35], v[48:51], v[96:99], v[32:35]
    ds_read_b128 v[136:139], v158 offset:3072
    v_mfma_f32_16x16x32_bf16 v[28:31], v[48:51], v[92:95], v[28:31]
    v_mfma_f32_16x16x32_bf16 v[24:27], v[48:51], v[88:91], v[24:27]
    s_waitcnt lgkmcnt(12)
    ds_read_b128 v[132:135], v158 offset:2560
    s_waitcnt lgkmcnt(8)
    v_mfma_f32_16x16x32_bf16 v[20:23], v[48:51], v[84:87], v[20:23]
    s_waitcnt lgkmcnt(7)
    v_mfma_f32_16x16x32_bf16 v[16:19], v[48:51], v[80:83], v[16:19]
    ds_read_b128 v[128:131], v158 offset:2048
    v_mfma_f32_16x16x32_bf16 v[44:47], v[52:55], v[104:107], v[44:47]
    v_mfma_f32_16x16x32_bf16 v[40:43], v[52:55], v[100:103], v[40:43]
    ds_read2_b32 v[48:49], v157 offset0:128 offset1:129
    v_mfma_f32_16x16x32_bf16 v[36:39], v[52:55], v[96:99], v[36:39]
    v_mfma_f32_16x16x32_bf16 v[32:35], v[52:55], v[92:95], v[32:35]
    ds_read2_b32 v[50:51], v157 offset0:130 offset1:131
    v_mfma_f32_16x16x32_bf16 v[28:31], v[52:55], v[88:91], v[28:31]
    v_mfma_f32_16x16x32_bf16 v[24:27], v[52:55], v[84:87], v[24:27]
    ds_read_b128 v[124:127], v158 offset:1536
    v_mfma_f32_16x16x32_bf16 v[20:23], v[52:55], v[80:83], v[20:23]
    v_mfma_f32_16x16x32_bf16 v[44:47], v[56:59], v[100:103], v[44:47]
    v_mfma_f32_16x16x32_bf16 v[40:43], v[56:59], v[96:99], v[40:43]
    ds_read2_b32 v[52:53], v157 offset0:0 offset1:1
    v_mfma_f32_16x16x32_bf16 v[36:39], v[56:59], v[92:95], v[36:39]
    v_mfma_f32_16x16x32_bf16 v[32:35], v[56:59], v[88:91], v[32:35]
    ds_read2_b32 v[54:55], v157 offset0:2 offset1:3
    v_mfma_f32_16x16x32_bf16 v[28:31], v[56:59], v[84:87], v[28:31]
    v_mfma_f32_16x16x32_bf16 v[24:27], v[56:59], v[80:83], v[24:27]
    ds_read_b128 v[120:123], v158 offset:1024
    v_mfma_f32_16x16x32_bf16 v[44:47], v[60:63], v[96:99], v[44:47]
    v_mfma_f32_16x16x32_bf16 v[40:43], v[60:63], v[92:95], v[40:43]
    s_waitcnt lgkmcnt(12)
    ds_read2_b32 v[56:57], v156 offset0:128 offset1:129
    v_mfma_f32_16x16x32_bf16 v[36:39], v[60:63], v[88:91], v[36:39]
    v_mfma_f32_16x16x32_bf16 v[32:35], v[60:63], v[84:87], v[32:35]
    ds_read2_b32 v[58:59], v156 offset0:130 offset1:131
    v_mfma_f32_16x16x32_bf16 v[28:31], v[60:63], v[80:83], v[28:31]
    v_mfma_f32_16x16x32_bf16 v[44:47], v[64:67], v[92:95], v[44:47]
    v_mfma_f32_16x16x32_bf16 v[40:43], v[64:67], v[88:91], v[40:43]
    s_waitcnt lgkmcnt(12)
    ds_read2_b32 v[60:61], v156 offset0:0 offset1:1
    v_mfma_f32_16x16x32_bf16 v[36:39], v[64:67], v[84:87], v[36:39]
    v_mfma_f32_16x16x32_bf16 v[32:35], v[64:67], v[80:83], v[32:35]
    ds_read2_b32 v[62:63], v156 offset0:2 offset1:3
    v_mfma_f32_16x16x32_bf16 v[44:47], v[68:71], v[88:91], v[44:47]
    v_mfma_f32_16x16x32_bf16 v[40:43], v[68:71], v[84:87], v[40:43]
    s_waitcnt lgkmcnt(12)
    ds_read2_b32 v[64:65], v155 offset0:128 offset1:129
    v_mfma_f32_16x16x32_bf16 v[36:39], v[68:71], v[80:83], v[36:39]
    ds_read2_b32 v[68:69], v155 offset0:0 offset1:1
    s_waitcnt lgkmcnt(12)
    ds_read2_b32 v[70:71], v155 offset0:2 offset1:3
    ds_read2_b32 v[66:67], v155 offset0:130 offset1:131
    s_waitcnt lgkmcnt(12)
    ds_read_b128 v[116:119], v158 offset:512
    ds_read_b128 v[112:115], v158 offset:0
    v_mfma_f32_16x16x32_bf16 v[44:47], v[72:75], v[84:87], v[44:47]
    v_mfma_f32_16x16x32_bf16 v[40:43], v[72:75], v[80:83], v[40:43]
    s_waitcnt lgkmcnt(12)
    ds_read2_b32 v[72:73], v154 offset0:128 offset1:129
    ds_read2_b32 v[74:75], v154 offset0:130 offset1:131
    v_mfma_f32_16x16x32_bf16 v[44:47], v[76:79], v[80:83], v[44:47]
    s_waitcnt lgkmcnt(12)
    ds_read2_b32 v[76:77], v154 offset0:0 offset1:1
    ds_read2_b32 v[78:79], v154 offset0:2 offset1:3
    s_sub_u32 s44, s44, 1
    s_cmp_eq_u32 s44, 0
    s_cbranch_scc1 L_cexit
    v_subrev_u32 v154, 64, v154
    v_subrev_u32 v155, 64, v155
    v_subrev_u32 v156, 64, v156
    v_subrev_u32 v157, 64, v157
    v_subrev_u32 v158, 64, v158
    v_mfma_f32_16x16x32_bf16 v[44:47], v[48:51], v[140:143], v[44:47]
    v_mfma_f32_16x16x32_bf16 v[40:43], v[48:51], v[136:139], v[40:43]
    s_waitcnt lgkmcnt(12)
    ds_read_b128 v[108:111], v158 offset:3584
    v_mfma_f32_16x16x32_bf16 v[36:39], v[48:51], v[132:135], v[36:39]
    v_mfma_f32_16x16x32_bf16 v[32:35], v[48:51], v[128:131], v[32:35]
    ds_read_b128 v[104:107], v158 offset:3072
    v_mfma_f32_16x16x32_bf16 v[28:31], v[48:51], v[124:127], v[28:31]
    v_mfma_f32_16x16x32_bf16 v[24:27], v[48:51], v[120:123], v[24:27]
    s_waitcnt lgkmcnt(12)
    ds_read_b128 v[100:103], v158 offset:2560
    s_waitcnt lgkmcnt(8)
    v_mfma_f32_16x16x32_bf16 v[20:23], v[48:51], v[116:119], v[20:23]
    s_waitcnt lgkmcnt(7)
    v_mfma_f32_16x16x32_bf16 v[16:19], v[48:51], v[112:115], v[16:19]
    ds_read_b128 v[96:99], v158 offset:2048
    v_mfma_f32_16x16x32_bf16 v[44:47], v[52:55], v[136:139], v[44:47]
    v_mfma_f32_16x16x32_bf16 v[40:43], v[52:55], v[132:135], v[40:43]
    ds_read2_b32 v[48:49], v157 offset0:128 offset1:129
    v_mfma_f32_16x16x32_bf16 v[36:39], v[52:55], v[128:131], v[36:39]
    v_mfma_f32_16x16x32_bf16 v[32:35], v[52:55], v[124:127], v[32:35]
    ds_read2_b32 v[50:51], v157 offset0:130 offset1:131
    v_mfma_f32_16x16x32_bf16 v[28:31], v[52:55], v[120:123], v[28:31]
    v_mfma_f32_16x16x32_bf16 v[24:27], v[52:55], v[116:119], v[24:27]
    ds_read_b128 v[92:95], v158 offset:1536
    v_mfma_f32_16x16x32_bf16 v[20:23], v[52:55], v[112:115], v[20:23]
    v_mfma_f32_16x16x32_bf16 v[44:47], v[56:59], v[132:135], v[44:47]
    v_mfma_f32_16x16x32_bf16 v[40:43], v[56:59], v[128:131], v[40:43]
    ds_read2_b32 v[52:53], v157 offset0:0 offset1:1
    v_mfma_f32_16x16x32_bf16 v[36:39], v[56:59], v[124:127], v[36:39]
    v_mfma_f32_16x16x32_bf16 v[32:35], v[56:59], v[120:123], v[32:35]
    ds_read2_b32 v[54:55], v157 offset0:2 offset1:3
    v_mfma_f32_16x16x32_bf16 v[28:31], v[56:59], v[116:119], v[28:31]
    v_mfma_f32_16x16x32_bf16 v[24:27], v[56:59], v[112:115], v[24:27]
    ds_read_b128 v[88:91], v158 offset:1024
    v_mfma_f32_16x16x32_bf16 v[44:47], v[60:63], v[128:131], v[44:47]
    v_mfma_f32_16x16x32_bf16 v[40:43], v[60:63], v[124:127], v[40:43]
    s_waitcnt lgkmcnt(12)
    ds_read2_b32 v[56:57], v156 offset0:128 offset1:129
    v_mfma_f32_16x16x32_bf16 v[36:39], v[60:63], v[120:123], v[36:39]
    v_mfma_f32_16x16x32_bf16 v[32:35], v[60:63], v[116:119], v[32:35]
    ds_read2_b32 v[58:59], v156 offset0:130 offset1:131
    v_mfma_f32_16x16x32_bf16 v[28:31], v[60:63], v[112:115], v[28:31]
    v_mfma_f32_16x16x32_bf16 v[44:47], v[64:67], v[124:127], v[44:47]
    v_mfma_f32_16x16x32_bf16 v[40:43], v[64:67], v[120:123], v[40:43]
    s_waitcnt lgkmcnt(12)
    ds_read2_b32 v[60:61], v156 offset0:0 offset1:1
    v_mfma_f32_16x16x32_bf16 v[36:39], v[64:67], v[116:119], v[36:39]
    v_mfma_f32_16x16x32_bf16 v[32:35], v[64:67], v[112:115], v[32:35]
    ds_read2_b32 v[62:63], v156 offset0:2 offset1:3
    v_mfma_f32_16x16x32_bf16 v[44:47], v[68:71], v[120:123], v[44:47]
    v_mfma_f32_16x16x32_bf16 v[40:43], v[68:71], v[116:119], v[40:43]
    s_waitcnt lgkmcnt(12)
    ds_read2_b32 v[64:65], v155 offset0:128 offset1:129
    v_mfma_f32_16x16x32_bf16 v[36:39], v[68:71], v[112:115], v[36:39]
    ds_read2_b32 v[68:69], v155 offset0:0 offset1:1
    s_waitcnt lgkmcnt(12)
    ds_read2_b32 v[70:71], v155 offset0:2 offset1:3
    ds_read2_b32 v[66:67], v155 offset0:130 offset1:131
    s_waitcnt lgkmcnt(12)
    ds_read_b128 v[84:87], v158 offset:512
    ds_read_b128 v[80:83], v158 offset:0
    v_mfma_f32_16x16x32_bf16 v[44:47], v[72:75], v[116:119], v[44:47]
    v_mfma_f32_16x16x32_bf16 v[40:43], v[72:75], v[112:115], v[40:43]
    s_waitcnt lgkmcnt(12)
    ds_read2_b32 v[72:73], v154 offset0:128 offset1:129
    ds_read2_b32 v[74:75], v154 offset0:130 offset1:131
    v_mfma_f32_16x16x32_bf16 v[44:47], v[76:79], v[112:115], v[44:47]
    s_waitcnt lgkmcnt(12)
    ds_read2_b32 v[76:77], v154 offset0:0 offset1:1
    ds_read2_b32 v[78:79], v154 offset0:2 offset1:3
    s_sub_u32 s44, s44, 1
    s_cmp_lg_u32 s44, 1
    s_cbranch_scc1 L_cloop
    s_mov_b32 s100, 0
Lw_72:
    ds_read_b32 v4, v162 offset:284
    s_waitcnt lgkmcnt(0)
    v_readfirstlane_b32 s99, v4
    s_cmp_ge_u32 s99, 1
    s_cbranch_scc1 Lwd_73
    s_add_u32 s100, s100, 1
    s_cmp_lt_u32 s100, 1048576
    s_cbranch_scc1 Lw_72
Lwd_73:
    ds_read_b128 v[144:147], v161 offset:2048
    ds_read_b128 v[148:151], v161 offset:3072
    s_waitcnt lgkmcnt(1)
    v_mfma_f32_16x16x16_bf16 v[32:35], v[164:165], v[144:145], v[32:35]
    v_mfma_f32_16x16x16_bf16 v[36:39], v[164:165], v[146:147], v[36:39]
    s_waitcnt lgkmcnt(0)
    v_mfma_f32_16x16x16_bf16 v[40:43], v[164:165], v[148:149], v[40:43]
    v_mfma_f32_16x16x16_bf16 v[44:47], v[164:165], v[150:151], v[44:47]
    s_branch L_cloop
L_pada16:
    s_branch L_warmed_a
L_cexit:
    s_setprio 3
    s_waitcnt lgkmcnt(0)
    v_mfma_f32_16x16x32_bf16 v[16:19], v[48:51], v[112:115], v[16:19]
    v_mfma_f32_16x16x32_bf16 v[20:23], v[48:51], v[116:119], v[20:23]
    v_mfma_f32_16x16x32_bf16 v[20:23], v[52:55], v[112:115], v[20:23]
    v_mfma_f32_16x16x32_bf16 v[24:27], v[48:51], v[120:123], v[24:27]
    v_mfma_f32_16x16x32_bf16 v[24:27], v[52:55], v[116:119], v[24:27]
    v_mfma_f32_16x16x32_bf16 v[24:27], v[56:59], v[112:115], v[24:27]
    v_mfma_f32_16x16x32_bf16 v[28:31], v[48:51], v[124:127], v[28:31]
    v_mfma_f32_16x16x32_bf16 v[28:31], v[52:55], v[120:123], v[28:31]
    v_mfma_f32_16x16x32_bf16 v[28:31], v[56:59], v[116:119], v[28:31]
    v_mfma_f32_16x16x32_bf16 v[28:31], v[60:63], v[112:115], v[28:31]
    s_nop 3
    v_cvt_pk_bf16_f32 v84, v24, v25
    v_cvt_pk_bf16_f32 v85, v26, v27
    s_nop 1
    v_cvt_pk_bf16_f32 v86, v28, v29
    v_cvt_pk_bf16_f32 v87, v30, v31
    s_nop 0
    v_permlane16_swap_b32 v84, v86
    v_permlane16_swap_b32 v85, v87
    global_store_dwordx4 v153, v[84:87], s[28:29] offset:1024 sc1
    v_cvt_pk_bf16_f32 v88, v32, v33
    v_cvt_pk_bf16_f32 v89, v34, v35
    v_cvt_pk_bf16_f32 v90, v36, v37
    v_cvt_pk_bf16_f32 v91, v38, v39
    s_nop 0
    v_permlane16_swap_b32 v88, v90
    v_permlane16_swap_b32 v89, v91
    global_store_dwordx4 v153, v[88:91], s[28:29] offset:2048 sc1
    v_cvt_pk_bf16_f32 v80, v16, v17
    v_cvt_pk_bf16_f32 v81, v18, v19
    v_cvt_pk_bf16_f32 v82, v20, v21
    v_cvt_pk_bf16_f32 v83, v22, v23
    s_nop 0
    v_permlane16_swap_b32 v80, v82
    v_permlane16_swap_b32 v81, v83
    global_store_dwordx4 v153, v[80:83], s[28:29] offset:0 sc1
    v_cvt_pk_bf16_f32 v92, v40, v41
    v_cvt_pk_bf16_f32 v93, v42, v43
    v_cvt_pk_bf16_f32 v94, v44, v45
    v_cvt_pk_bf16_f32 v95, v46, v47
    s_nop 0
    v_permlane16_swap_b32 v92, v94
    v_permlane16_swap_b32 v93, v95
    global_store_dwordx4 v153, v[92:95], s[28:29] offset:3072 sc1
    v_add_u32 v96, v80, v81
    v_add_u32 v97, v84, v85
    v_add_u32 v98, v88, v89
    v_add_u32 v99, v92, v93
    v_add3_u32 v96, v96, v82, v83
    v_add3_u32 v97, v97, v86, v87
    v_add3_u32 v98, v98, v90, v91
    v_add3_u32 v99, v99, v94, v95
    v_permlane32_swap_b32 v96, v97
    s_nop 0
    v_permlane32_swap_b32 v98, v99
    v_add_u32 v96, v96, v97
    v_add_u32 v98, v98, v99
    s_nop 0
    v_add_u32_dpp v96, v96, v96 quad_perm:[1,0,3,2] row_mask:0xf bank_mask:0xf
    v_add_u32_dpp v98, v98, v98 quad_perm:[1,0,3,2] row_mask:0xf bank_mask:0xf
    s_nop 0
    v_add_u32_dpp v96, v96, v96 quad_perm:[2,3,0,1] row_mask:0xf bank_mask:0xf
    v_add_u32_dpp v98, v98, v98 quad_perm:[2,3,0,1] row_mask:0xf bank_mask:0xf
    s_mov_b32 exec_lo, 0x22222222
    s_mov_b32 exec_hi, 0x22222222
    v_mov_b32 v96, v98
    s_mov_b32 exec_lo, 0x33333333
    s_mov_b32 exec_hi, 0x33333333
    ds_add_u32 v159, v96
    v_mov_b32 v4, 1
    s_mov_b64 exec, 1
    ds_add_u32 v3, v4 offset:196
    ds_add_rtn_u32 v4, v3, v4 offset:252
    s_mov_b64 exec, -1
    v_lshlrev_b32 v5, 2, v0
    v_add_u32 v5, 161792, v5
    ds_read_b32 v30, v5
    v_mov_b32 v31, 0x100
    s_waitcnt lgkmcnt(0)
    v_readfirstlane_b32 s98, v4
    s_add_u32 s98, s98, 1
    s_cmp_lg_u32 s98, s64
    s_cbranch_scc1 L_ynf
    s_mov_b64 exec, 0xffffffff
    s_mov_b32 s100, 0
    s_and_b32 s60, s33, 0xffffff00
L_ca:
    global_atomic_add_x2 v[28:29], v160, v[30:31], s[28:29] sc0 sc1
    s_waitcnt vmcnt(0)
    v_subrev_u32 v28, s60, v29
    v_cmp_le_u32 vcc, 0x600, v28
    s_cbranch_vccz L_cad
    s_mov_b64 exec, vcc
    s_sleep 8
    s_add_u32 s100, s100, 1
    s_cmp_lt_u32 s100, 1048576
    s_cbranch_scc1 L_ca
L_cad:
    s_mov_b64 exec, -1
L_ynf:
    s_branch L_cjoin
L_pada17:
    s_branch L_warmed_a
L_hloop:
    v_add_u32 v154, 8320, v154
    v_add_u32 v155, 8320, v155
    v_add_u32 v156, 8320, v156
    v_add_u32 v157, 8320, v157
    v_add_u32 v158, 4608, v158
    s_waitcnt lgkmcnt(15)
    v_mfma_f32_16x16x32_bf16 v[44:47], v[48:51], v[108:111], 0
    v_mfma_f32_16x16x32_bf16 v[40:43], v[48:51], v[104:107], 0
    s_waitcnt lgkmcnt(12)
    ds_read_b128 v[140:143], v158 offset:3584
    v_mfma_f32_16x16x32_bf16 v[36:39], v[48:51], v[100:103], 0
    s_waitcnt lgkmcnt(12)
    v_mfma_f32_16x16x32_bf16 v[32:35], v[48:51], v[96:99], 0
    ds_read_b128 v[136:139], v158 offset:3072
    v_mfma_f32_16x16x32_bf16 v[44:47], v[52:55], v[104:107], v[44:47]
    v_mfma_f32_16x16x32_bf16 v[40:43], v[52:55], v[100:103], v[40:43]
    ds_read2_b32 v[48:49], v157 offset0:128 offset1:129
    v_mfma_f32_16x16x32_bf16 v[36:39], v[52:55], v[96:99], v[36:39]
    s_waitcnt lgkmcnt(13)
    v_mfma_f32_16x16x32_bf16 v[32:35], v[52:55], v[92:95], v[32:35]
    ds_read2_b32 v[50:51], v157 offset0:130 offset1:131
    v_mfma_f32_16x16x32_bf16 v[44:47], v[56:59], v[100:103], v[44:47]
    v_mfma_f32_16x16x32_bf16 v[40:43], v[56:59], v[96:99], v[40:43]
    s_waitcnt lgkmcnt(12)
    ds_read2_b32 v[52:53], v157 offset0:0 offset1:1
    v_mfma_f32_16x16x32_bf16 v[36:39], v[56:59], v[92:95], v[36:39]
    v_mfma_f32_16x16x32_bf16 v[32:35], v[56:59], v[88:91], v[32:35]
    ds_read2_b32 v[54:55], v157 offset0:2 offset1:3
    v_mfma_f32_16x16x32_bf16 v[44:47], v[60:63], v[96:99], v[44:47]
    v_mfma_f32_16x16x32_bf16 v[40:43], v[60:63], v[92:95], v[40:43]
    s_waitcnt lgkmcnt(12)
    ds_read2_b32 v[56:57], v156 offset0:128 offset1:129
    v_mfma_f32_16x16x32_bf16 v[36:39], v[60:63], v[88:91], v[36:39]
    v_mfma_f32_16x16x32_bf16 v[32:35], v[60:63], v[84:87], v[32:35]
    ds_read2_b32 v[58:59], v156 offset0:130 offset1:131
    v_mfma_f32_16x16x32_bf16 v[44:47], v[64:67], v[92:95], v[44:47]
    v_mfma_f32_16x16x32_bf16 v[40:43], v[64:67], v[88:91], v[40:43]
    s_waitcnt lgkmcnt(12)
    ds_read2_b32 v[60:61], v156 offset0:0 offset1:1
    v_mfma_f32_16x16x32_bf16 v[36:39], v[64:67], v[84:87], v[36:39]
    v_mfma_f32_16x16x32_bf16 v[32:35], v[64:67], v[80:83], v[32:35]
    ds_read2_b32 v[62:63], v156 offset0:2 offset1:3
    v_mfma_f32_16x16x32_bf16 v[44:47], v[68:71], v[88:91], v[44:47]
    v_mfma_f32_16x16x32_bf16 v[40:43], v[68:71], v[84:87], v[40:43]
    s_waitcnt lgkmcnt(12)
    ds_read2_b32 v[64:65], v155 offset0:128 offset1:129
    v_mfma_f32_16x16x32_bf16 v[36:39], v[68:71], v[80:83], v[36:39]
    ds_read2_b32 v[68:69], v155 offset0:0 offset1:1
    s_waitcnt lgkmcnt(12)
    ds_read2_b32 v[70:71], v155 offset0:2 offset1:3
    ds_read2_b32 v[66:67], v155 offset0:130 offset1:131
    s_waitcnt lgkmcnt(12)
    ds_read_b128 v[132:135], v158 offset:2560
    ds_read_b128 v[128:131], v158 offset:2048
    s_waitcnt lgkmcnt(12)
    ds_read_b128 v[124:127], v158 offset:1536
    ds_read_b128 v[120:123], v158 offset:1024
    s_waitcnt lgkmcnt(12)
    ds_read_b128 v[116:119], v158 offset:512
    ds_read_b128 v[112:115], v158 offset:0
    v_mfma_f32_16x16x32_bf16 v[44:47], v[72:75], v[84:87], v[44:47]
    v_mfma_f32_16x16x32_bf16 v[40:43], v[72:75], v[80:83], v[40:43]
    s_waitcnt lgkmcnt(12)
    ds_read2_b32 v[72:73], v154 offset0:128 offset1:129
    ds_read2_b32 v[74:75], v154 offset0:130 offset1:131
    v_mfma_f32_16x16x32_bf16 v[44:47], v[76:79], v[80:83], v[44:47]
    s_waitcnt lgkmcnt(12)
    ds_read2_b32 v[76:77], v154 offset0:0 offset1:1
    ds_read2_b32 v[78:79], v154 offset0:2 offset1:3
    v_cvt_pk_bf16_f32 v8, v32, v33
    v_cvt_pk_bf16_f32 v9, v34, v35
    v_cvt_pk_bf16_f32 v10, v36, v37
    v_cvt_pk_bf16_f32 v11, v38, v39
    s_waitcnt lgkmcnt(12)
    ds_write_b128 v161, v[8:11] offset:2048
    v_cvt_pk_bf16_f32 v12, v40, v41
    v_cvt_pk_bf16_f32 v13, v42, v43
    v_cvt_pk_bf16_f32 v14, v44, v45
    v_cvt_pk_bf16_f32 v15, v46, v47
    ds_write_b128 v161, v[12:15] offset:3072
    s_waitcnt lgkmcnt(12)
    ds_write_b32 v162, v5 offset:284
    v_add_u32 v161, 2048, v161
    v_add_u32 v162, 4, v162
    s_sub_u32 s44, s44, 1
    s_cmp_eq_u32 s44, 0
    s_cbranch_scc1 L_hexit
    v_add_u32 v154, 8320, v154
    v_add_u32 v155, 8320, v155
    v_add_u32 v156, 8320, v156
    v_add_u32 v157, 8320, v157
    v_add_u32 v158, 4608, v158
    v_mfma_f32_16x16x32_bf16 v[44:47], v[48:51], v[140:143], 0
    v_mfma_f32_16x16x32_bf16 v[40:43], v[48:51], v[136:139], 0
    ds_read_b128 v[108:111], v158 offset:3584
    s_waitcnt lgkmcnt(13)
    v_mfma_f32_16x16x32_bf16 v[36:39], v[48:51], v[132:135], 0
    s_waitcnt lgkmcnt(12)
    v_mfma_f32_16x16x32_bf16 v[32:35], v[48:51], v[128:131], 0
    ds_read_b128 v[104:107], v158 offset:3072
    v_mfma_f32_16x16x32_bf16 v[44:47], v[52:55], v[136:139], v[44:47]
    v_mfma_f32_16x16x32_bf16 v[40:43], v[52:55], v[132:135], v[40:43]
    ds_read2_b32 v[48:49], v157 offset0:128 offset1:129
    v_mfma_f32_16x16x32_bf16 v[36:39], v[52:55], v[128:131], v[36:39]
    s_waitcnt lgkmcnt(13)
    v_mfma_f32_16x16x32_bf16 v[32:35], v[52:55], v[124:127], v[32:35]
    ds_read2_b32 v[50:51], v157 offset0:130 offset1:131
    v_mfma_f32_16x16x32_bf16 v[44:47], v[56:59], v[132:135], v[44:47]
    v_mfma_f32_16x16x32_bf16 v[40:43], v[56:59], v[128:131], v[40:43]
    s_waitcnt lgkmcnt(12)
    ds_read2_b32 v[52:53], v157 offset0:0 offset1:1
    v_mfma_f32_16x16x32_bf16 v[36:39], v[56:59], v[124:127], v[36:39]
    v_mfma_f32_16x16x32_bf16 v[32:35], v[56:59], v[120:123], v[32:35]
    ds_read2_b32 v[54:55], v157 offset0:2 offset1:3
    v_mfma_f32_16x16x32_bf16 v[44:47], v[60:63], v[128:131], v[44:47]
    v_mfma_f32_16x16x32_bf16 v[40:43], v[60:63], v[124:127], v[40:43]
    s_waitcnt lgkmcnt(12)
    ds_read2_b32 v[56:57], v156 offset0:128 offset1:129
    v_mfma_f32_16x16x32_bf16 v[36:39], v[60:63], v[120:123], v[36:39]
    v_mfma_f32_16x16x32_bf16 v[32:35], v[60:63], v[116:119], v[32:35]
    ds_read2_b32 v[58:59], v156 offset0:130 offset1:131
    v_mfma_f32_16x16x32_bf16 v[44:47], v[64:67], v[124:127], v[44:47]
    v_mfma_f32_16x16x32_bf16 v[40:43], v[64:67], v[120:123], v[40:43]
    s_waitcnt lgkmcnt(12)
    ds_read2_b32 v[60:61], v156 offset0:0 offset1:1
    v_mfma_f32_16x16x32_bf16 v[36:39], v[64:67], v[116:119], v[36:39]
    v_mfma_f32_16x16x32_bf16 v[32:35], v[64:67], v[112:115], v[32:35]
    ds_read2_b32 v[62:63], v156 offset0:2 offset1:3
    v_mfma_f32_16x16x32_bf16 v[44:47], v[68:71], v[120:123], v[44:47]
    v_mfma_f32_16x16x32_bf16 v[40:43], v[68:71], v[116:119], v[40:43]
    s_waitcnt lgkmcnt(12)
    ds_read2_b32 v[64:65], v155 offset0:128 offset1:129
    v_mfma_f32_16x16x32_bf16 v[36:39], v[68:71], v[112:115], v[36:39]
    ds_read2_b32 v[68:69], v155 offset0:0 offset1:1
    s_waitcnt lgkmcnt(12)
    ds_read2_b32 v[70:71], v155 offset0:2 offset1:3
    ds_read2_b32 v[66:67], v155 offset0:130 offset1:131
    s_waitcnt lgkmcnt(12)
    ds_read_b128 v[100:103], v158 offset:2560
    ds_read_b128 v[96:99], v158 offset:2048
    s_waitcnt lgkmcnt(12)
    ds_read_b128 v[92:95], v158 offset:1536
    ds_read_b128 v[88:91], v158 offset:1024
    s_waitcnt lgkmcnt(12)
    ds_read_b128 v[84:87], v158 offset:512
    ds_read_b128 v[80:83], v158 offset:0
    v_mfma_f32_16x16x32_bf16 v[44:47], v[72:75], v[116:119], v[44:47]
    v_mfma_f32_16x16x32_bf16 v[40:43], v[72:75], v[112:115], v[40:43]
    s_waitcnt lgkmcnt(12)
    ds_read2_b32 v[72:73], v154 offset0:128 offset1:129
    ds_read2_b32 v[74:75], v154 offset0:130 offset1:131
    v_mfma_f32_16x16x32_bf16 v[44:47], v[76:79], v[112:115], v[44:47]
    s_waitcnt lgkmcnt(12)
    ds_read2_b32 v[76:77], v154 offset0:0 offset1:1
    ds_read2_b32 v[78:79], v154 offset0:2 offset1:3
    v_cvt_pk_bf16_f32 v8, v32, v33
    v_cvt_pk_bf16_f32 v9, v34, v35
    v_cvt_pk_bf16_f32 v10, v36, v37
    v_cvt_pk_bf16_f32 v11, v38, v39
    s_waitcnt lgkmcnt(12)
    ds_write_b128 v161, v[8:11] offset:2048
    v_cvt_pk_bf16_f32 v12, v40, v41
    v_cvt_pk_bf16_f32 v13, v42, v43
    v_cvt_pk_bf16_f32 v14, v44, v45
    v_cvt_pk_bf16_f32 v15, v46, v47
    ds_write_b128 v161, v[12:15] offset:3072
    s_waitcnt lgkmcnt(12)
    ds_write_b32 v162, v5 offset:284
    v_add_u32 v161, 2048, v161
    v_add_u32 v162, 4, v162
    s_sub_u32 s44, s44, 1
    s_cmp_eq_u32 s44, 0
    s_cbranch_scc0 L_hloop
    s_branch L_skip4525
L_pada18:
    s_branch L_warmed_a
L_skip4525:
L_hexit:
L_cdone:
    s_waitcnt lgkmcnt(0)
    v_mov_b32 v4, 1
    s_mov_b64 exec, 1
    ds_add_u32 v3, v4 offset:196
    s_mov_b64 exec, -1
    s_setprio 0
    s_mov_b32 s100, 0
Lw_74:
    ds_read_b32 v4, v3 offset:196
    s_waitcnt lgkmcnt(0)
    v_readfirstlane_b32 s99, v4
    s_cmp_ge_u32 s99, 4
    s_cbranch_scc1 Lwd_75
    s_sleep 6
    s_add_u32 s100, s100, 1
    s_cmp_lt_u32 s100, 1048576
    s_cbranch_scc1 Lw_74
Lwd_75:
L_cjoin:
    s_setprio 2
    s_mov_b32 s100, 0
Lw_76:
    ds_read_b32 v4, v3 offset:192
    s_waitcnt lgkmcnt(0)
    v_readfirstlane_b32 s99, v4
    s_cmp_ge_u32 s99, 1
    s_cbranch_scc1 Lwd_77
    s_add_u32 s100, s100, 1
    s_cmp_lt_u32 s100, 1048576
    s_cbranch_scc1 Lw_76
Lwd_77:
    s_mov_b32 s91, s99
    s_cmp_eq_u32 s91, 1
    s_cselect_b32 s99, 0, 15728640
    s_add_u32 s16, s28, s99
    s_addc_u32 s17, s29, 0
    v_lshl_add_u32 v138, v0, 4, s80
    v_lshl_add_u32 v139, v0, 4, s82
    v_lshl_add_u32 v166, v0, 2, s83
    s_branch L_tail
L_end:
    s_endpgm
L_codeend:
.section .rodata,"a"
.p2align 6
.amdhsa_kernel gated_mix__ssm_conv_h3__sliding_local_dilated__prompt_kernel
  .amdhsa_next_free_vgpr 168
  .amdhsa_next_free_sgpr 102
  .amdhsa_accum_offset 168
  .amdhsa_group_segment_fixed_size 0
  .amdhsa_kernarg_size 104
  .amdhsa_user_sgpr_count 2
  .amdhsa_user_sgpr_kernarg_segment_ptr 1
  .amdhsa_system_sgpr_workgroup_id_x 1
.end_amdhsa_kernel
```

```asm
; @launch grid=(256,1,1) block=(768,1,1) lds=163840
.amdgcn_target "amdgcn-amd-amdhsa--gfx950"
.text
.globl gated_mix__ssm_conv_h3__sliding_local_dilated__prompt_kernel
.p2align 8
.type gated_mix__ssm_conv_h3__sliding_local_dilated__prompt_kernel,@function
gated_mix__ssm_conv_h3__sliding_local_dilated__prompt_kernel:
L_entry:
    s_load_dwordx16 s[4:19], s[0:1], 0
    s_load_dwordx8 s[20:27], s[0:1], 64
    s_load_dwordx2 s[28:29], s[0:1], 96
    s_cmp_ge_u32 s2, 256
    s_cbranch_scc1 L_end
    v_lshrrev_b32 v4, 6, v0
    v_and_b32 v0, 63, v0
    v_readfirstlane_b32 s32, v4
    s_getpc_b64 s[46:47]
L_pc:
    s_lshr_b32 s31, s2, 3
    s_mul_i32 s96, s31, 896
    s_cmp_lg_u32 s32, 2
    s_cbranch_scc1 L_nopf
    v_lshl_add_u32 v4, v0, 7, s96
    v_min_u32 v4, L_codeend-L_pc-4, v4
    s_mov_b64 exec, 0x7f
    global_load_dword v20, v4, s[46:47]
    s_mov_b64 exec, -1
L_nopf:
    v_mov_b32 v3, 160768
    v_lshl_add_u32 v5, v0, 3, v3
    v_mov_b32 v6, 0
    v_mov_b32 v7, 0
    ds_write_b64 v5, v[6:7]
    v_lshrrev_b32 v2, 4, v0
    v_and_b32 v1, 15, v0
    s_and_b32 s30, s2, 7
    s_and_b32 s36, s31, 7
    s_lshr_b32 s35, s31, 3
    s_lshl2_add_u32 s35, s30, s35
    s_cmp_ge_u32 s31, 20
    s_cselect_b32 s34, 1, 0
    s_cselect_b32 s96, 20, 0
    s_cselect_b32 s97, 5, 10
    s_sub_u32 s38, s31, s96
    s_cmp_ge_u32 s38, s97
    s_cselect_b32 s97, s97, 0
    s_cselect_b32 s96, 1, 0
    s_sub_u32 s38, s38, s97
    s_lshl1_add_u32 s37, s30, s96
    s_mul_i32 s39, s37, 163840
    s_setprio 3
    s_cmp_lt_u32 s32, 4
    s_cbranch_scc1 L_service
    s_cmp_lg_u32 s34, 0
    s_cbranch_scc1 L_awave
    s_branch L_compute
L_padb0:
    s_branch L_padb8
L_service:
    s_cmp_lg_u32 s34, 0
    s_cbranch_scc1 L_aserv
    s_setprio 3
    v_lshrrev_b32 v4, 3, v0
    v_and_b32 v5, 7, v0
    s_add_u32 s65, s30, s38
    s_mul_i32 s96, s65, 52
    s_lshr_b32 s96, s96, 8
    s_mul_i32 s96, s96, 5
    s_sub_u32 s65, s65, s96
    s_mul_i32 s65, s65, 512
    s_lshr_b32 s65, s65, 8
    s_mov_b32 s76, 0x76543210
    s_mov_b32 s77, 0x98
    s_bitcmp1_b32 s38, 0
    s_cselect_b32 s76, 0x76543210, s76
    s_cselect_b32 s77, 0x98, s77
    s_bitcmp0_b32 s37, 0
    s_cselect_b32 s76, 0x76543210, s76
    s_cselect_b32 s77, 0x98, s77
    s_mov_b64 s[78:79], s[76:77]
    s_and_b32 s67, s76, 15
    s_lshr_b64 s[76:77], s[76:77], 4
    s_add_u32 s67, s67, s65
    s_sub_u32 s99, s67, 10
    s_cselect_b32 s67, s67, s99
    s_and_b32 s96, s32, 1
    s_cmp_ge_u32 s32, 2
    s_cbranch_scc1 L_lw
    v_mul_u32_u24 v6, 1280, v4
    v_xor_b32 v7, v5, v2
    v_lshl_add_u32 v13, v7, 4, v6
    s_lshl_b32 s97, s96, 6
    v_xor_b32 v13, s97, v13
    v_xor_b32 v14, 64, v13
    s_sub_u32 s52, s39, 20480
    s_cmp_eq_u32 s37, 0
    s_cselect_b32 s52, 0, s52
    s_add_u32 s97, s39, 71680
    s_add_u32 s98, s39, 92160
    s_cmp_eq_u32 s96, 0
    s_cselect_b32 s52, s52, s97
    s_cselect_b32 s53, s39, s98
    s_mul_i32 s54, s96, 9216
    s_add_u32 s54, s54, 86016
    s_waitcnt lgkmcnt(0)
    s_mov_b32 s40, s4
    s_and_b32 s41, s5, 0xffff
    s_mov_b32 s42, 2621440
    s_mov_b32 s43, 0x00020000
    s_load_dword s33, s[28:29], 0
    s_cmp_lg_u32 s32, 0
    s_cbranch_scc1 L_nogw
    s_mov_b32 s48, s22
    s_and_b32 s49, s23, 0xffff
    s_mov_b32 s50, 1280
    s_mov_b32 s51, 0x00020000
    v_lshlrev_b32 v4, 4, v0
    s_mov_b32 m0, 162048
    s_nop 0
    buffer_load_dwordx4 v4, s[48:51], 0 offen lds
    s_mov_b64 exec, 0xffff
    buffer_load_dwordx4 v4, s[48:51], 0 offen offset:1024 lds
    s_mov_b64 exec, -1
L_nogw:
    s_mov_b32 m0, s54
    s_lshl_b32 s67, s67, 7
    s_add_u32 s59, s52, s67
    buffer_load_dwordx4 v13, s[40:43], s59 offen lds
    s_add_u32 m0, m0, 1024
    s_add_u32 s59, s59, 10240
    buffer_load_dwordx4 v14, s[40:43], s59 offen lds
    s_add_u32 m0, m0, 1024
    s_add_u32 s59, s53, s67
    buffer_load_dwordx4 v13, s[40:43], s59 offen lds
    s_add_u32 m0, m0, 1024
    s_add_u32 s59, s59, 10240
    buffer_load_dwordx4 v14, s[40:43], s59 offen lds
    s_add_u32 m0, m0, 1024
    s_add_u32 s59, s59, 10240
    buffer_load_dwordx4 v13, s[40:43], s59 offen lds
    s_add_u32 m0, m0, 1024
    s_add_u32 s59, s59, 10240
    buffer_load_dwordx4 v14, s[40:43], s59 offen lds
    s_add_u32 m0, m0, 1024
    s_add_u32 s59, s59, 10240
    buffer_load_dwordx4 v13, s[40:43], s59 offen lds
    s_add_u32 m0, m0, 1024
    s_add_u32 s59, s59, 10240
    buffer_load_dwordx4 v14, s[40:43], s59 offen lds
    s_add_u32 m0, m0, 1024
    s_add_u32 s59, s59, 10240
    buffer_load_dwordx4 v13, s[40:43], s59 offen lds
    s_and_b32 s67, s76, 15
    s_lshr_b64 s[76:77], s[76:77], 4
    s_add_u32 s67, s67, s65
    s_sub_u32 s99, s67, 10
    s_cselect_b32 s67, s67, s99
    s_add_u32 s62, s54, 43008
    s_sub_u32 s54, s54, 86016
    s_mov_b32 s61, s54
    s_mov_b32 s55, 1
    s_mul_i32 s96, s36, 102400
    s_add_u32 s96, s96, 9437184
    s_add_u32 s48, s28, s96
    s_addc_u32 s49, s29, 0
    s_and_b32 s49, s49, 0xffff
    s_mov_b32 s50, 102400
    s_mov_b32 s51, 0x00020000
    v_lshlrev_b32 v19, 4, v0
    s_lshl_b32 s66, s30, 5
    s_add_u32 s66, s66, s31
    s_lshl_b32 s66, s66, 8
    s_add_u32 s66, s66, 65536
    s_add_u32 s66, s66, 128
    v_lshrrev_b32 v5, 1, v1
    v_xor_b32 v5, v5, v2
    v_lshlrev_b32 v5, 4, v5
    v_lshl_add_u32 v5, v1, 7, v5
    s_lshl_b32 s97, s32, 6
    v_xor_b32 v5, s97, v5
    s_and_b32 s96, s38, 7
    s_lshl_b32 s96, s96, 11
    s_add_u32 s96, s96, 2048
    v_add_u32 v18, s96, v5
    s_add_u32 s97, s97, 162048
    v_lshl_add_u32 v17, v2, 4, s97
    s_mov_b32 s64, 86016
    v_mov_b64 v[20:21], 0
    v_mov_b64 v[22:23], 0
    v_mov_b64 v[24:25], 0
    v_mov_b64 v[26:27], 0
    v_mov_b64 v[28:29], 0
    v_mov_b64 v[30:31], 0
    s_lshl1_add_u32 s96, s35, s32
    s_mul_i32 s96, s96, 40960
    s_mul_i32 s97, s36, 160
    s_add_u32 s96, s96, s97
    v_add_u32 v4, 0, v0
    v_mul_u32_u24 v8, 6554, v4
    v_lshrrev_b32 v8, 16, v8
    v_mul_u32_u24 v8, 1120, v8
    v_lshl_add_u32 v4, v4, 4, s96
    v_add_u32 v8, v8, v4
    v_add_u32 v4, 64, v0
    v_mul_u32_u24 v9, 6554, v4
    v_lshrrev_b32 v9, 16, v9
    v_mul_u32_u24 v9, 1120, v9
    v_lshl_add_u32 v4, v4, 4, s96
    v_add_u32 v9, v9, v4
    v_add_u32 v4, 128, v0
    v_mul_u32_u24 v10, 6554, v4
    v_lshrrev_b32 v10, 16, v10
    v_mul_u32_u24 v10, 1120, v10
    v_lshl_add_u32 v4, v4, 4, s96
    v_add_u32 v10, v10, v4
    v_add_u32 v4, 192, v0
    v_mul_u32_u24 v11, 6554, v4
    v_lshrrev_b32 v11, 16, v11
    v_mul_u32_u24 v11, 1120, v11
    v_lshl_add_u32 v4, v4, 4, s96
    v_add_u32 v11, v11, v4
    s_branch L_skip212
L_padb1:
    s_branch L_padb9
L_skip212:
    v_add_u32 v4, 256, v0
    v_mul_u32_u24 v12, 6554, v4
    v_lshrrev_b32 v12, 16, v12
    v_mul_u32_u24 v12, 1120, v12
    v_lshl_add_u32 v4, v4, 4, s96
    v_add_u32 v12, v12, v4
    s_waitcnt lgkmcnt(0)
    s_mul_i32 s33, s33, 1664525
    s_add_u32 s33, s33, 1013904223
    s_branch L_ld_x_i
L_ld_x:
    s_and_b32 s68, s78, 15
    s_lshr_b64 s[78:79], s[78:79], 4
    s_add_u32 s68, s68, s65
    s_sub_u32 s99, s68, 10
    s_cselect_b32 s68, s68, s99
    s_lshl_b32 s68, s68, 7
    v_add_u32 v15, s64, v18
    v_add_u32 v16, s68, v17
    ds_read_b128 v[24:27], v15
    ds_read_b128 v[28:31], v16
    s_add_u32 s64, s64, 43008
    s_cmp_eq_u32 s64, 129024
    s_cselect_b32 s64, 0, s64
L_ld_x_i:
    s_mov_b32 m0, s54
    s_lshl_b32 s67, s67, 7
    s_add_u32 s59, s52, s67
    buffer_load_dwordx4 v13, s[40:43], s59 offen lds
    s_add_u32 m0, m0, 1024
    s_add_u32 s59, s59, 10240
    buffer_load_dwordx4 v14, s[40:43], s59 offen lds
    s_add_u32 m0, m0, 1024
    s_add_u32 s59, s53, s67
    buffer_load_dwordx4 v13, s[40:43], s59 offen lds
    s_add_u32 m0, m0, 1024
    s_add_u32 s59, s59, 10240
    buffer_load_dwordx4 v14, s[40:43], s59 offen lds
    s_add_u32 m0, m0, 1024
    s_add_u32 s59, s59, 10240
    buffer_load_dwordx4 v13, s[40:43], s59 offen lds
    s_add_u32 m0, m0, 1024
    s_add_u32 s59, s59, 10240
    s_waitcnt lgkmcnt(0)
    v_mfma_f32_16x16x32_bf16 v[20:23], v[28:31], v[24:27], v[20:23]
    s_cmp_lt_u32 s55, 9
    s_cbranch_scc1 Lmp_1
    s_load_dwordx4 s[88:91], s[28:29], s66 glc
Lmp_1:
    buffer_load_dwordx4 v14, s[40:43], s59 offen lds
    s_add_u32 m0, m0, 1024
    s_add_u32 s59, s59, 10240
    buffer_load_dwordx4 v13, s[40:43], s59 offen lds
    s_add_u32 m0, m0, 1024
    s_add_u32 s59, s59, 10240
    buffer_load_dwordx4 v14, s[40:43], s59 offen lds
    s_add_u32 m0, m0, 1024
    s_add_u32 s59, s59, 10240
    buffer_load_dwordx4 v13, s[40:43], s59 offen lds
    s_and_b32 s67, s76, 15
    s_lshr_b64 s[76:77], s[76:77], 4
    s_add_u32 s67, s67, s65
    s_sub_u32 s99, s67, 10
    s_cselect_b32 s67, s67, s99
    s_add_u32 s54, s54, 43008
    s_cmp_eq_u32 s54, s62
    s_cselect_b32 s54, s61, s54
    s_add_u32 s55, s55, 1
    s_mul_i32 s96, s55, s32
    s_cmp_eq_u32 s96, 2
    s_cbranch_scc1 L_pk0
    s_cmp_eq_u32 s96, 4
    s_cbranch_scc1 L_pk1
    s_cmp_eq_u32 s96, 6
    s_cbranch_scc1 L_pk2
    s_waitcnt vmcnt(9)
L_ld_x_b:
    s_barrier
    s_cmp_lt_u32 s55, 10
    s_cbranch_scc1 L_ld_x
    s_and_b32 s68, s78, 15
    s_lshr_b64 s[78:79], s[78:79], 4
    s_add_u32 s68, s68, s65
    s_sub_u32 s99, s68, 10
    s_cselect_b32 s68, s68, s99
    s_lshl_b32 s68, s68, 7
    v_add_u32 v15, s64, v18
    v_add_u32 v16, s68, v17
    ds_read_b128 v[24:27], v15
    ds_read_b128 v[28:31], v16
    s_add_u32 s64, s64, 43008
    s_cmp_eq_u32 s64, 129024
    s_cselect_b32 s64, 0, s64
    s_waitcnt lgkmcnt(0)
    v_mfma_f32_16x16x32_bf16 v[20:23], v[28:31], v[24:27], v[20:23]
    s_branch L_ld_end
L_padb2:
    s_branch L_padb10
L_pk0:
    s_mov_b32 s44, s20
    s_and_b32 s45, s21, 0xffff
    s_mov_b32 s46, 819200
    s_mov_b32 s47, 0x00020000
    s_sub_u32 s98, s38, 5
    s_cselect_b32 s98, s38, s98
    s_mov_b32 s97, 0xf900af56
    s_cmp_eq_u32 s98, 1
    s_cselect_b32 s97, 0xfe00ab55, s97
    s_cmp_eq_u32 s98, 2
    s_cselect_b32 s97, 0xff00aa55, s97
    s_cmp_eq_u32 s98, 3
    s_cselect_b32 s97, 0xff40aa15, s97
    s_cmp_eq_u32 s98, 4
    s_cselect_b32 s97, 0xff906a05, s97
    s_lshl_b32 s98, s37, 4
    s_lshr_b32 s97, s97, s98
    s_mul_i32 s96, s30, 160
    s_mul_i32 s59, s38, 81920
    s_mov_b32 m0, 129024
    v_add_u32 v4, 0, v0
    v_mul_u32_u24 v5, 6554, v4
    v_lshrrev_b32 v5, 16, v5
    v_mul_u32_u24 v6, 160, v5
    v_lshl_add_u32 v4, v4, 4, s96
    v_sub_u32 v4, v4, v6
    v_lshrrev_b32 v6, 2, v5
    v_lshlrev_b32 v6, 1, v6
    v_bfe_u32 v6, s97, v6, 2
    v_and_b32 v5, 15, v5
    v_lshl_add_u32 v5, v6, 4, v5
    v_mul_u32_u24 v5, 1280, v5
    v_add_u32 v4, v4, v5
    buffer_load_dwordx4 v4, s[44:47], s59 offen lds
    s_add_u32 m0, m0, 1024
    v_add_u32 v4, 64, v0
    v_mul_u32_u24 v5, 6554, v4
    v_lshrrev_b32 v5, 16, v5
    v_mul_u32_u24 v6, 160, v5
    v_lshl_add_u32 v4, v4, 4, s96
    v_sub_u32 v4, v4, v6
    v_lshrrev_b32 v6, 2, v5
    v_lshlrev_b32 v6, 1, v6
    v_bfe_u32 v6, s97, v6, 2
    v_and_b32 v5, 15, v5
    v_lshl_add_u32 v5, v6, 4, v5
    v_mul_u32_u24 v5, 1280, v5
    v_add_u32 v4, v4, v5
    buffer_load_dwordx4 v4, s[44:47], s59 offen lds
    s_add_u32 m0, m0, 1024
    v_add_u32 v4, 128, v0
    v_mul_u32_u24 v5, 6554, v4
    v_lshrrev_b32 v5, 16, v5
    v_mul_u32_u24 v6, 160, v5
    v_lshl_add_u32 v4, v4, 4, s96
    v_sub_u32 v4, v4, v6
    v_lshrrev_b32 v6, 2, v5
    v_lshlrev_b32 v6, 1, v6
    v_bfe_u32 v6, s97, v6, 2
    v_and_b32 v5, 15, v5
    v_lshl_add_u32 v5, v6, 4, v5
    v_mul_u32_u24 v5, 1280, v5
    v_add_u32 v4, v4, v5
    buffer_load_dwordx4 v4, s[44:47], s59 offen lds
    s_add_u32 m0, m0, 1024
    v_add_u32 v4, 192, v0
    v_mul_u32_u24 v5, 6554, v4
    v_lshrrev_b32 v5, 16, v5
    v_mul_u32_u24 v6, 160, v5
    v_lshl_add_u32 v4, v4, 4, s96
    v_sub_u32 v4, v4, v6
    v_lshrrev_b32 v6, 2, v5
    v_lshlrev_b32 v6, 1, v6
    v_bfe_u32 v6, s97, v6, 2
    v_and_b32 v5, 15, v5
    v_lshl_add_u32 v5, v6, 4, v5
    v_mul_u32_u24 v5, 1280, v5
    v_add_u32 v4, v4, v5
    buffer_load_dwordx4 v4, s[44:47], s59 offen lds
    s_add_u32 m0, m0, 1024
    v_add_u32 v4, 256, v0
    v_mul_u32_u24 v5, 6554, v4
    v_lshrrev_b32 v5, 16, v5
    v_mul_u32_u24 v6, 160, v5
    v_lshl_add_u32 v4, v4, 4, s96
    v_sub_u32 v4, v4, v6
    v_lshrrev_b32 v6, 2, v5
    v_lshlrev_b32 v6, 1, v6
    v_bfe_u32 v6, s97, v6, 2
    v_and_b32 v5, 15, v5
    v_lshl_add_u32 v5, v6, 4, v5
    v_mul_u32_u24 v5, 1280, v5
    v_add_u32 v4, v4, v5
    buffer_load_dwordx4 v4, s[44:47], s59 offen lds
    s_waitcnt vmcnt(14)
    s_branch L_ld_x_b
L_pk1:
    v_lshrrev_b32 v5, 2, v0
    v_mul_u32_u24 v5, 160, v5
    v_and_b32 v6, 3, v0
    v_lshl_add_u32 v5, v6, 3, v5
    v_add_u32 v5, 129024, v5
    ds_read_b64_tr_b16 v[40:41], v5 offset:0
    ds_read_b64_tr_b16 v[42:43], v5 offset:2560
    ds_read_b64_tr_b16 v[44:45], v5 offset:32
    ds_read_b64_tr_b16 v[46:47], v5 offset:2592
    ds_read_b64_tr_b16 v[48:49], v5 offset:64
    ds_read_b64_tr_b16 v[50:51], v5 offset:2624
    ds_read_b64_tr_b16 v[52:53], v5 offset:96
    ds_read_b64_tr_b16 v[54:55], v5 offset:2656
    ds_read_b64_tr_b16 v[56:57], v5 offset:128
    ds_read_b64_tr_b16 v[58:59], v5 offset:2688
    s_mul_i32 s96, s37, 51200
    s_mul_i32 s97, s38, 5120
    s_add_u32 s96, s96, s97
    s_add_u32 s96, s96, 9439232
    v_add_u32 v6, s96, v19
    s_waitcnt lgkmcnt(0)
    global_store_dwordx4 v6, v[40:43], s[28:29] offset:-2048 sc1
    global_store_dwordx4 v6, v[44:47], s[28:29] offset:-1024 sc1
    global_store_dwordx4 v6, v[48:51], s[28:29] offset:0 sc1
    global_store_dwordx4 v6, v[52:55], s[28:29] offset:1024 sc1
    global_store_dwordx4 v6, v[56:59], s[28:29] offset:2048 sc1
    s_waitcnt vmcnt(14)
    s_branch L_ld_x_b
L_padb3:
    s_branch L_padb11
L_pk2:
    s_lshl_b32 s96, s30, 5
    s_add_u32 s96, s96, s31
    s_lshl_b32 s96, s96, 8
    s_add_u32 s96, s96, 65536
    v_lshl_add_u32 v4, v0, 3, s96
    v_mov_b32 v6, 0
    s_and_b32 s97, s33, 0xffffff00
    v_mov_b32 v7, s97
    s_getreg_b32 s97, hwreg(HW_REG_XCC_ID, 0, 4)
    v_writelane_b32 v6, s33, 3
    v_writelane_b32 v7, s97, 3
    s_mov_b64 exec, 0xffff
    global_store_dwordx2 v4, v[6:7], s[28:29] sc1
    s_mov_b64 exec, -1
    s_lshl_b32 s96, s2, 7
    s_add_u32 s96, s96, 0x1F8000
    v_lshl_add_u32 v4, v0, 21, s96
    s_add_u32 s96, s96, 10518528
    v_writelane_b32 v4, s96, 6
    v_mov_b32 v5, 0
    s_mov_b64 exec, 0xde
    global_atomic_or v4, v5, s[28:29] sc1
    s_mul_i32 s96, s35, 81920
    s_mul_i32 s97, s36, 160
    s_add_u32 s96, s96, s97
    s_mov_b64 exec, 1
    v_mov_b32 v4, s96
    global_atomic_or v4, v5, s[24:25] sc1
    s_mov_b64 exec, -1
    s_waitcnt vmcnt(12)
    s_branch L_ld_x_b
L_lw:
    v_and_b32 v7, 2, v4
    v_xor_b32 v7, v7, v5
    v_mul_u32_u24 v6, 3840, v4
    v_lshl_add_u32 v13, v7, 4, v6
    s_lshl_b32 s97, s38, 7
    v_add_u32 v13, s97, v13
    v_xor_b32 v14, 64, v13
    s_mul_i32 s54, s96, 12288
    s_add_u32 s54, s54, 104448
    s_mul_i32 s52, s96, 122880
    s_waitcnt lgkmcnt(0)
    s_mov_b32 s44, s18
    s_and_b32 s45, s19, 0xffff
    s_mov_b32 s46, 2457600
    s_mov_b32 s47, 0x00020000
    s_load_dword s33, s[28:29], 0
    s_mov_b32 m0, s54
    s_mul_i32 s59, s67, 245760
    s_add_u32 s59, s59, s52
    buffer_load_dwordx4 v13, s[44:47], s59 offen lds
    s_add_u32 m0, m0, 1024
    s_add_u32 s59, s59, 1280
    buffer_load_dwordx4 v13, s[44:47], s59 offen lds
    s_add_u32 m0, m0, 1024
    s_add_u32 s59, s59, 1280
    buffer_load_dwordx4 v13, s[44:47], s59 offen lds
    s_add_u32 m0, m0, 1024
    s_add_u32 s59, s59, 28160
    buffer_load_dwordx4 v14, s[44:47], s59 offen lds
    s_add_u32 m0, m0, 1024
    s_add_u32 s59, s59, 1280
    buffer_load_dwordx4 v14, s[44:47], s59 offen lds
    s_add_u32 m0, m0, 1024
    s_add_u32 s59, s59, 1280
    buffer_load_dwordx4 v14, s[44:47], s59 offen lds
    s_add_u32 m0, m0, 1024
    s_add_u32 s59, s59, 28160
    buffer_load_dwordx4 v13, s[44:47], s59 offen lds
    s_add_u32 m0, m0, 1024
    s_add_u32 s59, s59, 1280
    buffer_load_dwordx4 v13, s[44:47], s59 offen lds
    s_add_u32 m0, m0, 1024
    s_add_u32 s59, s59, 1280
    buffer_load_dwordx4 v13, s[44:47], s59 offen lds
    s_add_u32 m0, m0, 1024
    s_add_u32 s59, s59, 28160
    buffer_load_dwordx4 v14, s[44:47], s59 offen lds
    s_add_u32 m0, m0, 1024
    s_add_u32 s59, s59, 1280
    buffer_load_dwordx4 v14, s[44:47], s59 offen lds
    s_add_u32 m0, m0, 1024
    s_add_u32 s59, s59, 1280
    buffer_load_dwordx4 v14, s[44:47], s59 offen lds
    s_and_b32 s67, s76, 15
    s_lshr_b64 s[76:77], s[76:77], 4
    s_add_u32 s67, s67, s65
    s_sub_u32 s99, s67, 10
    s_cselect_b32 s67, s67, s99
    s_add_u32 s62, s54, 43008
    s_sub_u32 s54, s54, 86016
    s_mov_b32 s61, s54
    s_mov_b32 s55, 1
    s_mul_i32 s96, s36, 102400
    s_add_u32 s96, s96, 9437184
    s_add_u32 s48, s28, s96
    s_addc_u32 s49, s29, 0
    s_and_b32 s49, s49, 0xffff
    s_mov_b32 s50, 102400
    s_mov_b32 s51, 0x00020000
    v_lshlrev_b32 v19, 4, v0
    s_lshl_b32 s66, s30, 5
    s_add_u32 s66, s66, s31
    s_lshl_b32 s66, s66, 8
    s_add_u32 s66, s66, 65536
    s_add_u32 s66, s66, 128
    v_mov_b32 v8, 0
    v_mov_b32 v9, 0
    v_mov_b32 v10, 0
    v_mov_b32 v11, 0
    v_mov_b32 v12, 0
    s_mov_b32 s40, s4
    s_and_b32 s41, s5, 0xffff
    s_mov_b32 s42, 2621440
    s_mov_b32 s43, 0x00020000
    s_waitcnt lgkmcnt(0)
    s_mul_i32 s33, s33, 1664525
    s_add_u32 s33, s33, 1013904223
L_ld_w:
    s_cmp_lt_u32 s55, 9
    s_cbranch_scc1 Lmp_2
    s_load_dwordx4 s[88:91], s[28:29], s66 glc
Lmp_2:
    s_mov_b32 m0, s54
    s_mul_i32 s59, s67, 245760
    s_add_u32 s59, s59, s52
    buffer_load_dwordx4 v13, s[44:47], s59 offen lds
    s_add_u32 m0, m0, 1024
    s_add_u32 s59, s59, 1280
    buffer_load_dwordx4 v13, s[44:47], s59 offen lds
    s_add_u32 m0, m0, 1024
    s_add_u32 s59, s59, 1280
    buffer_load_dwordx4 v13, s[44:47], s59 offen lds
    s_add_u32 m0, m0, 1024
    s_add_u32 s59, s59, 28160
    buffer_load_dwordx4 v14, s[44:47], s59 offen lds
    s_add_u32 m0, m0, 1024
    s_add_u32 s59, s59, 1280
    buffer_load_dwordx4 v14, s[44:47], s59 offen lds
    s_add_u32 m0, m0, 1024
    s_add_u32 s59, s59, 1280
    buffer_load_dwordx4 v14, s[44:47], s59 offen lds
    s_add_u32 m0, m0, 1024
    s_add_u32 s59, s59, 28160
    buffer_load_dwordx4 v13, s[44:47], s59 offen lds
    s_add_u32 m0, m0, 1024
    s_branch L_skip582
L_padb4:
    s_branch L_padb12
L_skip582:
    s_add_u32 s59, s59, 1280
    buffer_load_dwordx4 v13, s[44:47], s59 offen lds
    s_add_u32 m0, m0, 1024
    s_add_u32 s59, s59, 1280
    buffer_load_dwordx4 v13, s[44:47], s59 offen lds
    s_add_u32 m0, m0, 1024
    s_add_u32 s59, s59, 28160
    buffer_load_dwordx4 v14, s[44:47], s59 offen lds
    s_add_u32 m0, m0, 1024
    s_add_u32 s59, s59, 1280
    buffer_load_dwordx4 v14, s[44:47], s59 offen lds
    s_add_u32 m0, m0, 1024
    s_add_u32 s59, s59, 1280
    buffer_load_dwordx4 v14, s[44:47], s59 offen lds
    s_and_b32 s67, s76, 15
    s_lshr_b64 s[76:77], s[76:77], 4
    s_add_u32 s67, s67, s65
    s_sub_u32 s99, s67, 10
    s_cselect_b32 s67, s67, s99
    s_add_u32 s54, s54, 43008
    s_cmp_eq_u32 s54, s62
    s_cselect_b32 s54, s61, s54
    s_add_u32 s55, s55, 1
    s_waitcnt vmcnt(12)
L_ld_w_b:
    s_barrier
    s_cmp_lt_u32 s55, 10
    s_cbranch_scc1 L_ld_w
L_ld_end:
    s_waitcnt lgkmcnt(0)
    s_xor_b32 s96, s88, s33
    s_xor_b32 s97, s90, s33
    s_or_b32 s96, s96, s97
    s_cmp_eq_u32 s96, 0
    s_cbranch_scc1 L_wo_mk
    s_lshl_b32 s98, s30, 5
    s_add_u32 s98, s98, s31
    s_lshl_b32 s98, s98, 8
    s_add_u32 s98, s98, 65536
    s_add_u32 s98, s98, 128
    s_mov_b32 s100, 0
Lc_3:
    s_load_dwordx4 s[88:91], s[28:29], s98 glc
    s_waitcnt lgkmcnt(0)
    s_xor_b32 s96, s88, s33
    s_xor_b32 s97, s90, s33
    s_or_b32 s96, s96, s97
    s_cmp_eq_u32 s96, 0
    s_cbranch_scc1 Lcd_4
    s_sleep 2
    s_add_u32 s100, s100, 1
    s_cmp_lt_u32 s100, 1048576
    s_cbranch_scc1 Lc_3
    s_mov_b32 s91, 2
Lcd_4:
L_wo_mk:
    s_cmp_eq_u32 s91, 1
    s_cselect_b32 s99, 0, 15728640
    s_add_u32 s16, s28, s99
    s_addc_u32 s17, s29, 0
    s_cmp_lg_u32 s32, 2
    s_cbranch_scc1 L_wo_nc
    s_mov_b32 s44, s28
    s_and_b32 s45, s29, 0xffff
    s_mov_b32 s46, 1048576
    s_mov_b32 s47, 0x00020000
    v_lshlrev_b32 v4, 2, v0
    s_mov_b32 m0, 161152
    s_mov_b64 exec, 3
    s_add_u32 s66, s66, 8
    buffer_load_dword v4, s[44:47], s66 offen sc1 lds
    s_mov_b64 exec, -1
L_wo_nc:
    s_cmp_ge_u32 s32, 2
    s_cbranch_scc1 L_wo_a2
    s_mul_i32 m0, s32, 5120
    s_nop 0
    buffer_load_dwordx4 v8, s[40:43], 0 offen lds
    s_add_u32 m0, m0, 1024
    s_nop 0
    buffer_load_dwordx4 v9, s[40:43], 0 offen lds
    s_add_u32 m0, m0, 1024
    s_nop 0
    buffer_load_dwordx4 v10, s[40:43], 0 offen lds
    s_add_u32 m0, m0, 1024
    s_nop 0
    buffer_load_dwordx4 v11, s[40:43], 0 offen lds
    s_add_u32 m0, m0, 1024
    s_nop 0
    buffer_load_dwordx4 v12, s[40:43], 0 offen lds
    s_mov_b32 s59, 24576
    s_cmp_eq_u32 s32, 1
    s_cselect_b32 s59, 28672, s59
    s_add_u32 m0, s59, 10240
    s_nop 0
    buffer_load_dwordx4 v19, s[48:51], s59 offen offset:0 sc1 lds
    buffer_load_dwordx4 v19, s[48:51], s59 offen offset:1024 sc1 lds
    buffer_load_dwordx4 v19, s[48:51], s59 offen offset:2048 sc1 lds
    buffer_load_dwordx4 v19, s[48:51], s59 offen offset:3072 sc1 lds
    s_waitcnt vmcnt(9)
    s_branch L_wo_a3
L_padb5:
    s_branch L_padb13
L_wo_a2:
    s_mov_b32 s59, 0
    s_cmp_eq_u32 s32, 1
    s_cselect_b32 s59, 0, s59
    s_cmp_eq_u32 s32, 2
    s_cselect_b32 s59, 0, s59
    s_cmp_eq_u32 s32, 3
    s_cselect_b32 s59, 12288, s59
    s_add_u32 m0, s59, 10240
    s_nop 0
    buffer_load_dwordx4 v19, s[48:51], s59 offen offset:0 sc1 lds
    buffer_load_dwordx4 v19, s[48:51], s59 offen offset:1024 sc1 lds
    buffer_load_dwordx4 v19, s[48:51], s59 offen offset:2048 sc1 lds
    buffer_load_dwordx4 v19, s[48:51], s59 offen offset:3072 sc1 lds
    s_add_u32 m0, m0, 4096
    s_add_u32 s59, s59, 4096
    buffer_load_dwordx4 v19, s[48:51], s59 offen offset:0 sc1 lds
    buffer_load_dwordx4 v19, s[48:51], s59 offen offset:1024 sc1 lds
    buffer_load_dwordx4 v19, s[48:51], s59 offen offset:2048 sc1 lds
    buffer_load_dwordx4 v19, s[48:51], s59 offen offset:3072 sc1 lds
    s_add_u32 m0, m0, 4096
    s_add_u32 s59, s59, 4096
    buffer_load_dwordx4 v19, s[48:51], s59 offen offset:0 sc1 lds
    buffer_load_dwordx4 v19, s[48:51], s59 offen offset:1024 sc1 lds
    buffer_load_dwordx4 v19, s[48:51], s59 offen offset:2048 sc1 lds
    buffer_load_dwordx4 v19, s[48:51], s59 offen offset:3072 sc1 lds
    s_waitcnt vmcnt(12)
L_wo_a3:
    s_barrier
    s_cmp_ge_u32 s32, 2
    s_cbranch_scc1 L_wo_n9
    s_and_b32 s68, s78, 15
    s_lshr_b64 s[78:79], s[78:79], 4
    s_add_u32 s68, s68, s65
    s_sub_u32 s99, s68, 10
    s_cselect_b32 s68, s68, s99
    s_lshl_b32 s68, s68, 7
    v_add_u32 v15, s64, v18
    v_add_u32 v16, s68, v17
    ds_read_b128 v[24:27], v15
    ds_read_b128 v[28:31], v16
    s_add_u32 s64, s64, 43008
    s_cmp_eq_u32 s64, 129024
    s_cselect_b32 s64, 0, s64
L_wo_n9:
    s_mov_b32 s59, 32768
    s_cmp_eq_u32 s32, 1
    s_cselect_b32 s59, 36864, s59
    s_cmp_eq_u32 s32, 2
    s_cselect_b32 s59, 41984, s59
    s_cmp_eq_u32 s32, 3
    s_cselect_b32 s59, 46080, s59
    s_add_u32 s96, s59, 10240
    v_add_u32 v32, s96, v19
    buffer_load_dwordx4 v[40:43], v19, s[48:51], s59 offen offset:0 sc1
    buffer_load_dwordx4 v[44:47], v19, s[48:51], s59 offen offset:1024 sc1
    buffer_load_dwordx4 v[48:51], v19, s[48:51], s59 offen offset:2048 sc1
    buffer_load_dwordx4 v[52:55], v19, s[48:51], s59 offen offset:3072 sc1
    s_add_u32 s59, s59, 4096
    buffer_load_dwordx4 v[56:59], v19, s[48:51], s59 offen offset:0 sc1
    s_mov_b32 s59, 51200
    s_cmp_eq_u32 s32, 1
    s_cselect_b32 s59, 63488, s59
    s_cmp_eq_u32 s32, 2
    s_cselect_b32 s59, 76800, s59
    s_cmp_eq_u32 s32, 3
    s_cselect_b32 s59, 89088, s59
    s_add_u32 s96, s59, 10240
    v_add_u32 v33, s96, v19
    buffer_load_dwordx4 v[60:63], v19, s[48:51], s59 offen offset:0 sc1
    buffer_load_dwordx4 v[64:67], v19, s[48:51], s59 offen offset:1024 sc1
    buffer_load_dwordx4 v[68:71], v19, s[48:51], s59 offen offset:2048 sc1
    buffer_load_dwordx4 v[72:75], v19, s[48:51], s59 offen offset:3072 sc1
    s_add_u32 s59, s59, 4096
    buffer_load_dwordx4 v[76:79], v19, s[48:51], s59 offen offset:0 sc1
    buffer_load_dwordx4 v[80:83], v19, s[48:51], s59 offen offset:1024 sc1
    buffer_load_dwordx4 v[84:87], v19, s[48:51], s59 offen offset:2048 sc1
    buffer_load_dwordx4 v[88:91], v19, s[48:51], s59 offen offset:3072 sc1
    s_add_u32 s59, s59, 4096
    buffer_load_dwordx4 v[92:95], v19, s[48:51], s59 offen offset:0 sc1
    buffer_load_dwordx4 v[96:99], v19, s[48:51], s59 offen offset:1024 sc1
    buffer_load_dwordx4 v[100:103], v19, s[48:51], s59 offen offset:2048 sc1
    buffer_load_dwordx4 v[104:107], v19, s[48:51], s59 offen offset:3072 sc1
    s_add_u32 s59, s59, 4096
    buffer_load_dwordx4 v[108:111], v19, s[48:51], s59 offen offset:0 sc1
    s_waitcnt vmcnt(18)
    s_cmp_lt_u32 s32, 2
    s_cbranch_scc1 L_wo_g
    v_mov_b32 v4, 16
    s_mov_b64 exec, 1
    ds_add_u32 v3, v4 offset:268
    s_mov_b64 exec, -1
    s_branch L_wo_ng
L_wo_g:
    s_waitcnt lgkmcnt(0)
    v_mfma_f32_16x16x32_bf16 v[20:23], v[28:31], v[24:27], v[20:23]
    v_lshlrev_b32 v5, 2, v0
    v_add_u32 v5, 161792, v5
    s_cmp_eq_u32 s32, 0
    s_cbranch_scc1 L_wo_g0
    s_nop 3
    ds_write_b32 v5, v20
    v_mov_b32 v4, 1
    ds_write_b32 v3, v4 offset:172
    v_mov_b32 v4, 16
    s_mov_b64 exec, 1
    ds_add_u32 v3, v4 offset:268
    s_mov_b64 exec, -1
    s_branch L_wo_ng
L_wo_g0:
    v_mov_b32 v4, 16
    s_mov_b64 exec, 1
    ds_add_u32 v3, v4 offset:268
    s_mov_b64 exec, -1
    s_mov_b32 s100, 0
Lw_5:
    ds_read_b32 v4, v3 offset:172
    s_waitcnt lgkmcnt(0)
    v_readfirstlane_b32 s99, v4
    s_cmp_ge_u32 s99, 1
    s_cbranch_scc1 Lwd_6
    s_add_u32 s100, s100, 1
    s_cmp_lt_u32 s100, 1048576
    s_cbranch_scc1 Lw_5
Lwd_6:
    ds_read_b32 v21, v5
    s_waitcnt lgkmcnt(0)
    v_add_f32 v20, v20, v21
    v_cvt_pk_bf16_f32 v20, v20, v20
    v_and_b32 v20, 0xffff0000, v20
    v_mul_f32 v20, 0xbfb8aa3b, v20
    v_exp_f32 v20, v20
    s_nop 0
    v_add_f32 v20, 1.0, v20
    v_rcp_f32 v20, v20
    s_nop 0
    v_cvt_pk_bf16_f32 v20, v20, v20
    v_and_b32 v21, 0xffff0000, v20
    v_mov_b32 v20, s33
    s_and_b32 s96, s37, 1
    s_lshl3_add_u32 s96, s96, s38
    s_lshl_b32 s96, s96, 7
    s_mul_i32 s97, s30, 262144
    s_add_u32 s96, s96, s97
    s_add_u32 s96, s96, 7537664
    v_lshl_add_u32 v5, v1, 3, s96
    s_cmp_ge_u32 s38, 8
    s_cbranch_scc1 L_wo_ng
    s_mov_b64 exec, 0xffff
    s_cmp_lg_u32 s91, 1
    s_cbranch_scc1 Ldg_7
    global_store_dwordx2 v5, v[20:21], s[16:17]
    s_branch Ldd_8
L_pada0:
    s_branch L_pada8
L_padb6:
    s_branch L_padb14
Ldg_7:
    global_store_dwordx2 v5, v[20:21], s[16:17] sc1
Ldd_8:
    s_mov_b64 exec, -1
L_wo_ng:
    s_waitcnt vmcnt(0)
    s_cmp_eq_u32 s32, 3
    s_cbranch_scc1 L_help
L_wo_fl:
    s_lshl_b32 s96, s30, 5
    s_add_u32 s96, s96, s31
    s_lshl_b32 s96, s96, 8
    s_add_u32 s96, s96, 65536
    s_lshl3_add_u32 s96, s32, s96
    s_add_u32 s40, s28, s96
    s_addc_u32 s41, s29, 0
    s_mul_i32 s96, s36, 327680
    s_mul_i32 s97, s32, 163840
    s_add_u32 s96, s96, s97
    s_lshl_b32 s97, s35, 7
    s_add_u32 s96, s96, s97
    s_add_u32 s96, s96, 4194304
    v_lshrrev_b32 v126, 3, v0
    v_and_b32 v127, 7, v0
    v_and_b32 v125, 6, v126
    v_xor_b32 v125, v125, v127
    v_lshlrev_b32 v125, 4, v125
    v_lshl_add_u32 v125, v126, 7, v125
    s_mul_i32 s97, s32, 5120
    s_add_u32 s97, s97, 112640
    v_add_u32 v125, s97, v125
    v_lshlrev_b32 v126, 12, v126
    v_lshl_add_u32 v126, v127, 4, v126
    v_add_u32 v120, s96, v126
    v_add_u32 v121, 32768, v120
    v_add_u32 v122, 65536, v120
    v_add_u32 v123, 98304, v120
    v_add_u32 v124, 131072, v120
    s_and_b32 s44, s33, 0xffffff00
    s_add_u32 s44, s44, 0x600
    s_mov_b32 s100, 0
Lw_9:
    ds_read_b32 v4, v3 offset:196
    s_waitcnt lgkmcnt(0)
    v_readfirstlane_b32 s99, v4
    s_cmp_ge_u32 s99, 0
    s_cbranch_scc1 Lwd_10
    s_sleep 2
    s_add_u32 s100, s100, 1
    s_cmp_lt_u32 s100, 1048576
    s_cbranch_scc1 Lw_9
Lwd_10:
    ds_write_b128 v32, v[40:43] offset:0
    ds_write_b128 v32, v[44:47] offset:1024
    ds_write_b128 v32, v[48:51] offset:2048
    ds_write_b128 v32, v[52:55] offset:3072
    s_waitcnt lgkmcnt(4)
    ds_write_b128 v32, v[56:59] offset:4096
    v_mov_b32 v4, 1
    s_mov_b64 exec, 1
    ds_add_u32 v3, v4 offset:200
    s_mov_b64 exec, -1
    s_mov_b32 s100, 0
Lw_11:
    ds_read_b32 v4, v3 offset:196
    s_waitcnt lgkmcnt(0)
    v_readfirstlane_b32 s99, v4
    s_cmp_ge_u32 s99, 8
    s_cbranch_scc1 Lwd_12
    s_sleep 2
    s_add_u32 s100, s100, 1
    s_cmp_lt_u32 s100, 1048576
    s_cbranch_scc1 Lw_11
Lwd_12:
    s_mov_b32 s100, 0
Lw_13:
    ds_read_b32 v4, v3 offset:268
    s_waitcnt lgkmcnt(0)
    v_readfirstlane_b32 s99, v4
    s_cmp_ge_u32 s99, 72
    s_cbranch_scc1 Lwd_14
    s_sleep 1
    s_add_u32 s100, s100, 1
    s_cmp_lt_u32 s100, 1048576
    s_cbranch_scc1 Lw_13
Lwd_14:
    ds_write_b128 v33, v[60:63] offset:0
    ds_write_b128 v33, v[64:67] offset:1024
    ds_write_b128 v33, v[68:71] offset:2048
    ds_write_b128 v33, v[72:75] offset:3072
    s_waitcnt lgkmcnt(4)
    ds_write_b128 v33, v[76:79] offset:4096
    ds_write_b128 v33, v[80:83] offset:5120
    ds_write_b128 v33, v[84:87] offset:6144
    ds_write_b128 v33, v[88:91] offset:7168
    s_waitcnt lgkmcnt(4)
    ds_write_b128 v33, v[92:95] offset:8192
    ds_write_b128 v33, v[96:99] offset:9216
    ds_write_b128 v33, v[100:103] offset:10240
    ds_write_b128 v33, v[104:107] offset:11264
    s_waitcnt lgkmcnt(4)
    ds_write_b128 v33, v[108:111] offset:12288
    v_mov_b32 v4, 1
    s_mov_b64 exec, 1
    ds_add_u32 v3, v4 offset:204
    s_mov_b64 exec, -1
    s_cmp_lt_u32 s32, 2
    s_cbranch_scc1 L_aux
    s_endpgm
L_help:
    s_and_b32 s96, s35, 3
    s_lshl_b32 s96, s96, 9
    s_mul_i32 s97, s30, 262144
    s_add_u32 s96, s96, s97
    s_add_u32 s96, s96, 7537664
    v_lshl_add_u32 v14, v0, 3, s96
    v_lshl_add_u32 v13, v0, 2, v3
    s_mov_b32 s100, 0
L_gchk:
    global_load_dwordx2 v[18:19], v14, s[16:17] sc1
    s_waitcnt vmcnt(0)
    v_cmp_ne_u32 vcc, s33, v18
    s_cbranch_vccz L_gok
    s_sleep 4
    s_add_u32 s100, s100, 1
    s_cmp_lt_u32 s100, 1048576
    s_cbranch_scc1 L_gchk
L_gok:
    v_sub_f32 v18, 1.0, v19
    ds_write_b32 v13, v19 offset:768
    ds_write_b32 v13, v18 offset:512
    v_mov_b32 v4, 1
    s_mov_b64 exec, 1
    ds_add_u32 v3, v4 offset:208
    s_mov_b64 exec, -1
    s_cmp_eq_u32 s34, 0
    s_cbranch_scc1 L_wo_fl
    s_mul_i32 s96, s30, 262144
    s_and_b32 s97, s35, 3
    s_lshl_b32 s97, s97, 8
    s_add_u32 s96, s96, s97
    s_add_u32 s96, s96, 7536640
    v_lshl_add_u32 v12, v0, 2, s96
    s_mov_b32 exec_hi, 1048575
    s_mov_b32 exec_lo, 0xfffff
    s_mov_b32 s100, 0
L_rl1:
    global_load_dword v5, v12, s[16:17] sc1
    s_waitcnt vmcnt(0)
    v_cmp_ne_u32 vcc, s33, v5
    s_cbranch_vccz L_rd1
    s_sleep 2
    s_add_u32 s100, s100, 1
    s_cmp_lt_u32 s100, 1048576
    s_cbranch_scc1 L_rl1
L_rd1:
    s_mov_b64 exec, -1
    v_mov_b32 v4, 1
    ds_write_b32 v3, v4 offset:276
    s_cmp_lg_u32 s2, 240
    s_cbranch_scc1 L_th_exit
    v_lshlrev_b32 v20, 8, v0
    v_add_u32 v20, 65536, v20
    v_mov_b32 v24, 0
    v_mov_b32 v25, 0
    s_mov_b32 s52, 0
L_epl:
    s_mov_b64 exec, -1
    s_mov_b32 s100, 0
L_hpe:
    global_atomic_or_x2 v[26:27], v20, v[24:25], s[28:29] offset:24 sc0 sc1
    s_waitcnt vmcnt(0)
    v_cmp_ne_u32 vcc, s33, v26
    s_cbranch_vccz L_hde
    s_mov_b64 exec, vcc
    s_sleep 8
    s_add_u32 s100, s100, 1
    s_cmp_lt_u32 s100, 1048576
    s_cbranch_scc1 L_hpe
L_hde:
    s_mov_b64 exec, -1
    v_add_u32 v20, 0x4000, v20
    s_add_u32 s52, s52, 1
    s_cmp_lt_u32 s52, 4
    s_cbranch_scc1 L_epl
    v_mov_b32 v4, 0
    v_mov_b32 v5, s33
    s_mov_b64 exec, 1
    global_store_dword v4, v5, s[28:29] sc1
    s_mov_b64 exec, -1
L_th_exit:
    s_endpgm
L_pada1:
    s_branch L_pada9
L_aserv:
    v_lshrrev_b32 v5, 3, v0
    v_mul_u32_u24 v5, 1280, v5
    v_and_b32 v4, 7, v0
    v_lshl_add_u32 v4, v4, 4, v5
    s_lshl_b32 s96, s38, 8
    v_add_u32 v4, s96, v4
    s_and_b32 s97, s32, 1
    s_lshl_b32 s97, s97, 6
    v_xor_b32 v13, s97, v4
    v_xor_b32 v14, 16, v13
    v_xor_b32 v15, 32, v13
    v_xor_b32 v16, 48, v13
    s_mul_i32 s96, s32, 40960
    s_add_u32 s52, s39, s96
    s_lshl_b32 s53, s32, 12
    s_lshl_b32 s97, s97, 1
    s_add_u32 s96, s39, s97
    s_sub_u32 s96, s96, 5120
    v_xor_b32 v4, 0x70, v4
    v_add_u32 v17, s96, v4
    s_waitcnt lgkmcnt(0)
    s_mov_b32 s84, s6
    s_and_b32 s85, s7, 0xffff
    s_mov_b32 s86, 2621440
    s_mov_b32 s87, 0x00020000
    s_mov_b32 s80, s8
    s_and_b32 s81, s9, 0xffff
    s_mov_b32 s82, 2621440
    s_mov_b32 s83, 0x00020000
    s_load_dword s33, s[28:29], 0
    s_cmp_ge_u32 s38, 5
    s_cbranch_scc1 L_as_nokv
    s_cmp_ge_u32 s32, 2
    s_cbranch_scc1 L_as_nohalo
    s_mul_i32 m0, s32, 16896
    s_add_u32 m0, m0, 90496
    s_mov_b64 exec, 0xffffffff
    buffer_load_dwordx4 v17, s[84:87], 0 offen lds
    s_mov_b64 exec, -1
L_as_nohalo:
    s_add_u32 m0, s53, 91008
    s_add_u32 s59, s52, 0
    buffer_load_dwordx4 v13, s[84:87], s59 offen lds
    s_add_u32 m0, m0, 1024
    s_add_u32 s59, s59, 10240
    buffer_load_dwordx4 v14, s[84:87], s59 offen lds
    s_add_u32 m0, m0, 1024
    s_add_u32 s59, s59, 10240
    buffer_load_dwordx4 v15, s[84:87], s59 offen lds
    s_add_u32 m0, m0, 1024
    s_add_u32 s59, s59, 10240
    buffer_load_dwordx4 v16, s[84:87], s59 offen lds
    s_add_u32 m0, s53, 124288
    s_add_u32 s59, s52, 0
    buffer_load_dwordx4 v13, s[80:83], s59 offen lds
    s_add_u32 m0, m0, 1024
    s_add_u32 s59, s59, 10240
    buffer_load_dwordx4 v14, s[80:83], s59 offen lds
    s_add_u32 m0, m0, 1024
    s_add_u32 s59, s59, 10240
    buffer_load_dwordx4 v15, s[80:83], s59 offen lds
    s_add_u32 m0, m0, 1024
    s_add_u32 s59, s59, 10240
    buffer_load_dwordx4 v16, s[80:83], s59 offen lds
    s_add_u32 m0, s53, 107904
    s_add_u32 s59, s52, 128
    buffer_load_dwordx4 v13, s[84:87], s59 offen lds
    s_add_u32 m0, m0, 1024
    s_add_u32 s59, s59, 10240
    buffer_load_dwordx4 v14, s[84:87], s59 offen lds
    s_add_u32 m0, m0, 1024
    s_add_u32 s59, s59, 10240
    buffer_load_dwordx4 v15, s[84:87], s59 offen lds
    s_add_u32 m0, m0, 1024
    s_add_u32 s59, s59, 10240
    buffer_load_dwordx4 v16, s[84:87], s59 offen lds
    s_add_u32 m0, s53, 140672
    s_add_u32 s59, s52, 128
    buffer_load_dwordx4 v13, s[80:83], s59 offen lds
    s_add_u32 m0, m0, 1024
    s_add_u32 s59, s59, 10240
    buffer_load_dwordx4 v14, s[80:83], s59 offen lds
    s_add_u32 m0, m0, 1024
    s_add_u32 s59, s59, 10240
    buffer_load_dwordx4 v15, s[80:83], s59 offen lds
    s_add_u32 m0, m0, 1024
    s_add_u32 s59, s59, 10240
    buffer_load_dwordx4 v16, s[80:83], s59 offen lds
L_as_nokv:
    s_sub_u32 s96, s31, 20
    s_mul_i32 s97, s96, 43
    s_lshr_b32 s97, s97, 7
    s_mul_i32 s98, s96, 7
    s_sub_u32 s98, s98, s97
    s_lshr_b32 s96, 0x924, s96
    s_and_b32 s96, s96, 1
    s_sub_u32 s64, 7, s96
    s_mul_i32 s97, s30, 80
    s_add_u32 s98, s98, s97
    s_lshl_b32 s98, s98, 12
    s_add_u32 s80, s12, s98
    s_addc_u32 s81, s13, 0
    s_and_b32 s81, s81, 0xffff
    s_lshl_b32 s82, s64, 12
    s_lshl_b32 s52, s32, 12
    s_add_u32 s53, s52, 16384
    v_lshlrev_b32 v18, 4, v0
    buffer_load_dwordx4 v[24:27], v18, s[80:83], s52 offen offset:0
    buffer_load_dwordx4 v[28:31], v18, s[80:83], s52 offen offset:1024
    buffer_load_dwordx4 v[32:35], v18, s[80:83], s52 offen offset:2048
    buffer_load_dwordx4 v[36:39], v18, s[80:83], s52 offen offset:3072
    buffer_load_dwordx4 v[40:43], v18, s[80:83], s53 offen offset:0
    buffer_load_dwordx4 v[44:47], v18, s[80:83], s53 offen offset:1024
    buffer_load_dwordx4 v[48:51], v18, s[80:83], s53 offen offset:2048
    buffer_load_dwordx4 v[52:55], v18, s[80:83], s53 offen offset:3072
    s_waitcnt vmcnt(8) lgkmcnt(0)
    s_barrier
    s_mul_i32 s33, s33, 1664525
    s_add_u32 s33, s33, 1013904223
    s_mul_i32 s54, s32, 8320
    s_add_u32 s96, s54, 1008
    v_sub_u32 v19, s96, v18
    v_lshl_add_u32 v20, v1, 2, s54
    s_lshl_b32 s96, s32, 2
    v_add_u32 v21, s96, v3
    v_mov_b32 v22, 0
    s_mov_b32 s100, 0
Lw_15:
    ds_read_b32 v4, v3 offset:256
    s_waitcnt lgkmcnt(0)
    v_readfirstlane_b32 s99, v4
    s_cmp_ge_u32 s99, 8
    s_cbranch_scc1 Lwd_16
    s_sleep 1
    s_add_u32 s100, s100, 1
    s_cmp_lt_u32 s100, 1048576
    s_cbranch_scc1 Lw_15
Lwd_16:
    s_mov_b32 s98, 0xffff
    s_waitcnt vmcnt(4)
    v_readlane_b32 s60, v27, 63
    v_readlane_b32 s61, v31, 63
    v_readlane_b32 s62, v35, 63
    v_mov_b32_dpp v56, v27 wave_shr:1 row_mask:0xf bank_mask:0xf
    v_mov_b32_dpp v57, v31 wave_shr:1 row_mask:0xf bank_mask:0xf
    v_mov_b32_dpp v58, v35 wave_shr:1 row_mask:0xf bank_mask:0xf
    v_mov_b32_dpp v59, v39 wave_shr:1 row_mask:0xf bank_mask:0xf
    v_writelane_b32 v56, 0, 0
    v_writelane_b32 v57, s60, 0
    v_writelane_b32 v58, s61, 0
    v_writelane_b32 v59, s62, 0
    s_branch L_skip1180
L_pada2:
    s_branch L_pada10
L_skip1180:
    v_alignbit_b32 v60, v27, v27, 16
    v_bfi_b32 v76, s98, v27, v26
    v_alignbit_b32 v61, v26, v26, 16
    v_bfi_b32 v77, s98, v26, v25
    v_alignbit_b32 v62, v25, v25, 16
    v_bfi_b32 v78, s98, v25, v24
    v_alignbit_b32 v63, v24, v24, 16
    v_bfi_b32 v79, s98, v24, v56
    ds_write_b128 v19, v[60:63] offset:3072
    ds_write_b128 v19, v[76:79] offset:7232
    v_alignbit_b32 v64, v31, v31, 16
    v_bfi_b32 v80, s98, v31, v30
    v_alignbit_b32 v65, v30, v30, 16
    v_bfi_b32 v81, s98, v30, v29
    v_alignbit_b32 v66, v29, v29, 16
    v_bfi_b32 v82, s98, v29, v28
    v_alignbit_b32 v67, v28, v28, 16
    v_bfi_b32 v83, s98, v28, v57
    ds_write_b128 v19, v[64:67] offset:2048
    ds_write_b128 v19, v[80:83] offset:6208
    v_alignbit_b32 v68, v35, v35, 16
    v_bfi_b32 v84, s98, v35, v34
    v_alignbit_b32 v69, v34, v34, 16
    v_bfi_b32 v85, s98, v34, v33
    v_alignbit_b32 v70, v33, v33, 16
    v_bfi_b32 v86, s98, v33, v32
    v_alignbit_b32 v71, v32, v32, 16
    v_bfi_b32 v87, s98, v32, v58
    ds_write_b128 v19, v[68:71] offset:1024
    ds_write_b128 v19, v[84:87] offset:5184
    v_alignbit_b32 v72, v39, v39, 16
    v_bfi_b32 v88, s98, v39, v38
    v_alignbit_b32 v73, v38, v38, 16
    v_bfi_b32 v89, s98, v38, v37
    v_alignbit_b32 v74, v37, v37, 16
    v_bfi_b32 v90, s98, v37, v36
    v_alignbit_b32 v75, v36, v36, 16
    v_bfi_b32 v91, s98, v36, v59
    ds_write_b128 v19, v[72:75] offset:0
    ds_write_b128 v19, v[88:91] offset:4160
    ds_write_b32 v20, v22 offset:4096
    ds_write_b32 v20, v22 offset:8256
    v_mov_b32 v4, 1
    ds_write_b32 v21, v4 offset:312
    s_waitcnt lgkmcnt(0)
    s_add_u32 s96, s32, 4
    s_cmp_ge_u32 s96, s64
    s_cbranch_scc1 L_hb1
    s_waitcnt vmcnt(0)
    v_readlane_b32 s60, v43, 63
    v_readlane_b32 s61, v47, 63
    v_readlane_b32 s62, v51, 63
    v_mov_b32_dpp v56, v43 wave_shr:1 row_mask:0xf bank_mask:0xf
    v_mov_b32_dpp v57, v47 wave_shr:1 row_mask:0xf bank_mask:0xf
    v_mov_b32_dpp v58, v51 wave_shr:1 row_mask:0xf bank_mask:0xf
    v_mov_b32_dpp v59, v55 wave_shr:1 row_mask:0xf bank_mask:0xf
    v_writelane_b32 v56, 0, 0
    v_writelane_b32 v57, s60, 0
    v_writelane_b32 v58, s61, 0
    v_writelane_b32 v59, s62, 0
    v_alignbit_b32 v60, v43, v43, 16
    v_bfi_b32 v76, s98, v43, v42
    v_alignbit_b32 v61, v42, v42, 16
    v_bfi_b32 v77, s98, v42, v41
    v_alignbit_b32 v62, v41, v41, 16
    v_bfi_b32 v78, s98, v41, v40
    v_alignbit_b32 v63, v40, v40, 16
    v_bfi_b32 v79, s98, v40, v56
    ds_write_b128 v19, v[60:63] offset:36352
    ds_write_b128 v19, v[76:79] offset:40512
    v_alignbit_b32 v64, v47, v47, 16
    v_bfi_b32 v80, s98, v47, v46
    v_alignbit_b32 v65, v46, v46, 16
    v_bfi_b32 v81, s98, v46, v45
    v_alignbit_b32 v66, v45, v45, 16
    v_bfi_b32 v82, s98, v45, v44
    v_alignbit_b32 v67, v44, v44, 16
    v_bfi_b32 v83, s98, v44, v57
    ds_write_b128 v19, v[64:67] offset:35328
    ds_write_b128 v19, v[80:83] offset:39488
    v_alignbit_b32 v68, v51, v51, 16
    v_bfi_b32 v84, s98, v51, v50
    v_alignbit_b32 v69, v50, v50, 16
    v_bfi_b32 v85, s98, v50, v49
    v_alignbit_b32 v70, v49, v49, 16
    v_bfi_b32 v86, s98, v49, v48
    v_alignbit_b32 v71, v48, v48, 16
    v_bfi_b32 v87, s98, v48, v58
    ds_write_b128 v19, v[68:71] offset:34304
    ds_write_b128 v19, v[84:87] offset:38464
    v_alignbit_b32 v72, v55, v55, 16
    v_bfi_b32 v88, s98, v55, v54
    v_alignbit_b32 v73, v54, v54, 16
    v_bfi_b32 v89, s98, v54, v53
    v_alignbit_b32 v74, v53, v53, 16
    v_bfi_b32 v90, s98, v53, v52
    v_alignbit_b32 v75, v52, v52, 16
    v_bfi_b32 v91, s98, v52, v59
    ds_write_b128 v19, v[72:75] offset:33280
    ds_write_b128 v19, v[88:91] offset:37440
    ds_write_b32 v20, v22 offset:37376
    ds_write_b32 v20, v22 offset:41536
    v_mov_b32 v4, 1
    ds_write_b32 v21, v4 offset:328
    s_waitcnt lgkmcnt(0)
L_hb1:
    s_cmp_eq_u32 s32, 3
    s_cbranch_scc1 L_ahelp
    s_setprio 1
    s_mul_i32 s96, s36, 102400
    s_add_u32 s96, s96, 9437184
    s_add_u32 s48, s28, s96
    s_addc_u32 s49, s29, 0
    s_and_b32 s49, s49, 0xffff
    s_mov_b32 s50, 102400
    s_mov_b32 s51, 0x00020000
    v_lshlrev_b32 v19, 4, v0
    s_lshl1_add_u32 s96, s35, s32
    s_mul_i32 s96, s96, 40960
    s_mul_i32 s97, s36, 160
    s_add_u32 s96, s96, s97
    v_add_u32 v4, 0, v0
    v_mul_u32_u24 v8, 6554, v4
    v_lshrrev_b32 v8, 16, v8
    v_mul_u32_u24 v8, 1120, v8
    v_lshl_add_u32 v4, v4, 4, s96
    v_add_u32 v8, v8, v4
    v_add_u32 v4, 64, v0
    v_mul_u32_u24 v9, 6554, v4
    v_lshrrev_b32 v9, 16, v9
    v_mul_u32_u24 v9, 1120, v9
    s_branch L_skip1311
L_pada3:
    s_branch L_pada11
L_skip1311:
    v_lshl_add_u32 v4, v4, 4, s96
    v_add_u32 v9, v9, v4
    v_add_u32 v4, 128, v0
    v_mul_u32_u24 v10, 6554, v4
    v_lshrrev_b32 v10, 16, v10
    v_mul_u32_u24 v10, 1120, v10
    v_lshl_add_u32 v4, v4, 4, s96
    v_add_u32 v10, v10, v4
    v_add_u32 v4, 192, v0
    v_mul_u32_u24 v11, 6554, v4
    v_lshrrev_b32 v11, 16, v11
    v_mul_u32_u24 v11, 1120, v11
    v_lshl_add_u32 v4, v4, 4, s96
    v_add_u32 v11, v11, v4
    v_add_u32 v4, 256, v0
    v_mul_u32_u24 v12, 6554, v4
    v_lshrrev_b32 v12, 16, v12
    v_mul_u32_u24 v12, 1120, v12
    v_lshl_add_u32 v4, v4, 4, s96
    v_add_u32 v12, v12, v4
    s_mul_i32 s96, s32, 5120
    s_add_u32 s96, s96, 48128
    v_add_u32 v21, s96, v19
    s_mul_i32 s59, s32, 15360
    s_add_u32 s96, s59, 58368
    v_add_u32 v20, s96, v19
    s_add_u32 s60, s59, 51200
    s_setprio 3
    s_mov_b32 s100, 0
Lw_17:
    ds_read_b32 v4, v3 offset:280
    s_waitcnt lgkmcnt(0)
    v_readfirstlane_b32 s99, v4
    s_cmp_ge_u32 s99, 8
    s_cbranch_scc1 Lwd_18
    s_sleep 4
    s_add_u32 s100, s100, 1
    s_cmp_lt_u32 s100, 1048576
    s_cbranch_scc1 Lw_17
Lwd_18:
    s_mov_b32 s100, 0
Lw_19:
    ds_read_b32 v4, v3 offset:192
    s_waitcnt lgkmcnt(0)
    v_readfirstlane_b32 s99, v4
    s_cmp_ge_u32 s99, 1
    s_cbranch_scc1 Lwd_20
    s_sleep 2
    s_add_u32 s100, s100, 1
    s_cmp_lt_u32 s100, 1048576
    s_cbranch_scc1 Lw_19
Lwd_20:
    s_mov_b32 s59, 0
    s_cmp_eq_u32 s32, 1
    s_cselect_b32 s59, 17408, s59
    s_cmp_eq_u32 s32, 2
    s_cselect_b32 s59, 33792, s59
    s_add_u32 m0, s59, 109568
    s_nop 0
    buffer_load_dwordx4 v19, s[48:51], s59 offen offset:0 sc1 lds
    s_waitcnt vmcnt(3)
    buffer_load_dwordx4 v19, s[48:51], s59 offen offset:1024 sc1 lds
    s_waitcnt vmcnt(3)
    buffer_load_dwordx4 v19, s[48:51], s59 offen offset:2048 sc1 lds
    s_waitcnt vmcnt(3)
    buffer_load_dwordx4 v19, s[48:51], s59 offen offset:3072 sc1 lds
    s_add_u32 m0, m0, 4096
    s_add_u32 s59, s59, 4096
    s_waitcnt vmcnt(3)
    buffer_load_dwordx4 v19, s[48:51], s59 offen offset:0 sc1 lds
    s_waitcnt vmcnt(3)
    buffer_load_dwordx4 v19, s[48:51], s59 offen offset:1024 sc1 lds
    s_waitcnt vmcnt(3)
    buffer_load_dwordx4 v19, s[48:51], s59 offen offset:2048 sc1 lds
    s_waitcnt vmcnt(3)
    buffer_load_dwordx4 v19, s[48:51], s59 offen offset:3072 sc1 lds
    s_add_u32 m0, m0, 4096
    s_add_u32 s59, s59, 4096
    s_waitcnt vmcnt(3)
    buffer_load_dwordx4 v19, s[48:51], s59 offen offset:0 sc1 lds
    s_waitcnt vmcnt(3)
    buffer_load_dwordx4 v19, s[48:51], s59 offen offset:1024 sc1 lds
    s_waitcnt vmcnt(3)
    buffer_load_dwordx4 v19, s[48:51], s59 offen offset:2048 sc1 lds
    s_waitcnt vmcnt(3)
    buffer_load_dwordx4 v19, s[48:51], s59 offen offset:3072 sc1 lds
    s_add_u32 m0, m0, 4096
    s_add_u32 s59, s59, 4096
    s_waitcnt vmcnt(3)
    buffer_load_dwordx4 v19, s[48:51], s59 offen offset:0 sc1 lds
    s_waitcnt vmcnt(3)
    buffer_load_dwordx4 v19, s[48:51], s59 offen offset:1024 sc1 lds
    s_waitcnt vmcnt(3)
    buffer_load_dwordx4 v19, s[48:51], s59 offen offset:2048 sc1 lds
    s_waitcnt vmcnt(3)
    buffer_load_dwordx4 v19, s[48:51], s59 offen offset:3072 sc1 lds
    s_add_u32 m0, m0, 4096
    s_add_u32 s59, s59, 4096
    s_waitcnt vmcnt(3)
    buffer_load_dwordx4 v19, s[48:51], s59 offen offset:0 sc1 lds
    s_waitcnt vmcnt(3)
    s_mov_b32 s59, s60
    buffer_load_dwordx4 v[24:27], v19, s[48:51], s59 offen offset:0 sc1
    buffer_load_dwordx4 v[28:31], v19, s[48:51], s59 offen offset:1024 sc1
    buffer_load_dwordx4 v[32:35], v19, s[48:51], s59 offen offset:2048 sc1
    buffer_load_dwordx4 v[36:39], v19, s[48:51], s59 offen offset:3072 sc1
    s_add_u32 s59, s59, 4096
    buffer_load_dwordx4 v[40:43], v19, s[48:51], s59 offen offset:0 sc1
    buffer_load_dwordx4 v[44:47], v19, s[48:51], s59 offen offset:1024 sc1
    buffer_load_dwordx4 v[48:51], v19, s[48:51], s59 offen offset:2048 sc1
    buffer_load_dwordx4 v[52:55], v19, s[48:51], s59 offen offset:3072 sc1
    s_add_u32 s59, s59, 4096
    buffer_load_dwordx4 v[56:59], v19, s[48:51], s59 offen offset:0 sc1
    buffer_load_dwordx4 v[60:63], v19, s[48:51], s59 offen offset:1024 sc1
    buffer_load_dwordx4 v[64:67], v19, s[48:51], s59 offen offset:2048 sc1
    buffer_load_dwordx4 v[68:71], v19, s[48:51], s59 offen offset:3072 sc1
    s_add_u32 s59, s59, 4096
    buffer_load_dwordx4 v[72:75], v19, s[48:51], s59 offen offset:0 sc1
    buffer_load_dwordx4 v[76:79], v19, s[48:51], s59 offen offset:1024 sc1
    buffer_load_dwordx4 v[80:83], v19, s[48:51], s59 offen offset:2048 sc1
    s_cmp_lt_u32 s32, 2
    s_cbranch_scc1 L_ai_x
    s_add_u32 s59, s59, 3072
    buffer_load_dwordx4 v[84:87], v19, s[48:51], s59 offen offset:0 sc1
    buffer_load_dwordx4 v[88:91], v19, s[48:51], s59 offen offset:1024 sc1
    buffer_load_dwordx4 v[92:95], v19, s[48:51], s59 offen offset:2048 sc1
    buffer_load_dwordx4 v[96:99], v19, s[48:51], s59 offen offset:3072 sc1
    s_add_u32 s59, s59, 4096
    buffer_load_dwordx4 v[100:103], v19, s[48:51], s59 offen offset:0 sc1
    v_add_u32 v21, 15360, v20
    s_branch L_ai_d
L_pada4:
    s_branch L_pada12
L_ai_x:
    global_load_dwordx4 v[84:87], v8, s[4:5]
    global_load_dwordx4 v[88:91], v9, s[4:5]
    global_load_dwordx4 v[92:95], v10, s[4:5]
    global_load_dwordx4 v[96:99], v11, s[4:5]
    global_load_dwordx4 v[100:103], v12, s[4:5]
L_ai_d:
    s_waitcnt vmcnt(0)
    v_mov_b32 v4, 1
    s_mov_b64 exec, 1
    ds_add_u32 v3, v4 offset:200
    s_mov_b64 exec, -1
    s_lshl_b32 s96, s30, 5
    s_add_u32 s96, s96, s31
    s_lshl_b32 s96, s96, 8
    s_add_u32 s96, s96, 65536
    s_lshl3_add_u32 s96, s32, s96
    s_add_u32 s40, s28, s96
    s_addc_u32 s41, s29, 0
    s_mul_i32 s96, s36, 327680
    s_mul_i32 s97, s32, 163840
    s_add_u32 s96, s96, s97
    s_lshl_b32 s97, s35, 7
    s_add_u32 s96, s96, s97
    s_add_u32 s96, s96, 4194304
    v_lshrrev_b32 v126, 3, v0
    v_and_b32 v127, 7, v0
    v_and_b32 v125, 6, v126
    v_xor_b32 v125, v125, v127
    v_lshlrev_b32 v125, 4, v125
    v_lshl_add_u32 v125, v126, 7, v125
    s_mul_i32 s97, s32, 5120
    s_add_u32 s97, s97, 0
    v_add_u32 v125, s97, v125
    v_lshlrev_b32 v126, 12, v126
    v_lshl_add_u32 v126, v127, 4, v126
    v_add_u32 v120, s96, v126
    v_add_u32 v121, 32768, v120
    v_add_u32 v122, 65536, v120
    v_add_u32 v123, 98304, v120
    v_add_u32 v124, 131072, v120
    s_and_b32 s44, s33, 0xffffff00
    s_add_u32 s44, s44, 0x600
    s_mov_b32 s100, 0
Lw_21:
    ds_read_b32 v4, v3 offset:304
    s_waitcnt lgkmcnt(0)
    v_readfirstlane_b32 s99, v4
    s_cmp_ge_u32 s99, 1
    s_cbranch_scc1 Lwd_22
    s_sleep 8
    s_add_u32 s100, s100, 1
    s_cmp_lt_u32 s100, 1048576
    s_cbranch_scc1 Lw_21
Lwd_22:
    s_mov_b32 s100, 0
Lw_23:
    ds_read_b32 v4, v3 offset:196
    s_waitcnt lgkmcnt(0)
    v_readfirstlane_b32 s99, v4
    s_cmp_ge_u32 s99, 8
    s_cbranch_scc1 Lwd_24
    s_sleep 1
    s_add_u32 s100, s100, 1
    s_cmp_lt_u32 s100, 1048576
    s_cbranch_scc1 Lw_23
Lwd_24:
    ds_write_b128 v21, v[84:87] offset:0
    ds_write_b128 v21, v[88:91] offset:1024
    ds_write_b128 v21, v[92:95] offset:2048
    ds_write_b128 v21, v[96:99] offset:3072
    s_waitcnt lgkmcnt(4)
    ds_write_b128 v21, v[100:103] offset:4096
    s_lshr_b32 s96, s32, 1
    s_xor_b32 s96, s96, 1
    v_mov_b32 v4, s96
    s_mov_b64 exec, 1
    ds_add_u32 v3, v4 offset:376
    s_mov_b64 exec, -1
    s_setprio 0
    ds_write_b128 v20, v[24:27] offset:0
    ds_write_b128 v20, v[28:31] offset:1024
    ds_write_b128 v20, v[32:35] offset:2048
    ds_write_b128 v20, v[36:39] offset:3072
    s_waitcnt lgkmcnt(4)
    ds_write_b128 v20, v[40:43] offset:4096
    ds_write_b128 v20, v[44:47] offset:5120
    ds_write_b128 v20, v[48:51] offset:6144
    ds_write_b128 v20, v[52:55] offset:7168
    s_waitcnt lgkmcnt(4)
    ds_write_b128 v20, v[56:59] offset:8192
    ds_write_b128 v20, v[60:63] offset:9216
    ds_write_b128 v20, v[64:67] offset:10240
    ds_write_b128 v20, v[68:71] offset:11264
    s_waitcnt lgkmcnt(4)
    ds_write_b128 v20, v[72:75] offset:12288
    ds_write_b128 v20, v[76:79] offset:13312
    ds_write_b128 v20, v[80:83] offset:14336
    s_setprio 3
    v_mov_b32 v4, 1
    s_mov_b64 exec, 1
    ds_add_u32 v3, v4 offset:204
    s_mov_b64 exec, -1
    s_cmp_lt_u32 s32, 2
    s_cbranch_scc1 L_aux
    s_endpgm
L_pada5:
    s_branch L_pada13
L_ahelp:
    v_lshlrev_b32 v4, 2, v0
    v_add_u32 v4, 161792, v4
    v_mov_b32 v5, 0
    ds_write_b32 v4, v5
    s_lshl_b32 s96, s30, 5
    s_add_u32 s96, s96, s31
    s_lshl_b32 s96, s96, 8
    s_add_u32 s96, s96, 65536
    v_lshl_add_u32 v4, v0, 3, s96
    v_mov_b32 v6, 0
    s_and_b32 s97, s33, 0xffffff00
    v_mov_b32 v7, s97
    s_getreg_b32 s97, hwreg(HW_REG_XCC_ID, 0, 4)
    v_writelane_b32 v6, s33, 3
    v_writelane_b32 v7, s97, 3
    s_mov_b64 exec, 0xffff
    global_store_dwordx2 v4, v[6:7], s[28:29] sc1
    s_mov_b64 exec, -1
    s_cmp_lg_u32 s31, 30
    s_cbranch_scc1 L_nocen
    s_sleep 8
    s_lshl_b32 s96, s30, 13
    s_add_u32 s96, s96, 65536
    v_and_b32 v4, 31, v0
    v_lshl_add_u32 v20, v4, 8, s96
    v_mov_b32 v24, 0
    v_mov_b32 v25, 0
    s_mov_b64 exec, 0xffffffff
    s_mov_b32 s100, 0
L_hpg:
    global_atomic_or_x2 v[26:27], v20, v[24:25], s[28:29] offset:24 sc0 sc1
    s_waitcnt vmcnt(0)
    v_cmp_ne_u32 vcc, s33, v26
    s_cbranch_vccz L_hdg
    s_mov_b64 exec, vcc
    s_sleep 2
    s_add_u32 s100, s100, 1
    s_cmp_lt_u32 s100, 1048576
    s_cbranch_scc1 L_hpg
L_hdg:
    s_mov_b64 exec, -1
    v_readfirstlane_b32 s96, v27
    s_nop 1
    v_cmp_ne_u32 vcc, s96, v27
    s_cmp_eq_u32 vcc_lo, 0
    s_cselect_b32 s96, 1, 2
    v_mov_b32 v22, s33
    v_mov_b32 v23, s96
    s_mov_b64 exec, 0xffffffff
    global_store_dwordx2 v20, v[22:23], s[28:29] offset:136 sc1
    s_lshl_b32 s96, s30, 8
    s_add_u32 s96, s96, 65536
    v_lshl_add_u32 v21, v0, 11, s96
    global_store_dword v21, v22, s[28:29] offset:128 sc1
    s_mov_b64 exec, -1
L_nocen:
    s_sub_u32 s52, s31, 20
    s_mul_i32 s96, s30, 262144
    s_mul_i32 s97, s52, 16768
    s_add_u32 s96, s96, s97
    s_add_u32 s53, s96, 7340032
    s_mul_i32 s96, s30, 327680
    s_mul_i32 s97, s52, 27392
    s_min_u32 s97, s97, 300288
    s_add_u32 s96, s96, s97
    s_add_u32 s54, s96, 0
    s_mul_i32 s55, s36, 102400
    s_add_u32 s55, s55, 9437184
    v_lshlrev_b32 v15, 7, v0
    s_mov_b32 s44, s28
    s_and_b32 s45, s29, 0xffff
    s_mov_b32 s46, 16777216
    s_mov_b32 s47, 0x00020000
    s_mov_b32 s100, 0
Lw_25:
    ds_read_b32 v4, v3 offset:280
    s_waitcnt lgkmcnt(0)
    v_readfirstlane_b32 s99, v4
    s_cmp_ge_u32 s99, 8
    s_cbranch_scc1 Lwd_26
    s_sleep 2
    s_add_u32 s100, s100, 1
    s_cmp_lt_u32 s100, 1048576
    s_cbranch_scc1 Lw_25
Lwd_26:
    buffer_load_dword v18, v15, s[44:47], s53 offen sc1
    s_add_u32 s53, s53, 8192
    buffer_load_dword v18, v15, s[44:47], s53 offen sc1
    s_add_u32 s53, s53, 8192
    s_mov_b64 exec, 0x7
    buffer_load_dword v18, v15, s[44:47], s53 offen sc1
    s_add_u32 s53, s53, 8192
    s_mov_b64 exec, -1
    s_lshl_b32 s98, s30, 5
    s_add_u32 s98, s98, s31
    s_lshl_b32 s98, s98, 8
    s_add_u32 s98, s98, 65536
    s_add_u32 s98, s98, 128
    s_mov_b32 s100, 0
Lc_27:
    s_load_dwordx4 s[88:91], s[28:29], s98 glc
    s_waitcnt lgkmcnt(0)
    s_xor_b32 s96, s88, s33
    s_xor_b32 s97, s90, s33
    s_or_b32 s96, s96, s97
    s_cmp_eq_u32 s96, 0
    s_cbranch_scc1 Lcd_28
    s_sleep 2
    s_add_u32 s100, s100, 1
    s_cmp_lt_u32 s100, 1048576
    s_cbranch_scc1 Lc_27
    s_mov_b32 s91, 2
Lcd_28:
    s_cmp_eq_u32 s91, 1
    s_cselect_b32 s99, 0, 15728640
    s_add_u32 s16, s28, s99
    s_addc_u32 s17, s29, 0
    v_mov_b32 v4, s91
    ds_write_b32 v3, v4 offset:192
    s_mov_b32 s40, s24
    s_and_b32 s41, s25, 0xffff
    s_mov_b32 s42, 2621440
    s_mov_b32 s43, 0x00020000
    s_cmp_lg_u32 s91, 1
    s_cbranch_scc1 L_noot
    s_sleep 32
    buffer_load_dword v18, v15, s[40:43], s54 offen sc1
    s_add_u32 s54, s54, 8192
    buffer_load_dword v18, v15, s[40:43], s54 offen sc1
    s_add_u32 s54, s54, 8192
    buffer_load_dword v18, v15, s[40:43], s54 offen sc1
    s_add_u32 s54, s54, 8192
    s_mov_b64 exec, 0x3fffff
    buffer_load_dword v18, v15, s[40:43], s54 offen sc1
    s_add_u32 s54, s54, 8192
    s_mov_b64 exec, -1
L_noot:
    s_lshl_b32 s96, s2, 7
    s_add_u32 s96, s96, 0x1F8000
    v_lshl_add_u32 v4, v0, 21, s96
    s_add_u32 s96, s96, 10518528
    v_writelane_b32 v4, s96, 6
    v_mov_b32 v5, 0
    s_mov_b64 exec, 0xde
    global_atomic_or v4, v5, s[28:29] sc1
    s_mov_b64 exec, -1
    s_waitcnt vmcnt(0)
    v_mov_b32 v4, 1
    ds_write_b32 v3, v4 offset:248
    v_mov_b32 v4, 1
    s_mov_b64 exec, 1
    ds_add_u32 v3, v4 offset:200
    s_mov_b64 exec, -1
    v_mov_b32 v4, 1
    s_mov_b64 exec, 1
    ds_add_u32 v3, v4 offset:204
    s_mov_b64 exec, -1
    s_mov_b32 s100, 0
Lw_29:
    ds_read_b32 v4, v3 offset:304
    s_waitcnt lgkmcnt(0)
    v_readfirstlane_b32 s99, v4
    s_cmp_ge_u32 s99, 1
    s_cbranch_scc1 Lwd_30
    s_sleep 8
    s_add_u32 s100, s100, 1
    s_cmp_lt_u32 s100, 1048576
    s_cbranch_scc1 Lw_29
Lwd_30:
    s_branch L_help
L_pada6:
    s_branch L_pada14
L_padb7:
    s_branch L_padb15
L_aux:
    s_mov_b32 s100, 0
L_yp:
    s_load_dwordx2 s[42:43], s[40:41], 0 glc
    s_waitcnt lgkmcnt(0)
    s_and_b32 s43, s43, 0xffffff00
    s_cmp_eq_u32 s43, s44
    s_cbranch_scc1 L_ypd
    s_sleep 1
    s_add_u32 s100, s100, 1
    s_cmp_lt_u32 s100, 1048576
    s_cbranch_scc1 L_yp
L_ypd:
    s_mov_b32 s100, 0
L_yretry:
    global_load_dwordx4 v[128:131], v120, s[28:29] sc1
    global_load_dwordx4 v[132:135], v121, s[28:29] sc1
    global_load_dwordx4 v[136:139], v122, s[28:29] sc1
    global_load_dwordx4 v[140:143], v123, s[28:29] sc1
    global_load_dwordx4 v[144:147], v124, s[28:29] sc1
    v_mov_b32 v16, 0
    s_waitcnt vmcnt(4)
    ds_write_b128 v125, v[128:131] offset:0
    v_add3_u32 v16, v16, v128, v129
    v_add3_u32 v16, v16, v130, v131
    s_waitcnt vmcnt(3)
    ds_write_b128 v125, v[132:135] offset:1024
    v_add3_u32 v16, v16, v132, v133
    v_add3_u32 v16, v16, v134, v135
    s_waitcnt vmcnt(2)
    ds_write_b128 v125, v[136:139] offset:2048
    v_add3_u32 v16, v16, v136, v137
    v_add3_u32 v16, v16, v138, v139
    s_waitcnt vmcnt(1)
    ds_write_b128 v125, v[140:143] offset:3072
    v_add3_u32 v16, v16, v140, v141
    v_add3_u32 v16, v16, v142, v143
    s_waitcnt vmcnt(0)
    ds_write_b128 v125, v[144:147] offset:4096
    v_add3_u32 v16, v16, v144, v145
    v_add3_u32 v16, v16, v146, v147
    s_nop 1
    v_add_u32_dpp v16, v16, v16 row_ror:8 row_mask:0xf bank_mask:0xf
    s_nop 1
    v_add_u32_dpp v16, v16, v16 row_ror:4 row_mask:0xf bank_mask:0xf
    s_nop 1
    v_add_u32_dpp v16, v16, v16 row_ror:2 row_mask:0xf bank_mask:0xf
    s_nop 1
    v_add_u32_dpp v16, v16, v16 row_ror:1 row_mask:0xf bank_mask:0xf
    s_nop 0
    v_readlane_b32 s96, v16, 0
    v_readlane_b32 s97, v16, 16
    v_readlane_b32 s98, v16, 32
    v_readlane_b32 s99, v16, 48
    s_add_u32 s96, s96, s97
    s_add_u32 s98, s98, s99
    s_add_u32 s96, s96, s98
    s_cmp_eq_u32 s96, s42
    s_cbranch_scc1 L_yok
    s_sleep 2
    s_add_u32 s100, s100, 1
    s_cmp_lt_u32 s100, 1048576
    s_cbranch_scc1 L_yretry
L_yok:
    v_mov_b32 v4, 1
    s_mov_b64 exec, 1
    ds_add_u32 v3, v4 offset:212
    s_mov_b64 exec, -1
    s_endpgm
L_compute:
    s_waitcnt lgkmcnt(0)
    s_load_dword s33, s[28:29], 0
    s_setprio 2
    s_sub_u32 s40, s32, 4
    s_lshr_b32 s42, s40, 2
    s_and_b32 s56, s40, 3
    s_xor_b32 s41, s56, s42
    s_sub_u32 s46, s38, 5
    s_cselect_b32 s46, s38, s46
    s_mov_b32 s96, 0xf9af5600
    s_mov_b32 s45, 0x886f5f4f
    s_cmp_eq_u32 s46, 1
    s_cselect_b32 s96, 0xfeab5500, s96
    s_cselect_b32 s45, 0x8c5f4f8f, s45
    s_cmp_eq_u32 s46, 2
    s_cselect_b32 s96, 0xffaa5500, s96
    s_cselect_b32 s45, 0x8e4f3f87, s45
    s_cmp_eq_u32 s46, 3
    s_cselect_b32 s96, 0xffaa1540, s96
    s_cselect_b32 s45, 0x8f3f2f83, s45
    s_cmp_eq_u32 s46, 4
    s_cselect_b32 s96, 0xff6a0590, s96
    s_cselect_b32 s45, 0x3f2f1f81, s45
    s_lshl_b32 s97, s41, 3
    s_lshr_b32 s96, s96, s97
    s_lshr_b32 s45, s45, s97
    s_and_b32 s45, s45, 0xff
    v_lshrrev_b32 v5, 1, v1
    v_xor_b32 v5, v5, v2
    v_lshlrev_b32 v5, 4, v5
    v_lshl_add_u32 v132, v1, 7, v5
    s_lshl_b32 s97, s42, 13
    v_add_u32 v132, s97, v132
    v_and_b32 v4, 3, v0
    v_lshlrev_b32 v5, 1, v4
    v_bfe_u32 v5, s96, v5, 2
    v_bfe_u32 v6, v0, 3, 2
    v_xor_b32 v5, v5, v6
    v_lshl_add_u32 v5, v5, 2, v4
    v_bfe_u32 v6, v0, 2, 2
    v_mad_u32_u24 v6, v2, 24, v6
    v_lshlrev_b32 v6, 7, v6
    v_lshl_add_u32 v133, v5, 3, v6
    v_add_u32 v133, 18432, v133
    v_mov_b32 v8, 0
    v_mov_b32 v9, 0
    v_mov_b32 v10, 0
    v_mov_b32 v11, 0
    v_mov_b32 v12, 0
    v_mov_b32 v13, 0
    v_mov_b32 v14, 0
    v_mov_b32 v15, 0
    v_mov_b32 v16, 0
    v_mov_b32 v17, 0
    v_mov_b32 v18, 0
    v_mov_b32 v19, 0
    v_mov_b32 v20, 0
    v_mov_b32 v21, 0
    v_mov_b32 v22, 0
    v_mov_b32 v23, 0
    v_mov_b32 v24, 0
    v_mov_b32 v25, 0
    v_mov_b32 v26, 0
    v_mov_b32 v27, 0
    v_mov_b32 v28, 0
    v_mov_b32 v29, 0
    v_mov_b32 v30, 0
    v_mov_b32 v31, 0
    v_mov_b32 v32, 0
    v_mov_b32 v33, 0
    v_mov_b32 v34, 0
    v_mov_b32 v35, 0
    v_mov_b32 v36, 0
    v_mov_b32 v37, 0
    v_mov_b32 v38, 0
    v_mov_b32 v39, 0
    v_mov_b32 v40, 0
    v_mov_b32 v41, 0
    v_mov_b32 v42, 0
    v_mov_b32 v43, 0
    v_mov_b32 v44, 0
    v_mov_b32 v45, 0
    v_mov_b32 v46, 0
    v_mov_b32 v47, 0
    v_mov_b32 v48, 0
    v_mov_b32 v49, 0
    v_mov_b32 v50, 0
    v_mov_b32 v51, 0
    v_mov_b32 v52, 0
    v_mov_b32 v53, 0
    v_mov_b32 v54, 0
    v_mov_b32 v55, 0
    v_mov_b32 v56, 0
    v_mov_b32 v57, 0
    v_mov_b32 v58, 0
    v_mov_b32 v59, 0
    v_mov_b32 v60, 0
    v_mov_b32 v61, 0
    v_mov_b32 v62, 0
    v_mov_b32 v63, 0
    v_mov_b32 v64, 0
    v_mov_b32 v65, 0
    v_mov_b32 v66, 0
    v_mov_b32 v67, 0
    s_mov_b32 s43, 0
    s_mov_b32 s44, 86016
    v_add_u32 v134, 86016, v132
    v_xor_b32 v135, 64, v134
    v_add_u32 v136, 86016, v133
    v_mov_b32 v7, 0xf149f2ca
    v_lshlrev_b32 v4, 2, v2
    v_sub_u32 v4, v1, v4
    v_subrev_u32 v5, 0, v4
    v_and_b32 v5, 0x80000001, v5
    v_cmp_eq_u32 vcc, 0, v5
    s_nop 1
    v_cndmask_b32 v144, v7, 0, vcc
    v_cmp_eq_u32 vcc, 0x80000000, v5
    s_nop 1
    v_cndmask_b32 v148, v7, 0, vcc
    v_subrev_u32 v5, 1, v4
    v_and_b32 v5, 0x80000001, v5
    v_cmp_eq_u32 vcc, 0, v5
    s_nop 1
    v_cndmask_b32 v145, v7, 0, vcc
    v_cmp_eq_u32 vcc, 0x80000000, v5
    s_nop 1
    v_cndmask_b32 v149, v7, 0, vcc
    v_subrev_u32 v5, 2, v4
    v_and_b32 v5, 0x80000001, v5
    v_cmp_eq_u32 vcc, 0, v5
    s_nop 1
    v_cndmask_b32 v146, v7, 0, vcc
    v_cmp_eq_u32 vcc, 0x80000000, v5
    s_nop 1
    v_cndmask_b32 v150, v7, 0, vcc
    v_subrev_u32 v5, 3, v4
    v_and_b32 v5, 0x80000001, v5
    v_cmp_eq_u32 vcc, 0, v5
    s_nop 1
    v_cndmask_b32 v147, v7, 0, vcc
    v_cmp_eq_u32 vcc, 0x80000000, v5
    s_nop 1
    v_cndmask_b32 v151, v7, 0, vcc
    v_and_b32 v5, 1, v1
    v_lshlrev_b32 v6, 4, v5
    v_mov_b32 v7, 0xffff
    v_lshlrev_b32 v7, v6, v7
    v_sub_u32 v5, v4, v5
    v_cmp_le_i32 vcc, 0, v5
    s_nop 1
    v_cndmask_b32 v152, 0, v7, vcc
    v_cndmask_b32 v154, v7, 0, vcc
    v_cmp_le_i32 vcc, 2, v5
    s_nop 1
    v_cndmask_b32 v153, 0, v7, vcc
    v_cndmask_b32 v155, v7, 0, vcc
    v_mov_b32 v7, 0x0c0c0c0c
    s_mov_b32 s96, 0x1000100
    v_bfi_b32 v152, v152, s96, v7
    s_mov_b32 s96, 0x3020302
    v_bfi_b32 v153, v153, s96, v7
    s_mov_b32 s96, 0x1000100
    v_bfi_b32 v154, v154, s96, v7
    s_mov_b32 s96, 0x3020302
    v_bfi_b32 v155, v155, s96, v7
    s_or_b32 s96, s37, s42
    s_cmp_eq_u32 s96, 0
    s_cselect_b32 s96, 0xf149f2ca, 0
    v_add_f32 v140, s96, v148
    v_add_f32 v141, s96, v149
    v_add_f32 v142, s96, v150
    v_add_f32 v143, s96, v151
    s_mov_b32 s54, 0x3ea52b5c
    v_bfe_i32 v157, s45, v2, 1
    v_cmp_ne_u32 s[50:51], 0, v157
    s_bfe_u32 s60, s45, 131076
    v_cmp_eq_u32 s[52:53], s60, v2
    s_bfe_u32 s61, s45, 65542
    s_lshr_b32 s62, s41, 1
    s_add_u32 s96, s41, 1
    s_bfe_u32 s96, s96, 65537
    s_xor_b32 s57, s96, 1
    s_bitcmp1_b32 s45, 7
    s_cselect_b32 s63, s62, s61
    s_mul_i32 s96, s63, 13824
    s_lshl_b32 s97, s42, 11
    s_add_u32 s96, s96, s97
    s_add_u32 s96, s96, 129024
    v_lshl_add_u32 v156, v0, 3, s96
    v_and_b32 v4, 0x33, v0
    s_lshl_b32 s97, s60, 5
    s_add_u32 s96, s96, s97
    v_lshl_add_u32 v162, v4, 3, s96
    s_lshl_b32 s96, s41, 10
    s_add_u32 s96, s96, 156672
    v_lshl_add_u32 v164, v0, 3, s96
    v_min_u32 v4, 16, v0
    v_lshl_add_u32 v163, v4, 2, v3
    v_add_u32 v163, 128, v163
    s_lshl1_add_u32 s96, s41, s42
    s_lshl_b32 s96, s96, 2
    v_add_u32 v165, s96, v3
    s_lshl_b32 s96, s41, 1
    s_lshl_b32 s96, s42, s96
    s_lshl1_add_u32 s97, s42, 1
    s_mul_i32 s98, s61, 6
    s_lshl_b32 s97, s97, s98
    s_or_b32 s98, s96, s97
    s_bitcmp1_b32 s45, 7
    s_cselect_b32 s48, s96, s98
    s_cselect_b32 s49, s96, s97
    s_lshl_b32 s49, s49, 8
    s_and_b32 s64, s37, 1
    s_lshl1_add_u32 s65, s64, s42
    s_mul_i32 s96, s65, 81920
    s_mul_i32 s97, s30, 327680
    s_add_u32 s96, s96, s97
    s_lshl_b32 s97, s38, 11
    s_add_u32 s96, s96, s97
    s_mul_i32 s97, s57, 20480
    s_lshl3_add_u32 s97, s62, s97
    s_add_u32 s97, s97, s96
    v_lshl_add_u32 v160, v0, 4, s97
    s_lshl_b32 s97, s60, 8
    s_lshl3_add_u32 s97, s61, s97
    s_add_u32 s97, s97, 20480
    s_add_u32 s97, s97, s96
    v_lshrrev_b32 v4, 1, v2
    v_mul_u32_u24 v4, 38912, v4
    v_lshl_add_u32 v4, v2, 10, v4
    v_lshl_add_u32 v4, v1, 4, v4
    v_add_u32 v161, s97, v4
    s_mul_i32 s66, s30, 262144
    s_add_u32 s66, s66, 7340032
    s_lshl_b32 s96, s65, 8
    s_lshl_b32 s97, s57, 7
    s_add_u32 s96, s96, s97
    s_lshl1_add_u32 s97, s38, s62
    s_lshl2_add_u32 s96, s97, s96
    s_add_u32 s96, s96, s66
    s_add_u32 s55, s96, 196608
    s_cmp_ge_u32 s38, 5
    s_cselect_b32 s96, 3, -1
    s_add_u32 s96, s96, s46
    s_add_u32 s96, s96, s62
    s_and_b32 s96, s96, 7
    s_lshl3_add_u32 s96, s64, s96
    s_lshl1_add_u32 s96, s96, s62
    s_lshl1_add_u32 s96, s96, s42
    s_xor_b32 s97, s96, 2
    s_mul_i32 s96, s96, 3072
    s_mul_i32 s97, s97, 3072
    s_add_u32 s96, s96, s66
    s_add_u32 s97, s97, s66
    v_lshl_add_u32 v159, v0, 4, s96
    v_lshl_add_u32 v158, v0, 4, s97
    v_add_u32 v157, 40960, v160
    s_mul_i32 s96, s57, 51200
    s_add_u32 s80, s96, 10240
    s_mul_i32 s81, s56, 2560
    s_add_u32 s81, s81, 0
    s_mov_b32 s93, 112640
    s_mov_b32 s101, 0
    s_and_b32 s98, s35, 3
    s_lshr_b32 s96, s56, 1
    s_lshl1_add_u32 s96, s98, s96
    s_lshl1_add_u32 s96, s96, s57
    s_mul_i32 s96, s96, 20480
    s_and_b32 s97, s56, 1
    s_lshl_b32 s97, s97, 10
    s_add_u32 s96, s96, s97
    s_mul_i32 s97, s30, 327680
    s_add_u32 s96, s96, s97
    s_add_u32 s82, s96, 4096
    s_mul_i32 s96, s30, 262144
    s_lshl_b32 s98, s98, 8
    s_add_u32 s96, s96, s98
    s_add_u32 s83, s96, 7536640
    s_mul_i32 s84, s56, 5120
    s_add_u32 s84, s84, 129024
    s_lshl2_add_u32 s96, s35, s56
    s_mul_i32 s96, s96, 20480
    s_mul_i32 s97, s36, 160
    s_add_u32 s85, s96, s97
    v_lshl_add_u32 v138, v0, 4, s80
    v_lshl_add_u32 v139, v0, 4, s82
    v_lshl_add_u32 v166, v0, 2, s83
    s_waitcnt lgkmcnt(0)
    s_mul_i32 s33, s33, 1664525
    s_add_u32 s33, s33, 1013904223
    s_cmp_eq_u32 s32, 4
    s_cbranch_scc1 L_padb0
    s_cmp_eq_u32 s32, 5
    s_cbranch_scc1 L_padb1
    s_cmp_eq_u32 s32, 6
    s_cbranch_scc1 L_padb2
    s_cmp_eq_u32 s32, 7
    s_cbranch_scc1 L_padb3
    s_cmp_eq_u32 s32, 8
    s_cbranch_scc1 L_padb4
    s_cmp_eq_u32 s32, 9
    s_cbranch_scc1 L_padb5
    s_cmp_eq_u32 s32, 10
    s_cbranch_scc1 L_padb6
    s_branch L_padb7
L_padb8:
    s_branch L_padb16
L_warmed_b:
    s_cmp_lg_u32 s42, 0
    s_cbranch_scc1 L_gemm_40
L_gemm_50:
    s_barrier
    ds_read_b64_tr_b16 v[112:113], v136 offset:1024
    ds_read_b64_tr_b16 v[114:115], v136 offset:1536
    ds_read_b128 v[68:71], v134 offset:0
    ds_read_b128 v[72:75], v134 offset:2048
    ds_read_b128 v[76:79], v134 offset:4096
    ds_read_b128 v[80:83], v134 offset:6144
    ds_read_b128 v[84:87], v134 offset:8192
    ds_read_b64_tr_b16 v[116:117], v136 offset:2048
    ds_read_b64_tr_b16 v[118:119], v136 offset:2560
    ds_read_b64_tr_b16 v[108:109], v136 offset:0
    ds_read_b64_tr_b16 v[110:111], v136 offset:512
    s_branch L_skip2111
L_padb9:
    s_branch L_padb17
L_skip2111:
L_gemm_5:
    s_waitcnt lgkmcnt(8)
    v_mfma_f32_16x16x32_bf16 v[28:31], v[112:115], v[68:71], v[28:31]
    s_setprio 2
    ds_read_b64_tr_b16 v[124:125], v136 offset:13312
    s_waitcnt lgkmcnt(8)
    v_mfma_f32_16x16x32_bf16 v[32:35], v[112:115], v[72:75], v[32:35]
    ds_read_b64_tr_b16 v[126:127], v136 offset:13824
    s_waitcnt lgkmcnt(8)
    v_mfma_f32_16x16x32_bf16 v[36:39], v[112:115], v[76:79], v[36:39]
    ds_read_b128 v[88:91], v135 offset:0
    s_waitcnt lgkmcnt(8)
    v_mfma_f32_16x16x32_bf16 v[40:43], v[112:115], v[80:83], v[40:43]
    ds_read_b128 v[92:95], v135 offset:2048
    s_waitcnt lgkmcnt(8)
    v_mfma_f32_16x16x32_bf16 v[44:47], v[112:115], v[84:87], v[44:47]
    ds_read_b128 v[96:99], v135 offset:4096
    s_waitcnt lgkmcnt(7)
    v_mfma_f32_16x16x32_bf16 v[48:51], v[68:71], v[116:119], v[48:51]
    ds_read_b128 v[100:103], v135 offset:6144
    v_mfma_f32_16x16x32_bf16 v[52:55], v[72:75], v[116:119], v[52:55]
    ds_read_b128 v[104:107], v135 offset:8192
    v_mfma_f32_16x16x32_bf16 v[56:59], v[76:79], v[116:119], v[56:59]
    ds_read_b64_tr_b16 v[128:129], v136 offset:14336
    v_mfma_f32_16x16x32_bf16 v[60:63], v[80:83], v[116:119], v[60:63]
    ds_read_b64_tr_b16 v[130:131], v136 offset:14848
    v_mfma_f32_16x16x32_bf16 v[64:67], v[84:87], v[116:119], v[64:67]
    ds_read_b64_tr_b16 v[120:121], v136 offset:12288
    s_waitcnt lgkmcnt(10)
    v_mfma_f32_16x16x32_bf16 v[12:15], v[108:111], v[72:75], v[12:15]
    ds_read_b64_tr_b16 v[122:123], v136 offset:12800
    v_mfma_f32_16x16x32_bf16 v[16:19], v[108:111], v[76:79], v[16:19]
    v_mfma_f32_16x16x32_bf16 v[20:23], v[108:111], v[80:83], v[20:23]
    v_mfma_f32_16x16x32_bf16 v[24:27], v[108:111], v[84:87], v[24:27]
    s_waitcnt lgkmcnt(8)
    v_mfma_f32_16x16x32_bf16 v[28:31], v[124:127], v[88:91], v[28:31]
    s_add_u32 s44, s44, 43008
    s_cmp_eq_u32 s44, 129024
    s_cselect_b32 s44, 0, s44
    v_add_u32 v134, s44, v132
    v_add_u32 v136, s44, v133
    s_waitcnt lgkmcnt(7)
    v_mfma_f32_16x16x32_bf16 v[32:35], v[124:127], v[92:95], v[32:35]
    s_waitcnt lgkmcnt(0)
    s_barrier
    s_setprio 1
    ds_read_b64_tr_b16 v[112:113], v136 offset:1024
    v_mfma_f32_16x16x32_bf16 v[36:39], v[124:127], v[96:99], v[36:39]
    ds_read_b64_tr_b16 v[114:115], v136 offset:1536
    v_mfma_f32_16x16x32_bf16 v[40:43], v[124:127], v[100:103], v[40:43]
    v_xor_b32 v135, 64, v134
    ds_read_b128 v[68:71], v134 offset:0
    v_mfma_f32_16x16x32_bf16 v[44:47], v[124:127], v[104:107], v[44:47]
    ds_read_b128 v[72:75], v134 offset:2048
    v_mfma_f32_16x16x32_bf16 v[48:51], v[88:91], v[128:131], v[48:51]
    ds_read_b128 v[76:79], v134 offset:4096
    v_mfma_f32_16x16x32_bf16 v[52:55], v[92:95], v[128:131], v[52:55]
    ds_read_b128 v[80:83], v134 offset:6144
    v_mfma_f32_16x16x32_bf16 v[56:59], v[96:99], v[128:131], v[56:59]
    ds_read_b128 v[84:87], v134 offset:8192
    v_mfma_f32_16x16x32_bf16 v[60:63], v[100:103], v[128:131], v[60:63]
    ds_read_b64_tr_b16 v[116:117], v136 offset:2048
    v_mfma_f32_16x16x32_bf16 v[64:67], v[104:107], v[128:131], v[64:67]
    ds_read_b64_tr_b16 v[118:119], v136 offset:2560
    v_mfma_f32_16x16x32_bf16 v[12:15], v[120:123], v[92:95], v[12:15]
    ds_read_b64_tr_b16 v[108:109], v136 offset:0
    v_mfma_f32_16x16x32_bf16 v[16:19], v[120:123], v[96:99], v[16:19]
    s_add_u32 s43, s43, 1
    ds_read_b64_tr_b16 v[110:111], v136 offset:512
    v_mfma_f32_16x16x32_bf16 v[20:23], v[120:123], v[100:103], v[20:23]
    s_cmp_lt_u32 s43, 9
    v_mfma_f32_16x16x32_bf16 v[24:27], v[120:123], v[104:107], v[24:27]
    s_cbranch_scc1 L_gemm_5
    s_waitcnt lgkmcnt(8)
    v_mfma_f32_16x16x32_bf16 v[28:31], v[112:115], v[68:71], v[28:31]
    s_bitcmp1_b32 s45, 7
    s_setprio 3
    s_cbranch_scc1 Llp_31
    s_setprio 1
Llp_31:
    ds_read_b64_tr_b16 v[124:125], v136 offset:13312
    s_waitcnt lgkmcnt(8)
    v_mfma_f32_16x16x32_bf16 v[32:35], v[112:115], v[72:75], v[32:35]
    ds_read_b64_tr_b16 v[126:127], v136 offset:13824
    s_waitcnt lgkmcnt(8)
    v_mfma_f32_16x16x32_bf16 v[36:39], v[112:115], v[76:79], v[36:39]
    ds_read_b128 v[88:91], v135 offset:0
    s_waitcnt lgkmcnt(8)
    v_mfma_f32_16x16x32_bf16 v[40:43], v[112:115], v[80:83], v[40:43]
    ds_read_b128 v[92:95], v135 offset:2048
    s_waitcnt lgkmcnt(8)
    v_mfma_f32_16x16x32_bf16 v[44:47], v[112:115], v[84:87], v[44:47]
    ds_read_b128 v[96:99], v135 offset:4096
    s_waitcnt lgkmcnt(7)
    v_mfma_f32_16x16x32_bf16 v[48:51], v[68:71], v[116:119], v[48:51]
    ds_read_b128 v[100:103], v135 offset:6144
    v_mfma_f32_16x16x32_bf16 v[52:55], v[72:75], v[116:119], v[52:55]
    ds_read_b128 v[104:107], v135 offset:8192
    v_mfma_f32_16x16x32_bf16 v[56:59], v[76:79], v[116:119], v[56:59]
    ds_read_b64_tr_b16 v[128:129], v136 offset:14336
    v_mfma_f32_16x16x32_bf16 v[60:63], v[80:83], v[116:119], v[60:63]
    ds_read_b64_tr_b16 v[130:131], v136 offset:14848
    v_mfma_f32_16x16x32_bf16 v[64:67], v[84:87], v[116:119], v[64:67]
    ds_read_b64_tr_b16 v[120:121], v136 offset:12288
    s_waitcnt lgkmcnt(10)
    v_mfma_f32_16x16x32_bf16 v[12:15], v[108:111], v[72:75], v[12:15]
    ds_read_b64_tr_b16 v[122:123], v136 offset:12800
    v_mfma_f32_16x16x32_bf16 v[16:19], v[108:111], v[76:79], v[16:19]
    ds_read_b64 v[6:7], v3 offset:384
    v_mfma_f32_16x16x32_bf16 v[20:23], v[108:111], v[80:83], v[20:23]
    v_mfma_f32_16x16x32_bf16 v[24:27], v[108:111], v[84:87], v[24:27]
    s_waitcnt lgkmcnt(0)
    v_mfma_f32_16x16x32_bf16 v[44:47], v[124:127], v[104:107], v[44:47]
    v_readfirstlane_b32 s90, v6
    v_readfirstlane_b32 s91, v7
    v_mfma_f32_16x16x32_bf16 v[24:27], v[120:123], v[104:107], v[24:27]
    v_mov_b64 v[70:71], 0
    v_mov_b64 v[74:75], 0
    v_mfma_f32_16x16x32_bf16 v[40:43], v[124:127], v[100:103], v[40:43]
    v_mov_b64 v[78:79], 0
    v_mov_b64 v[82:83], 0
    v_mfma_f32_16x16x32_bf16 v[20:23], v[120:123], v[100:103], v[20:23]
    v_mov_b32 v111, s33
    v_mov_b32 v115, s33
    v_mfma_f32_16x16x32_bf16 v[36:39], v[124:127], v[96:99], v[36:39]
    v_mov_b32 v119, s33
    v_mfma_f32_16x16x32_bf16 v[16:19], v[120:123], v[96:99], v[16:19]
    v_mfma_f32_16x16x32_bf16 v[32:35], v[124:127], v[92:95], v[32:35]
    v_mfma_f32_16x16x32_bf16 v[12:15], v[120:123], v[92:95], v[12:15]
    v_mfma_f32_16x16x32_bf16 v[28:31], v[124:127], v[88:91], v[28:31]
    s_branch L_gdone
L_padb10:
    s_branch L_padb18
L_gemm_40:
    s_barrier
    ds_read_b64_tr_b16 v[112:113], v136 offset:1024
    ds_read_b64_tr_b16 v[114:115], v136 offset:1536
    ds_read_b128 v[72:75], v134 offset:2048
    ds_read_b128 v[76:79], v134 offset:4096
    ds_read_b128 v[80:83], v134 offset:6144
    ds_read_b128 v[84:87], v134 offset:8192
    ds_read_b64_tr_b16 v[116:117], v136 offset:2048
    ds_read_b64_tr_b16 v[118:119], v136 offset:2560
    ds_read_b64_tr_b16 v[108:109], v136 offset:0
    ds_read_b64_tr_b16 v[110:111], v136 offset:512
L_gemm_4:
    s_waitcnt lgkmcnt(7)
    v_mfma_f32_16x16x32_bf16 v[32:35], v[112:115], v[72:75], v[32:35]
    s_setprio 1
    ds_read_b64_tr_b16 v[124:125], v136 offset:13312
    s_waitcnt lgkmcnt(7)
    v_mfma_f32_16x16x32_bf16 v[36:39], v[112:115], v[76:79], v[36:39]
    ds_read_b64_tr_b16 v[126:127], v136 offset:13824
    s_waitcnt lgkmcnt(7)
    v_mfma_f32_16x16x32_bf16 v[40:43], v[112:115], v[80:83], v[40:43]
    ds_read_b128 v[92:95], v135 offset:2048
    s_waitcnt lgkmcnt(7)
    v_mfma_f32_16x16x32_bf16 v[44:47], v[112:115], v[84:87], v[44:47]
    ds_read_b128 v[96:99], v135 offset:4096
    s_waitcnt lgkmcnt(6)
    v_mfma_f32_16x16x32_bf16 v[52:55], v[72:75], v[116:119], v[52:55]
    ds_read_b128 v[100:103], v135 offset:6144
    v_mfma_f32_16x16x32_bf16 v[56:59], v[76:79], v[116:119], v[56:59]
    ds_read_b128 v[104:107], v135 offset:8192
    v_mfma_f32_16x16x32_bf16 v[60:63], v[80:83], v[116:119], v[60:63]
    ds_read_b64_tr_b16 v[128:129], v136 offset:14336
    v_mfma_f32_16x16x32_bf16 v[64:67], v[84:87], v[116:119], v[64:67]
    ds_read_b64_tr_b16 v[130:131], v136 offset:14848
    s_waitcnt lgkmcnt(8)
    v_mfma_f32_16x16x32_bf16 v[12:15], v[108:111], v[72:75], v[12:15]
    ds_read_b64_tr_b16 v[120:121], v136 offset:12288
    v_mfma_f32_16x16x32_bf16 v[16:19], v[108:111], v[76:79], v[16:19]
    ds_read_b64_tr_b16 v[122:123], v136 offset:12800
    v_mfma_f32_16x16x32_bf16 v[20:23], v[108:111], v[80:83], v[20:23]
    v_mfma_f32_16x16x32_bf16 v[24:27], v[108:111], v[84:87], v[24:27]
    s_waitcnt lgkmcnt(7)
    v_mfma_f32_16x16x32_bf16 v[32:35], v[124:127], v[92:95], v[32:35]
    s_add_u32 s44, s44, 43008
    s_cmp_eq_u32 s44, 129024
    s_cselect_b32 s44, 0, s44
    v_add_u32 v134, s44, v132
    v_add_u32 v136, s44, v133
    s_waitcnt lgkmcnt(6)
    v_mfma_f32_16x16x32_bf16 v[36:39], v[124:127], v[96:99], v[36:39]
    s_waitcnt lgkmcnt(0)
    s_barrier
    s_setprio 2
    ds_read_b64_tr_b16 v[112:113], v136 offset:1024
    v_mfma_f32_16x16x32_bf16 v[40:43], v[124:127], v[100:103], v[40:43]
    ds_read_b64_tr_b16 v[114:115], v136 offset:1536
    v_mfma_f32_16x16x32_bf16 v[44:47], v[124:127], v[104:107], v[44:47]
    v_xor_b32 v135, 64, v134
    ds_read_b128 v[72:75], v134 offset:2048
    v_mfma_f32_16x16x32_bf16 v[52:55], v[92:95], v[128:131], v[52:55]
    ds_read_b128 v[76:79], v134 offset:4096
    v_mfma_f32_16x16x32_bf16 v[56:59], v[96:99], v[128:131], v[56:59]
    ds_read_b128 v[80:83], v134 offset:6144
    v_mfma_f32_16x16x32_bf16 v[60:63], v[100:103], v[128:131], v[60:63]
    ds_read_b128 v[84:87], v134 offset:8192
    v_mfma_f32_16x16x32_bf16 v[64:67], v[104:107], v[128:131], v[64:67]
    ds_read_b64_tr_b16 v[116:117], v136 offset:2048
    v_mfma_f32_16x16x32_bf16 v[12:15], v[120:123], v[92:95], v[12:15]
    ds_read_b64_tr_b16 v[118:119], v136 offset:2560
    v_mfma_f32_16x16x32_bf16 v[16:19], v[120:123], v[96:99], v[16:19]
    s_add_u32 s43, s43, 1
    ds_read_b64_tr_b16 v[108:109], v136 offset:0
    v_mfma_f32_16x16x32_bf16 v[20:23], v[120:123], v[100:103], v[20:23]
    s_cmp_lt_u32 s43, 9
    ds_read_b64_tr_b16 v[110:111], v136 offset:512
    v_mfma_f32_16x16x32_bf16 v[24:27], v[120:123], v[104:107], v[24:27]
    s_cbranch_scc1 L_gemm_4
    s_waitcnt lgkmcnt(7)
    v_mfma_f32_16x16x32_bf16 v[32:35], v[112:115], v[72:75], v[32:35]
    s_bitcmp1_b32 s45, 7
    s_setprio 3
    s_cbranch_scc1 Llp_32
    s_setprio 1
Llp_32:
    ds_read_b64_tr_b16 v[124:125], v136 offset:13312
    s_waitcnt lgkmcnt(7)
    v_mfma_f32_16x16x32_bf16 v[36:39], v[112:115], v[76:79], v[36:39]
    ds_read_b64_tr_b16 v[126:127], v136 offset:13824
    s_waitcnt lgkmcnt(7)
    v_mfma_f32_16x16x32_bf16 v[40:43], v[112:115], v[80:83], v[40:43]
    ds_read_b128 v[92:95], v135 offset:2048
    s_waitcnt lgkmcnt(7)
    v_mfma_f32_16x16x32_bf16 v[44:47], v[112:115], v[84:87], v[44:47]
    ds_read_b128 v[96:99], v135 offset:4096
    s_waitcnt lgkmcnt(6)
    v_mfma_f32_16x16x32_bf16 v[52:55], v[72:75], v[116:119], v[52:55]
    ds_read_b128 v[100:103], v135 offset:6144
    v_mfma_f32_16x16x32_bf16 v[56:59], v[76:79], v[116:119], v[56:59]
    ds_read_b128 v[104:107], v135 offset:8192
    v_mfma_f32_16x16x32_bf16 v[60:63], v[80:83], v[116:119], v[60:63]
    ds_read_b64_tr_b16 v[128:129], v136 offset:14336
    v_mfma_f32_16x16x32_bf16 v[64:67], v[84:87], v[116:119], v[64:67]
    ds_read_b64_tr_b16 v[130:131], v136 offset:14848
    s_waitcnt lgkmcnt(8)
    v_mfma_f32_16x16x32_bf16 v[12:15], v[108:111], v[72:75], v[12:15]
    ds_read_b64_tr_b16 v[120:121], v136 offset:12288
    v_mfma_f32_16x16x32_bf16 v[16:19], v[108:111], v[76:79], v[16:19]
    ds_read_b64_tr_b16 v[122:123], v136 offset:12800
    v_mfma_f32_16x16x32_bf16 v[20:23], v[108:111], v[80:83], v[20:23]
    ds_read_b64 v[6:7], v3 offset:384
    v_mfma_f32_16x16x32_bf16 v[24:27], v[108:111], v[84:87], v[24:27]
    s_waitcnt lgkmcnt(0)
    v_mfma_f32_16x16x32_bf16 v[44:47], v[124:127], v[104:107], v[44:47]
    v_readfirstlane_b32 s90, v6
    v_readfirstlane_b32 s91, v7
    v_mfma_f32_16x16x32_bf16 v[24:27], v[120:123], v[104:107], v[24:27]
    v_mov_b64 v[70:71], 0
    v_mov_b64 v[74:75], 0
    v_mfma_f32_16x16x32_bf16 v[40:43], v[124:127], v[100:103], v[40:43]
    v_mov_b64 v[78:79], 0
    v_mov_b64 v[82:83], 0
    v_mfma_f32_16x16x32_bf16 v[20:23], v[120:123], v[100:103], v[20:23]
    v_mov_b32 v111, s33
    v_mov_b32 v115, s33
    v_mfma_f32_16x16x32_bf16 v[36:39], v[124:127], v[96:99], v[36:39]
    v_mov_b32 v119, s33
    v_mfma_f32_16x16x32_bf16 v[16:19], v[120:123], v[96:99], v[16:19]
    v_mfma_f32_16x16x32_bf16 v[32:35], v[124:127], v[92:95], v[32:35]
    v_mfma_f32_16x16x32_bf16 v[12:15], v[120:123], v[92:95], v[12:15]
L_gdone:
    s_cmp_lg_u32 s90, s33
    s_cbranch_scc1 L_mslow
L_mback:
    s_cmp_eq_u32 s91, 1
    s_cselect_b32 s99, 0, 15728640
    s_add_u32 s16, s28, s99
    s_addc_u32 s17, s29, 0
    s_add_u32 s18, s16, 13107200
    s_addc_u32 s19, s17, 0
    s_cmp_eq_u32 s91, 1
    s_cselect_b64 s[18:19], s[24:25], s[18:19]
    s_bitcmp0_b32 s45, 7
    s_cbranch_scc1 L_full
    v_mov_b32 v5, 1
    v_cvt_pk_bf16_f32 v84, v44, v45
    v_cvt_pk_bf16_f32 v85, v46, v47
    ds_write_b64 v156, v[84:85] offset:6656
    ds_write_b32 v165, v5 offset:344
    v_cvt_pk_bf16_f32 v80, v40, v41
    s_branch L_skip2392
L_padb11:
    s_branch L_padb19
L_skip2392:
    v_cvt_pk_bf16_f32 v81, v42, v43
    v_cvt_pk_bf16_f32 v76, v36, v37
    v_cvt_pk_bf16_f32 v77, v38, v39
    v_cvt_pk_bf16_f32 v72, v32, v33
    v_cvt_pk_bf16_f32 v73, v34, v35
    s_mov_b32 s100, 0
    s_cmp_eq_u32 s42, 0
    s_cbranch_scc1 L_l_k0
    ds_read_b32 v4, v165 offset:340
    ds_read_b64 v[68:69], v156 offset:4608
    s_branch L_l_k1
L_l_k0:
    v_cvt_pk_bf16_f32 v68, v28, v29
    v_cvt_pk_bf16_f32 v69, v30, v31
    v_mov_b32 v4, 1
L_l_k1:
    s_mov_b64 exec, s[50:51]
    v_cvt_pk_bf16_f32 v82, v24, v25
    v_cvt_pk_bf16_f32 v83, v26, v27
    v_cvt_pk_bf16_f32 v78, v20, v21
    v_cvt_pk_bf16_f32 v79, v22, v23
    v_cvt_pk_bf16_f32 v74, v16, v17
    v_cvt_pk_bf16_f32 v75, v18, v19
    v_cvt_pk_bf16_f32 v70, v12, v13
    v_cvt_pk_bf16_f32 v71, v14, v15
    s_mov_b64 exec, -1
    v_mfma_f32_16x16x16_bf16 v[40:43], v[84:85], v[82:83], v[144:147]
    v_cvt_pk_bf16_f32 v24, v24, v25
    v_cvt_pk_bf16_f32 v25, v26, v27
    v_mfma_f32_16x16x16_bf16 v[124:127], v[80:81], v[82:83], v[148:151]
    v_mfma_f32_16x16x16_bf16 v[36:39], v[80:81], v[78:79], v[144:147]
    v_cvt_pk_bf16_f32 v20, v20, v21
    v_cvt_pk_bf16_f32 v21, v22, v23
    v_mfma_f32_16x16x16_bf16 v[120:123], v[76:77], v[78:79], v[148:151]
    v_mfma_f32_16x16x16_bf16 v[32:35], v[76:77], v[74:75], v[144:147]
    v_cvt_pk_bf16_f32 v16, v16, v17
    v_cvt_pk_bf16_f32 v17, v18, v19
    v_mfma_f32_16x16x16_bf16 v[8:11], v[72:73], v[74:75], v[148:151]
    v_mfma_f32_16x16x16_bf16 v[28:31], v[72:73], v[70:71], v[144:147]
    v_cvt_pk_bf16_f32 v12, v12, v13
    v_cvt_pk_bf16_f32 v13, v14, v15
L_l_kw:
    s_waitcnt lgkmcnt(0)
    v_readfirstlane_b32 s96, v4
    s_cmp_eq_u32 s96, 0
    s_cbranch_scc1 L_l_kslow
L_l_kok:
    v_mfma_f32_16x16x16_bf16 v[44:47], v[68:69], v[70:71], v[140:143]
    ds_write_b64 v156, v[80:81] offset:6144
    ds_write_b64 v156, v[24:25] offset:2048
    v_max3_f32 v110, v40, v41, v124
    v_max3_f32 v114, v42, v43, v126
    v_max_f32 v110, v110, v125
    v_max_f32 v114, v114, v127
    ds_write_b64 v156, v[76:77] offset:5632
    ds_write_b64 v156, v[20:21] offset:1536
    v_max3_f32 v116, v36, v37, v120
    v_max3_f32 v117, v38, v39, v122
    v_max_f32 v116, v116, v121
    v_max_f32 v117, v117, v123
    ds_write_b64 v156, v[72:73] offset:5120
    ds_write_b64 v156, v[16:17] offset:1024
    v_max3_f32 v112, v32, v33, v8
    v_max3_f32 v113, v34, v35, v10
    v_max_f32 v112, v112, v9
    v_max_f32 v113, v113, v11
    ds_write_b64 v156, v[68:69] offset:4608
    ds_write_b64 v156, v[12:13] offset:512
    ds_write_b32 v165, v5 offset:128
    v_max3_f32 v108, v28, v29, v44
    v_max3_f32 v109, v30, v31, v46
    v_max_f32 v108, v108, v45
    v_max_f32 v109, v109, v47
    s_cmp_lg_u32 s91, 1
    s_cbranch_scc1 Ldg_33
    global_store_dwordx4 v158, v[116:119], s[16:17] offset:2048
    global_store_dwordx4 v158, v[112:115], s[16:17] offset:1024
    global_store_dwordx4 v158, v[108:111], s[16:17] offset:0
    s_branch Ldd_34
Ldg_33:
    global_store_dwordx4 v158, v[116:119], s[16:17] offset:2048 sc1
    global_store_dwordx4 v158, v[112:115], s[16:17] offset:1024 sc1
    global_store_dwordx4 v158, v[108:111], s[16:17] offset:0 sc1
Ldd_34:
    s_setprio 1
    v_mfma_f32_16x16x32_bf16 v[64:67], v[104:107], v[128:131], v[64:67]
    v_mfma_f32_16x16x32_bf16 v[60:63], v[100:103], v[128:131], v[60:63]
    v_mfma_f32_16x16x32_bf16 v[56:59], v[96:99], v[128:131], v[56:59]
    v_mfma_f32_16x16x32_bf16 v[52:55], v[92:95], v[128:131], v[52:55]
    s_cmp_lg_u32 s42, 0
    s_cbranch_scc1 L_nv_l
    v_mfma_f32_16x16x32_bf16 v[48:51], v[88:91], v[128:131], v[48:51]
L_nv_l:
    s_nop 2
    v_cvt_pk_bf16_f32 v88, v64, v65
    v_cvt_pk_bf16_f32 v89, v66, v67
    s_waitcnt lgkmcnt(6)
    ds_write_b64 v156, v[88:89] offset:11264
    v_cvt_pk_bf16_f32 v90, v60, v61
    v_cvt_pk_bf16_f32 v91, v62, v63
    ds_write_b64 v156, v[90:91] offset:10752
    v_cvt_pk_bf16_f32 v92, v56, v57
    v_cvt_pk_bf16_f32 v93, v58, v59
    ds_write_b64 v156, v[92:93] offset:10240
    v_cvt_pk_bf16_f32 v94, v52, v53
    v_cvt_pk_bf16_f32 v95, v54, v55
    ds_write_b64 v156, v[94:95] offset:9728
    s_cmp_lg_u32 s42, 0
    s_cbranch_scc1 L_l_nv0
    v_cvt_pk_bf16_f32 v96, v48, v49
    v_cvt_pk_bf16_f32 v97, v50, v51
    ds_write_b64 v156, v[96:97] offset:9216
    ds_write_b32 v165, v5 offset:160
    s_branch L_l_v0
L_l_nv0:
    ds_write_b32 v165, v5 offset:160
    s_mov_b32 s100, 0
Lm_35:
    ds_read_b32 v4, v163
    s_waitcnt lgkmcnt(0)
    v_cmp_eq_u32 vcc, 0, v4
    s_and_b32 s99, vcc_lo, s49
    s_cbranch_scc0 Lmd_36
    s_add_u32 s100, s100, 1
    s_cmp_lt_u32 s100, 1048576
    s_cbranch_scc1 Lm_35
Lmd_36:
    ds_read_b64 v[96:97], v156 offset:9216
L_l_v0:
    s_setprio 0
    s_mov_b32 s100, 0
L_xp:
    global_load_dwordx4 v[28:31], v159, s[16:17] offset:0 sc1
    global_load_dwordx4 v[32:35], v159, s[16:17] offset:1024 sc1
    global_load_dwordx4 v[36:39], v159, s[16:17] offset:2048 sc1
    s_waitcnt vmcnt(0)
    v_cmp_ne_u32 vcc, s33, v31
    v_cmp_ne_u32 s[60:61], s33, v35
    v_cmp_ne_u32 s[62:63], s33, v39
    s_or_b64 vcc, vcc, s[60:61]
    s_or_b64 vcc, vcc, s[62:63]
    s_cbranch_scc0 L_xpd
    s_add_u32 s100, s100, 1
    s_cmp_lt_u32 s100, 1048576
    s_cbranch_scc1 L_xp
L_xpd:
    s_setprio 2
    v_pk_add_f32 v[68:69], v[108:109], v[28:29]
    v_pk_add_f32 v[70:71], v[112:113], v[32:33]
    v_pk_add_f32 v[72:73], v[116:117], v[36:37]
    v_add_f32 v74, v110, v30
    v_add_f32 v75, v114, v34
    s_branch L_soft
L_l_kslow:
    ds_read_b32 v4, v165 offset:340
    ds_read_b64 v[68:69], v156 offset:4608
    s_add_u32 s100, s100, 1
    s_cmp_lt_u32 s100, 1048576
    s_cbranch_scc1 L_l_kw
    s_waitcnt lgkmcnt(0)
    s_branch L_l_kok
L_padb12:
    s_branch L_padb20
L_mslow:
    s_lshl_b32 s98, s30, 5
    s_add_u32 s98, s98, s31
    s_lshl_b32 s98, s98, 8
    s_add_u32 s98, s98, 65536
    s_add_u32 s98, s98, 128
    s_mov_b32 s100, 0
Lc_37:
    s_load_dwordx4 s[88:91], s[28:29], s98 glc
    s_waitcnt lgkmcnt(0)
    s_cmp_eq_u32 s90, s33
    s_cbranch_scc1 Lcd_38
    s_sleep 2
    s_add_u32 s100, s100, 1
    s_cmp_lt_u32 s100, 1048576
    s_cbranch_scc1 Lc_37
    s_mov_b32 s91, 2
Lcd_38:
    s_branch L_mback
L_full:
    v_mfma_f32_16x16x32_bf16 v[64:67], v[104:107], v[128:131], v[64:67]
    v_mfma_f32_16x16x32_bf16 v[60:63], v[100:103], v[128:131], v[60:63]
    v_mfma_f32_16x16x32_bf16 v[56:59], v[96:99], v[128:131], v[56:59]
    v_mfma_f32_16x16x32_bf16 v[52:55], v[92:95], v[128:131], v[52:55]
    s_cmp_lg_u32 s42, 0
    s_cbranch_scc1 L_nv_f
    v_mfma_f32_16x16x32_bf16 v[48:51], v[88:91], v[128:131], v[48:51]
L_nv_f:
    s_setprio 2
    v_cvt_pk_bf16_f32 v124, v44, v45
    v_cvt_pk_bf16_f32 v125, v46, v47
    v_cvt_pk_bf16_f32 v120, v40, v41
    v_cvt_pk_bf16_f32 v121, v42, v43
    v_cvt_pk_bf16_f32 v116, v36, v37
    v_cvt_pk_bf16_f32 v117, v38, v39
    v_cvt_pk_bf16_f32 v112, v32, v33
    v_cvt_pk_bf16_f32 v113, v34, v35
    v_cvt_pk_bf16_f32 v68, v12, v13
    v_cvt_pk_bf16_f32 v69, v14, v15
    v_cvt_pk_bf16_f32 v72, v16, v17
    v_cvt_pk_bf16_f32 v73, v18, v19
    v_cvt_pk_bf16_f32 v76, v20, v21
    v_cvt_pk_bf16_f32 v77, v22, v23
    v_cvt_pk_bf16_f32 v80, v24, v25
    v_cvt_pk_bf16_f32 v81, v26, v27
    v_cvt_pk_bf16_f32 v88, v64, v65
    v_cvt_pk_bf16_f32 v89, v66, v67
    s_cmp_lg_u32 s42, 0
    s_cbranch_scc1 L_f_nb
    ds_write_b64 v164, v[124:125]
    ds_write_b64 v164, v[88:89] offset:512
    v_mov_b32 v5, 1
    ds_write_b32 v165, v5 offset:128
    v_cvt_pk_bf16_f32 v108, v28, v29
    v_cvt_pk_bf16_f32 v109, v30, v31
    v_cvt_pk_bf16_f32 v96, v48, v49
    v_cvt_pk_bf16_f32 v97, v50, v51
L_f_nb:
    v_cvt_pk_bf16_f32 v94, v52, v53
    v_cvt_pk_bf16_f32 v95, v54, v55
    v_cvt_pk_bf16_f32 v92, v56, v57
    v_cvt_pk_bf16_f32 v93, v58, v59
    v_cvt_pk_bf16_f32 v90, v60, v61
    v_cvt_pk_bf16_f32 v91, v62, v63
    s_mov_b32 s100, 0
Lm_39:
    ds_read_b32 v4, v163
    s_waitcnt lgkmcnt(0)
    v_cmp_eq_u32 vcc, 0, v4
    s_and_b32 s99, vcc_lo, s48
    s_cbranch_scc0 Lmd_40
    s_add_u32 s100, s100, 1
    s_cmp_lt_u32 s100, 1048576
    s_cbranch_scc1 Lm_39
Lmd_40:
    s_cmp_eq_u32 s42, 0
    s_cbranch_scc1 L_f_nr
    ds_read_b64 v[108:109], v164
    ds_read_b64 v[96:97], v164 offset:512
L_f_nr:
    s_mov_b64 exec, s[52:53]
    ds_read_b64 v[70:71], v156 offset:512
    ds_read_b64 v[74:75], v156 offset:1024
    ds_read_b64 v[78:79], v156 offset:1536
    ds_read_b64 v[82:83], v156 offset:2048
    s_mov_b64 exec, -1
    ds_read_b64 v[110:111], v156 offset:4608
    ds_read_b64 v[114:115], v156 offset:5120
    ds_read_b64 v[118:119], v156 offset:5632
    ds_read_b64 v[122:123], v156 offset:6144
    ds_read_b64 v[126:127], v156 offset:6656
    s_waitcnt lgkmcnt(3)
    v_mfma_f32_16x16x32_bf16 v[8:11], v[112:115], v[68:71], v[144:147]
    v_mfma_f32_16x16x32_bf16 v[24:27], v[108:111], v[68:71], v[140:143]
    s_waitcnt lgkmcnt(2)
    v_mfma_f32_16x16x32_bf16 v[12:15], v[116:119], v[72:75], v[144:147]
    v_mfma_f32_16x16x32_bf16 v[28:31], v[112:115], v[72:75], v[148:151]
    s_waitcnt lgkmcnt(1)
    v_mfma_f32_16x16x32_bf16 v[16:19], v[120:123], v[76:79], v[144:147]
    v_mfma_f32_16x16x32_bf16 v[32:35], v[116:119], v[76:79], v[148:151]
    s_waitcnt lgkmcnt(0)
    v_mfma_f32_16x16x32_bf16 v[20:23], v[124:127], v[80:83], v[144:147]
    v_mfma_f32_16x16x32_bf16 v[36:39], v[120:123], v[80:83], v[148:151]
    v_max3_f32 v68, v8, v9, v24
    v_max3_f32 v69, v10, v11, v26
    v_max_f32 v68, v68, v25
    v_max_f32 v69, v69, v27
    v_max3_f32 v70, v12, v13, v28
    v_max3_f32 v71, v14, v15, v30
    v_max_f32 v70, v70, v29
    v_max_f32 v71, v71, v31
    v_max3_f32 v72, v16, v17, v32
    v_max3_f32 v73, v18, v19, v34
    v_max_f32 v72, v72, v33
    v_max_f32 v73, v73, v35
    v_max3_f32 v74, v20, v21, v36
    v_max3_f32 v75, v22, v23, v38
    v_max_f32 v74, v74, v37
    v_max_f32 v75, v75, v39
L_soft:
    v_max_f32 v76, v68, v69
    v_max_f32 v77, v70, v71
    v_max_f32 v78, v72, v73
    v_max_f32 v79, v74, v75
    v_mov_b32 v84, 0x3f803f80
    v_permlane32_swap_b32 v76, v77
    v_permlane32_swap_b32 v78, v79
    v_max_f32 v76, v76, v77
    v_max_f32 v78, v78, v79
    v_mov_b32 v85, 0x3f803f80
    v_mov_b32 v86, 0x3f803f80
    v_permlane16_swap_b32 v76, v78
    v_max_f32 v76, v76, v78
    v_mul_f32 v78, s54, v76
    v_mul_f32 v76, s54, v76
    v_mov_b32 v87, 0x3f803f80
    v_mov_b32 v4, 1
    v_permlane16_swap_b32 v76, v78
    v_mov_b32 v77, v76
    v_mov_b32 v79, v78
    s_waitcnt lgkmcnt(0)
    v_permlane32_swap_b32 v76, v77
    v_permlane32_swap_b32 v78, v79
    v_fma_f32 v68, v68, s54, -v76
    v_fma_f32 v69, v69, s54, -v76
    v_fma_f32 v70, v70, s54, -v77
    v_fma_f32 v71, v71, s54, -v77
    v_fma_f32 v72, v72, s54, -v78
    v_fma_f32 v73, v73, s54, -v78
    v_fma_f32 v74, v74, s54, -v79
    v_fma_f32 v75, v75, s54, -v79
    s_bitcmp1_b32 s45, 7
    s_cbranch_scc1 L_novx
    ds_read_b32 v6, v163
    ds_read_b64 v[106:107], v162 offset:9216
    ds_read_b64 v[104:105], v162 offset:9728
    ds_read_b64 v[102:103], v162 offset:10240
    ds_read_b64 v[100:101], v162 offset:10752
    ds_read_b64 v[98:99], v162 offset:11264
L_novx:
    v_exp_f32 v68, v68
    v_exp_f32 v69, v69
    v_exp_f32 v70, v70
    v_exp_f32 v71, v71
    s_branch L_skip2717
L_padb13:
    s_branch L_warmed_b
L_skip2717:
    v_exp_f32 v72, v72
    v_exp_f32 v73, v73
    v_exp_f32 v74, v74
    v_exp_f32 v75, v75
    v_cvt_pk_bf16_f32 v80, v68, v69
    v_perm_b32 v108, v80, v80, v152
    v_perm_b32 v109, v80, v80, v153
    v_perm_b32 v110, v80, v80, v154
    v_perm_b32 v111, v80, v80, v155
    v_cvt_pk_bf16_f32 v81, v70, v71
    v_perm_b32 v112, v81, v81, v152
    v_perm_b32 v113, v81, v81, v153
    v_perm_b32 v114, v81, v81, v154
    v_perm_b32 v115, v81, v81, v155
    v_mfma_f32_16x16x32_bf16 v[24:27], v[84:87], v[108:111], 0
    v_mfma_f32_16x16x32_bf16 v[8:11], v[94:97], v[108:111], 0
    v_cvt_pk_bf16_f32 v82, v72, v73
    v_perm_b32 v116, v82, v82, v152
    v_perm_b32 v117, v82, v82, v153
    v_perm_b32 v118, v82, v82, v154
    v_perm_b32 v119, v82, v82, v155
    v_mfma_f32_16x16x32_bf16 v[28:31], v[84:87], v[112:115], 0
    v_mfma_f32_16x16x32_bf16 v[12:15], v[92:95], v[112:115], 0
    v_cvt_pk_bf16_f32 v83, v74, v75
    v_perm_b32 v120, v83, v83, v152
    v_perm_b32 v121, v83, v83, v153
    v_perm_b32 v122, v83, v83, v154
    v_perm_b32 v123, v83, v83, v155
    v_mfma_f32_16x16x32_bf16 v[32:35], v[84:87], v[116:119], 0
    v_mfma_f32_16x16x32_bf16 v[16:19], v[90:93], v[116:119], 0
    s_bitcmp1_b32 s45, 7
    v_mfma_f32_16x16x32_bf16 v[36:39], v[84:87], v[120:123], 0
    v_mfma_f32_16x16x32_bf16 v[20:23], v[88:91], v[120:123], 0
    s_cbranch_scc1 L_norem
    s_mov_b32 s100, 0
L_vxw:
    s_waitcnt lgkmcnt(0)
    v_cmp_eq_u32 vcc, 0, v6
    s_and_b32 s99, vcc_lo, s49
    s_cbranch_scc1 L_vxslow
L_vxok:
    v_mfma_f32_16x16x32_bf16 v[40:43], v[104:107], v[108:111], 0
    v_mfma_f32_16x16x32_bf16 v[44:47], v[102:105], v[112:115], 0
    v_mfma_f32_16x16x32_bf16 v[48:51], v[100:103], v[116:119], 0
    v_mfma_f32_16x16x32_bf16 v[52:55], v[98:101], v[120:123], 0
L_norem:
    s_mov_b64 exec, 1
    ds_add_u32 v3, v4 offset:196
    s_mov_b64 exec, -1
    v_rcp_f32 v24, v24
    v_rcp_f32 v28, v28
    v_rcp_f32 v32, v32
    v_rcp_f32 v36, v36
    v_pk_mul_f32 v[8:9], v[8:9], v[24:25] op_sel_hi:[1,0]
    v_pk_mul_f32 v[10:11], v[10:11], v[24:25] op_sel_hi:[1,0]
    v_pk_mul_f32 v[12:13], v[12:13], v[28:29] op_sel_hi:[1,0]
    v_pk_mul_f32 v[14:15], v[14:15], v[28:29] op_sel_hi:[1,0]
    v_pk_mul_f32 v[16:17], v[16:17], v[32:33] op_sel_hi:[1,0]
    v_pk_mul_f32 v[18:19], v[18:19], v[32:33] op_sel_hi:[1,0]
    v_pk_mul_f32 v[20:21], v[20:21], v[36:37] op_sel_hi:[1,0]
    v_pk_mul_f32 v[22:23], v[22:23], v[36:37] op_sel_hi:[1,0]
    v_cvt_pk_bf16_f32 v56, v8, v9
    v_cvt_pk_bf16_f32 v57, v10, v11
    v_cvt_pk_bf16_f32 v58, v12, v13
    v_cvt_pk_bf16_f32 v59, v14, v15
    v_cvt_pk_bf16_f32 v60, v16, v17
    v_cvt_pk_bf16_f32 v61, v18, v19
    v_cvt_pk_bf16_f32 v62, v20, v21
    v_cvt_pk_bf16_f32 v63, v22, v23
    s_mov_b64 exec, s[50:51]
    s_cmp_lg_u32 s91, 1
    s_cbranch_scc1 Ldg_41
    global_store_dwordx2 v160, v[56:57], s[18:19] offset:0
    global_store_dwordx2 v160, v[58:59], s[18:19] offset:1024
    global_store_dwordx2 v157, v[60:61], s[18:19] offset:0
    global_store_dwordx2 v157, v[62:63], s[18:19] offset:1024
    s_branch Ldd_42
Ldg_41:
    global_store_dwordx2 v160, v[56:57], s[18:19] offset:0 sc1
    global_store_dwordx2 v160, v[58:59], s[18:19] offset:1024 sc1
    global_store_dwordx2 v157, v[60:61], s[18:19] offset:0 sc1
    global_store_dwordx2 v157, v[62:63], s[18:19] offset:1024 sc1
Ldd_42:
    s_mov_b64 exec, -1
    s_bitcmp1_b32 s45, 7
    s_cbranch_scc1 L_norem2
    v_pk_mul_f32 v[64:65], v[40:41], v[24:25] op_sel_hi:[1,0]
    v_pk_mul_f32 v[66:67], v[42:43], v[24:25] op_sel_hi:[1,0]
    s_mov_b32 exec_lo, 0xffff0000
    v_pk_mul_f32 v[64:65], v[44:45], v[28:29] op_sel_hi:[1,0]
    v_pk_mul_f32 v[66:67], v[46:47], v[28:29] op_sel_hi:[1,0]
    s_mov_b32 exec_lo, 0
    v_pk_mul_f32 v[64:65], v[48:49], v[32:33] op_sel_hi:[1,0]
    v_pk_mul_f32 v[66:67], v[50:51], v[32:33] op_sel_hi:[1,0]
    s_mov_b32 exec_hi, 0xffff0000
    v_pk_mul_f32 v[64:65], v[52:53], v[36:37] op_sel_hi:[1,0]
    v_pk_mul_f32 v[66:67], v[54:55], v[36:37] op_sel_hi:[1,0]
    s_mov_b64 exec, -1
    v_cvt_pk_bf16_f32 v64, v64, v65
    v_cvt_pk_bf16_f32 v65, v66, v67
    s_cmp_lg_u32 s91, 1
    s_cbranch_scc1 Ldg_43
    global_store_dwordx2 v161, v[64:65], s[18:19]
    s_branch Ldd_44
Ldg_43:
    global_store_dwordx2 v161, v[64:65], s[18:19] sc1
Ldd_44:
L_norem2:
    v_mov_b32 v6, s55
    v_mov_b32 v5, s33
    s_mov_b64 exec, 1
    ds_add_u32 v3, v4 offset:268
    s_waitcnt vmcnt(0)
    s_cmp_lg_u32 s91, 1
    s_cbranch_scc1 Ldg_45
    global_store_dword v6, v5, s[16:17]
    s_branch Ldd_46
L_pada7:
    s_branch L_pada15
L_padb14:
    s_branch L_warmed_b
Ldg_45:
    global_store_dword v6, v5, s[16:17] sc1
Ldd_46:
    s_mov_b64 exec, -1
L_tail:
    s_lshl_b32 s96, s57, 2
    v_add_u32 v136, s96, v3
    s_add_u32 s62, s18, 8192
    s_addc_u32 s63, s19, 0
    s_add_u32 s64, s18, 16384
    s_addc_u32 s65, s19, 0
    s_setprio 2
    s_cmp_eq_u32 s57, 0
    s_cbranch_scc1 L_tp
    s_setprio 1
L_tp:
    v_mov_b32 v135, 0
    v_lshl_add_u32 v137, v0, 4, s84
    s_lshl_b32 s96, s56, 2
    v_add_u32 v160, s96, v3
    s_cmp_lg_u32 s34, 0
    s_cbranch_scc1 L_opa
    s_mov_b32 s100, 0
Lw_47:
    ds_read_b32 v4, v3 offset:268
    s_waitcnt lgkmcnt(0)
    v_readfirstlane_b32 s99, v4
    s_cmp_ge_u32 s99, 64
    s_cbranch_scc1 Lwd_48
    s_add_u32 s100, s100, 1
    s_cmp_lt_u32 s100, 1048576
    s_cbranch_scc1 Lw_47
Lwd_48:
    s_cmp_lg_u32 s57, 0
    s_cbranch_scc1 L_prep
L_opb:
    s_mov_b32 s100, 0
Lw_49:
    ds_read_b32 v4, v136 offset:200
    s_waitcnt lgkmcnt(0)
    v_readfirstlane_b32 s99, v4
    s_cmp_ge_u32 s99, 4
    s_cbranch_scc1 Lwd_50
    s_sleep 1
    s_add_u32 s100, s100, 1
    s_cmp_lt_u32 s100, 1048576
    s_cbranch_scc1 Lw_49
Lwd_50:
    ds_read_b128 v[68:71], v138 offset:0
    ds_read_b128 v[72:75], v138 offset:1024
    ds_read_b128 v[76:79], v138 offset:2048
    ds_read_b128 v[80:83], v138 offset:3072
    ds_read_b128 v[84:87], v138 offset:4096
    ds_read_b128 v[88:91], v138 offset:5120
    ds_read_b128 v[92:95], v138 offset:6144
    ds_read_b128 v[96:99], v138 offset:7168
    ds_read_b128 v[100:103], v138 offset:8192
    ds_read_b128 v[104:107], v138 offset:9216
    ds_read_b128 v[108:111], v138 offset:10240
    ds_read_b128 v[112:115], v138 offset:11264
    s_waitcnt lgkmcnt(8)
    ds_read_b128 v[116:119], v138 offset:12288
    ds_read_b128 v[120:123], v138 offset:13312
    ds_read_b128 v[124:127], v138 offset:14336
    ds_read_b128 v[128:131], v138 offset:15360
    s_cmp_eq_u32 s57, 0
    s_cbranch_scc1 L_opp
L_lgo:
    s_mov_b32 s100, 0
Lw_51:
    ds_read_b32 v4, v160 offset:216
    s_waitcnt lgkmcnt(0)
    v_readfirstlane_b32 s99, v4
    s_cmp_ge_u32 s99, 1
    s_cbranch_scc1 Lwd_52
    s_sleep 1
    s_add_u32 s100, s100, 1
    s_cmp_lt_u32 s100, 1048576
    s_cbranch_scc1 Lw_51
Lwd_52:
    s_branch L_late
L_opp:
    s_mov_b32 exec_hi, 0xfffff
    s_mov_b32 exec_lo, 0xfffff
    s_mov_b32 s100, 0
L_op:
    global_load_dword v4, v166, s[16:17] sc1
    s_waitcnt vmcnt(0)
    v_cmp_ne_u32 vcc, s33, v4
    s_cbranch_vccz L_opd
    s_add_u32 s100, s100, 1
    s_cmp_lt_u32 s100, 1048576
    s_cbranch_scc1 L_op
    s_branch L_opd
L_opa:
    s_cmp_eq_u32 s57, 0
    s_cbranch_scc1 L_opa1
    s_mov_b32 s100, 0
Lw_53:
    ds_read_b32 v4, v3 offset:376
    s_waitcnt lgkmcnt(0)
    v_readfirstlane_b32 s99, v4
    s_cmp_ge_u32 s99, 2
    s_cbranch_scc1 Lwd_54
    s_sleep 1
    s_add_u32 s100, s100, 1
    s_cmp_lt_u32 s100, 1048576
    s_cbranch_scc1 Lw_53
Lwd_54:
    s_setprio 3
    s_branch L_prep
L_pada8:
    s_branch L_pada16
L_padb15:
    s_branch L_warmed_b
L_opa1:
    s_mov_b32 s100, 0
Lw_55:
    ds_read_b32 v4, v3 offset:200
    s_waitcnt lgkmcnt(0)
    v_readfirstlane_b32 s99, v4
    s_cmp_ge_u32 s99, 4
    s_cbranch_scc1 Lwd_56
    s_sleep 1
    s_add_u32 s100, s100, 1
    s_cmp_lt_u32 s100, 1048576
    s_cbranch_scc1 Lw_55
Lwd_56:
    ds_read_b128 v[68:71], v138 offset:0
    ds_read_b128 v[72:75], v138 offset:1024
    ds_read_b128 v[76:79], v138 offset:2048
    ds_read_b128 v[80:83], v138 offset:3072
    ds_read_b128 v[84:87], v138 offset:4096
    ds_read_b128 v[88:91], v138 offset:5120
    ds_read_b128 v[92:95], v138 offset:6144
    ds_read_b128 v[96:99], v138 offset:7168
    ds_read_b128 v[100:103], v138 offset:8192
    ds_read_b128 v[104:107], v138 offset:9216
    ds_read_b128 v[108:111], v138 offset:10240
    ds_read_b128 v[112:115], v138 offset:11264
    s_waitcnt lgkmcnt(8)
    ds_read_b128 v[116:119], v138 offset:12288
    ds_read_b128 v[120:123], v138 offset:13312
    ds_read_b128 v[124:127], v138 offset:14336
    ds_read_b128 v[128:131], v138 offset:15360
    s_mov_b32 s100, 0
Lw_57:
    ds_read_b32 v4, v3 offset:276
    s_waitcnt lgkmcnt(0)
    v_readfirstlane_b32 s99, v4
    s_cmp_ge_u32 s99, 1
    s_cbranch_scc1 Lwd_58
    s_sleep 1
    s_add_u32 s100, s100, 1
    s_cmp_lt_u32 s100, 1048576
    s_cbranch_scc1 Lw_57
Lwd_58:
L_opd:
    s_mov_b64 exec, -1
    s_cmp_eq_u32 s57, 0
    s_cbranch_scc1 L_early
L_late:
    global_load_dwordx4 v[28:31], v139, s[18:19] offset:-4096 sc1
    global_load_dwordx4 v[32:35], v139, s[18:19] offset:-2048 sc1
    global_load_dwordx4 v[36:39], v139, s[18:19] offset:0 sc1
    global_load_dwordx4 v[40:43], v139, s[18:19] offset:2048 sc1
    global_load_dwordx4 v[44:47], v139, s[62:63] offset:-4096 sc1
    global_load_dwordx4 v[48:51], v139, s[62:63] offset:-2048 sc1
    global_load_dwordx4 v[52:55], v139, s[62:63] offset:0 sc1
    global_load_dwordx4 v[56:59], v139, s[62:63] offset:2048 sc1
    global_load_dwordx4 v[60:63], v139, s[64:65] offset:-4096 sc1
    global_load_dwordx4 v[64:67], v139, s[64:65] offset:-2048 sc1
    s_lshr_b32 s96, s56, 1
    s_lshl_b32 s96, s96, 7
    s_add_u32 s96, s96, 3072
    v_add_u32 v166, s96, v166
    v_mov_b32 v134, s33
    s_and_b32 s96, s56, 1
    s_lshl1_add_u32 s96, s96, s57
    s_lshl2_add_u32 s96, s36, s96
    s_lshl_b64 s[66:67], 1, s96
    s_cmp_eq_u32 s34, 0
    s_cbranch_scc1 L_nogq
    s_mov_b32 s100, 0
Lw_59:
    ds_read_b32 v4, v3 offset:204
    s_waitcnt lgkmcnt(0)
    v_readfirstlane_b32 s99, v4
    s_cmp_ge_u32 s99, 4
    s_cbranch_scc1 Lwd_60
    s_sleep 1
    s_add_u32 s100, s100, 1
    s_cmp_lt_u32 s100, 1048576
    s_cbranch_scc1 Lw_59
Lwd_60:
    ds_read_b128 v[68:71], v138 offset:0
    ds_read_b128 v[72:75], v138 offset:1024
    ds_read_b128 v[76:79], v138 offset:2048
    ds_read_b128 v[80:83], v138 offset:3072
    ds_read_b128 v[84:87], v138 offset:4096
    ds_read_b128 v[88:91], v138 offset:5120
    ds_read_b128 v[92:95], v138 offset:6144
    ds_read_b128 v[96:99], v138 offset:7168
    ds_read_b128 v[100:103], v138 offset:8192
    ds_read_b128 v[104:107], v138 offset:9216
    ds_read_b128 v[108:111], v138 offset:10240
    ds_read_b128 v[112:115], v138 offset:11264
    s_waitcnt lgkmcnt(8)
    ds_read_b128 v[116:119], v138 offset:12288
    ds_read_b128 v[120:123], v138 offset:13312
    ds_read_b128 v[124:127], v138 offset:14336
    ds_read_b128 v[128:131], v138 offset:15360
    s_branch L_nogq
L_pada9:
    s_branch L_pada17
L_padb16:
    s_branch L_warmed_b
    s_setprio 3
    s_waitcnt lgkmcnt(6)
L_prep:
    s_lshl_b32 s96, s56, 6
    s_add_u32 s96, s96, 161280
    v_lshl_add_u32 v164, v1, 2, s96
    v_mul_u32_u24 v161, 160, v1
    v_lshl_add_u32 v161, v2, 3, v161
    v_add_u32 v5, s81, v161
    s_mov_b32 s100, 0
Lw_61:
    ds_read_b32 v4, v3 offset:208
    s_waitcnt lgkmcnt(0)
    v_readfirstlane_b32 s99, v4
    s_cmp_ge_u32 s99, 1
    s_cbranch_scc1 Lwd_62
    s_add_u32 s100, s100, 1
    s_cmp_lt_u32 s100, 1048576
    s_cbranch_scc1 Lw_61
Lwd_62:
    ds_read2st64_b32 v[162:163], v164 offset0:0 offset1:1
    ds_read_b64 v[150:151], v5 offset:0
    ds_read_b64 v[152:153], v5 offset:32
    ds_read_b64 v[154:155], v5 offset:64
    ds_read_b64 v[156:157], v5 offset:96
    ds_read_b64 v[158:159], v5 offset:128
    v_add_u32 v161, s84, v161
    v_add_u32 v5, 0, v0
    v_mul_u32_u24 v165, 6554, v5
    v_lshrrev_b32 v165, 16, v165
    v_mul_u32_u24 v165, 1120, v165
    v_lshl_add_u32 v5, v5, 4, s85
    v_add_u32 v165, v165, v5
    v_add_u32 v5, 64, v0
    v_mul_u32_u24 v7, 6554, v5
    v_lshrrev_b32 v7, 16, v7
    v_mul_u32_u24 v7, 1120, v7
    v_lshl_add_u32 v5, v5, 4, s85
    v_add_u32 v7, v7, v5
    v_add_u32 v5, 128, v0
    v_mul_u32_u24 v135, 6554, v5
    v_lshrrev_b32 v135, 16, v135
    v_mul_u32_u24 v135, 1120, v135
    v_lshl_add_u32 v5, v5, 4, s85
    v_add_u32 v135, v135, v5
    v_bfe_u32 v5, v0, 3, 2
    v_xor_b32 v5, s56, v5
    v_lshlrev_b32 v5, 5, v5
    v_lshrrev_b32 v6, 2, v0
    v_lshl_add_u32 v5, v6, 7, v5
    v_and_b32 v6, 3, v0
    v_lshl_add_u32 v5, v6, 3, v5
    v_add_u32 v164, s93, v5
    s_waitcnt lgkmcnt(0)
    v_lshlrev_b32 v140, 16, v150
    v_and_b32 v141, 0xffff0000, v150
    v_lshlrev_b32 v142, 16, v151
    v_and_b32 v143, 0xffff0000, v151
    v_lshlrev_b32 v144, 16, v152
    v_and_b32 v145, 0xffff0000, v152
    v_lshlrev_b32 v146, 16, v153
    v_and_b32 v147, 0xffff0000, v153
    v_lshlrev_b32 v148, 16, v154
    v_and_b32 v149, 0xffff0000, v154
    v_lshlrev_b32 v150, 16, v155
    v_and_b32 v151, 0xffff0000, v155
    v_lshlrev_b32 v152, 16, v156
    v_and_b32 v153, 0xffff0000, v156
    v_lshlrev_b32 v154, 16, v157
    v_and_b32 v155, 0xffff0000, v157
    v_lshlrev_b32 v156, 16, v158
    v_and_b32 v157, 0xffff0000, v158
    v_lshlrev_b32 v158, 16, v159
    v_and_b32 v159, 0xffff0000, v159
    v_pk_mul_f32 v[140:141], v[140:141], v[162:163] op_sel:[0,1] op_sel_hi:[1,1]
    v_pk_mul_f32 v[142:143], v[142:143], v[162:163] op_sel:[0,1] op_sel_hi:[1,1]
    v_pk_mul_f32 v[144:145], v[144:145], v[162:163] op_sel:[0,1] op_sel_hi:[1,1]
    v_pk_mul_f32 v[146:147], v[146:147], v[162:163] op_sel:[0,1] op_sel_hi:[1,1]
    v_pk_mul_f32 v[148:149], v[148:149], v[162:163] op_sel:[0,1] op_sel_hi:[1,1]
    v_pk_mul_f32 v[150:151], v[150:151], v[162:163] op_sel:[0,1] op_sel_hi:[1,1]
    v_pk_mul_f32 v[152:153], v[152:153], v[162:163] op_sel:[0,1] op_sel_hi:[1,1]
    v_pk_mul_f32 v[154:155], v[154:155], v[162:163] op_sel:[0,1] op_sel_hi:[1,1]
    v_pk_mul_f32 v[156:157], v[156:157], v[162:163] op_sel:[0,1] op_sel_hi:[1,1]
    v_pk_mul_f32 v[158:159], v[158:159], v[162:163] op_sel:[0,1] op_sel_hi:[1,1]
    s_setprio 1
    s_cmp_eq_u32 s34, 0
    s_cbranch_scc1 L_opb
    s_branch L_lgo
L_pada10:
    s_branch L_pada18
L_padb17:
    s_branch L_warmed_b
L_nogq:
    s_waitcnt lgkmcnt(0)
    s_waitcnt vmcnt(9)
    v_mfma_f32_16x16x32_bf16 v[8:11], v[68:71], v[28:31], 0
    ds_read_b128 v[68:71], v138 offset:16384
    v_mfma_f32_16x16x32_bf16 v[12:15], v[72:75], v[28:31], 0
    ds_read_b128 v[72:75], v138 offset:17408
    v_mfma_f32_16x16x32_bf16 v[16:19], v[76:79], v[28:31], 0
    ds_read_b128 v[76:79], v138 offset:18432
    v_mfma_f32_16x16x32_bf16 v[20:23], v[80:83], v[28:31], 0
    ds_read_b128 v[80:83], v138 offset:19456
    v_mfma_f32_16x16x32_bf16 v[24:27], v[84:87], v[28:31], 0
    ds_read_b128 v[84:87], v138 offset:20480
    s_waitcnt vmcnt(8)
    v_mfma_f32_16x16x32_bf16 v[8:11], v[88:91], v[32:35], v[8:11]
    ds_read_b128 v[88:91], v138 offset:21504
    v_mfma_f32_16x16x32_bf16 v[12:15], v[92:95], v[32:35], v[12:15]
    ds_read_b128 v[92:95], v138 offset:22528
    v_mfma_f32_16x16x32_bf16 v[16:19], v[96:99], v[32:35], v[16:19]
    ds_read_b128 v[96:99], v138 offset:23552
    v_mfma_f32_16x16x32_bf16 v[20:23], v[100:103], v[32:35], v[20:23]
    ds_read_b128 v[100:103], v138 offset:24576
    v_mfma_f32_16x16x32_bf16 v[24:27], v[104:107], v[32:35], v[24:27]
    ds_read_b128 v[104:107], v138 offset:25600
    s_waitcnt vmcnt(7)
    v_mfma_f32_16x16x32_bf16 v[8:11], v[108:111], v[36:39], v[8:11]
    ds_read_b128 v[108:111], v138 offset:26624
    v_mfma_f32_16x16x32_bf16 v[12:15], v[112:115], v[36:39], v[12:15]
    ds_read_b128 v[112:115], v138 offset:27648
    v_mfma_f32_16x16x32_bf16 v[16:19], v[116:119], v[36:39], v[16:19]
    s_waitcnt lgkmcnt(10)
    ds_read_b128 v[116:119], v138 offset:28672
    v_mfma_f32_16x16x32_bf16 v[20:23], v[120:123], v[36:39], v[20:23]
    ds_read_b128 v[120:123], v138 offset:29696
    v_mfma_f32_16x16x32_bf16 v[24:27], v[124:127], v[36:39], v[24:27]
    s_waitcnt lgkmcnt(10)
    ds_read_b128 v[124:127], v138 offset:30720
    s_waitcnt vmcnt(6)
    v_mfma_f32_16x16x32_bf16 v[8:11], v[128:131], v[40:43], v[8:11]
    ds_read_b128 v[128:131], v138 offset:31744
    v_mfma_f32_16x16x32_bf16 v[12:15], v[68:71], v[40:43], v[12:15]
    s_waitcnt lgkmcnt(10)
    ds_read_b128 v[68:71], v138 offset:32768
    v_mfma_f32_16x16x32_bf16 v[16:19], v[72:75], v[40:43], v[16:19]
    ds_read_b128 v[72:75], v138 offset:33792
    v_mfma_f32_16x16x32_bf16 v[20:23], v[76:79], v[40:43], v[20:23]
    s_waitcnt lgkmcnt(10)
    ds_read_b128 v[76:79], v138 offset:34816
    v_mfma_f32_16x16x32_bf16 v[24:27], v[80:83], v[40:43], v[24:27]
    ds_read_b128 v[80:83], v138 offset:35840
    s_waitcnt vmcnt(5)
    v_mfma_f32_16x16x32_bf16 v[8:11], v[84:87], v[44:47], v[8:11]
    s_waitcnt lgkmcnt(10)
    ds_read_b128 v[84:87], v138 offset:36864
    v_mfma_f32_16x16x32_bf16 v[12:15], v[88:91], v[44:47], v[12:15]
    ds_read_b128 v[88:91], v138 offset:37888
    v_mfma_f32_16x16x32_bf16 v[16:19], v[92:95], v[44:47], v[16:19]
    s_waitcnt lgkmcnt(10)
    ds_read_b128 v[92:95], v138 offset:38912
    v_mfma_f32_16x16x32_bf16 v[20:23], v[96:99], v[44:47], v[20:23]
    ds_read_b128 v[96:99], v138 offset:39936
    v_mfma_f32_16x16x32_bf16 v[24:27], v[100:103], v[44:47], v[24:27]
    s_waitcnt lgkmcnt(10)
    ds_read_b128 v[100:103], v138 offset:40960
    s_waitcnt vmcnt(4)
    v_mfma_f32_16x16x32_bf16 v[8:11], v[104:107], v[48:51], v[8:11]
    ds_read_b128 v[104:107], v138 offset:41984
    v_mfma_f32_16x16x32_bf16 v[12:15], v[108:111], v[48:51], v[12:15]
    s_waitcnt lgkmcnt(10)
    ds_read_b128 v[108:111], v138 offset:43008
    v_mfma_f32_16x16x32_bf16 v[16:19], v[112:115], v[48:51], v[16:19]
    ds_read_b128 v[112:115], v138 offset:44032
    v_mfma_f32_16x16x32_bf16 v[20:23], v[116:119], v[48:51], v[20:23]
    s_waitcnt lgkmcnt(10)
    ds_read_b128 v[116:119], v138 offset:45056
    v_mfma_f32_16x16x32_bf16 v[24:27], v[120:123], v[48:51], v[24:27]
    ds_read_b128 v[120:123], v138 offset:46080
    s_waitcnt vmcnt(3)
    v_mfma_f32_16x16x32_bf16 v[8:11], v[124:127], v[52:55], v[8:11]
    s_waitcnt lgkmcnt(10)
    ds_read_b128 v[124:127], v138 offset:47104
    v_mfma_f32_16x16x32_bf16 v[12:15], v[128:131], v[52:55], v[12:15]
    ds_read_b128 v[128:131], v138 offset:48128
    v_mfma_f32_16x16x32_bf16 v[16:19], v[68:71], v[52:55], v[16:19]
    s_waitcnt lgkmcnt(10)
    ds_read_b128 v[68:71], v138 offset:49152
    v_mfma_f32_16x16x32_bf16 v[20:23], v[72:75], v[52:55], v[20:23]
    ds_read_b128 v[72:75], v138 offset:50176
    v_mfma_f32_16x16x32_bf16 v[24:27], v[76:79], v[52:55], v[24:27]
    s_waitcnt vmcnt(0)
    v_mfma_f32_16x16x32_bf16 v[8:11], v[80:83], v[56:59], v[8:11]
    s_mov_b64 exec, s[66:67]
    global_store_dword v166, v134, s[28:29]
    s_mov_b64 exec, -1
    v_mfma_f32_16x16x32_bf16 v[12:15], v[84:87], v[56:59], v[12:15]
    v_mfma_f32_16x16x32_bf16 v[16:19], v[88:91], v[56:59], v[16:19]
    s_waitcnt lgkmcnt(11)
    v_mfma_f32_16x16x32_bf16 v[20:23], v[92:95], v[56:59], v[20:23]
    s_waitcnt lgkmcnt(10)
    v_mfma_f32_16x16x32_bf16 v[24:27], v[96:99], v[56:59], v[24:27]
    s_waitcnt lgkmcnt(9)
    v_mfma_f32_16x16x32_bf16 v[8:11], v[100:103], v[60:63], v[8:11]
    s_waitcnt lgkmcnt(8)
    v_mfma_f32_16x16x32_bf16 v[12:15], v[104:107], v[60:63], v[12:15]
    s_waitcnt lgkmcnt(7)
    v_mfma_f32_16x16x32_bf16 v[16:19], v[108:111], v[60:63], v[16:19]
    s_waitcnt lgkmcnt(6)
    v_mfma_f32_16x16x32_bf16 v[20:23], v[112:115], v[60:63], v[20:23]
    s_waitcnt lgkmcnt(5)
    v_mfma_f32_16x16x32_bf16 v[24:27], v[116:119], v[60:63], v[24:27]
    s_waitcnt lgkmcnt(4)
    v_mfma_f32_16x16x32_bf16 v[8:11], v[120:123], v[64:67], v[8:11]
    s_waitcnt lgkmcnt(3)
    v_mfma_f32_16x16x32_bf16 v[12:15], v[124:127], v[64:67], v[12:15]
    s_waitcnt lgkmcnt(2)
    v_mfma_f32_16x16x32_bf16 v[16:19], v[128:131], v[64:67], v[16:19]
    s_waitcnt lgkmcnt(1)
    v_mfma_f32_16x16x32_bf16 v[20:23], v[68:71], v[64:67], v[20:23]
    s_waitcnt lgkmcnt(0)
    v_mfma_f32_16x16x32_bf16 v[24:27], v[72:75], v[64:67], v[24:27]
    s_cmp_lg_u32 s101, 0
    s_cbranch_scc1 L_cvl
L_cvdl:
    s_setprio 3
    s_mov_b32 s100, 0
L_fb:
    ds_read_b32 v4, v160 offset:232
    ds_read_b128 v[28:31], v137 offset:0
    ds_read_b128 v[32:35], v137 offset:1024
    ds_read_b128 v[36:39], v137 offset:2048
    ds_read_b128 v[40:43], v137 offset:3072
    ds_read_b128 v[44:47], v137 offset:4096
    ds_read_b32 v5, v3 offset:212
    ds_read_b64_tr_b16 v[48:49], v164 offset:0
    ds_read_b64_tr_b16 v[50:51], v164 offset:2048
    ds_read_b64_tr_b16 v[52:53], v164 offset:4096
    ds_read_b64_tr_b16 v[54:55], v164 offset:6144
    ds_read_b64_tr_b16 v[56:57], v164 offset:8192
    s_waitcnt lgkmcnt(11)
    v_readfirstlane_b32 s96, v4
    s_cmp_lg_u32 s96, 0
    s_cbranch_scc1 L_fp
    s_waitcnt lgkmcnt(0)
    s_add_u32 s100, s100, 1
    s_cmp_lt_u32 s100, 1048576
    s_branch L_skip3276
L_pada11:
    s_branch L_pada19
L_padb18:
    s_branch L_warmed_b
L_skip3276:
    s_cbranch_scc1 L_fb
L_fp:
    s_mov_b64 exec, 0xffffffff
    global_load_dword v6, v166, s[28:29] sc1
    s_mov_b64 exec, -1
    s_waitcnt lgkmcnt(10)
    v_pk_add_f32 v[28:29], v[28:29], v[8:9]
    v_pk_add_f32 v[30:31], v[30:31], v[10:11]
    s_waitcnt lgkmcnt(9)
    v_pk_add_f32 v[32:33], v[32:33], v[12:13]
    v_pk_add_f32 v[34:35], v[34:35], v[14:15]
    s_waitcnt lgkmcnt(8)
    v_pk_add_f32 v[36:37], v[36:37], v[16:17]
    v_pk_add_f32 v[38:39], v[38:39], v[18:19]
    s_waitcnt lgkmcnt(7)
    v_pk_add_f32 v[40:41], v[40:41], v[20:21]
    v_pk_add_f32 v[42:43], v[42:43], v[22:23]
    s_waitcnt lgkmcnt(6)
    v_pk_add_f32 v[44:45], v[44:45], v[24:25]
    v_pk_add_f32 v[46:47], v[46:47], v[26:27]
    v_pk_mul_f32 v[28:29], v[28:29], v[162:163] op_sel_hi:[1,0]
    v_pk_mul_f32 v[30:31], v[30:31], v[162:163] op_sel_hi:[1,0]
    v_pk_mul_f32 v[32:33], v[32:33], v[162:163] op_sel_hi:[1,0]
    v_pk_mul_f32 v[34:35], v[34:35], v[162:163] op_sel_hi:[1,0]
    v_pk_mul_f32 v[36:37], v[36:37], v[162:163] op_sel_hi:[1,0]
    v_pk_mul_f32 v[38:39], v[38:39], v[162:163] op_sel_hi:[1,0]
    v_pk_mul_f32 v[40:41], v[40:41], v[162:163] op_sel_hi:[1,0]
    v_pk_mul_f32 v[42:43], v[42:43], v[162:163] op_sel_hi:[1,0]
    v_pk_mul_f32 v[44:45], v[44:45], v[162:163] op_sel_hi:[1,0]
    v_pk_mul_f32 v[46:47], v[46:47], v[162:163] op_sel_hi:[1,0]
    s_mov_b32 s100, 0
L_fy:
    s_waitcnt lgkmcnt(5)
    v_readfirstlane_b32 s96, v5
    s_cmp_eq_u32 s96, 2
    s_cbranch_scc1 L_fin
    ds_read_b32 v5, v3 offset:212
    ds_read_b64_tr_b16 v[48:49], v164 offset:0
    ds_read_b64_tr_b16 v[50:51], v164 offset:2048
    ds_read_b64_tr_b16 v[52:53], v164 offset:4096
    ds_read_b64_tr_b16 v[54:55], v164 offset:6144
    ds_read_b64_tr_b16 v[56:57], v164 offset:8192
    s_add_u32 s100, s100, 1
    s_cmp_lt_u32 s100, 1048576
    s_cbranch_scc1 L_fy
L_fin:
    s_waitcnt lgkmcnt(4)
    v_lshlrev_b32 v60, 16, v48
    v_and_b32 v61, 0xffff0000, v48
    v_lshlrev_b32 v62, 16, v49
    v_and_b32 v63, 0xffff0000, v49
    v_pk_fma_f32 v[28:29], v[60:61], v[140:141], v[28:29]
    v_pk_fma_f32 v[30:31], v[62:63], v[142:143], v[30:31]
    v_cvt_pk_bf16_f32 v48, v28, v29
    v_cvt_pk_bf16_f32 v49, v30, v31
    ds_write_b64 v161, v[48:49] offset:0
    s_waitcnt lgkmcnt(4)
    v_lshlrev_b32 v60, 16, v50
    v_and_b32 v61, 0xffff0000, v50
    v_lshlrev_b32 v62, 16, v51
    v_and_b32 v63, 0xffff0000, v51
    v_pk_fma_f32 v[32:33], v[60:61], v[144:145], v[32:33]
    v_pk_fma_f32 v[34:35], v[62:63], v[146:147], v[34:35]
    v_cvt_pk_bf16_f32 v50, v32, v33
    v_cvt_pk_bf16_f32 v51, v34, v35
    ds_write_b64 v161, v[50:51] offset:32
    s_waitcnt lgkmcnt(4)
    v_lshlrev_b32 v60, 16, v52
    v_and_b32 v61, 0xffff0000, v52
    v_lshlrev_b32 v62, 16, v53
    v_and_b32 v63, 0xffff0000, v53
    v_pk_fma_f32 v[36:37], v[60:61], v[148:149], v[36:37]
    v_pk_fma_f32 v[38:39], v[62:63], v[150:151], v[38:39]
    v_cvt_pk_bf16_f32 v52, v36, v37
    v_cvt_pk_bf16_f32 v53, v38, v39
    ds_write_b64 v161, v[52:53] offset:64
    s_waitcnt lgkmcnt(4)
    v_lshlrev_b32 v60, 16, v54
    v_and_b32 v61, 0xffff0000, v54
    v_lshlrev_b32 v62, 16, v55
    v_and_b32 v63, 0xffff0000, v55
    v_pk_fma_f32 v[40:41], v[60:61], v[152:153], v[40:41]
    v_pk_fma_f32 v[42:43], v[62:63], v[154:155], v[42:43]
    v_cvt_pk_bf16_f32 v54, v40, v41
    v_cvt_pk_bf16_f32 v55, v42, v43
    ds_write_b64 v161, v[54:55] offset:96
    s_waitcnt lgkmcnt(4)
    v_lshlrev_b32 v60, 16, v56
    v_and_b32 v61, 0xffff0000, v56
    v_lshlrev_b32 v62, 16, v57
    v_and_b32 v63, 0xffff0000, v57
    v_pk_fma_f32 v[44:45], v[60:61], v[156:157], v[44:45]
    v_pk_fma_f32 v[46:47], v[62:63], v[158:159], v[46:47]
    v_cvt_pk_bf16_f32 v56, v44, v45
    v_cvt_pk_bf16_f32 v57, v46, v47
    ds_write_b64 v161, v[56:57] offset:128
    ds_read_b128 v[72:75], v137 offset:0
    ds_read_b128 v[76:79], v137 offset:1024
    ds_read_b128 v[80:83], v137 offset:2048
    s_mov_b32 s100, 0
    s_cmp_lg_u32 s91, 1
    s_cbranch_scc1 L_rdok
L_rdw:
    s_waitcnt vmcnt(0)
    v_cmp_ne_u32 vcc, s33, v6
    s_cmp_eq_u32 vcc_lo, 0
    s_cbranch_scc1 L_rdok
    s_mov_b64 exec, 0xffffffff
    global_load_dword v6, v166, s[28:29] sc1
    s_mov_b64 exec, -1
    s_add_u32 s100, s100, 1
    s_cmp_lt_u32 s100, 1048576
    s_cbranch_scc1 L_rdw
L_rdok:
    s_waitcnt lgkmcnt(2)
    global_store_dwordx4 v165, v[72:75], s[24:25]
    s_waitcnt lgkmcnt(1)
    global_store_dwordx4 v7, v[76:79], s[24:25]
    s_waitcnt lgkmcnt(0)
    s_mov_b64 exec, 0xffffffff
    global_store_dwordx4 v135, v[80:83], s[24:25]
    s_endpgm
L_vxslow:
    ds_read_b32 v6, v163
    ds_read_b64 v[106:107], v162 offset:9216
    ds_read_b64 v[104:105], v162 offset:9728
    ds_read_b64 v[102:103], v162 offset:10240
    ds_read_b64 v[100:101], v162 offset:10752
    ds_read_b64 v[98:99], v162 offset:11264
    s_add_u32 s100, s100, 1
    s_cmp_lt_u32 s100, 1048576
    s_cbranch_scc1 L_vxw
    s_waitcnt lgkmcnt(0)
    s_branch L_vxok
L_pada12:
    s_branch L_pada20
L_padb19:
    s_branch L_warmed_b
L_early:
    v_mov_b32 v5, 1
    global_load_dwordx4 v[28:31], v139, s[18:19] offset:-4096 sc1
    global_load_dwordx4 v[32:35], v139, s[18:19] offset:-2048 sc1
    global_load_dwordx4 v[36:39], v139, s[18:19] offset:0 sc1
    global_load_dwordx4 v[40:43], v139, s[18:19] offset:2048 sc1
    global_load_dwordx4 v[44:47], v139, s[62:63] offset:-4096 sc1
    global_load_dwordx4 v[48:51], v139, s[62:63] offset:-2048 sc1
    ds_write_b32 v160, v5 offset:216
    s_lshr_b32 s96, s56, 1
    s_lshl_b32 s96, s96, 7
    s_add_u32 s96, s96, 3072
    v_add_u32 v166, s96, v166
    v_mov_b32 v134, s33
    s_and_b32 s96, s56, 1
    s_lshl1_add_u32 s96, s96, s57
    s_lshl2_add_u32 s96, s36, s96
    s_lshl_b64 s[66:67], 1, s96
    s_waitcnt lgkmcnt(0)
    s_waitcnt vmcnt(5)
    v_mfma_f32_16x16x32_bf16 v[8:11], v[68:71], v[28:31], 0
    ds_read_b128 v[68:71], v138 offset:16384
    v_mfma_f32_16x16x32_bf16 v[12:15], v[72:75], v[28:31], 0
    global_load_dwordx4 v[52:55], v139, s[62:63] offset:0 sc1
    ds_read_b128 v[72:75], v138 offset:17408
    v_mfma_f32_16x16x32_bf16 v[16:19], v[76:79], v[28:31], 0
    ds_read_b128 v[76:79], v138 offset:18432
    v_mfma_f32_16x16x32_bf16 v[20:23], v[80:83], v[28:31], 0
    global_load_dwordx4 v[56:59], v139, s[62:63] offset:2048 sc1
    ds_read_b128 v[80:83], v138 offset:19456
    v_mfma_f32_16x16x32_bf16 v[24:27], v[84:87], v[28:31], 0
    ds_read_b128 v[84:87], v138 offset:20480
    s_waitcnt vmcnt(6)
    v_mfma_f32_16x16x32_bf16 v[8:11], v[88:91], v[32:35], v[8:11]
    ds_read_b128 v[88:91], v138 offset:21504
    v_mfma_f32_16x16x32_bf16 v[12:15], v[92:95], v[32:35], v[12:15]
    global_load_dwordx4 v[60:63], v139, s[64:65] offset:-4096 sc1
    ds_read_b128 v[92:95], v138 offset:22528
    v_mfma_f32_16x16x32_bf16 v[16:19], v[96:99], v[32:35], v[16:19]
    ds_read_b128 v[96:99], v138 offset:23552
    v_mfma_f32_16x16x32_bf16 v[20:23], v[100:103], v[32:35], v[20:23]
    global_load_dwordx4 v[64:67], v139, s[64:65] offset:-2048 sc1
    ds_read_b128 v[100:103], v138 offset:24576
    v_mfma_f32_16x16x32_bf16 v[24:27], v[104:107], v[32:35], v[24:27]
    ds_read_b128 v[104:107], v138 offset:25600
    s_waitcnt vmcnt(7)
    v_mfma_f32_16x16x32_bf16 v[8:11], v[108:111], v[36:39], v[8:11]
    ds_read_b128 v[108:111], v138 offset:26624
    v_mfma_f32_16x16x32_bf16 v[12:15], v[112:115], v[36:39], v[12:15]
    s_waitcnt lgkmcnt(9)
    ds_read_b128 v[112:115], v138 offset:27648
    v_mfma_f32_16x16x32_bf16 v[16:19], v[116:119], v[36:39], v[16:19]
    ds_read_b128 v[116:119], v138 offset:28672
    v_mfma_f32_16x16x32_bf16 v[20:23], v[120:123], v[36:39], v[20:23]
    s_waitcnt lgkmcnt(9)
    ds_read_b128 v[120:123], v138 offset:29696
    v_mfma_f32_16x16x32_bf16 v[24:27], v[124:127], v[36:39], v[24:27]
    ds_read_b128 v[124:127], v138 offset:30720
    s_waitcnt vmcnt(6)
    v_mfma_f32_16x16x32_bf16 v[8:11], v[128:131], v[40:43], v[8:11]
    s_waitcnt lgkmcnt(9)
    ds_read_b128 v[128:131], v138 offset:31744
    v_mfma_f32_16x16x32_bf16 v[12:15], v[68:71], v[40:43], v[12:15]
    ds_read_b128 v[68:71], v138 offset:32768
    v_mfma_f32_16x16x32_bf16 v[16:19], v[72:75], v[40:43], v[16:19]
    s_waitcnt lgkmcnt(9)
    ds_read_b128 v[72:75], v138 offset:33792
    v_mfma_f32_16x16x32_bf16 v[20:23], v[76:79], v[40:43], v[20:23]
    ds_read_b128 v[76:79], v138 offset:34816
    v_mfma_f32_16x16x32_bf16 v[24:27], v[80:83], v[40:43], v[24:27]
    s_waitcnt lgkmcnt(9)
    ds_read_b128 v[80:83], v138 offset:35840
    s_waitcnt vmcnt(5)
    v_mfma_f32_16x16x32_bf16 v[8:11], v[84:87], v[44:47], v[8:11]
    ds_read_b128 v[84:87], v138 offset:36864
    v_mfma_f32_16x16x32_bf16 v[12:15], v[88:91], v[44:47], v[12:15]
    s_waitcnt lgkmcnt(9)
    ds_read_b128 v[88:91], v138 offset:37888
    v_mfma_f32_16x16x32_bf16 v[16:19], v[92:95], v[44:47], v[16:19]
    ds_read_b128 v[92:95], v138 offset:38912
    v_mfma_f32_16x16x32_bf16 v[20:23], v[96:99], v[44:47], v[20:23]
    s_waitcnt lgkmcnt(9)
    ds_read_b128 v[96:99], v138 offset:39936
    v_mfma_f32_16x16x32_bf16 v[24:27], v[100:103], v[44:47], v[24:27]
    ds_read_b128 v[100:103], v138 offset:40960
    s_waitcnt vmcnt(4)
    v_mfma_f32_16x16x32_bf16 v[8:11], v[104:107], v[48:51], v[8:11]
    s_waitcnt lgkmcnt(9)
    ds_read_b128 v[104:107], v138 offset:41984
    v_mfma_f32_16x16x32_bf16 v[12:15], v[108:111], v[48:51], v[12:15]
    ds_read_b128 v[108:111], v138 offset:43008
    v_mfma_f32_16x16x32_bf16 v[16:19], v[112:115], v[48:51], v[16:19]
    s_waitcnt lgkmcnt(9)
    ds_read_b128 v[112:115], v138 offset:44032
    v_mfma_f32_16x16x32_bf16 v[20:23], v[116:119], v[48:51], v[20:23]
    ds_read_b128 v[116:119], v138 offset:45056
    v_mfma_f32_16x16x32_bf16 v[24:27], v[120:123], v[48:51], v[24:27]
    s_waitcnt lgkmcnt(9)
    ds_read_b128 v[120:123], v138 offset:46080
    s_waitcnt vmcnt(3)
    v_mfma_f32_16x16x32_bf16 v[8:11], v[124:127], v[52:55], v[8:11]
    ds_read_b128 v[124:127], v138 offset:47104
    v_mfma_f32_16x16x32_bf16 v[12:15], v[128:131], v[52:55], v[12:15]
    s_waitcnt lgkmcnt(9)
    ds_read_b128 v[128:131], v138 offset:48128
    v_mfma_f32_16x16x32_bf16 v[16:19], v[68:71], v[52:55], v[16:19]
    ds_read_b128 v[68:71], v138 offset:49152
    v_mfma_f32_16x16x32_bf16 v[20:23], v[72:75], v[52:55], v[20:23]
    s_waitcnt lgkmcnt(9)
    ds_read_b128 v[72:75], v138 offset:50176
    v_mfma_f32_16x16x32_bf16 v[24:27], v[76:79], v[52:55], v[24:27]
    s_waitcnt vmcnt(0)
    v_mfma_f32_16x16x32_bf16 v[8:11], v[80:83], v[56:59], v[8:11]
    s_mov_b64 exec, s[66:67]
    global_store_dword v166, v134, s[28:29]
    s_mov_b64 exec, -1
    v_mfma_f32_16x16x32_bf16 v[12:15], v[84:87], v[56:59], v[12:15]
    v_mfma_f32_16x16x32_bf16 v[16:19], v[88:91], v[56:59], v[16:19]
    v_mfma_f32_16x16x32_bf16 v[20:23], v[92:95], v[56:59], v[20:23]
    v_mfma_f32_16x16x32_bf16 v[24:27], v[96:99], v[56:59], v[24:27]
    s_waitcnt lgkmcnt(9)
    v_mfma_f32_16x16x32_bf16 v[8:11], v[100:103], v[60:63], v[8:11]
    s_waitcnt lgkmcnt(8)
    v_mfma_f32_16x16x32_bf16 v[12:15], v[104:107], v[60:63], v[12:15]
    s_waitcnt lgkmcnt(7)
    v_mfma_f32_16x16x32_bf16 v[16:19], v[108:111], v[60:63], v[16:19]
    s_waitcnt lgkmcnt(6)
    v_mfma_f32_16x16x32_bf16 v[20:23], v[112:115], v[60:63], v[20:23]
    s_waitcnt lgkmcnt(5)
    v_mfma_f32_16x16x32_bf16 v[24:27], v[116:119], v[60:63], v[24:27]
    s_waitcnt lgkmcnt(4)
    v_mfma_f32_16x16x32_bf16 v[8:11], v[120:123], v[64:67], v[8:11]
    s_waitcnt lgkmcnt(3)
    v_mfma_f32_16x16x32_bf16 v[12:15], v[124:127], v[64:67], v[12:15]
    s_waitcnt lgkmcnt(2)
    v_mfma_f32_16x16x32_bf16 v[16:19], v[128:131], v[64:67], v[16:19]
    s_waitcnt lgkmcnt(1)
    v_mfma_f32_16x16x32_bf16 v[20:23], v[68:71], v[64:67], v[20:23]
    s_waitcnt lgkmcnt(0)
    v_mfma_f32_16x16x32_bf16 v[24:27], v[72:75], v[64:67], v[24:27]
    s_setprio 0
    s_mov_b32 s100, 0
Lw_63:
    ds_read_b32 v4, v3 offset:196
    s_branch L_skip3554
L_pada13:
    s_branch L_warmed_a
L_padb20:
    s_branch L_warmed_b
L_skip3554:
    s_waitcnt lgkmcnt(0)
    v_readfirstlane_b32 s99, v4
    s_cmp_ge_u32 s99, 8
    s_cbranch_scc1 Lwd_64
    s_add_u32 s100, s100, 1
    s_cmp_lt_u32 s100, 1048576
    s_cbranch_scc1 Lw_63
Lwd_64:
    ds_write_b128 v137, v[8:11] offset:0
    ds_write_b128 v137, v[12:15] offset:1024
    ds_write_b128 v137, v[16:19] offset:2048
    ds_write_b128 v137, v[20:23] offset:3072
    ds_write_b128 v137, v[24:27] offset:4096
    v_mov_b32 v4, 2
    ds_write_b32 v160, v4 offset:232
    s_cmp_lg_u32 s101, 0
    s_cbranch_scc1 L_cve
L_cvde:
    s_endpgm
L_cvl:
    s_cmp_ge_u32 s31, 26
    s_cselect_b32 s96, 8, 0
    s_lshl_b32 s97, s30, 8
    s_add_u32 s96, s96, s97
    s_add_u32 s96, s96, 65536
    s_and_b32 s98, s33, 0xffffff00
    s_mov_b64 exec, 0xffffffff
    s_mov_b32 s100, 0
L_cwl:
    v_subrev_u32 v132, s98, v133
    v_cmp_le_u32 vcc, 0x600, v132
    s_cbranch_vccz L_cxl
    s_mov_b64 exec, vcc
    v_lshlrev_b32 v68, 2, v0
    v_add_u32 v68, 161792, v68
    ds_read_b32 v70, v68
    v_mov_b32 v71, 0x100
    v_lshl_add_u32 v68, v0, 11, s96
    s_sleep 8
    s_waitcnt lgkmcnt(0)
    global_atomic_add_x2 v[132:133], v68, v[70:71], s[28:29] sc0 sc1
    s_waitcnt vmcnt(0)
    s_add_u32 s100, s100, 1
    s_cmp_lt_u32 s100, 1048576
    s_cbranch_scc1 L_cwl
L_cxl:
    s_mov_b64 exec, -1
    s_branch L_cvdl
L_cve:
    s_cmp_ge_u32 s31, 26
    s_cselect_b32 s96, 8, 0
    s_lshl_b32 s97, s30, 8
    s_add_u32 s96, s96, s97
    s_add_u32 s96, s96, 65536
    s_and_b32 s98, s33, 0xffffff00
    s_mov_b64 exec, 0xffffffff
    s_mov_b32 s100, 0
L_cwe:
    v_subrev_u32 v132, s98, v133
    v_cmp_le_u32 vcc, 0x600, v132
    s_cbranch_vccz L_cxe
    s_mov_b64 exec, vcc
    v_lshlrev_b32 v68, 2, v0
    v_add_u32 v68, 161792, v68
    ds_read_b32 v70, v68
    v_mov_b32 v71, 0x100
    v_lshl_add_u32 v68, v0, 11, s96
    s_sleep 8
    s_waitcnt lgkmcnt(0)
    global_atomic_add_x2 v[132:133], v68, v[70:71], s[28:29] sc0 sc1
    s_waitcnt vmcnt(0)
    s_add_u32 s100, s100, 1
    s_cmp_lt_u32 s100, 1048576
    s_cbranch_scc1 L_cwe
L_cxe:
    s_mov_b64 exec, -1
    s_branch L_cvde
L_awave:
    s_sub_u32 s65, s32, 4
    s_min_u32 s99, s38, 4
    s_lshl3_add_u32 s58, s99, s65
    s_lshl_b32 s96, s58, 7
    s_add_u32 s97, s96, 64
    v_sub_u32 v4, v1, v2
    v_and_b32 v4, 3, v4
    v_and_or_b32 v4, v1, 12, v4
    v_lshrrev_b32 v5, 1, v4
    v_lshlrev_b32 v4, 4, v4
    s_waitcnt lgkmcnt(0)
    s_load_dwordx16 s[40:55], s[10:11], s96
    s_load_dwordx16 s[76:91], s[10:11], s97
    s_setprio 2
    s_waitcnt lgkmcnt(0)
    v_cmp_eq_u32 vcc, 0, v5
    s_mov_b64 exec, vcc
    v_bfe_u32 v42, s40, v4, 16
    v_bfe_u32 v43, s48, v4, 16
    v_bfe_u32 v44, s76, v4, 16
    v_bfe_u32 v45, s84, v4, 16
    s_mov_b64 exec, -1
    v_cmp_eq_u32 vcc, 1, v5
    s_mov_b64 exec, vcc
    v_bfe_u32 v42, s41, v4, 16
    v_bfe_u32 v43, s49, v4, 16
    v_bfe_u32 v44, s77, v4, 16
    v_bfe_u32 v45, s85, v4, 16
    s_mov_b64 exec, -1
    v_cmp_eq_u32 vcc, 2, v5
    s_mov_b64 exec, vcc
    v_bfe_u32 v42, s42, v4, 16
    v_bfe_u32 v43, s50, v4, 16
    v_bfe_u32 v44, s78, v4, 16
    v_bfe_u32 v45, s86, v4, 16
    s_mov_b64 exec, -1
    v_cmp_eq_u32 vcc, 3, v5
    s_mov_b64 exec, vcc
    v_bfe_u32 v42, s43, v4, 16
    v_bfe_u32 v43, s51, v4, 16
    v_bfe_u32 v44, s79, v4, 16
    v_bfe_u32 v45, s87, v4, 16
    s_mov_b64 exec, -1
    v_cmp_eq_u32 vcc, 4, v5
    s_mov_b64 exec, vcc
    v_bfe_u32 v42, s44, v4, 16
    v_bfe_u32 v43, s52, v4, 16
    v_bfe_u32 v44, s80, v4, 16
    v_bfe_u32 v45, s88, v4, 16
    s_mov_b64 exec, -1
    v_cmp_eq_u32 vcc, 5, v5
    s_mov_b64 exec, vcc
    v_bfe_u32 v42, s45, v4, 16
    v_bfe_u32 v43, s53, v4, 16
    v_bfe_u32 v44, s81, v4, 16
    v_bfe_u32 v45, s89, v4, 16
    s_mov_b64 exec, -1
    v_cmp_eq_u32 vcc, 6, v5
    s_mov_b64 exec, vcc
    v_bfe_u32 v42, s46, v4, 16
    v_bfe_u32 v43, s54, v4, 16
    v_bfe_u32 v44, s82, v4, 16
    v_bfe_u32 v45, s90, v4, 16
    s_mov_b64 exec, -1
    v_cmp_eq_u32 vcc, 7, v5
    s_mov_b64 exec, vcc
    v_bfe_u32 v42, s47, v4, 16
    v_bfe_u32 v43, s55, v4, 16
    v_bfe_u32 v44, s83, v4, 16
    v_bfe_u32 v45, s91, v4, 16
    s_mov_b64 exec, -1
    s_sub_u32 s65, s32, 4
    s_load_dword s33, s[28:29], 0
    s_setprio 2
    s_and_b32 s56, s65, 3
    s_lshr_b32 s57, s65, 2
    s_sub_u32 s96, s31, 20
    s_mul_i32 s97, s96, 43
    s_lshr_b32 s97, s97, 7
    s_mul_i32 s41, s96, 7
    s_sub_u32 s41, s41, s97
    s_mul_i32 s97, s97, 3
    s_sub_u32 s97, s96, s97
    s_cmp_eq_u32 s97, 2
    s_cselect_b32 s64, 6, 7
    s_mul_i32 s97, s30, 80
    s_add_u32 s41, s41, s97
    s_cmp_lt_u32 s65, s64
    s_cselect_b32 s52, 1, 0
    s_cselect_b32 s98, s65, 0
    s_cselect_b32 s20, 7, s64
    s_cselect_b32 s54, 0, 448
    s_add_u32 s41, s41, s98
    s_mul_i32 s42, s98, 8320
    s_mul_i32 s68, s98, 4608
    s_add_u32 s68, s68, 58240
    s_lshl_b32 s55, s41, 12
    s_lshr_b32 s96, s41, 1
    s_lshl_b32 s96, s96, 2
    s_load_dword s53, s[14:15], s96
    v_lshlrev_b32 v8, 4, v0
    v_lshl_add_u32 v5, v1, 3, v2
    s_lshr_b32 s96, s65, 2
    s_mul_i32 s97, s96, 16896
    s_add_u32 s97, s97, 90496
    v_lshl_add_u32 v5, v5, 7, s97
    s_mul_i32 s45, s96, 512
    s_lshl_b32 s96, s65, 1
    v_xor_b32 v6, s96, v1
    v_and_b32 v6, 7, v6
    v_lshl_add_u32 v9, v6, 4, v5
    v_add_u32 v6, 7, v1
    v_xor_b32 v6, s96, v6
    v_and_b32 v6, 7, v6
    v_lshl_add_u32 v11, v6, 4, v5
    v_xor_b32 v10, 16, v9
    v_xor_b32 v12, 16, v11
    v_subrev_u32 v46, s45, v9
    v_subrev_u32 v47, s45, v10
    s_lshl_b32 s96, s58, 16
    s_lshl_b32 s97, s37, 8
    s_add_u32 s96, s96, s97
    s_add_u32 s96, s96, 1048576
    v_lshlrev_b32 v5, 12, v2
    v_lshl_add_u32 v5, v1, 4, v5
    v_add_u32 v14, s96, v5
    s_add_u32 s60, s28, 16384
    s_addc_u32 s61, s29, 0
    s_add_u32 s62, s28, 32768
    s_addc_u32 s63, s29, 0
    s_add_u32 s66, s28, 49152
    s_addc_u32 s67, s29, 0
    s_lshl4_add_u32 s96, s58, s37
    s_lshl_b32 s96, s96, 7
    s_add_u32 s96, s96, 262144
    v_add_u32 v5, v1, v2
    v_lshl_add_u32 v148, v5, 3, s96
    s_lshr_b32 s96, s41, 4
    s_lshl_b32 s96, s96, 11
    s_and_b32 s97, s41, 15
    s_lshl3_add_u32 s96, s97, s96
    s_add_u32 s96, s96, 262144
    v_lshl_add_u32 v149, v1, 7, s96
    s_waitcnt lgkmcnt(0)
    s_mul_i32 s33, s33, 1664525
    s_add_u32 s33, s33, 1013904223
    s_mov_b32 s43, s98
    v_bfe_u32 v5, v1, 2, 1
    v_lshlrev_b32 v5, 4, v5
    v_and_b32 v6, 3, v1
    v_lshrrev_b32 v7, 3, v1
    v_mov_b32 v4, 0x3f80
    v_lshlrev_b32 v4, v5, v4
    v_cmp_eq_u32 vcc, v6, v2
    s_nop 1
    v_cndmask_b32 v4, 0, v4, vcc
    v_cmp_eq_u32 vcc, 0, v7
    s_nop 1
    v_cndmask_b32 v40, 0, v4, vcc
    v_cndmask_b32 v41, v4, 0, vcc
    v_or_b32 v4, 2, v7
    v_cmp_ge_u32 vcc, v6, v2
    s_nop 1
    v_cndmask_b32 v7, v7, v4, vcc
    v_lshlrev_b32 v42, v5, v42
    v_lshlrev_b32 v43, v5, v43
    v_lshlrev_b32 v44, v5, v44
    v_lshlrev_b32 v45, v5, v45
    v_cmp_eq_u32 vcc, 0, v7
    s_nop 1
    v_cndmask_b32 v16, 0, v42, vcc
    v_cndmask_b32 v20, 0, v42, vcc
    v_cndmask_b32 v22, 0, v43, vcc
    v_cndmask_b32 v26, 0, v43, vcc
    v_cndmask_b32 v28, 0, v44, vcc
    v_cndmask_b32 v32, 0, v44, vcc
    v_cndmask_b32 v34, 0, v45, vcc
    v_cndmask_b32 v38, 0, v45, vcc
    v_cmp_eq_u32 vcc, 1, v7
    s_nop 1
    v_cndmask_b32 v17, 0, v42, vcc
    v_cndmask_b32 v21, 0, v42, vcc
    v_cndmask_b32 v23, 0, v43, vcc
    v_cndmask_b32 v27, 0, v43, vcc
    v_cndmask_b32 v29, 0, v44, vcc
    v_cndmask_b32 v33, 0, v44, vcc
    v_cndmask_b32 v35, 0, v45, vcc
    v_cndmask_b32 v39, 0, v45, vcc
    v_cmp_eq_u32 vcc, 2, v7
    s_nop 1
    v_cndmask_b32 v18, 0, v42, vcc
    v_cndmask_b32 v24, 0, v43, vcc
    v_cndmask_b32 v30, 0, v44, vcc
    v_cndmask_b32 v36, 0, v45, vcc
    v_cmp_eq_u32 vcc, 3, v7
    s_nop 1
    v_cndmask_b32 v19, 0, v42, vcc
    v_cndmask_b32 v25, 0, v43, vcc
    v_cndmask_b32 v31, 0, v44, vcc
    v_cndmask_b32 v37, 0, v45, vcc
    s_barrier
    s_cmp_ge_u32 s38, 5
    s_cbranch_scc1 L_nokv
    ds_read_b128 v[48:51], v11
    ds_read_b128 v[52:55], v9 offset:512
    ds_read_b128 v[56:59], v9 offset:1024
    ds_read_b128 v[60:63], v46 offset:33792
    ds_read_b128 v[64:67], v46 offset:34304
    ds_read_b128 v[68:71], v12
    ds_read_b128 v[72:75], v10 offset:512
    ds_read_b128 v[76:79], v10 offset:1024
    ds_read_b128 v[80:83], v47 offset:33792
    ds_read_b128 v[84:87], v47 offset:34304
    s_waitcnt lgkmcnt(8)
    v_swap_b32 v50, v52
    v_swap_b32 v51, v53
    s_nop 1
    v_mfma_f32_16x16x32_bf16 v[88:91], v[16:19], v[48:51], 0
    v_mfma_f32_16x16x32_bf16 v[96:99], v[22:25], v[52:55], 0
    s_waitcnt lgkmcnt(7)
    v_mov_b64 v[48:49], v[56:57]
    v_mov_b64 v[52:53], v[58:59]
    s_nop 0
    v_mfma_f32_16x16x32_bf16 v[92:95], v[18:21], v[48:51], 0
    v_mfma_f32_16x16x32_bf16 v[100:103], v[24:27], v[52:55], 0
    s_waitcnt lgkmcnt(5)
    v_mfma_f32_16x16x16_bf16 v[104:107], v[40:41], v[60:61], 0
    v_mfma_f32_16x16x16_bf16 v[108:111], v[40:41], v[64:65], 0
    v_mfma_f32_16x16x16_bf16 v[112:115], v[40:41], v[62:63], 0
    v_mfma_f32_16x16x16_bf16 v[116:119], v[40:41], v[66:67], 0
    s_waitcnt lgkmcnt(3)
    v_swap_b32 v70, v72
    v_swap_b32 v71, v73
    s_nop 1
    v_mfma_f32_16x16x32_bf16 v[48:51], v[28:31], v[68:71], 0
    v_mfma_f32_16x16x32_bf16 v[56:59], v[34:37], v[72:75], 0
    s_waitcnt lgkmcnt(2)
    v_mov_b64 v[68:69], v[76:77]
    v_mov_b64 v[72:73], v[78:79]
    s_nop 0
    v_mfma_f32_16x16x32_bf16 v[52:55], v[30:33], v[68:71], 0
    v_mfma_f32_16x16x32_bf16 v[60:63], v[36:39], v[72:75], 0
    v_pk_mul_f32 v[88:89], v[88:89], v[104:105]
    v_pk_mul_f32 v[90:91], v[90:91], v[106:107]
    v_pk_mul_f32 v[92:93], v[92:93], v[108:109]
    v_pk_mul_f32 v[94:95], v[94:95], v[110:111]
    v_pk_mul_f32 v[96:97], v[96:97], v[112:113]
    v_pk_mul_f32 v[98:99], v[98:99], v[114:115]
    v_pk_mul_f32 v[100:101], v[100:101], v[116:117]
    v_pk_mul_f32 v[102:103], v[102:103], v[118:119]
    s_waitcnt lgkmcnt(0)
    v_mfma_f32_16x16x16_bf16 v[104:107], v[40:41], v[80:81], 0
    v_mfma_f32_16x16x16_bf16 v[108:111], v[40:41], v[84:85], 0
    v_mfma_f32_16x16x16_bf16 v[112:115], v[40:41], v[82:83], 0
    v_mfma_f32_16x16x16_bf16 v[116:119], v[40:41], v[86:87], 0
    v_cvt_pk_bf16_f32 v120, v88, v89
    v_cvt_pk_bf16_f32 v121, v90, v91
    v_cvt_pk_bf16_f32 v122, v92, v93
    v_cvt_pk_bf16_f32 v123, v94, v95
    global_store_dwordx4 v14, v[120:123], s[28:29] sc1
    v_cvt_pk_bf16_f32 v124, v96, v97
    v_cvt_pk_bf16_f32 v125, v98, v99
    v_cvt_pk_bf16_f32 v126, v100, v101
    v_cvt_pk_bf16_f32 v127, v102, v103
    global_store_dwordx4 v14, v[124:127], s[60:61] sc1
    v_add_u32 v76, v120, v121
    v_add3_u32 v76, v76, v122, v123
    v_add_u32 v77, v124, v125
    v_add3_u32 v77, v77, v126, v127
    v_pk_mul_f32 v[48:49], v[48:49], v[104:105]
    v_pk_mul_f32 v[50:51], v[50:51], v[106:107]
    v_pk_mul_f32 v[52:53], v[52:53], v[108:109]
    v_pk_mul_f32 v[54:55], v[54:55], v[110:111]
    v_pk_mul_f32 v[56:57], v[56:57], v[112:113]
    v_pk_mul_f32 v[58:59], v[58:59], v[114:115]
    v_pk_mul_f32 v[60:61], v[60:61], v[116:117]
    v_pk_mul_f32 v[62:63], v[62:63], v[118:119]
    v_cvt_pk_bf16_f32 v68, v48, v49
    v_cvt_pk_bf16_f32 v69, v50, v51
    v_cvt_pk_bf16_f32 v70, v52, v53
    v_cvt_pk_bf16_f32 v71, v54, v55
    global_store_dwordx4 v14, v[68:71], s[62:63] sc1
    v_cvt_pk_bf16_f32 v72, v56, v57
    v_cvt_pk_bf16_f32 v73, v58, v59
    v_cvt_pk_bf16_f32 v74, v60, v61
    v_cvt_pk_bf16_f32 v75, v62, v63
    global_store_dwordx4 v14, v[72:75], s[66:67] sc1
    v_add_u32 v78, v68, v69
    v_add3_u32 v78, v78, v70, v71
    v_add_u32 v79, v72, v73
    v_add3_u32 v79, v79, v74, v75
    v_add_u32_dpp v80, v76, v76 row_ror:8 row_mask:0xf bank_mask:0xf
    v_add_u32_dpp v81, v77, v77 row_ror:8 row_mask:0xf bank_mask:0xf
    s_nop 0
    v_add_u32_dpp v80, v78, v78 row_ror:8 row_mask:0xf bank_mask:0xc
    v_add_u32_dpp v81, v79, v79 row_ror:8 row_mask:0xf bank_mask:0xc
    v_mov_b32 v76, s33
    v_add_u32_dpp v77, v80, v80 row_half_mirror row_mask:0xf bank_mask:0xf
    s_nop 1
    v_add_u32_dpp v77, v81, v81 row_half_mirror row_mask:0xf bank_mask:0xa
    s_nop 1
    v_add_u32_dpp v77, v77, v77 quad_perm:[1,0,3,2] row_mask:0xf bank_mask:0xf
    s_nop 1
    v_add_u32_dpp v77, v77, v77 quad_perm:[2,3,0,1] row_mask:0xf bank_mask:0xf
    s_mov_b32 exec_lo, 0x11111111
    s_mov_b32 exec_hi, 0x11111111
    global_store_dwordx2 v148, v[76:77], s[28:29] sc1
    s_mov_b64 exec, -1
L_nokv:
    v_mov_b32 v4, 1
    s_mov_b64 exec, 1
    ds_add_u32 v3, v4 offset:256
    s_mov_b64 exec, -1
    s_setprio 1
    s_mov_b32 s98, s43
    s_add_u32 s96, s55, 1048576
    s_add_u32 s76, s28, s96
    s_addc_u32 s77, s29, 0
    s_and_b32 s77, s77, 0xffff
    s_mov_b32 s78, 4096
    s_mov_b32 s79, 0x00020000
    v_sub_u32 v5, 2031, v1
    v_and_b32 v6, 1, v5
    v_lshrrev_b32 v5, 1, v5
    v_lshl_add_u32 v5, v2, 2, v5
    v_lshlrev_b32 v5, 2, v5
    v_mul_u32_u24 v6, 4160, v6
    s_sub_u32 s96, s42, s54
    v_add3_u32 v5, v5, v6, s96
    v_subrev_u32 v154, 3584, v5
    s_branch L_skip3962
L_pada14:
    s_branch L_warmed_a
L_skip3962:
    v_subrev_u32 v155, 2560, v5
    v_subrev_u32 v156, 1536, v5
    v_subrev_u32 v157, 512, v5
    v_lshlrev_b32 v5, 5, v1
    v_lshl_add_u32 v5, v2, 4, v5
    s_sub_u32 s96, s68, s54
    s_add_u32 s96, s96, 480
    v_add_u32 v158, s96, v5
    v_and_b32 v5, 1, v2
    v_lshlrev_b32 v5, 9, v5
    v_lshl_add_u32 v5, v1, 5, v5
    v_lshrrev_b32 v6, 1, v2
    v_lshl_add_u32 v5, v6, 4, v5
    s_add_u32 s96, s55, 4194304
    v_add_u32 v153, s96, v5
    v_and_b32 v5, 28, v0
    v_add_u32 v159, 161792, v5
    s_cmp_ge_u32 s31, 26
    s_cselect_b32 s96, 8, 0
    s_lshl_b32 s97, s30, 8
    s_add_u32 s96, s96, s97
    s_add_u32 s96, s96, 65536
    v_and_b32 v5, 31, v0
    v_lshl_add_u32 v160, v5, 11, s96
    s_mul_i32 s96, s98, 2048
    s_add_u32 s96, s96, 88448
    v_add_u32 v161, s96, v8
    s_lshl_b32 s96, s98, 2
    v_add_u32 v162, s96, v3
    s_mul_i32 s96, s57, 51200
    s_sub_u32 s80, 109568, s96
    s_mul_i32 s81, s56, 2560
    s_add_u32 s81, s81, 48128
    s_mov_b32 s93, 0
    s_mov_b32 s101, 0
    s_and_b32 s98, s35, 3
    s_lshr_b32 s96, s56, 1
    s_lshl1_add_u32 s96, s98, s96
    s_lshl1_add_u32 s96, s96, s57
    s_mul_i32 s96, s96, 20480
    s_and_b32 s97, s56, 1
    s_lshl_b32 s97, s97, 10
    s_add_u32 s96, s96, s97
    s_mul_i32 s97, s30, 327680
    s_add_u32 s96, s96, s97
    s_add_u32 s82, s96, 4096
    s_mul_i32 s96, s30, 262144
    s_lshl_b32 s98, s98, 8
    s_add_u32 s96, s96, s98
    s_add_u32 s83, s96, 7536640
    s_mul_i32 s84, s56, 5120
    s_add_u32 s84, s84, 10240
    s_lshl2_add_u32 s96, s35, s56
    s_mul_i32 s96, s96, 20480
    s_mul_i32 s97, s36, 160
    s_add_u32 s85, s96, s97
    v_and_b32 v5, 1, v1
    v_lshlrev_b32 v5, 4, v5
    v_mov_b32 v6, 0x3f80
    v_lshlrev_b32 v6, v5, v6
    v_lshrrev_b32 v7, 1, v1
    v_lshlrev_b32 v4, 1, v2
    v_sub_u32 v4, v7, v4
    v_cmp_eq_u32 vcc, 0, v4
    s_nop 1
    v_cndmask_b32 v164, 0, v6, vcc
    v_cmp_eq_u32 vcc, 1, v4
    s_nop 1
    v_cndmask_b32 v165, 0, v6, vcc
    s_lshl_b32 s96, s41, 4
    s_lshr_b32 s53, s53, s96
    s_and_b32 s53, s53, 0xffff
    v_lshlrev_b32 v6, v5, s53
    v_lshlrev_b32 v4, 2, v2
    v_sub_u32 v4, v7, v4
    v_cmp_eq_u32 vcc, -8, v4
    s_nop 1
    v_cndmask_b32 v144, 0, v6, vcc
    v_cmp_eq_u32 vcc, -7, v4
    s_nop 1
    v_cndmask_b32 v145, 0, v6, vcc
    v_cmp_eq_u32 vcc, -6, v4
    s_nop 1
    v_cndmask_b32 v146, 0, v6, vcc
    v_cmp_eq_u32 vcc, -5, v4
    s_nop 1
    v_cndmask_b32 v147, 0, v6, vcc
    s_cmp_eq_u32 s32, 4
    s_cbranch_scc1 L_pada0
    s_cmp_eq_u32 s32, 5
    s_cbranch_scc1 L_pada1
    s_cmp_eq_u32 s32, 6
    s_cbranch_scc1 L_pada2
    s_cmp_eq_u32 s32, 7
    s_cbranch_scc1 L_pada3
    s_cmp_eq_u32 s32, 8
    s_cbranch_scc1 L_pada4
    s_cmp_eq_u32 s32, 9
    s_cbranch_scc1 L_pada5
    s_cmp_eq_u32 s32, 10
    s_cbranch_scc1 L_pada6
    s_branch L_pada7
L_warmed_a:
    s_setprio 2
    s_cmp_lg_u32 s52, 0
    s_cbranch_scc1 L_owner
    s_waitcnt vmcnt(0)
    v_mov_b32 v4, 1
    s_mov_b64 exec, 1
    ds_add_u32 v3, v4 offset:280
    s_mov_b64 exec, -1
    s_cmp_lg_u32 s65, 7
    s_cbranch_scc1 L_cdone
    s_mov_b32 s100, 0
Lw_65:
    ds_read_b32 v4, v3 offset:312
    s_waitcnt lgkmcnt(0)
    v_readfirstlane_b32 s99, v4
    s_cmp_ge_u32 s99, 1
    s_cbranch_scc1 Lwd_66
    s_add_u32 s100, s100, 1
    s_cmp_lt_u32 s100, 1048576
    s_cbranch_scc1 Lw_65
Lwd_66:
    ds_read2_b32 v[48:49], v157 offset0:128 offset1:129
    ds_read2_b32 v[50:51], v157 offset0:130 offset1:131
    ds_read2_b32 v[52:53], v157 offset0:0 offset1:1
    ds_read2_b32 v[54:55], v157 offset0:2 offset1:3
    ds_read2_b32 v[56:57], v156 offset0:128 offset1:129
    ds_read2_b32 v[58:59], v156 offset0:130 offset1:131
    ds_read2_b32 v[60:61], v156 offset0:0 offset1:1
    ds_read2_b32 v[62:63], v156 offset0:2 offset1:3
    ds_read2_b32 v[64:65], v155 offset0:128 offset1:129
    ds_read2_b32 v[66:67], v155 offset0:130 offset1:131
    ds_read2_b32 v[68:69], v155 offset0:0 offset1:1
    ds_read2_b32 v[70:71], v155 offset0:2 offset1:3
    s_waitcnt lgkmcnt(6)
    ds_read2_b32 v[72:73], v154 offset0:128 offset1:129
    ds_read2_b32 v[74:75], v154 offset0:130 offset1:131
    ds_read2_b32 v[76:77], v154 offset0:0 offset1:1
    ds_read2_b32 v[78:79], v154 offset0:2 offset1:3
    s_setprio 3
    v_mov_b32 v5, 1
    s_mov_b32 s100, 0
Lw_67:
    ds_read_b32 v4, v3 offset:280
    s_waitcnt lgkmcnt(0)
    v_readfirstlane_b32 s99, v4
    s_cmp_ge_u32 s99, 8
    s_cbranch_scc1 Lwd_68
    s_add_u32 s100, s100, 1
    s_cmp_lt_u32 s100, 1048576
    s_cbranch_scc1 Lw_67
Lwd_68:
    ds_read_b128 v[80:83], v158 offset:0
    ds_read_b128 v[84:87], v158 offset:512
    ds_read_b128 v[88:91], v158 offset:1024
    ds_read_b128 v[92:95], v158 offset:1536
    ds_read_b128 v[96:99], v158 offset:2048
    ds_read_b128 v[100:103], v158 offset:2560
    ds_read_b128 v[104:107], v158 offset:3072
    ds_read_b128 v[108:111], v158 offset:3584
    s_waitcnt lgkmcnt(0)
    s_setprio 3
    s_branch L_hloop
L_pada15:
    s_branch L_warmed_a
L_owner:
    v_mov_b32 v44, 0
    v_mov_b32 v45, 0
    v_lshl_add_u32 v5, v0, 3, s68
    ds_write_b64 v5, v[44:45]
    s_mov_b64 exec, 0xffff
    s_mov_b32 s100, 0
L_ep:
    global_atomic_or_x2 v[46:47], v149, v[44:45], s[28:29] sc0 sc1
    s_waitcnt vmcnt(0)
    v_cmp_ne_u32 vcc, s33, v46
    s_cbranch_vccz L_epd
    s_mov_b64 exec, vcc
    s_add_u32 s100, s100, 1
    s_cmp_lt_u32 s100, 1048576
    s_cbranch_scc1 L_ep
L_epd:
    s_mov_b64 exec, -1
    s_setprio 3
    s_mov_b32 s100, 0
    s_add_u32 m0, s68, 512
    s_nop 0
    buffer_load_dwordx4 v8, s[76:79], 0 offen offset:0 sc1 lds
    buffer_load_dwordx4 v8, s[76:79], 0 offen offset:1024 sc1 lds
    buffer_load_dwordx4 v8, s[76:79], 0 offen offset:2048 sc1 lds
    buffer_load_dwordx4 v8, s[76:79], 0 offen offset:3072 sc1 lds
    v_add_u32_dpp v47, v47, v47 row_ror:8 row_mask:0xf bank_mask:0xf
    s_nop 1
    v_add_u32_dpp v47, v47, v47 row_ror:4 row_mask:0xf bank_mask:0xf
    s_nop 1
    v_add_u32_dpp v47, v47, v47 row_ror:2 row_mask:0xf bank_mask:0xf
    s_nop 1
    v_add_u32_dpp v47, v47, v47 row_ror:1 row_mask:0xf bank_mask:0xf
    s_nop 0
    v_readfirstlane_b32 s60, v47
    s_mov_b32 s100, 0
Lw_69:
    ds_read_b32 v4, v162 offset:312
    s_waitcnt lgkmcnt(0)
    v_readfirstlane_b32 s99, v4
    s_cmp_ge_u32 s99, 1
    s_cbranch_scc1 Lwd_70
    s_add_u32 s100, s100, 1
    s_cmp_lt_u32 s100, 1048576
    s_cbranch_scc1 Lw_69
Lwd_70:
    ds_read2_b32 v[48:49], v157 offset0:128 offset1:129
    ds_read2_b32 v[50:51], v157 offset0:130 offset1:131
    ds_read2_b32 v[52:53], v157 offset0:0 offset1:1
    ds_read2_b32 v[54:55], v157 offset0:2 offset1:3
    ds_read2_b32 v[56:57], v156 offset0:128 offset1:129
    ds_read2_b32 v[58:59], v156 offset0:130 offset1:131
    ds_read2_b32 v[60:61], v156 offset0:0 offset1:1
    ds_read2_b32 v[62:63], v156 offset0:2 offset1:3
    ds_read2_b32 v[64:65], v155 offset0:128 offset1:129
    ds_read2_b32 v[66:67], v155 offset0:130 offset1:131
    ds_read2_b32 v[68:69], v155 offset0:0 offset1:1
    ds_read2_b32 v[70:71], v155 offset0:2 offset1:3
    s_waitcnt lgkmcnt(6)
    ds_read2_b32 v[72:73], v154 offset0:128 offset1:129
    ds_read2_b32 v[74:75], v154 offset0:130 offset1:131
    ds_read2_b32 v[76:77], v154 offset0:0 offset1:1
    ds_read2_b32 v[78:79], v154 offset0:2 offset1:3
    s_mov_b32 s100, 0
L_uretry:
    s_waitcnt vmcnt(0) lgkmcnt(0)
    ds_read_b128 v[108:111], v158 offset:3584
    ds_read_b128 v[104:107], v158 offset:3072
    ds_read_b128 v[100:103], v158 offset:2560
    ds_read_b128 v[96:99], v158 offset:2048
    ds_read_b128 v[92:95], v158 offset:1536
    ds_read_b128 v[88:91], v158 offset:1024
    ds_read_b128 v[84:87], v158 offset:512
    ds_read_b128 v[80:83], v158 offset:0
    s_waitcnt lgkmcnt(7)
    v_mfma_f32_16x16x32_bf16 v[44:47], v[144:147], v[108:111], 0
    v_add_u32 v9, v108, v109
    v_add3_u32 v9, v9, v110, v111
    s_waitcnt lgkmcnt(6)
    v_mfma_f32_16x16x32_bf16 v[40:43], v[144:147], v[104:107], 0
    v_add3_u32 v9, v9, v104, v105
    v_add3_u32 v9, v9, v106, v107
    s_waitcnt lgkmcnt(5)
    v_mfma_f32_16x16x32_bf16 v[36:39], v[144:147], v[100:103], 0
    v_add3_u32 v9, v9, v100, v101
    v_add3_u32 v9, v9, v102, v103
    s_waitcnt lgkmcnt(4)
    v_mfma_f32_16x16x32_bf16 v[32:35], v[144:147], v[96:99], 0
    v_add3_u32 v9, v9, v96, v97
    v_add3_u32 v9, v9, v98, v99
    s_waitcnt lgkmcnt(3)
    v_mfma_f32_16x16x32_bf16 v[28:31], v[144:147], v[92:95], 0
    v_add3_u32 v9, v9, v92, v93
    v_add3_u32 v9, v9, v94, v95
    s_waitcnt lgkmcnt(2)
    v_mfma_f32_16x16x32_bf16 v[24:27], v[144:147], v[88:91], 0
    v_add3_u32 v9, v9, v88, v89
    v_add3_u32 v9, v9, v90, v91
    s_waitcnt lgkmcnt(1)
    v_mfma_f32_16x16x32_bf16 v[20:23], v[144:147], v[84:87], 0
    v_add3_u32 v9, v9, v84, v85
    v_add3_u32 v9, v9, v86, v87
    s_waitcnt lgkmcnt(0)
    v_mfma_f32_16x16x32_bf16 v[16:19], v[144:147], v[80:83], 0
    v_add3_u32 v9, v9, v80, v81
    v_add3_u32 v9, v9, v82, v83
    s_nop 1
    v_add_u32_dpp v9, v9, v9 row_ror:8 row_mask:0xf bank_mask:0xf
    s_nop 1
    v_add_u32_dpp v9, v9, v9 row_ror:4 row_mask:0xf bank_mask:0xf
    s_nop 1
    v_add_u32_dpp v9, v9, v9 row_ror:2 row_mask:0xf bank_mask:0xf
    s_nop 1
    v_add_u32_dpp v9, v9, v9 row_ror:1 row_mask:0xf bank_mask:0xf
    s_nop 0
    v_readlane_b32 s96, v9, 32
    v_readlane_b32 s97, v9, 48
    v_mov_b32 v4, 1
    s_add_u32 s96, s96, s97
    s_cmp_eq_u32 s96, s60
    s_cbranch_scc1 L_uok
    buffer_load_dwordx4 v8, s[76:79], 0 offen offset:0 sc1 lds
    buffer_load_dwordx4 v8, s[76:79], 0 offen offset:1024 sc1 lds
    buffer_load_dwordx4 v8, s[76:79], 0 offen offset:2048 sc1 lds
    buffer_load_dwordx4 v8, s[76:79], 0 offen offset:3072 sc1 lds
    s_add_u32 s100, s100, 1
    s_cmp_lt_u32 s100, 1048576
    s_cbranch_scc1 L_uretry
L_uok:
    s_mov_b64 exec, 1
    ds_add_u32 v3, v4 offset:280
    s_mov_b64 exec, -1
    s_branch L_skip4259
L_pada16:
    s_branch L_warmed_a
L_skip4259:
L_cloop:
    s_setprio 2
    s_cmp_gt_u32 s20, 4
    s_cbranch_scc1 Lcp_71
    s_setprio 1
    s_cmp_gt_u32 s20, 2
    s_cbranch_scc1 Lcp_71
    s_setprio 0
Lcp_71:
    v_subrev_u32 v154, 64, v154
    v_subrev_u32 v155, 64, v155
    v_subrev_u32 v156, 64, v156
    v_subrev_u32 v157, 64, v157
    v_subrev_u32 v158, 64, v158
    s_waitcnt lgkmcnt(15)
    v_mfma_f32_16x16x32_bf16 v[44:47], v[48:51], v[108:111], v[44:47]
    v_mfma_f32_16x16x32_bf16 v[40:43], v[48:51], v[104:107], v[40:43]
    s_waitcnt lgkmcnt(12)
    ds_read_b128 v[140:143], v158 offset:3584
    v_mfma_f32_16x16x32_bf16 v[36:39], v[48:51], v[100:103], v[36:39]
    v_mfma_f32_16x16x32_bf16 v[32:35], v[48:51], v[96:99], v[32:35]
    ds_read_b128 v[136:139], v158 offset:3072
    v_mfma_f32_16x16x32_bf16 v[28:31], v[48:51], v[92:95], v[28:31]
    v_mfma_f32_16x16x32_bf16 v[24:27], v[48:51], v[88:91], v[24:27]
    s_waitcnt lgkmcnt(12)
    ds_read_b128 v[132:135], v158 offset:2560
    s_waitcnt lgkmcnt(8)
    v_mfma_f32_16x16x32_bf16 v[20:23], v[48:51], v[84:87], v[20:23]
    s_waitcnt lgkmcnt(7)
    v_mfma_f32_16x16x32_bf16 v[16:19], v[48:51], v[80:83], v[16:19]
    ds_read_b128 v[128:131], v158 offset:2048
    v_mfma_f32_16x16x32_bf16 v[44:47], v[52:55], v[104:107], v[44:47]
    v_mfma_f32_16x16x32_bf16 v[40:43], v[52:55], v[100:103], v[40:43]
    ds_read2_b32 v[48:49], v157 offset0:128 offset1:129
    v_mfma_f32_16x16x32_bf16 v[36:39], v[52:55], v[96:99], v[36:39]
    v_mfma_f32_16x16x32_bf16 v[32:35], v[52:55], v[92:95], v[32:35]
    ds_read2_b32 v[50:51], v157 offset0:130 offset1:131
    v_mfma_f32_16x16x32_bf16 v[28:31], v[52:55], v[88:91], v[28:31]
    v_mfma_f32_16x16x32_bf16 v[24:27], v[52:55], v[84:87], v[24:27]
    ds_read_b128 v[124:127], v158 offset:1536
    v_mfma_f32_16x16x32_bf16 v[20:23], v[52:55], v[80:83], v[20:23]
    v_mfma_f32_16x16x32_bf16 v[44:47], v[56:59], v[100:103], v[44:47]
    v_mfma_f32_16x16x32_bf16 v[40:43], v[56:59], v[96:99], v[40:43]
    ds_read2_b32 v[52:53], v157 offset0:0 offset1:1
    v_mfma_f32_16x16x32_bf16 v[36:39], v[56:59], v[92:95], v[36:39]
    v_mfma_f32_16x16x32_bf16 v[32:35], v[56:59], v[88:91], v[32:35]
    ds_read2_b32 v[54:55], v157 offset0:2 offset1:3
    v_mfma_f32_16x16x32_bf16 v[28:31], v[56:59], v[84:87], v[28:31]
    v_mfma_f32_16x16x32_bf16 v[24:27], v[56:59], v[80:83], v[24:27]
    ds_read_b128 v[120:123], v158 offset:1024
    v_mfma_f32_16x16x32_bf16 v[44:47], v[60:63], v[96:99], v[44:47]
    v_mfma_f32_16x16x32_bf16 v[40:43], v[60:63], v[92:95], v[40:43]
    s_waitcnt lgkmcnt(12)
    ds_read2_b32 v[56:57], v156 offset0:128 offset1:129
    v_mfma_f32_16x16x32_bf16 v[36:39], v[60:63], v[88:91], v[36:39]
    v_mfma_f32_16x16x32_bf16 v[32:35], v[60:63], v[84:87], v[32:35]
    ds_read2_b32 v[58:59], v156 offset0:130 offset1:131
    v_mfma_f32_16x16x32_bf16 v[28:31], v[60:63], v[80:83], v[28:31]
    v_mfma_f32_16x16x32_bf16 v[44:47], v[64:67], v[92:95], v[44:47]
    v_mfma_f32_16x16x32_bf16 v[40:43], v[64:67], v[88:91], v[40:43]
    s_waitcnt lgkmcnt(12)
    ds_read2_b32 v[60:61], v156 offset0:0 offset1:1
    v_mfma_f32_16x16x32_bf16 v[36:39], v[64:67], v[84:87], v[36:39]
    v_mfma_f32_16x16x32_bf16 v[32:35], v[64:67], v[80:83], v[32:35]
    ds_read2_b32 v[62:63], v156 offset0:2 offset1:3
    v_mfma_f32_16x16x32_bf16 v[44:47], v[68:71], v[88:91], v[44:47]
    v_mfma_f32_16x16x32_bf16 v[40:43], v[68:71], v[84:87], v[40:43]
    s_waitcnt lgkmcnt(12)
    ds_read2_b32 v[64:65], v155 offset0:128 offset1:129
    v_mfma_f32_16x16x32_bf16 v[36:39], v[68:71], v[80:83], v[36:39]
    ds_read2_b32 v[68:69], v155 offset0:0 offset1:1
    s_waitcnt lgkmcnt(12)
    ds_read2_b32 v[70:71], v155 offset0:2 offset1:3
    ds_read2_b32 v[66:67], v155 offset0:130 offset1:131
    s_waitcnt lgkmcnt(12)
    ds_read_b128 v[116:119], v158 offset:512
    ds_read_b128 v[112:115], v158 offset:0
    v_mfma_f32_16x16x32_bf16 v[44:47], v[72:75], v[84:87], v[44:47]
    v_mfma_f32_16x16x32_bf16 v[40:43], v[72:75], v[80:83], v[40:43]
    s_waitcnt lgkmcnt(12)
    ds_read2_b32 v[72:73], v154 offset0:128 offset1:129
    ds_read2_b32 v[74:75], v154 offset0:130 offset1:131
    v_mfma_f32_16x16x32_bf16 v[44:47], v[76:79], v[80:83], v[44:47]
    s_waitcnt lgkmcnt(12)
    ds_read2_b32 v[76:77], v154 offset0:0 offset1:1
    ds_read2_b32 v[78:79], v154 offset0:2 offset1:3
    v_subrev_u32 v154, 64, v154
    v_subrev_u32 v155, 64, v155
    v_subrev_u32 v156, 64, v156
    v_subrev_u32 v157, 64, v157
    v_subrev_u32 v158, 64, v158
    v_mfma_f32_16x16x32_bf16 v[44:47], v[48:51], v[140:143], v[44:47]
    v_mfma_f32_16x16x32_bf16 v[40:43], v[48:51], v[136:139], v[40:43]
    s_waitcnt lgkmcnt(12)
    ds_read_b128 v[108:111], v158 offset:3584
    v_mfma_f32_16x16x32_bf16 v[36:39], v[48:51], v[132:135], v[36:39]
    v_mfma_f32_16x16x32_bf16 v[32:35], v[48:51], v[128:131], v[32:35]
    ds_read_b128 v[104:107], v158 offset:3072
    v_mfma_f32_16x16x32_bf16 v[28:31], v[48:51], v[124:127], v[28:31]
    v_mfma_f32_16x16x32_bf16 v[24:27], v[48:51], v[120:123], v[24:27]
    s_waitcnt lgkmcnt(12)
    ds_read_b128 v[100:103], v158 offset:2560
    s_waitcnt lgkmcnt(8)
    v_mfma_f32_16x16x32_bf16 v[20:23], v[48:51], v[116:119], v[20:23]
    s_waitcnt lgkmcnt(7)
    v_mfma_f32_16x16x32_bf16 v[16:19], v[48:51], v[112:115], v[16:19]
    ds_read_b128 v[96:99], v158 offset:2048
    v_mfma_f32_16x16x32_bf16 v[44:47], v[52:55], v[136:139], v[44:47]
    v_mfma_f32_16x16x32_bf16 v[40:43], v[52:55], v[132:135], v[40:43]
    ds_read2_b32 v[48:49], v157 offset0:128 offset1:129
    v_mfma_f32_16x16x32_bf16 v[36:39], v[52:55], v[128:131], v[36:39]
    v_mfma_f32_16x16x32_bf16 v[32:35], v[52:55], v[124:127], v[32:35]
    ds_read2_b32 v[50:51], v157 offset0:130 offset1:131
    v_mfma_f32_16x16x32_bf16 v[28:31], v[52:55], v[120:123], v[28:31]
    v_mfma_f32_16x16x32_bf16 v[24:27], v[52:55], v[116:119], v[24:27]
    ds_read_b128 v[92:95], v158 offset:1536
    v_mfma_f32_16x16x32_bf16 v[20:23], v[52:55], v[112:115], v[20:23]
    v_mfma_f32_16x16x32_bf16 v[44:47], v[56:59], v[132:135], v[44:47]
    v_mfma_f32_16x16x32_bf16 v[40:43], v[56:59], v[128:131], v[40:43]
    ds_read2_b32 v[52:53], v157 offset0:0 offset1:1
    v_mfma_f32_16x16x32_bf16 v[36:39], v[56:59], v[124:127], v[36:39]
    v_mfma_f32_16x16x32_bf16 v[32:35], v[56:59], v[120:123], v[32:35]
    ds_read2_b32 v[54:55], v157 offset0:2 offset1:3
    v_mfma_f32_16x16x32_bf16 v[28:31], v[56:59], v[116:119], v[28:31]
    v_mfma_f32_16x16x32_bf16 v[24:27], v[56:59], v[112:115], v[24:27]
    ds_read_b128 v[88:91], v158 offset:1024
    v_mfma_f32_16x16x32_bf16 v[44:47], v[60:63], v[128:131], v[44:47]
    v_mfma_f32_16x16x32_bf16 v[40:43], v[60:63], v[124:127], v[40:43]
    s_waitcnt lgkmcnt(12)
    ds_read2_b32 v[56:57], v156 offset0:128 offset1:129
    v_mfma_f32_16x16x32_bf16 v[36:39], v[60:63], v[120:123], v[36:39]
    v_mfma_f32_16x16x32_bf16 v[32:35], v[60:63], v[116:119], v[32:35]
    ds_read2_b32 v[58:59], v156 offset0:130 offset1:131
    v_mfma_f32_16x16x32_bf16 v[28:31], v[60:63], v[112:115], v[28:31]
    v_mfma_f32_16x16x32_bf16 v[44:47], v[64:67], v[124:127], v[44:47]
    v_mfma_f32_16x16x32_bf16 v[40:43], v[64:67], v[120:123], v[40:43]
    s_waitcnt lgkmcnt(12)
    ds_read2_b32 v[60:61], v156 offset0:0 offset1:1
    v_mfma_f32_16x16x32_bf16 v[36:39], v[64:67], v[116:119], v[36:39]
    v_mfma_f32_16x16x32_bf16 v[32:35], v[64:67], v[112:115], v[32:35]
    ds_read2_b32 v[62:63], v156 offset0:2 offset1:3
    v_mfma_f32_16x16x32_bf16 v[44:47], v[68:71], v[120:123], v[44:47]
    v_mfma_f32_16x16x32_bf16 v[40:43], v[68:71], v[116:119], v[40:43]
    s_waitcnt lgkmcnt(12)
    ds_read2_b32 v[64:65], v155 offset0:128 offset1:129
    v_mfma_f32_16x16x32_bf16 v[36:39], v[68:71], v[112:115], v[36:39]
    ds_read2_b32 v[68:69], v155 offset0:0 offset1:1
    s_waitcnt lgkmcnt(12)
    ds_read2_b32 v[70:71], v155 offset0:2 offset1:3
    ds_read2_b32 v[66:67], v155 offset0:130 offset1:131
    s_waitcnt lgkmcnt(12)
    ds_read_b128 v[84:87], v158 offset:512
    ds_read_b128 v[80:83], v158 offset:0
    v_mfma_f32_16x16x32_bf16 v[44:47], v[72:75], v[116:119], v[44:47]
    v_mfma_f32_16x16x32_bf16 v[40:43], v[72:75], v[112:115], v[40:43]
    s_waitcnt lgkmcnt(12)
    ds_read2_b32 v[72:73], v154 offset0:128 offset1:129
    ds_read2_b32 v[74:75], v154 offset0:130 offset1:131
    v_mfma_f32_16x16x32_bf16 v[44:47], v[76:79], v[112:115], v[44:47]
    s_waitcnt lgkmcnt(12)
    ds_read2_b32 v[76:77], v154 offset0:0 offset1:1
    ds_read2_b32 v[78:79], v154 offset0:2 offset1:3
    s_sub_u32 s20, s20, 2
    s_cmp_lg_u32 s20, 1
    s_cbranch_scc1 L_cloop
    s_branch L_skip4424
L_pada17:
    s_branch L_warmed_a
L_skip4424:
L_cexit:
    s_setprio 0
    v_subrev_u32 v156, 64, v156
    v_subrev_u32 v157, 64, v157
    v_subrev_u32 v158, 64, v158
    s_mov_b32 s100, 0
Lw_72:
    ds_read_b32 v4, v162 offset:284
    s_waitcnt lgkmcnt(0)
    v_readfirstlane_b32 s99, v4
    s_cmp_ge_u32 s99, 1
    s_cbranch_scc1 Lwd_73
    s_add_u32 s100, s100, 1
    s_cmp_lt_u32 s100, 1048576
    s_cbranch_scc1 Lw_72
Lwd_73:
    ds_read_b128 v[144:147], v161 offset:2048
    ds_read_b128 v[148:151], v161 offset:3072
    ds_read_b128 v[112:115], v158 offset:0
    ds_read2_b32 v[128:129], v157 offset0:128 offset1:129
    ds_read2_b32 v[130:131], v157 offset0:130 offset1:131
    ds_read_b128 v[116:119], v158 offset:512
    ds_read2_b32 v[132:133], v157 offset0:0 offset1:1
    ds_read2_b32 v[134:135], v157 offset0:2 offset1:3
    ds_read_b128 v[120:123], v158 offset:1024
    ds_read2_b32 v[136:137], v156 offset0:128 offset1:129
    ds_read2_b32 v[138:139], v156 offset0:130 offset1:131
    ds_read_b128 v[124:127], v158 offset:1536
    ds_read2_b32 v[140:141], v156 offset0:0 offset1:1
    ds_read2_b32 v[142:143], v156 offset0:2 offset1:3
    s_mov_b32 s62, 0x11111111
    s_mov_b32 s63, 0x11111111
    v_mfma_f32_16x16x32_bf16 v[32:35], v[48:51], v[96:99], v[32:35]
    v_mfma_f32_16x16x32_bf16 v[36:39], v[48:51], v[100:103], v[36:39]
    v_mfma_f32_16x16x32_bf16 v[32:35], v[52:55], v[92:95], v[32:35]
    v_mfma_f32_16x16x32_bf16 v[36:39], v[52:55], v[96:99], v[36:39]
    v_mfma_f32_16x16x32_bf16 v[32:35], v[56:59], v[88:91], v[32:35]
    v_mfma_f32_16x16x32_bf16 v[36:39], v[56:59], v[92:95], v[36:39]
    s_waitcnt lgkmcnt(12)
    v_mfma_f32_16x16x16_bf16 v[40:43], v[164:165], v[148:149], v[40:43]
    v_mfma_f32_16x16x16_bf16 v[44:47], v[164:165], v[150:151], v[44:47]
    v_mfma_f32_16x16x16_bf16 v[32:35], v[164:165], v[144:145], v[32:35]
    v_mfma_f32_16x16x16_bf16 v[36:39], v[164:165], v[146:147], v[36:39]
    v_mfma_f32_16x16x32_bf16 v[32:35], v[60:63], v[84:87], v[32:35]
    v_mfma_f32_16x16x32_bf16 v[36:39], v[60:63], v[88:91], v[36:39]
    v_mfma_f32_16x16x32_bf16 v[32:35], v[64:67], v[80:83], v[32:35]
    v_mfma_f32_16x16x32_bf16 v[36:39], v[64:67], v[84:87], v[36:39]
    v_mfma_f32_16x16x32_bf16 v[36:39], v[68:71], v[80:83], v[36:39]
    s_waitcnt lgkmcnt(0)
    v_mfma_f32_16x16x32_bf16 v[16:19], v[48:51], v[80:83], v[16:19]
    v_mfma_f32_16x16x32_bf16 v[20:23], v[48:51], v[84:87], v[20:23]
    v_mfma_f32_16x16x32_bf16 v[20:23], v[52:55], v[80:83], v[20:23]
    s_nop 1
    v_cvt_pk_bf16_f32 v8, v32, v33
    v_cvt_pk_bf16_f32 v9, v34, v35
    v_mfma_f32_16x16x32_bf16 v[16:19], v[128:131], v[112:115], v[16:19]
    v_cvt_pk_bf16_f32 v10, v36, v37
    v_cvt_pk_bf16_f32 v11, v38, v39
    v_mfma_f32_16x16x32_bf16 v[20:23], v[128:131], v[116:119], v[20:23]
    v_permlane16_swap_b32 v8, v10
    v_permlane16_swap_b32 v9, v11
    v_mfma_f32_16x16x32_bf16 v[20:23], v[132:135], v[112:115], v[20:23]
    global_store_dwordx4 v153, v[8:11], s[28:29] offset:2048 sc1
    v_add_u32 v6, v8, v9
    v_mfma_f32_16x16x32_bf16 v[24:27], v[48:51], v[88:91], v[24:27]
    v_mfma_f32_16x16x32_bf16 v[28:31], v[48:51], v[92:95], v[28:31]
    v_mfma_f32_16x16x32_bf16 v[24:27], v[52:55], v[84:87], v[24:27]
    v_add3_u32 v6, v6, v10, v11
    s_nop 1
    v_add_u32_dpp v6, v6, v6 quad_perm:[1,0,3,2] row_mask:0xf bank_mask:0xf
    v_mfma_f32_16x16x32_bf16 v[28:31], v[52:55], v[88:91], v[28:31]
    s_nop 0
    v_add_u32_dpp v6, v6, v6 quad_perm:[2,3,0,1] row_mask:0xf bank_mask:0xf
    s_mov_b64 exec, s[62:63]
    ds_add_u32 v159, v6 offset:64
    s_mov_b64 exec, -1
    v_mfma_f32_16x16x32_bf16 v[24:27], v[56:59], v[80:83], v[24:27]
    v_cvt_pk_bf16_f32 v12, v16, v17
    v_cvt_pk_bf16_f32 v13, v18, v19
    v_mfma_f32_16x16x32_bf16 v[28:31], v[56:59], v[84:87], v[28:31]
    v_cvt_pk_bf16_f32 v14, v20, v21
    v_cvt_pk_bf16_f32 v15, v22, v23
    v_mfma_f32_16x16x32_bf16 v[28:31], v[60:63], v[80:83], v[28:31]
    v_permlane16_swap_b32 v12, v14
    v_permlane16_swap_b32 v13, v15
    v_mfma_f32_16x16x32_bf16 v[24:27], v[128:131], v[120:123], v[24:27]
    global_store_dwordx4 v153, v[12:15], s[28:29] offset:0 sc1
    v_add_u32 v6, v12, v13
    v_mfma_f32_16x16x32_bf16 v[28:31], v[128:131], v[124:127], v[28:31]
    v_add3_u32 v6, v6, v14, v15
    s_nop 1
    v_add_u32_dpp v6, v6, v6 quad_perm:[1,0,3,2] row_mask:0xf bank_mask:0xf
    v_mfma_f32_16x16x32_bf16 v[24:27], v[132:135], v[116:119], v[24:27]
    s_nop 0
    v_add_u32_dpp v6, v6, v6 quad_perm:[2,3,0,1] row_mask:0xf bank_mask:0xf
    s_mov_b64 exec, s[62:63]
    ds_add_u32 v159, v6 offset:0
    s_mov_b64 exec, -1
    v_mfma_f32_16x16x32_bf16 v[28:31], v[132:135], v[120:123], v[28:31]
    v_mfma_f32_16x16x32_bf16 v[24:27], v[136:139], v[112:115], v[24:27]
    v_mfma_f32_16x16x32_bf16 v[28:31], v[136:139], v[116:119], v[28:31]
    v_mfma_f32_16x16x32_bf16 v[28:31], v[140:143], v[112:115], v[28:31]
    v_mfma_f32_16x16x32_bf16 v[40:43], v[48:51], v[104:107], v[40:43]
    v_mfma_f32_16x16x32_bf16 v[44:47], v[48:51], v[108:111], v[44:47]
    v_mfma_f32_16x16x32_bf16 v[40:43], v[52:55], v[100:103], v[40:43]
    s_nop 2
    v_cvt_pk_bf16_f32 v8, v24, v25
    v_cvt_pk_bf16_f32 v9, v26, v27
    v_mfma_f32_16x16x32_bf16 v[44:47], v[52:55], v[104:107], v[44:47]
    v_cvt_pk_bf16_f32 v10, v28, v29
    v_cvt_pk_bf16_f32 v11, v30, v31
    v_mfma_f32_16x16x32_bf16 v[40:43], v[56:59], v[96:99], v[40:43]
    v_permlane16_swap_b32 v8, v10
    v_permlane16_swap_b32 v9, v11
    v_mfma_f32_16x16x32_bf16 v[44:47], v[56:59], v[100:103], v[44:47]
    global_store_dwordx4 v153, v[8:11], s[28:29] offset:1024 sc1
    v_add_u32 v6, v8, v9
    v_mfma_f32_16x16x32_bf16 v[40:43], v[60:63], v[92:95], v[40:43]
    v_add3_u32 v6, v6, v10, v11
    s_nop 1
    v_add_u32_dpp v6, v6, v6 quad_perm:[1,0,3,2] row_mask:0xf bank_mask:0xf
    v_mfma_f32_16x16x32_bf16 v[44:47], v[60:63], v[96:99], v[44:47]
    s_nop 0
    v_add_u32_dpp v6, v6, v6 quad_perm:[2,3,0,1] row_mask:0xf bank_mask:0xf
    s_mov_b64 exec, s[62:63]
    ds_add_u32 v159, v6 offset:32
    s_mov_b64 exec, -1
    v_mfma_f32_16x16x32_bf16 v[40:43], v[64:67], v[88:91], v[40:43]
    v_mfma_f32_16x16x32_bf16 v[44:47], v[64:67], v[92:95], v[44:47]
    v_mfma_f32_16x16x32_bf16 v[40:43], v[68:71], v[84:87], v[40:43]
    v_mfma_f32_16x16x32_bf16 v[44:47], v[68:71], v[88:91], v[44:47]
    v_mfma_f32_16x16x32_bf16 v[40:43], v[72:75], v[80:83], v[40:43]
    v_mfma_f32_16x16x32_bf16 v[44:47], v[72:75], v[84:87], v[44:47]
    v_mfma_f32_16x16x32_bf16 v[44:47], v[76:79], v[80:83], v[44:47]
    s_setprio 3
    s_nop 4
    v_cvt_pk_bf16_f32 v12, v40, v41
    v_cvt_pk_bf16_f32 v13, v42, v43
    v_cvt_pk_bf16_f32 v14, v44, v45
    v_cvt_pk_bf16_f32 v15, v46, v47
    s_nop 0
    v_permlane16_swap_b32 v12, v14
    v_permlane16_swap_b32 v13, v15
    s_branch L_skip4567
L_pada18:
    s_branch L_warmed_a
L_skip4567:
    global_store_dwordx4 v153, v[12:15], s[28:29] offset:3072 sc1
    v_add_u32 v6, v12, v13
    v_add3_u32 v6, v6, v14, v15
    s_nop 1
    v_add_u32_dpp v6, v6, v6 quad_perm:[1,0,3,2] row_mask:0xf bank_mask:0xf
    s_nop 1
    v_add_u32_dpp v6, v6, v6 quad_perm:[2,3,0,1] row_mask:0xf bank_mask:0xf
    s_mov_b64 exec, s[62:63]
    ds_add_u32 v159, v6 offset:96
    s_mov_b64 exec, -1
    v_mov_b32 v4, 1
    s_mov_b64 exec, 1
    ds_add_u32 v3, v4 offset:196
    ds_add_rtn_u32 v4, v3, v4 offset:252
    s_mov_b64 exec, -1
    v_lshlrev_b32 v5, 2, v0
    v_add_u32 v5, 161792, v5
    ds_read_b32 v30, v5
    v_mov_b32 v31, 0x100
    s_waitcnt lgkmcnt(0)
    v_readfirstlane_b32 s98, v4
    s_add_u32 s98, s98, 1
    s_cmp_lg_u32 s98, s64
    s_cbranch_scc1 L_ynf
    s_mov_b64 exec, 0xffffffff
    global_atomic_add_x2 v[132:133], v160, v[30:31], s[28:29] sc0 sc1
    s_mov_b64 exec, -1
    s_mov_b32 s101, 1
L_ynf:
    s_branch L_cjoin
L_pada19:
    s_branch L_warmed_a
L_hloop:
    v_add_u32 v154, 8320, v154
    v_add_u32 v155, 8320, v155
    v_add_u32 v156, 8320, v156
    v_add_u32 v157, 8320, v157
    v_add_u32 v158, 4608, v158
    s_waitcnt lgkmcnt(15)
    v_mfma_f32_16x16x32_bf16 v[44:47], v[48:51], v[108:111], 0
    v_mfma_f32_16x16x32_bf16 v[40:43], v[48:51], v[104:107], 0
    s_waitcnt lgkmcnt(12)
    ds_read_b128 v[140:143], v158 offset:3584
    v_mfma_f32_16x16x32_bf16 v[36:39], v[48:51], v[100:103], 0
    s_waitcnt lgkmcnt(12)
    v_mfma_f32_16x16x32_bf16 v[32:35], v[48:51], v[96:99], 0
    ds_read_b128 v[136:139], v158 offset:3072
    v_mfma_f32_16x16x32_bf16 v[44:47], v[52:55], v[104:107], v[44:47]
    v_mfma_f32_16x16x32_bf16 v[40:43], v[52:55], v[100:103], v[40:43]
    ds_read2_b32 v[48:49], v157 offset0:128 offset1:129
    v_mfma_f32_16x16x32_bf16 v[36:39], v[52:55], v[96:99], v[36:39]
    s_waitcnt lgkmcnt(13)
    v_mfma_f32_16x16x32_bf16 v[32:35], v[52:55], v[92:95], v[32:35]
    ds_read2_b32 v[50:51], v157 offset0:130 offset1:131
    v_mfma_f32_16x16x32_bf16 v[44:47], v[56:59], v[100:103], v[44:47]
    v_mfma_f32_16x16x32_bf16 v[40:43], v[56:59], v[96:99], v[40:43]
    s_waitcnt lgkmcnt(12)
    ds_read2_b32 v[52:53], v157 offset0:0 offset1:1
    v_mfma_f32_16x16x32_bf16 v[36:39], v[56:59], v[92:95], v[36:39]
    v_mfma_f32_16x16x32_bf16 v[32:35], v[56:59], v[88:91], v[32:35]
    ds_read2_b32 v[54:55], v157 offset0:2 offset1:3
    v_mfma_f32_16x16x32_bf16 v[44:47], v[60:63], v[96:99], v[44:47]
    v_mfma_f32_16x16x32_bf16 v[40:43], v[60:63], v[92:95], v[40:43]
    s_waitcnt lgkmcnt(12)
    ds_read2_b32 v[56:57], v156 offset0:128 offset1:129
    v_mfma_f32_16x16x32_bf16 v[36:39], v[60:63], v[88:91], v[36:39]
    v_mfma_f32_16x16x32_bf16 v[32:35], v[60:63], v[84:87], v[32:35]
    ds_read2_b32 v[58:59], v156 offset0:130 offset1:131
    v_mfma_f32_16x16x32_bf16 v[44:47], v[64:67], v[92:95], v[44:47]
    v_mfma_f32_16x16x32_bf16 v[40:43], v[64:67], v[88:91], v[40:43]
    s_waitcnt lgkmcnt(12)
    ds_read2_b32 v[60:61], v156 offset0:0 offset1:1
    v_mfma_f32_16x16x32_bf16 v[36:39], v[64:67], v[84:87], v[36:39]
    v_mfma_f32_16x16x32_bf16 v[32:35], v[64:67], v[80:83], v[32:35]
    ds_read2_b32 v[62:63], v156 offset0:2 offset1:3
    v_mfma_f32_16x16x32_bf16 v[44:47], v[68:71], v[88:91], v[44:47]
    v_mfma_f32_16x16x32_bf16 v[40:43], v[68:71], v[84:87], v[40:43]
    s_waitcnt lgkmcnt(12)
    ds_read2_b32 v[64:65], v155 offset0:128 offset1:129
    v_mfma_f32_16x16x32_bf16 v[36:39], v[68:71], v[80:83], v[36:39]
    ds_read2_b32 v[68:69], v155 offset0:0 offset1:1
    s_waitcnt lgkmcnt(12)
    ds_read2_b32 v[70:71], v155 offset0:2 offset1:3
    ds_read2_b32 v[66:67], v155 offset0:130 offset1:131
    s_waitcnt lgkmcnt(12)
    ds_read_b128 v[132:135], v158 offset:2560
    ds_read_b128 v[128:131], v158 offset:2048
    s_waitcnt lgkmcnt(12)
    ds_read_b128 v[124:127], v158 offset:1536
    ds_read_b128 v[120:123], v158 offset:1024
    s_waitcnt lgkmcnt(12)
    ds_read_b128 v[116:119], v158 offset:512
    ds_read_b128 v[112:115], v158 offset:0
    v_mfma_f32_16x16x32_bf16 v[44:47], v[72:75], v[84:87], v[44:47]
    v_mfma_f32_16x16x32_bf16 v[40:43], v[72:75], v[80:83], v[40:43]
    s_waitcnt lgkmcnt(12)
    ds_read2_b32 v[72:73], v154 offset0:128 offset1:129
    ds_read2_b32 v[74:75], v154 offset0:130 offset1:131
    v_mfma_f32_16x16x32_bf16 v[44:47], v[76:79], v[80:83], v[44:47]
    s_waitcnt lgkmcnt(12)
    ds_read2_b32 v[76:77], v154 offset0:0 offset1:1
    ds_read2_b32 v[78:79], v154 offset0:2 offset1:3
    v_cvt_pk_bf16_f32 v8, v32, v33
    v_cvt_pk_bf16_f32 v9, v34, v35
    v_cvt_pk_bf16_f32 v10, v36, v37
    v_cvt_pk_bf16_f32 v11, v38, v39
    s_waitcnt lgkmcnt(12)
    ds_write_b128 v161, v[8:11] offset:2048
    v_cvt_pk_bf16_f32 v12, v40, v41
    v_cvt_pk_bf16_f32 v13, v42, v43
    v_cvt_pk_bf16_f32 v14, v44, v45
    v_cvt_pk_bf16_f32 v15, v46, v47
    ds_write_b128 v161, v[12:15] offset:3072
    s_waitcnt lgkmcnt(12)
    ds_write_b32 v162, v5 offset:284
    v_add_u32 v161, 2048, v161
    v_add_u32 v162, 4, v162
    s_sub_u32 s20, s20, 1
    s_cmp_eq_u32 s20, 0
    s_cbranch_scc1 L_hexit
    v_add_u32 v154, 8320, v154
    v_add_u32 v155, 8320, v155
    v_add_u32 v156, 8320, v156
    v_add_u32 v157, 8320, v157
    v_add_u32 v158, 4608, v158
    v_mfma_f32_16x16x32_bf16 v[44:47], v[48:51], v[140:143], 0
    v_mfma_f32_16x16x32_bf16 v[40:43], v[48:51], v[136:139], 0
    ds_read_b128 v[108:111], v158 offset:3584
    s_waitcnt lgkmcnt(13)
    v_mfma_f32_16x16x32_bf16 v[36:39], v[48:51], v[132:135], 0
    s_waitcnt lgkmcnt(12)
    v_mfma_f32_16x16x32_bf16 v[32:35], v[48:51], v[128:131], 0
    ds_read_b128 v[104:107], v158 offset:3072
    v_mfma_f32_16x16x32_bf16 v[44:47], v[52:55], v[136:139], v[44:47]
    v_mfma_f32_16x16x32_bf16 v[40:43], v[52:55], v[132:135], v[40:43]
    ds_read2_b32 v[48:49], v157 offset0:128 offset1:129
    v_mfma_f32_16x16x32_bf16 v[36:39], v[52:55], v[128:131], v[36:39]
    s_waitcnt lgkmcnt(13)
    v_mfma_f32_16x16x32_bf16 v[32:35], v[52:55], v[124:127], v[32:35]
    ds_read2_b32 v[50:51], v157 offset0:130 offset1:131
    v_mfma_f32_16x16x32_bf16 v[44:47], v[56:59], v[132:135], v[44:47]
    v_mfma_f32_16x16x32_bf16 v[40:43], v[56:59], v[128:131], v[40:43]
    s_waitcnt lgkmcnt(12)
    ds_read2_b32 v[52:53], v157 offset0:0 offset1:1
    v_mfma_f32_16x16x32_bf16 v[36:39], v[56:59], v[124:127], v[36:39]
    v_mfma_f32_16x16x32_bf16 v[32:35], v[56:59], v[120:123], v[32:35]
    ds_read2_b32 v[54:55], v157 offset0:2 offset1:3
    v_mfma_f32_16x16x32_bf16 v[44:47], v[60:63], v[128:131], v[44:47]
    v_mfma_f32_16x16x32_bf16 v[40:43], v[60:63], v[124:127], v[40:43]
    s_waitcnt lgkmcnt(12)
    ds_read2_b32 v[56:57], v156 offset0:128 offset1:129
    v_mfma_f32_16x16x32_bf16 v[36:39], v[60:63], v[120:123], v[36:39]
    v_mfma_f32_16x16x32_bf16 v[32:35], v[60:63], v[116:119], v[32:35]
    ds_read2_b32 v[58:59], v156 offset0:130 offset1:131
    v_mfma_f32_16x16x32_bf16 v[44:47], v[64:67], v[124:127], v[44:47]
    v_mfma_f32_16x16x32_bf16 v[40:43], v[64:67], v[120:123], v[40:43]
    s_waitcnt lgkmcnt(12)
    ds_read2_b32 v[60:61], v156 offset0:0 offset1:1
    v_mfma_f32_16x16x32_bf16 v[36:39], v[64:67], v[116:119], v[36:39]
    v_mfma_f32_16x16x32_bf16 v[32:35], v[64:67], v[112:115], v[32:35]
    ds_read2_b32 v[62:63], v156 offset0:2 offset1:3
    v_mfma_f32_16x16x32_bf16 v[44:47], v[68:71], v[120:123], v[44:47]
    v_mfma_f32_16x16x32_bf16 v[40:43], v[68:71], v[116:119], v[40:43]
    s_waitcnt lgkmcnt(12)
    ds_read2_b32 v[64:65], v155 offset0:128 offset1:129
    v_mfma_f32_16x16x32_bf16 v[36:39], v[68:71], v[112:115], v[36:39]
    ds_read2_b32 v[68:69], v155 offset0:0 offset1:1
    s_waitcnt lgkmcnt(12)
    ds_read2_b32 v[70:71], v155 offset0:2 offset1:3
    ds_read2_b32 v[66:67], v155 offset0:130 offset1:131
    s_waitcnt lgkmcnt(12)
    ds_read_b128 v[100:103], v158 offset:2560
    ds_read_b128 v[96:99], v158 offset:2048
    s_waitcnt lgkmcnt(12)
    ds_read_b128 v[92:95], v158 offset:1536
    ds_read_b128 v[88:91], v158 offset:1024
    s_waitcnt lgkmcnt(12)
    ds_read_b128 v[84:87], v158 offset:512
    ds_read_b128 v[80:83], v158 offset:0
    v_mfma_f32_16x16x32_bf16 v[44:47], v[72:75], v[116:119], v[44:47]
    v_mfma_f32_16x16x32_bf16 v[40:43], v[72:75], v[112:115], v[40:43]
    s_waitcnt lgkmcnt(12)
    ds_read2_b32 v[72:73], v154 offset0:128 offset1:129
    ds_read2_b32 v[74:75], v154 offset0:130 offset1:131
    v_mfma_f32_16x16x32_bf16 v[44:47], v[76:79], v[112:115], v[44:47]
    s_waitcnt lgkmcnt(12)
    ds_read2_b32 v[76:77], v154 offset0:0 offset1:1
    ds_read2_b32 v[78:79], v154 offset0:2 offset1:3
    v_cvt_pk_bf16_f32 v8, v32, v33
    v_cvt_pk_bf16_f32 v9, v34, v35
    v_cvt_pk_bf16_f32 v10, v36, v37
    v_cvt_pk_bf16_f32 v11, v38, v39
    s_waitcnt lgkmcnt(12)
    ds_write_b128 v161, v[8:11] offset:2048
    v_cvt_pk_bf16_f32 v12, v40, v41
    v_cvt_pk_bf16_f32 v13, v42, v43
    v_cvt_pk_bf16_f32 v14, v44, v45
    v_cvt_pk_bf16_f32 v15, v46, v47
    ds_write_b128 v161, v[12:15] offset:3072
    s_waitcnt lgkmcnt(12)
    ds_write_b32 v162, v5 offset:284
    v_add_u32 v161, 2048, v161
    v_add_u32 v162, 4, v162
    s_sub_u32 s20, s20, 1
    s_cmp_eq_u32 s20, 0
    s_cbranch_scc0 L_hloop
    s_branch L_skip4771
L_pada20:
    s_branch L_warmed_a
L_skip4771:
L_hexit:
L_cdone:
    s_waitcnt lgkmcnt(0)
    v_mov_b32 v4, 1
    s_mov_b64 exec, 1
    ds_add_u32 v3, v4 offset:196
    s_mov_b64 exec, -1
    s_setprio 0
    s_mov_b32 s100, 0
Lw_74:
    ds_read_b32 v4, v3 offset:196
    s_waitcnt lgkmcnt(0)
    v_readfirstlane_b32 s99, v4
    s_cmp_ge_u32 s99, 4
    s_cbranch_scc1 Lwd_75
    s_sleep 6
    s_add_u32 s100, s100, 1
    s_cmp_lt_u32 s100, 1048576
    s_cbranch_scc1 Lw_74
Lwd_75:
L_cjoin:
    s_setprio 2
    s_mov_b32 s100, 0
Lw_76:
    ds_read_b32 v4, v3 offset:192
    s_waitcnt lgkmcnt(0)
    v_readfirstlane_b32 s99, v4
    s_cmp_ge_u32 s99, 1
    s_cbranch_scc1 Lwd_77
    s_add_u32 s100, s100, 1
    s_cmp_lt_u32 s100, 1048576
    s_cbranch_scc1 Lw_76
Lwd_77:
    s_mov_b32 s91, s99
    s_cmp_eq_u32 s91, 1
    s_cselect_b32 s99, 0, 15728640
    s_add_u32 s16, s28, s99
    s_addc_u32 s17, s29, 0
    s_add_u32 s18, s16, 13107200
    s_addc_u32 s19, s17, 0
    s_cmp_eq_u32 s91, 1
    s_cselect_b64 s[18:19], s[24:25], s[18:19]
    v_lshl_add_u32 v138, v0, 4, s80
    v_lshl_add_u32 v139, v0, 4, s82
    v_lshl_add_u32 v166, v0, 2, s83
    s_branch L_tail
L_end:
    s_endpgm
L_codeend:
.section .rodata,"a"
.p2align 6
.amdhsa_kernel gated_mix__ssm_conv_h3__sliding_local_dilated__prompt_kernel
  .amdhsa_next_free_vgpr 168
  .amdhsa_next_free_sgpr 102
  .amdhsa_accum_offset 168
  .amdhsa_group_segment_fixed_size 0
  .amdhsa_kernarg_size 104
  .amdhsa_user_sgpr_count 2
  .amdhsa_user_sgpr_kernarg_segment_ptr 1
  .amdhsa_system_sgpr_workgroup_id_x 1
.end_amdhsa_kernel
```

```asm
; @launch grid=(256,1,1) block=(768,1,1) lds=163840
.amdgcn_target "amdgcn-amd-amdhsa--gfx950"
.text
.globl gated_mix__ssm_conv_h3__sliding_local_dilated__prompt_kernel
.p2align 8
.type gated_mix__ssm_conv_h3__sliding_local_dilated__prompt_kernel,@function
gated_mix__ssm_conv_h3__sliding_local_dilated__prompt_kernel:
L_entry:
    s_load_dwordx16 s[4:19], s[0:1], 0
    s_load_dwordx8 s[20:27], s[0:1], 64
    s_load_dwordx2 s[28:29], s[0:1], 96
    s_cmp_ge_u32 s2, 256
    s_cbranch_scc1 L_end
    v_lshrrev_b32 v4, 6, v0
    v_and_b32 v0, 63, v0
    v_readfirstlane_b32 s32, v4
    s_lshr_b32 s96, s32, 1
    s_cmp_eq_u32 s96, 2
    s_cbranch_scc1 L_hop0
L_hopped:
    s_getpc_b64 s[46:47]
L_pc:
    s_lshr_b32 s31, s2, 3
    s_mul_i32 s96, s31, 896
    s_cmp_lg_u32 s32, 2
    s_cbranch_scc1 L_nopf
    v_lshl_add_u32 v4, v0, 7, s96
    v_min_u32 v4, L_codeend-L_pc-4, v4
    s_mov_b64 exec, 0x7f
    global_load_dword v20, v4, s[46:47]
    s_mov_b64 exec, -1
L_nopf:
    v_mov_b32 v3, 160768
    v_lshl_add_u32 v5, v0, 3, v3
    v_mov_b32 v6, 0
    v_mov_b32 v7, 0
    ds_write_b64 v5, v[6:7]
    v_lshrrev_b32 v2, 4, v0
    v_and_b32 v1, 15, v0
    s_and_b32 s30, s2, 7
    s_and_b32 s36, s31, 7
    s_lshr_b32 s35, s31, 3
    s_lshl2_add_u32 s35, s30, s35
    s_cmp_ge_u32 s31, 20
    s_cselect_b32 s34, 1, 0
    s_cselect_b32 s96, 20, 0
    s_cselect_b32 s97, 5, 10
    s_sub_u32 s38, s31, s96
    s_cmp_ge_u32 s38, s97
    s_cselect_b32 s97, s97, 0
    s_cselect_b32 s96, 1, 0
    s_sub_u32 s38, s38, s97
    s_lshl1_add_u32 s37, s30, s96
    s_mul_i32 s39, s37, 163840
    s_setprio 3
    s_cmp_lt_u32 s32, 4
    s_cbranch_scc1 L_service
    s_cmp_lg_u32 s34, 0
    s_cbranch_scc1 L_awave
    s_branch L_compute
L_service:
    s_cmp_eq_u32 s34, 0
    s_cbranch_scc1 L_bserv
L_aserv:
    v_lshrrev_b32 v5, 3, v0
    v_mul_u32_u24 v5, 1280, v5
    v_and_b32 v4, 7, v0
    v_lshl_add_u32 v4, v4, 4, v5
    s_lshl_b32 s96, s38, 8
    v_add_u32 v4, s96, v4
    s_and_b32 s97, s32, 1
    s_lshl_b32 s97, s97, 6
    v_xor_b32 v13, s97, v4
    v_xor_b32 v14, 16, v13
    v_xor_b32 v15, 32, v13
    v_xor_b32 v16, 48, v13
    s_mul_i32 s96, s32, 40960
    s_add_u32 s52, s39, s96
    s_lshl_b32 s53, s32, 12
    s_lshl_b32 s97, s97, 1
    s_add_u32 s96, s39, s97
    s_sub_u32 s96, s96, 5120
    v_xor_b32 v4, 0x70, v4
    v_add_u32 v17, s96, v4
    s_waitcnt lgkmcnt(0)
    s_mov_b32 s84, s6
    s_and_b32 s85, s7, 0xffff
    s_mov_b32 s86, 2621440
    s_mov_b32 s87, 0x00020000
    s_mov_b32 s80, s8
    s_and_b32 s81, s9, 0xffff
    s_mov_b32 s82, 2621440
    s_mov_b32 s83, 0x00020000
    s_load_dword s33, s[28:29], 0
    s_cmp_ge_u32 s38, 5
    s_cbranch_scc1 L_as_nokv
    s_cmp_ge_u32 s32, 2
    s_cbranch_scc1 L_as_nohalo
    s_mul_i32 m0, s32, 16896
    s_add_u32 m0, m0, 90496
    s_mov_b64 exec, 0xffffffff
    buffer_load_dwordx4 v17, s[84:87], 0 offen lds
    s_mov_b64 exec, -1
L_as_nohalo:
    s_add_u32 m0, s53, 91008
    s_mov_b32 s59, s52
    buffer_load_dwordx4 v13, s[84:87], s59 offen lds
    s_add_u32 m0, m0, 16768
    s_nop 0
    buffer_load_dwordx4 v13, s[84:87], s59 offen offset:128 lds
    s_sub_u32 m0, m0, 15744
    s_add_u32 s59, s59, 10240
    buffer_load_dwordx4 v14, s[84:87], s59 offen lds
    s_add_u32 m0, m0, 16768
    s_nop 0
    buffer_load_dwordx4 v14, s[84:87], s59 offen offset:128 lds
    s_sub_u32 m0, m0, 15744
    s_add_u32 s59, s59, 10240
    buffer_load_dwordx4 v15, s[84:87], s59 offen lds
    s_add_u32 m0, m0, 16768
    s_nop 0
    buffer_load_dwordx4 v15, s[84:87], s59 offen offset:128 lds
    s_sub_u32 m0, m0, 15744
    s_add_u32 s59, s59, 10240
    buffer_load_dwordx4 v16, s[84:87], s59 offen lds
    s_add_u32 m0, m0, 16768
    s_nop 0
    buffer_load_dwordx4 v16, s[84:87], s59 offen offset:128 lds
    s_add_u32 m0, s53, 124288
    s_mov_b32 s59, s52
    buffer_load_dwordx4 v13, s[80:83], s59 offen lds
    s_add_u32 m0, m0, 16256
    s_nop 0
    buffer_load_dwordx4 v13, s[80:83], s59 offen offset:128 lds
    s_sub_u32 m0, m0, 15232
    s_add_u32 s59, s59, 10240
    buffer_load_dwordx4 v14, s[80:83], s59 offen lds
    s_add_u32 m0, m0, 16256
    s_nop 0
    buffer_load_dwordx4 v14, s[80:83], s59 offen offset:128 lds
    s_sub_u32 m0, m0, 15232
    s_add_u32 s59, s59, 10240
    buffer_load_dwordx4 v15, s[80:83], s59 offen lds
    s_add_u32 m0, m0, 16256
    s_nop 0
    buffer_load_dwordx4 v15, s[80:83], s59 offen offset:128 lds
    s_sub_u32 m0, m0, 15232
    s_add_u32 s59, s59, 10240
    buffer_load_dwordx4 v16, s[80:83], s59 offen lds
    s_add_u32 m0, m0, 16256
    s_nop 0
    buffer_load_dwordx4 v16, s[80:83], s59 offen offset:128 lds
    s_branch L_as_kv
L_hop0:
    s_cmp_eq_u32 s32, 4
    s_cbranch_scc1 L_hopped
    s_branch L_hop1
L_bserv:
    v_lshrrev_b32 v4, 3, v0
    v_and_b32 v5, 7, v0
    s_add_u32 s65, s30, s38
    s_mul_i32 s96, s65, 52
    s_lshr_b32 s96, s96, 8
    s_mul_i32 s96, s96, 5
    s_sub_u32 s65, s65, s96
    s_mul_i32 s65, s65, 512
    s_lshr_b32 s65, s65, 8
    s_mov_b32 s76, 0x76543210
    s_mov_b32 s77, 0x98
    s_bitcmp1_b32 s38, 0
    s_cselect_b32 s76, 0x76543210, s76
    s_cselect_b32 s77, 0x98, s77
    s_bitcmp0_b32 s37, 0
    s_cselect_b32 s76, 0x76543210, s76
    s_cselect_b32 s77, 0x98, s77
    s_mov_b64 s[78:79], s[76:77]
    s_and_b32 s67, s76, 15
    s_lshr_b64 s[76:77], s[76:77], 4
    s_add_u32 s67, s67, s65
    s_sub_u32 s99, s67, 10
    s_cselect_b32 s67, s67, s99
    s_and_b32 s96, s32, 1
    s_cmp_ge_u32 s32, 2
    s_cbranch_scc1 L_lw
    v_mul_u32_u24 v6, 1280, v4
    v_xor_b32 v7, v5, v2
    v_lshl_add_u32 v13, v7, 4, v6
    s_lshl_b32 s97, s96, 6
    v_xor_b32 v13, s97, v13
    v_xor_b32 v14, 64, v13
    s_sub_u32 s52, s39, 20480
    s_cmp_eq_u32 s37, 0
    s_cselect_b32 s52, 0, s52
    s_add_u32 s97, s39, 71680
    s_add_u32 s98, s39, 92160
    s_cmp_eq_u32 s96, 0
    s_cselect_b32 s52, s52, s97
    s_cselect_b32 s53, s39, s98
    s_mul_i32 s54, s96, 9216
    s_add_u32 s54, s54, 86016
    s_waitcnt lgkmcnt(0)
    s_mov_b32 s40, s4
    s_and_b32 s41, s5, 0xffff
    s_mov_b32 s42, 2621440
    s_mov_b32 s43, 0x00020000
    s_load_dword s33, s[28:29], 0
    s_cmp_lg_u32 s32, 0
    s_cbranch_scc1 L_nogw
    s_mov_b32 s48, s22
    s_and_b32 s49, s23, 0xffff
    s_mov_b32 s50, 1280
    s_mov_b32 s51, 0x00020000
    v_lshlrev_b32 v4, 4, v0
    s_mov_b32 m0, 162048
    s_nop 0
    buffer_load_dwordx4 v4, s[48:51], 0 offen lds
    s_mov_b64 exec, 0xffff
    buffer_load_dwordx4 v4, s[48:51], 0 offen offset:1024 lds
    s_mov_b64 exec, -1
L_nogw:
    s_mov_b32 m0, s54
    s_lshl_b32 s67, s67, 7
    s_add_u32 s59, s52, s67
    buffer_load_dwordx4 v13, s[40:43], s59 offen lds
    s_add_u32 m0, m0, 1024
    s_add_u32 s59, s59, 10240
    buffer_load_dwordx4 v14, s[40:43], s59 offen lds
    s_add_u32 m0, m0, 1024
    s_add_u32 s59, s53, s67
    buffer_load_dwordx4 v13, s[40:43], s59 offen lds
    s_add_u32 m0, m0, 1024
    s_add_u32 s59, s59, 10240
    buffer_load_dwordx4 v14, s[40:43], s59 offen lds
    s_add_u32 m0, m0, 1024
    s_add_u32 s59, s59, 10240
    buffer_load_dwordx4 v13, s[40:43], s59 offen lds
    s_add_u32 m0, m0, 1024
    s_add_u32 s59, s59, 10240
    buffer_load_dwordx4 v14, s[40:43], s59 offen lds
    s_add_u32 m0, m0, 1024
    s_add_u32 s59, s59, 10240
    buffer_load_dwordx4 v13, s[40:43], s59 offen lds
    s_add_u32 m0, m0, 1024
    s_add_u32 s59, s59, 10240
    buffer_load_dwordx4 v14, s[40:43], s59 offen lds
    s_add_u32 m0, m0, 1024
    s_add_u32 s59, s59, 10240
    buffer_load_dwordx4 v13, s[40:43], s59 offen lds
    s_and_b32 s67, s76, 15
    s_lshr_b64 s[76:77], s[76:77], 4
    s_add_u32 s67, s67, s65
    s_sub_u32 s99, s67, 10
    s_cselect_b32 s67, s67, s99
    s_branch L_ld_x_c
L_hop1:
    s_branch L_hopped
L_padb0:
    s_branch L_padb8
L_lw:
    v_and_b32 v7, 2, v4
    v_xor_b32 v7, v7, v5
    v_mul_u32_u24 v6, 3840, v4
    v_lshl_add_u32 v13, v7, 4, v6
    s_lshl_b32 s97, s38, 7
    v_add_u32 v13, s97, v13
    v_xor_b32 v14, 64, v13
    s_mul_i32 s54, s96, 12288
    s_add_u32 s54, s54, 104448
    s_mul_i32 s52, s96, 122880
    s_waitcnt lgkmcnt(0)
    s_mov_b32 s44, s18
    s_and_b32 s45, s19, 0xffff
    s_mov_b32 s46, 2457600
    s_mov_b32 s47, 0x00020000
    s_load_dword s33, s[28:29], 0
    s_mov_b32 m0, s54
    s_mul_i32 s59, s67, 245760
    s_add_u32 s59, s59, s52
    buffer_load_dwordx4 v13, s[44:47], s59 offen lds
    s_add_u32 m0, m0, 1024
    s_add_u32 s59, s59, 1280
    buffer_load_dwordx4 v13, s[44:47], s59 offen lds
    s_add_u32 m0, m0, 1024
    s_add_u32 s59, s59, 1280
    buffer_load_dwordx4 v13, s[44:47], s59 offen lds
    s_add_u32 m0, m0, 1024
    s_add_u32 s59, s59, 28160
    buffer_load_dwordx4 v14, s[44:47], s59 offen lds
    s_add_u32 m0, m0, 1024
    s_add_u32 s59, s59, 1280
    buffer_load_dwordx4 v14, s[44:47], s59 offen lds
    s_add_u32 m0, m0, 1024
    s_add_u32 s59, s59, 1280
    buffer_load_dwordx4 v14, s[44:47], s59 offen lds
    s_add_u32 m0, m0, 1024
    s_add_u32 s59, s59, 28160
    buffer_load_dwordx4 v13, s[44:47], s59 offen lds
    s_add_u32 m0, m0, 1024
    s_add_u32 s59, s59, 1280
    buffer_load_dwordx4 v13, s[44:47], s59 offen lds
    s_add_u32 m0, m0, 1024
    s_add_u32 s59, s59, 1280
    buffer_load_dwordx4 v13, s[44:47], s59 offen lds
    s_add_u32 m0, m0, 1024
    s_add_u32 s59, s59, 28160
    buffer_load_dwordx4 v14, s[44:47], s59 offen lds
    s_add_u32 m0, m0, 1024
    s_add_u32 s59, s59, 1280
    buffer_load_dwordx4 v14, s[44:47], s59 offen lds
    s_add_u32 m0, m0, 1024
    s_add_u32 s59, s59, 1280
    buffer_load_dwordx4 v14, s[44:47], s59 offen lds
    s_and_b32 s67, s76, 15
    s_lshr_b64 s[76:77], s[76:77], 4
    s_add_u32 s67, s67, s65
    s_sub_u32 s99, s67, 10
    s_cselect_b32 s67, s67, s99
    s_branch L_ld_w_c
L_ld_x_c:
    s_add_u32 s62, s54, 43008
    s_sub_u32 s54, s54, 86016
    s_mov_b32 s61, s54
    s_mov_b32 s55, 1
    s_mul_i32 s96, s36, 102400
    s_add_u32 s96, s96, 9437184
    s_add_u32 s48, s28, s96
    s_addc_u32 s49, s29, 0
    s_and_b32 s49, s49, 0xffff
    s_mov_b32 s50, 102400
    s_mov_b32 s51, 0x00020000
    v_lshlrev_b32 v19, 4, v0
    s_lshl_b32 s66, s30, 5
    s_add_u32 s66, s66, s31
    s_lshl_b32 s66, s66, 8
    s_add_u32 s66, s66, 65536
    s_add_u32 s66, s66, 128
    v_lshrrev_b32 v5, 1, v1
    v_xor_b32 v5, v5, v2
    v_lshlrev_b32 v5, 4, v5
    v_lshl_add_u32 v5, v1, 7, v5
    s_lshl_b32 s97, s32, 6
    v_xor_b32 v5, s97, v5
    s_and_b32 s96, s38, 7
    s_lshl_b32 s96, s96, 11
    s_add_u32 s96, s96, 2048
    v_add_u32 v18, s96, v5
    s_add_u32 s97, s97, 162048
    v_lshl_add_u32 v17, v2, 4, s97
    s_mov_b32 s64, 86016
    v_mov_b64 v[20:21], 0
    v_mov_b64 v[22:23], 0
    v_mov_b64 v[24:25], 0
    v_mov_b64 v[26:27], 0
    v_mov_b64 v[28:29], 0
    v_mov_b64 v[30:31], 0
    s_lshl1_add_u32 s96, s35, s32
    s_mul_i32 s96, s96, 40960
    s_mul_i32 s97, s36, 160
    s_add_u32 s96, s96, s97
    v_add_u32 v4, 0, v0
    v_mul_u32_u24 v8, 6554, v4
    v_lshrrev_b32 v8, 16, v8
    v_mul_u32_u24 v8, 1120, v8
    v_lshl_add_u32 v4, v4, 4, s96
    v_add_u32 v8, v8, v4
    v_add_u32 v4, 64, v0
    v_mul_u32_u24 v9, 6554, v4
    v_lshrrev_b32 v9, 16, v9
    v_mul_u32_u24 v9, 1120, v9
    v_lshl_add_u32 v4, v4, 4, s96
    v_add_u32 v9, v9, v4
    v_add_u32 v4, 128, v0
    v_mul_u32_u24 v10, 6554, v4
    v_lshrrev_b32 v10, 16, v10
    v_mul_u32_u24 v10, 1120, v10
    v_lshl_add_u32 v4, v4, 4, s96
    v_add_u32 v10, v10, v4
    v_add_u32 v4, 192, v0
    v_mul_u32_u24 v11, 6554, v4
    v_lshrrev_b32 v11, 16, v11
    v_mul_u32_u24 v11, 1120, v11
    v_lshl_add_u32 v4, v4, 4, s96
    v_add_u32 v11, v11, v4
    v_add_u32 v4, 256, v0
    v_mul_u32_u24 v12, 6554, v4
    v_lshrrev_b32 v12, 16, v12
    v_mul_u32_u24 v12, 1120, v12
    v_lshl_add_u32 v4, v4, 4, s96
    v_add_u32 v12, v12, v4
    s_waitcnt lgkmcnt(0)
    s_mul_i32 s33, s33, 1664525
    s_add_u32 s33, s33, 1013904223
    s_branch L_ld_x_i
L_padb1:
    s_branch L_padb9
L_ld_x:
    s_and_b32 s68, s78, 15
    s_lshr_b64 s[78:79], s[78:79], 4
    s_add_u32 s68, s68, s65
    s_sub_u32 s99, s68, 10
    s_cselect_b32 s68, s68, s99
    s_lshl_b32 s68, s68, 7
    v_add_u32 v15, s64, v18
    v_add_u32 v16, s68, v17
    ds_read_b128 v[24:27], v15
    ds_read_b128 v[28:31], v16
    s_add_u32 s64, s64, 43008
    s_cmp_eq_u32 s64, 129024
    s_cselect_b32 s64, 0, s64
L_ld_x_i:
    s_mov_b32 m0, s54
    s_lshl_b32 s67, s67, 7
    s_add_u32 s59, s52, s67
    buffer_load_dwordx4 v13, s[40:43], s59 offen lds
    s_add_u32 m0, m0, 1024
    s_add_u32 s59, s59, 10240
    buffer_load_dwordx4 v14, s[40:43], s59 offen lds
    s_add_u32 m0, m0, 1024
    s_add_u32 s59, s53, s67
    buffer_load_dwordx4 v13, s[40:43], s59 offen lds
    s_add_u32 m0, m0, 1024
    s_add_u32 s59, s59, 10240
    buffer_load_dwordx4 v14, s[40:43], s59 offen lds
    s_add_u32 m0, m0, 1024
    s_add_u32 s59, s59, 10240
    buffer_load_dwordx4 v13, s[40:43], s59 offen lds
    s_add_u32 m0, m0, 1024
    s_add_u32 s59, s59, 10240
    s_waitcnt lgkmcnt(0)
    v_mfma_f32_16x16x32_bf16 v[20:23], v[28:31], v[24:27], v[20:23]
    s_cmp_lt_u32 s55, 9
    s_cbranch_scc1 Lmp_1
    s_load_dwordx4 s[88:91], s[28:29], s66 glc
Lmp_1:
    buffer_load_dwordx4 v14, s[40:43], s59 offen lds
    s_add_u32 m0, m0, 1024
    s_add_u32 s59, s59, 10240
    buffer_load_dwordx4 v13, s[40:43], s59 offen lds
    s_add_u32 m0, m0, 1024
    s_add_u32 s59, s59, 10240
    buffer_load_dwordx4 v14, s[40:43], s59 offen lds
    s_add_u32 m0, m0, 1024
    s_add_u32 s59, s59, 10240
    buffer_load_dwordx4 v13, s[40:43], s59 offen lds
    s_and_b32 s67, s76, 15
    s_lshr_b64 s[76:77], s[76:77], 4
    s_add_u32 s67, s67, s65
    s_sub_u32 s99, s67, 10
    s_cselect_b32 s67, s67, s99
    s_add_u32 s54, s54, 43008
    s_cmp_eq_u32 s54, s62
    s_cselect_b32 s54, s61, s54
    s_add_u32 s55, s55, 1
    s_cmp_eq_u32 s55, 2
    s_cbranch_scc1 L_ld_x_e
L_ld_x_w:
    s_waitcnt vmcnt(9)
L_ld_x_b:
    s_barrier
    s_cmp_lt_u32 s55, 10
    s_cbranch_scc1 L_ld_x
    s_and_b32 s68, s78, 15
    s_lshr_b64 s[78:79], s[78:79], 4
    s_add_u32 s68, s68, s65
    s_sub_u32 s99, s68, 10
    s_cselect_b32 s68, s68, s99
    s_lshl_b32 s68, s68, 7
    v_add_u32 v15, s64, v18
    v_add_u32 v16, s68, v17
    ds_read_b128 v[24:27], v15
    ds_read_b128 v[28:31], v16
    s_add_u32 s64, s64, 43008
    s_cmp_eq_u32 s64, 129024
    s_cselect_b32 s64, 0, s64
    s_waitcnt lgkmcnt(0)
    v_mfma_f32_16x16x32_bf16 v[20:23], v[28:31], v[24:27], v[20:23]
    s_branch L_ld_end
L_ld_w_e:
    s_barrier
    s_branch L_ld_w_w
L_ld_x_e:
    s_barrier
    s_cmp_lg_u32 s32, 1
    s_cbranch_scc1 L_ld_x_w
    s_lshl_b32 s96, s30, 5
    s_add_u32 s96, s96, s31
    s_lshl_b32 s96, s96, 8
    s_add_u32 s96, s96, 65536
    v_lshl_add_u32 v4, v0, 3, s96
    v_mov_b32 v6, 0
    s_and_b32 s97, s33, 0xffffff00
    v_mov_b32 v7, s97
    s_getreg_b32 s97, hwreg(HW_REG_XCC_ID, 0, 4)
    v_writelane_b32 v6, s33, 3
    v_writelane_b32 v7, s97, 3
    s_mov_b64 exec, 0xffff
    global_store_dwordx2 v4, v[6:7], s[28:29] sc1
    s_mov_b64 exec, -1
    s_lshl_b32 s96, s2, 7
    s_add_u32 s96, s96, 0x1F8000
    v_lshl_add_u32 v4, v0, 21, s96
    s_add_u32 s96, s96, 10518528
    v_writelane_b32 v4, s96, 6
    v_mov_b32 v5, 0
    s_mov_b64 exec, 0xde
    global_atomic_or v4, v5, s[28:29] sc1
    s_mul_i32 s96, s35, 81920
    s_mul_i32 s97, s36, 160
    s_add_u32 s96, s96, s97
    s_mov_b64 exec, 1
    v_mov_b32 v4, s96
    global_atomic_or v4, v5, s[24:25] sc1
    s_mov_b64 exec, -1
    s_waitcnt vmcnt(12)
    s_branch L_ld_x_b
L_padb2:
    s_branch L_padb10
L_ld_w_c:
    s_add_u32 s62, s54, 43008
    s_sub_u32 s54, s54, 86016
    s_mov_b32 s61, s54
    s_mov_b32 s55, 1
    s_mul_i32 s96, s36, 102400
    s_add_u32 s96, s96, 9437184
    s_add_u32 s48, s28, s96
    s_addc_u32 s49, s29, 0
    s_and_b32 s49, s49, 0xffff
    s_mov_b32 s50, 102400
    s_mov_b32 s51, 0x00020000
    v_lshlrev_b32 v19, 4, v0
    s_lshl_b32 s66, s30, 5
    s_add_u32 s66, s66, s31
    s_lshl_b32 s66, s66, 8
    s_add_u32 s66, s66, 65536
    s_add_u32 s66, s66, 128
    v_mov_b32 v8, 0
    v_mov_b32 v9, 0
    v_mov_b32 v10, 0
    v_mov_b32 v11, 0
    v_mov_b32 v12, 0
    s_mov_b32 s40, s4
    s_and_b32 s41, s5, 0xffff
    s_mov_b32 s42, 2621440
    s_mov_b32 s43, 0x00020000
    s_waitcnt lgkmcnt(0)
    s_mul_i32 s33, s33, 1664525
    s_add_u32 s33, s33, 1013904223
L_ld_w:
    s_cmp_lt_u32 s55, 9
    s_cbranch_scc1 Lmp_2
    s_load_dwordx4 s[88:91], s[28:29], s66 glc
Lmp_2:
    s_mov_b32 m0, s54
    s_mul_i32 s59, s67, 245760
    s_add_u32 s59, s59, s52
    buffer_load_dwordx4 v13, s[44:47], s59 offen lds
    s_add_u32 m0, m0, 1024
    s_add_u32 s59, s59, 1280
    buffer_load_dwordx4 v13, s[44:47], s59 offen lds
    s_add_u32 m0, m0, 1024
    s_add_u32 s59, s59, 1280
    buffer_load_dwordx4 v13, s[44:47], s59 offen lds
    s_add_u32 m0, m0, 1024
    s_add_u32 s59, s59, 28160
    buffer_load_dwordx4 v14, s[44:47], s59 offen lds
    s_add_u32 m0, m0, 1024
    s_add_u32 s59, s59, 1280
    buffer_load_dwordx4 v14, s[44:47], s59 offen lds
    s_add_u32 m0, m0, 1024
    s_add_u32 s59, s59, 1280
    buffer_load_dwordx4 v14, s[44:47], s59 offen lds
    s_add_u32 m0, m0, 1024
    s_add_u32 s59, s59, 28160
    buffer_load_dwordx4 v13, s[44:47], s59 offen lds
    s_add_u32 m0, m0, 1024
    s_add_u32 s59, s59, 1280
    buffer_load_dwordx4 v13, s[44:47], s59 offen lds
    s_add_u32 m0, m0, 1024
    s_add_u32 s59, s59, 1280
    buffer_load_dwordx4 v13, s[44:47], s59 offen lds
    s_add_u32 m0, m0, 1024
    s_add_u32 s59, s59, 28160
    buffer_load_dwordx4 v14, s[44:47], s59 offen lds
    s_add_u32 m0, m0, 1024
    s_add_u32 s59, s59, 1280
    buffer_load_dwordx4 v14, s[44:47], s59 offen lds
    s_add_u32 m0, m0, 1024
    s_add_u32 s59, s59, 1280
    buffer_load_dwordx4 v14, s[44:47], s59 offen lds
    s_and_b32 s67, s76, 15
    s_lshr_b64 s[76:77], s[76:77], 4
    s_add_u32 s67, s67, s65
    s_sub_u32 s99, s67, 10
    s_cselect_b32 s67, s67, s99
    s_add_u32 s54, s54, 43008
    s_cmp_eq_u32 s54, s62
    s_cselect_b32 s54, s61, s54
    s_add_u32 s55, s55, 1
    s_cmp_eq_u32 s55, 2
    s_cbranch_scc1 L_ld_w_e
L_ld_w_w:
    s_waitcnt vmcnt(12)
L_ld_w_b:
    s_barrier
    s_cmp_lt_u32 s55, 10
    s_cbranch_scc1 L_ld_w
L_ld_end:
    s_waitcnt lgkmcnt(0)
    s_cmp_eq_u32 s90, s33
    s_cbranch_scc1 L_wo_mk
    s_lshl_b32 s98, s30, 5
    s_add_u32 s98, s98, s31
    s_lshl_b32 s98, s98, 8
    s_add_u32 s98, s98, 65536
    s_add_u32 s98, s98, 128
    s_mov_b32 s100, 0
Lc_3:
    s_load_dwordx4 s[88:91], s[28:29], s98 glc
    s_waitcnt lgkmcnt(0)
    s_cmp_eq_u32 s90, s33
    s_cbranch_scc1 Lcd_4
    s_sleep 2
    s_add_u32 s100, s100, 1
    s_cmp_lt_u32 s100, 1048576
    s_cbranch_scc1 Lc_3
    s_mov_b32 s91, 2
Lcd_4:
L_wo_mk:
    s_cmp_eq_u32 s91, 1
    s_cselect_b32 s99, 0, 15728640
    s_add_u32 s16, s28, s99
    s_addc_u32 s17, s29, 0
    s_cmp_lg_u32 s32, 2
    s_cbranch_scc1 L_wo_nc
    s_mov_b32 s44, s28
    s_and_b32 s45, s29, 0xffff
    s_mov_b32 s46, 1048576
    s_mov_b32 s47, 0x00020000
    v_lshlrev_b32 v4, 2, v0
    s_mov_b32 m0, 161152
    s_mov_b64 exec, 3
    s_add_u32 s66, s66, 8
    buffer_load_dword v4, s[44:47], s66 offen sc1 lds
    s_mov_b64 exec, -1
L_wo_nc:
    s_cmp_ge_u32 s32, 2
    s_cbranch_scc1 L_wo_a2
    s_mul_i32 m0, s32, 5120
    s_nop 0
    buffer_load_dwordx4 v8, s[40:43], 0 offen lds
    s_add_u32 m0, m0, 1024
    s_nop 0
    buffer_load_dwordx4 v9, s[40:43], 0 offen lds
    s_add_u32 m0, m0, 1024
    s_nop 0
    buffer_load_dwordx4 v10, s[40:43], 0 offen lds
    s_add_u32 m0, m0, 1024
    s_nop 0
    buffer_load_dwordx4 v11, s[40:43], 0 offen lds
    s_add_u32 m0, m0, 1024
    s_nop 0
    buffer_load_dwordx4 v12, s[40:43], 0 offen lds
    s_mov_b32 s59, 24576
    s_cmp_eq_u32 s32, 1
    s_cselect_b32 s59, 28672, s59
    s_add_u32 m0, s59, 10240
    s_nop 0
    buffer_load_dwordx4 v19, s[48:51], s59 offen offset:0 sc1 lds
    buffer_load_dwordx4 v19, s[48:51], s59 offen offset:1024 sc1 lds
    buffer_load_dwordx4 v19, s[48:51], s59 offen offset:2048 sc1 lds
    buffer_load_dwordx4 v19, s[48:51], s59 offen offset:3072 sc1 lds
    s_waitcnt vmcnt(9)
    s_branch L_wo_a3
L_padb3:
    s_branch L_padb11
L_wo_a2:
    s_mov_b32 s59, 0
    s_cmp_eq_u32 s32, 1
    s_cselect_b32 s59, 0, s59
    s_cmp_eq_u32 s32, 2
    s_cselect_b32 s59, 0, s59
    s_cmp_eq_u32 s32, 3
    s_cselect_b32 s59, 12288, s59
    s_add_u32 m0, s59, 10240
    s_nop 0
    buffer_load_dwordx4 v19, s[48:51], s59 offen offset:0 sc1 lds
    buffer_load_dwordx4 v19, s[48:51], s59 offen offset:1024 sc1 lds
    buffer_load_dwordx4 v19, s[48:51], s59 offen offset:2048 sc1 lds
    buffer_load_dwordx4 v19, s[48:51], s59 offen offset:3072 sc1 lds
    s_add_u32 m0, m0, 4096
    s_add_u32 s59, s59, 4096
    buffer_load_dwordx4 v19, s[48:51], s59 offen offset:0 sc1 lds
    buffer_load_dwordx4 v19, s[48:51], s59 offen offset:1024 sc1 lds
    buffer_load_dwordx4 v19, s[48:51], s59 offen offset:2048 sc1 lds
    buffer_load_dwordx4 v19, s[48:51], s59 offen offset:3072 sc1 lds
    s_add_u32 m0, m0, 4096
    s_add_u32 s59, s59, 4096
    buffer_load_dwordx4 v19, s[48:51], s59 offen offset:0 sc1 lds
    buffer_load_dwordx4 v19, s[48:51], s59 offen offset:1024 sc1 lds
    buffer_load_dwordx4 v19, s[48:51], s59 offen offset:2048 sc1 lds
    buffer_load_dwordx4 v19, s[48:51], s59 offen offset:3072 sc1 lds
    s_waitcnt vmcnt(12)
L_wo_a3:
    s_barrier
    s_cmp_ge_u32 s32, 2
    s_cbranch_scc1 L_wo_n9
    s_and_b32 s68, s78, 15
    s_lshr_b64 s[78:79], s[78:79], 4
    s_add_u32 s68, s68, s65
    s_sub_u32 s99, s68, 10
    s_cselect_b32 s68, s68, s99
    s_lshl_b32 s68, s68, 7
    v_add_u32 v15, s64, v18
    v_add_u32 v16, s68, v17
    ds_read_b128 v[24:27], v15
    ds_read_b128 v[28:31], v16
    s_add_u32 s64, s64, 43008
    s_cmp_eq_u32 s64, 129024
    s_cselect_b32 s64, 0, s64
L_wo_n9:
    s_mov_b32 s59, 32768
    s_cmp_eq_u32 s32, 1
    s_cselect_b32 s59, 36864, s59
    s_cmp_eq_u32 s32, 2
    s_cselect_b32 s59, 41984, s59
    s_cmp_eq_u32 s32, 3
    s_cselect_b32 s59, 46080, s59
    s_add_u32 s96, s59, 10240
    v_add_u32 v32, s96, v19
    buffer_load_dwordx4 v[40:43], v19, s[48:51], s59 offen offset:0 sc1
    buffer_load_dwordx4 v[44:47], v19, s[48:51], s59 offen offset:1024 sc1
    buffer_load_dwordx4 v[48:51], v19, s[48:51], s59 offen offset:2048 sc1
    buffer_load_dwordx4 v[52:55], v19, s[48:51], s59 offen offset:3072 sc1
    s_add_u32 s59, s59, 4096
    buffer_load_dwordx4 v[56:59], v19, s[48:51], s59 offen offset:0 sc1
    s_mov_b32 s59, 51200
    s_cmp_eq_u32 s32, 1
    s_cselect_b32 s59, 63488, s59
    s_cmp_eq_u32 s32, 2
    s_cselect_b32 s59, 76800, s59
    s_cmp_eq_u32 s32, 3
    s_cselect_b32 s59, 89088, s59
    s_add_u32 s96, s59, 10240
    v_add_u32 v33, s96, v19
    buffer_load_dwordx4 v[60:63], v19, s[48:51], s59 offen offset:0 sc1
    buffer_load_dwordx4 v[64:67], v19, s[48:51], s59 offen offset:1024 sc1
    buffer_load_dwordx4 v[68:71], v19, s[48:51], s59 offen offset:2048 sc1
    buffer_load_dwordx4 v[72:75], v19, s[48:51], s59 offen offset:3072 sc1
    s_add_u32 s59, s59, 4096
    buffer_load_dwordx4 v[76:79], v19, s[48:51], s59 offen offset:0 sc1
    buffer_load_dwordx4 v[80:83], v19, s[48:51], s59 offen offset:1024 sc1
    buffer_load_dwordx4 v[84:87], v19, s[48:51], s59 offen offset:2048 sc1
    buffer_load_dwordx4 v[88:91], v19, s[48:51], s59 offen offset:3072 sc1
    s_add_u32 s59, s59, 4096
    buffer_load_dwordx4 v[92:95], v19, s[48:51], s59 offen offset:0 sc1
    buffer_load_dwordx4 v[96:99], v19, s[48:51], s59 offen offset:1024 sc1
    buffer_load_dwordx4 v[100:103], v19, s[48:51], s59 offen offset:2048 sc1
    buffer_load_dwordx4 v[104:107], v19, s[48:51], s59 offen offset:3072 sc1
    s_add_u32 s59, s59, 4096
    buffer_load_dwordx4 v[108:111], v19, s[48:51], s59 offen offset:0 sc1
    s_waitcnt vmcnt(18)
    s_cmp_lt_u32 s32, 2
    s_cbranch_scc1 L_wo_g
    v_mov_b32 v4, 16
    s_mov_b64 exec, 1
    ds_add_u32 v3, v4 offset:268
    s_mov_b64 exec, -1
    s_branch L_wo_ng
L_wo_g:
    s_waitcnt lgkmcnt(0)
    v_mfma_f32_16x16x32_bf16 v[20:23], v[28:31], v[24:27], v[20:23]
    v_lshlrev_b32 v5, 2, v0
    v_add_u32 v5, 161792, v5
    s_cmp_eq_u32 s32, 0
    s_cbranch_scc1 L_wo_g0
    s_nop 3
    ds_write_b32 v5, v20
    v_mov_b32 v4, 1
    ds_write_b32 v3, v4 offset:172
    v_mov_b32 v4, 16
    s_mov_b64 exec, 1
    ds_add_u32 v3, v4 offset:268
    s_mov_b64 exec, -1
    s_branch L_wo_ng
L_wo_g0:
    v_mov_b32 v4, 16
    s_mov_b64 exec, 1
    ds_add_u32 v3, v4 offset:268
    s_mov_b64 exec, -1
    s_mov_b32 s100, 0
Lw_5:
    ds_read_b32 v4, v3 offset:172
    s_waitcnt lgkmcnt(0)
    v_readfirstlane_b32 s99, v4
    s_cmp_ge_u32 s99, 1
    s_cbranch_scc1 Lwd_6
    s_add_u32 s100, s100, 1
    s_cmp_lt_u32 s100, 1048576
    s_cbranch_scc1 Lw_5
Lwd_6:
    ds_read_b32 v21, v5
    s_waitcnt lgkmcnt(0)
    v_add_f32 v20, v20, v21
    v_cvt_pk_bf16_f32 v20, v20, v20
    v_and_b32 v20, 0xffff0000, v20
    v_mul_f32 v20, 0xbfb8aa3b, v20
    v_exp_f32 v20, v20
    s_nop 0
    v_add_f32 v20, 1.0, v20
    v_rcp_f32 v20, v20
    s_nop 0
    v_cvt_pk_bf16_f32 v20, v20, v20
    v_and_b32 v21, 0xffff0000, v20
    v_mov_b32 v20, s33
    s_and_b32 s96, s37, 1
    s_lshl3_add_u32 s96, s96, s38
    s_lshl_b32 s96, s96, 7
    s_mul_i32 s97, s30, 262144
    s_add_u32 s96, s96, s97
    s_add_u32 s96, s96, 7537664
    v_lshl_add_u32 v5, v1, 3, s96
    s_cmp_ge_u32 s38, 8
    s_cbranch_scc1 L_wo_ng
    s_mov_b64 exec, 0xffff
    s_cmp_lg_u32 s91, 1
    s_cbranch_scc1 Ldg_7
    global_store_dwordx2 v5, v[20:21], s[16:17]
    s_branch Ldd_8
L_pada0:
    s_branch L_pada8
L_padb4:
    s_branch L_padb12
Ldg_7:
    global_store_dwordx2 v5, v[20:21], s[16:17] sc1
Ldd_8:
    s_mov_b64 exec, -1
L_wo_ng:
    s_waitcnt vmcnt(0)
    s_cmp_eq_u32 s32, 3
    s_cbranch_scc1 L_help
L_wo_fl:
    s_lshl_b32 s96, s30, 5
    s_add_u32 s96, s96, s31
    s_lshl_b32 s96, s96, 8
    s_add_u32 s96, s96, 65536
    s_lshl3_add_u32 s96, s32, s96
    s_add_u32 s40, s28, s96
    s_addc_u32 s41, s29, 0
    s_mul_i32 s96, s36, 327680
    s_mul_i32 s97, s32, 163840
    s_add_u32 s96, s96, s97
    s_lshl_b32 s97, s35, 7
    s_add_u32 s96, s96, s97
    s_add_u32 s96, s96, 4194304
    v_lshrrev_b32 v126, 3, v0
    v_and_b32 v127, 7, v0
    v_and_b32 v125, 6, v126
    v_xor_b32 v125, v125, v127
    v_lshlrev_b32 v125, 4, v125
    v_lshl_add_u32 v125, v126, 7, v125
    s_mul_i32 s97, s32, 5120
    s_add_u32 s97, s97, 112640
    v_add_u32 v125, s97, v125
    v_lshlrev_b32 v126, 12, v126
    v_lshl_add_u32 v126, v127, 4, v126
    v_add_u32 v120, s96, v126
    v_add_u32 v121, 32768, v120
    v_add_u32 v122, 65536, v120
    v_add_u32 v123, 98304, v120
    v_add_u32 v124, 131072, v120
    s_and_b32 s44, s33, 0xffffff00
    s_add_u32 s44, s44, 0x600
    s_mov_b32 s100, 0
Lw_9:
    ds_read_b32 v4, v3 offset:196
    s_waitcnt lgkmcnt(0)
    v_readfirstlane_b32 s99, v4
    s_cmp_ge_u32 s99, 0
    s_cbranch_scc1 Lwd_10
    s_sleep 2
    s_add_u32 s100, s100, 1
    s_cmp_lt_u32 s100, 1048576
    s_cbranch_scc1 Lw_9
Lwd_10:
    ds_write_b128 v32, v[40:43] offset:0
    ds_write_b128 v32, v[44:47] offset:1024
    ds_write_b128 v32, v[48:51] offset:2048
    ds_write_b128 v32, v[52:55] offset:3072
    s_waitcnt lgkmcnt(4)
    ds_write_b128 v32, v[56:59] offset:4096
    v_mov_b32 v4, 1
    s_mov_b64 exec, 1
    ds_add_u32 v3, v4 offset:200
    s_mov_b64 exec, -1
    s_mov_b32 s100, 0
Lw_11:
    ds_read_b32 v4, v3 offset:196
    s_waitcnt lgkmcnt(0)
    v_readfirstlane_b32 s99, v4
    s_cmp_ge_u32 s99, 8
    s_cbranch_scc1 Lwd_12
    s_sleep 2
    s_add_u32 s100, s100, 1
    s_cmp_lt_u32 s100, 1048576
    s_cbranch_scc1 Lw_11
Lwd_12:
    s_mov_b32 s100, 0
Lw_13:
    ds_read_b32 v4, v3 offset:268
    s_waitcnt lgkmcnt(0)
    v_readfirstlane_b32 s99, v4
    s_cmp_ge_u32 s99, 72
    s_cbranch_scc1 Lwd_14
    s_sleep 1
    s_add_u32 s100, s100, 1
    s_cmp_lt_u32 s100, 1048576
    s_cbranch_scc1 Lw_13
Lwd_14:
    ds_write_b128 v33, v[60:63] offset:0
    ds_write_b128 v33, v[64:67] offset:1024
    ds_write_b128 v33, v[68:71] offset:2048
    ds_write_b128 v33, v[72:75] offset:3072
    s_waitcnt lgkmcnt(4)
    ds_write_b128 v33, v[76:79] offset:4096
    ds_write_b128 v33, v[80:83] offset:5120
    ds_write_b128 v33, v[84:87] offset:6144
    ds_write_b128 v33, v[88:91] offset:7168
    s_waitcnt lgkmcnt(4)
    ds_write_b128 v33, v[92:95] offset:8192
    ds_write_b128 v33, v[96:99] offset:9216
    ds_write_b128 v33, v[100:103] offset:10240
    ds_write_b128 v33, v[104:107] offset:11264
    s_waitcnt lgkmcnt(4)
    ds_write_b128 v33, v[108:111] offset:12288
    v_mov_b32 v4, 1
    s_mov_b64 exec, 1
    ds_add_u32 v3, v4 offset:204
    s_mov_b64 exec, -1
    s_cmp_lt_u32 s32, 2
    s_cbranch_scc1 L_aux
    s_endpgm
L_help:
    s_and_b32 s96, s35, 3
    s_lshl_b32 s96, s96, 9
    s_mul_i32 s97, s30, 262144
    s_add_u32 s96, s96, s97
    s_add_u32 s96, s96, 7537664
    v_lshl_add_u32 v14, v0, 3, s96
    v_lshl_add_u32 v13, v0, 2, v3
    s_mov_b32 s100, 0
L_gchk:
    global_load_dwordx2 v[18:19], v14, s[16:17] sc1
    s_waitcnt vmcnt(0)
    v_cmp_ne_u32 vcc, s33, v18
    s_cbranch_vccz L_gok
    s_sleep 4
    s_add_u32 s100, s100, 1
    s_cmp_lt_u32 s100, 1048576
    s_cbranch_scc1 L_gchk
L_gok:
    v_sub_f32 v18, 1.0, v19
    ds_write_b32 v13, v19 offset:768
    ds_write_b32 v13, v18 offset:512
    v_mov_b32 v4, 1
    s_mov_b64 exec, 1
    ds_add_u32 v3, v4 offset:208
    s_mov_b64 exec, -1
    s_cmp_eq_u32 s34, 0
    s_cbranch_scc1 L_wo_fl
    s_mul_i32 s96, s30, 262144
    s_and_b32 s97, s35, 3
    s_lshl_b32 s97, s97, 8
    s_add_u32 s96, s96, s97
    s_add_u32 s96, s96, 7536640
    v_lshl_add_u32 v12, v0, 2, s96
    s_mov_b32 exec_hi, 1048575
    s_mov_b32 exec_lo, 0xfffff
    s_mov_b32 s100, 0
L_rl1:
    global_load_dword v5, v12, s[16:17] sc1
    s_waitcnt vmcnt(0)
    v_cmp_ne_u32 vcc, s33, v5
    s_cbranch_vccz L_rd1
    s_sleep 2
    s_add_u32 s100, s100, 1
    s_cmp_lt_u32 s100, 1048576
    s_cbranch_scc1 L_rl1
L_rd1:
    s_mov_b64 exec, -1
    v_mov_b32 v4, 1
    ds_write_b32 v3, v4 offset:276
    s_cmp_lg_u32 s2, 240
    s_cbranch_scc1 L_th_exit
    v_lshlrev_b32 v20, 8, v0
    v_add_u32 v20, 65536, v20
    v_mov_b32 v24, 0
    v_mov_b32 v25, 0
    s_mov_b32 s52, 0
L_epl:
    s_mov_b64 exec, -1
    s_mov_b32 s100, 0
L_hpe:
    global_atomic_or_x2 v[26:27], v20, v[24:25], s[28:29] offset:24 sc0 sc1
    s_waitcnt vmcnt(0)
    v_cmp_ne_u32 vcc, s33, v26
    s_cbranch_vccz L_hde
    s_mov_b64 exec, vcc
    s_sleep 8
    s_add_u32 s100, s100, 1
    s_cmp_lt_u32 s100, 1048576
    s_cbranch_scc1 L_hpe
L_hde:
    s_mov_b64 exec, -1
    v_add_u32 v20, 0x4000, v20
    s_add_u32 s52, s52, 1
    s_cmp_lt_u32 s52, 4
    s_cbranch_scc1 L_epl
    v_mov_b32 v4, 0
    v_mov_b32 v5, s33
    s_mov_b64 exec, 1
    global_store_dword v4, v5, s[28:29] sc1
    s_mov_b64 exec, -1
L_th_exit:
    s_endpgm
L_pada1:
    s_branch L_pada9
L_as_nokv:
    s_sleep 24
L_as_kv:
    s_sub_u32 s96, s31, 20
    s_mul_i32 s97, s96, 43
    s_lshr_b32 s97, s97, 7
    s_mul_i32 s98, s96, 7
    s_sub_u32 s98, s98, s97
    s_lshr_b32 s96, 0x924, s96
    s_and_b32 s96, s96, 1
    s_sub_u32 s64, 7, s96
    s_mul_i32 s97, s30, 80
    s_add_u32 s98, s98, s97
    s_add_u32 s56, s98, s32
    s_lshr_b32 s96, s56, 1
    s_lshl_b32 s96, s96, 2
    s_add_u32 s97, s96, 8
    s_min_u32 s97, s97, 1276
    s_load_dword s57, s[14:15], s96
    s_load_dword s58, s[14:15], s97
    s_lshl_b32 s98, s98, 12
    s_add_u32 s80, s12, s98
    s_addc_u32 s81, s13, 0
    s_and_b32 s81, s81, 0xffff
    s_lshl_b32 s82, s64, 12
    s_lshl_b32 s52, s32, 12
    s_add_u32 s53, s52, 16384
    v_lshlrev_b32 v18, 4, v0
    s_setprio 0
    s_waitcnt vmcnt(8)
    buffer_load_dwordx4 v[24:27], v18, s[80:83], s52 offen offset:0
    buffer_load_dwordx4 v[28:31], v18, s[80:83], s52 offen offset:1024
    buffer_load_dwordx4 v[32:35], v18, s[80:83], s52 offen offset:2048
    buffer_load_dwordx4 v[36:39], v18, s[80:83], s52 offen offset:3072
    buffer_load_dwordx4 v[40:43], v18, s[80:83], s53 offen offset:0
    buffer_load_dwordx4 v[44:47], v18, s[80:83], s53 offen offset:1024
    buffer_load_dwordx4 v[48:51], v18, s[80:83], s53 offen offset:2048
    buffer_load_dwordx4 v[52:55], v18, s[80:83], s53 offen offset:3072
    s_setprio 3
    s_waitcnt vmcnt(8) lgkmcnt(0)
    s_barrier
    s_mul_i32 s33, s33, 1664525
    s_add_u32 s33, s33, 1013904223
    s_mul_i32 s54, s32, 8320
    s_add_u32 s96, s54, 1008
    v_sub_u32 v19, s96, v18
    v_lshl_add_u32 v20, v1, 2, s54
    s_lshl_b32 s96, s32, 2
    v_add_u32 v21, s96, v3
    v_mov_b32 v22, 0
    s_mov_b32 s100, 0
Lw_15:
    ds_read_b32 v4, v3 offset:256
    s_waitcnt lgkmcnt(0)
    v_readfirstlane_b32 s99, v4
    s_cmp_ge_u32 s99, 8
    s_cbranch_scc1 Lwd_16
    s_sleep 1
    s_add_u32 s100, s100, 1
    s_cmp_lt_u32 s100, 1048576
    s_cbranch_scc1 Lw_15
Lwd_16:
    s_cmp_lg_u32 s32, 3
    s_cbranch_scc1 L_nohello
    s_waitcnt vmcnt(0)
    s_lshl_b32 s96, s30, 5
    s_add_u32 s96, s96, s31
    s_lshl_b32 s96, s96, 8
    s_add_u32 s96, s96, 65536
    v_lshl_add_u32 v4, v0, 3, s96
    v_mov_b32 v6, 0
    s_and_b32 s97, s33, 0xffffff00
    v_mov_b32 v7, s97
    s_getreg_b32 s97, hwreg(HW_REG_XCC_ID, 0, 4)
    v_writelane_b32 v6, s33, 3
    v_writelane_b32 v7, s97, 3
    s_mov_b64 exec, 0xffff
    global_store_dwordx2 v4, v[6:7], s[28:29] sc1
    s_mov_b64 exec, -1
L_nohello:
    s_mov_b32 s98, 0xffff
    s_lshl_b32 s96, s56, 4
    s_lshr_b32 s96, s57, s96
    s_lshl_b32 s96, s96, 16
    s_waitcnt vmcnt(4)
    s_mov_b64 exec, 1
    v_lshlrev_b32 v4, 16, v24
    v_add_f32 v4, s96, v4
    v_cvt_pk_bf16_f32 v4, v4, v4
    v_bfi_b32 v24, s98, v4, v24
    s_mov_b64 exec, -1
    v_readlane_b32 s60, v27, 63
    v_readlane_b32 s61, v31, 63
    v_readlane_b32 s62, v35, 63
    v_mov_b32_dpp v56, v27 wave_shr:1 row_mask:0xf bank_mask:0xf
    v_mov_b32_dpp v57, v31 wave_shr:1 row_mask:0xf bank_mask:0xf
    v_mov_b32_dpp v58, v35 wave_shr:1 row_mask:0xf bank_mask:0xf
    v_mov_b32_dpp v59, v39 wave_shr:1 row_mask:0xf bank_mask:0xf
    v_writelane_b32 v56, 0, 0
    v_writelane_b32 v57, s60, 0
    v_writelane_b32 v58, s61, 0
    v_writelane_b32 v59, s62, 0
    v_alignbit_b32 v60, v27, v27, 16
    v_bfi_b32 v76, s98, v27, v26
    v_alignbit_b32 v61, v26, v26, 16
    v_bfi_b32 v77, s98, v26, v25
    v_alignbit_b32 v62, v25, v25, 16
    v_bfi_b32 v78, s98, v25, v24
    v_alignbit_b32 v63, v24, v24, 16
    v_bfi_b32 v79, s98, v24, v56
    ds_write_b128 v19, v[60:63] offset:3072
    ds_write_b128 v19, v[76:79] offset:7232
    v_alignbit_b32 v64, v31, v31, 16
    v_bfi_b32 v80, s98, v31, v30
    v_alignbit_b32 v65, v30, v30, 16
    v_bfi_b32 v81, s98, v30, v29
    v_alignbit_b32 v66, v29, v29, 16
    v_bfi_b32 v82, s98, v29, v28
    v_alignbit_b32 v67, v28, v28, 16
    v_bfi_b32 v83, s98, v28, v57
    ds_write_b128 v19, v[64:67] offset:2048
    ds_write_b128 v19, v[80:83] offset:6208
    v_alignbit_b32 v68, v35, v35, 16
    v_bfi_b32 v84, s98, v35, v34
    v_alignbit_b32 v69, v34, v34, 16
    v_bfi_b32 v85, s98, v34, v33
    v_alignbit_b32 v70, v33, v33, 16
    v_bfi_b32 v86, s98, v33, v32
    v_alignbit_b32 v71, v32, v32, 16
    v_bfi_b32 v87, s98, v32, v58
    ds_write_b128 v19, v[68:71] offset:1024
    ds_write_b128 v19, v[84:87] offset:5184
    v_alignbit_b32 v72, v39, v39, 16
    v_bfi_b32 v88, s98, v39, v38
    v_alignbit_b32 v73, v38, v38, 16
    v_bfi_b32 v89, s98, v38, v37
    v_alignbit_b32 v74, v37, v37, 16
    v_bfi_b32 v90, s98, v37, v36
    v_alignbit_b32 v75, v36, v36, 16
    v_bfi_b32 v91, s98, v36, v59
    ds_write_b128 v19, v[72:75] offset:0
    ds_write_b128 v19, v[88:91] offset:4160
    ds_write_b32 v20, v22 offset:4096
    ds_write_b32 v20, v22 offset:8256
    v_mov_b32 v4, 1
    ds_write_b32 v21, v4 offset:312
    s_waitcnt lgkmcnt(0)
    s_add_u32 s96, s32, 4
    s_cmp_ge_u32 s96, s64
    s_cbranch_scc1 L_hb1
    s_lshl_b32 s96, s56, 4
    s_lshr_b32 s96, s58, s96
    s_lshl_b32 s96, s96, 16
    s_waitcnt vmcnt(0)
    s_mov_b64 exec, 1
    v_lshlrev_b32 v4, 16, v40
    v_add_f32 v4, s96, v4
    v_cvt_pk_bf16_f32 v4, v4, v4
    s_branch L_skip1163
L_pada2:
    s_branch L_pada10
L_skip1163:
    v_bfi_b32 v40, s98, v4, v40
    s_mov_b64 exec, -1
    v_readlane_b32 s60, v43, 63
    v_readlane_b32 s61, v47, 63
    v_readlane_b32 s62, v51, 63
    v_mov_b32_dpp v56, v43 wave_shr:1 row_mask:0xf bank_mask:0xf
    v_mov_b32_dpp v57, v47 wave_shr:1 row_mask:0xf bank_mask:0xf
    v_mov_b32_dpp v58, v51 wave_shr:1 row_mask:0xf bank_mask:0xf
    v_mov_b32_dpp v59, v55 wave_shr:1 row_mask:0xf bank_mask:0xf
    v_writelane_b32 v56, 0, 0
    v_writelane_b32 v57, s60, 0
    v_writelane_b32 v58, s61, 0
    v_writelane_b32 v59, s62, 0
    v_alignbit_b32 v60, v43, v43, 16
    v_bfi_b32 v76, s98, v43, v42
    v_alignbit_b32 v61, v42, v42, 16
    v_bfi_b32 v77, s98, v42, v41
    v_alignbit_b32 v62, v41, v41, 16
    v_bfi_b32 v78, s98, v41, v40
    v_alignbit_b32 v63, v40, v40, 16
    v_bfi_b32 v79, s98, v40, v56
    ds_write_b128 v19, v[60:63] offset:36352
    ds_write_b128 v19, v[76:79] offset:40512
    v_alignbit_b32 v64, v47, v47, 16
    v_bfi_b32 v80, s98, v47, v46
    v_alignbit_b32 v65, v46, v46, 16
    v_bfi_b32 v81, s98, v46, v45
    v_alignbit_b32 v66, v45, v45, 16
    v_bfi_b32 v82, s98, v45, v44
    v_alignbit_b32 v67, v44, v44, 16
    v_bfi_b32 v83, s98, v44, v57
    ds_write_b128 v19, v[64:67] offset:35328
    ds_write_b128 v19, v[80:83] offset:39488
    v_alignbit_b32 v68, v51, v51, 16
    v_bfi_b32 v84, s98, v51, v50
    v_alignbit_b32 v69, v50, v50, 16
    v_bfi_b32 v85, s98, v50, v49
    v_alignbit_b32 v70, v49, v49, 16
    v_bfi_b32 v86, s98, v49, v48
    v_alignbit_b32 v71, v48, v48, 16
    v_bfi_b32 v87, s98, v48, v58
    ds_write_b128 v19, v[68:71] offset:34304
    ds_write_b128 v19, v[84:87] offset:38464
    v_alignbit_b32 v72, v55, v55, 16
    v_bfi_b32 v88, s98, v55, v54
    v_alignbit_b32 v73, v54, v54, 16
    v_bfi_b32 v89, s98, v54, v53
    v_alignbit_b32 v74, v53, v53, 16
    v_bfi_b32 v90, s98, v53, v52
    v_alignbit_b32 v75, v52, v52, 16
    v_bfi_b32 v91, s98, v52, v59
    ds_write_b128 v19, v[72:75] offset:33280
    ds_write_b128 v19, v[88:91] offset:37440
    ds_write_b32 v20, v22 offset:37376
    ds_write_b32 v20, v22 offset:41536
    v_mov_b32 v4, 1
    ds_write_b32 v21, v4 offset:328
    s_waitcnt lgkmcnt(0)
L_hb1:
    s_cmp_eq_u32 s32, 3
    s_cbranch_scc1 L_ahelp
    s_setprio 1
    s_mul_i32 s96, s36, 102400
    s_add_u32 s96, s96, 9437184
    s_add_u32 s48, s28, s96
    s_addc_u32 s49, s29, 0
    s_and_b32 s49, s49, 0xffff
    s_mov_b32 s50, 102400
    s_mov_b32 s51, 0x00020000
    v_lshlrev_b32 v19, 4, v0
    s_lshl1_add_u32 s96, s35, s32
    s_mul_i32 s96, s96, 40960
    s_mul_i32 s97, s36, 160
    s_add_u32 s96, s96, s97
    v_add_u32 v4, 0, v0
    v_mul_u32_u24 v8, 6554, v4
    v_lshrrev_b32 v8, 16, v8
    v_mul_u32_u24 v8, 1120, v8
    v_lshl_add_u32 v4, v4, 4, s96
    v_add_u32 v8, v8, v4
    v_add_u32 v4, 64, v0
    v_mul_u32_u24 v9, 6554, v4
    v_lshrrev_b32 v9, 16, v9
    v_mul_u32_u24 v9, 1120, v9
    v_lshl_add_u32 v4, v4, 4, s96
    v_add_u32 v9, v9, v4
    v_add_u32 v4, 128, v0
    v_mul_u32_u24 v10, 6554, v4
    v_lshrrev_b32 v10, 16, v10
    v_mul_u32_u24 v10, 1120, v10
    v_lshl_add_u32 v4, v4, 4, s96
    v_add_u32 v10, v10, v4
    v_add_u32 v4, 192, v0
    v_mul_u32_u24 v11, 6554, v4
    v_lshrrev_b32 v11, 16, v11
    v_mul_u32_u24 v11, 1120, v11
    v_lshl_add_u32 v4, v4, 4, s96
    v_add_u32 v11, v11, v4
    v_add_u32 v4, 256, v0
    v_mul_u32_u24 v12, 6554, v4
    v_lshrrev_b32 v12, 16, v12
    v_mul_u32_u24 v12, 1120, v12
    v_lshl_add_u32 v4, v4, 4, s96
    v_add_u32 v12, v12, v4
    s_mul_i32 s96, s32, 5120
    s_add_u32 s96, s96, 48128
    v_add_u32 v21, s96, v19
    s_mul_i32 s59, s32, 15360
    s_add_u32 s96, s59, 58368
    v_add_u32 v20, s96, v19
    s_add_u32 s60, s59, 51200
    s_setprio 3
    s_mov_b32 s100, 0
Lw_17:
    ds_read_b32 v4, v3 offset:280
    s_waitcnt lgkmcnt(0)
    v_readfirstlane_b32 s99, v4
    s_cmp_ge_u32 s99, 8
    s_cbranch_scc1 Lwd_18
    s_sleep 4
    s_add_u32 s100, s100, 1
    s_cmp_lt_u32 s100, 1048576
    s_cbranch_scc1 Lw_17
Lwd_18:
    s_mov_b32 s100, 0
Lw_19:
    ds_read_b32 v4, v3 offset:192
    s_waitcnt lgkmcnt(0)
    v_readfirstlane_b32 s99, v4
    s_cmp_ge_u32 s99, 1
    s_cbranch_scc1 Lwd_20
    s_sleep 2
    s_add_u32 s100, s100, 1
    s_cmp_lt_u32 s100, 1048576
    s_cbranch_scc1 Lw_19
Lwd_20:
    s_mov_b32 s59, 0
    s_cmp_eq_u32 s32, 1
    s_cselect_b32 s59, 17408, s59
    s_cmp_eq_u32 s32, 2
    s_cselect_b32 s59, 33792, s59
    s_add_u32 m0, s59, 109568
    s_nop 0
    buffer_load_dwordx4 v19, s[48:51], s59 offen offset:0 sc1 lds
    s_waitcnt vmcnt(3)
    buffer_load_dwordx4 v19, s[48:51], s59 offen offset:1024 sc1 lds
    s_waitcnt vmcnt(3)
    buffer_load_dwordx4 v19, s[48:51], s59 offen offset:2048 sc1 lds
    s_waitcnt vmcnt(3)
    s_branch L_skip1312
L_pada3:
    s_branch L_pada11
L_skip1312:
    buffer_load_dwordx4 v19, s[48:51], s59 offen offset:3072 sc1 lds
    s_add_u32 m0, m0, 4096
    s_add_u32 s59, s59, 4096
    s_waitcnt vmcnt(3)
    buffer_load_dwordx4 v19, s[48:51], s59 offen offset:0 sc1 lds
    s_waitcnt vmcnt(3)
    buffer_load_dwordx4 v19, s[48:51], s59 offen offset:1024 sc1 lds
    s_waitcnt vmcnt(3)
    buffer_load_dwordx4 v19, s[48:51], s59 offen offset:2048 sc1 lds
    s_waitcnt vmcnt(3)
    buffer_load_dwordx4 v19, s[48:51], s59 offen offset:3072 sc1 lds
    s_add_u32 m0, m0, 4096
    s_add_u32 s59, s59, 4096
    s_waitcnt vmcnt(3)
    buffer_load_dwordx4 v19, s[48:51], s59 offen offset:0 sc1 lds
    s_waitcnt vmcnt(3)
    buffer_load_dwordx4 v19, s[48:51], s59 offen offset:1024 sc1 lds
    s_waitcnt vmcnt(3)
    buffer_load_dwordx4 v19, s[48:51], s59 offen offset:2048 sc1 lds
    s_waitcnt vmcnt(3)
    buffer_load_dwordx4 v19, s[48:51], s59 offen offset:3072 sc1 lds
    s_add_u32 m0, m0, 4096
    s_add_u32 s59, s59, 4096
    s_waitcnt vmcnt(3)
    buffer_load_dwordx4 v19, s[48:51], s59 offen offset:0 sc1 lds
    s_waitcnt vmcnt(3)
    buffer_load_dwordx4 v19, s[48:51], s59 offen offset:1024 sc1 lds
    s_waitcnt vmcnt(3)
    buffer_load_dwordx4 v19, s[48:51], s59 offen offset:2048 sc1 lds
    s_waitcnt vmcnt(3)
    buffer_load_dwordx4 v19, s[48:51], s59 offen offset:3072 sc1 lds
    s_add_u32 m0, m0, 4096
    s_add_u32 s59, s59, 4096
    s_waitcnt vmcnt(3)
    buffer_load_dwordx4 v19, s[48:51], s59 offen offset:0 sc1 lds
    s_waitcnt vmcnt(3)
    s_mov_b32 s59, s60
    buffer_load_dwordx4 v[24:27], v19, s[48:51], s59 offen offset:0 sc1
    buffer_load_dwordx4 v[28:31], v19, s[48:51], s59 offen offset:1024 sc1
    buffer_load_dwordx4 v[32:35], v19, s[48:51], s59 offen offset:2048 sc1
    buffer_load_dwordx4 v[36:39], v19, s[48:51], s59 offen offset:3072 sc1
    s_add_u32 s59, s59, 4096
    buffer_load_dwordx4 v[40:43], v19, s[48:51], s59 offen offset:0 sc1
    buffer_load_dwordx4 v[44:47], v19, s[48:51], s59 offen offset:1024 sc1
    buffer_load_dwordx4 v[48:51], v19, s[48:51], s59 offen offset:2048 sc1
    buffer_load_dwordx4 v[52:55], v19, s[48:51], s59 offen offset:3072 sc1
    s_add_u32 s59, s59, 4096
    buffer_load_dwordx4 v[56:59], v19, s[48:51], s59 offen offset:0 sc1
    buffer_load_dwordx4 v[60:63], v19, s[48:51], s59 offen offset:1024 sc1
    buffer_load_dwordx4 v[64:67], v19, s[48:51], s59 offen offset:2048 sc1
    buffer_load_dwordx4 v[68:71], v19, s[48:51], s59 offen offset:3072 sc1
    s_add_u32 s59, s59, 4096
    buffer_load_dwordx4 v[72:75], v19, s[48:51], s59 offen offset:0 sc1
    buffer_load_dwordx4 v[76:79], v19, s[48:51], s59 offen offset:1024 sc1
    buffer_load_dwordx4 v[80:83], v19, s[48:51], s59 offen offset:2048 sc1
    s_cmp_lt_u32 s32, 2
    s_cbranch_scc1 L_ai_x
    s_add_u32 s59, s59, 3072
    buffer_load_dwordx4 v[84:87], v19, s[48:51], s59 offen offset:0 sc1
    buffer_load_dwordx4 v[88:91], v19, s[48:51], s59 offen offset:1024 sc1
    buffer_load_dwordx4 v[92:95], v19, s[48:51], s59 offen offset:2048 sc1
    buffer_load_dwordx4 v[96:99], v19, s[48:51], s59 offen offset:3072 sc1
    s_add_u32 s59, s59, 4096
    buffer_load_dwordx4 v[100:103], v19, s[48:51], s59 offen offset:0 sc1
    v_add_u32 v21, 15360, v20
    s_branch L_ai_d
L_pada4:
    s_branch L_pada12
L_ai_x:
    global_load_dwordx4 v[84:87], v8, s[4:5]
    global_load_dwordx4 v[88:91], v9, s[4:5]
    global_load_dwordx4 v[92:95], v10, s[4:5]
    global_load_dwordx4 v[96:99], v11, s[4:5]
    global_load_dwordx4 v[100:103], v12, s[4:5]
L_ai_d:
    s_waitcnt vmcnt(0)
    v_mov_b32 v4, 1
    s_mov_b64 exec, 1
    ds_add_u32 v3, v4 offset:200
    s_mov_b64 exec, -1
    s_lshl_b32 s96, s30, 5
    s_add_u32 s96, s96, s31
    s_lshl_b32 s96, s96, 8
    s_add_u32 s96, s96, 65536
    s_lshl3_add_u32 s96, s32, s96
    s_add_u32 s40, s28, s96
    s_addc_u32 s41, s29, 0
    s_mul_i32 s96, s36, 327680
    s_mul_i32 s97, s32, 163840
    s_add_u32 s96, s96, s97
    s_lshl_b32 s97, s35, 7
    s_add_u32 s96, s96, s97
    s_add_u32 s96, s96, 4194304
    v_lshrrev_b32 v126, 3, v0
    v_and_b32 v127, 7, v0
    v_and_b32 v125, 6, v126
    v_xor_b32 v125, v125, v127
    v_lshlrev_b32 v125, 4, v125
    v_lshl_add_u32 v125, v126, 7, v125
    s_mul_i32 s97, s32, 5120
    s_add_u32 s97, s97, 0
    v_add_u32 v125, s97, v125
    v_lshlrev_b32 v126, 12, v126
    v_lshl_add_u32 v126, v127, 4, v126
    v_add_u32 v120, s96, v126
    v_add_u32 v121, 32768, v120
    v_add_u32 v122, 65536, v120
    v_add_u32 v123, 98304, v120
    v_add_u32 v124, 131072, v120
    s_and_b32 s44, s33, 0xffffff00
    s_add_u32 s44, s44, 0x600
    s_mov_b32 s100, 0
Lw_21:
    ds_read_b32 v4, v3 offset:304
    s_waitcnt lgkmcnt(0)
    v_readfirstlane_b32 s99, v4
    s_cmp_ge_u32 s99, 1
    s_cbranch_scc1 Lwd_22
    s_sleep 8
    s_add_u32 s100, s100, 1
    s_cmp_lt_u32 s100, 1048576
    s_cbranch_scc1 Lw_21
Lwd_22:
    s_mov_b32 s100, 0
Lw_23:
    ds_read_b32 v4, v3 offset:196
    s_waitcnt lgkmcnt(0)
    v_readfirstlane_b32 s99, v4
    s_cmp_ge_u32 s99, 8
    s_cbranch_scc1 Lwd_24
    s_sleep 1
    s_add_u32 s100, s100, 1
    s_cmp_lt_u32 s100, 1048576
    s_cbranch_scc1 Lw_23
Lwd_24:
    ds_write_b128 v21, v[84:87] offset:0
    ds_write_b128 v21, v[88:91] offset:1024
    ds_write_b128 v21, v[92:95] offset:2048
    ds_write_b128 v21, v[96:99] offset:3072
    s_waitcnt lgkmcnt(4)
    ds_write_b128 v21, v[100:103] offset:4096
    s_lshr_b32 s96, s32, 1
    s_xor_b32 s96, s96, 1
    v_mov_b32 v4, s96
    s_mov_b64 exec, 1
    ds_add_u32 v3, v4 offset:376
    s_mov_b64 exec, -1
    s_setprio 0
    ds_write_b128 v20, v[24:27] offset:0
    ds_write_b128 v20, v[28:31] offset:1024
    ds_write_b128 v20, v[32:35] offset:2048
    ds_write_b128 v20, v[36:39] offset:3072
    s_waitcnt lgkmcnt(4)
    ds_write_b128 v20, v[40:43] offset:4096
    ds_write_b128 v20, v[44:47] offset:5120
    ds_write_b128 v20, v[48:51] offset:6144
    ds_write_b128 v20, v[52:55] offset:7168
    s_waitcnt lgkmcnt(4)
    ds_write_b128 v20, v[56:59] offset:8192
    ds_write_b128 v20, v[60:63] offset:9216
    ds_write_b128 v20, v[64:67] offset:10240
    ds_write_b128 v20, v[68:71] offset:11264
    s_waitcnt lgkmcnt(4)
    ds_write_b128 v20, v[72:75] offset:12288
    ds_write_b128 v20, v[76:79] offset:13312
    ds_write_b128 v20, v[80:83] offset:14336
    s_setprio 3
    v_mov_b32 v4, 1
    s_mov_b64 exec, 1
    ds_add_u32 v3, v4 offset:204
    s_mov_b64 exec, -1
    s_cmp_lt_u32 s32, 2
    s_cbranch_scc1 L_aux
    s_endpgm
L_pada5:
    s_branch L_pada13
L_ahelp:
    v_lshlrev_b32 v4, 2, v0
    v_add_u32 v4, 161792, v4
    v_mov_b32 v5, 0
    ds_write_b32 v4, v5
    s_cmp_lg_u32 s31, 30
    s_cbranch_scc1 L_nocen
    s_sleep 8
    s_lshl_b32 s96, s30, 13
    s_add_u32 s96, s96, 65536
    v_and_b32 v4, 31, v0
    v_lshl_add_u32 v20, v4, 8, s96
    v_and_b32 v4, 7, v0
    v_bfe_u32 v5, v0, 3, 1
    v_lshl_add_u32 v4, v4, 5, v5
    v_lshlrev_b32 v4, 8, v4
    s_mov_b32 exec_lo, 0
    v_add_u32 v20, 73216, v4
    s_mov_b32 exec_lo, -1
    v_mov_b32 v24, 0
    v_mov_b32 v25, 0
    s_mov_b32 s60, -1
    s_mov_b32 s61, 0xffff
    s_mov_b64 exec, s[60:61]
    s_mov_b32 s100, 0
L_hpg:
    global_atomic_or_x2 v[26:27], v20, v[24:25], s[28:29] offset:24 sc0 sc1
    s_waitcnt vmcnt(0)
    v_cmp_ne_u32 vcc, s33, v26
    s_cbranch_vccz L_hdg
    s_mov_b64 exec, vcc
    s_sleep 2
    s_add_u32 s100, s100, 1
    s_cmp_lt_u32 s100, 1048576
    s_cbranch_scc1 L_hpg
L_hdg:
    s_mov_b64 exec, -1
    v_readfirstlane_b32 s96, v27
    s_nop 1
    v_cmp_ne_u32 vcc, s96, v27
    s_cmp_eq_u32 vcc_lo, 0
    s_cselect_b32 s96, 1, 2
    v_mov_b32 v22, s33
    v_mov_b32 v23, s96
    s_mov_b64 exec, 0xffffffff
    global_store_dwordx2 v20, v[22:23], s[28:29] offset:136 sc1
    s_mov_b64 exec, -1
L_nocen:
    s_sub_u32 s52, s31, 20
    s_mul_i32 s96, s30, 262144
    s_mul_i32 s97, s52, 16768
    s_add_u32 s96, s96, s97
    s_add_u32 s53, s96, 7340032
    s_mul_i32 s96, s30, 327680
    s_mul_i32 s97, s52, 27392
    s_min_u32 s97, s97, 300288
    s_add_u32 s96, s96, s97
    s_add_u32 s54, s96, 0
    s_mul_i32 s55, s36, 102400
    s_add_u32 s55, s55, 9437184
    v_lshlrev_b32 v15, 7, v0
    s_mov_b32 s44, s28
    s_and_b32 s45, s29, 0xffff
    s_mov_b32 s46, 16777216
    s_mov_b32 s47, 0x00020000
    s_mov_b32 s100, 0
Lw_25:
    ds_read_b32 v4, v3 offset:280
    s_waitcnt lgkmcnt(0)
    v_readfirstlane_b32 s99, v4
    s_cmp_ge_u32 s99, 8
    s_cbranch_scc1 Lwd_26
    s_sleep 2
    s_add_u32 s100, s100, 1
    s_cmp_lt_u32 s100, 1048576
    s_cbranch_scc1 Lw_25
Lwd_26:
    buffer_load_dword v18, v15, s[44:47], s53 offen sc1
    s_add_u32 s53, s53, 8192
    buffer_load_dword v18, v15, s[44:47], s53 offen sc1
    s_add_u32 s53, s53, 8192
    s_mov_b64 exec, 0x7
    buffer_load_dword v18, v15, s[44:47], s53 offen sc1
    s_add_u32 s53, s53, 8192
    s_mov_b64 exec, -1
    s_lshl_b32 s98, s30, 5
    s_add_u32 s98, s98, s31
    s_lshl_b32 s98, s98, 8
    s_add_u32 s98, s98, 65536
    s_add_u32 s98, s98, 128
    s_mov_b32 s100, 0
Lc_27:
    s_load_dwordx4 s[88:91], s[28:29], s98 glc
    s_waitcnt lgkmcnt(0)
    s_cmp_eq_u32 s90, s33
    s_cbranch_scc1 Lcd_28
    s_sleep 2
    s_add_u32 s100, s100, 1
    s_cmp_lt_u32 s100, 1048576
    s_cbranch_scc1 Lc_27
    s_mov_b32 s91, 2
Lcd_28:
    s_cmp_eq_u32 s91, 1
    s_cselect_b32 s99, 0, 15728640
    s_add_u32 s16, s28, s99
    s_addc_u32 s17, s29, 0
    v_mov_b32 v4, s91
    ds_write_b32 v3, v4 offset:192
    s_mov_b32 s40, s24
    s_and_b32 s41, s25, 0xffff
    s_mov_b32 s42, 2621440
    s_mov_b32 s43, 0x00020000
    s_cmp_lg_u32 s91, 1
    s_cbranch_scc1 L_noot
    s_sleep 32
    buffer_load_dword v18, v15, s[40:43], s54 offen sc1
    s_add_u32 s54, s54, 8192
    buffer_load_dword v18, v15, s[40:43], s54 offen sc1
    s_add_u32 s54, s54, 8192
    buffer_load_dword v18, v15, s[40:43], s54 offen sc1
    s_add_u32 s54, s54, 8192
    s_mov_b64 exec, 0x3fffff
    buffer_load_dword v18, v15, s[40:43], s54 offen sc1
    s_add_u32 s54, s54, 8192
    s_mov_b64 exec, -1
L_noot:
    s_lshl_b32 s96, s2, 7
    s_add_u32 s96, s96, 0x1F8000
    v_lshl_add_u32 v4, v0, 21, s96
    s_add_u32 s96, s96, 10518528
    v_writelane_b32 v4, s96, 6
    v_mov_b32 v5, 0
    s_mov_b64 exec, 0xde
    global_atomic_or v4, v5, s[28:29] sc1
    s_mov_b64 exec, -1
    s_waitcnt vmcnt(0)
    v_mov_b32 v4, 1
    ds_write_b32 v3, v4 offset:248
    v_mov_b32 v4, 1
    s_mov_b64 exec, 1
    ds_add_u32 v3, v4 offset:200
    s_mov_b64 exec, -1
    v_mov_b32 v4, 1
    s_mov_b64 exec, 1
    ds_add_u32 v3, v4 offset:204
    s_mov_b64 exec, -1
    s_mov_b32 s100, 0
Lw_29:
    ds_read_b32 v4, v3 offset:304
    s_waitcnt lgkmcnt(0)
    v_readfirstlane_b32 s99, v4
    s_cmp_ge_u32 s99, 1
    s_cbranch_scc1 Lwd_30
    s_sleep 8
    s_add_u32 s100, s100, 1
    s_cmp_lt_u32 s100, 1048576
    s_cbranch_scc1 Lw_29
Lwd_30:
    s_branch L_help
L_pada6:
    s_branch L_pada14
L_padb5:
    s_branch L_padb13
L_aux:
    s_mov_b32 s100, 0
L_yp:
    s_load_dwordx2 s[42:43], s[40:41], 0 glc
    s_waitcnt lgkmcnt(0)
    s_and_b32 s43, s43, 0xffffff00
    s_cmp_eq_u32 s43, s44
    s_cbranch_scc1 L_ypd
    s_sleep 1
    s_add_u32 s100, s100, 1
    s_cmp_lt_u32 s100, 1048576
    s_cbranch_scc1 L_yp
L_ypd:
    s_mov_b32 s100, 0
L_yretry:
    global_load_dwordx4 v[128:131], v120, s[28:29] sc1
    global_load_dwordx4 v[132:135], v121, s[28:29] sc1
    global_load_dwordx4 v[136:139], v122, s[28:29] sc1
    global_load_dwordx4 v[140:143], v123, s[28:29] sc1
    global_load_dwordx4 v[144:147], v124, s[28:29] sc1
    v_mov_b32 v16, 0
    s_waitcnt vmcnt(4)
    ds_write_b128 v125, v[128:131] offset:0
    v_add3_u32 v16, v16, v128, v129
    v_add3_u32 v16, v16, v130, v131
    s_waitcnt vmcnt(3)
    ds_write_b128 v125, v[132:135] offset:1024
    v_add3_u32 v16, v16, v132, v133
    v_add3_u32 v16, v16, v134, v135
    s_waitcnt vmcnt(2)
    ds_write_b128 v125, v[136:139] offset:2048
    v_add3_u32 v16, v16, v136, v137
    v_add3_u32 v16, v16, v138, v139
    s_waitcnt vmcnt(1)
    ds_write_b128 v125, v[140:143] offset:3072
    v_add3_u32 v16, v16, v140, v141
    v_add3_u32 v16, v16, v142, v143
    s_waitcnt vmcnt(0)
    ds_write_b128 v125, v[144:147] offset:4096
    v_add3_u32 v16, v16, v144, v145
    v_add3_u32 v16, v16, v146, v147
    s_nop 1
    v_add_u32_dpp v16, v16, v16 row_ror:8 row_mask:0xf bank_mask:0xf
    s_nop 1
    v_add_u32_dpp v16, v16, v16 row_ror:4 row_mask:0xf bank_mask:0xf
    s_nop 1
    v_add_u32_dpp v16, v16, v16 row_ror:2 row_mask:0xf bank_mask:0xf
    s_nop 1
    v_add_u32_dpp v16, v16, v16 row_ror:1 row_mask:0xf bank_mask:0xf
    s_nop 0
    v_readlane_b32 s96, v16, 0
    v_readlane_b32 s97, v16, 16
    v_readlane_b32 s98, v16, 32
    v_readlane_b32 s99, v16, 48
    s_add_u32 s96, s96, s97
    s_add_u32 s98, s98, s99
    s_add_u32 s96, s96, s98
    s_cmp_eq_u32 s96, s42
    s_cbranch_scc1 L_yok
    s_sleep 2
    s_add_u32 s100, s100, 1
    s_cmp_lt_u32 s100, 1048576
    s_cbranch_scc1 L_yretry
L_yok:
    v_mov_b32 v4, 1
    s_mov_b64 exec, 1
    ds_add_u32 v3, v4 offset:212
    s_mov_b64 exec, -1
    s_endpgm
L_compute:
    s_waitcnt lgkmcnt(0)
    s_load_dword s33, s[28:29], 0
    s_setprio 2
    s_sub_u32 s40, s32, 4
    s_lshr_b32 s42, s40, 2
    s_and_b32 s56, s40, 3
    s_xor_b32 s41, s56, s42
    s_sub_u32 s46, s38, 5
    s_cselect_b32 s46, s38, s46
    s_mov_b32 s96, 0xf9af5600
    s_mov_b32 s45, 0x886f5f4f
    s_cmp_eq_u32 s46, 1
    s_cselect_b32 s96, 0xfeab5500, s96
    s_cselect_b32 s45, 0x8c5f4f8f, s45
    s_cmp_eq_u32 s46, 2
    s_cselect_b32 s96, 0xffaa5500, s96
    s_cselect_b32 s45, 0x8e4f3f87, s45
    s_cmp_eq_u32 s46, 3
    s_cselect_b32 s96, 0xffaa1540, s96
    s_cselect_b32 s45, 0x8f3f2f83, s45
    s_cmp_eq_u32 s46, 4
    s_cselect_b32 s96, 0xff6a0590, s96
    s_cselect_b32 s45, 0x3f2f1f81, s45
    s_lshl_b32 s97, s41, 3
    s_lshr_b32 s96, s96, s97
    s_lshr_b32 s45, s45, s97
    s_and_b32 s45, s45, 0xff
    v_lshrrev_b32 v5, 1, v1
    v_xor_b32 v5, v5, v2
    v_lshlrev_b32 v5, 4, v5
    v_lshl_add_u32 v132, v1, 7, v5
    s_lshl_b32 s97, s42, 13
    v_add_u32 v132, s97, v132
    v_and_b32 v4, 3, v0
    v_lshlrev_b32 v5, 1, v4
    v_bfe_u32 v5, s96, v5, 2
    v_bfe_u32 v6, v0, 3, 2
    v_xor_b32 v5, v5, v6
    v_lshl_add_u32 v5, v5, 2, v4
    v_bfe_u32 v6, v0, 2, 2
    v_mad_u32_u24 v6, v2, 24, v6
    v_lshlrev_b32 v6, 7, v6
    v_lshl_add_u32 v133, v5, 3, v6
    v_add_u32 v133, 18432, v133
    v_mov_b32 v8, 0
    v_mov_b32 v9, 0
    v_mov_b32 v10, 0
    v_mov_b32 v11, 0
    v_mov_b32 v12, 0
    v_mov_b32 v13, 0
    v_mov_b32 v14, 0
    v_mov_b32 v15, 0
    v_mov_b32 v16, 0
    v_mov_b32 v17, 0
    v_mov_b32 v18, 0
    v_mov_b32 v19, 0
    v_mov_b32 v20, 0
    v_mov_b32 v21, 0
    v_mov_b32 v22, 0
    v_mov_b32 v23, 0
    v_mov_b32 v24, 0
    v_mov_b32 v25, 0
    v_mov_b32 v26, 0
    v_mov_b32 v27, 0
    v_mov_b32 v28, 0
    v_mov_b32 v29, 0
    v_mov_b32 v30, 0
    v_mov_b32 v31, 0
    v_mov_b32 v32, 0
    v_mov_b32 v33, 0
    v_mov_b32 v34, 0
    v_mov_b32 v35, 0
    v_mov_b32 v36, 0
    v_mov_b32 v37, 0
    v_mov_b32 v38, 0
    v_mov_b32 v39, 0
    v_mov_b32 v40, 0
    v_mov_b32 v41, 0
    v_mov_b32 v42, 0
    v_mov_b32 v43, 0
    v_mov_b32 v44, 0
    v_mov_b32 v45, 0
    v_mov_b32 v46, 0
    v_mov_b32 v47, 0
    v_mov_b32 v48, 0
    v_mov_b32 v49, 0
    v_mov_b32 v50, 0
    v_mov_b32 v51, 0
    v_mov_b32 v52, 0
    v_mov_b32 v53, 0
    v_mov_b32 v54, 0
    v_mov_b32 v55, 0
    v_mov_b32 v56, 0
    v_mov_b32 v57, 0
    v_mov_b32 v58, 0
    v_mov_b32 v59, 0
    v_mov_b32 v60, 0
    v_mov_b32 v61, 0
    v_mov_b32 v62, 0
    v_mov_b32 v63, 0
    v_mov_b32 v64, 0
    v_mov_b32 v65, 0
    v_mov_b32 v66, 0
    v_mov_b32 v67, 0
    s_mov_b32 s43, 0
    s_mov_b32 s44, 86016
    v_add_u32 v134, 86016, v132
    v_xor_b32 v135, 64, v134
    v_add_u32 v136, 86016, v133
    v_mov_b32 v7, 0xf149f2ca
    v_lshlrev_b32 v4, 2, v2
    v_sub_u32 v4, v1, v4
    v_subrev_u32 v5, 0, v4
    v_and_b32 v5, 0x80000001, v5
    v_cmp_eq_u32 vcc, 0, v5
    s_nop 1
    v_cndmask_b32 v144, v7, 0, vcc
    v_cmp_eq_u32 vcc, 0x80000000, v5
    s_nop 1
    v_cndmask_b32 v148, v7, 0, vcc
    v_subrev_u32 v5, 1, v4
    v_and_b32 v5, 0x80000001, v5
    v_cmp_eq_u32 vcc, 0, v5
    s_nop 1
    v_cndmask_b32 v145, v7, 0, vcc
    v_cmp_eq_u32 vcc, 0x80000000, v5
    s_nop 1
    v_cndmask_b32 v149, v7, 0, vcc
    v_subrev_u32 v5, 2, v4
    v_and_b32 v5, 0x80000001, v5
    v_cmp_eq_u32 vcc, 0, v5
    s_nop 1
    v_cndmask_b32 v146, v7, 0, vcc
    v_cmp_eq_u32 vcc, 0x80000000, v5
    s_nop 1
    v_cndmask_b32 v150, v7, 0, vcc
    v_subrev_u32 v5, 3, v4
    v_and_b32 v5, 0x80000001, v5
    v_cmp_eq_u32 vcc, 0, v5
    s_nop 1
    v_cndmask_b32 v147, v7, 0, vcc
    v_cmp_eq_u32 vcc, 0x80000000, v5
    s_nop 1
    v_cndmask_b32 v151, v7, 0, vcc
    v_and_b32 v5, 1, v1
    v_lshlrev_b32 v6, 4, v5
    v_mov_b32 v7, 0xffff
    v_lshlrev_b32 v7, v6, v7
    v_sub_u32 v5, v4, v5
    v_cmp_le_i32 vcc, 0, v5
    s_nop 1
    v_cndmask_b32 v152, 0, v7, vcc
    v_cndmask_b32 v154, v7, 0, vcc
    v_cmp_le_i32 vcc, 2, v5
    s_nop 1
    v_cndmask_b32 v153, 0, v7, vcc
    v_cndmask_b32 v155, v7, 0, vcc
    v_mov_b32 v7, 0x0c0c0c0c
    s_mov_b32 s96, 0x1000100
    v_bfi_b32 v152, v152, s96, v7
    s_mov_b32 s96, 0x3020302
    v_bfi_b32 v153, v153, s96, v7
    s_mov_b32 s96, 0x1000100
    v_bfi_b32 v154, v154, s96, v7
    s_mov_b32 s96, 0x3020302
    v_bfi_b32 v155, v155, s96, v7
    s_or_b32 s96, s37, s42
    s_cmp_eq_u32 s96, 0
    s_cselect_b32 s96, 0xf149f2ca, 0
    v_add_f32 v140, s96, v148
    v_add_f32 v141, s96, v149
    v_add_f32 v142, s96, v150
    v_add_f32 v143, s96, v151
    s_mov_b32 s54, 0x3ea52b5c
    v_bfe_i32 v157, s45, v2, 1
    v_cmp_ne_u32 s[50:51], 0, v157
    s_bfe_u32 s60, s45, 131076
    v_cmp_eq_u32 s[52:53], s60, v2
    s_bfe_u32 s61, s45, 65542
    s_lshr_b32 s62, s41, 1
    s_add_u32 s96, s41, 1
    s_bfe_u32 s96, s96, 65537
    s_xor_b32 s57, s96, 1
    s_bitcmp1_b32 s45, 7
    s_cselect_b32 s63, s62, s61
    s_mul_i32 s96, s63, 13824
    s_lshl_b32 s97, s42, 11
    s_add_u32 s96, s96, s97
    s_add_u32 s96, s96, 129024
    v_lshl_add_u32 v156, v0, 3, s96
    v_and_b32 v4, 0x33, v0
    s_lshl_b32 s97, s60, 5
    s_add_u32 s96, s96, s97
    v_lshl_add_u32 v162, v4, 3, s96
    s_lshl_b32 s96, s41, 10
    s_add_u32 s96, s96, 156672
    v_lshl_add_u32 v164, v0, 3, s96
    v_min_u32 v4, 16, v0
    v_lshl_add_u32 v163, v4, 2, v3
    v_add_u32 v163, 128, v163
    s_lshl1_add_u32 s96, s41, s42
    s_lshl_b32 s96, s96, 2
    v_add_u32 v165, s96, v3
    s_lshl_b32 s96, s41, 1
    s_lshl_b32 s96, s42, s96
    s_lshl1_add_u32 s97, s42, 1
    s_mul_i32 s98, s61, 6
    s_lshl_b32 s97, s97, s98
    s_or_b32 s98, s96, s97
    s_bitcmp1_b32 s45, 7
    s_cselect_b32 s48, s96, s98
    s_cselect_b32 s49, s96, s97
    s_lshl_b32 s49, s49, 8
    s_and_b32 s64, s37, 1
    s_lshl1_add_u32 s65, s64, s42
    s_mul_i32 s96, s65, 81920
    s_mul_i32 s97, s30, 327680
    s_add_u32 s96, s96, s97
    s_lshl_b32 s97, s38, 11
    s_add_u32 s96, s96, s97
    s_mul_i32 s97, s57, 20480
    s_lshl3_add_u32 s97, s62, s97
    s_add_u32 s97, s97, s96
    v_lshl_add_u32 v160, v0, 4, s97
    s_lshl_b32 s97, s60, 8
    s_lshl3_add_u32 s97, s61, s97
    s_add_u32 s97, s97, 20480
    s_add_u32 s97, s97, s96
    v_lshrrev_b32 v4, 1, v2
    v_mul_u32_u24 v4, 38912, v4
    v_lshl_add_u32 v4, v2, 10, v4
    v_lshl_add_u32 v4, v1, 4, v4
    v_add_u32 v161, s97, v4
    s_mul_i32 s66, s30, 262144
    s_add_u32 s66, s66, 7340032
    s_lshl_b32 s96, s65, 8
    s_lshl_b32 s97, s57, 7
    s_add_u32 s96, s96, s97
    s_lshl1_add_u32 s97, s38, s62
    s_lshl2_add_u32 s96, s97, s96
    s_add_u32 s96, s96, s66
    s_add_u32 s55, s96, 196608
    s_cmp_ge_u32 s38, 5
    s_cselect_b32 s96, 3, -1
    s_add_u32 s96, s96, s46
    s_add_u32 s96, s96, s62
    s_and_b32 s96, s96, 7
    s_lshl3_add_u32 s96, s64, s96
    s_lshl1_add_u32 s96, s96, s62
    s_lshl1_add_u32 s96, s96, s42
    s_xor_b32 s97, s96, 2
    s_mul_i32 s96, s96, 3072
    s_mul_i32 s97, s97, 3072
    s_add_u32 s96, s96, s66
    s_add_u32 s97, s97, s66
    v_lshl_add_u32 v159, v0, 4, s96
    v_lshl_add_u32 v158, v0, 4, s97
    v_add_u32 v157, 40960, v160
    s_mul_i32 s96, s57, 51200
    s_add_u32 s80, s96, 10240
    s_mul_i32 s81, s56, 2560
    s_add_u32 s81, s81, 0
    s_mov_b32 s93, 112640
    s_mov_b32 s101, 0
    s_and_b32 s98, s35, 3
    s_lshr_b32 s96, s56, 1
    s_lshl1_add_u32 s96, s98, s96
    s_lshl1_add_u32 s96, s96, s57
    s_mul_i32 s96, s96, 20480
    s_and_b32 s97, s56, 1
    s_lshl_b32 s97, s97, 10
    s_add_u32 s96, s96, s97
    s_mul_i32 s97, s30, 327680
    s_add_u32 s96, s96, s97
    s_add_u32 s82, s96, 4096
    s_mul_i32 s96, s30, 262144
    s_lshl_b32 s98, s98, 8
    s_add_u32 s96, s96, s98
    s_add_u32 s83, s96, 7536640
    s_mul_i32 s84, s56, 5120
    s_add_u32 s84, s84, 129024
    s_lshl2_add_u32 s96, s35, s56
    s_mul_i32 s96, s96, 20480
    s_mul_i32 s97, s36, 160
    s_add_u32 s85, s96, s97
    v_lshl_add_u32 v138, v0, 4, s80
    v_lshl_add_u32 v139, v0, 4, s82
    v_lshl_add_u32 v166, v0, 2, s83
    s_waitcnt lgkmcnt(0)
    s_mul_i32 s33, s33, 1664525
    s_add_u32 s33, s33, 1013904223
    s_cmp_eq_u32 s32, 4
    s_cbranch_scc1 L_padb0
    s_cmp_eq_u32 s32, 5
    s_cbranch_scc1 L_padb1
    s_cmp_eq_u32 s32, 6
    s_cbranch_scc1 L_padb2
    s_cmp_eq_u32 s32, 7
    s_cbranch_scc1 L_padb3
    s_cmp_eq_u32 s32, 8
    s_cbranch_scc1 L_padb4
    s_cmp_eq_u32 s32, 9
    s_cbranch_scc1 L_padb5
    s_cmp_eq_u32 s32, 10
    s_cbranch_scc1 L_padb6
    s_branch L_padb7
L_padb6:
    s_branch L_padb14
L_warmed_b:
    s_barrier
    s_cmp_lg_u32 s42, 0
    s_cbranch_scc1 L_gemm_40
L_gemm_50:
    s_barrier
    ds_read_b64_tr_b16 v[112:113], v136 offset:1024
    ds_read_b64_tr_b16 v[114:115], v136 offset:1536
    ds_read_b128 v[68:71], v134 offset:0
    ds_read_b128 v[72:75], v134 offset:2048
    ds_read_b128 v[76:79], v134 offset:4096
    ds_read_b128 v[80:83], v134 offset:6144
    ds_read_b128 v[84:87], v134 offset:8192
    ds_read_b64_tr_b16 v[116:117], v136 offset:2048
    ds_read_b64_tr_b16 v[118:119], v136 offset:2560
    ds_read_b64_tr_b16 v[108:109], v136 offset:0
    ds_read_b64_tr_b16 v[110:111], v136 offset:512
    s_branch L_skip2036
L_padb7:
    s_branch L_padb15
L_skip2036:
L_gemm_5:
    s_waitcnt lgkmcnt(8)
    v_mfma_f32_16x16x32_bf16 v[28:31], v[112:115], v[68:71], v[28:31]
    s_setprio 2
    ds_read_b64_tr_b16 v[124:125], v136 offset:13312
    s_waitcnt lgkmcnt(8)
    v_mfma_f32_16x16x32_bf16 v[32:35], v[112:115], v[72:75], v[32:35]
    ds_read_b64_tr_b16 v[126:127], v136 offset:13824
    s_waitcnt lgkmcnt(8)
    v_mfma_f32_16x16x32_bf16 v[36:39], v[112:115], v[76:79], v[36:39]
    ds_read_b128 v[88:91], v135 offset:0
    s_waitcnt lgkmcnt(8)
    v_mfma_f32_16x16x32_bf16 v[40:43], v[112:115], v[80:83], v[40:43]
    ds_read_b128 v[92:95], v135 offset:2048
    s_waitcnt lgkmcnt(8)
    v_mfma_f32_16x16x32_bf16 v[44:47], v[112:115], v[84:87], v[44:47]
    ds_read_b128 v[96:99], v135 offset:4096
    s_waitcnt lgkmcnt(7)
    v_mfma_f32_16x16x32_bf16 v[48:51], v[68:71], v[116:119], v[48:51]
    ds_read_b128 v[100:103], v135 offset:6144
    v_mfma_f32_16x16x32_bf16 v[52:55], v[72:75], v[116:119], v[52:55]
    ds_read_b128 v[104:107], v135 offset:8192
    v_mfma_f32_16x16x32_bf16 v[56:59], v[76:79], v[116:119], v[56:59]
    ds_read_b64_tr_b16 v[128:129], v136 offset:14336
    v_mfma_f32_16x16x32_bf16 v[60:63], v[80:83], v[116:119], v[60:63]
    ds_read_b64_tr_b16 v[130:131], v136 offset:14848
    v_mfma_f32_16x16x32_bf16 v[64:67], v[84:87], v[116:119], v[64:67]
    ds_read_b64_tr_b16 v[120:121], v136 offset:12288
    s_waitcnt lgkmcnt(10)
    v_mfma_f32_16x16x32_bf16 v[12:15], v[108:111], v[72:75], v[12:15]
    ds_read_b64_tr_b16 v[122:123], v136 offset:12800
    v_mfma_f32_16x16x32_bf16 v[16:19], v[108:111], v[76:79], v[16:19]
    v_mfma_f32_16x16x32_bf16 v[20:23], v[108:111], v[80:83], v[20:23]
    v_mfma_f32_16x16x32_bf16 v[24:27], v[108:111], v[84:87], v[24:27]
    s_waitcnt lgkmcnt(8)
    v_mfma_f32_16x16x32_bf16 v[28:31], v[124:127], v[88:91], v[28:31]
    s_add_u32 s44, s44, 43008
    s_cmp_eq_u32 s44, 129024
    s_cselect_b32 s44, 0, s44
    v_add_u32 v134, s44, v132
    v_add_u32 v136, s44, v133
    s_waitcnt lgkmcnt(7)
    v_mfma_f32_16x16x32_bf16 v[32:35], v[124:127], v[92:95], v[32:35]
    s_waitcnt lgkmcnt(0)
    s_barrier
    s_setprio 1
    ds_read_b64_tr_b16 v[112:113], v136 offset:1024
    v_mfma_f32_16x16x32_bf16 v[36:39], v[124:127], v[96:99], v[36:39]
    ds_read_b64_tr_b16 v[114:115], v136 offset:1536
    v_mfma_f32_16x16x32_bf16 v[40:43], v[124:127], v[100:103], v[40:43]
    v_xor_b32 v135, 64, v134
    ds_read_b128 v[68:71], v134 offset:0
    v_mfma_f32_16x16x32_bf16 v[44:47], v[124:127], v[104:107], v[44:47]
    ds_read_b128 v[72:75], v134 offset:2048
    v_mfma_f32_16x16x32_bf16 v[48:51], v[88:91], v[128:131], v[48:51]
    ds_read_b128 v[76:79], v134 offset:4096
    v_mfma_f32_16x16x32_bf16 v[52:55], v[92:95], v[128:131], v[52:55]
    ds_read_b128 v[80:83], v134 offset:6144
    v_mfma_f32_16x16x32_bf16 v[56:59], v[96:99], v[128:131], v[56:59]
    ds_read_b128 v[84:87], v134 offset:8192
    v_mfma_f32_16x16x32_bf16 v[60:63], v[100:103], v[128:131], v[60:63]
    ds_read_b64_tr_b16 v[116:117], v136 offset:2048
    v_mfma_f32_16x16x32_bf16 v[64:67], v[104:107], v[128:131], v[64:67]
    ds_read_b64_tr_b16 v[118:119], v136 offset:2560
    v_mfma_f32_16x16x32_bf16 v[12:15], v[120:123], v[92:95], v[12:15]
    ds_read_b64_tr_b16 v[108:109], v136 offset:0
    v_mfma_f32_16x16x32_bf16 v[16:19], v[120:123], v[96:99], v[16:19]
    s_add_u32 s43, s43, 1
    ds_read_b64_tr_b16 v[110:111], v136 offset:512
    v_mfma_f32_16x16x32_bf16 v[20:23], v[120:123], v[100:103], v[20:23]
    s_cmp_lt_u32 s43, 9
    v_mfma_f32_16x16x32_bf16 v[24:27], v[120:123], v[104:107], v[24:27]
    s_cbranch_scc1 L_gemm_5
    s_waitcnt lgkmcnt(8)
    v_mfma_f32_16x16x32_bf16 v[28:31], v[112:115], v[68:71], v[28:31]
    s_bitcmp1_b32 s45, 7
    s_setprio 3
    s_cbranch_scc1 Llp_31
    s_setprio 1
Llp_31:
    ds_read_b64_tr_b16 v[124:125], v136 offset:13312
    s_waitcnt lgkmcnt(8)
    v_mfma_f32_16x16x32_bf16 v[32:35], v[112:115], v[72:75], v[32:35]
    ds_read_b64_tr_b16 v[126:127], v136 offset:13824
    s_waitcnt lgkmcnt(8)
    v_mfma_f32_16x16x32_bf16 v[36:39], v[112:115], v[76:79], v[36:39]
    ds_read_b128 v[88:91], v135 offset:0
    s_waitcnt lgkmcnt(8)
    v_mfma_f32_16x16x32_bf16 v[40:43], v[112:115], v[80:83], v[40:43]
    ds_read_b128 v[92:95], v135 offset:2048
    s_waitcnt lgkmcnt(8)
    v_mfma_f32_16x16x32_bf16 v[44:47], v[112:115], v[84:87], v[44:47]
    ds_read_b128 v[96:99], v135 offset:4096
    s_waitcnt lgkmcnt(7)
    v_mfma_f32_16x16x32_bf16 v[48:51], v[68:71], v[116:119], v[48:51]
    ds_read_b128 v[100:103], v135 offset:6144
    v_mfma_f32_16x16x32_bf16 v[52:55], v[72:75], v[116:119], v[52:55]
    ds_read_b128 v[104:107], v135 offset:8192
    v_mfma_f32_16x16x32_bf16 v[56:59], v[76:79], v[116:119], v[56:59]
    ds_read_b64_tr_b16 v[128:129], v136 offset:14336
    v_mfma_f32_16x16x32_bf16 v[60:63], v[80:83], v[116:119], v[60:63]
    ds_read_b64_tr_b16 v[130:131], v136 offset:14848
    v_mfma_f32_16x16x32_bf16 v[64:67], v[84:87], v[116:119], v[64:67]
    ds_read_b64_tr_b16 v[120:121], v136 offset:12288
    s_waitcnt lgkmcnt(10)
    v_mfma_f32_16x16x32_bf16 v[12:15], v[108:111], v[72:75], v[12:15]
    ds_read_b64_tr_b16 v[122:123], v136 offset:12800
    v_mfma_f32_16x16x32_bf16 v[16:19], v[108:111], v[76:79], v[16:19]
    ds_read_b64 v[6:7], v3 offset:384
    v_mfma_f32_16x16x32_bf16 v[20:23], v[108:111], v[80:83], v[20:23]
    v_mfma_f32_16x16x32_bf16 v[24:27], v[108:111], v[84:87], v[24:27]
    s_waitcnt lgkmcnt(0)
    v_mfma_f32_16x16x32_bf16 v[44:47], v[124:127], v[104:107], v[44:47]
    v_readfirstlane_b32 s90, v6
    v_readfirstlane_b32 s91, v7
    v_mfma_f32_16x16x32_bf16 v[24:27], v[120:123], v[104:107], v[24:27]
    v_mov_b64 v[70:71], 0
    v_mov_b64 v[74:75], 0
    v_mfma_f32_16x16x32_bf16 v[40:43], v[124:127], v[100:103], v[40:43]
    v_mov_b64 v[78:79], 0
    v_mov_b64 v[82:83], 0
    v_mfma_f32_16x16x32_bf16 v[20:23], v[120:123], v[100:103], v[20:23]
    v_mov_b32 v111, s33
    v_mov_b32 v115, s33
    v_mfma_f32_16x16x32_bf16 v[36:39], v[124:127], v[96:99], v[36:39]
    v_mov_b32 v119, s33
    v_mfma_f32_16x16x32_bf16 v[16:19], v[120:123], v[96:99], v[16:19]
    v_mfma_f32_16x16x32_bf16 v[32:35], v[124:127], v[92:95], v[32:35]
    v_mfma_f32_16x16x32_bf16 v[12:15], v[120:123], v[92:95], v[12:15]
    v_mfma_f32_16x16x32_bf16 v[28:31], v[124:127], v[88:91], v[28:31]
    s_branch L_gdone
L_padb8:
    s_branch L_padb16
L_gemm_40:
    s_barrier
    ds_read_b64_tr_b16 v[112:113], v136 offset:1024
    ds_read_b64_tr_b16 v[114:115], v136 offset:1536
    ds_read_b128 v[72:75], v134 offset:2048
    ds_read_b128 v[76:79], v134 offset:4096
    ds_read_b128 v[80:83], v134 offset:6144
    ds_read_b128 v[84:87], v134 offset:8192
    ds_read_b64_tr_b16 v[116:117], v136 offset:2048
    ds_read_b64_tr_b16 v[118:119], v136 offset:2560
    ds_read_b64_tr_b16 v[108:109], v136 offset:0
    ds_read_b64_tr_b16 v[110:111], v136 offset:512
L_gemm_4:
    s_waitcnt lgkmcnt(7)
    v_mfma_f32_16x16x32_bf16 v[32:35], v[112:115], v[72:75], v[32:35]
    s_setprio 1
    ds_read_b64_tr_b16 v[124:125], v136 offset:13312
    s_waitcnt lgkmcnt(7)
    v_mfma_f32_16x16x32_bf16 v[36:39], v[112:115], v[76:79], v[36:39]
    ds_read_b64_tr_b16 v[126:127], v136 offset:13824
    s_waitcnt lgkmcnt(7)
    v_mfma_f32_16x16x32_bf16 v[40:43], v[112:115], v[80:83], v[40:43]
    ds_read_b128 v[92:95], v135 offset:2048
    s_waitcnt lgkmcnt(7)
    v_mfma_f32_16x16x32_bf16 v[44:47], v[112:115], v[84:87], v[44:47]
    ds_read_b128 v[96:99], v135 offset:4096
    s_waitcnt lgkmcnt(6)
    v_mfma_f32_16x16x32_bf16 v[52:55], v[72:75], v[116:119], v[52:55]
    ds_read_b128 v[100:103], v135 offset:6144
    v_mfma_f32_16x16x32_bf16 v[56:59], v[76:79], v[116:119], v[56:59]
    ds_read_b128 v[104:107], v135 offset:8192
    v_mfma_f32_16x16x32_bf16 v[60:63], v[80:83], v[116:119], v[60:63]
    ds_read_b64_tr_b16 v[128:129], v136 offset:14336
    v_mfma_f32_16x16x32_bf16 v[64:67], v[84:87], v[116:119], v[64:67]
    ds_read_b64_tr_b16 v[130:131], v136 offset:14848
    s_waitcnt lgkmcnt(8)
    v_mfma_f32_16x16x32_bf16 v[12:15], v[108:111], v[72:75], v[12:15]
    ds_read_b64_tr_b16 v[120:121], v136 offset:12288
    v_mfma_f32_16x16x32_bf16 v[16:19], v[108:111], v[76:79], v[16:19]
    ds_read_b64_tr_b16 v[122:123], v136 offset:12800
    v_mfma_f32_16x16x32_bf16 v[20:23], v[108:111], v[80:83], v[20:23]
    v_mfma_f32_16x16x32_bf16 v[24:27], v[108:111], v[84:87], v[24:27]
    s_waitcnt lgkmcnt(7)
    v_mfma_f32_16x16x32_bf16 v[32:35], v[124:127], v[92:95], v[32:35]
    s_add_u32 s44, s44, 43008
    s_cmp_eq_u32 s44, 129024
    s_cselect_b32 s44, 0, s44
    v_add_u32 v134, s44, v132
    v_add_u32 v136, s44, v133
    s_waitcnt lgkmcnt(6)
    v_mfma_f32_16x16x32_bf16 v[36:39], v[124:127], v[96:99], v[36:39]
    s_waitcnt lgkmcnt(0)
    s_barrier
    s_setprio 2
    ds_read_b64_tr_b16 v[112:113], v136 offset:1024
    v_mfma_f32_16x16x32_bf16 v[40:43], v[124:127], v[100:103], v[40:43]
    ds_read_b64_tr_b16 v[114:115], v136 offset:1536
    v_mfma_f32_16x16x32_bf16 v[44:47], v[124:127], v[104:107], v[44:47]
    v_xor_b32 v135, 64, v134
    ds_read_b128 v[72:75], v134 offset:2048
    v_mfma_f32_16x16x32_bf16 v[52:55], v[92:95], v[128:131], v[52:55]
    ds_read_b128 v[76:79], v134 offset:4096
    v_mfma_f32_16x16x32_bf16 v[56:59], v[96:99], v[128:131], v[56:59]
    ds_read_b128 v[80:83], v134 offset:6144
    v_mfma_f32_16x16x32_bf16 v[60:63], v[100:103], v[128:131], v[60:63]
    ds_read_b128 v[84:87], v134 offset:8192
    v_mfma_f32_16x16x32_bf16 v[64:67], v[104:107], v[128:131], v[64:67]
    ds_read_b64_tr_b16 v[116:117], v136 offset:2048
    v_mfma_f32_16x16x32_bf16 v[12:15], v[120:123], v[92:95], v[12:15]
    ds_read_b64_tr_b16 v[118:119], v136 offset:2560
    v_mfma_f32_16x16x32_bf16 v[16:19], v[120:123], v[96:99], v[16:19]
    s_add_u32 s43, s43, 1
    ds_read_b64_tr_b16 v[108:109], v136 offset:0
    v_mfma_f32_16x16x32_bf16 v[20:23], v[120:123], v[100:103], v[20:23]
    s_cmp_lt_u32 s43, 9
    ds_read_b64_tr_b16 v[110:111], v136 offset:512
    v_mfma_f32_16x16x32_bf16 v[24:27], v[120:123], v[104:107], v[24:27]
    s_cbranch_scc1 L_gemm_4
    s_waitcnt lgkmcnt(7)
    v_mfma_f32_16x16x32_bf16 v[32:35], v[112:115], v[72:75], v[32:35]
    s_bitcmp1_b32 s45, 7
    s_setprio 3
    s_cbranch_scc1 Llp_32
    s_setprio 1
Llp_32:
    ds_read_b64_tr_b16 v[124:125], v136 offset:13312
    s_waitcnt lgkmcnt(7)
    v_mfma_f32_16x16x32_bf16 v[36:39], v[112:115], v[76:79], v[36:39]
    ds_read_b64_tr_b16 v[126:127], v136 offset:13824
    s_waitcnt lgkmcnt(7)
    v_mfma_f32_16x16x32_bf16 v[40:43], v[112:115], v[80:83], v[40:43]
    ds_read_b128 v[92:95], v135 offset:2048
    s_waitcnt lgkmcnt(7)
    v_mfma_f32_16x16x32_bf16 v[44:47], v[112:115], v[84:87], v[44:47]
    ds_read_b128 v[96:99], v135 offset:4096
    s_waitcnt lgkmcnt(6)
    v_mfma_f32_16x16x32_bf16 v[52:55], v[72:75], v[116:119], v[52:55]
    ds_read_b128 v[100:103], v135 offset:6144
    v_mfma_f32_16x16x32_bf16 v[56:59], v[76:79], v[116:119], v[56:59]
    ds_read_b128 v[104:107], v135 offset:8192
    v_mfma_f32_16x16x32_bf16 v[60:63], v[80:83], v[116:119], v[60:63]
    ds_read_b64_tr_b16 v[128:129], v136 offset:14336
    v_mfma_f32_16x16x32_bf16 v[64:67], v[84:87], v[116:119], v[64:67]
    ds_read_b64_tr_b16 v[130:131], v136 offset:14848
    s_waitcnt lgkmcnt(8)
    v_mfma_f32_16x16x32_bf16 v[12:15], v[108:111], v[72:75], v[12:15]
    ds_read_b64_tr_b16 v[120:121], v136 offset:12288
    v_mfma_f32_16x16x32_bf16 v[16:19], v[108:111], v[76:79], v[16:19]
    ds_read_b64_tr_b16 v[122:123], v136 offset:12800
    v_mfma_f32_16x16x32_bf16 v[20:23], v[108:111], v[80:83], v[20:23]
    ds_read_b64 v[6:7], v3 offset:384
    v_mfma_f32_16x16x32_bf16 v[24:27], v[108:111], v[84:87], v[24:27]
    s_waitcnt lgkmcnt(0)
    v_mfma_f32_16x16x32_bf16 v[44:47], v[124:127], v[104:107], v[44:47]
    v_readfirstlane_b32 s90, v6
    v_readfirstlane_b32 s91, v7
    v_mfma_f32_16x16x32_bf16 v[24:27], v[120:123], v[104:107], v[24:27]
    v_mov_b64 v[70:71], 0
    v_mov_b64 v[74:75], 0
    v_mfma_f32_16x16x32_bf16 v[40:43], v[124:127], v[100:103], v[40:43]
    v_mov_b64 v[78:79], 0
    v_mov_b64 v[82:83], 0
    v_mfma_f32_16x16x32_bf16 v[20:23], v[120:123], v[100:103], v[20:23]
    v_mov_b32 v111, s33
    v_mov_b32 v115, s33
    v_mfma_f32_16x16x32_bf16 v[36:39], v[124:127], v[96:99], v[36:39]
    v_mov_b32 v119, s33
    v_mfma_f32_16x16x32_bf16 v[16:19], v[120:123], v[96:99], v[16:19]
    v_mfma_f32_16x16x32_bf16 v[32:35], v[124:127], v[92:95], v[32:35]
    v_mfma_f32_16x16x32_bf16 v[12:15], v[120:123], v[92:95], v[12:15]
L_gdone:
    s_cmp_lg_u32 s90, s33
    s_cbranch_scc1 L_mslow
L_mback:
    s_cmp_eq_u32 s91, 1
    s_cselect_b32 s99, 0, 15728640
    s_add_u32 s16, s28, s99
    s_addc_u32 s17, s29, 0
    s_add_u32 s18, s16, 13107200
    s_addc_u32 s19, s17, 0
    s_cmp_eq_u32 s91, 1
    s_cselect_b64 s[18:19], s[24:25], s[18:19]
    s_bitcmp0_b32 s45, 7
    s_cbranch_scc1 L_full
    v_mov_b32 v5, 1
    v_cvt_pk_bf16_f32 v84, v44, v45
    v_cvt_pk_bf16_f32 v85, v46, v47
    ds_write_b64 v156, v[84:85] offset:6656
    ds_write_b32 v165, v5 offset:344
    v_cvt_pk_bf16_f32 v80, v40, v41
    s_branch L_skip2317
L_padb9:
    s_branch L_padb17
L_skip2317:
    v_cvt_pk_bf16_f32 v81, v42, v43
    v_cvt_pk_bf16_f32 v76, v36, v37
    v_cvt_pk_bf16_f32 v77, v38, v39
    v_cvt_pk_bf16_f32 v72, v32, v33
    v_cvt_pk_bf16_f32 v73, v34, v35
    s_mov_b32 s100, 0
    s_cmp_eq_u32 s42, 0
    s_cbranch_scc1 L_l_k0
    ds_read_b32 v4, v165 offset:340
    ds_read_b64 v[68:69], v156 offset:4608
    s_branch L_l_k1
L_l_k0:
    v_cvt_pk_bf16_f32 v68, v28, v29
    v_cvt_pk_bf16_f32 v69, v30, v31
    v_mov_b32 v4, 1
L_l_k1:
    s_mov_b64 exec, s[50:51]
    v_cvt_pk_bf16_f32 v82, v24, v25
    v_cvt_pk_bf16_f32 v83, v26, v27
    v_cvt_pk_bf16_f32 v78, v20, v21
    v_cvt_pk_bf16_f32 v79, v22, v23
    v_cvt_pk_bf16_f32 v74, v16, v17
    v_cvt_pk_bf16_f32 v75, v18, v19
    v_cvt_pk_bf16_f32 v70, v12, v13
    v_cvt_pk_bf16_f32 v71, v14, v15
    s_mov_b64 exec, -1
    v_mfma_f32_16x16x16_bf16 v[40:43], v[84:85], v[82:83], v[144:147]
    v_cvt_pk_bf16_f32 v24, v24, v25
    v_cvt_pk_bf16_f32 v25, v26, v27
    v_mfma_f32_16x16x16_bf16 v[124:127], v[80:81], v[82:83], v[148:151]
    v_mfma_f32_16x16x16_bf16 v[36:39], v[80:81], v[78:79], v[144:147]
    v_cvt_pk_bf16_f32 v20, v20, v21
    v_cvt_pk_bf16_f32 v21, v22, v23
    v_mfma_f32_16x16x16_bf16 v[120:123], v[76:77], v[78:79], v[148:151]
    v_mfma_f32_16x16x16_bf16 v[32:35], v[76:77], v[74:75], v[144:147]
    v_cvt_pk_bf16_f32 v16, v16, v17
    v_cvt_pk_bf16_f32 v17, v18, v19
    v_mfma_f32_16x16x16_bf16 v[8:11], v[72:73], v[74:75], v[148:151]
    v_mfma_f32_16x16x16_bf16 v[28:31], v[72:73], v[70:71], v[144:147]
    v_cvt_pk_bf16_f32 v12, v12, v13
    v_cvt_pk_bf16_f32 v13, v14, v15
L_l_kw:
    s_waitcnt lgkmcnt(0)
    v_readfirstlane_b32 s96, v4
    s_cmp_eq_u32 s96, 0
    s_cbranch_scc1 L_l_kslow
L_l_kok:
    v_mfma_f32_16x16x16_bf16 v[44:47], v[68:69], v[70:71], v[140:143]
    ds_write_b64 v156, v[80:81] offset:6144
    ds_write_b64 v156, v[24:25] offset:2048
    v_max3_f32 v110, v40, v41, v124
    v_max3_f32 v114, v42, v43, v126
    v_max_f32 v110, v110, v125
    v_max_f32 v114, v114, v127
    ds_write_b64 v156, v[76:77] offset:5632
    ds_write_b64 v156, v[20:21] offset:1536
    v_max3_f32 v116, v36, v37, v120
    v_max3_f32 v117, v38, v39, v122
    v_max_f32 v116, v116, v121
    v_max_f32 v117, v117, v123
    ds_write_b64 v156, v[72:73] offset:5120
    ds_write_b64 v156, v[16:17] offset:1024
    v_max3_f32 v112, v32, v33, v8
    v_max3_f32 v113, v34, v35, v10
    v_max_f32 v112, v112, v9
    v_max_f32 v113, v113, v11
    ds_write_b64 v156, v[68:69] offset:4608
    ds_write_b64 v156, v[12:13] offset:512
    ds_write_b32 v165, v5 offset:128
    v_max3_f32 v108, v28, v29, v44
    v_max3_f32 v109, v30, v31, v46
    v_max_f32 v108, v108, v45
    v_max_f32 v109, v109, v47
    s_cmp_lg_u32 s91, 1
    s_cbranch_scc1 Ldg_33
    global_store_dwordx4 v158, v[116:119], s[16:17] offset:2048
    global_store_dwordx4 v158, v[112:115], s[16:17] offset:1024
    global_store_dwordx4 v158, v[108:111], s[16:17] offset:0
    s_branch Ldd_34
Ldg_33:
    global_store_dwordx4 v158, v[116:119], s[16:17] offset:2048 sc1
    global_store_dwordx4 v158, v[112:115], s[16:17] offset:1024 sc1
    global_store_dwordx4 v158, v[108:111], s[16:17] offset:0 sc1
Ldd_34:
    s_setprio 1
    v_mfma_f32_16x16x32_bf16 v[64:67], v[104:107], v[128:131], v[64:67]
    v_mfma_f32_16x16x32_bf16 v[60:63], v[100:103], v[128:131], v[60:63]
    v_mfma_f32_16x16x32_bf16 v[56:59], v[96:99], v[128:131], v[56:59]
    v_mfma_f32_16x16x32_bf16 v[52:55], v[92:95], v[128:131], v[52:55]
    s_cmp_lg_u32 s42, 0
    s_cbranch_scc1 L_nv_l
    v_mfma_f32_16x16x32_bf16 v[48:51], v[88:91], v[128:131], v[48:51]
L_nv_l:
    s_nop 2
    v_cvt_pk_bf16_f32 v88, v64, v65
    v_cvt_pk_bf16_f32 v89, v66, v67
    s_waitcnt lgkmcnt(6)
    ds_write_b64 v156, v[88:89] offset:11264
    v_cvt_pk_bf16_f32 v90, v60, v61
    v_cvt_pk_bf16_f32 v91, v62, v63
    ds_write_b64 v156, v[90:91] offset:10752
    v_cvt_pk_bf16_f32 v92, v56, v57
    v_cvt_pk_bf16_f32 v93, v58, v59
    ds_write_b64 v156, v[92:93] offset:10240
    v_cvt_pk_bf16_f32 v94, v52, v53
    v_cvt_pk_bf16_f32 v95, v54, v55
    ds_write_b64 v156, v[94:95] offset:9728
    s_cmp_lg_u32 s42, 0
    s_cbranch_scc1 L_l_nv0
    v_cvt_pk_bf16_f32 v96, v48, v49
    v_cvt_pk_bf16_f32 v97, v50, v51
    ds_write_b64 v156, v[96:97] offset:9216
    ds_write_b32 v165, v5 offset:160
    s_branch L_l_v0
L_l_nv0:
    ds_write_b32 v165, v5 offset:160
    s_mov_b32 s100, 0
Lm_35:
    ds_read_b32 v4, v163
    s_waitcnt lgkmcnt(0)
    v_cmp_eq_u32 vcc, 0, v4
    s_and_b32 s99, vcc_lo, s49
    s_cbranch_scc0 Lmd_36
    s_add_u32 s100, s100, 1
    s_cmp_lt_u32 s100, 1048576
    s_cbranch_scc1 Lm_35
Lmd_36:
    ds_read_b64 v[96:97], v156 offset:9216
L_l_v0:
    s_setprio 0
    s_mov_b32 s100, 0
L_xp:
    global_load_dwordx4 v[28:31], v159, s[16:17] offset:0 sc1
    global_load_dwordx4 v[32:35], v159, s[16:17] offset:1024 sc1
    global_load_dwordx4 v[36:39], v159, s[16:17] offset:2048 sc1
    s_waitcnt vmcnt(0)
    v_cmp_ne_u32 vcc, s33, v31
    v_cmp_ne_u32 s[60:61], s33, v35
    v_cmp_ne_u32 s[62:63], s33, v39
    s_or_b64 vcc, vcc, s[60:61]
    s_or_b64 vcc, vcc, s[62:63]
    s_cbranch_scc0 L_xpd
    s_add_u32 s100, s100, 1
    s_cmp_lt_u32 s100, 1048576
    s_cbranch_scc1 L_xp
L_xpd:
    s_setprio 2
    v_pk_add_f32 v[68:69], v[108:109], v[28:29]
    v_pk_add_f32 v[70:71], v[112:113], v[32:33]
    v_pk_add_f32 v[72:73], v[116:117], v[36:37]
    v_add_f32 v74, v110, v30
    v_add_f32 v75, v114, v34
    s_branch L_soft
L_l_kslow:
    ds_read_b32 v4, v165 offset:340
    ds_read_b64 v[68:69], v156 offset:4608
    s_add_u32 s100, s100, 1
    s_cmp_lt_u32 s100, 1048576
    s_cbranch_scc1 L_l_kw
    s_waitcnt lgkmcnt(0)
    s_branch L_l_kok
L_padb10:
    s_branch L_padb18
L_mslow:
    s_lshl_b32 s98, s30, 5
    s_add_u32 s98, s98, s31
    s_lshl_b32 s98, s98, 8
    s_add_u32 s98, s98, 65536
    s_add_u32 s98, s98, 128
    s_mov_b32 s100, 0
Lc_37:
    s_load_dwordx4 s[88:91], s[28:29], s98 glc
    s_waitcnt lgkmcnt(0)
    s_cmp_eq_u32 s90, s33
    s_cbranch_scc1 Lcd_38
    s_sleep 2
    s_add_u32 s100, s100, 1
    s_cmp_lt_u32 s100, 1048576
    s_cbranch_scc1 Lc_37
    s_mov_b32 s91, 2
Lcd_38:
    s_branch L_mback
L_full:
    v_mfma_f32_16x16x32_bf16 v[64:67], v[104:107], v[128:131], v[64:67]
    v_mfma_f32_16x16x32_bf16 v[60:63], v[100:103], v[128:131], v[60:63]
    v_mfma_f32_16x16x32_bf16 v[56:59], v[96:99], v[128:131], v[56:59]
    v_mfma_f32_16x16x32_bf16 v[52:55], v[92:95], v[128:131], v[52:55]
    s_cmp_lg_u32 s42, 0
    s_cbranch_scc1 L_nv_f
    v_mfma_f32_16x16x32_bf16 v[48:51], v[88:91], v[128:131], v[48:51]
L_nv_f:
    s_setprio 2
    v_cvt_pk_bf16_f32 v124, v44, v45
    v_cvt_pk_bf16_f32 v125, v46, v47
    v_cvt_pk_bf16_f32 v120, v40, v41
    v_cvt_pk_bf16_f32 v121, v42, v43
    v_cvt_pk_bf16_f32 v116, v36, v37
    v_cvt_pk_bf16_f32 v117, v38, v39
    v_cvt_pk_bf16_f32 v112, v32, v33
    v_cvt_pk_bf16_f32 v113, v34, v35
    v_cvt_pk_bf16_f32 v68, v12, v13
    v_cvt_pk_bf16_f32 v69, v14, v15
    v_cvt_pk_bf16_f32 v72, v16, v17
    v_cvt_pk_bf16_f32 v73, v18, v19
    v_cvt_pk_bf16_f32 v76, v20, v21
    v_cvt_pk_bf16_f32 v77, v22, v23
    v_cvt_pk_bf16_f32 v80, v24, v25
    v_cvt_pk_bf16_f32 v81, v26, v27
    v_cvt_pk_bf16_f32 v88, v64, v65
    v_cvt_pk_bf16_f32 v89, v66, v67
    s_cmp_lg_u32 s42, 0
    s_cbranch_scc1 L_f_nb
    ds_write_b64 v164, v[124:125]
    ds_write_b64 v164, v[88:89] offset:512
    v_mov_b32 v5, 1
    ds_write_b32 v165, v5 offset:128
    v_cvt_pk_bf16_f32 v108, v28, v29
    v_cvt_pk_bf16_f32 v109, v30, v31
    v_cvt_pk_bf16_f32 v96, v48, v49
    v_cvt_pk_bf16_f32 v97, v50, v51
L_f_nb:
    v_cvt_pk_bf16_f32 v94, v52, v53
    v_cvt_pk_bf16_f32 v95, v54, v55
    v_cvt_pk_bf16_f32 v92, v56, v57
    v_cvt_pk_bf16_f32 v93, v58, v59
    v_cvt_pk_bf16_f32 v90, v60, v61
    v_cvt_pk_bf16_f32 v91, v62, v63
    s_mov_b32 s100, 0
Lm_39:
    ds_read_b32 v4, v163
    s_waitcnt lgkmcnt(0)
    v_cmp_eq_u32 vcc, 0, v4
    s_and_b32 s99, vcc_lo, s48
    s_cbranch_scc0 Lmd_40
    s_add_u32 s100, s100, 1
    s_cmp_lt_u32 s100, 1048576
    s_cbranch_scc1 Lm_39
Lmd_40:
    s_cmp_eq_u32 s42, 0
    s_cbranch_scc1 L_f_nr
    ds_read_b64 v[108:109], v164
    ds_read_b64 v[96:97], v164 offset:512
L_f_nr:
    s_mov_b64 exec, s[52:53]
    ds_read_b64 v[70:71], v156 offset:512
    ds_read_b64 v[74:75], v156 offset:1024
    ds_read_b64 v[78:79], v156 offset:1536
    ds_read_b64 v[82:83], v156 offset:2048
    s_mov_b64 exec, -1
    ds_read_b64 v[110:111], v156 offset:4608
    ds_read_b64 v[114:115], v156 offset:5120
    ds_read_b64 v[118:119], v156 offset:5632
    ds_read_b64 v[122:123], v156 offset:6144
    ds_read_b64 v[126:127], v156 offset:6656
    s_waitcnt lgkmcnt(3)
    v_mfma_f32_16x16x32_bf16 v[8:11], v[112:115], v[68:71], v[144:147]
    v_mfma_f32_16x16x32_bf16 v[24:27], v[108:111], v[68:71], v[140:143]
    s_waitcnt lgkmcnt(2)
    v_mfma_f32_16x16x32_bf16 v[12:15], v[116:119], v[72:75], v[144:147]
    v_mfma_f32_16x16x32_bf16 v[28:31], v[112:115], v[72:75], v[148:151]
    s_waitcnt lgkmcnt(1)
    v_mfma_f32_16x16x32_bf16 v[16:19], v[120:123], v[76:79], v[144:147]
    v_mfma_f32_16x16x32_bf16 v[32:35], v[116:119], v[76:79], v[148:151]
    s_waitcnt lgkmcnt(0)
    v_mfma_f32_16x16x32_bf16 v[20:23], v[124:127], v[80:83], v[144:147]
    v_mfma_f32_16x16x32_bf16 v[36:39], v[120:123], v[80:83], v[148:151]
    v_max3_f32 v68, v8, v9, v24
    v_max3_f32 v69, v10, v11, v26
    v_max_f32 v68, v68, v25
    v_max_f32 v69, v69, v27
    v_max3_f32 v70, v12, v13, v28
    v_max3_f32 v71, v14, v15, v30
    v_max_f32 v70, v70, v29
    v_max_f32 v71, v71, v31
    v_max3_f32 v72, v16, v17, v32
    v_max3_f32 v73, v18, v19, v34
    v_max_f32 v72, v72, v33
    v_max_f32 v73, v73, v35
    v_max3_f32 v74, v20, v21, v36
    v_max3_f32 v75, v22, v23, v38
    v_max_f32 v74, v74, v37
    v_max_f32 v75, v75, v39
L_soft:
    v_max_f32 v76, v68, v69
    v_max_f32 v77, v70, v71
    v_max_f32 v78, v72, v73
    v_max_f32 v79, v74, v75
    v_mov_b32 v84, 0x3f803f80
    v_permlane32_swap_b32 v76, v77
    v_permlane32_swap_b32 v78, v79
    v_max_f32 v76, v76, v77
    v_max_f32 v78, v78, v79
    v_mov_b32 v85, 0x3f803f80
    v_mov_b32 v86, 0x3f803f80
    v_permlane16_swap_b32 v76, v78
    v_max_f32 v76, v76, v78
    v_mul_f32 v78, s54, v76
    v_mul_f32 v76, s54, v76
    v_mov_b32 v87, 0x3f803f80
    v_mov_b32 v4, 1
    v_permlane16_swap_b32 v76, v78
    v_mov_b32 v77, v76
    v_mov_b32 v79, v78
    s_waitcnt lgkmcnt(0)
    v_permlane32_swap_b32 v76, v77
    v_permlane32_swap_b32 v78, v79
    v_fma_f32 v68, v68, s54, -v76
    v_fma_f32 v69, v69, s54, -v76
    v_fma_f32 v70, v70, s54, -v77
    v_fma_f32 v71, v71, s54, -v77
    v_fma_f32 v72, v72, s54, -v78
    v_fma_f32 v73, v73, s54, -v78
    v_fma_f32 v74, v74, s54, -v79
    v_fma_f32 v75, v75, s54, -v79
    s_bitcmp1_b32 s45, 7
    s_cbranch_scc1 L_novx
    ds_read_b32 v6, v163
    ds_read_b64 v[106:107], v162 offset:9216
    ds_read_b64 v[104:105], v162 offset:9728
    ds_read_b64 v[102:103], v162 offset:10240
    ds_read_b64 v[100:101], v162 offset:10752
    ds_read_b64 v[98:99], v162 offset:11264
L_novx:
    v_exp_f32 v68, v68
    v_exp_f32 v69, v69
    v_exp_f32 v70, v70
    v_exp_f32 v71, v71
    s_branch L_skip2642
L_padb11:
    s_branch L_warmed_b
L_skip2642:
    v_exp_f32 v72, v72
    v_exp_f32 v73, v73
    v_exp_f32 v74, v74
    v_exp_f32 v75, v75
    v_cvt_pk_bf16_f32 v80, v68, v69
    v_perm_b32 v108, v80, v80, v152
    v_perm_b32 v109, v80, v80, v153
    v_perm_b32 v110, v80, v80, v154
    v_perm_b32 v111, v80, v80, v155
    v_cvt_pk_bf16_f32 v81, v70, v71
    v_perm_b32 v112, v81, v81, v152
    v_perm_b32 v113, v81, v81, v153
    v_perm_b32 v114, v81, v81, v154
    v_perm_b32 v115, v81, v81, v155
    v_mfma_f32_16x16x32_bf16 v[24:27], v[84:87], v[108:111], 0
    v_mfma_f32_16x16x32_bf16 v[8:11], v[94:97], v[108:111], 0
    v_cvt_pk_bf16_f32 v82, v72, v73
    v_perm_b32 v116, v82, v82, v152
    v_perm_b32 v117, v82, v82, v153
    v_perm_b32 v118, v82, v82, v154
    v_perm_b32 v119, v82, v82, v155
    v_mfma_f32_16x16x32_bf16 v[28:31], v[84:87], v[112:115], 0
    v_mfma_f32_16x16x32_bf16 v[12:15], v[92:95], v[112:115], 0
    v_cvt_pk_bf16_f32 v83, v74, v75
    v_perm_b32 v120, v83, v83, v152
    v_perm_b32 v121, v83, v83, v153
    v_perm_b32 v122, v83, v83, v154
    v_perm_b32 v123, v83, v83, v155
    v_mfma_f32_16x16x32_bf16 v[32:35], v[84:87], v[116:119], 0
    v_mfma_f32_16x16x32_bf16 v[16:19], v[90:93], v[116:119], 0
    s_bitcmp1_b32 s45, 7
    v_mfma_f32_16x16x32_bf16 v[36:39], v[84:87], v[120:123], 0
    v_mfma_f32_16x16x32_bf16 v[20:23], v[88:91], v[120:123], 0
    s_cbranch_scc1 L_norem
    s_mov_b32 s100, 0
L_vxw:
    s_waitcnt lgkmcnt(0)
    v_cmp_eq_u32 vcc, 0, v6
    s_and_b32 s99, vcc_lo, s49
    s_cbranch_scc1 L_vxslow
L_vxok:
    v_mfma_f32_16x16x32_bf16 v[40:43], v[104:107], v[108:111], 0
    v_mfma_f32_16x16x32_bf16 v[44:47], v[102:105], v[112:115], 0
    v_mfma_f32_16x16x32_bf16 v[48:51], v[100:103], v[116:119], 0
    v_mfma_f32_16x16x32_bf16 v[52:55], v[98:101], v[120:123], 0
L_norem:
    s_mov_b64 exec, 1
    ds_add_u32 v3, v4 offset:196
    s_mov_b64 exec, -1
    v_rcp_f32 v24, v24
    v_rcp_f32 v28, v28
    v_rcp_f32 v32, v32
    v_rcp_f32 v36, v36
    v_pk_mul_f32 v[8:9], v[8:9], v[24:25] op_sel_hi:[1,0]
    v_pk_mul_f32 v[10:11], v[10:11], v[24:25] op_sel_hi:[1,0]
    v_pk_mul_f32 v[12:13], v[12:13], v[28:29] op_sel_hi:[1,0]
    v_pk_mul_f32 v[14:15], v[14:15], v[28:29] op_sel_hi:[1,0]
    v_pk_mul_f32 v[16:17], v[16:17], v[32:33] op_sel_hi:[1,0]
    v_pk_mul_f32 v[18:19], v[18:19], v[32:33] op_sel_hi:[1,0]
    v_pk_mul_f32 v[20:21], v[20:21], v[36:37] op_sel_hi:[1,0]
    v_pk_mul_f32 v[22:23], v[22:23], v[36:37] op_sel_hi:[1,0]
    v_cvt_pk_bf16_f32 v56, v8, v9
    v_cvt_pk_bf16_f32 v57, v10, v11
    v_cvt_pk_bf16_f32 v58, v12, v13
    v_cvt_pk_bf16_f32 v59, v14, v15
    v_cvt_pk_bf16_f32 v60, v16, v17
    v_cvt_pk_bf16_f32 v61, v18, v19
    v_cvt_pk_bf16_f32 v62, v20, v21
    v_cvt_pk_bf16_f32 v63, v22, v23
    s_mov_b64 exec, s[50:51]
    s_cmp_lg_u32 s91, 1
    s_cbranch_scc1 Ldg_41
    global_store_dwordx2 v160, v[56:57], s[18:19] offset:0
    global_store_dwordx2 v160, v[58:59], s[18:19] offset:1024
    global_store_dwordx2 v157, v[60:61], s[18:19] offset:0
    global_store_dwordx2 v157, v[62:63], s[18:19] offset:1024
    s_branch Ldd_42
Ldg_41:
    global_store_dwordx2 v160, v[56:57], s[18:19] offset:0 sc1
    global_store_dwordx2 v160, v[58:59], s[18:19] offset:1024 sc1
    global_store_dwordx2 v157, v[60:61], s[18:19] offset:0 sc1
    global_store_dwordx2 v157, v[62:63], s[18:19] offset:1024 sc1
Ldd_42:
    s_mov_b64 exec, -1
    s_bitcmp1_b32 s45, 7
    s_cbranch_scc1 L_norem2
    v_pk_mul_f32 v[64:65], v[40:41], v[24:25] op_sel_hi:[1,0]
    v_pk_mul_f32 v[66:67], v[42:43], v[24:25] op_sel_hi:[1,0]
    s_mov_b32 exec_lo, 0xffff0000
    v_pk_mul_f32 v[64:65], v[44:45], v[28:29] op_sel_hi:[1,0]
    v_pk_mul_f32 v[66:67], v[46:47], v[28:29] op_sel_hi:[1,0]
    s_mov_b32 exec_lo, 0
    v_pk_mul_f32 v[64:65], v[48:49], v[32:33] op_sel_hi:[1,0]
    v_pk_mul_f32 v[66:67], v[50:51], v[32:33] op_sel_hi:[1,0]
    s_mov_b32 exec_hi, 0xffff0000
    v_pk_mul_f32 v[64:65], v[52:53], v[36:37] op_sel_hi:[1,0]
    v_pk_mul_f32 v[66:67], v[54:55], v[36:37] op_sel_hi:[1,0]
    s_mov_b64 exec, -1
    v_cvt_pk_bf16_f32 v64, v64, v65
    v_cvt_pk_bf16_f32 v65, v66, v67
    s_cmp_lg_u32 s91, 1
    s_cbranch_scc1 Ldg_43
    global_store_dwordx2 v161, v[64:65], s[18:19]
    s_branch Ldd_44
Ldg_43:
    global_store_dwordx2 v161, v[64:65], s[18:19] sc1
Ldd_44:
L_norem2:
    v_mov_b32 v6, s55
    v_mov_b32 v5, s33
    s_mov_b64 exec, 1
    ds_add_u32 v3, v4 offset:268
    s_waitcnt vmcnt(0)
    s_cmp_lg_u32 s91, 1
    s_cbranch_scc1 Ldg_45
    global_store_dword v6, v5, s[16:17]
    s_branch Ldd_46
L_pada7:
    s_branch L_pada15
L_padb12:
    s_branch L_warmed_b
Ldg_45:
    global_store_dword v6, v5, s[16:17] sc1
Ldd_46:
    s_mov_b64 exec, -1
L_tail:
    s_lshl_b32 s96, s57, 2
    v_add_u32 v136, s96, v3
    s_add_u32 s62, s18, 8192
    s_addc_u32 s63, s19, 0
    s_add_u32 s64, s18, 16384
    s_addc_u32 s65, s19, 0
    s_setprio 2
    s_cmp_eq_u32 s57, 0
    s_cbranch_scc1 L_tp
    s_setprio 1
L_tp:
    v_mov_b32 v135, 0
    v_lshl_add_u32 v137, v0, 4, s84
    s_lshl_b32 s96, s56, 2
    v_add_u32 v160, s96, v3
    s_cmp_lg_u32 s34, 0
    s_cbranch_scc1 L_opa
    s_mov_b32 s100, 0
Lw_47:
    ds_read_b32 v4, v3 offset:268
    s_waitcnt lgkmcnt(0)
    v_readfirstlane_b32 s99, v4
    s_cmp_ge_u32 s99, 64
    s_cbranch_scc1 Lwd_48
    s_add_u32 s100, s100, 1
    s_cmp_lt_u32 s100, 1048576
    s_cbranch_scc1 Lw_47
Lwd_48:
    s_cmp_lg_u32 s57, 0
    s_cbranch_scc1 L_prep
L_opb:
    s_mov_b32 s100, 0
Lw_49:
    ds_read_b32 v4, v136 offset:200
    s_waitcnt lgkmcnt(0)
    v_readfirstlane_b32 s99, v4
    s_cmp_ge_u32 s99, 4
    s_cbranch_scc1 Lwd_50
    s_sleep 1
    s_add_u32 s100, s100, 1
    s_cmp_lt_u32 s100, 1048576
    s_cbranch_scc1 Lw_49
Lwd_50:
    ds_read_b128 v[68:71], v138 offset:0
    ds_read_b128 v[72:75], v138 offset:1024
    ds_read_b128 v[76:79], v138 offset:2048
    ds_read_b128 v[80:83], v138 offset:3072
    ds_read_b128 v[84:87], v138 offset:4096
    ds_read_b128 v[88:91], v138 offset:5120
    ds_read_b128 v[92:95], v138 offset:6144
    ds_read_b128 v[96:99], v138 offset:7168
    ds_read_b128 v[100:103], v138 offset:8192
    ds_read_b128 v[104:107], v138 offset:9216
    ds_read_b128 v[108:111], v138 offset:10240
    ds_read_b128 v[112:115], v138 offset:11264
    s_waitcnt lgkmcnt(8)
    ds_read_b128 v[116:119], v138 offset:12288
    ds_read_b128 v[120:123], v138 offset:13312
    ds_read_b128 v[124:127], v138 offset:14336
    ds_read_b128 v[128:131], v138 offset:15360
    s_cmp_eq_u32 s57, 0
    s_cbranch_scc1 L_opp
L_lgo:
    s_mov_b32 s100, 0
Lw_51:
    ds_read_b32 v4, v160 offset:216
    s_waitcnt lgkmcnt(0)
    v_readfirstlane_b32 s99, v4
    s_cmp_ge_u32 s99, 1
    s_cbranch_scc1 Lwd_52
    s_sleep 1
    s_add_u32 s100, s100, 1
    s_cmp_lt_u32 s100, 1048576
    s_cbranch_scc1 Lw_51
Lwd_52:
    s_branch L_late
L_opp:
    s_mov_b32 exec_hi, 0xfffff
    s_mov_b32 exec_lo, 0xfffff
    s_mov_b32 s100, 0
L_op:
    global_load_dword v4, v166, s[16:17] sc1
    s_waitcnt vmcnt(0)
    v_cmp_ne_u32 vcc, s33, v4
    s_cbranch_vccz L_opd
    s_add_u32 s100, s100, 1
    s_cmp_lt_u32 s100, 1048576
    s_cbranch_scc1 L_op
    s_branch L_opd
L_opa:
    s_cmp_eq_u32 s57, 0
    s_cbranch_scc1 L_opa1
    s_mov_b32 s100, 0
Lw_53:
    ds_read_b32 v4, v3 offset:376
    s_waitcnt lgkmcnt(0)
    v_readfirstlane_b32 s99, v4
    s_cmp_ge_u32 s99, 2
    s_cbranch_scc1 Lwd_54
    s_sleep 1
    s_add_u32 s100, s100, 1
    s_cmp_lt_u32 s100, 1048576
    s_cbranch_scc1 Lw_53
Lwd_54:
    s_setprio 3
    s_branch L_prep
L_pada8:
    s_branch L_pada16
L_padb13:
    s_branch L_warmed_b
L_opa1:
    s_mov_b32 s100, 0
Lw_55:
    ds_read_b32 v4, v3 offset:200
    s_waitcnt lgkmcnt(0)
    v_readfirstlane_b32 s99, v4
    s_cmp_ge_u32 s99, 4
    s_cbranch_scc1 Lwd_56
    s_sleep 1
    s_add_u32 s100, s100, 1
    s_cmp_lt_u32 s100, 1048576
    s_cbranch_scc1 Lw_55
Lwd_56:
    ds_read_b128 v[68:71], v138 offset:0
    ds_read_b128 v[72:75], v138 offset:1024
    ds_read_b128 v[76:79], v138 offset:2048
    ds_read_b128 v[80:83], v138 offset:3072
    ds_read_b128 v[84:87], v138 offset:4096
    ds_read_b128 v[88:91], v138 offset:5120
    ds_read_b128 v[92:95], v138 offset:6144
    ds_read_b128 v[96:99], v138 offset:7168
    ds_read_b128 v[100:103], v138 offset:8192
    ds_read_b128 v[104:107], v138 offset:9216
    ds_read_b128 v[108:111], v138 offset:10240
    ds_read_b128 v[112:115], v138 offset:11264
    s_waitcnt lgkmcnt(8)
    ds_read_b128 v[116:119], v138 offset:12288
    ds_read_b128 v[120:123], v138 offset:13312
    ds_read_b128 v[124:127], v138 offset:14336
    ds_read_b128 v[128:131], v138 offset:15360
    s_mov_b32 s100, 0
Lw_57:
    ds_read_b32 v4, v3 offset:276
    s_waitcnt lgkmcnt(0)
    v_readfirstlane_b32 s99, v4
    s_cmp_ge_u32 s99, 1
    s_cbranch_scc1 Lwd_58
    s_sleep 1
    s_add_u32 s100, s100, 1
    s_cmp_lt_u32 s100, 1048576
    s_cbranch_scc1 Lw_57
Lwd_58:
L_opd:
    s_mov_b64 exec, -1
    s_cmp_eq_u32 s57, 0
    s_cbranch_scc1 L_early
L_late:
    global_load_dwordx4 v[28:31], v139, s[18:19] offset:-4096 sc1
    global_load_dwordx4 v[32:35], v139, s[18:19] offset:-2048 sc1
    global_load_dwordx4 v[36:39], v139, s[18:19] offset:0 sc1
    global_load_dwordx4 v[40:43], v139, s[18:19] offset:2048 sc1
    global_load_dwordx4 v[44:47], v139, s[62:63] offset:-4096 sc1
    global_load_dwordx4 v[48:51], v139, s[62:63] offset:-2048 sc1
    global_load_dwordx4 v[52:55], v139, s[62:63] offset:0 sc1
    global_load_dwordx4 v[56:59], v139, s[62:63] offset:2048 sc1
    global_load_dwordx4 v[60:63], v139, s[64:65] offset:-4096 sc1
    global_load_dwordx4 v[64:67], v139, s[64:65] offset:-2048 sc1
    s_lshr_b32 s96, s56, 1
    s_lshl_b32 s96, s96, 7
    s_add_u32 s96, s96, 3072
    v_add_u32 v166, s96, v166
    v_mov_b32 v134, s33
    s_and_b32 s96, s56, 1
    s_lshl1_add_u32 s96, s96, s57
    s_lshl2_add_u32 s96, s36, s96
    s_lshl_b64 s[66:67], 1, s96
    s_cmp_eq_u32 s34, 0
    s_cbranch_scc1 L_nogq
    s_mov_b32 s100, 0
Lw_59:
    ds_read_b32 v4, v3 offset:204
    s_waitcnt lgkmcnt(0)
    v_readfirstlane_b32 s99, v4
    s_cmp_ge_u32 s99, 4
    s_cbranch_scc1 Lwd_60
    s_sleep 1
    s_add_u32 s100, s100, 1
    s_cmp_lt_u32 s100, 1048576
    s_cbranch_scc1 Lw_59
Lwd_60:
    ds_read_b128 v[68:71], v138 offset:0
    ds_read_b128 v[72:75], v138 offset:1024
    ds_read_b128 v[76:79], v138 offset:2048
    ds_read_b128 v[80:83], v138 offset:3072
    ds_read_b128 v[84:87], v138 offset:4096
    ds_read_b128 v[88:91], v138 offset:5120
    ds_read_b128 v[92:95], v138 offset:6144
    ds_read_b128 v[96:99], v138 offset:7168
    ds_read_b128 v[100:103], v138 offset:8192
    ds_read_b128 v[104:107], v138 offset:9216
    ds_read_b128 v[108:111], v138 offset:10240
    ds_read_b128 v[112:115], v138 offset:11264
    s_waitcnt lgkmcnt(8)
    ds_read_b128 v[116:119], v138 offset:12288
    ds_read_b128 v[120:123], v138 offset:13312
    ds_read_b128 v[124:127], v138 offset:14336
    ds_read_b128 v[128:131], v138 offset:15360
    s_branch L_nogq
L_pada9:
    s_branch L_pada17
L_padb14:
    s_branch L_warmed_b
    s_setprio 3
    s_waitcnt lgkmcnt(6)
L_prep:
    s_lshl_b32 s96, s56, 6
    s_add_u32 s96, s96, 161280
    v_lshl_add_u32 v164, v1, 2, s96
    v_mul_u32_u24 v161, 160, v1
    v_lshl_add_u32 v161, v2, 3, v161
    v_add_u32 v5, s81, v161
    s_mov_b32 s100, 0
Lw_61:
    ds_read_b32 v4, v3 offset:208
    s_waitcnt lgkmcnt(0)
    v_readfirstlane_b32 s99, v4
    s_cmp_ge_u32 s99, 1
    s_cbranch_scc1 Lwd_62
    s_add_u32 s100, s100, 1
    s_cmp_lt_u32 s100, 1048576
    s_cbranch_scc1 Lw_61
Lwd_62:
    ds_read2st64_b32 v[162:163], v164 offset0:0 offset1:1
    ds_read_b64 v[150:151], v5 offset:0
    ds_read_b64 v[152:153], v5 offset:32
    ds_read_b64 v[154:155], v5 offset:64
    ds_read_b64 v[156:157], v5 offset:96
    ds_read_b64 v[158:159], v5 offset:128
    v_add_u32 v161, s84, v161
    v_add_u32 v5, 0, v0
    v_mul_u32_u24 v165, 6554, v5
    v_lshrrev_b32 v165, 16, v165
    v_mul_u32_u24 v165, 1120, v165
    v_lshl_add_u32 v5, v5, 4, s85
    v_add_u32 v165, v165, v5
    v_add_u32 v5, 64, v0
    v_mul_u32_u24 v7, 6554, v5
    v_lshrrev_b32 v7, 16, v7
    v_mul_u32_u24 v7, 1120, v7
    v_lshl_add_u32 v5, v5, 4, s85
    v_add_u32 v7, v7, v5
    v_add_u32 v5, 128, v0
    v_mul_u32_u24 v135, 6554, v5
    v_lshrrev_b32 v135, 16, v135
    v_mul_u32_u24 v135, 1120, v135
    v_lshl_add_u32 v5, v5, 4, s85
    v_add_u32 v135, v135, v5
    v_bfe_u32 v5, v0, 3, 2
    v_xor_b32 v5, s56, v5
    v_lshlrev_b32 v5, 5, v5
    v_lshrrev_b32 v6, 2, v0
    v_lshl_add_u32 v5, v6, 7, v5
    v_and_b32 v6, 3, v0
    v_lshl_add_u32 v5, v6, 3, v5
    v_add_u32 v164, s93, v5
    s_waitcnt lgkmcnt(0)
    v_lshlrev_b32 v140, 16, v150
    v_and_b32 v141, 0xffff0000, v150
    v_lshlrev_b32 v142, 16, v151
    v_and_b32 v143, 0xffff0000, v151
    v_lshlrev_b32 v144, 16, v152
    v_and_b32 v145, 0xffff0000, v152
    v_lshlrev_b32 v146, 16, v153
    v_and_b32 v147, 0xffff0000, v153
    v_lshlrev_b32 v148, 16, v154
    v_and_b32 v149, 0xffff0000, v154
    v_lshlrev_b32 v150, 16, v155
    v_and_b32 v151, 0xffff0000, v155
    v_lshlrev_b32 v152, 16, v156
    v_and_b32 v153, 0xffff0000, v156
    v_lshlrev_b32 v154, 16, v157
    v_and_b32 v155, 0xffff0000, v157
    v_lshlrev_b32 v156, 16, v158
    v_and_b32 v157, 0xffff0000, v158
    v_lshlrev_b32 v158, 16, v159
    v_and_b32 v159, 0xffff0000, v159
    v_pk_mul_f32 v[140:141], v[140:141], v[162:163] op_sel:[0,1] op_sel_hi:[1,1]
    v_pk_mul_f32 v[142:143], v[142:143], v[162:163] op_sel:[0,1] op_sel_hi:[1,1]
    v_pk_mul_f32 v[144:145], v[144:145], v[162:163] op_sel:[0,1] op_sel_hi:[1,1]
    v_pk_mul_f32 v[146:147], v[146:147], v[162:163] op_sel:[0,1] op_sel_hi:[1,1]
    v_pk_mul_f32 v[148:149], v[148:149], v[162:163] op_sel:[0,1] op_sel_hi:[1,1]
    v_pk_mul_f32 v[150:151], v[150:151], v[162:163] op_sel:[0,1] op_sel_hi:[1,1]
    v_pk_mul_f32 v[152:153], v[152:153], v[162:163] op_sel:[0,1] op_sel_hi:[1,1]
    v_pk_mul_f32 v[154:155], v[154:155], v[162:163] op_sel:[0,1] op_sel_hi:[1,1]
    v_pk_mul_f32 v[156:157], v[156:157], v[162:163] op_sel:[0,1] op_sel_hi:[1,1]
    v_pk_mul_f32 v[158:159], v[158:159], v[162:163] op_sel:[0,1] op_sel_hi:[1,1]
    s_setprio 1
    s_cmp_eq_u32 s34, 0
    s_cbranch_scc1 L_opb
    s_branch L_lgo
L_pada10:
    s_branch L_pada18
L_padb15:
    s_branch L_warmed_b
L_nogq:
    s_waitcnt lgkmcnt(0)
    s_waitcnt vmcnt(9)
    v_mfma_f32_16x16x32_bf16 v[8:11], v[68:71], v[28:31], 0
    ds_read_b128 v[68:71], v138 offset:16384
    v_mfma_f32_16x16x32_bf16 v[12:15], v[72:75], v[28:31], 0
    ds_read_b128 v[72:75], v138 offset:17408
    v_mfma_f32_16x16x32_bf16 v[16:19], v[76:79], v[28:31], 0
    ds_read_b128 v[76:79], v138 offset:18432
    v_mfma_f32_16x16x32_bf16 v[20:23], v[80:83], v[28:31], 0
    ds_read_b128 v[80:83], v138 offset:19456
    v_mfma_f32_16x16x32_bf16 v[24:27], v[84:87], v[28:31], 0
    ds_read_b128 v[84:87], v138 offset:20480
    s_waitcnt vmcnt(8)
    v_mfma_f32_16x16x32_bf16 v[8:11], v[88:91], v[32:35], v[8:11]
    ds_read_b128 v[88:91], v138 offset:21504
    v_mfma_f32_16x16x32_bf16 v[12:15], v[92:95], v[32:35], v[12:15]
    ds_read_b128 v[92:95], v138 offset:22528
    v_mfma_f32_16x16x32_bf16 v[16:19], v[96:99], v[32:35], v[16:19]
    ds_read_b128 v[96:99], v138 offset:23552
    v_mfma_f32_16x16x32_bf16 v[20:23], v[100:103], v[32:35], v[20:23]
    ds_read_b128 v[100:103], v138 offset:24576
    v_mfma_f32_16x16x32_bf16 v[24:27], v[104:107], v[32:35], v[24:27]
    ds_read_b128 v[104:107], v138 offset:25600
    s_waitcnt vmcnt(7)
    v_mfma_f32_16x16x32_bf16 v[8:11], v[108:111], v[36:39], v[8:11]
    ds_read_b128 v[108:111], v138 offset:26624
    v_mfma_f32_16x16x32_bf16 v[12:15], v[112:115], v[36:39], v[12:15]
    ds_read_b128 v[112:115], v138 offset:27648
    v_mfma_f32_16x16x32_bf16 v[16:19], v[116:119], v[36:39], v[16:19]
    s_waitcnt lgkmcnt(10)
    ds_read_b128 v[116:119], v138 offset:28672
    v_mfma_f32_16x16x32_bf16 v[20:23], v[120:123], v[36:39], v[20:23]
    ds_read_b128 v[120:123], v138 offset:29696
    v_mfma_f32_16x16x32_bf16 v[24:27], v[124:127], v[36:39], v[24:27]
    s_waitcnt lgkmcnt(10)
    ds_read_b128 v[124:127], v138 offset:30720
    s_waitcnt vmcnt(6)
    v_mfma_f32_16x16x32_bf16 v[8:11], v[128:131], v[40:43], v[8:11]
    ds_read_b128 v[128:131], v138 offset:31744
    v_mfma_f32_16x16x32_bf16 v[12:15], v[68:71], v[40:43], v[12:15]
    s_waitcnt lgkmcnt(10)
    ds_read_b128 v[68:71], v138 offset:32768
    v_mfma_f32_16x16x32_bf16 v[16:19], v[72:75], v[40:43], v[16:19]
    ds_read_b128 v[72:75], v138 offset:33792
    v_mfma_f32_16x16x32_bf16 v[20:23], v[76:79], v[40:43], v[20:23]
    s_waitcnt lgkmcnt(10)
    ds_read_b128 v[76:79], v138 offset:34816
    v_mfma_f32_16x16x32_bf16 v[24:27], v[80:83], v[40:43], v[24:27]
    ds_read_b128 v[80:83], v138 offset:35840
    s_waitcnt vmcnt(5)
    v_mfma_f32_16x16x32_bf16 v[8:11], v[84:87], v[44:47], v[8:11]
    s_waitcnt lgkmcnt(10)
    ds_read_b128 v[84:87], v138 offset:36864
    v_mfma_f32_16x16x32_bf16 v[12:15], v[88:91], v[44:47], v[12:15]
    ds_read_b128 v[88:91], v138 offset:37888
    v_mfma_f32_16x16x32_bf16 v[16:19], v[92:95], v[44:47], v[16:19]
    s_waitcnt lgkmcnt(10)
    ds_read_b128 v[92:95], v138 offset:38912
    v_mfma_f32_16x16x32_bf16 v[20:23], v[96:99], v[44:47], v[20:23]
    ds_read_b128 v[96:99], v138 offset:39936
    v_mfma_f32_16x16x32_bf16 v[24:27], v[100:103], v[44:47], v[24:27]
    s_waitcnt lgkmcnt(10)
    ds_read_b128 v[100:103], v138 offset:40960
    s_waitcnt vmcnt(4)
    v_mfma_f32_16x16x32_bf16 v[8:11], v[104:107], v[48:51], v[8:11]
    ds_read_b128 v[104:107], v138 offset:41984
    v_mfma_f32_16x16x32_bf16 v[12:15], v[108:111], v[48:51], v[12:15]
    s_waitcnt lgkmcnt(10)
    ds_read_b128 v[108:111], v138 offset:43008
    v_mfma_f32_16x16x32_bf16 v[16:19], v[112:115], v[48:51], v[16:19]
    ds_read_b128 v[112:115], v138 offset:44032
    v_mfma_f32_16x16x32_bf16 v[20:23], v[116:119], v[48:51], v[20:23]
    s_waitcnt lgkmcnt(10)
    ds_read_b128 v[116:119], v138 offset:45056
    v_mfma_f32_16x16x32_bf16 v[24:27], v[120:123], v[48:51], v[24:27]
    ds_read_b128 v[120:123], v138 offset:46080
    s_waitcnt vmcnt(3)
    v_mfma_f32_16x16x32_bf16 v[8:11], v[124:127], v[52:55], v[8:11]
    s_waitcnt lgkmcnt(10)
    ds_read_b128 v[124:127], v138 offset:47104
    v_mfma_f32_16x16x32_bf16 v[12:15], v[128:131], v[52:55], v[12:15]
    ds_read_b128 v[128:131], v138 offset:48128
    v_mfma_f32_16x16x32_bf16 v[16:19], v[68:71], v[52:55], v[16:19]
    s_waitcnt lgkmcnt(10)
    ds_read_b128 v[68:71], v138 offset:49152
    v_mfma_f32_16x16x32_bf16 v[20:23], v[72:75], v[52:55], v[20:23]
    ds_read_b128 v[72:75], v138 offset:50176
    v_mfma_f32_16x16x32_bf16 v[24:27], v[76:79], v[52:55], v[24:27]
    s_waitcnt vmcnt(0)
    v_mfma_f32_16x16x32_bf16 v[8:11], v[80:83], v[56:59], v[8:11]
    s_mov_b64 exec, s[66:67]
    global_store_dword v166, v134, s[28:29]
    s_mov_b64 exec, -1
    v_mfma_f32_16x16x32_bf16 v[12:15], v[84:87], v[56:59], v[12:15]
    v_mfma_f32_16x16x32_bf16 v[16:19], v[88:91], v[56:59], v[16:19]
    s_waitcnt lgkmcnt(11)
    v_mfma_f32_16x16x32_bf16 v[20:23], v[92:95], v[56:59], v[20:23]
    s_waitcnt lgkmcnt(10)
    v_mfma_f32_16x16x32_bf16 v[24:27], v[96:99], v[56:59], v[24:27]
    s_waitcnt lgkmcnt(9)
    v_mfma_f32_16x16x32_bf16 v[8:11], v[100:103], v[60:63], v[8:11]
    s_waitcnt lgkmcnt(8)
    v_mfma_f32_16x16x32_bf16 v[12:15], v[104:107], v[60:63], v[12:15]
    s_waitcnt lgkmcnt(7)
    v_mfma_f32_16x16x32_bf16 v[16:19], v[108:111], v[60:63], v[16:19]
    s_waitcnt lgkmcnt(6)
    v_mfma_f32_16x16x32_bf16 v[20:23], v[112:115], v[60:63], v[20:23]
    s_waitcnt lgkmcnt(5)
    v_mfma_f32_16x16x32_bf16 v[24:27], v[116:119], v[60:63], v[24:27]
    s_waitcnt lgkmcnt(4)
    v_mfma_f32_16x16x32_bf16 v[8:11], v[120:123], v[64:67], v[8:11]
    s_waitcnt lgkmcnt(3)
    v_mfma_f32_16x16x32_bf16 v[12:15], v[124:127], v[64:67], v[12:15]
    s_waitcnt lgkmcnt(2)
    v_mfma_f32_16x16x32_bf16 v[16:19], v[128:131], v[64:67], v[16:19]
    s_waitcnt lgkmcnt(1)
    v_mfma_f32_16x16x32_bf16 v[20:23], v[68:71], v[64:67], v[20:23]
    s_waitcnt lgkmcnt(0)
    v_mfma_f32_16x16x32_bf16 v[24:27], v[72:75], v[64:67], v[24:27]
    s_cmp_lg_u32 s101, 0
    s_cbranch_scc1 L_cvl
L_cvdl:
    s_setprio 3
    s_mov_b32 s100, 0
L_fb:
    ds_read_b32 v4, v160 offset:232
    ds_read_b128 v[28:31], v137 offset:0
    ds_read_b128 v[32:35], v137 offset:1024
    ds_read_b128 v[36:39], v137 offset:2048
    ds_read_b128 v[40:43], v137 offset:3072
    ds_read_b128 v[44:47], v137 offset:4096
    ds_read_b32 v5, v3 offset:212
    ds_read_b64_tr_b16 v[48:49], v164 offset:0
    ds_read_b64_tr_b16 v[50:51], v164 offset:2048
    ds_read_b64_tr_b16 v[52:53], v164 offset:4096
    ds_read_b64_tr_b16 v[54:55], v164 offset:6144
    ds_read_b64_tr_b16 v[56:57], v164 offset:8192
    s_waitcnt lgkmcnt(11)
    v_readfirstlane_b32 s96, v4
    s_cmp_lg_u32 s96, 0
    s_cbranch_scc1 L_fp
    s_waitcnt lgkmcnt(0)
    s_add_u32 s100, s100, 1
    s_cmp_lt_u32 s100, 1048576
    s_branch L_skip3201
L_pada11:
    s_branch L_pada19
L_padb16:
    s_branch L_warmed_b
L_skip3201:
    s_cbranch_scc1 L_fb
L_fp:
    s_mov_b64 exec, 0xffffffff
    global_load_dword v6, v166, s[28:29] sc1
    s_mov_b64 exec, -1
    s_waitcnt lgkmcnt(10)
    v_pk_add_f32 v[28:29], v[28:29], v[8:9]
    v_pk_add_f32 v[30:31], v[30:31], v[10:11]
    s_waitcnt lgkmcnt(9)
    v_pk_add_f32 v[32:33], v[32:33], v[12:13]
    v_pk_add_f32 v[34:35], v[34:35], v[14:15]
    s_waitcnt lgkmcnt(8)
    v_pk_add_f32 v[36:37], v[36:37], v[16:17]
    v_pk_add_f32 v[38:39], v[38:39], v[18:19]
    s_waitcnt lgkmcnt(7)
    v_pk_add_f32 v[40:41], v[40:41], v[20:21]
    v_pk_add_f32 v[42:43], v[42:43], v[22:23]
    s_waitcnt lgkmcnt(6)
    v_pk_add_f32 v[44:45], v[44:45], v[24:25]
    v_pk_add_f32 v[46:47], v[46:47], v[26:27]
    v_pk_mul_f32 v[28:29], v[28:29], v[162:163] op_sel_hi:[1,0]
    v_pk_mul_f32 v[30:31], v[30:31], v[162:163] op_sel_hi:[1,0]
    v_pk_mul_f32 v[32:33], v[32:33], v[162:163] op_sel_hi:[1,0]
    v_pk_mul_f32 v[34:35], v[34:35], v[162:163] op_sel_hi:[1,0]
    v_pk_mul_f32 v[36:37], v[36:37], v[162:163] op_sel_hi:[1,0]
    v_pk_mul_f32 v[38:39], v[38:39], v[162:163] op_sel_hi:[1,0]
    v_pk_mul_f32 v[40:41], v[40:41], v[162:163] op_sel_hi:[1,0]
    v_pk_mul_f32 v[42:43], v[42:43], v[162:163] op_sel_hi:[1,0]
    v_pk_mul_f32 v[44:45], v[44:45], v[162:163] op_sel_hi:[1,0]
    v_pk_mul_f32 v[46:47], v[46:47], v[162:163] op_sel_hi:[1,0]
    s_mov_b32 s100, 0
L_fy:
    s_waitcnt lgkmcnt(5)
    v_readfirstlane_b32 s96, v5
    s_cmp_eq_u32 s96, 2
    s_cbranch_scc1 L_fin
    ds_read_b32 v5, v3 offset:212
    ds_read_b64_tr_b16 v[48:49], v164 offset:0
    ds_read_b64_tr_b16 v[50:51], v164 offset:2048
    ds_read_b64_tr_b16 v[52:53], v164 offset:4096
    ds_read_b64_tr_b16 v[54:55], v164 offset:6144
    ds_read_b64_tr_b16 v[56:57], v164 offset:8192
    s_add_u32 s100, s100, 1
    s_cmp_lt_u32 s100, 1048576
    s_cbranch_scc1 L_fy
L_fin:
    s_waitcnt lgkmcnt(4)
    v_lshlrev_b32 v60, 16, v48
    v_and_b32 v61, 0xffff0000, v48
    v_lshlrev_b32 v62, 16, v49
    v_and_b32 v63, 0xffff0000, v49
    v_pk_fma_f32 v[28:29], v[60:61], v[140:141], v[28:29]
    v_pk_fma_f32 v[30:31], v[62:63], v[142:143], v[30:31]
    v_cvt_pk_bf16_f32 v48, v28, v29
    v_cvt_pk_bf16_f32 v49, v30, v31
    ds_write_b64 v161, v[48:49] offset:0
    s_waitcnt lgkmcnt(4)
    v_lshlrev_b32 v60, 16, v50
    v_and_b32 v61, 0xffff0000, v50
    v_lshlrev_b32 v62, 16, v51
    v_and_b32 v63, 0xffff0000, v51
    v_pk_fma_f32 v[32:33], v[60:61], v[144:145], v[32:33]
    v_pk_fma_f32 v[34:35], v[62:63], v[146:147], v[34:35]
    v_cvt_pk_bf16_f32 v50, v32, v33
    v_cvt_pk_bf16_f32 v51, v34, v35
    ds_write_b64 v161, v[50:51] offset:32
    s_waitcnt lgkmcnt(4)
    v_lshlrev_b32 v60, 16, v52
    v_and_b32 v61, 0xffff0000, v52
    v_lshlrev_b32 v62, 16, v53
    v_and_b32 v63, 0xffff0000, v53
    v_pk_fma_f32 v[36:37], v[60:61], v[148:149], v[36:37]
    v_pk_fma_f32 v[38:39], v[62:63], v[150:151], v[38:39]
    v_cvt_pk_bf16_f32 v52, v36, v37
    v_cvt_pk_bf16_f32 v53, v38, v39
    ds_write_b64 v161, v[52:53] offset:64
    s_waitcnt lgkmcnt(4)
    v_lshlrev_b32 v60, 16, v54
    v_and_b32 v61, 0xffff0000, v54
    v_lshlrev_b32 v62, 16, v55
    v_and_b32 v63, 0xffff0000, v55
    v_pk_fma_f32 v[40:41], v[60:61], v[152:153], v[40:41]
    v_pk_fma_f32 v[42:43], v[62:63], v[154:155], v[42:43]
    v_cvt_pk_bf16_f32 v54, v40, v41
    v_cvt_pk_bf16_f32 v55, v42, v43
    ds_write_b64 v161, v[54:55] offset:96
    s_waitcnt lgkmcnt(4)
    v_lshlrev_b32 v60, 16, v56
    v_and_b32 v61, 0xffff0000, v56
    v_lshlrev_b32 v62, 16, v57
    v_and_b32 v63, 0xffff0000, v57
    v_pk_fma_f32 v[44:45], v[60:61], v[156:157], v[44:45]
    v_pk_fma_f32 v[46:47], v[62:63], v[158:159], v[46:47]
    v_cvt_pk_bf16_f32 v56, v44, v45
    v_cvt_pk_bf16_f32 v57, v46, v47
    ds_write_b64 v161, v[56:57] offset:128
    ds_read_b128 v[72:75], v137 offset:0
    ds_read_b128 v[76:79], v137 offset:1024
    ds_read_b128 v[80:83], v137 offset:2048
    s_mov_b32 s100, 0
    s_cmp_lg_u32 s91, 1
    s_cbranch_scc1 L_rdok
L_rdw:
    s_waitcnt vmcnt(0)
    v_cmp_ne_u32 vcc, s33, v6
    s_cmp_eq_u32 vcc_lo, 0
    s_cbranch_scc1 L_rdok
    s_mov_b64 exec, 0xffffffff
    global_load_dword v6, v166, s[28:29] sc1
    s_mov_b64 exec, -1
    s_add_u32 s100, s100, 1
    s_cmp_lt_u32 s100, 1048576
    s_cbranch_scc1 L_rdw
L_rdok:
    s_waitcnt lgkmcnt(2)
    global_store_dwordx4 v165, v[72:75], s[24:25]
    s_waitcnt lgkmcnt(1)
    global_store_dwordx4 v7, v[76:79], s[24:25]
    s_waitcnt lgkmcnt(0)
    s_mov_b64 exec, 0xffffffff
    global_store_dwordx4 v135, v[80:83], s[24:25]
    s_endpgm
L_vxslow:
    ds_read_b32 v6, v163
    ds_read_b64 v[106:107], v162 offset:9216
    ds_read_b64 v[104:105], v162 offset:9728
    ds_read_b64 v[102:103], v162 offset:10240
    ds_read_b64 v[100:101], v162 offset:10752
    ds_read_b64 v[98:99], v162 offset:11264
    s_add_u32 s100, s100, 1
    s_cmp_lt_u32 s100, 1048576
    s_cbranch_scc1 L_vxw
    s_waitcnt lgkmcnt(0)
    s_branch L_vxok
L_pada12:
    s_branch L_pada20
L_padb17:
    s_branch L_warmed_b
L_early:
    v_mov_b32 v5, 1
    global_load_dwordx4 v[28:31], v139, s[18:19] offset:-4096 sc1
    global_load_dwordx4 v[32:35], v139, s[18:19] offset:-2048 sc1
    global_load_dwordx4 v[36:39], v139, s[18:19] offset:0 sc1
    global_load_dwordx4 v[40:43], v139, s[18:19] offset:2048 sc1
    global_load_dwordx4 v[44:47], v139, s[62:63] offset:-4096 sc1
    global_load_dwordx4 v[48:51], v139, s[62:63] offset:-2048 sc1
    ds_write_b32 v160, v5 offset:216
    s_lshr_b32 s96, s56, 1
    s_lshl_b32 s96, s96, 7
    s_add_u32 s96, s96, 3072
    v_add_u32 v166, s96, v166
    v_mov_b32 v134, s33
    s_and_b32 s96, s56, 1
    s_lshl1_add_u32 s96, s96, s57
    s_lshl2_add_u32 s96, s36, s96
    s_lshl_b64 s[66:67], 1, s96
    s_waitcnt lgkmcnt(0)
    s_waitcnt vmcnt(5)
    v_mfma_f32_16x16x32_bf16 v[8:11], v[68:71], v[28:31], 0
    ds_read_b128 v[68:71], v138 offset:16384
    v_mfma_f32_16x16x32_bf16 v[12:15], v[72:75], v[28:31], 0
    global_load_dwordx4 v[52:55], v139, s[62:63] offset:0 sc1
    ds_read_b128 v[72:75], v138 offset:17408
    v_mfma_f32_16x16x32_bf16 v[16:19], v[76:79], v[28:31], 0
    ds_read_b128 v[76:79], v138 offset:18432
    v_mfma_f32_16x16x32_bf16 v[20:23], v[80:83], v[28:31], 0
    global_load_dwordx4 v[56:59], v139, s[62:63] offset:2048 sc1
    ds_read_b128 v[80:83], v138 offset:19456
    v_mfma_f32_16x16x32_bf16 v[24:27], v[84:87], v[28:31], 0
    ds_read_b128 v[84:87], v138 offset:20480
    s_waitcnt vmcnt(6)
    v_mfma_f32_16x16x32_bf16 v[8:11], v[88:91], v[32:35], v[8:11]
    ds_read_b128 v[88:91], v138 offset:21504
    v_mfma_f32_16x16x32_bf16 v[12:15], v[92:95], v[32:35], v[12:15]
    global_load_dwordx4 v[60:63], v139, s[64:65] offset:-4096 sc1
    ds_read_b128 v[92:95], v138 offset:22528
    v_mfma_f32_16x16x32_bf16 v[16:19], v[96:99], v[32:35], v[16:19]
    ds_read_b128 v[96:99], v138 offset:23552
    v_mfma_f32_16x16x32_bf16 v[20:23], v[100:103], v[32:35], v[20:23]
    global_load_dwordx4 v[64:67], v139, s[64:65] offset:-2048 sc1
    ds_read_b128 v[100:103], v138 offset:24576
    v_mfma_f32_16x16x32_bf16 v[24:27], v[104:107], v[32:35], v[24:27]
    ds_read_b128 v[104:107], v138 offset:25600
    s_waitcnt vmcnt(7)
    v_mfma_f32_16x16x32_bf16 v[8:11], v[108:111], v[36:39], v[8:11]
    ds_read_b128 v[108:111], v138 offset:26624
    v_mfma_f32_16x16x32_bf16 v[12:15], v[112:115], v[36:39], v[12:15]
    s_waitcnt lgkmcnt(9)
    ds_read_b128 v[112:115], v138 offset:27648
    v_mfma_f32_16x16x32_bf16 v[16:19], v[116:119], v[36:39], v[16:19]
    ds_read_b128 v[116:119], v138 offset:28672
    v_mfma_f32_16x16x32_bf16 v[20:23], v[120:123], v[36:39], v[20:23]
    s_waitcnt lgkmcnt(9)
    ds_read_b128 v[120:123], v138 offset:29696
    v_mfma_f32_16x16x32_bf16 v[24:27], v[124:127], v[36:39], v[24:27]
    ds_read_b128 v[124:127], v138 offset:30720
    s_waitcnt vmcnt(6)
    v_mfma_f32_16x16x32_bf16 v[8:11], v[128:131], v[40:43], v[8:11]
    s_waitcnt lgkmcnt(9)
    ds_read_b128 v[128:131], v138 offset:31744
    v_mfma_f32_16x16x32_bf16 v[12:15], v[68:71], v[40:43], v[12:15]
    ds_read_b128 v[68:71], v138 offset:32768
    v_mfma_f32_16x16x32_bf16 v[16:19], v[72:75], v[40:43], v[16:19]
    s_waitcnt lgkmcnt(9)
    ds_read_b128 v[72:75], v138 offset:33792
    v_mfma_f32_16x16x32_bf16 v[20:23], v[76:79], v[40:43], v[20:23]
    ds_read_b128 v[76:79], v138 offset:34816
    v_mfma_f32_16x16x32_bf16 v[24:27], v[80:83], v[40:43], v[24:27]
    s_waitcnt lgkmcnt(9)
    ds_read_b128 v[80:83], v138 offset:35840
    s_waitcnt vmcnt(5)
    v_mfma_f32_16x16x32_bf16 v[8:11], v[84:87], v[44:47], v[8:11]
    ds_read_b128 v[84:87], v138 offset:36864
    v_mfma_f32_16x16x32_bf16 v[12:15], v[88:91], v[44:47], v[12:15]
    s_waitcnt lgkmcnt(9)
    ds_read_b128 v[88:91], v138 offset:37888
    v_mfma_f32_16x16x32_bf16 v[16:19], v[92:95], v[44:47], v[16:19]
    ds_read_b128 v[92:95], v138 offset:38912
    v_mfma_f32_16x16x32_bf16 v[20:23], v[96:99], v[44:47], v[20:23]
    s_waitcnt lgkmcnt(9)
    ds_read_b128 v[96:99], v138 offset:39936
    v_mfma_f32_16x16x32_bf16 v[24:27], v[100:103], v[44:47], v[24:27]
    ds_read_b128 v[100:103], v138 offset:40960
    s_waitcnt vmcnt(4)
    v_mfma_f32_16x16x32_bf16 v[8:11], v[104:107], v[48:51], v[8:11]
    s_waitcnt lgkmcnt(9)
    ds_read_b128 v[104:107], v138 offset:41984
    v_mfma_f32_16x16x32_bf16 v[12:15], v[108:111], v[48:51], v[12:15]
    ds_read_b128 v[108:111], v138 offset:43008
    v_mfma_f32_16x16x32_bf16 v[16:19], v[112:115], v[48:51], v[16:19]
    s_waitcnt lgkmcnt(9)
    ds_read_b128 v[112:115], v138 offset:44032
    v_mfma_f32_16x16x32_bf16 v[20:23], v[116:119], v[48:51], v[20:23]
    ds_read_b128 v[116:119], v138 offset:45056
    v_mfma_f32_16x16x32_bf16 v[24:27], v[120:123], v[48:51], v[24:27]
    s_waitcnt lgkmcnt(9)
    ds_read_b128 v[120:123], v138 offset:46080
    s_waitcnt vmcnt(3)
    v_mfma_f32_16x16x32_bf16 v[8:11], v[124:127], v[52:55], v[8:11]
    ds_read_b128 v[124:127], v138 offset:47104
    v_mfma_f32_16x16x32_bf16 v[12:15], v[128:131], v[52:55], v[12:15]
    s_waitcnt lgkmcnt(9)
    ds_read_b128 v[128:131], v138 offset:48128
    v_mfma_f32_16x16x32_bf16 v[16:19], v[68:71], v[52:55], v[16:19]
    ds_read_b128 v[68:71], v138 offset:49152
    v_mfma_f32_16x16x32_bf16 v[20:23], v[72:75], v[52:55], v[20:23]
    s_waitcnt lgkmcnt(9)
    ds_read_b128 v[72:75], v138 offset:50176
    v_mfma_f32_16x16x32_bf16 v[24:27], v[76:79], v[52:55], v[24:27]
    s_waitcnt vmcnt(0)
    v_mfma_f32_16x16x32_bf16 v[8:11], v[80:83], v[56:59], v[8:11]
    s_mov_b64 exec, s[66:67]
    global_store_dword v166, v134, s[28:29]
    s_mov_b64 exec, -1
    v_mfma_f32_16x16x32_bf16 v[12:15], v[84:87], v[56:59], v[12:15]
    v_mfma_f32_16x16x32_bf16 v[16:19], v[88:91], v[56:59], v[16:19]
    v_mfma_f32_16x16x32_bf16 v[20:23], v[92:95], v[56:59], v[20:23]
    v_mfma_f32_16x16x32_bf16 v[24:27], v[96:99], v[56:59], v[24:27]
    s_waitcnt lgkmcnt(9)
    v_mfma_f32_16x16x32_bf16 v[8:11], v[100:103], v[60:63], v[8:11]
    s_waitcnt lgkmcnt(8)
    v_mfma_f32_16x16x32_bf16 v[12:15], v[104:107], v[60:63], v[12:15]
    s_waitcnt lgkmcnt(7)
    v_mfma_f32_16x16x32_bf16 v[16:19], v[108:111], v[60:63], v[16:19]
    s_waitcnt lgkmcnt(6)
    v_mfma_f32_16x16x32_bf16 v[20:23], v[112:115], v[60:63], v[20:23]
    s_waitcnt lgkmcnt(5)
    v_mfma_f32_16x16x32_bf16 v[24:27], v[116:119], v[60:63], v[24:27]
    s_waitcnt lgkmcnt(4)
    v_mfma_f32_16x16x32_bf16 v[8:11], v[120:123], v[64:67], v[8:11]
    s_waitcnt lgkmcnt(3)
    v_mfma_f32_16x16x32_bf16 v[12:15], v[124:127], v[64:67], v[12:15]
    s_waitcnt lgkmcnt(2)
    v_mfma_f32_16x16x32_bf16 v[16:19], v[128:131], v[64:67], v[16:19]
    s_waitcnt lgkmcnt(1)
    v_mfma_f32_16x16x32_bf16 v[20:23], v[68:71], v[64:67], v[20:23]
    s_waitcnt lgkmcnt(0)
    v_mfma_f32_16x16x32_bf16 v[24:27], v[72:75], v[64:67], v[24:27]
    s_setprio 0
    s_mov_b32 s100, 0
Lw_63:
    ds_read_b32 v4, v3 offset:196
    s_branch L_skip3479
L_pada13:
    s_branch L_warmed_a
L_padb18:
    s_branch L_warmed_b
L_skip3479:
    s_waitcnt lgkmcnt(0)
    v_readfirstlane_b32 s99, v4
    s_cmp_ge_u32 s99, 8
    s_cbranch_scc1 Lwd_64
    s_add_u32 s100, s100, 1
    s_cmp_lt_u32 s100, 1048576
    s_cbranch_scc1 Lw_63
Lwd_64:
    ds_write_b128 v137, v[8:11] offset:0
    ds_write_b128 v137, v[12:15] offset:1024
    ds_write_b128 v137, v[16:19] offset:2048
    ds_write_b128 v137, v[20:23] offset:3072
    ds_write_b128 v137, v[24:27] offset:4096
    v_mov_b32 v4, 2
    ds_write_b32 v160, v4 offset:232
    s_cmp_lg_u32 s101, 0
    s_cbranch_scc1 L_cve
L_cvde:
    s_endpgm
L_cvl:
    s_cmp_ge_u32 s31, 26
    s_cselect_b32 s96, 8, 0
    s_lshl_b32 s97, s30, 8
    s_add_u32 s96, s96, s97
    s_add_u32 s96, s96, 65536
    s_and_b32 s98, s33, 0xffffff00
    s_mov_b64 exec, 0xffffffff
    s_mov_b32 s100, 0
L_cwl:
    v_subrev_u32 v132, s98, v133
    v_cmp_le_u32 vcc, 0x600, v132
    s_cbranch_vccz L_cxl
    s_mov_b64 exec, vcc
    v_lshlrev_b32 v68, 2, v0
    v_add_u32 v68, 161792, v68
    ds_read_b32 v70, v68
    v_mov_b32 v71, 0x100
    v_lshl_add_u32 v68, v0, 11, s96
    s_sleep 8
    s_waitcnt lgkmcnt(0)
    global_atomic_add_x2 v[132:133], v68, v[70:71], s[28:29] sc0 sc1
    s_waitcnt vmcnt(0)
    s_add_u32 s100, s100, 1
    s_cmp_lt_u32 s100, 1048576
    s_cbranch_scc1 L_cwl
L_cxl:
    s_mov_b64 exec, -1
    s_branch L_cvdl
L_cve:
    s_cmp_ge_u32 s31, 26
    s_cselect_b32 s96, 8, 0
    s_lshl_b32 s97, s30, 8
    s_add_u32 s96, s96, s97
    s_add_u32 s96, s96, 65536
    s_and_b32 s98, s33, 0xffffff00
    s_mov_b64 exec, 0xffffffff
    s_mov_b32 s100, 0
L_cwe:
    v_subrev_u32 v132, s98, v133
    v_cmp_le_u32 vcc, 0x600, v132
    s_cbranch_vccz L_cxe
    s_mov_b64 exec, vcc
    v_lshlrev_b32 v68, 2, v0
    v_add_u32 v68, 161792, v68
    ds_read_b32 v70, v68
    v_mov_b32 v71, 0x100
    v_lshl_add_u32 v68, v0, 11, s96
    s_sleep 8
    s_waitcnt lgkmcnt(0)
    global_atomic_add_x2 v[132:133], v68, v[70:71], s[28:29] sc0 sc1
    s_waitcnt vmcnt(0)
    s_add_u32 s100, s100, 1
    s_cmp_lt_u32 s100, 1048576
    s_cbranch_scc1 L_cwe
L_cxe:
    s_mov_b64 exec, -1
    s_branch L_cvde
L_awave:
    s_sub_u32 s65, s32, 4
    s_cmp_lt_u32 s38, 5
    s_cbranch_scc1 L_nopack
    s_lshl1_add_u32 s40, s30, s38
    s_sub_u32 s40, s40, 5
    s_lshl4_add_u32 s40, s65, s40
    s_mov_b32 s58, 0
    s_cmp_ge_u32 s40, 100
    s_cbranch_scc1 L_packed
    s_mul_i32 s41, s40, 205
    s_lshr_b32 s41, s41, 11
    s_mul_i32 s42, s41, 10
    s_sub_u32 s42, s40, s42
    v_lshrrev_b32 v4, 3, v0
    v_mul_u32_u24 v4, 1280, v4
    v_and_b32 v5, 7, v0
    v_lshl_add_u32 v4, v5, 4, v4
    s_mul_i32 s43, s41, 81920
    s_lshl_b32 s96, s42, 7
    s_add_u32 s43, s43, s96
    s_lshl_b32 s44, s65, 13
    s_add_u32 s44, s44, 90496
    s_mov_b32 m0, s44
    s_waitcnt lgkmcnt(0)
    s_mov_b32 s48, s20
    s_and_b32 s49, s21, 0xffff
    s_mov_b32 s50, 819200
    s_mov_b32 s51, 0x00020000
    buffer_load_dwordx4 v4, s[48:51], s43 offen lds
    s_add_u32 m0, m0, 1024
    s_add_u32 s43, s43, 10240
    buffer_load_dwordx4 v4, s[48:51], s43 offen lds
    s_add_u32 m0, m0, 1024
    s_add_u32 s43, s43, 10240
    buffer_load_dwordx4 v4, s[48:51], s43 offen lds
    s_add_u32 m0, m0, 1024
    s_add_u32 s43, s43, 10240
    buffer_load_dwordx4 v4, s[48:51], s43 offen lds
    s_add_u32 m0, m0, 1024
    s_add_u32 s43, s43, 10240
    buffer_load_dwordx4 v4, s[48:51], s43 offen lds
    s_add_u32 m0, m0, 1024
    s_add_u32 s43, s43, 10240
    buffer_load_dwordx4 v4, s[48:51], s43 offen lds
    s_add_u32 m0, m0, 1024
    s_add_u32 s43, s43, 10240
    buffer_load_dwordx4 v4, s[48:51], s43 offen lds
    s_add_u32 m0, m0, 1024
    s_add_u32 s43, s43, 10240
    buffer_load_dwordx4 v4, s[48:51], s43 offen lds
    s_sub_u32 s45, s41, 5
    s_cselect_b32 s45, s41, s45
    s_mov_b32 s46, 0xf9af5600
    s_cmp_eq_u32 s45, 1
    s_cselect_b32 s46, 0xfeab5500, s46
    s_cmp_eq_u32 s45, 2
    s_cselect_b32 s46, 0xffaa5500, s46
    s_cmp_eq_u32 s45, 3
    s_cselect_b32 s46, 0xffaa1540, s46
    s_cmp_eq_u32 s45, 4
    s_cselect_b32 s46, 0xff6a0590, s46
    v_lshrrev_b32 v4, 2, v0
    v_and_b32 v5, 3, v0
    v_lshlrev_b32 v5, 3, v5
    v_lshl_add_u32 v4, v4, 7, v5
    v_add_u32 v4, s44, v4
    v_lshlrev_b32 v5, 1, v2
    v_bfe_u32 v8, s46, v5, 2
    v_lshl_add_u32 v8, v8, 11, v4
    s_lshr_b32 s46, s46, 8
    v_bfe_u32 v9, s46, v5, 2
    v_lshl_add_u32 v9, v9, 11, v4
    s_lshr_b32 s46, s46, 8
    v_bfe_u32 v10, s46, v5, 2
    v_lshl_add_u32 v10, v10, 11, v4
    s_lshr_b32 s46, s46, 8
    v_bfe_u32 v11, s46, v5, 2
    v_lshl_add_u32 v11, v11, 11, v4
    s_mul_i32 s41, s41, 5120
    s_add_u32 s41, s41, 9437184
    s_lshl2_add_u32 s96, s42, 0
    s_mul_i32 s97, s96, 205
    s_lshr_b32 s97, s97, 10
    s_mul_i32 s97, s97, 97280
    s_lshl_b32 s96, s96, 10
    s_add_u32 s96, s96, s97
    s_add_u32 s96, s96, s41
    v_lshl_add_u32 v12, v0, 4, s96
    s_lshl2_add_u32 s96, s42, 1
    s_mul_i32 s97, s96, 205
    s_lshr_b32 s97, s97, 10
    s_mul_i32 s97, s97, 97280
    s_lshl_b32 s96, s96, 10
    s_add_u32 s96, s96, s97
    s_add_u32 s96, s96, s41
    v_lshl_add_u32 v13, v0, 4, s96
    s_lshl2_add_u32 s96, s42, 2
    s_mul_i32 s97, s96, 205
    s_lshr_b32 s97, s97, 10
    s_mul_i32 s97, s97, 97280
    s_lshl_b32 s96, s96, 10
    s_add_u32 s96, s96, s97
    s_add_u32 s96, s96, s41
    v_lshl_add_u32 v14, v0, 4, s96
    s_lshl2_add_u32 s96, s42, 3
    s_mul_i32 s97, s96, 205
    s_lshr_b32 s97, s97, 10
    s_mul_i32 s97, s97, 97280
    s_lshl_b32 s96, s96, 10
    s_add_u32 s96, s96, s97
    s_add_u32 s96, s96, s41
    v_lshl_add_u32 v15, v0, 4, s96
    s_add_u32 s44, s28, 51200
    s_addc_u32 s45, s29, 0
    s_waitcnt vmcnt(0)
    ds_read_b64_tr_b16 v[48:49], v9 offset:0
    ds_read_b64_tr_b16 v[50:51], v10 offset:0
    ds_read_b64_tr_b16 v[52:53], v9 offset:32
    ds_read_b64_tr_b16 v[54:55], v10 offset:32
    ds_read_b64_tr_b16 v[56:57], v9 offset:64
    ds_read_b64_tr_b16 v[58:59], v10 offset:64
    ds_read_b64_tr_b16 v[60:61], v9 offset:96
    ds_read_b64_tr_b16 v[62:63], v10 offset:96
    s_waitcnt lgkmcnt(4)
    ds_read_b64_tr_b16 v[64:65], v8 offset:0
    ds_read_b64_tr_b16 v[66:67], v11 offset:0
    ds_read_b64_tr_b16 v[68:69], v8 offset:32
    ds_read_b64_tr_b16 v[70:71], v11 offset:32
    ds_read_b64_tr_b16 v[72:73], v8 offset:64
    ds_read_b64_tr_b16 v[74:75], v11 offset:64
    ds_read_b64_tr_b16 v[76:77], v8 offset:96
    ds_read_b64_tr_b16 v[78:79], v11 offset:96
    s_waitcnt lgkmcnt(0)
    global_store_dwordx4 v12, v[48:51], s[28:29] sc1
    global_store_dwordx4 v13, v[52:55], s[28:29] sc1
    global_store_dwordx4 v14, v[56:59], s[28:29] sc1
    global_store_dwordx4 v15, v[60:63], s[28:29] sc1
    global_store_dwordx4 v12, v[64:67], s[44:45] sc1
    global_store_dwordx4 v13, v[68:71], s[44:45] sc1
    global_store_dwordx4 v14, v[72:75], s[44:45] sc1
    global_store_dwordx4 v15, v[76:79], s[44:45] sc1
L_packed:
    s_waitcnt lgkmcnt(0)
    s_branch L_notap
L_nopack:
    s_min_u32 s99, s38, 4
    s_lshl3_add_u32 s58, s99, s65
    s_lshl_b32 s96, s58, 7
    s_add_u32 s97, s96, 64
    v_sub_u32 v4, v1, v2
    v_and_b32 v4, 3, v4
    v_and_or_b32 v4, v1, 12, v4
    v_lshrrev_b32 v5, 1, v4
    v_lshlrev_b32 v4, 4, v4
    s_waitcnt lgkmcnt(0)
    s_load_dwordx16 s[40:55], s[10:11], s96
    s_load_dwordx16 s[76:91], s[10:11], s97
    s_setprio 2
    s_waitcnt lgkmcnt(0)
    v_cmp_eq_u32 vcc, 0, v5
    s_mov_b64 exec, vcc
    v_bfe_u32 v42, s40, v4, 16
    v_bfe_u32 v43, s48, v4, 16
    v_bfe_u32 v44, s76, v4, 16
    v_bfe_u32 v45, s84, v4, 16
    s_mov_b64 exec, -1
    v_cmp_eq_u32 vcc, 1, v5
    s_mov_b64 exec, vcc
    v_bfe_u32 v42, s41, v4, 16
    v_bfe_u32 v43, s49, v4, 16
    v_bfe_u32 v44, s77, v4, 16
    v_bfe_u32 v45, s85, v4, 16
    s_mov_b64 exec, -1
    v_cmp_eq_u32 vcc, 2, v5
    s_mov_b64 exec, vcc
    v_bfe_u32 v42, s42, v4, 16
    v_bfe_u32 v43, s50, v4, 16
    v_bfe_u32 v44, s78, v4, 16
    v_bfe_u32 v45, s86, v4, 16
    s_mov_b64 exec, -1
    v_cmp_eq_u32 vcc, 3, v5
    s_mov_b64 exec, vcc
    v_bfe_u32 v42, s43, v4, 16
    v_bfe_u32 v43, s51, v4, 16
    v_bfe_u32 v44, s79, v4, 16
    v_bfe_u32 v45, s87, v4, 16
    s_mov_b64 exec, -1
    v_cmp_eq_u32 vcc, 4, v5
    s_mov_b64 exec, vcc
    v_bfe_u32 v42, s44, v4, 16
    v_bfe_u32 v43, s52, v4, 16
    v_bfe_u32 v44, s80, v4, 16
    v_bfe_u32 v45, s88, v4, 16
    s_mov_b64 exec, -1
    v_cmp_eq_u32 vcc, 5, v5
    s_mov_b64 exec, vcc
    v_bfe_u32 v42, s45, v4, 16
    v_bfe_u32 v43, s53, v4, 16
    v_bfe_u32 v44, s81, v4, 16
    v_bfe_u32 v45, s89, v4, 16
    s_mov_b64 exec, -1
    v_cmp_eq_u32 vcc, 6, v5
    s_mov_b64 exec, vcc
    v_bfe_u32 v42, s46, v4, 16
    v_bfe_u32 v43, s54, v4, 16
    v_bfe_u32 v44, s82, v4, 16
    v_bfe_u32 v45, s90, v4, 16
    s_mov_b64 exec, -1
    v_cmp_eq_u32 vcc, 7, v5
    s_mov_b64 exec, vcc
    v_bfe_u32 v42, s47, v4, 16
    v_bfe_u32 v43, s55, v4, 16
    v_bfe_u32 v44, s83, v4, 16
    v_bfe_u32 v45, s91, v4, 16
    s_mov_b64 exec, -1
L_notap:
    s_load_dword s33, s[28:29], 0
    s_setprio 2
    s_and_b32 s56, s65, 3
    s_lshr_b32 s57, s65, 2
    s_sub_u32 s96, s31, 20
    s_mul_i32 s97, s96, 43
    s_lshr_b32 s97, s97, 7
    s_mul_i32 s41, s96, 7
    s_sub_u32 s41, s41, s97
    s_mul_i32 s97, s97, 3
    s_sub_u32 s97, s96, s97
    s_cmp_eq_u32 s97, 2
    s_cselect_b32 s64, 6, 7
    s_mul_i32 s97, s30, 80
    s_add_u32 s41, s41, s97
    s_cmp_lt_u32 s65, s64
    s_cselect_b32 s52, 1, 0
    s_cselect_b32 s98, s65, 0
    s_cselect_b32 s20, 7, s64
    s_cselect_b32 s54, 0, 448
    s_add_u32 s41, s41, s98
    s_mul_i32 s42, s98, 8320
    s_mul_i32 s68, s98, 4608
    s_add_u32 s68, s68, 58240
    s_lshl_b32 s55, s41, 12
    v_lshlrev_b32 v8, 4, v0
    v_lshl_add_u32 v5, v1, 3, v2
    s_lshr_b32 s96, s65, 2
    s_mul_i32 s97, s96, 16896
    s_add_u32 s97, s97, 90496
    v_lshl_add_u32 v5, v5, 7, s97
    s_mul_i32 s45, s96, 512
    s_lshl_b32 s96, s65, 1
    v_xor_b32 v6, s96, v1
    v_and_b32 v6, 7, v6
    v_lshl_add_u32 v9, v6, 4, v5
    v_add_u32 v6, 7, v1
    v_xor_b32 v6, s96, v6
    v_and_b32 v6, 7, v6
    v_lshl_add_u32 v11, v6, 4, v5
    v_xor_b32 v10, 16, v9
    v_xor_b32 v12, 16, v11
    v_subrev_u32 v46, s45, v9
    v_subrev_u32 v47, s45, v10
    s_lshl_b32 s96, s58, 16
    s_lshl_b32 s97, s37, 8
    s_add_u32 s96, s96, s97
    s_add_u32 s96, s96, 1048576
    v_lshlrev_b32 v5, 12, v2
    v_lshl_add_u32 v5, v1, 4, v5
    v_add_u32 v14, s96, v5
    s_add_u32 s60, s28, 16384
    s_addc_u32 s61, s29, 0
    s_add_u32 s62, s28, 32768
    s_addc_u32 s63, s29, 0
    s_add_u32 s66, s28, 49152
    s_addc_u32 s67, s29, 0
    s_lshl4_add_u32 s96, s58, s37
    s_lshl_b32 s96, s96, 7
    s_add_u32 s96, s96, 262144
    v_add_u32 v5, v1, v2
    v_lshl_add_u32 v148, v5, 3, s96
    s_lshr_b32 s96, s41, 4
    s_lshl_b32 s96, s96, 11
    s_and_b32 s97, s41, 15
    s_lshl3_add_u32 s96, s97, s96
    s_add_u32 s96, s96, 262144
    v_lshl_add_u32 v149, v1, 7, s96
    s_waitcnt lgkmcnt(0)
    s_mul_i32 s33, s33, 1664525
    s_add_u32 s33, s33, 1013904223
    s_mov_b32 s43, s98
    v_bfe_u32 v5, v1, 2, 1
    v_lshlrev_b32 v5, 4, v5
    v_and_b32 v6, 3, v1
    v_lshrrev_b32 v7, 3, v1
    v_mov_b32 v4, 0x3f80
    v_lshlrev_b32 v4, v5, v4
    v_cmp_eq_u32 vcc, v6, v2
    s_nop 1
    v_cndmask_b32 v4, 0, v4, vcc
    v_cmp_eq_u32 vcc, 0, v7
    s_nop 1
    v_cndmask_b32 v40, 0, v4, vcc
    v_cndmask_b32 v41, v4, 0, vcc
    v_or_b32 v4, 2, v7
    v_cmp_ge_u32 vcc, v6, v2
    s_nop 1
    v_cndmask_b32 v7, v7, v4, vcc
    v_lshlrev_b32 v42, v5, v42
    v_lshlrev_b32 v43, v5, v43
    v_lshlrev_b32 v44, v5, v44
    v_lshlrev_b32 v45, v5, v45
    v_cmp_eq_u32 vcc, 0, v7
    s_nop 1
    v_cndmask_b32 v16, 0, v42, vcc
    v_cndmask_b32 v20, 0, v42, vcc
    v_cndmask_b32 v22, 0, v43, vcc
    v_cndmask_b32 v26, 0, v43, vcc
    v_cndmask_b32 v28, 0, v44, vcc
    v_cndmask_b32 v32, 0, v44, vcc
    v_cndmask_b32 v34, 0, v45, vcc
    v_cndmask_b32 v38, 0, v45, vcc
    v_cmp_eq_u32 vcc, 1, v7
    s_nop 1
    v_cndmask_b32 v17, 0, v42, vcc
    v_cndmask_b32 v21, 0, v42, vcc
    v_cndmask_b32 v23, 0, v43, vcc
    v_cndmask_b32 v27, 0, v43, vcc
    v_cndmask_b32 v29, 0, v44, vcc
    v_cndmask_b32 v33, 0, v44, vcc
    v_cndmask_b32 v35, 0, v45, vcc
    v_cndmask_b32 v39, 0, v45, vcc
    v_cmp_eq_u32 vcc, 2, v7
    s_nop 1
    v_cndmask_b32 v18, 0, v42, vcc
    v_cndmask_b32 v24, 0, v43, vcc
    v_cndmask_b32 v30, 0, v44, vcc
    v_cndmask_b32 v36, 0, v45, vcc
    v_cmp_eq_u32 vcc, 3, v7
    s_nop 1
    v_cndmask_b32 v19, 0, v42, vcc
    v_cndmask_b32 v25, 0, v43, vcc
    v_cndmask_b32 v31, 0, v44, vcc
    v_cndmask_b32 v37, 0, v45, vcc
    s_barrier
    s_cmp_ge_u32 s38, 5
    s_cbranch_scc1 L_nokv
    ds_read_b128 v[48:51], v11
    ds_read_b128 v[52:55], v9 offset:512
    ds_read_b128 v[56:59], v9 offset:1024
    ds_read_b128 v[60:63], v46 offset:33792
    ds_read_b128 v[64:67], v46 offset:34304
    ds_read_b128 v[68:71], v12
    ds_read_b128 v[72:75], v10 offset:512
    ds_read_b128 v[76:79], v10 offset:1024
    ds_read_b128 v[80:83], v47 offset:33792
    ds_read_b128 v[84:87], v47 offset:34304
    s_waitcnt lgkmcnt(8)
    v_swap_b32 v50, v52
    v_swap_b32 v51, v53
    s_nop 1
    v_mfma_f32_16x16x32_bf16 v[88:91], v[16:19], v[48:51], 0
    v_mfma_f32_16x16x32_bf16 v[96:99], v[22:25], v[52:55], 0
    s_waitcnt lgkmcnt(7)
    v_mov_b64 v[48:49], v[56:57]
    v_mov_b64 v[52:53], v[58:59]
    s_nop 0
    v_mfma_f32_16x16x32_bf16 v[92:95], v[18:21], v[48:51], 0
    v_mfma_f32_16x16x32_bf16 v[100:103], v[24:27], v[52:55], 0
    s_waitcnt lgkmcnt(5)
    v_mfma_f32_16x16x16_bf16 v[104:107], v[40:41], v[60:61], 0
    v_mfma_f32_16x16x16_bf16 v[108:111], v[40:41], v[64:65], 0
    v_mfma_f32_16x16x16_bf16 v[112:115], v[40:41], v[62:63], 0
    v_mfma_f32_16x16x16_bf16 v[116:119], v[40:41], v[66:67], 0
    s_waitcnt lgkmcnt(3)
    v_swap_b32 v70, v72
    v_swap_b32 v71, v73
    s_nop 1
    v_mfma_f32_16x16x32_bf16 v[48:51], v[28:31], v[68:71], 0
    v_mfma_f32_16x16x32_bf16 v[56:59], v[34:37], v[72:75], 0
    s_waitcnt lgkmcnt(2)
    v_mov_b64 v[68:69], v[76:77]
    v_mov_b64 v[72:73], v[78:79]
    s_nop 0
    v_mfma_f32_16x16x32_bf16 v[52:55], v[30:33], v[68:71], 0
    v_mfma_f32_16x16x32_bf16 v[60:63], v[36:39], v[72:75], 0
    v_pk_mul_f32 v[88:89], v[88:89], v[104:105]
    v_pk_mul_f32 v[90:91], v[90:91], v[106:107]
    v_pk_mul_f32 v[92:93], v[92:93], v[108:109]
    v_pk_mul_f32 v[94:95], v[94:95], v[110:111]
    v_pk_mul_f32 v[96:97], v[96:97], v[112:113]
    v_pk_mul_f32 v[98:99], v[98:99], v[114:115]
    v_pk_mul_f32 v[100:101], v[100:101], v[116:117]
    v_pk_mul_f32 v[102:103], v[102:103], v[118:119]
    s_waitcnt lgkmcnt(0)
    v_mfma_f32_16x16x16_bf16 v[104:107], v[40:41], v[80:81], 0
    v_mfma_f32_16x16x16_bf16 v[108:111], v[40:41], v[84:85], 0
    v_mfma_f32_16x16x16_bf16 v[112:115], v[40:41], v[82:83], 0
    v_mfma_f32_16x16x16_bf16 v[116:119], v[40:41], v[86:87], 0
    v_cvt_pk_bf16_f32 v120, v88, v89
    v_cvt_pk_bf16_f32 v121, v90, v91
    v_cvt_pk_bf16_f32 v122, v92, v93
    v_cvt_pk_bf16_f32 v123, v94, v95
    global_store_dwordx4 v14, v[120:123], s[28:29] sc1
    v_cvt_pk_bf16_f32 v124, v96, v97
    v_cvt_pk_bf16_f32 v125, v98, v99
    v_cvt_pk_bf16_f32 v126, v100, v101
    v_cvt_pk_bf16_f32 v127, v102, v103
    global_store_dwordx4 v14, v[124:127], s[60:61] sc1
    v_add_u32 v76, v120, v121
    v_add3_u32 v76, v76, v122, v123
    v_add_u32 v77, v124, v125
    v_add3_u32 v77, v77, v126, v127
    v_pk_mul_f32 v[48:49], v[48:49], v[104:105]
    v_pk_mul_f32 v[50:51], v[50:51], v[106:107]
    v_pk_mul_f32 v[52:53], v[52:53], v[108:109]
    v_pk_mul_f32 v[54:55], v[54:55], v[110:111]
    v_pk_mul_f32 v[56:57], v[56:57], v[112:113]
    v_pk_mul_f32 v[58:59], v[58:59], v[114:115]
    v_pk_mul_f32 v[60:61], v[60:61], v[116:117]
    v_pk_mul_f32 v[62:63], v[62:63], v[118:119]
    v_cvt_pk_bf16_f32 v68, v48, v49
    v_cvt_pk_bf16_f32 v69, v50, v51
    v_cvt_pk_bf16_f32 v70, v52, v53
    v_cvt_pk_bf16_f32 v71, v54, v55
    global_store_dwordx4 v14, v[68:71], s[62:63] sc1
    v_cvt_pk_bf16_f32 v72, v56, v57
    v_cvt_pk_bf16_f32 v73, v58, v59
    v_cvt_pk_bf16_f32 v74, v60, v61
    v_cvt_pk_bf16_f32 v75, v62, v63
    global_store_dwordx4 v14, v[72:75], s[66:67] sc1
    v_add_u32 v78, v68, v69
    v_add3_u32 v78, v78, v70, v71
    v_add_u32 v79, v72, v73
    v_add3_u32 v79, v79, v74, v75
    v_add_u32_dpp v80, v76, v76 row_ror:8 row_mask:0xf bank_mask:0xf
    v_add_u32_dpp v81, v77, v77 row_ror:8 row_mask:0xf bank_mask:0xf
    s_nop 0
    v_add_u32_dpp v80, v78, v78 row_ror:8 row_mask:0xf bank_mask:0xc
    v_add_u32_dpp v81, v79, v79 row_ror:8 row_mask:0xf bank_mask:0xc
    v_mov_b32 v76, s33
    v_add_u32_dpp v77, v80, v80 row_half_mirror row_mask:0xf bank_mask:0xf
    s_nop 1
    v_add_u32_dpp v77, v81, v81 row_half_mirror row_mask:0xf bank_mask:0xa
    s_nop 1
    v_add_u32_dpp v77, v77, v77 quad_perm:[1,0,3,2] row_mask:0xf bank_mask:0xf
    s_nop 1
    v_add_u32_dpp v77, v77, v77 quad_perm:[2,3,0,1] row_mask:0xf bank_mask:0xf
    s_mov_b32 exec_lo, 0x11111111
    s_mov_b32 exec_hi, 0x11111111
    global_store_dwordx2 v148, v[76:77], s[28:29] sc1
    s_mov_b64 exec, -1
    s_branch L_kvd
L_pada14:
    s_branch L_warmed_a
L_nokv:
    s_waitcnt vmcnt(0)
L_kvd:
    v_mov_b32 v4, 1
    s_mov_b64 exec, 1
    ds_add_u32 v3, v4 offset:256
    s_mov_b64 exec, -1
    s_setprio 1
    s_mov_b32 s98, s43
    s_add_u32 s96, s55, 1048576
    s_add_u32 s76, s28, s96
    s_addc_u32 s77, s29, 0
    s_and_b32 s77, s77, 0xffff
    s_mov_b32 s78, 4096
    s_mov_b32 s79, 0x00020000
    v_sub_u32 v5, 2031, v1
    v_and_b32 v6, 1, v5
    v_lshrrev_b32 v5, 1, v5
    v_lshl_add_u32 v5, v2, 2, v5
    v_lshlrev_b32 v5, 2, v5
    v_mul_u32_u24 v6, 4160, v6
    s_sub_u32 s96, s42, s54
    v_add3_u32 v5, v5, v6, s96
    v_subrev_u32 v154, 3584, v5
    v_subrev_u32 v155, 2560, v5
    v_subrev_u32 v156, 1536, v5
    v_subrev_u32 v157, 512, v5
    v_lshlrev_b32 v5, 5, v1
    v_lshl_add_u32 v5, v2, 4, v5
    s_sub_u32 s96, s68, s54
    s_add_u32 s96, s96, 480
    v_add_u32 v158, s96, v5
    v_and_b32 v5, 1, v2
    v_lshlrev_b32 v5, 9, v5
    v_lshl_add_u32 v5, v1, 5, v5
    v_lshrrev_b32 v6, 1, v2
    v_lshl_add_u32 v5, v6, 4, v5
    s_add_u32 s96, s55, 4194304
    v_add_u32 v153, s96, v5
    v_and_b32 v5, 28, v0
    v_add_u32 v159, 161792, v5
    s_cmp_ge_u32 s31, 26
    s_cselect_b32 s96, 8, 0
    s_lshl_b32 s97, s30, 8
    s_add_u32 s96, s96, s97
    s_add_u32 s96, s96, 65536
    v_and_b32 v5, 31, v0
    v_lshl_add_u32 v160, v5, 11, s96
    s_mul_i32 s96, s98, 2048
    s_add_u32 s96, s96, 88448
    v_add_u32 v161, s96, v8
    s_lshl_b32 s96, s98, 2
    v_add_u32 v162, s96, v3
    s_mul_i32 s96, s57, 51200
    s_sub_u32 s80, 109568, s96
    s_mul_i32 s81, s56, 2560
    s_add_u32 s81, s81, 48128
    s_mov_b32 s93, 0
    s_mov_b32 s101, 0
    s_and_b32 s98, s35, 3
    s_lshr_b32 s96, s56, 1
    s_lshl1_add_u32 s96, s98, s96
    s_lshl1_add_u32 s96, s96, s57
    s_mul_i32 s96, s96, 20480
    s_and_b32 s97, s56, 1
    s_lshl_b32 s97, s97, 10
    s_add_u32 s96, s96, s97
    s_mul_i32 s97, s30, 327680
    s_add_u32 s96, s96, s97
    s_add_u32 s82, s96, 4096
    s_mul_i32 s96, s30, 262144
    s_lshl_b32 s98, s98, 8
    s_add_u32 s96, s96, s98
    s_add_u32 s83, s96, 7536640
    s_mul_i32 s84, s56, 5120
    s_add_u32 s84, s84, 10240
    s_lshl2_add_u32 s96, s35, s56
    s_mul_i32 s96, s96, 20480
    s_mul_i32 s97, s36, 160
    s_add_u32 s85, s96, s97
    v_and_b32 v5, 1, v1
    v_lshlrev_b32 v5, 4, v5
    v_mov_b32 v6, 0x3f80
    v_lshlrev_b32 v6, v5, v6
    v_lshrrev_b32 v7, 1, v1
    v_lshlrev_b32 v4, 1, v2
    v_sub_u32 v4, v7, v4
    v_cmp_eq_u32 vcc, 0, v4
    s_nop 1
    v_cndmask_b32 v164, 0, v6, vcc
    v_cmp_eq_u32 vcc, 1, v4
    s_nop 1
    v_cndmask_b32 v165, 0, v6, vcc
    s_cmp_eq_u32 s32, 4
    s_cbranch_scc1 L_pada0
    s_cmp_eq_u32 s32, 5
    s_cbranch_scc1 L_pada1
    s_cmp_eq_u32 s32, 6
    s_cbranch_scc1 L_pada2
    s_cmp_eq_u32 s32, 7
    s_cbranch_scc1 L_pada3
    s_cmp_eq_u32 s32, 8
    s_cbranch_scc1 L_pada4
    s_cmp_eq_u32 s32, 9
    s_cbranch_scc1 L_pada5
    s_cmp_eq_u32 s32, 10
    s_cbranch_scc1 L_pada6
    s_branch L_pada7
L_warmed_a:
    s_setprio 2
    s_cmp_lg_u32 s52, 0
    s_cbranch_scc1 L_owner
    s_waitcnt vmcnt(0)
    v_mov_b32 v4, 1
    s_mov_b64 exec, 1
    ds_add_u32 v3, v4 offset:280
    s_mov_b64 exec, -1
    s_cmp_lg_u32 s65, 7
    s_cbranch_scc1 L_cdone
    s_mov_b32 s100, 0
Lw_65:
    ds_read_b32 v4, v3 offset:312
    s_waitcnt lgkmcnt(0)
    v_readfirstlane_b32 s99, v4
    s_cmp_ge_u32 s99, 1
    s_cbranch_scc1 Lwd_66
    s_add_u32 s100, s100, 1
    s_cmp_lt_u32 s100, 1048576
    s_cbranch_scc1 Lw_65
Lwd_66:
    ds_read2_b32 v[48:49], v157 offset0:128 offset1:129
    ds_read2_b32 v[50:51], v157 offset0:130 offset1:131
    ds_read2_b32 v[52:53], v157 offset0:0 offset1:1
    ds_read2_b32 v[54:55], v157 offset0:2 offset1:3
    ds_read2_b32 v[56:57], v156 offset0:128 offset1:129
    ds_read2_b32 v[58:59], v156 offset0:130 offset1:131
    ds_read2_b32 v[60:61], v156 offset0:0 offset1:1
    ds_read2_b32 v[62:63], v156 offset0:2 offset1:3
    ds_read2_b32 v[64:65], v155 offset0:128 offset1:129
    ds_read2_b32 v[66:67], v155 offset0:130 offset1:131
    ds_read2_b32 v[68:69], v155 offset0:0 offset1:1
    ds_read2_b32 v[70:71], v155 offset0:2 offset1:3
    s_waitcnt lgkmcnt(6)
    ds_read2_b32 v[72:73], v154 offset0:128 offset1:129
    ds_read2_b32 v[74:75], v154 offset0:130 offset1:131
    ds_read2_b32 v[76:77], v154 offset0:0 offset1:1
    ds_read2_b32 v[78:79], v154 offset0:2 offset1:3
    s_setprio 3
    v_mov_b32 v5, 1
    s_mov_b32 s100, 0
Lw_67:
    ds_read_b32 v4, v3 offset:280
    s_waitcnt lgkmcnt(0)
    v_readfirstlane_b32 s99, v4
    s_cmp_ge_u32 s99, 8
    s_cbranch_scc1 Lwd_68
    s_add_u32 s100, s100, 1
    s_cmp_lt_u32 s100, 1048576
    s_cbranch_scc1 Lw_67
Lwd_68:
    ds_read_b128 v[80:83], v158 offset:0
    ds_read_b128 v[84:87], v158 offset:512
    ds_read_b128 v[88:91], v158 offset:1024
    ds_read_b128 v[92:95], v158 offset:1536
    ds_read_b128 v[96:99], v158 offset:2048
    ds_read_b128 v[100:103], v158 offset:2560
    ds_read_b128 v[104:107], v158 offset:3072
    ds_read_b128 v[108:111], v158 offset:3584
    s_waitcnt lgkmcnt(0)
    s_setprio 2
    s_branch L_hloop
L_pada15:
    s_branch L_warmed_a
L_owner:
    v_mov_b32 v44, 0
    v_mov_b32 v45, 0
    v_lshl_add_u32 v5, v0, 3, s68
    ds_write_b64 v5, v[44:45]
    s_mov_b64 exec, 0xffff
    s_mov_b32 s100, 0
L_ep:
    global_atomic_or_x2 v[46:47], v149, v[44:45], s[28:29] sc0 sc1
    s_waitcnt vmcnt(0)
    v_cmp_ne_u32 vcc, s33, v46
    s_cbranch_vccz L_epd
    s_mov_b64 exec, vcc
    s_add_u32 s100, s100, 1
    s_cmp_lt_u32 s100, 1048576
    s_cbranch_scc1 L_ep
L_epd:
    s_mov_b64 exec, -1
    s_setprio 3
    s_mov_b32 s100, 0
    s_add_u32 m0, s68, 512
    s_nop 0
    buffer_load_dwordx4 v8, s[76:79], 0 offen offset:0 sc1 lds
    buffer_load_dwordx4 v8, s[76:79], 0 offen offset:1024 sc1 lds
    buffer_load_dwordx4 v8, s[76:79], 0 offen offset:2048 sc1 lds
    buffer_load_dwordx4 v8, s[76:79], 0 offen offset:3072 sc1 lds
    v_add_u32_dpp v47, v47, v47 row_ror:8 row_mask:0xf bank_mask:0xf
    s_nop 1
    v_add_u32_dpp v47, v47, v47 row_ror:4 row_mask:0xf bank_mask:0xf
    s_nop 1
    v_add_u32_dpp v47, v47, v47 row_ror:2 row_mask:0xf bank_mask:0xf
    s_nop 1
    v_add_u32_dpp v47, v47, v47 row_ror:1 row_mask:0xf bank_mask:0xf
    s_nop 0
    v_readfirstlane_b32 s60, v47
    s_mov_b32 s100, 0
Lw_69:
    ds_read_b32 v4, v162 offset:312
    s_waitcnt lgkmcnt(0)
    v_readfirstlane_b32 s99, v4
    s_cmp_ge_u32 s99, 1
    s_cbranch_scc1 Lwd_70
    s_add_u32 s100, s100, 1
    s_cmp_lt_u32 s100, 1048576
    s_cbranch_scc1 Lw_69
Lwd_70:
    ds_read2_b32 v[48:49], v157 offset0:128 offset1:129
    ds_read2_b32 v[50:51], v157 offset0:130 offset1:131
    ds_read2_b32 v[52:53], v157 offset0:0 offset1:1
    ds_read2_b32 v[54:55], v157 offset0:2 offset1:3
    ds_read2_b32 v[56:57], v156 offset0:128 offset1:129
    ds_read2_b32 v[58:59], v156 offset0:130 offset1:131
    ds_read2_b32 v[60:61], v156 offset0:0 offset1:1
    ds_read2_b32 v[62:63], v156 offset0:2 offset1:3
    ds_read2_b32 v[64:65], v155 offset0:128 offset1:129
    ds_read2_b32 v[66:67], v155 offset0:130 offset1:131
    ds_read2_b32 v[68:69], v155 offset0:0 offset1:1
    ds_read2_b32 v[70:71], v155 offset0:2 offset1:3
    s_waitcnt lgkmcnt(6)
    ds_read2_b32 v[72:73], v154 offset0:128 offset1:129
    ds_read2_b32 v[74:75], v154 offset0:130 offset1:131
    ds_read2_b32 v[76:77], v154 offset0:0 offset1:1
    ds_read2_b32 v[78:79], v154 offset0:2 offset1:3
    s_mov_b32 s100, 0
L_uretry:
    s_waitcnt vmcnt(0) lgkmcnt(0)
    ds_read_b128 v[108:111], v158 offset:3584
    ds_read_b128 v[104:107], v158 offset:3072
    ds_read_b128 v[100:103], v158 offset:2560
    ds_read_b128 v[96:99], v158 offset:2048
    ds_read_b128 v[92:95], v158 offset:1536
    ds_read_b128 v[88:91], v158 offset:1024
    ds_read_b128 v[84:87], v158 offset:512
    ds_read_b128 v[80:83], v158 offset:0
    s_waitcnt lgkmcnt(7)
    v_mfma_f32_16x16x32_bf16 v[44:47], v[48:51], v[108:111], 0
    v_add_u32 v9, v108, v109
    v_add3_u32 v9, v9, v110, v111
    s_waitcnt lgkmcnt(6)
    v_mfma_f32_16x16x32_bf16 v[40:43], v[48:51], v[104:107], 0
    v_add3_u32 v9, v9, v104, v105
    v_add3_u32 v9, v9, v106, v107
    s_waitcnt lgkmcnt(5)
    v_mfma_f32_16x16x32_bf16 v[36:39], v[48:51], v[100:103], 0
    v_add3_u32 v9, v9, v100, v101
    v_add3_u32 v9, v9, v102, v103
    s_waitcnt lgkmcnt(4)
    v_mfma_f32_16x16x32_bf16 v[32:35], v[48:51], v[96:99], 0
    v_add3_u32 v9, v9, v96, v97
    v_add3_u32 v9, v9, v98, v99
    s_waitcnt lgkmcnt(3)
    v_mfma_f32_16x16x32_bf16 v[28:31], v[48:51], v[92:95], 0
    v_add3_u32 v9, v9, v92, v93
    v_add3_u32 v9, v9, v94, v95
    s_waitcnt lgkmcnt(2)
    v_mfma_f32_16x16x32_bf16 v[24:27], v[48:51], v[88:91], 0
    v_add3_u32 v9, v9, v88, v89
    v_add3_u32 v9, v9, v90, v91
    s_waitcnt lgkmcnt(1)
    v_mfma_f32_16x16x32_bf16 v[20:23], v[48:51], v[84:87], 0
    v_add3_u32 v9, v9, v84, v85
    v_add3_u32 v9, v9, v86, v87
    s_waitcnt lgkmcnt(0)
    v_mfma_f32_16x16x32_bf16 v[16:19], v[48:51], v[80:83], 0
    v_add3_u32 v9, v9, v80, v81
    v_add3_u32 v9, v9, v82, v83
    s_nop 1
    v_add_u32_dpp v9, v9, v9 row_ror:8 row_mask:0xf bank_mask:0xf
    s_nop 1
    v_add_u32_dpp v9, v9, v9 row_ror:4 row_mask:0xf bank_mask:0xf
    s_nop 1
    v_add_u32_dpp v9, v9, v9 row_ror:2 row_mask:0xf bank_mask:0xf
    s_nop 1
    v_add_u32_dpp v9, v9, v9 row_ror:1 row_mask:0xf bank_mask:0xf
    s_nop 0
    v_readlane_b32 s96, v9, 32
    v_readlane_b32 s97, v9, 48
    v_mov_b32 v4, 1
    s_add_u32 s96, s96, s97
    s_cmp_eq_u32 s96, s60
    s_cbranch_scc1 L_uok
    buffer_load_dwordx4 v8, s[76:79], 0 offen offset:0 sc1 lds
    buffer_load_dwordx4 v8, s[76:79], 0 offen offset:1024 sc1 lds
    buffer_load_dwordx4 v8, s[76:79], 0 offen offset:2048 sc1 lds
    buffer_load_dwordx4 v8, s[76:79], 0 offen offset:3072 sc1 lds
    s_add_u32 s100, s100, 1
    s_cmp_lt_u32 s100, 1048576
    s_cbranch_scc1 L_uretry
L_uok:
    s_mov_b64 exec, 1
    ds_add_u32 v3, v4 offset:280
    s_mov_b64 exec, -1
    s_setprio 2
    v_subrev_u32 v154, 64, v154
    v_subrev_u32 v155, 64, v155
    v_subrev_u32 v156, 64, v156
    v_subrev_u32 v157, 64, v157
    v_subrev_u32 v158, 64, v158
    ds_read_b128 v[140:143], v158 offset:3584
    ds_read_b128 v[136:139], v158 offset:3072
    ds_read_b128 v[132:135], v158 offset:2560
    ds_read_b128 v[128:131], v158 offset:2048
    s_branch L_centry
L_pada16:
    s_branch L_warmed_a
L_cloop:
    s_setprio 2
    s_cmp_gt_u32 s20, 6
    s_cbranch_scc1 Lcp_71
    s_setprio 1
    s_cmp_gt_u32 s20, 2
    s_cbranch_scc1 Lcp_71
    s_setprio 0
Lcp_71:
    v_subrev_u32 v154, 64, v154
    v_subrev_u32 v155, 64, v155
    v_subrev_u32 v156, 64, v156
    v_subrev_u32 v157, 64, v157
    v_subrev_u32 v158, 64, v158
    s_waitcnt lgkmcnt(15)
    v_mfma_f32_16x16x32_bf16 v[44:47], v[48:51], v[108:111], v[44:47]
    v_mfma_f32_16x16x32_bf16 v[40:43], v[48:51], v[104:107], v[40:43]
    s_waitcnt lgkmcnt(12)
    ds_read_b128 v[140:143], v158 offset:3584
    v_mfma_f32_16x16x32_bf16 v[36:39], v[48:51], v[100:103], v[36:39]
    v_mfma_f32_16x16x32_bf16 v[32:35], v[48:51], v[96:99], v[32:35]
    ds_read_b128 v[136:139], v158 offset:3072
    v_mfma_f32_16x16x32_bf16 v[28:31], v[48:51], v[92:95], v[28:31]
    v_mfma_f32_16x16x32_bf16 v[24:27], v[48:51], v[88:91], v[24:27]
    s_waitcnt lgkmcnt(12)
    ds_read_b128 v[132:135], v158 offset:2560
    s_waitcnt lgkmcnt(8)
    v_mfma_f32_16x16x32_bf16 v[20:23], v[48:51], v[84:87], v[20:23]
    s_waitcnt lgkmcnt(7)
    v_mfma_f32_16x16x32_bf16 v[16:19], v[48:51], v[80:83], v[16:19]
    ds_read_b128 v[128:131], v158 offset:2048
L_centry:
    v_mfma_f32_16x16x32_bf16 v[44:47], v[52:55], v[104:107], v[44:47]
    v_mfma_f32_16x16x32_bf16 v[40:43], v[52:55], v[100:103], v[40:43]
    ds_read2_b32 v[48:49], v157 offset0:128 offset1:129
    v_mfma_f32_16x16x32_bf16 v[36:39], v[52:55], v[96:99], v[36:39]
    v_mfma_f32_16x16x32_bf16 v[32:35], v[52:55], v[92:95], v[32:35]
    ds_read2_b32 v[50:51], v157 offset0:130 offset1:131
    v_mfma_f32_16x16x32_bf16 v[28:31], v[52:55], v[88:91], v[28:31]
    v_mfma_f32_16x16x32_bf16 v[24:27], v[52:55], v[84:87], v[24:27]
    ds_read_b128 v[124:127], v158 offset:1536
    v_mfma_f32_16x16x32_bf16 v[20:23], v[52:55], v[80:83], v[20:23]
    v_mfma_f32_16x16x32_bf16 v[44:47], v[56:59], v[100:103], v[44:47]
    v_mfma_f32_16x16x32_bf16 v[40:43], v[56:59], v[96:99], v[40:43]
    ds_read2_b32 v[52:53], v157 offset0:0 offset1:1
    v_mfma_f32_16x16x32_bf16 v[36:39], v[56:59], v[92:95], v[36:39]
    v_mfma_f32_16x16x32_bf16 v[32:35], v[56:59], v[88:91], v[32:35]
    ds_read2_b32 v[54:55], v157 offset0:2 offset1:3
    v_mfma_f32_16x16x32_bf16 v[28:31], v[56:59], v[84:87], v[28:31]
    v_mfma_f32_16x16x32_bf16 v[24:27], v[56:59], v[80:83], v[24:27]
    ds_read_b128 v[120:123], v158 offset:1024
    v_mfma_f32_16x16x32_bf16 v[44:47], v[60:63], v[96:99], v[44:47]
    v_mfma_f32_16x16x32_bf16 v[40:43], v[60:63], v[92:95], v[40:43]
    s_waitcnt lgkmcnt(12)
    ds_read2_b32 v[56:57], v156 offset0:128 offset1:129
    v_mfma_f32_16x16x32_bf16 v[36:39], v[60:63], v[88:91], v[36:39]
    v_mfma_f32_16x16x32_bf16 v[32:35], v[60:63], v[84:87], v[32:35]
    ds_read2_b32 v[58:59], v156 offset0:130 offset1:131
    v_mfma_f32_16x16x32_bf16 v[28:31], v[60:63], v[80:83], v[28:31]
    v_mfma_f32_16x16x32_bf16 v[44:47], v[64:67], v[92:95], v[44:47]
    v_mfma_f32_16x16x32_bf16 v[40:43], v[64:67], v[88:91], v[40:43]
    s_waitcnt lgkmcnt(12)
    ds_read2_b32 v[60:61], v156 offset0:0 offset1:1
    v_mfma_f32_16x16x32_bf16 v[36:39], v[64:67], v[84:87], v[36:39]
    v_mfma_f32_16x16x32_bf16 v[32:35], v[64:67], v[80:83], v[32:35]
    ds_read2_b32 v[62:63], v156 offset0:2 offset1:3
    v_mfma_f32_16x16x32_bf16 v[44:47], v[68:71], v[88:91], v[44:47]
    v_mfma_f32_16x16x32_bf16 v[40:43], v[68:71], v[84:87], v[40:43]
    s_waitcnt lgkmcnt(12)
    ds_read2_b32 v[64:65], v155 offset0:128 offset1:129
    v_mfma_f32_16x16x32_bf16 v[36:39], v[68:71], v[80:83], v[36:39]
    ds_read2_b32 v[68:69], v155 offset0:0 offset1:1
    s_waitcnt lgkmcnt(12)
    ds_read2_b32 v[70:71], v155 offset0:2 offset1:3
    ds_read2_b32 v[66:67], v155 offset0:130 offset1:131
    s_waitcnt lgkmcnt(12)
    ds_read_b128 v[116:119], v158 offset:512
    ds_read_b128 v[112:115], v158 offset:0
    v_mfma_f32_16x16x32_bf16 v[44:47], v[72:75], v[84:87], v[44:47]
    v_mfma_f32_16x16x32_bf16 v[40:43], v[72:75], v[80:83], v[40:43]
    s_waitcnt lgkmcnt(12)
    ds_read2_b32 v[72:73], v154 offset0:128 offset1:129
    ds_read2_b32 v[74:75], v154 offset0:130 offset1:131
    v_mfma_f32_16x16x32_bf16 v[44:47], v[76:79], v[80:83], v[44:47]
    s_waitcnt lgkmcnt(12)
    ds_read2_b32 v[76:77], v154 offset0:0 offset1:1
    ds_read2_b32 v[78:79], v154 offset0:2 offset1:3
    v_subrev_u32 v154, 64, v154
    v_subrev_u32 v155, 64, v155
    v_subrev_u32 v156, 64, v156
    v_subrev_u32 v157, 64, v157
    v_subrev_u32 v158, 64, v158
    v_mfma_f32_16x16x32_bf16 v[44:47], v[48:51], v[140:143], v[44:47]
    v_mfma_f32_16x16x32_bf16 v[40:43], v[48:51], v[136:139], v[40:43]
    s_waitcnt lgkmcnt(12)
    ds_read_b128 v[108:111], v158 offset:3584
    v_mfma_f32_16x16x32_bf16 v[36:39], v[48:51], v[132:135], v[36:39]
    v_mfma_f32_16x16x32_bf16 v[32:35], v[48:51], v[128:131], v[32:35]
    ds_read_b128 v[104:107], v158 offset:3072
    v_mfma_f32_16x16x32_bf16 v[28:31], v[48:51], v[124:127], v[28:31]
    v_mfma_f32_16x16x32_bf16 v[24:27], v[48:51], v[120:123], v[24:27]
    s_waitcnt lgkmcnt(12)
    ds_read_b128 v[100:103], v158 offset:2560
    s_waitcnt lgkmcnt(8)
    v_mfma_f32_16x16x32_bf16 v[20:23], v[48:51], v[116:119], v[20:23]
    s_waitcnt lgkmcnt(7)
    v_mfma_f32_16x16x32_bf16 v[16:19], v[48:51], v[112:115], v[16:19]
    ds_read_b128 v[96:99], v158 offset:2048
    v_mfma_f32_16x16x32_bf16 v[44:47], v[52:55], v[136:139], v[44:47]
    v_mfma_f32_16x16x32_bf16 v[40:43], v[52:55], v[132:135], v[40:43]
    ds_read2_b32 v[48:49], v157 offset0:128 offset1:129
    v_mfma_f32_16x16x32_bf16 v[36:39], v[52:55], v[128:131], v[36:39]
    v_mfma_f32_16x16x32_bf16 v[32:35], v[52:55], v[124:127], v[32:35]
    ds_read2_b32 v[50:51], v157 offset0:130 offset1:131
    v_mfma_f32_16x16x32_bf16 v[28:31], v[52:55], v[120:123], v[28:31]
    v_mfma_f32_16x16x32_bf16 v[24:27], v[52:55], v[116:119], v[24:27]
    ds_read_b128 v[92:95], v158 offset:1536
    v_mfma_f32_16x16x32_bf16 v[20:23], v[52:55], v[112:115], v[20:23]
    v_mfma_f32_16x16x32_bf16 v[44:47], v[56:59], v[132:135], v[44:47]
    v_mfma_f32_16x16x32_bf16 v[40:43], v[56:59], v[128:131], v[40:43]
    ds_read2_b32 v[52:53], v157 offset0:0 offset1:1
    v_mfma_f32_16x16x32_bf16 v[36:39], v[56:59], v[124:127], v[36:39]
    v_mfma_f32_16x16x32_bf16 v[32:35], v[56:59], v[120:123], v[32:35]
    ds_read2_b32 v[54:55], v157 offset0:2 offset1:3
    v_mfma_f32_16x16x32_bf16 v[28:31], v[56:59], v[116:119], v[28:31]
    v_mfma_f32_16x16x32_bf16 v[24:27], v[56:59], v[112:115], v[24:27]
    ds_read_b128 v[88:91], v158 offset:1024
    v_mfma_f32_16x16x32_bf16 v[44:47], v[60:63], v[128:131], v[44:47]
    v_mfma_f32_16x16x32_bf16 v[40:43], v[60:63], v[124:127], v[40:43]
    s_waitcnt lgkmcnt(12)
    ds_read2_b32 v[56:57], v156 offset0:128 offset1:129
    v_mfma_f32_16x16x32_bf16 v[36:39], v[60:63], v[120:123], v[36:39]
    v_mfma_f32_16x16x32_bf16 v[32:35], v[60:63], v[116:119], v[32:35]
    ds_read2_b32 v[58:59], v156 offset0:130 offset1:131
    v_mfma_f32_16x16x32_bf16 v[28:31], v[60:63], v[112:115], v[28:31]
    v_mfma_f32_16x16x32_bf16 v[44:47], v[64:67], v[124:127], v[44:47]
    v_mfma_f32_16x16x32_bf16 v[40:43], v[64:67], v[120:123], v[40:43]
    s_waitcnt lgkmcnt(12)
    ds_read2_b32 v[60:61], v156 offset0:0 offset1:1
    v_mfma_f32_16x16x32_bf16 v[36:39], v[64:67], v[116:119], v[36:39]
    v_mfma_f32_16x16x32_bf16 v[32:35], v[64:67], v[112:115], v[32:35]
    ds_read2_b32 v[62:63], v156 offset0:2 offset1:3
    v_mfma_f32_16x16x32_bf16 v[44:47], v[68:71], v[120:123], v[44:47]
    v_mfma_f32_16x16x32_bf16 v[40:43], v[68:71], v[116:119], v[40:43]
    s_waitcnt lgkmcnt(12)
    ds_read2_b32 v[64:65], v155 offset0:128 offset1:129
    v_mfma_f32_16x16x32_bf16 v[36:39], v[68:71], v[112:115], v[36:39]
    ds_read2_b32 v[68:69], v155 offset0:0 offset1:1
    s_waitcnt lgkmcnt(12)
    ds_read2_b32 v[70:71], v155 offset0:2 offset1:3
    ds_read2_b32 v[66:67], v155 offset0:130 offset1:131
    s_waitcnt lgkmcnt(12)
    ds_read_b128 v[84:87], v158 offset:512
    ds_read_b128 v[80:83], v158 offset:0
    v_mfma_f32_16x16x32_bf16 v[44:47], v[72:75], v[116:119], v[44:47]
    v_mfma_f32_16x16x32_bf16 v[40:43], v[72:75], v[112:115], v[40:43]
    s_waitcnt lgkmcnt(12)
    ds_read2_b32 v[72:73], v154 offset0:128 offset1:129
    ds_read2_b32 v[74:75], v154 offset0:130 offset1:131
    v_mfma_f32_16x16x32_bf16 v[44:47], v[76:79], v[112:115], v[44:47]
    s_waitcnt lgkmcnt(12)
    ds_read2_b32 v[76:77], v154 offset0:0 offset1:1
    ds_read2_b32 v[78:79], v154 offset0:2 offset1:3
    s_sub_u32 s20, s20, 2
    s_cmp_lg_u32 s20, 1
    s_cbranch_scc1 L_cloop
    s_branch L_skip4487
L_pada17:
    s_branch L_warmed_a
L_skip4487:
L_cexit:
    s_setprio 0
    v_subrev_u32 v156, 64, v156
    v_subrev_u32 v157, 64, v157
    v_subrev_u32 v158, 64, v158
    s_mov_b32 s100, 0
Lw_72:
    ds_read_b32 v4, v162 offset:284
    s_waitcnt lgkmcnt(0)
    v_readfirstlane_b32 s99, v4
    s_cmp_ge_u32 s99, 1
    s_cbranch_scc1 Lwd_73
    s_add_u32 s100, s100, 1
    s_cmp_lt_u32 s100, 1048576
    s_cbranch_scc1 Lw_72
Lwd_73:
    ds_read_b128 v[144:147], v161 offset:2048
    ds_read_b128 v[148:151], v161 offset:3072
    ds_read_b128 v[112:115], v158 offset:0
    ds_read2_b32 v[128:129], v157 offset0:128 offset1:129
    ds_read2_b32 v[130:131], v157 offset0:130 offset1:131
    ds_read_b128 v[116:119], v158 offset:512
    ds_read2_b32 v[132:133], v157 offset0:0 offset1:1
    ds_read2_b32 v[134:135], v157 offset0:2 offset1:3
    ds_read_b128 v[120:123], v158 offset:1024
    ds_read2_b32 v[136:137], v156 offset0:128 offset1:129
    ds_read2_b32 v[138:139], v156 offset0:130 offset1:131
    ds_read_b128 v[124:127], v158 offset:1536
    ds_read2_b32 v[140:141], v156 offset0:0 offset1:1
    ds_read2_b32 v[142:143], v156 offset0:2 offset1:3
    s_mov_b32 s62, 0x11111111
    s_mov_b32 s63, 0x11111111
    v_mfma_f32_16x16x32_bf16 v[32:35], v[48:51], v[96:99], v[32:35]
    v_mfma_f32_16x16x32_bf16 v[36:39], v[48:51], v[100:103], v[36:39]
    v_mfma_f32_16x16x32_bf16 v[32:35], v[52:55], v[92:95], v[32:35]
    v_mfma_f32_16x16x32_bf16 v[36:39], v[52:55], v[96:99], v[36:39]
    v_mfma_f32_16x16x32_bf16 v[32:35], v[56:59], v[88:91], v[32:35]
    v_mfma_f32_16x16x32_bf16 v[36:39], v[56:59], v[92:95], v[36:39]
    s_waitcnt lgkmcnt(12)
    v_mfma_f32_16x16x16_bf16 v[40:43], v[164:165], v[148:149], v[40:43]
    v_mfma_f32_16x16x16_bf16 v[44:47], v[164:165], v[150:151], v[44:47]
    v_mfma_f32_16x16x16_bf16 v[32:35], v[164:165], v[144:145], v[32:35]
    v_mfma_f32_16x16x16_bf16 v[36:39], v[164:165], v[146:147], v[36:39]
    v_mfma_f32_16x16x32_bf16 v[32:35], v[60:63], v[84:87], v[32:35]
    v_mfma_f32_16x16x32_bf16 v[36:39], v[60:63], v[88:91], v[36:39]
    v_mfma_f32_16x16x32_bf16 v[32:35], v[64:67], v[80:83], v[32:35]
    v_mfma_f32_16x16x32_bf16 v[36:39], v[64:67], v[84:87], v[36:39]
    v_mfma_f32_16x16x32_bf16 v[36:39], v[68:71], v[80:83], v[36:39]
    s_waitcnt lgkmcnt(0)
    v_mfma_f32_16x16x32_bf16 v[16:19], v[48:51], v[80:83], v[16:19]
    v_mfma_f32_16x16x32_bf16 v[20:23], v[48:51], v[84:87], v[20:23]
    v_mfma_f32_16x16x32_bf16 v[20:23], v[52:55], v[80:83], v[20:23]
    s_nop 1
    v_cvt_pk_bf16_f32 v8, v32, v33
    v_cvt_pk_bf16_f32 v9, v34, v35
    v_mfma_f32_16x16x32_bf16 v[16:19], v[128:131], v[112:115], v[16:19]
    v_cvt_pk_bf16_f32 v10, v36, v37
    v_cvt_pk_bf16_f32 v11, v38, v39
    v_mfma_f32_16x16x32_bf16 v[20:23], v[128:131], v[116:119], v[20:23]
    v_permlane16_swap_b32 v8, v10
    v_permlane16_swap_b32 v9, v11
    v_mfma_f32_16x16x32_bf16 v[20:23], v[132:135], v[112:115], v[20:23]
    global_store_dwordx4 v153, v[8:11], s[28:29] offset:2048 sc1
    v_add_u32 v6, v8, v9
    v_mfma_f32_16x16x32_bf16 v[24:27], v[48:51], v[88:91], v[24:27]
    v_mfma_f32_16x16x32_bf16 v[28:31], v[48:51], v[92:95], v[28:31]
    v_mfma_f32_16x16x32_bf16 v[24:27], v[52:55], v[84:87], v[24:27]
    v_add3_u32 v6, v6, v10, v11
    s_nop 1
    v_add_u32_dpp v6, v6, v6 quad_perm:[1,0,3,2] row_mask:0xf bank_mask:0xf
    v_mfma_f32_16x16x32_bf16 v[28:31], v[52:55], v[88:91], v[28:31]
    s_nop 0
    v_add_u32_dpp v6, v6, v6 quad_perm:[2,3,0,1] row_mask:0xf bank_mask:0xf
    s_mov_b64 exec, s[62:63]
    ds_add_u32 v159, v6 offset:64
    s_mov_b64 exec, -1
    v_mfma_f32_16x16x32_bf16 v[24:27], v[56:59], v[80:83], v[24:27]
    v_cvt_pk_bf16_f32 v12, v16, v17
    v_cvt_pk_bf16_f32 v13, v18, v19
    v_mfma_f32_16x16x32_bf16 v[28:31], v[56:59], v[84:87], v[28:31]
    v_cvt_pk_bf16_f32 v14, v20, v21
    v_cvt_pk_bf16_f32 v15, v22, v23
    v_mfma_f32_16x16x32_bf16 v[28:31], v[60:63], v[80:83], v[28:31]
    v_permlane16_swap_b32 v12, v14
    v_permlane16_swap_b32 v13, v15
    v_mfma_f32_16x16x32_bf16 v[24:27], v[128:131], v[120:123], v[24:27]
    global_store_dwordx4 v153, v[12:15], s[28:29] offset:0 sc1
    v_add_u32 v6, v12, v13
    v_mfma_f32_16x16x32_bf16 v[28:31], v[128:131], v[124:127], v[28:31]
    v_add3_u32 v6, v6, v14, v15
    s_nop 1
    v_add_u32_dpp v6, v6, v6 quad_perm:[1,0,3,2] row_mask:0xf bank_mask:0xf
    v_mfma_f32_16x16x32_bf16 v[24:27], v[132:135], v[116:119], v[24:27]
    s_nop 0
    v_add_u32_dpp v6, v6, v6 quad_perm:[2,3,0,1] row_mask:0xf bank_mask:0xf
    s_mov_b64 exec, s[62:63]
    ds_add_u32 v159, v6 offset:0
    s_mov_b64 exec, -1
    v_mfma_f32_16x16x32_bf16 v[28:31], v[132:135], v[120:123], v[28:31]
    v_mfma_f32_16x16x32_bf16 v[24:27], v[136:139], v[112:115], v[24:27]
    v_mfma_f32_16x16x32_bf16 v[28:31], v[136:139], v[116:119], v[28:31]
    v_mfma_f32_16x16x32_bf16 v[28:31], v[140:143], v[112:115], v[28:31]
    v_mfma_f32_16x16x32_bf16 v[40:43], v[48:51], v[104:107], v[40:43]
    v_mfma_f32_16x16x32_bf16 v[44:47], v[48:51], v[108:111], v[44:47]
    v_mfma_f32_16x16x32_bf16 v[40:43], v[52:55], v[100:103], v[40:43]
    s_nop 2
    v_cvt_pk_bf16_f32 v8, v24, v25
    v_cvt_pk_bf16_f32 v9, v26, v27
    v_mfma_f32_16x16x32_bf16 v[44:47], v[52:55], v[104:107], v[44:47]
    v_cvt_pk_bf16_f32 v10, v28, v29
    v_cvt_pk_bf16_f32 v11, v30, v31
    v_mfma_f32_16x16x32_bf16 v[40:43], v[56:59], v[96:99], v[40:43]
    v_permlane16_swap_b32 v8, v10
    v_permlane16_swap_b32 v9, v11
    v_mfma_f32_16x16x32_bf16 v[44:47], v[56:59], v[100:103], v[44:47]
    global_store_dwordx4 v153, v[8:11], s[28:29] offset:1024 sc1
    v_add_u32 v6, v8, v9
    v_mfma_f32_16x16x32_bf16 v[40:43], v[60:63], v[92:95], v[40:43]
    v_add3_u32 v6, v6, v10, v11
    s_nop 1
    v_add_u32_dpp v6, v6, v6 quad_perm:[1,0,3,2] row_mask:0xf bank_mask:0xf
    v_mfma_f32_16x16x32_bf16 v[44:47], v[60:63], v[96:99], v[44:47]
    s_nop 0
    v_add_u32_dpp v6, v6, v6 quad_perm:[2,3,0,1] row_mask:0xf bank_mask:0xf
    s_mov_b64 exec, s[62:63]
    ds_add_u32 v159, v6 offset:32
    s_mov_b64 exec, -1
    v_mfma_f32_16x16x32_bf16 v[40:43], v[64:67], v[88:91], v[40:43]
    v_mfma_f32_16x16x32_bf16 v[44:47], v[64:67], v[92:95], v[44:47]
    v_mfma_f32_16x16x32_bf16 v[40:43], v[68:71], v[84:87], v[40:43]
    v_mfma_f32_16x16x32_bf16 v[44:47], v[68:71], v[88:91], v[44:47]
    v_mfma_f32_16x16x32_bf16 v[40:43], v[72:75], v[80:83], v[40:43]
    v_mfma_f32_16x16x32_bf16 v[44:47], v[72:75], v[84:87], v[44:47]
    v_mfma_f32_16x16x32_bf16 v[44:47], v[76:79], v[80:83], v[44:47]
    s_setprio 3
    s_nop 4
    v_cvt_pk_bf16_f32 v12, v40, v41
    v_cvt_pk_bf16_f32 v13, v42, v43
    v_cvt_pk_bf16_f32 v14, v44, v45
    v_cvt_pk_bf16_f32 v15, v46, v47
    s_nop 0
    v_permlane16_swap_b32 v12, v14
    v_permlane16_swap_b32 v13, v15
    s_branch L_skip4630
L_pada18:
    s_branch L_warmed_a
L_skip4630:
    global_store_dwordx4 v153, v[12:15], s[28:29] offset:3072 sc1
    v_add_u32 v6, v12, v13
    v_add3_u32 v6, v6, v14, v15
    s_nop 1
    v_add_u32_dpp v6, v6, v6 quad_perm:[1,0,3,2] row_mask:0xf bank_mask:0xf
    s_nop 1
    v_add_u32_dpp v6, v6, v6 quad_perm:[2,3,0,1] row_mask:0xf bank_mask:0xf
    s_mov_b64 exec, s[62:63]
    ds_add_u32 v159, v6 offset:96
    s_mov_b64 exec, -1
    v_mov_b32 v4, 1
    s_mov_b64 exec, 1
    ds_add_u32 v3, v4 offset:196
    ds_add_rtn_u32 v4, v3, v4 offset:252
    s_mov_b64 exec, -1
    v_lshlrev_b32 v5, 2, v0
    v_add_u32 v5, 161792, v5
    ds_read_b32 v30, v5
    v_mov_b32 v31, 0x100
    s_waitcnt lgkmcnt(0)
    v_readfirstlane_b32 s98, v4
    s_add_u32 s98, s98, 1
    s_cmp_lg_u32 s98, s64
    s_cbranch_scc1 L_ynf
    s_mov_b64 exec, 0xffffffff
    global_atomic_add_x2 v[132:133], v160, v[30:31], s[28:29] sc0 sc1
    s_mov_b64 exec, -1
    s_mov_b32 s101, 1
L_ynf:
    s_branch L_cjoin
L_pada19:
    s_branch L_warmed_a
L_hloop:
    v_add_u32 v154, 8320, v154
    v_add_u32 v155, 8320, v155
    v_add_u32 v156, 8320, v156
    v_add_u32 v157, 8320, v157
    v_add_u32 v158, 4608, v158
    s_waitcnt lgkmcnt(15)
    v_mfma_f32_16x16x32_bf16 v[44:47], v[48:51], v[108:111], 0
    v_mfma_f32_16x16x32_bf16 v[40:43], v[48:51], v[104:107], 0
    s_waitcnt lgkmcnt(12)
    ds_read_b128 v[140:143], v158 offset:3584
    v_mfma_f32_16x16x32_bf16 v[36:39], v[48:51], v[100:103], 0
    s_waitcnt lgkmcnt(12)
    v_mfma_f32_16x16x32_bf16 v[32:35], v[48:51], v[96:99], 0
    ds_read_b128 v[136:139], v158 offset:3072
    v_mfma_f32_16x16x32_bf16 v[44:47], v[52:55], v[104:107], v[44:47]
    v_mfma_f32_16x16x32_bf16 v[40:43], v[52:55], v[100:103], v[40:43]
    ds_read2_b32 v[48:49], v157 offset0:128 offset1:129
    v_mfma_f32_16x16x32_bf16 v[36:39], v[52:55], v[96:99], v[36:39]
    s_waitcnt lgkmcnt(13)
    v_mfma_f32_16x16x32_bf16 v[32:35], v[52:55], v[92:95], v[32:35]
    ds_read2_b32 v[50:51], v157 offset0:130 offset1:131
    v_mfma_f32_16x16x32_bf16 v[44:47], v[56:59], v[100:103], v[44:47]
    v_mfma_f32_16x16x32_bf16 v[40:43], v[56:59], v[96:99], v[40:43]
    s_waitcnt lgkmcnt(12)
    ds_read2_b32 v[52:53], v157 offset0:0 offset1:1
    v_mfma_f32_16x16x32_bf16 v[36:39], v[56:59], v[92:95], v[36:39]
    v_mfma_f32_16x16x32_bf16 v[32:35], v[56:59], v[88:91], v[32:35]
    ds_read2_b32 v[54:55], v157 offset0:2 offset1:3
    v_mfma_f32_16x16x32_bf16 v[44:47], v[60:63], v[96:99], v[44:47]
    v_mfma_f32_16x16x32_bf16 v[40:43], v[60:63], v[92:95], v[40:43]
    s_waitcnt lgkmcnt(12)
    ds_read2_b32 v[56:57], v156 offset0:128 offset1:129
    v_mfma_f32_16x16x32_bf16 v[36:39], v[60:63], v[88:91], v[36:39]
    v_mfma_f32_16x16x32_bf16 v[32:35], v[60:63], v[84:87], v[32:35]
    ds_read2_b32 v[58:59], v156 offset0:130 offset1:131
    v_mfma_f32_16x16x32_bf16 v[44:47], v[64:67], v[92:95], v[44:47]
    v_mfma_f32_16x16x32_bf16 v[40:43], v[64:67], v[88:91], v[40:43]
    s_waitcnt lgkmcnt(12)
    ds_read2_b32 v[60:61], v156 offset0:0 offset1:1
    v_mfma_f32_16x16x32_bf16 v[36:39], v[64:67], v[84:87], v[36:39]
    v_mfma_f32_16x16x32_bf16 v[32:35], v[64:67], v[80:83], v[32:35]
    ds_read2_b32 v[62:63], v156 offset0:2 offset1:3
    v_mfma_f32_16x16x32_bf16 v[44:47], v[68:71], v[88:91], v[44:47]
    v_mfma_f32_16x16x32_bf16 v[40:43], v[68:71], v[84:87], v[40:43]
    s_waitcnt lgkmcnt(12)
    ds_read2_b32 v[64:65], v155 offset0:128 offset1:129
    v_mfma_f32_16x16x32_bf16 v[36:39], v[68:71], v[80:83], v[36:39]
    ds_read2_b32 v[68:69], v155 offset0:0 offset1:1
    s_waitcnt lgkmcnt(12)
    ds_read2_b32 v[70:71], v155 offset0:2 offset1:3
    ds_read2_b32 v[66:67], v155 offset0:130 offset1:131
    s_waitcnt lgkmcnt(12)
    ds_read_b128 v[132:135], v158 offset:2560
    ds_read_b128 v[128:131], v158 offset:2048
    s_waitcnt lgkmcnt(12)
    ds_read_b128 v[124:127], v158 offset:1536
    ds_read_b128 v[120:123], v158 offset:1024
    s_waitcnt lgkmcnt(12)
    ds_read_b128 v[116:119], v158 offset:512
    ds_read_b128 v[112:115], v158 offset:0
    v_mfma_f32_16x16x32_bf16 v[44:47], v[72:75], v[84:87], v[44:47]
    v_mfma_f32_16x16x32_bf16 v[40:43], v[72:75], v[80:83], v[40:43]
    s_waitcnt lgkmcnt(12)
    ds_read2_b32 v[72:73], v154 offset0:128 offset1:129
    ds_read2_b32 v[74:75], v154 offset0:130 offset1:131
    v_mfma_f32_16x16x32_bf16 v[44:47], v[76:79], v[80:83], v[44:47]
    s_waitcnt lgkmcnt(12)
    ds_read2_b32 v[76:77], v154 offset0:0 offset1:1
    ds_read2_b32 v[78:79], v154 offset0:2 offset1:3
    v_cvt_pk_bf16_f32 v8, v32, v33
    v_cvt_pk_bf16_f32 v9, v34, v35
    v_cvt_pk_bf16_f32 v10, v36, v37
    v_cvt_pk_bf16_f32 v11, v38, v39
    s_waitcnt lgkmcnt(12)
    ds_write_b128 v161, v[8:11] offset:2048
    v_cvt_pk_bf16_f32 v12, v40, v41
    v_cvt_pk_bf16_f32 v13, v42, v43
    v_cvt_pk_bf16_f32 v14, v44, v45
    v_cvt_pk_bf16_f32 v15, v46, v47
    ds_write_b128 v161, v[12:15] offset:3072
    s_waitcnt lgkmcnt(12)
    ds_write_b32 v162, v5 offset:284
    v_add_u32 v161, 2048, v161
    v_add_u32 v162, 4, v162
    s_sub_u32 s20, s20, 1
    s_cmp_eq_u32 s20, 0
    s_cbranch_scc1 L_hexit
    v_add_u32 v154, 8320, v154
    v_add_u32 v155, 8320, v155
    v_add_u32 v156, 8320, v156
    v_add_u32 v157, 8320, v157
    v_add_u32 v158, 4608, v158
    v_mfma_f32_16x16x32_bf16 v[44:47], v[48:51], v[140:143], 0
    v_mfma_f32_16x16x32_bf16 v[40:43], v[48:51], v[136:139], 0
    ds_read_b128 v[108:111], v158 offset:3584
    s_waitcnt lgkmcnt(13)
    v_mfma_f32_16x16x32_bf16 v[36:39], v[48:51], v[132:135], 0
    s_waitcnt lgkmcnt(12)
    v_mfma_f32_16x16x32_bf16 v[32:35], v[48:51], v[128:131], 0
    ds_read_b128 v[104:107], v158 offset:3072
    v_mfma_f32_16x16x32_bf16 v[44:47], v[52:55], v[136:139], v[44:47]
    v_mfma_f32_16x16x32_bf16 v[40:43], v[52:55], v[132:135], v[40:43]
    ds_read2_b32 v[48:49], v157 offset0:128 offset1:129
    v_mfma_f32_16x16x32_bf16 v[36:39], v[52:55], v[128:131], v[36:39]
    s_waitcnt lgkmcnt(13)
    v_mfma_f32_16x16x32_bf16 v[32:35], v[52:55], v[124:127], v[32:35]
    ds_read2_b32 v[50:51], v157 offset0:130 offset1:131
    v_mfma_f32_16x16x32_bf16 v[44:47], v[56:59], v[132:135], v[44:47]
    v_mfma_f32_16x16x32_bf16 v[40:43], v[56:59], v[128:131], v[40:43]
    s_waitcnt lgkmcnt(12)
    ds_read2_b32 v[52:53], v157 offset0:0 offset1:1
    v_mfma_f32_16x16x32_bf16 v[36:39], v[56:59], v[124:127], v[36:39]
    v_mfma_f32_16x16x32_bf16 v[32:35], v[56:59], v[120:123], v[32:35]
    ds_read2_b32 v[54:55], v157 offset0:2 offset1:3
    v_mfma_f32_16x16x32_bf16 v[44:47], v[60:63], v[128:131], v[44:47]
    v_mfma_f32_16x16x32_bf16 v[40:43], v[60:63], v[124:127], v[40:43]
    s_waitcnt lgkmcnt(12)
    ds_read2_b32 v[56:57], v156 offset0:128 offset1:129
    v_mfma_f32_16x16x32_bf16 v[36:39], v[60:63], v[120:123], v[36:39]
    v_mfma_f32_16x16x32_bf16 v[32:35], v[60:63], v[116:119], v[32:35]
    ds_read2_b32 v[58:59], v156 offset0:130 offset1:131
    v_mfma_f32_16x16x32_bf16 v[44:47], v[64:67], v[124:127], v[44:47]
    v_mfma_f32_16x16x32_bf16 v[40:43], v[64:67], v[120:123], v[40:43]
    s_waitcnt lgkmcnt(12)
    ds_read2_b32 v[60:61], v156 offset0:0 offset1:1
    v_mfma_f32_16x16x32_bf16 v[36:39], v[64:67], v[116:119], v[36:39]
    v_mfma_f32_16x16x32_bf16 v[32:35], v[64:67], v[112:115], v[32:35]
    ds_read2_b32 v[62:63], v156 offset0:2 offset1:3
    v_mfma_f32_16x16x32_bf16 v[44:47], v[68:71], v[120:123], v[44:47]
    v_mfma_f32_16x16x32_bf16 v[40:43], v[68:71], v[116:119], v[40:43]
    s_waitcnt lgkmcnt(12)
    ds_read2_b32 v[64:65], v155 offset0:128 offset1:129
    v_mfma_f32_16x16x32_bf16 v[36:39], v[68:71], v[112:115], v[36:39]
    ds_read2_b32 v[68:69], v155 offset0:0 offset1:1
    s_waitcnt lgkmcnt(12)
    ds_read2_b32 v[70:71], v155 offset0:2 offset1:3
    ds_read2_b32 v[66:67], v155 offset0:130 offset1:131
    s_waitcnt lgkmcnt(12)
    ds_read_b128 v[100:103], v158 offset:2560
    ds_read_b128 v[96:99], v158 offset:2048
    s_waitcnt lgkmcnt(12)
    ds_read_b128 v[92:95], v158 offset:1536
    ds_read_b128 v[88:91], v158 offset:1024
    s_waitcnt lgkmcnt(12)
    ds_read_b128 v[84:87], v158 offset:512
    ds_read_b128 v[80:83], v158 offset:0
    v_mfma_f32_16x16x32_bf16 v[44:47], v[72:75], v[116:119], v[44:47]
    v_mfma_f32_16x16x32_bf16 v[40:43], v[72:75], v[112:115], v[40:43]
    s_waitcnt lgkmcnt(12)
    ds_read2_b32 v[72:73], v154 offset0:128 offset1:129
    ds_read2_b32 v[74:75], v154 offset0:130 offset1:131
    v_mfma_f32_16x16x32_bf16 v[44:47], v[76:79], v[112:115], v[44:47]
    s_waitcnt lgkmcnt(12)
    ds_read2_b32 v[76:77], v154 offset0:0 offset1:1
    ds_read2_b32 v[78:79], v154 offset0:2 offset1:3
    v_cvt_pk_bf16_f32 v8, v32, v33
    v_cvt_pk_bf16_f32 v9, v34, v35
    v_cvt_pk_bf16_f32 v10, v36, v37
    v_cvt_pk_bf16_f32 v11, v38, v39
    s_waitcnt lgkmcnt(12)
    ds_write_b128 v161, v[8:11] offset:2048
    v_cvt_pk_bf16_f32 v12, v40, v41
    v_cvt_pk_bf16_f32 v13, v42, v43
    v_cvt_pk_bf16_f32 v14, v44, v45
    v_cvt_pk_bf16_f32 v15, v46, v47
    ds_write_b128 v161, v[12:15] offset:3072
    s_waitcnt lgkmcnt(12)
    ds_write_b32 v162, v5 offset:284
    v_add_u32 v161, 2048, v161
    v_add_u32 v162, 4, v162
    s_sub_u32 s20, s20, 1
    s_cmp_eq_u32 s20, 0
    s_cbranch_scc0 L_hloop
    s_branch L_skip4834
L_pada20:
    s_branch L_warmed_a
L_skip4834:
L_hexit:
L_cdone:
    s_waitcnt lgkmcnt(0)
    v_mov_b32 v4, 1
    s_mov_b64 exec, 1
    ds_add_u32 v3, v4 offset:196
    s_mov_b64 exec, -1
    s_setprio 0
    s_mov_b32 s100, 0
Lw_74:
    ds_read_b32 v4, v3 offset:196
    s_waitcnt lgkmcnt(0)
    v_readfirstlane_b32 s99, v4
    s_cmp_ge_u32 s99, 4
    s_cbranch_scc1 Lwd_75
    s_sleep 6
    s_add_u32 s100, s100, 1
    s_cmp_lt_u32 s100, 1048576
    s_cbranch_scc1 Lw_74
Lwd_75:
L_cjoin:
    s_setprio 2
    s_mov_b32 s100, 0
Lw_76:
    ds_read_b32 v4, v3 offset:192
    s_waitcnt lgkmcnt(0)
    v_readfirstlane_b32 s99, v4
    s_cmp_ge_u32 s99, 1
    s_cbranch_scc1 Lwd_77
    s_add_u32 s100, s100, 1
    s_cmp_lt_u32 s100, 1048576
    s_cbranch_scc1 Lw_76
Lwd_77:
    s_mov_b32 s91, s99
    s_cmp_eq_u32 s91, 1
    s_cselect_b32 s99, 0, 15728640
    s_add_u32 s16, s28, s99
    s_addc_u32 s17, s29, 0
    s_add_u32 s18, s16, 13107200
    s_addc_u32 s19, s17, 0
    s_cmp_eq_u32 s91, 1
    s_cselect_b64 s[18:19], s[24:25], s[18:19]
    v_lshl_add_u32 v138, v0, 4, s80
    v_lshl_add_u32 v139, v0, 4, s82
    v_lshl_add_u32 v166, v0, 2, s83
    s_branch L_tail
L_end:
    s_endpgm
L_codeend:
.section .rodata,"a"
.p2align 6
.amdhsa_kernel gated_mix__ssm_conv_h3__sliding_local_dilated__prompt_kernel
  .amdhsa_next_free_vgpr 168
  .amdhsa_next_free_sgpr 102
  .amdhsa_accum_offset 168
  .amdhsa_group_segment_fixed_size 0
  .amdhsa_kernarg_size 104
  .amdhsa_user_sgpr_count 2
  .amdhsa_user_sgpr_kernarg_segment_ptr 1
  .amdhsa_system_sgpr_workgroup_id_x 1
.end_amdhsa_kernel
```

```asm
; @launch grid=(256,1,1) block=(768,1,1) lds=163840
.amdgcn_target "amdgcn-amd-amdhsa--gfx950"
.text
.p2align 12
.globl gated_mix__ssm_conv_h3__sliding_local_dilated__prompt_kernel
.p2align 8
.type gated_mix__ssm_conv_h3__sliding_local_dilated__prompt_kernel,@function
gated_mix__ssm_conv_h3__sliding_local_dilated__prompt_kernel:
L_entry:
    s_load_dwordx16 s[4:19], s[0:1], 0
    s_load_dwordx8 s[20:27], s[0:1], 64
    s_load_dwordx2 s[28:29], s[0:1], 96
    s_cmp_ge_u32 s2, 256
    s_cbranch_scc1 L_end
    v_lshrrev_b32 v4, 6, v0
    v_and_b32 v0, 63, v0
    v_readfirstlane_b32 s32, v4
    s_lshr_b32 s31, s2, 3
    v_mov_b32 v3, 160768
    v_lshrrev_b32 v2, 4, v0
    v_and_b32 v1, 15, v0
    s_and_b32 s30, s2, 7
    s_and_b32 s36, s31, 7
    s_lshr_b32 s35, s31, 3
    s_lshl2_add_u32 s35, s30, s35
    s_cmp_ge_u32 s31, 20
    s_cselect_b32 s34, 1, 0
    s_cselect_b32 s96, 20, 0
    s_cselect_b32 s97, 5, 10
    s_sub_u32 s38, s31, s96
    s_cmp_ge_u32 s38, s97
    s_cselect_b32 s97, s97, 0
    s_cselect_b32 s96, 1, 0
    s_sub_u32 s38, s38, s97
    s_lshl1_add_u32 s37, s30, s96
    s_mul_i32 s39, s37, 163840
    s_cmp_ge_u32 s32, 4
    s_cbranch_scc1 L_cw
    s_setprio 3
    s_cmp_lg_u32 s34, 0
    s_cbranch_scc1 L_aserv
    s_branch L_bserv
L_aserv:
    v_lshrrev_b32 v5, 3, v0
    v_mul_u32_u24 v5, 1280, v5
    v_and_b32 v4, 7, v0
    v_lshl_add_u32 v4, v4, 4, v5
    s_lshl_b32 s96, s38, 8
    v_add_u32 v4, s96, v4
    s_and_b32 s97, s32, 1
    s_lshl_b32 s97, s97, 6
    v_xor_b32 v13, s97, v4
    v_xor_b32 v14, 16, v13
    v_xor_b32 v15, 32, v13
    v_xor_b32 v16, 48, v13
    s_mul_i32 s96, s32, 40960
    s_add_u32 s52, s39, s96
    s_lshl_b32 s53, s32, 12
    s_lshl_b32 s97, s97, 1
    s_add_u32 s96, s39, s97
    s_sub_u32 s96, s96, 5120
    v_xor_b32 v4, 0x70, v4
    v_add_u32 v17, s96, v4
    s_waitcnt lgkmcnt(0)
    s_mov_b32 s84, s6
    s_and_b32 s85, s7, 0xffff
    s_mov_b32 s86, 2621440
    s_mov_b32 s87, 0x00020000
    s_mov_b32 s80, s8
    s_and_b32 s81, s9, 0xffff
    s_mov_b32 s82, 2621440
    s_mov_b32 s83, 0x00020000
    s_load_dword s33, s[28:29], 0
    s_cmp_ge_u32 s38, 5
    s_cbranch_scc1 L_as_nokv
    s_cmp_ge_u32 s32, 2
    s_cbranch_scc1 L_as_nohalo
    s_mul_i32 m0, s32, 16896
    s_add_u32 m0, m0, 90496
    s_mov_b64 exec, 0xffffffff
    buffer_load_dwordx4 v17, s[84:87], 0 offen lds
    s_mov_b64 exec, -1
L_as_nohalo:
    s_add_u32 m0, s53, 91008
    s_mov_b32 s59, s52
    buffer_load_dwordx4 v13, s[84:87], s59 offen lds
    s_addk_i32 m0, 16768
    s_nop 0
    buffer_load_dwordx4 v13, s[84:87], s59 offen offset:128 lds
    s_addk_i32 m0, -15744
    s_addk_i32 s59, 10240
    buffer_load_dwordx4 v14, s[84:87], s59 offen lds
    s_addk_i32 m0, 16768
    s_nop 0
    buffer_load_dwordx4 v14, s[84:87], s59 offen offset:128 lds
    s_addk_i32 m0, -15744
    s_addk_i32 s59, 10240
    buffer_load_dwordx4 v15, s[84:87], s59 offen lds
    s_addk_i32 m0, 16768
    s_nop 0
    buffer_load_dwordx4 v15, s[84:87], s59 offen offset:128 lds
    s_addk_i32 m0, -15744
    s_addk_i32 s59, 10240
    buffer_load_dwordx4 v16, s[84:87], s59 offen lds
    s_addk_i32 m0, 16768
    s_nop 0
    buffer_load_dwordx4 v16, s[84:87], s59 offen offset:128 lds
    s_add_u32 m0, s53, 124288
    s_mov_b32 s59, s52
    buffer_load_dwordx4 v13, s[80:83], s59 offen lds
    s_addk_i32 m0, 16256
    s_nop 0
    buffer_load_dwordx4 v13, s[80:83], s59 offen offset:128 lds
    s_addk_i32 m0, -15232
    s_addk_i32 s59, 10240
    buffer_load_dwordx4 v14, s[80:83], s59 offen lds
    s_addk_i32 m0, 16256
    s_nop 0
    buffer_load_dwordx4 v14, s[80:83], s59 offen offset:128 lds
    s_addk_i32 m0, -15232
    s_addk_i32 s59, 10240
    buffer_load_dwordx4 v15, s[80:83], s59 offen lds
    s_addk_i32 m0, 16256
    s_nop 0
    buffer_load_dwordx4 v15, s[80:83], s59 offen offset:128 lds
    s_addk_i32 m0, -15232
    s_addk_i32 s59, 10240
    buffer_load_dwordx4 v16, s[80:83], s59 offen lds
    s_addk_i32 m0, 16256
    s_nop 0
    buffer_load_dwordx4 v16, s[80:83], s59 offen offset:128 lds
    s_branch L_as_kv
L_cw:
    s_cmp_lg_u32 s32, 4
    s_cbranch_scc1 L_nopf
    s_getpc_b64 s[46:47]
L_pc:
    s_lshr_b32 s96, s2, 3
    s_mul_i32 s96, s96, 896
    v_lshl_add_u32 v4, v0, 7, s96
    v_min_u32 v4, L_codeend-L_pc-4, v4
    s_mov_b64 exec, 0x7f
    global_load_dword v137, v4, s[46:47]
    s_mov_b64 exec, -1
    v_lshl_add_u32 v5, v0, 3, v3
    v_mov_b32 v6, 0
    v_mov_b32 v7, 0
    ds_write_b64 v5, v[6:7]
L_nopf:
    s_cmp_lg_u32 s34, 0
    s_cbranch_scc1 L_awave
    s_branch L_compute
L_service:
L_bserv:
    v_lshrrev_b32 v4, 3, v0
    v_and_b32 v5, 7, v0
    s_add_u32 s65, s30, s38
    s_mul_i32 s96, s65, 52
    s_lshr_b32 s96, s96, 8
    s_mul_i32 s96, s96, 5
    s_sub_u32 s65, s65, s96
    s_mul_i32 s65, s65, 512
    s_lshr_b32 s65, s65, 8
    s_mov_b32 s67, s65
    s_and_b32 s96, s32, 1
    s_cmp_ge_u32 s32, 2
    s_cbranch_scc1 L_lw
    v_mul_u32_u24 v6, 1280, v4
    v_xor_b32 v7, v5, v2
    v_lshl_add_u32 v13, v7, 4, v6
    s_lshl_b32 s97, s96, 6
    v_xor_b32 v13, s97, v13
    v_xor_b32 v14, 64, v13
    s_sub_u32 s52, s39, 20480
    s_cmp_eq_u32 s37, 0
    s_cselect_b32 s52, 0, s52
    s_add_u32 s97, s39, 71680
    s_add_u32 s98, s39, 92160
    s_cmp_eq_u32 s96, 0
    s_cselect_b32 s52, s52, s97
    s_cselect_b32 s53, s39, s98
    s_mul_i32 s54, s96, 9216
    s_add_u32 s54, s54, 86016
    s_waitcnt lgkmcnt(0)
    s_mov_b32 s40, s4
    s_and_b32 s41, s5, 0xffff
    s_mov_b32 s42, 2621440
    s_mov_b32 s43, 0x00020000
    s_mov_b32 m0, s54
    s_lshl_b32 s67, s67, 7
    s_add_u32 s59, s52, s67
    buffer_load_dwordx4 v13, s[40:43], s59 offen lds
    s_addk_i32 m0, 1024
    s_addk_i32 s59, 10240
    buffer_load_dwordx4 v14, s[40:43], s59 offen lds
    s_addk_i32 m0, 1024
    s_add_u32 s59, s53, s67
    buffer_load_dwordx4 v13, s[40:43], s59 offen lds
    s_addk_i32 m0, 1024
    s_addk_i32 s59, 10240
    buffer_load_dwordx4 v14, s[40:43], s59 offen lds
    s_addk_i32 m0, 1024
    s_addk_i32 s59, 10240
    buffer_load_dwordx4 v13, s[40:43], s59 offen lds
    s_addk_i32 m0, 1024
    s_addk_i32 s59, 10240
    buffer_load_dwordx4 v14, s[40:43], s59 offen lds
    s_addk_i32 m0, 1024
    s_addk_i32 s59, 10240
    buffer_load_dwordx4 v13, s[40:43], s59 offen lds
    s_addk_i32 m0, 1024
    s_addk_i32 s59, 10240
    buffer_load_dwordx4 v14, s[40:43], s59 offen lds
    s_addk_i32 m0, 1024
    s_addk_i32 s59, 10240
    buffer_load_dwordx4 v13, s[40:43], s59 offen lds
    s_branch L_ld_x_c
L_lw:
    v_and_b32 v7, 2, v4
    v_xor_b32 v7, v7, v5
    v_mul_u32_u24 v6, 3840, v4
    v_lshl_add_u32 v13, v7, 4, v6
    s_lshl_b32 s97, s38, 7
    v_add_u32 v13, s97, v13
    v_xor_b32 v14, 64, v13
    s_mul_i32 s54, s96, 12288
    s_add_u32 s54, s54, 104448
    s_mul_i32 s52, s96, 122880
    s_waitcnt lgkmcnt(0)
    s_mov_b32 s44, s18
    s_and_b32 s45, s19, 0xffff
    s_mov_b32 s46, 2457600
    s_mov_b32 s47, 0x00020000
    s_mov_b32 m0, s54
    s_mul_i32 s59, s67, 245760
    s_add_u32 s59, s59, s52
    buffer_load_dwordx4 v13, s[44:47], s59 offen lds
    s_addk_i32 m0, 1024
    s_addk_i32 s59, 1280
    buffer_load_dwordx4 v13, s[44:47], s59 offen lds
    s_addk_i32 m0, 1024
    s_addk_i32 s59, 1280
    buffer_load_dwordx4 v13, s[44:47], s59 offen lds
    s_addk_i32 m0, 1024
    s_addk_i32 s59, 28160
    buffer_load_dwordx4 v14, s[44:47], s59 offen lds
    s_addk_i32 m0, 1024
    s_addk_i32 s59, 1280
    buffer_load_dwordx4 v14, s[44:47], s59 offen lds
    s_addk_i32 m0, 1024
    s_addk_i32 s59, 1280
    buffer_load_dwordx4 v14, s[44:47], s59 offen lds
    s_addk_i32 m0, 1024
    s_addk_i32 s59, 28160
    buffer_load_dwordx4 v13, s[44:47], s59 offen lds
    s_addk_i32 m0, 1024
    s_addk_i32 s59, 1280
    buffer_load_dwordx4 v13, s[44:47], s59 offen lds
    s_addk_i32 m0, 1024
    s_addk_i32 s59, 1280
    buffer_load_dwordx4 v13, s[44:47], s59 offen lds
    s_addk_i32 m0, 1024
    s_addk_i32 s59, 28160
    buffer_load_dwordx4 v14, s[44:47], s59 offen lds
    s_addk_i32 m0, 1024
    s_addk_i32 s59, 1280
    buffer_load_dwordx4 v14, s[44:47], s59 offen lds
    s_addk_i32 m0, 1024
    s_addk_i32 s59, 1280
    buffer_load_dwordx4 v14, s[44:47], s59 offen lds
    s_branch L_ld_w_c
L_padb0:
    s_branch L_padb8
L_ld_x_c:
    s_load_dword s33, s[28:29], 0
    s_mov_b32 s76, s65
    s_mov_b32 s78, s65
    s_mov_b32 s67, s76
    s_add_u32 s76, s76, 1
    s_cmp_eq_u32 s76, 10
    s_cselect_b32 s76, 0, s76
    s_mov_b32 s67, s76
    s_add_u32 s76, s76, 1
    s_cmp_eq_u32 s76, 10
    s_cselect_b32 s76, 0, s76
    s_cmp_lg_u32 s32, 0
    s_cbranch_scc1 L_nogw
    s_mov_b32 s48, s22
    s_and_b32 s49, s23, 0xffff
    s_mov_b32 s50, 1280
    s_mov_b32 s51, 0x00020000
    v_lshlrev_b32 v4, 4, v0
    s_mov_b32 m0, 162048
    s_nop 0
    buffer_load_dwordx4 v4, s[48:51], 0 offen lds
    s_mov_b64 exec, 0xffff
    buffer_load_dwordx4 v4, s[48:51], 0 offen offset:1024 lds
    s_mov_b64 exec, -1
L_nogw:
    s_add_u32 s62, s54, 43008
    s_sub_u32 s54, s54, 86016
    s_mov_b32 s61, s54
    s_mov_b32 s55, 1
    s_mul_i32 s96, s36, 102400
    s_add_u32 s96, s96, 9437184
    s_add_u32 s48, s28, s96
    s_addc_u32 s49, s29, 0
    s_and_b32 s49, s49, 0xffff
    s_mov_b32 s50, 102400
    s_mov_b32 s51, 0x00020000
    v_lshlrev_b32 v19, 4, v0
    s_lshl_b32 s66, s30, 5
    s_add_u32 s66, s66, s31
    s_lshl_b32 s66, s66, 8
    s_add_u32 s66, s66, 65536
    s_add_u32 s66, s66, 128
    v_lshrrev_b32 v5, 1, v1
    v_xor_b32 v5, v5, v2
    v_lshlrev_b32 v5, 4, v5
    v_lshl_add_u32 v5, v1, 7, v5
    s_lshl_b32 s97, s32, 6
    v_xor_b32 v5, s97, v5
    s_and_b32 s96, s38, 7
    s_lshl_b32 s96, s96, 11
    s_add_u32 s96, s96, 2048
    v_add_u32 v18, s96, v5
    s_add_u32 s97, s97, 162048
    v_lshl_add_u32 v17, v2, 4, s97
    s_mov_b32 s64, 86016
    v_mov_b64 v[20:21], 0
    v_mov_b64 v[22:23], 0
    v_mov_b64 v[24:25], 0
    v_mov_b64 v[26:27], 0
    v_mov_b64 v[28:29], 0
    v_mov_b64 v[30:31], 0
    s_lshl1_add_u32 s96, s35, s32
    s_mul_i32 s96, s96, 40960
    s_mul_i32 s97, s36, 160
    s_add_u32 s96, s96, s97
    v_add_u32 v4, 0, v0
    v_mul_u32_u24 v8, 6554, v4
    v_lshrrev_b32 v8, 16, v8
    v_mul_u32_u24 v8, 1120, v8
    v_lshl_add_u32 v4, v4, 4, s96
    v_add_u32 v8, v8, v4
    v_add_u32 v4, 64, v0
    v_mul_u32_u24 v9, 6554, v4
    v_lshrrev_b32 v9, 16, v9
    v_mul_u32_u24 v9, 1120, v9
    v_lshl_add_u32 v4, v4, 4, s96
    v_add_u32 v9, v9, v4
    v_add_u32 v4, 128, v0
    v_mul_u32_u24 v10, 6554, v4
    v_lshrrev_b32 v10, 16, v10
    v_mul_u32_u24 v10, 1120, v10
    v_lshl_add_u32 v4, v4, 4, s96
    v_add_u32 v10, v10, v4
    v_add_u32 v4, 192, v0
    v_mul_u32_u24 v11, 6554, v4
    v_lshrrev_b32 v11, 16, v11
    v_mul_u32_u24 v11, 1120, v11
    v_lshl_add_u32 v4, v4, 4, s96
    v_add_u32 v11, v11, v4
    v_add_u32 v4, 256, v0
    v_mul_u32_u24 v12, 6554, v4
    v_lshrrev_b32 v12, 16, v12
    v_mul_u32_u24 v12, 1120, v12
    v_lshl_add_u32 v4, v4, 4, s96
    v_add_u32 v12, v12, v4
    s_waitcnt lgkmcnt(0)
    s_mul_i32 s33, s33, 1664525
    s_add_u32 s33, s33, 1013904223
    s_branch L_ld_x_i
L_ld_x:
    s_mov_b32 s68, s78
    s_add_u32 s78, s78, 1
    s_cmp_eq_u32 s78, 10
    s_cselect_b32 s78, 0, s78
    s_lshl_b32 s68, s68, 7
    v_add_u32 v15, s64, v18
    v_add_u32 v16, s68, v17
    ds_read_b128 v[24:27], v15
    ds_read_b128 v[28:31], v16
    s_add_u32 s64, s64, 43008
    s_cmp_eq_u32 s64, 129024
    s_cselect_b32 s64, 0, s64
L_ld_x_i:
    s_mov_b32 m0, s54
    s_lshl_b32 s67, s67, 7
    s_add_u32 s59, s52, s67
    buffer_load_dwordx4 v13, s[40:43], s59 offen lds
    s_addk_i32 m0, 1024
    s_addk_i32 s59, 10240
    buffer_load_dwordx4 v14, s[40:43], s59 offen lds
    s_addk_i32 m0, 1024
    s_add_u32 s59, s53, s67
    buffer_load_dwordx4 v13, s[40:43], s59 offen lds
    s_addk_i32 m0, 1024
    s_addk_i32 s59, 10240
    buffer_load_dwordx4 v14, s[40:43], s59 offen lds
    s_addk_i32 m0, 1024
    s_addk_i32 s59, 10240
    buffer_load_dwordx4 v13, s[40:43], s59 offen lds
    s_addk_i32 m0, 1024
    s_addk_i32 s59, 10240
    s_waitcnt lgkmcnt(0)
    v_mfma_f32_16x16x32_bf16 v[20:23], v[28:31], v[24:27], v[20:23]
    s_cmp_lt_u32 s55, 9
    s_cbranch_scc1 Lmp_1
    s_load_dwordx4 s[88:91], s[28:29], s66 glc
Lmp_1:
    buffer_load_dwordx4 v14, s[40:43], s59 offen lds
    s_addk_i32 m0, 1024
    s_addk_i32 s59, 10240
    buffer_load_dwordx4 v13, s[40:43], s59 offen lds
    s_addk_i32 m0, 1024
    s_addk_i32 s59, 10240
    buffer_load_dwordx4 v14, s[40:43], s59 offen lds
    s_addk_i32 m0, 1024
    s_addk_i32 s59, 10240
    buffer_load_dwordx4 v13, s[40:43], s59 offen lds
    s_mov_b32 s67, s76
    s_add_u32 s76, s76, 1
    s_cmp_eq_u32 s76, 10
    s_cselect_b32 s76, 0, s76
    s_add_u32 s54, s54, 43008
    s_cmp_eq_u32 s54, s62
    s_cselect_b32 s54, s61, s54
    s_add_u32 s55, s55, 1
    s_cmp_eq_u32 s55, 2
    s_cbranch_scc1 L_ld_x_e
L_ld_x_w:
    s_waitcnt vmcnt(9)
L_ld_x_b:
    s_barrier
    s_cmp_lt_u32 s55, 10
    s_cbranch_scc1 L_ld_x
    s_mov_b32 s68, s78
    s_add_u32 s78, s78, 1
    s_cmp_eq_u32 s78, 10
    s_cselect_b32 s78, 0, s78
    s_lshl_b32 s68, s68, 7
    v_add_u32 v15, s64, v18
    v_add_u32 v16, s68, v17
    ds_read_b128 v[24:27], v15
    ds_read_b128 v[28:31], v16
    s_add_u32 s64, s64, 43008
    s_cmp_eq_u32 s64, 129024
    s_cselect_b32 s64, 0, s64
    s_waitcnt lgkmcnt(0)
    v_mfma_f32_16x16x32_bf16 v[20:23], v[28:31], v[24:27], v[20:23]
    s_branch L_ld_end
L_ld_w_e:
    s_barrier
    s_branch L_ld_w_w
L_padb1:
    s_branch L_padb9
L_ld_x_e:
    s_barrier
    s_cmp_lg_u32 s32, 1
    s_cbranch_scc1 L_ld_x_w
    s_lshl_b32 s96, s30, 5
    s_add_u32 s96, s96, s31
    s_lshl_b32 s96, s96, 8
    s_add_u32 s96, s96, 65536
    v_lshl_add_u32 v4, v0, 3, s96
    v_mov_b32 v6, 0
    s_and_b32 s97, s33, 0xffffff00
    v_mov_b32 v7, s97
    s_getreg_b32 s97, hwreg(HW_REG_XCC_ID, 0, 4)
    v_writelane_b32 v6, s33, 3
    v_writelane_b32 v7, s97, 3
    s_mov_b64 exec, 0xffff
    global_store_dwordx2 v4, v[6:7], s[28:29] sc1
    s_mov_b64 exec, -1
    s_waitcnt vmcnt(10)
    s_branch L_ld_x_b
L_ld_w_c:
    s_load_dword s33, s[28:29], 0
    s_mov_b32 s76, s65
    s_mov_b32 s78, s65
    s_mov_b32 s67, s76
    s_add_u32 s76, s76, 1
    s_cmp_eq_u32 s76, 10
    s_cselect_b32 s76, 0, s76
    s_mov_b32 s67, s76
    s_add_u32 s76, s76, 1
    s_cmp_eq_u32 s76, 10
    s_cselect_b32 s76, 0, s76
    s_add_u32 s62, s54, 43008
    s_sub_u32 s54, s54, 86016
    s_mov_b32 s61, s54
    s_mov_b32 s55, 1
    s_mul_i32 s96, s36, 102400
    s_add_u32 s96, s96, 9437184
    s_add_u32 s48, s28, s96
    s_addc_u32 s49, s29, 0
    s_and_b32 s49, s49, 0xffff
    s_mov_b32 s50, 102400
    s_mov_b32 s51, 0x00020000
    v_lshlrev_b32 v19, 4, v0
    s_lshl_b32 s66, s30, 5
    s_add_u32 s66, s66, s31
    s_lshl_b32 s66, s66, 8
    s_add_u32 s66, s66, 65536
    s_add_u32 s66, s66, 128
    v_mov_b32 v8, 0
    v_mov_b32 v9, 0
    v_mov_b32 v10, 0
    v_mov_b32 v11, 0
    v_mov_b32 v12, 0
    s_mov_b32 s40, s4
    s_and_b32 s41, s5, 0xffff
    s_mov_b32 s42, 2621440
    s_mov_b32 s43, 0x00020000
    s_waitcnt lgkmcnt(0)
    s_mul_i32 s33, s33, 1664525
    s_add_u32 s33, s33, 1013904223
L_ld_w:
    s_cmp_lt_u32 s55, 9
    s_cbranch_scc1 Lmp_2
    s_load_dwordx4 s[88:91], s[28:29], s66 glc
Lmp_2:
    s_mov_b32 m0, s54
    s_mul_i32 s59, s67, 245760
    s_add_u32 s59, s59, s52
    buffer_load_dwordx4 v13, s[44:47], s59 offen lds
    s_addk_i32 m0, 1024
    s_addk_i32 s59, 1280
    buffer_load_dwordx4 v13, s[44:47], s59 offen lds
    s_addk_i32 m0, 1024
    s_addk_i32 s59, 1280
    buffer_load_dwordx4 v13, s[44:47], s59 offen lds
    s_addk_i32 m0, 1024
    s_addk_i32 s59, 28160
    buffer_load_dwordx4 v14, s[44:47], s59 offen lds
    s_addk_i32 m0, 1024
    s_addk_i32 s59, 1280
    buffer_load_dwordx4 v14, s[44:47], s59 offen lds
    s_addk_i32 m0, 1024
    s_addk_i32 s59, 1280
    buffer_load_dwordx4 v14, s[44:47], s59 offen lds
    s_addk_i32 m0, 1024
    s_addk_i32 s59, 28160
    buffer_load_dwordx4 v13, s[44:47], s59 offen lds
    s_addk_i32 m0, 1024
    s_addk_i32 s59, 1280
    buffer_load_dwordx4 v13, s[44:47], s59 offen lds
    s_addk_i32 m0, 1024
    s_addk_i32 s59, 1280
    buffer_load_dwordx4 v13, s[44:47], s59 offen lds
    s_addk_i32 m0, 1024
    s_addk_i32 s59, 28160
    buffer_load_dwordx4 v14, s[44:47], s59 offen lds
    s_addk_i32 m0, 1024
    s_addk_i32 s59, 1280
    buffer_load_dwordx4 v14, s[44:47], s59 offen lds
    s_addk_i32 m0, 1024
    s_addk_i32 s59, 1280
    buffer_load_dwordx4 v14, s[44:47], s59 offen lds
    s_mov_b32 s67, s76
    s_add_u32 s76, s76, 1
    s_cmp_eq_u32 s76, 10
    s_cselect_b32 s76, 0, s76
    s_add_u32 s54, s54, 43008
    s_cmp_eq_u32 s54, s62
    s_cselect_b32 s54, s61, s54
    s_add_u32 s55, s55, 1
    s_cmp_eq_u32 s55, 2
    s_cbranch_scc1 L_ld_w_e
L_ld_w_w:
    s_waitcnt vmcnt(12)
L_ld_w_b:
    s_barrier
    s_cmp_lt_u32 s55, 10
    s_cbranch_scc1 L_ld_w
L_ld_end:
    s_waitcnt lgkmcnt(0)
    s_cmp_eq_u32 s90, s33
    s_cbranch_scc1 L_wo_mk
    s_lshl_b32 s98, s30, 5
    s_add_u32 s98, s98, s31
    s_lshl_b32 s98, s98, 8
    s_add_u32 s98, s98, 65536
    s_add_u32 s98, s98, 128
    s_mov_b32 s100, 0
Lc_3:
    s_load_dwordx4 s[88:91], s[28:29], s98 glc
    s_waitcnt lgkmcnt(0)
    s_cmp_eq_u32 s90, s33
    s_cbranch_scc1 Lcd_4
    s_sleep 2
    s_add_u32 s100, s100, 1
    s_cmp_lt_u32 s100, 1048576
    s_cbranch_scc1 Lc_3
    s_mov_b32 s91, 2
Lcd_4:
L_wo_mk:
    s_cmp_eq_u32 s91, 1
    s_cselect_b32 s99, 0, 15728640
    s_add_u32 s16, s28, s99
    s_addc_u32 s17, s29, 0
    s_cmp_lg_u32 s32, 2
    s_cbranch_scc1 L_wo_nc
    s_mov_b32 s44, s28
    s_and_b32 s45, s29, 0xffff
    s_mov_b32 s46, 1048576
    s_mov_b32 s47, 0x00020000
    v_lshlrev_b32 v4, 2, v0
    s_mov_b32 m0, 161152
    s_mov_b64 exec, 3
    s_add_u32 s66, s66, 8
    buffer_load_dword v4, s[44:47], s66 offen sc1 lds
    s_mov_b64 exec, -1
L_wo_nc:
    s_cmp_ge_u32 s32, 2
    s_cbranch_scc1 L_wo_a2
    s_mul_i32 m0, s32, 5120
    s_nop 0
    buffer_load_dwordx4 v8, s[40:43], 0 offen lds
    s_addk_i32 m0, 1024
    s_nop 0
    buffer_load_dwordx4 v9, s[40:43], 0 offen lds
    s_addk_i32 m0, 1024
    s_nop 0
    buffer_load_dwordx4 v10, s[40:43], 0 offen lds
    s_addk_i32 m0, 1024
    s_nop 0
    buffer_load_dwordx4 v11, s[40:43], 0 offen lds
    s_addk_i32 m0, 1024
    s_nop 0
    buffer_load_dwordx4 v12, s[40:43], 0 offen lds
    s_mov_b32 s59, 24576
    s_cmp_eq_u32 s32, 1
    s_cselect_b32 s59, 28672, s59
    s_add_u32 m0, s59, 10240
    s_nop 0
    buffer_load_dwordx4 v19, s[48:51], s59 offen offset:0 sc1 lds
    buffer_load_dwordx4 v19, s[48:51], s59 offen offset:1024 sc1 lds
    buffer_load_dwordx4 v19, s[48:51], s59 offen offset:2048 sc1 lds
    buffer_load_dwordx4 v19, s[48:51], s59 offen offset:3072 sc1 lds
    s_waitcnt vmcnt(9)
    s_branch L_wo_a3
L_padb2:
    s_branch L_padb10
L_wo_a2:
    s_mov_b32 s59, 0
    s_cmp_eq_u32 s32, 1
    s_cselect_b32 s59, 0, s59
    s_cmp_eq_u32 s32, 2
    s_cselect_b32 s59, 0, s59
    s_cmp_eq_u32 s32, 3
    s_cselect_b32 s59, 12288, s59
    s_add_u32 m0, s59, 10240
    s_nop 0
    buffer_load_dwordx4 v19, s[48:51], s59 offen offset:0 sc1 lds
    buffer_load_dwordx4 v19, s[48:51], s59 offen offset:1024 sc1 lds
    buffer_load_dwordx4 v19, s[48:51], s59 offen offset:2048 sc1 lds
    buffer_load_dwordx4 v19, s[48:51], s59 offen offset:3072 sc1 lds
    s_addk_i32 m0, 4096
    s_addk_i32 s59, 4096
    buffer_load_dwordx4 v19, s[48:51], s59 offen offset:0 sc1 lds
    buffer_load_dwordx4 v19, s[48:51], s59 offen offset:1024 sc1 lds
    buffer_load_dwordx4 v19, s[48:51], s59 offen offset:2048 sc1 lds
    buffer_load_dwordx4 v19, s[48:51], s59 offen offset:3072 sc1 lds
    s_addk_i32 m0, 4096
    s_addk_i32 s59, 4096
    buffer_load_dwordx4 v19, s[48:51], s59 offen offset:0 sc1 lds
    buffer_load_dwordx4 v19, s[48:51], s59 offen offset:1024 sc1 lds
    buffer_load_dwordx4 v19, s[48:51], s59 offen offset:2048 sc1 lds
    buffer_load_dwordx4 v19, s[48:51], s59 offen offset:3072 sc1 lds
    s_waitcnt vmcnt(12)
L_wo_a3:
    s_barrier
    s_cmp_ge_u32 s32, 2
    s_cbranch_scc1 L_wo_n9
    s_mov_b32 s68, s78
    s_add_u32 s78, s78, 1
    s_cmp_eq_u32 s78, 10
    s_cselect_b32 s78, 0, s78
    s_lshl_b32 s68, s68, 7
    v_add_u32 v15, s64, v18
    v_add_u32 v16, s68, v17
    ds_read_b128 v[24:27], v15
    ds_read_b128 v[28:31], v16
    s_add_u32 s64, s64, 43008
    s_cmp_eq_u32 s64, 129024
    s_cselect_b32 s64, 0, s64
L_wo_n9:
    s_mov_b32 s59, 32768
    s_cmp_eq_u32 s32, 1
    s_cselect_b32 s59, 36864, s59
    s_cmp_eq_u32 s32, 2
    s_cselect_b32 s59, 41984, s59
    s_cmp_eq_u32 s32, 3
    s_cselect_b32 s59, 46080, s59
    s_add_u32 s96, s59, 10240
    v_add_u32 v32, s96, v19
    buffer_load_dwordx4 v[40:43], v19, s[48:51], s59 offen offset:0 sc1
    buffer_load_dwordx4 v[44:47], v19, s[48:51], s59 offen offset:1024 sc1
    buffer_load_dwordx4 v[48:51], v19, s[48:51], s59 offen offset:2048 sc1
    buffer_load_dwordx4 v[52:55], v19, s[48:51], s59 offen offset:3072 sc1
    s_addk_i32 s59, 4096
    buffer_load_dwordx4 v[56:59], v19, s[48:51], s59 offen offset:0 sc1
    s_mov_b32 s59, 51200
    s_cmp_eq_u32 s32, 1
    s_cselect_b32 s59, 63488, s59
    s_cmp_eq_u32 s32, 2
    s_cselect_b32 s59, 76800, s59
    s_cmp_eq_u32 s32, 3
    s_cselect_b32 s59, 89088, s59
    s_add_u32 s96, s59, 10240
    v_add_u32 v33, s96, v19
    buffer_load_dwordx4 v[60:63], v19, s[48:51], s59 offen offset:0 sc1
    buffer_load_dwordx4 v[64:67], v19, s[48:51], s59 offen offset:1024 sc1
    buffer_load_dwordx4 v[68:71], v19, s[48:51], s59 offen offset:2048 sc1
    buffer_load_dwordx4 v[72:75], v19, s[48:51], s59 offen offset:3072 sc1
    s_addk_i32 s59, 4096
    buffer_load_dwordx4 v[76:79], v19, s[48:51], s59 offen offset:0 sc1
    buffer_load_dwordx4 v[80:83], v19, s[48:51], s59 offen offset:1024 sc1
    buffer_load_dwordx4 v[84:87], v19, s[48:51], s59 offen offset:2048 sc1
    buffer_load_dwordx4 v[88:91], v19, s[48:51], s59 offen offset:3072 sc1
    s_addk_i32 s59, 4096
    buffer_load_dwordx4 v[92:95], v19, s[48:51], s59 offen offset:0 sc1
    buffer_load_dwordx4 v[96:99], v19, s[48:51], s59 offen offset:1024 sc1
    buffer_load_dwordx4 v[100:103], v19, s[48:51], s59 offen offset:2048 sc1
    buffer_load_dwordx4 v[104:107], v19, s[48:51], s59 offen offset:3072 sc1
    s_addk_i32 s59, 4096
    buffer_load_dwordx4 v[108:111], v19, s[48:51], s59 offen offset:0 sc1
    s_waitcnt vmcnt(18)
    s_cmp_lt_u32 s32, 2
    s_cbranch_scc1 L_wo_g
    v_mov_b32 v4, 16
    s_mov_b64 exec, 1
    ds_add_u32 v3, v4 offset:268
    s_mov_b64 exec, -1
    s_branch L_wo_ng
L_wo_g:
    s_waitcnt lgkmcnt(0)
    v_mfma_f32_16x16x32_bf16 v[20:23], v[28:31], v[24:27], v[20:23]
    v_lshlrev_b32 v5, 2, v0
    v_add_u32 v5, 161792, v5
    s_cmp_eq_u32 s32, 0
    s_cbranch_scc1 L_wo_g0
    s_nop 3
    ds_write_b32 v5, v20
    v_mov_b32 v4, 1
    ds_write_b32 v3, v4 offset:172
    v_mov_b32 v4, 16
    s_mov_b64 exec, 1
    ds_add_u32 v3, v4 offset:268
    s_mov_b64 exec, -1
    s_branch L_wo_ng
L_wo_g0:
    v_mov_b32 v4, 16
    s_mov_b64 exec, 1
    ds_add_u32 v3, v4 offset:268
    s_mov_b64 exec, -1
    s_mov_b32 s100, 0
Lw_5:
    ds_read_b32 v4, v3 offset:172
    s_waitcnt lgkmcnt(0)
    v_readfirstlane_b32 s99, v4
    s_cmp_ge_u32 s99, 1
    s_cbranch_scc1 Lwd_6
    s_add_u32 s100, s100, 1
    s_cmp_lt_u32 s100, 1048576
    s_cbranch_scc1 Lw_5
Lwd_6:
    ds_read_b32 v21, v5
    s_waitcnt lgkmcnt(0)
    v_add_f32 v20, v20, v21
    v_cvt_pk_bf16_f32 v20, v20, v20
    v_and_b32 v20, 0xffff0000, v20
    v_mul_f32 v20, 0xbfb8aa3b, v20
    v_exp_f32 v20, v20
    s_nop 0
    v_add_f32 v20, 1.0, v20
    v_rcp_f32 v20, v20
    s_nop 0
    v_cvt_pk_bf16_f32 v20, v20, v20
    v_and_b32 v21, 0xffff0000, v20
    v_mov_b32 v20, s33
    s_and_b32 s96, s37, 1
    s_lshl3_add_u32 s96, s96, s38
    s_lshl_b32 s96, s96, 7
    s_mul_i32 s97, s30, 262144
    s_add_u32 s96, s96, s97
    s_add_u32 s96, s96, 7537664
    v_lshl_add_u32 v5, v1, 3, s96
    s_cmp_ge_u32 s38, 8
    s_cbranch_scc1 L_wo_ng
    s_mov_b64 exec, 0xffff
    s_cmp_lg_u32 s91, 1
    s_cbranch_scc1 Ldg_7
    global_store_dwordx2 v5, v[20:21], s[16:17]
    s_branch Ldd_8
L_pada0:
    s_branch L_pada8
L_padb3:
    s_branch L_padb11
Ldg_7:
    global_store_dwordx2 v5, v[20:21], s[16:17] sc1
Ldd_8:
    s_mov_b64 exec, -1
L_wo_ng:
    s_waitcnt vmcnt(0)
    s_cmp_eq_u32 s32, 3
    s_cbranch_scc1 L_help
L_wo_fl:
    s_lshl_b32 s96, s30, 5
    s_add_u32 s96, s96, s31
    s_lshl_b32 s96, s96, 8
    s_add_u32 s96, s96, 65536
    s_lshl3_add_u32 s96, s32, s96
    s_add_u32 s40, s28, s96
    s_addc_u32 s41, s29, 0
    s_mul_i32 s96, s36, 327680
    s_mul_i32 s97, s32, 163840
    s_add_u32 s96, s96, s97
    s_lshl_b32 s97, s35, 7
    s_add_u32 s96, s96, s97
    s_add_u32 s96, s96, 4194304
    v_lshrrev_b32 v126, 3, v0
    v_and_b32 v127, 7, v0
    v_and_b32 v125, 6, v126
    v_xor_b32 v125, v125, v127
    v_lshlrev_b32 v125, 4, v125
    v_lshl_add_u32 v125, v126, 7, v125
    s_mul_i32 s97, s32, 5120
    s_add_u32 s97, s97, 112640
    v_add_u32 v125, s97, v125
    v_lshlrev_b32 v126, 12, v126
    v_lshl_add_u32 v126, v127, 4, v126
    v_add_u32 v120, s96, v126
    v_add_u32 v121, 32768, v120
    v_add_u32 v122, 65536, v120
    v_add_u32 v123, 98304, v120
    v_add_u32 v124, 131072, v120
    s_and_b32 s44, s33, 0xffffff00
    s_add_u32 s44, s44, 0x600
    s_mov_b32 s100, 0
Lw_9:
    ds_read_b32 v4, v3 offset:196
    s_waitcnt lgkmcnt(0)
    v_readfirstlane_b32 s99, v4
    s_cmp_ge_u32 s99, 0
    s_cbranch_scc1 Lwd_10
    s_sleep 2
    s_add_u32 s100, s100, 1
    s_cmp_lt_u32 s100, 1048576
    s_cbranch_scc1 Lw_9
Lwd_10:
    ds_write_b128 v32, v[40:43] offset:0
    ds_write_b128 v32, v[44:47] offset:1024
    ds_write_b128 v32, v[48:51] offset:2048
    ds_write_b128 v32, v[52:55] offset:3072
    s_waitcnt lgkmcnt(4)
    ds_write_b128 v32, v[56:59] offset:4096
    v_mov_b32 v4, 1
    s_mov_b64 exec, 1
    ds_add_u32 v3, v4 offset:200
    s_mov_b64 exec, -1
    s_mov_b32 s100, 0
Lw_11:
    ds_read_b32 v4, v3 offset:196
    s_waitcnt lgkmcnt(0)
    v_readfirstlane_b32 s99, v4
    s_cmp_ge_u32 s99, 8
    s_cbranch_scc1 Lwd_12
    s_sleep 2
    s_add_u32 s100, s100, 1
    s_cmp_lt_u32 s100, 1048576
    s_cbranch_scc1 Lw_11
Lwd_12:
    s_mov_b32 s100, 0
Lw_13:
    ds_read_b32 v4, v3 offset:268
    s_waitcnt lgkmcnt(0)
    v_readfirstlane_b32 s99, v4
    s_cmp_ge_u32 s99, 72
    s_cbranch_scc1 Lwd_14
    s_sleep 1
    s_add_u32 s100, s100, 1
    s_cmp_lt_u32 s100, 1048576
    s_cbranch_scc1 Lw_13
Lwd_14:
    ds_write_b128 v33, v[60:63] offset:0
    ds_write_b128 v33, v[64:67] offset:1024
    ds_write_b128 v33, v[68:71] offset:2048
    ds_write_b128 v33, v[72:75] offset:3072
    s_waitcnt lgkmcnt(4)
    ds_write_b128 v33, v[76:79] offset:4096
    ds_write_b128 v33, v[80:83] offset:5120
    ds_write_b128 v33, v[84:87] offset:6144
    ds_write_b128 v33, v[88:91] offset:7168
    s_waitcnt lgkmcnt(4)
    ds_write_b128 v33, v[92:95] offset:8192
    ds_write_b128 v33, v[96:99] offset:9216
    ds_write_b128 v33, v[100:103] offset:10240
    ds_write_b128 v33, v[104:107] offset:11264
    s_waitcnt lgkmcnt(4)
    ds_write_b128 v33, v[108:111] offset:12288
    v_mov_b32 v4, 1
    s_mov_b64 exec, 1
    ds_add_u32 v3, v4 offset:204
    s_mov_b64 exec, -1
    s_cmp_lt_u32 s32, 2
    s_cbranch_scc1 L_aux
    s_endpgm
L_help:
    s_and_b32 s96, s35, 3
    s_lshl_b32 s96, s96, 9
    s_mul_i32 s97, s30, 262144
    s_add_u32 s96, s96, s97
    s_add_u32 s96, s96, 7537664
    v_lshl_add_u32 v14, v0, 3, s96
    v_lshl_add_u32 v13, v0, 2, v3
    s_mov_b32 s100, 0
L_gchk:
    global_load_dwordx2 v[18:19], v14, s[16:17] sc1
    s_waitcnt vmcnt(0)
    v_cmp_ne_u32 vcc, s33, v18
    s_cbranch_vccz L_gok
    s_sleep 4
    s_add_u32 s100, s100, 1
    s_cmp_lt_u32 s100, 1048576
    s_cbranch_scc1 L_gchk
L_gok:
    v_sub_f32 v18, 1.0, v19
    ds_write_b32 v13, v19 offset:768
    ds_write_b32 v13, v18 offset:512
    v_mov_b32 v4, 1
    s_mov_b64 exec, 1
    ds_add_u32 v3, v4 offset:208
    s_mov_b64 exec, -1
    s_cmp_eq_u32 s34, 0
    s_cbranch_scc1 L_wo_fl
    s_mul_i32 s96, s30, 262144
    s_and_b32 s97, s35, 3
    s_lshl_b32 s97, s97, 8
    s_add_u32 s96, s96, s97
    s_add_u32 s96, s96, 7536640
    v_lshl_add_u32 v12, v0, 2, s96
    s_mov_b32 exec_hi, 1048575
    s_mov_b32 exec_lo, 0xfffff
    s_mov_b32 s100, 0
L_rl1:
    global_load_dword v5, v12, s[16:17] sc1
    s_waitcnt vmcnt(0)
    v_cmp_ne_u32 vcc, s33, v5
    s_cbranch_vccz L_rd1
    s_sleep 2
    s_add_u32 s100, s100, 1
    s_cmp_lt_u32 s100, 1048576
    s_cbranch_scc1 L_rl1
L_rd1:
    s_mov_b64 exec, -1
    v_mov_b32 v4, 1
    ds_write_b32 v3, v4 offset:276
    s_cmp_lg_u32 s2, 240
    s_cbranch_scc1 L_th_exit
L_th_exit:
    s_endpgm
L_pada1:
    s_branch L_pada9
L_as_nokv:
L_as_kv:
    s_sub_u32 s96, s31, 20
    s_mul_i32 s97, s96, 43
    s_lshr_b32 s97, s97, 7
    s_mul_i32 s98, s96, 7
    s_sub_u32 s98, s98, s97
    s_lshr_b32 s96, 0x924, s96
    s_and_b32 s96, s96, 1
    s_sub_u32 s64, 7, s96
    s_mul_i32 s97, s30, 80
    s_add_u32 s98, s98, s97
    s_add_u32 s56, s98, s32
    s_lshr_b32 s96, s56, 1
    s_lshl_b32 s96, s96, 2
    s_add_u32 s97, s96, 8
    s_min_u32 s97, s97, 1276
    s_load_dword s57, s[14:15], s96
    s_load_dword s58, s[14:15], s97
    s_lshl_b32 s98, s98, 12
    s_add_u32 s80, s12, s98
    s_addc_u32 s81, s13, 0
    s_and_b32 s81, s81, 0xffff
    s_lshl_b32 s82, s64, 12
    s_lshl_b32 s52, s32, 12
    s_add_u32 s53, s52, 16384
    v_lshlrev_b32 v18, 4, v0
    s_cmp_lt_u32 s38, 5
    s_cbranch_scc1 L_hpre
    s_waitcnt lgkmcnt(0)
    s_barrier
L_hpre:
    s_setprio 0
    s_waitcnt vmcnt(8)
    buffer_load_dwordx4 v[24:27], v18, s[80:83], s52 offen offset:0
    buffer_load_dwordx4 v[28:31], v18, s[80:83], s52 offen offset:1024
    buffer_load_dwordx4 v[32:35], v18, s[80:83], s52 offen offset:2048
    buffer_load_dwordx4 v[36:39], v18, s[80:83], s52 offen offset:3072
    buffer_load_dwordx4 v[40:43], v18, s[80:83], s53 offen offset:0
    buffer_load_dwordx4 v[44:47], v18, s[80:83], s53 offen offset:1024
    buffer_load_dwordx4 v[48:51], v18, s[80:83], s53 offen offset:2048
    buffer_load_dwordx4 v[52:55], v18, s[80:83], s53 offen offset:3072
    s_setprio 3
    s_cmp_ge_u32 s38, 5
    s_cbranch_scc1 L_hpost
    s_waitcnt vmcnt(8) lgkmcnt(0)
    s_barrier
L_hpost:
    s_mul_i32 s33, s33, 1664525
    s_add_u32 s33, s33, 1013904223
    s_mul_i32 s54, s32, 8320
    s_add_u32 s96, s54, 1008
    v_sub_u32 v19, s96, v18
    v_lshl_add_u32 v20, v1, 2, s54
    s_lshl_b32 s96, s32, 2
    v_add_u32 v21, s96, v3
    v_mov_b32 v22, 0
    s_cmp_ge_u32 s38, 5
    s_cbranch_scc1 L_nohello
    s_mov_b32 s100, 0
Lw_15:
    ds_read_b32 v4, v3 offset:256
    s_waitcnt lgkmcnt(0)
    v_readfirstlane_b32 s99, v4
    s_cmp_ge_u32 s99, 8
    s_cbranch_scc1 Lwd_16
    s_sleep 1
    s_add_u32 s100, s100, 1
    s_cmp_lt_u32 s100, 1048576
    s_cbranch_scc1 Lw_15
Lwd_16:
    s_cmp_lg_u32 s32, 3
    s_cbranch_scc1 L_nohello
    s_waitcnt vmcnt(0)
    s_lshl_b32 s96, s30, 5
    s_add_u32 s96, s96, s31
    s_lshl_b32 s96, s96, 8
    s_add_u32 s96, s96, 65536
    v_lshl_add_u32 v4, v0, 3, s96
    v_mov_b32 v6, 0
    s_and_b32 s97, s33, 0xffffff00
    v_mov_b32 v7, s97
    s_getreg_b32 s97, hwreg(HW_REG_XCC_ID, 0, 4)
    v_writelane_b32 v6, s33, 3
    v_writelane_b32 v7, s97, 3
    s_mov_b64 exec, 0xffff
    global_store_dwordx2 v4, v[6:7], s[28:29] sc1
    s_mov_b64 exec, -1
L_nohello:
    s_mov_b32 s98, 0xffff
    s_lshl_b32 s96, s56, 4
    s_lshr_b32 s96, s57, s96
    s_lshl_b32 s96, s96, 16
    s_waitcnt vmcnt(4)
    s_mov_b64 exec, 1
    v_lshlrev_b32 v4, 16, v24
    v_add_f32 v4, s96, v4
    v_cvt_pk_bf16_f32 v4, v4, v4
    v_bfi_b32 v24, s98, v4, v24
    s_mov_b64 exec, -1
    v_readlane_b32 s60, v27, 63
    v_readlane_b32 s61, v31, 63
    v_readlane_b32 s62, v35, 63
    v_mov_b32_dpp v56, v27 wave_shr:1 row_mask:0xf bank_mask:0xf
    v_mov_b32_dpp v57, v31 wave_shr:1 row_mask:0xf bank_mask:0xf
    v_mov_b32_dpp v58, v35 wave_shr:1 row_mask:0xf bank_mask:0xf
    v_mov_b32_dpp v59, v39 wave_shr:1 row_mask:0xf bank_mask:0xf
    v_writelane_b32 v56, 0, 0
    v_writelane_b32 v57, s60, 0
    v_writelane_b32 v58, s61, 0
    v_writelane_b32 v59, s62, 0
    v_alignbit_b32 v60, v27, v27, 16
    v_bfi_b32 v76, s98, v27, v26
    v_alignbit_b32 v61, v26, v26, 16
    v_bfi_b32 v77, s98, v26, v25
    v_alignbit_b32 v62, v25, v25, 16
    v_bfi_b32 v78, s98, v25, v24
    v_alignbit_b32 v63, v24, v24, 16
    v_bfi_b32 v79, s98, v24, v56
    ds_write_b128 v19, v[60:63] offset:3072
    ds_write_b128 v19, v[76:79] offset:7232
    v_alignbit_b32 v64, v31, v31, 16
    v_bfi_b32 v80, s98, v31, v30
    v_alignbit_b32 v65, v30, v30, 16
    v_bfi_b32 v81, s98, v30, v29
    v_alignbit_b32 v66, v29, v29, 16
    v_bfi_b32 v82, s98, v29, v28
    v_alignbit_b32 v67, v28, v28, 16
    v_bfi_b32 v83, s98, v28, v57
    ds_write_b128 v19, v[64:67] offset:2048
    ds_write_b128 v19, v[80:83] offset:6208
    v_alignbit_b32 v68, v35, v35, 16
    v_bfi_b32 v84, s98, v35, v34
    v_alignbit_b32 v69, v34, v34, 16
    v_bfi_b32 v85, s98, v34, v33
    v_alignbit_b32 v70, v33, v33, 16
    v_bfi_b32 v86, s98, v33, v32
    v_alignbit_b32 v71, v32, v32, 16
    v_bfi_b32 v87, s98, v32, v58
    ds_write_b128 v19, v[68:71] offset:1024
    ds_write_b128 v19, v[84:87] offset:5184
    v_alignbit_b32 v72, v39, v39, 16
    v_bfi_b32 v88, s98, v39, v38
    v_alignbit_b32 v73, v38, v38, 16
    v_bfi_b32 v89, s98, v38, v37
    v_alignbit_b32 v74, v37, v37, 16
    v_bfi_b32 v90, s98, v37, v36
    v_alignbit_b32 v75, v36, v36, 16
    v_bfi_b32 v91, s98, v36, v59
    ds_write_b128 v19, v[72:75] offset:0
    ds_write_b128 v19, v[88:91] offset:4160
    ds_write_b32 v20, v22 offset:4096
    ds_write_b32 v20, v22 offset:8256
    v_mov_b32 v4, 1
    ds_write_b32 v21, v4 offset:312
    s_waitcnt lgkmcnt(0)
    s_add_u32 s96, s32, 4
    s_cmp_ge_u32 s96, s64
    s_cbranch_scc1 L_hb1
    s_lshl_b32 s96, s56, 4
    s_lshr_b32 s96, s58, s96
    s_branch L_skip1107
L_pada2:
    s_branch L_pada10
L_skip1107:
    s_lshl_b32 s96, s96, 16
    s_waitcnt vmcnt(0)
    s_mov_b64 exec, 1
    v_lshlrev_b32 v4, 16, v40
    v_add_f32 v4, s96, v4
    v_cvt_pk_bf16_f32 v4, v4, v4
    v_bfi_b32 v40, s98, v4, v40
    s_mov_b64 exec, -1
    v_readlane_b32 s60, v43, 63
    v_readlane_b32 s61, v47, 63
    v_readlane_b32 s62, v51, 63
    v_mov_b32_dpp v56, v43 wave_shr:1 row_mask:0xf bank_mask:0xf
    v_mov_b32_dpp v57, v47 wave_shr:1 row_mask:0xf bank_mask:0xf
    v_mov_b32_dpp v58, v51 wave_shr:1 row_mask:0xf bank_mask:0xf
    v_mov_b32_dpp v59, v55 wave_shr:1 row_mask:0xf bank_mask:0xf
    v_writelane_b32 v56, 0, 0
    v_writelane_b32 v57, s60, 0
    v_writelane_b32 v58, s61, 0
    v_writelane_b32 v59, s62, 0
    v_alignbit_b32 v60, v43, v43, 16
    v_bfi_b32 v76, s98, v43, v42
    v_alignbit_b32 v61, v42, v42, 16
    v_bfi_b32 v77, s98, v42, v41
    v_alignbit_b32 v62, v41, v41, 16
    v_bfi_b32 v78, s98, v41, v40
    v_alignbit_b32 v63, v40, v40, 16
    v_bfi_b32 v79, s98, v40, v56
    ds_write_b128 v19, v[60:63] offset:36352
    ds_write_b128 v19, v[76:79] offset:40512
    v_alignbit_b32 v64, v47, v47, 16
    v_bfi_b32 v80, s98, v47, v46
    v_alignbit_b32 v65, v46, v46, 16
    v_bfi_b32 v81, s98, v46, v45
    v_alignbit_b32 v66, v45, v45, 16
    v_bfi_b32 v82, s98, v45, v44
    v_alignbit_b32 v67, v44, v44, 16
    v_bfi_b32 v83, s98, v44, v57
    ds_write_b128 v19, v[64:67] offset:35328
    ds_write_b128 v19, v[80:83] offset:39488
    v_alignbit_b32 v68, v51, v51, 16
    v_bfi_b32 v84, s98, v51, v50
    v_alignbit_b32 v69, v50, v50, 16
    v_bfi_b32 v85, s98, v50, v49
    v_alignbit_b32 v70, v49, v49, 16
    v_bfi_b32 v86, s98, v49, v48
    v_alignbit_b32 v71, v48, v48, 16
    v_bfi_b32 v87, s98, v48, v58
    ds_write_b128 v19, v[68:71] offset:34304
    ds_write_b128 v19, v[84:87] offset:38464
    v_alignbit_b32 v72, v55, v55, 16
    v_bfi_b32 v88, s98, v55, v54
    v_alignbit_b32 v73, v54, v54, 16
    v_bfi_b32 v89, s98, v54, v53
    v_alignbit_b32 v74, v53, v53, 16
    v_bfi_b32 v90, s98, v53, v52
    v_alignbit_b32 v75, v52, v52, 16
    v_bfi_b32 v91, s98, v52, v59
    ds_write_b128 v19, v[72:75] offset:33280
    ds_write_b128 v19, v[88:91] offset:37440
    ds_write_b32 v20, v22 offset:37376
    ds_write_b32 v20, v22 offset:41536
    v_mov_b32 v4, 1
    ds_write_b32 v21, v4 offset:328
    s_waitcnt lgkmcnt(0)
L_hb1:
    s_cmp_eq_u32 s32, 3
    s_cbranch_scc1 L_ahelp
    s_setprio 1
    s_mul_i32 s96, s36, 102400
    s_add_u32 s96, s96, 9437184
    s_add_u32 s48, s28, s96
    s_addc_u32 s49, s29, 0
    s_and_b32 s49, s49, 0xffff
    s_mov_b32 s50, 102400
    s_mov_b32 s51, 0x00020000
    v_lshlrev_b32 v19, 4, v0
    s_lshl1_add_u32 s96, s35, s32
    s_mul_i32 s96, s96, 40960
    s_mul_i32 s97, s36, 160
    s_add_u32 s96, s96, s97
    v_add_u32 v4, 0, v0
    v_mul_u32_u24 v8, 6554, v4
    v_lshrrev_b32 v8, 16, v8
    v_mul_u32_u24 v8, 1120, v8
    v_lshl_add_u32 v4, v4, 4, s96
    v_add_u32 v8, v8, v4
    v_add_u32 v4, 64, v0
    v_mul_u32_u24 v9, 6554, v4
    v_lshrrev_b32 v9, 16, v9
    v_mul_u32_u24 v9, 1120, v9
    v_lshl_add_u32 v4, v4, 4, s96
    v_add_u32 v9, v9, v4
    v_add_u32 v4, 128, v0
    v_mul_u32_u24 v10, 6554, v4
    v_lshrrev_b32 v10, 16, v10
    v_mul_u32_u24 v10, 1120, v10
    v_lshl_add_u32 v4, v4, 4, s96
    v_add_u32 v10, v10, v4
    v_add_u32 v4, 192, v0
    v_mul_u32_u24 v11, 6554, v4
    v_lshrrev_b32 v11, 16, v11
    v_mul_u32_u24 v11, 1120, v11
    v_lshl_add_u32 v4, v4, 4, s96
    v_add_u32 v11, v11, v4
    v_add_u32 v4, 256, v0
    v_mul_u32_u24 v12, 6554, v4
    v_lshrrev_b32 v12, 16, v12
    v_mul_u32_u24 v12, 1120, v12
    v_lshl_add_u32 v4, v4, 4, s96
    v_add_u32 v12, v12, v4
    s_mul_i32 s96, s32, 5120
    s_add_u32 s96, s96, 48128
    v_add_u32 v21, s96, v19
    s_mul_i32 s59, s32, 15360
    s_add_u32 s96, s59, 58368
    v_add_u32 v20, s96, v19
    s_add_u32 s60, s59, 51200
    s_setprio 3
    s_mov_b32 s100, 0
Lw_17:
    ds_read_b32 v4, v3 offset:280
    s_waitcnt lgkmcnt(0)
    v_readfirstlane_b32 s99, v4
    s_cmp_ge_u32 s99, 8
    s_cbranch_scc1 Lwd_18
    s_sleep 4
    s_add_u32 s100, s100, 1
    s_cmp_lt_u32 s100, 1048576
    s_cbranch_scc1 Lw_17
Lwd_18:
    s_mov_b32 s100, 0
Lw_19:
    ds_read_b32 v4, v3 offset:192
    s_waitcnt lgkmcnt(0)
    v_readfirstlane_b32 s99, v4
    s_cmp_ge_u32 s99, 1
    s_cbranch_scc1 Lwd_20
    s_sleep 2
    s_add_u32 s100, s100, 1
    s_cmp_lt_u32 s100, 1048576
    s_cbranch_scc1 Lw_19
Lwd_20:
    s_mov_b32 s59, 0
    s_cmp_eq_u32 s32, 1
    s_cselect_b32 s59, 17408, s59
    s_cmp_eq_u32 s32, 2
    s_cselect_b32 s59, 33792, s59
    s_add_u32 m0, s59, 109568
    s_nop 0
    buffer_load_dwordx4 v19, s[48:51], s59 offen offset:0 sc1 lds
    s_waitcnt vmcnt(3)
    s_branch L_skip1258
L_pada3:
    s_branch L_pada11
L_skip1258:
    buffer_load_dwordx4 v19, s[48:51], s59 offen offset:1024 sc1 lds
    s_waitcnt vmcnt(3)
    buffer_load_dwordx4 v19, s[48:51], s59 offen offset:2048 sc1 lds
    s_waitcnt vmcnt(3)
    buffer_load_dwordx4 v19, s[48:51], s59 offen offset:3072 sc1 lds
    s_addk_i32 m0, 4096
    s_addk_i32 s59, 4096
    s_waitcnt vmcnt(3)
    buffer_load_dwordx4 v19, s[48:51], s59 offen offset:0 sc1 lds
    s_waitcnt vmcnt(3)
    buffer_load_dwordx4 v19, s[48:51], s59 offen offset:1024 sc1 lds
    s_waitcnt vmcnt(3)
    buffer_load_dwordx4 v19, s[48:51], s59 offen offset:2048 sc1 lds
    s_waitcnt vmcnt(3)
    buffer_load_dwordx4 v19, s[48:51], s59 offen offset:3072 sc1 lds
    s_addk_i32 m0, 4096
    s_addk_i32 s59, 4096
    s_waitcnt vmcnt(3)
    buffer_load_dwordx4 v19, s[48:51], s59 offen offset:0 sc1 lds
    s_waitcnt vmcnt(3)
    buffer_load_dwordx4 v19, s[48:51], s59 offen offset:1024 sc1 lds
    s_waitcnt vmcnt(3)
    buffer_load_dwordx4 v19, s[48:51], s59 offen offset:2048 sc1 lds
    s_waitcnt vmcnt(3)
    buffer_load_dwordx4 v19, s[48:51], s59 offen offset:3072 sc1 lds
    s_addk_i32 m0, 4096
    s_addk_i32 s59, 4096
    s_waitcnt vmcnt(3)
    buffer_load_dwordx4 v19, s[48:51], s59 offen offset:0 sc1 lds
    s_waitcnt vmcnt(3)
    buffer_load_dwordx4 v19, s[48:51], s59 offen offset:1024 sc1 lds
    s_waitcnt vmcnt(3)
    buffer_load_dwordx4 v19, s[48:51], s59 offen offset:2048 sc1 lds
    s_waitcnt vmcnt(3)
    buffer_load_dwordx4 v19, s[48:51], s59 offen offset:3072 sc1 lds
    s_addk_i32 m0, 4096
    s_addk_i32 s59, 4096
    s_waitcnt vmcnt(3)
    buffer_load_dwordx4 v19, s[48:51], s59 offen offset:0 sc1 lds
    s_waitcnt vmcnt(3)
    s_mov_b32 s59, s60
    buffer_load_dwordx4 v[24:27], v19, s[48:51], s59 offen offset:0 sc1
    buffer_load_dwordx4 v[28:31], v19, s[48:51], s59 offen offset:1024 sc1
    buffer_load_dwordx4 v[32:35], v19, s[48:51], s59 offen offset:2048 sc1
    buffer_load_dwordx4 v[36:39], v19, s[48:51], s59 offen offset:3072 sc1
    s_addk_i32 s59, 4096
    buffer_load_dwordx4 v[40:43], v19, s[48:51], s59 offen offset:0 sc1
    buffer_load_dwordx4 v[44:47], v19, s[48:51], s59 offen offset:1024 sc1
    buffer_load_dwordx4 v[48:51], v19, s[48:51], s59 offen offset:2048 sc1
    buffer_load_dwordx4 v[52:55], v19, s[48:51], s59 offen offset:3072 sc1
    s_addk_i32 s59, 4096
    buffer_load_dwordx4 v[56:59], v19, s[48:51], s59 offen offset:0 sc1
    buffer_load_dwordx4 v[60:63], v19, s[48:51], s59 offen offset:1024 sc1
    buffer_load_dwordx4 v[64:67], v19, s[48:51], s59 offen offset:2048 sc1
    buffer_load_dwordx4 v[68:71], v19, s[48:51], s59 offen offset:3072 sc1
    s_addk_i32 s59, 4096
    buffer_load_dwordx4 v[72:75], v19, s[48:51], s59 offen offset:0 sc1
    buffer_load_dwordx4 v[76:79], v19, s[48:51], s59 offen offset:1024 sc1
    buffer_load_dwordx4 v[80:83], v19, s[48:51], s59 offen offset:2048 sc1
    s_cmp_lt_u32 s32, 2
    s_cbranch_scc1 L_ai_x
    s_addk_i32 s59, 3072
    buffer_load_dwordx4 v[84:87], v19, s[48:51], s59 offen offset:0 sc1
    buffer_load_dwordx4 v[88:91], v19, s[48:51], s59 offen offset:1024 sc1
    buffer_load_dwordx4 v[92:95], v19, s[48:51], s59 offen offset:2048 sc1
    buffer_load_dwordx4 v[96:99], v19, s[48:51], s59 offen offset:3072 sc1
    s_addk_i32 s59, 4096
    buffer_load_dwordx4 v[100:103], v19, s[48:51], s59 offen offset:0 sc1
    v_add_u32 v21, 15360, v20
    s_branch L_ai_d
L_pada4:
    s_branch L_pada12
L_ai_x:
    global_load_dwordx4 v[84:87], v8, s[4:5]
    global_load_dwordx4 v[88:91], v9, s[4:5]
    global_load_dwordx4 v[92:95], v10, s[4:5]
    global_load_dwordx4 v[96:99], v11, s[4:5]
    global_load_dwordx4 v[100:103], v12, s[4:5]
L_ai_d:
    s_waitcnt vmcnt(0)
    v_mov_b32 v4, 1
    s_mov_b64 exec, 1
    ds_add_u32 v3, v4 offset:200
    s_mov_b64 exec, -1
    s_lshl_b32 s96, s30, 5
    s_add_u32 s96, s96, s31
    s_lshl_b32 s96, s96, 8
    s_add_u32 s96, s96, 65536
    s_lshl3_add_u32 s96, s32, s96
    s_add_u32 s40, s28, s96
    s_addc_u32 s41, s29, 0
    s_mul_i32 s96, s36, 327680
    s_mul_i32 s97, s32, 163840
    s_add_u32 s96, s96, s97
    s_lshl_b32 s97, s35, 7
    s_add_u32 s96, s96, s97
    s_add_u32 s96, s96, 4194304
    v_lshrrev_b32 v126, 3, v0
    v_and_b32 v127, 7, v0
    v_and_b32 v125, 6, v126
    v_xor_b32 v125, v125, v127
    v_lshlrev_b32 v125, 4, v125
    v_lshl_add_u32 v125, v126, 7, v125
    s_mul_i32 s97, s32, 5120
    s_add_u32 s97, s97, 0
    v_add_u32 v125, s97, v125
    v_lshlrev_b32 v126, 12, v126
    v_lshl_add_u32 v126, v127, 4, v126
    v_add_u32 v120, s96, v126
    v_add_u32 v121, 32768, v120
    v_add_u32 v122, 65536, v120
    v_add_u32 v123, 98304, v120
    v_add_u32 v124, 131072, v120
    s_and_b32 s44, s33, 0xffffff00
    s_add_u32 s44, s44, 0x600
    s_mov_b32 s100, 0
Lw_21:
    ds_read_b32 v4, v3 offset:304
    s_waitcnt lgkmcnt(0)
    v_readfirstlane_b32 s99, v4
    s_cmp_ge_u32 s99, 1
    s_cbranch_scc1 Lwd_22
    s_sleep 8
    s_add_u32 s100, s100, 1
    s_cmp_lt_u32 s100, 1048576
    s_cbranch_scc1 Lw_21
Lwd_22:
    s_mov_b32 s100, 0
Lw_23:
    ds_read_b32 v4, v3 offset:196
    s_waitcnt lgkmcnt(0)
    v_readfirstlane_b32 s99, v4
    s_cmp_ge_u32 s99, 8
    s_cbranch_scc1 Lwd_24
    s_sleep 1
    s_add_u32 s100, s100, 1
    s_cmp_lt_u32 s100, 1048576
    s_cbranch_scc1 Lw_23
Lwd_24:
    ds_write_b128 v21, v[84:87] offset:0
    ds_write_b128 v21, v[88:91] offset:1024
    ds_write_b128 v21, v[92:95] offset:2048
    ds_write_b128 v21, v[96:99] offset:3072
    s_waitcnt lgkmcnt(4)
    ds_write_b128 v21, v[100:103] offset:4096
    s_lshr_b32 s96, s32, 1
    s_xor_b32 s96, s96, 1
    v_mov_b32 v4, s96
    s_mov_b64 exec, 1
    ds_add_u32 v3, v4 offset:376
    s_mov_b64 exec, -1
    s_setprio 0
    ds_write_b128 v20, v[24:27] offset:0
    ds_write_b128 v20, v[28:31] offset:1024
    ds_write_b128 v20, v[32:35] offset:2048
    ds_write_b128 v20, v[36:39] offset:3072
    s_waitcnt lgkmcnt(4)
    ds_write_b128 v20, v[40:43] offset:4096
    ds_write_b128 v20, v[44:47] offset:5120
    ds_write_b128 v20, v[48:51] offset:6144
    ds_write_b128 v20, v[52:55] offset:7168
    s_waitcnt lgkmcnt(4)
    ds_write_b128 v20, v[56:59] offset:8192
    ds_write_b128 v20, v[60:63] offset:9216
    ds_write_b128 v20, v[64:67] offset:10240
    ds_write_b128 v20, v[68:71] offset:11264
    s_waitcnt lgkmcnt(4)
    ds_write_b128 v20, v[72:75] offset:12288
    ds_write_b128 v20, v[76:79] offset:13312
    ds_write_b128 v20, v[80:83] offset:14336
    s_setprio 3
    v_mov_b32 v4, 1
    s_mov_b64 exec, 1
    ds_add_u32 v3, v4 offset:204
    s_mov_b64 exec, -1
    s_cmp_lt_u32 s32, 2
    s_cbranch_scc1 L_aux
    s_endpgm
L_pada5:
    s_branch L_pada13
L_ahelp:
    v_lshlrev_b32 v4, 2, v0
    v_add_u32 v4, 161792, v4
    v_mov_b32 v5, 0
    ds_write_b32 v4, v5
    s_cmp_lt_u32 s38, 5
    s_cbranch_scc1 L_hell2
    s_mov_b32 s100, 0
Lw_25:
    ds_read_b32 v4, v3 offset:256
    s_waitcnt lgkmcnt(0)
    v_readfirstlane_b32 s99, v4
    s_cmp_ge_u32 s99, 8
    s_cbranch_scc1 Lwd_26
    s_sleep 1
    s_add_u32 s100, s100, 1
    s_cmp_lt_u32 s100, 1048576
    s_cbranch_scc1 Lw_25
Lwd_26:
    s_lshl_b32 s96, s30, 5
    s_add_u32 s96, s96, s31
    s_lshl_b32 s96, s96, 8
    s_add_u32 s96, s96, 65536
    v_lshl_add_u32 v4, v0, 3, s96
    v_mov_b32 v6, 0
    s_and_b32 s97, s33, 0xffffff00
    v_mov_b32 v7, s97
    s_getreg_b32 s97, hwreg(HW_REG_XCC_ID, 0, 4)
    v_writelane_b32 v6, s33, 3
    v_writelane_b32 v7, s97, 3
    s_mov_b64 exec, 0xffff
    global_store_dwordx2 v4, v[6:7], s[28:29] sc1
    s_mov_b64 exec, -1
L_hell2:
    s_cmp_lg_u32 s31, 30
    s_cbranch_scc1 L_nocen
    s_lshl_b32 s96, s30, 13
    s_add_u32 s96, s96, 65536
    v_and_b32 v4, 31, v0
    v_lshl_add_u32 v20, v4, 8, s96
    v_and_b32 v4, 7, v0
    v_bfe_u32 v5, v0, 3, 1
    v_lshl_add_u32 v4, v4, 5, v5
    v_lshlrev_b32 v4, 8, v4
    s_mov_b32 exec_lo, 0
    v_add_u32 v20, 73216, v4
    s_mov_b32 exec_lo, -1
    v_mov_b32 v24, 0
    v_mov_b32 v25, 0
    s_mov_b32 s60, -1
    s_mov_b32 s61, 0xffff
    s_mov_b64 exec, s[60:61]
    s_mov_b32 s100, 0
L_hpg:
    global_atomic_or_x2 v[26:27], v20, v[24:25], s[28:29] offset:24 sc0 sc1
    s_waitcnt vmcnt(0)
    v_cmp_ne_u32 vcc, s33, v26
    s_cbranch_vccz L_hdg
    s_mov_b64 exec, vcc
    s_sleep 2
    s_add_u32 s100, s100, 1
    s_cmp_lt_u32 s100, 1048576
    s_cbranch_scc1 L_hpg
L_hdg:
    s_mov_b64 exec, -1
    v_readfirstlane_b32 s96, v27
    s_nop 1
    v_cmp_ne_u32 vcc, s96, v27
    s_cmp_eq_u32 vcc_lo, 0
    s_cselect_b32 s96, 1, 2
    v_mov_b32 v22, s33
    v_mov_b32 v23, s96
    s_mov_b64 exec, 0xffffffff
    global_store_dwordx2 v20, v[22:23], s[28:29] offset:136 sc1
    s_mov_b64 exec, -1
L_nocen:
    s_sub_u32 s52, s31, 20
    s_mul_i32 s96, s30, 262144
    s_mul_i32 s97, s52, 384
    s_add_u32 s96, s96, s97
    s_add_u32 s53, s96, 7536640
    s_mul_i32 s96, s30, 327680
    s_mul_i32 s97, s52, 27392
    s_min_u32 s97, s97, 300288
    s_add_u32 s96, s96, s97
    s_add_u32 s54, s96, 0
    s_mul_i32 s55, s36, 102400
    s_add_u32 s55, s55, 9437184
    v_lshlrev_b32 v15, 7, v0
    s_mov_b32 s44, s28
    s_and_b32 s45, s29, 0xffff
    s_mov_b32 s46, 16777216
    s_mov_b32 s47, 0x00020000
    s_mov_b32 s100, 0
Lw_27:
    ds_read_b32 v4, v3 offset:280
    s_waitcnt lgkmcnt(0)
    v_readfirstlane_b32 s99, v4
    s_cmp_ge_u32 s99, 8
    s_cbranch_scc1 Lwd_28
    s_sleep 2
    s_add_u32 s100, s100, 1
    s_cmp_lt_u32 s100, 1048576
    s_cbranch_scc1 Lw_27
Lwd_28:
    s_mov_b64 exec, 0x7
    buffer_load_dword v18, v15, s[44:47], s53 offen sc1
    s_add_u32 s53, s53, 8192
    s_mov_b64 exec, -1
    s_mov_b32 s40, s24
    s_and_b32 s41, s25, 0xffff
    s_mov_b32 s42, 2621440
    s_mov_b32 s43, 0x00020000
    buffer_load_dword v18, v15, s[40:43], s54 offen sc1
    s_add_u32 s54, s54, 8192
    buffer_load_dword v18, v15, s[40:43], s54 offen sc1
    s_add_u32 s54, s54, 8192
    buffer_load_dword v18, v15, s[40:43], s54 offen sc1
    s_add_u32 s54, s54, 8192
    s_mov_b64 exec, 0x3fffff
    buffer_load_dword v18, v15, s[40:43], s54 offen sc1
    s_add_u32 s54, s54, 8192
    s_mov_b64 exec, -1
    s_lshl_b32 s98, s30, 5
    s_add_u32 s98, s98, s31
    s_lshl_b32 s98, s98, 8
    s_add_u32 s98, s98, 65536
    s_add_u32 s98, s98, 128
    s_mov_b32 s100, 0
Lc_29:
    s_load_dwordx4 s[88:91], s[28:29], s98 glc
    s_waitcnt lgkmcnt(0)
    s_cmp_eq_u32 s90, s33
    s_cbranch_scc1 Lcd_30
    s_sleep 2
    s_add_u32 s100, s100, 1
    s_cmp_lt_u32 s100, 1048576
    s_cbranch_scc1 Lc_29
    s_mov_b32 s91, 2
Lcd_30:
    s_cmp_eq_u32 s91, 1
    s_cselect_b32 s99, 0, 15728640
    s_add_u32 s16, s28, s99
    s_addc_u32 s17, s29, 0
    v_mov_b32 v4, s91
    ds_write_b32 v3, v4 offset:192
    s_waitcnt vmcnt(0)
    v_mov_b32 v4, 1
    ds_write_b32 v3, v4 offset:248
    v_mov_b32 v4, 1
    s_mov_b64 exec, 1
    ds_add_u32 v3, v4 offset:200
    s_mov_b64 exec, -1
    v_mov_b32 v4, 1
    s_mov_b64 exec, 1
    ds_add_u32 v3, v4 offset:204
    s_mov_b64 exec, -1
    s_cmp_lg_u32 s2, 240
    s_cbranch_scc1 L_noep
    v_lshlrev_b32 v20, 8, v0
    v_add_u32 v20, 65536, v20
    v_mov_b32 v24, 0
    v_mov_b32 v25, 0
    s_mov_b32 s52, 0
L_epl:
    s_mov_b64 exec, -1
    s_mov_b32 s100, 0
L_hpe:
    global_atomic_or_x2 v[26:27], v20, v[24:25], s[28:29] offset:24 sc0 sc1
    s_waitcnt vmcnt(0)
    v_cmp_ne_u32 vcc, s33, v26
    s_cbranch_vccz L_hde
    s_mov_b64 exec, vcc
    s_sleep 8
    s_add_u32 s100, s100, 1
    s_cmp_lt_u32 s100, 1048576
    s_cbranch_scc1 L_hpe
L_hde:
    s_mov_b64 exec, -1
    v_add_u32 v20, 0x4000, v20
    s_add_u32 s52, s52, 1
    s_cmp_lt_u32 s52, 4
    s_cbranch_scc1 L_epl
    v_mov_b32 v4, 0
    v_mov_b32 v5, s33
    s_mov_b64 exec, 1
    global_store_dword v4, v5, s[28:29] sc1
    s_mov_b64 exec, -1
L_noep:
    s_mov_b32 s100, 0
Lw_31:
    ds_read_b32 v4, v3 offset:304
    s_branch L_skip1626
L_pada6:
    s_branch L_pada14
L_padb4:
    s_branch L_padb12
L_skip1626:
    s_waitcnt lgkmcnt(0)
    v_readfirstlane_b32 s99, v4
    s_cmp_ge_u32 s99, 1
    s_cbranch_scc1 Lwd_32
    s_sleep 8
    s_add_u32 s100, s100, 1
    s_cmp_lt_u32 s100, 1048576
    s_cbranch_scc1 Lw_31
Lwd_32:
    s_branch L_help
L_aux:
    s_mov_b32 s100, 0
L_yp:
    s_load_dwordx2 s[42:43], s[40:41], 0 glc
    s_waitcnt lgkmcnt(0)
    s_and_b32 s43, s43, 0xffffff00
    s_cmp_eq_u32 s43, s44
    s_cbranch_scc1 L_ypd
    s_sleep 1
    s_add_u32 s100, s100, 1
    s_cmp_lt_u32 s100, 1048576
    s_cbranch_scc1 L_yp
L_ypd:
    s_mov_b32 s100, 0
L_yretry:
    global_load_dwordx4 v[128:131], v120, s[28:29] sc1
    global_load_dwordx4 v[132:135], v121, s[28:29] sc1
    global_load_dwordx4 v[136:139], v122, s[28:29] sc1
    global_load_dwordx4 v[140:143], v123, s[28:29] sc1
    global_load_dwordx4 v[144:147], v124, s[28:29] sc1
    v_mov_b32 v16, 0
    s_waitcnt vmcnt(4)
    ds_write_b128 v125, v[128:131] offset:0
    v_add3_u32 v16, v16, v128, v129
    v_add3_u32 v16, v16, v130, v131
    s_waitcnt vmcnt(3)
    ds_write_b128 v125, v[132:135] offset:1024
    v_add3_u32 v16, v16, v132, v133
    v_add3_u32 v16, v16, v134, v135
    s_waitcnt vmcnt(2)
    ds_write_b128 v125, v[136:139] offset:2048
    v_add3_u32 v16, v16, v136, v137
    v_add3_u32 v16, v16, v138, v139
    s_waitcnt vmcnt(1)
    ds_write_b128 v125, v[140:143] offset:3072
    v_add3_u32 v16, v16, v140, v141
    v_add3_u32 v16, v16, v142, v143
    s_waitcnt vmcnt(0)
    ds_write_b128 v125, v[144:147] offset:4096
    v_add3_u32 v16, v16, v144, v145
    v_add3_u32 v16, v16, v146, v147
    s_nop 1
    v_add_u32_dpp v16, v16, v16 row_ror:8 row_mask:0xf bank_mask:0xf
    s_nop 1
    v_add_u32_dpp v16, v16, v16 row_ror:4 row_mask:0xf bank_mask:0xf
    s_nop 1
    v_add_u32_dpp v16, v16, v16 row_ror:2 row_mask:0xf bank_mask:0xf
    s_nop 1
    v_add_u32_dpp v16, v16, v16 row_ror:1 row_mask:0xf bank_mask:0xf
    s_nop 0
    v_readlane_b32 s96, v16, 0
    v_readlane_b32 s97, v16, 16
    v_readlane_b32 s98, v16, 32
    v_readlane_b32 s99, v16, 48
    s_add_u32 s96, s96, s97
    s_add_u32 s98, s98, s99
    s_add_u32 s96, s96, s98
    s_cmp_eq_u32 s96, s42
    s_cbranch_scc1 L_yok
    s_sleep 2
    s_add_u32 s100, s100, 1
    s_cmp_lt_u32 s100, 1048576
    s_cbranch_scc1 L_yretry
L_yok:
    v_mov_b32 v4, 1
    s_mov_b64 exec, 1
    ds_add_u32 v3, v4 offset:212
    s_mov_b64 exec, -1
    s_endpgm
L_compute:
    s_waitcnt lgkmcnt(0)
    s_load_dword s33, s[28:29], 0
    s_setprio 2
    s_sub_u32 s40, s32, 4
    s_lshr_b32 s42, s40, 2
    s_and_b32 s56, s40, 3
    s_xor_b32 s41, s56, s42
    s_sub_u32 s46, s38, 5
    s_cselect_b32 s46, s38, s46
    s_mov_b32 s96, 0xf9af5600
    s_mov_b32 s45, 0x886f5f4f
    s_cmp_eq_u32 s46, 1
    s_cselect_b32 s96, 0xfeab5500, s96
    s_cselect_b32 s45, 0x8c5f4f8f, s45
    s_cmp_eq_u32 s46, 2
    s_cselect_b32 s96, 0xffaa5500, s96
    s_cselect_b32 s45, 0x8e4f3f87, s45
    s_cmp_eq_u32 s46, 3
    s_cselect_b32 s96, 0xffaa1540, s96
    s_cselect_b32 s45, 0x8f3f2f83, s45
    s_cmp_eq_u32 s46, 4
    s_cselect_b32 s96, 0xff6a0590, s96
    s_cselect_b32 s45, 0x3f2f1f81, s45
    s_lshl_b32 s97, s41, 3
    s_lshr_b32 s96, s96, s97
    s_lshr_b32 s45, s45, s97
    s_and_b32 s45, s45, 0xff
    v_lshrrev_b32 v5, 1, v1
    v_xor_b32 v5, v5, v2
    v_lshlrev_b32 v5, 4, v5
    v_lshl_add_u32 v132, v1, 7, v5
    s_lshl_b32 s97, s42, 13
    v_add_u32 v132, s97, v132
    v_and_b32 v4, 3, v0
    v_lshlrev_b32 v5, 1, v4
    v_bfe_u32 v5, s96, v5, 2
    v_bfe_u32 v6, v0, 3, 2
    v_xor_b32 v5, v5, v6
    v_lshl_add_u32 v5, v5, 2, v4
    v_bfe_u32 v6, v0, 2, 2
    v_mad_u32_u24 v6, v2, 24, v6
    v_lshlrev_b32 v6, 7, v6
    v_lshl_add_u32 v133, v5, 3, v6
    v_add_u32 v133, 18432, v133
    v_mov_b32 v8, 0
    v_mov_b32 v9, 0
    v_mov_b32 v10, 0
    v_mov_b32 v11, 0
    v_mov_b32 v12, 0
    v_mov_b32 v13, 0
    v_mov_b32 v14, 0
    v_mov_b32 v15, 0
    v_mov_b32 v16, 0
    v_mov_b32 v17, 0
    v_mov_b32 v18, 0
    v_mov_b32 v19, 0
    v_mov_b32 v20, 0
    v_mov_b32 v21, 0
    v_mov_b32 v22, 0
    v_mov_b32 v23, 0
    v_mov_b32 v24, 0
    v_mov_b32 v25, 0
    v_mov_b32 v26, 0
    v_mov_b32 v27, 0
    v_mov_b32 v28, 0
    v_mov_b32 v29, 0
    v_mov_b32 v30, 0
    v_mov_b32 v31, 0
    v_mov_b32 v32, 0
    v_mov_b32 v33, 0
    v_mov_b32 v34, 0
    v_mov_b32 v35, 0
    v_mov_b32 v36, 0
    v_mov_b32 v37, 0
    v_mov_b32 v38, 0
    v_mov_b32 v39, 0
    v_mov_b32 v40, 0
    v_mov_b32 v41, 0
    v_mov_b32 v42, 0
    v_mov_b32 v43, 0
    v_mov_b32 v44, 0
    v_mov_b32 v45, 0
    v_mov_b32 v46, 0
    v_mov_b32 v47, 0
    v_mov_b32 v48, 0
    v_mov_b32 v49, 0
    v_mov_b32 v50, 0
    v_mov_b32 v51, 0
    v_mov_b32 v52, 0
    v_mov_b32 v53, 0
    v_mov_b32 v54, 0
    v_mov_b32 v55, 0
    v_mov_b32 v56, 0
    v_mov_b32 v57, 0
    v_mov_b32 v58, 0
    v_mov_b32 v59, 0
    v_mov_b32 v60, 0
    v_mov_b32 v61, 0
    v_mov_b32 v62, 0
    v_mov_b32 v63, 0
    v_mov_b32 v64, 0
    v_mov_b32 v65, 0
    v_mov_b32 v66, 0
    v_mov_b32 v67, 0
    s_mov_b32 s43, 0
    s_mov_b32 s44, 86016
    v_add_u32 v134, 86016, v132
    v_xor_b32 v135, 64, v134
    v_add_u32 v136, 86016, v133
    v_mov_b32 v7, 0xf149f2ca
    v_lshlrev_b32 v4, 2, v2
    v_sub_u32 v4, v1, v4
    v_subrev_u32 v5, 0, v4
    v_and_b32 v5, 0x80000001, v5
    v_cmp_eq_u32 vcc, 0, v5
    s_nop 1
    v_cndmask_b32 v144, v7, 0, vcc
    v_cmp_eq_u32 vcc, 0x80000000, v5
    s_nop 1
    v_cndmask_b32 v148, v7, 0, vcc
    v_subrev_u32 v5, 1, v4
    v_and_b32 v5, 0x80000001, v5
    v_cmp_eq_u32 vcc, 0, v5
    s_nop 1
    v_cndmask_b32 v145, v7, 0, vcc
    v_cmp_eq_u32 vcc, 0x80000000, v5
    s_nop 1
    v_cndmask_b32 v149, v7, 0, vcc
    v_subrev_u32 v5, 2, v4
    v_and_b32 v5, 0x80000001, v5
    v_cmp_eq_u32 vcc, 0, v5
    s_nop 1
    v_cndmask_b32 v146, v7, 0, vcc
    v_cmp_eq_u32 vcc, 0x80000000, v5
    s_nop 1
    v_cndmask_b32 v150, v7, 0, vcc
    v_subrev_u32 v5, 3, v4
    v_and_b32 v5, 0x80000001, v5
    v_cmp_eq_u32 vcc, 0, v5
    s_nop 1
    v_cndmask_b32 v147, v7, 0, vcc
    v_cmp_eq_u32 vcc, 0x80000000, v5
    s_nop 1
    v_cndmask_b32 v151, v7, 0, vcc
    v_and_b32 v5, 1, v1
    v_lshlrev_b32 v6, 4, v5
    v_mov_b32 v7, 0xffff
    v_lshlrev_b32 v7, v6, v7
    v_sub_u32 v5, v4, v5
    v_cmp_le_i32 vcc, 0, v5
    s_nop 1
    v_cndmask_b32 v152, 0, v7, vcc
    v_cndmask_b32 v154, v7, 0, vcc
    v_cmp_le_i32 vcc, 2, v5
    s_nop 1
    v_cndmask_b32 v153, 0, v7, vcc
    v_cndmask_b32 v155, v7, 0, vcc
    v_mov_b32 v7, 0x0c0c0c0c
    s_mov_b32 s96, 0x1000100
    v_bfi_b32 v152, v152, s96, v7
    s_mov_b32 s96, 0x3020302
    v_bfi_b32 v153, v153, s96, v7
    s_mov_b32 s96, 0x1000100
    v_bfi_b32 v154, v154, s96, v7
    s_mov_b32 s96, 0x3020302
    v_bfi_b32 v155, v155, s96, v7
    s_or_b32 s96, s37, s42
    s_cmp_eq_u32 s96, 0
    s_cselect_b32 s96, 0xf149f2ca, 0
    v_add_f32 v140, s96, v148
    v_add_f32 v141, s96, v149
    v_add_f32 v142, s96, v150
    v_add_f32 v143, s96, v151
    s_mov_b32 s54, 0x3ea52b5c
    v_bfe_i32 v157, s45, v2, 1
    v_cmp_ne_u32 s[50:51], 0, v157
    s_bfe_u32 s60, s45, 131076
    v_cmp_eq_u32 s[52:53], s60, v2
    s_bfe_u32 s61, s45, 65542
    s_lshr_b32 s62, s41, 1
    s_add_u32 s96, s41, 1
    s_bfe_u32 s96, s96, 65537
    s_xor_b32 s57, s96, 1
    s_bitcmp1_b32 s45, 7
    s_cselect_b32 s63, s62, s61
    s_mul_i32 s96, s63, 13824
    s_lshl_b32 s97, s42, 11
    s_add_u32 s96, s96, s97
    s_add_u32 s96, s96, 129024
    v_lshl_add_u32 v156, v0, 3, s96
    v_and_b32 v4, 0x33, v0
    s_lshl_b32 s97, s60, 5
    s_add_u32 s96, s96, s97
    v_lshl_add_u32 v162, v4, 3, s96
    s_lshl_b32 s96, s41, 10
    s_add_u32 s96, s96, 156672
    v_lshl_add_u32 v164, v0, 3, s96
    v_min_u32 v4, 16, v0
    v_lshl_add_u32 v163, v4, 2, v3
    v_add_u32 v163, 128, v163
    s_lshl1_add_u32 s96, s41, s42
    s_lshl_b32 s96, s96, 2
    v_add_u32 v165, s96, v3
    s_lshl_b32 s96, s41, 1
    s_lshl_b32 s96, s42, s96
    s_lshl1_add_u32 s97, s42, 1
    s_mul_i32 s98, s61, 6
    s_lshl_b32 s97, s97, s98
    s_or_b32 s98, s96, s97
    s_bitcmp1_b32 s45, 7
    s_cselect_b32 s48, s96, s98
    s_cselect_b32 s49, s96, s97
    s_lshl_b32 s49, s49, 8
    s_and_b32 s64, s37, 1
    s_lshl1_add_u32 s65, s64, s42
    s_mul_i32 s96, s65, 81920
    s_mul_i32 s97, s30, 327680
    s_add_u32 s96, s96, s97
    s_lshl_b32 s97, s38, 11
    s_add_u32 s96, s96, s97
    s_add_u32 s67, s96, 20480
    s_mul_i32 s97, s57, 20480
    s_lshl3_add_u32 s97, s62, s97
    s_add_u32 s97, s97, s96
    v_lshl_add_u32 v160, v0, 4, s97
    s_lshl_b32 s97, s60, 8
    s_lshl3_add_u32 s97, s61, s97
    s_add_u32 s97, s97, 20480
    s_add_u32 s97, s97, s96
    v_lshrrev_b32 v4, 1, v2
    v_mul_u32_u24 v4, 38912, v4
    v_lshl_add_u32 v4, v2, 10, v4
    v_lshl_add_u32 v4, v1, 4, v4
    v_add_u32 v161, s97, v4
    s_mul_i32 s66, s30, 262144
    s_add_u32 s66, s66, 7340032
    s_lshl_b32 s96, s65, 8
    s_lshl_b32 s97, s57, 7
    s_add_u32 s96, s96, s97
    s_lshl1_add_u32 s97, s38, s62
    s_lshl2_add_u32 s96, s97, s96
    s_add_u32 s96, s96, s66
    s_add_u32 s55, s96, 196608
    s_mul_i32 s96, s62, 40960
    s_add_u32 s96, s96, s67
    v_lshl_add_u32 v159, v0, 4, s96
    s_mul_i32 s96, s62, 77824
    s_sub_u32 s96, 38912, s96
    v_add_u32 v158, s96, v159
    s_cmp_gt_u32 s46, 0
    s_cselect_b32 s96, 1, 0
    s_cmp_lt_u32 s46, 4
    s_cselect_b32 s97, 64, 0
    s_or_b32 s96, s96, s97
    s_lshl_b32 s47, s96, s42
    s_mov_b32 s76, 0x7060500
    s_mov_b32 s77, 0x7060501
    s_mov_b32 s78, 0x7060502
    s_mov_b32 s79, 0x7060503
    s_mov_b32 s58, 0x0c0c0400
    s_mov_b32 s59, 0x04000c0c
    v_add_u32 v157, 40960, v160
    s_mul_i32 s96, s57, 51200
    s_add_u32 s80, s96, 10240
    s_mul_i32 s81, s56, 2560
    s_add_u32 s81, s81, 0
    s_mov_b32 s93, 112640
    s_mov_b32 s101, 0
    s_and_b32 s98, s35, 3
    s_lshr_b32 s96, s56, 1
    s_lshl1_add_u32 s96, s98, s96
    s_lshl1_add_u32 s96, s96, s57
    s_mul_i32 s96, s96, 20480
    s_and_b32 s97, s56, 1
    s_lshl_b32 s97, s97, 10
    s_add_u32 s96, s96, s97
    s_mul_i32 s97, s30, 327680
    s_add_u32 s96, s96, s97
    s_add_u32 s82, s96, 4096
    s_mul_i32 s96, s30, 262144
    s_lshl_b32 s98, s98, 8
    s_add_u32 s96, s96, s98
    s_add_u32 s83, s96, 7536640
    s_mul_i32 s84, s56, 5120
    s_add_u32 s84, s84, 129024
    s_lshl2_add_u32 s96, s35, s56
    s_mul_i32 s96, s96, 20480
    s_mul_i32 s97, s36, 160
    s_add_u32 s85, s96, s97
    v_lshl_add_u32 v138, v0, 4, s80
    v_lshl_add_u32 v139, v0, 4, s82
    v_lshl_add_u32 v166, v0, 2, s83
    s_waitcnt lgkmcnt(0)
    s_mul_i32 s33, s33, 1664525
    s_add_u32 s33, s33, 1013904223
    s_cmp_eq_u32 s32, 4
    s_cbranch_scc1 L_padb0
    s_cmp_eq_u32 s32, 5
    s_cbranch_scc1 L_padb1
    s_cmp_eq_u32 s32, 6
    s_cbranch_scc1 L_padb2
    s_cmp_eq_u32 s32, 7
    s_cbranch_scc1 L_padb3
    s_cmp_eq_u32 s32, 8
    s_cbranch_scc1 L_padb4
    s_cmp_eq_u32 s32, 9
    s_cbranch_scc1 L_padb5
    s_cmp_eq_u32 s32, 10
    s_cbranch_scc1 L_padb6
    s_branch L_padb7
L_padb5:
    s_branch L_padb13
L_warmed_b:
    s_barrier
    s_cmp_lg_u32 s42, 0
    s_cbranch_scc1 L_gemm_40
L_gemm_50:
    s_barrier
    ds_read_b64_tr_b16 v[112:113], v136 offset:1024
    ds_read_b64_tr_b16 v[114:115], v136 offset:1536
    ds_read_b128 v[68:71], v134 offset:0
    ds_read_b128 v[72:75], v134 offset:2048
    ds_read_b128 v[76:79], v134 offset:4096
    ds_read_b128 v[80:83], v134 offset:6144
    ds_read_b128 v[84:87], v134 offset:8192
    ds_read_b64_tr_b16 v[116:117], v136 offset:2048
    ds_read_b64_tr_b16 v[118:119], v136 offset:2560
    ds_read_b64_tr_b16 v[108:109], v136 offset:0
    ds_read_b64_tr_b16 v[110:111], v136 offset:512
L_gemm_5:
    s_waitcnt lgkmcnt(8)
    v_mfma_f32_16x16x32_bf16 v[28:31], v[112:115], v[68:71], v[28:31]
    s_setprio 2
    ds_read_b64_tr_b16 v[124:125], v136 offset:13312
    s_waitcnt lgkmcnt(8)
    v_mfma_f32_16x16x32_bf16 v[32:35], v[112:115], v[72:75], v[32:35]
    ds_read_b64_tr_b16 v[126:127], v136 offset:13824
    s_waitcnt lgkmcnt(8)
    v_mfma_f32_16x16x32_bf16 v[36:39], v[112:115], v[76:79], v[36:39]
    ds_read_b128 v[88:91], v135 offset:0
    s_waitcnt lgkmcnt(8)
    v_mfma_f32_16x16x32_bf16 v[40:43], v[112:115], v[80:83], v[40:43]
    ds_read_b128 v[92:95], v135 offset:2048
    s_waitcnt lgkmcnt(8)
    v_mfma_f32_16x16x32_bf16 v[44:47], v[112:115], v[84:87], v[44:47]
    ds_read_b128 v[96:99], v135 offset:4096
    s_waitcnt lgkmcnt(7)
    v_mfma_f32_16x16x32_bf16 v[48:51], v[68:71], v[116:119], v[48:51]
    ds_read_b128 v[100:103], v135 offset:6144
    v_mfma_f32_16x16x32_bf16 v[52:55], v[72:75], v[116:119], v[52:55]
    ds_read_b128 v[104:107], v135 offset:8192
    v_mfma_f32_16x16x32_bf16 v[56:59], v[76:79], v[116:119], v[56:59]
    ds_read_b64_tr_b16 v[128:129], v136 offset:14336
    v_mfma_f32_16x16x32_bf16 v[60:63], v[80:83], v[116:119], v[60:63]
    ds_read_b64_tr_b16 v[130:131], v136 offset:14848
    v_mfma_f32_16x16x32_bf16 v[64:67], v[84:87], v[116:119], v[64:67]
    ds_read_b64_tr_b16 v[120:121], v136 offset:12288
    s_waitcnt lgkmcnt(10)
    v_mfma_f32_16x16x32_bf16 v[12:15], v[108:111], v[72:75], v[12:15]
    ds_read_b64_tr_b16 v[122:123], v136 offset:12800
    v_mfma_f32_16x16x32_bf16 v[16:19], v[108:111], v[76:79], v[16:19]
    v_mfma_f32_16x16x32_bf16 v[20:23], v[108:111], v[80:83], v[20:23]
    v_mfma_f32_16x16x32_bf16 v[24:27], v[108:111], v[84:87], v[24:27]
    s_waitcnt lgkmcnt(8)
    v_mfma_f32_16x16x32_bf16 v[28:31], v[124:127], v[88:91], v[28:31]
    s_add_u32 s44, s44, 43008
    s_cmp_eq_u32 s44, 129024
    s_cselect_b32 s44, 0, s44
    v_add_u32 v134, s44, v132
    v_add_u32 v136, s44, v133
    s_waitcnt lgkmcnt(7)
    v_mfma_f32_16x16x32_bf16 v[32:35], v[124:127], v[92:95], v[32:35]
    s_waitcnt lgkmcnt(0)
    s_barrier
    s_setprio 1
    ds_read_b64_tr_b16 v[112:113], v136 offset:1024
    v_mfma_f32_16x16x32_bf16 v[36:39], v[124:127], v[96:99], v[36:39]
    ds_read_b64_tr_b16 v[114:115], v136 offset:1536
    v_mfma_f32_16x16x32_bf16 v[40:43], v[124:127], v[100:103], v[40:43]
    v_xor_b32 v135, 64, v134
    ds_read_b128 v[68:71], v134 offset:0
    v_mfma_f32_16x16x32_bf16 v[44:47], v[124:127], v[104:107], v[44:47]
    ds_read_b128 v[72:75], v134 offset:2048
    v_mfma_f32_16x16x32_bf16 v[48:51], v[88:91], v[128:131], v[48:51]
    ds_read_b128 v[76:79], v134 offset:4096
    v_mfma_f32_16x16x32_bf16 v[52:55], v[92:95], v[128:131], v[52:55]
    ds_read_b128 v[80:83], v134 offset:6144
    v_mfma_f32_16x16x32_bf16 v[56:59], v[96:99], v[128:131], v[56:59]
    ds_read_b128 v[84:87], v134 offset:8192
    v_mfma_f32_16x16x32_bf16 v[60:63], v[100:103], v[128:131], v[60:63]
    ds_read_b64_tr_b16 v[116:117], v136 offset:2048
    v_mfma_f32_16x16x32_bf16 v[64:67], v[104:107], v[128:131], v[64:67]
    ds_read_b64_tr_b16 v[118:119], v136 offset:2560
    v_mfma_f32_16x16x32_bf16 v[12:15], v[120:123], v[92:95], v[12:15]
    ds_read_b64_tr_b16 v[108:109], v136 offset:0
    v_mfma_f32_16x16x32_bf16 v[16:19], v[120:123], v[96:99], v[16:19]
    s_add_u32 s43, s43, 1
    ds_read_b64_tr_b16 v[110:111], v136 offset:512
    v_mfma_f32_16x16x32_bf16 v[20:23], v[120:123], v[100:103], v[20:23]
    s_cmp_lt_u32 s43, 9
    v_mfma_f32_16x16x32_bf16 v[24:27], v[120:123], v[104:107], v[24:27]
    s_cbranch_scc1 L_gemm_5
    s_waitcnt lgkmcnt(8)
    v_mfma_f32_16x16x32_bf16 v[28:31], v[112:115], v[68:71], v[28:31]
    s_bitcmp1_b32 s45, 7
    s_setprio 3
    s_cbranch_scc1 Llp_33
    s_setprio 1
Llp_33:
    ds_read_b64_tr_b16 v[124:125], v136 offset:13312
    s_waitcnt lgkmcnt(8)
    v_mfma_f32_16x16x32_bf16 v[32:35], v[112:115], v[72:75], v[32:35]
    ds_read_b64_tr_b16 v[126:127], v136 offset:13824
    s_waitcnt lgkmcnt(8)
    v_mfma_f32_16x16x32_bf16 v[36:39], v[112:115], v[76:79], v[36:39]
    ds_read_b128 v[88:91], v135 offset:0
    s_waitcnt lgkmcnt(8)
    v_mfma_f32_16x16x32_bf16 v[40:43], v[112:115], v[80:83], v[40:43]
    ds_read_b128 v[92:95], v135 offset:2048
    s_waitcnt lgkmcnt(8)
    v_mfma_f32_16x16x32_bf16 v[44:47], v[112:115], v[84:87], v[44:47]
    ds_read_b128 v[96:99], v135 offset:4096
    s_waitcnt lgkmcnt(7)
    v_mfma_f32_16x16x32_bf16 v[48:51], v[68:71], v[116:119], v[48:51]
    ds_read_b128 v[100:103], v135 offset:6144
    v_mfma_f32_16x16x32_bf16 v[52:55], v[72:75], v[116:119], v[52:55]
    ds_read_b128 v[104:107], v135 offset:8192
    v_mfma_f32_16x16x32_bf16 v[56:59], v[76:79], v[116:119], v[56:59]
    ds_read_b64_tr_b16 v[128:129], v136 offset:14336
    v_mfma_f32_16x16x32_bf16 v[60:63], v[80:83], v[116:119], v[60:63]
    ds_read_b64_tr_b16 v[130:131], v136 offset:14848
    v_mfma_f32_16x16x32_bf16 v[64:67], v[84:87], v[116:119], v[64:67]
    ds_read_b64_tr_b16 v[120:121], v136 offset:12288
    s_waitcnt lgkmcnt(10)
    v_mfma_f32_16x16x32_bf16 v[12:15], v[108:111], v[72:75], v[12:15]
    ds_read_b64_tr_b16 v[122:123], v136 offset:12800
    v_mfma_f32_16x16x32_bf16 v[16:19], v[108:111], v[76:79], v[16:19]
    ds_read_b64 v[6:7], v3 offset:384
    v_mfma_f32_16x16x32_bf16 v[20:23], v[108:111], v[80:83], v[20:23]
    v_mfma_f32_16x16x32_bf16 v[24:27], v[108:111], v[84:87], v[24:27]
    s_waitcnt lgkmcnt(0)
    v_mfma_f32_16x16x32_bf16 v[44:47], v[124:127], v[104:107], v[44:47]
    v_readfirstlane_b32 s90, v6
    v_readfirstlane_b32 s91, v7
    v_mfma_f32_16x16x32_bf16 v[24:27], v[120:123], v[104:107], v[24:27]
    v_mov_b64 v[70:71], 0
    v_mov_b64 v[74:75], 0
    v_mfma_f32_16x16x32_bf16 v[40:43], v[124:127], v[100:103], v[40:43]
    v_mov_b64 v[78:79], 0
    v_mov_b64 v[82:83], 0
    v_mfma_f32_16x16x32_bf16 v[20:23], v[120:123], v[100:103], v[20:23]
    v_mov_b32 v119, s33
    v_mfma_f32_16x16x32_bf16 v[36:39], v[124:127], v[96:99], v[36:39]
    v_mfma_f32_16x16x32_bf16 v[16:19], v[120:123], v[96:99], v[16:19]
    v_mfma_f32_16x16x32_bf16 v[32:35], v[124:127], v[92:95], v[32:35]
    v_mfma_f32_16x16x32_bf16 v[12:15], v[120:123], v[92:95], v[12:15]
    v_mfma_f32_16x16x32_bf16 v[28:31], v[124:127], v[88:91], v[28:31]
    s_branch L_gdone
L_padb6:
    s_branch L_padb14
L_gemm_40:
    s_barrier
    ds_read_b64_tr_b16 v[112:113], v136 offset:1024
    ds_read_b64_tr_b16 v[114:115], v136 offset:1536
    ds_read_b128 v[72:75], v134 offset:2048
    ds_read_b128 v[76:79], v134 offset:4096
    ds_read_b128 v[80:83], v134 offset:6144
    ds_read_b128 v[84:87], v134 offset:8192
    ds_read_b64_tr_b16 v[116:117], v136 offset:2048
    ds_read_b64_tr_b16 v[118:119], v136 offset:2560
    ds_read_b64_tr_b16 v[108:109], v136 offset:0
    ds_read_b64_tr_b16 v[110:111], v136 offset:512
L_gemm_4:
    s_waitcnt lgkmcnt(7)
    v_mfma_f32_16x16x32_bf16 v[32:35], v[112:115], v[72:75], v[32:35]
    s_setprio 1
    ds_read_b64_tr_b16 v[124:125], v136 offset:13312
    s_waitcnt lgkmcnt(7)
    v_mfma_f32_16x16x32_bf16 v[36:39], v[112:115], v[76:79], v[36:39]
    ds_read_b64_tr_b16 v[126:127], v136 offset:13824
    s_waitcnt lgkmcnt(7)
    v_mfma_f32_16x16x32_bf16 v[40:43], v[112:115], v[80:83], v[40:43]
    ds_read_b128 v[92:95], v135 offset:2048
    s_waitcnt lgkmcnt(7)
    v_mfma_f32_16x16x32_bf16 v[44:47], v[112:115], v[84:87], v[44:47]
    ds_read_b128 v[96:99], v135 offset:4096
    s_waitcnt lgkmcnt(6)
    v_mfma_f32_16x16x32_bf16 v[52:55], v[72:75], v[116:119], v[52:55]
    ds_read_b128 v[100:103], v135 offset:6144
    v_mfma_f32_16x16x32_bf16 v[56:59], v[76:79], v[116:119], v[56:59]
    ds_read_b128 v[104:107], v135 offset:8192
    v_mfma_f32_16x16x32_bf16 v[60:63], v[80:83], v[116:119], v[60:63]
    ds_read_b64_tr_b16 v[128:129], v136 offset:14336
    v_mfma_f32_16x16x32_bf16 v[64:67], v[84:87], v[116:119], v[64:67]
    ds_read_b64_tr_b16 v[130:131], v136 offset:14848
    s_waitcnt lgkmcnt(8)
    v_mfma_f32_16x16x32_bf16 v[12:15], v[108:111], v[72:75], v[12:15]
    ds_read_b64_tr_b16 v[120:121], v136 offset:12288
    v_mfma_f32_16x16x32_bf16 v[16:19], v[108:111], v[76:79], v[16:19]
    ds_read_b64_tr_b16 v[122:123], v136 offset:12800
    v_mfma_f32_16x16x32_bf16 v[20:23], v[108:111], v[80:83], v[20:23]
    v_mfma_f32_16x16x32_bf16 v[24:27], v[108:111], v[84:87], v[24:27]
    s_waitcnt lgkmcnt(7)
    v_mfma_f32_16x16x32_bf16 v[32:35], v[124:127], v[92:95], v[32:35]
    s_add_u32 s44, s44, 43008
    s_cmp_eq_u32 s44, 129024
    s_cselect_b32 s44, 0, s44
    v_add_u32 v134, s44, v132
    v_add_u32 v136, s44, v133
    s_waitcnt lgkmcnt(6)
    v_mfma_f32_16x16x32_bf16 v[36:39], v[124:127], v[96:99], v[36:39]
    s_waitcnt lgkmcnt(0)
    s_barrier
    s_setprio 2
    ds_read_b64_tr_b16 v[112:113], v136 offset:1024
    v_mfma_f32_16x16x32_bf16 v[40:43], v[124:127], v[100:103], v[40:43]
    ds_read_b64_tr_b16 v[114:115], v136 offset:1536
    v_mfma_f32_16x16x32_bf16 v[44:47], v[124:127], v[104:107], v[44:47]
    v_xor_b32 v135, 64, v134
    ds_read_b128 v[72:75], v134 offset:2048
    v_mfma_f32_16x16x32_bf16 v[52:55], v[92:95], v[128:131], v[52:55]
    ds_read_b128 v[76:79], v134 offset:4096
    v_mfma_f32_16x16x32_bf16 v[56:59], v[96:99], v[128:131], v[56:59]
    ds_read_b128 v[80:83], v134 offset:6144
    v_mfma_f32_16x16x32_bf16 v[60:63], v[100:103], v[128:131], v[60:63]
    ds_read_b128 v[84:87], v134 offset:8192
    v_mfma_f32_16x16x32_bf16 v[64:67], v[104:107], v[128:131], v[64:67]
    ds_read_b64_tr_b16 v[116:117], v136 offset:2048
    v_mfma_f32_16x16x32_bf16 v[12:15], v[120:123], v[92:95], v[12:15]
    ds_read_b64_tr_b16 v[118:119], v136 offset:2560
    v_mfma_f32_16x16x32_bf16 v[16:19], v[120:123], v[96:99], v[16:19]
    s_add_u32 s43, s43, 1
    ds_read_b64_tr_b16 v[108:109], v136 offset:0
    v_mfma_f32_16x16x32_bf16 v[20:23], v[120:123], v[100:103], v[20:23]
    s_cmp_lt_u32 s43, 9
    ds_read_b64_tr_b16 v[110:111], v136 offset:512
    v_mfma_f32_16x16x32_bf16 v[24:27], v[120:123], v[104:107], v[24:27]
    s_cbranch_scc1 L_gemm_4
    s_waitcnt lgkmcnt(7)
    v_mfma_f32_16x16x32_bf16 v[32:35], v[112:115], v[72:75], v[32:35]
    s_bitcmp1_b32 s45, 7
    s_setprio 3
    s_cbranch_scc1 Llp_34
    s_setprio 1
Llp_34:
    ds_read_b64_tr_b16 v[124:125], v136 offset:13312
    s_waitcnt lgkmcnt(7)
    v_mfma_f32_16x16x32_bf16 v[36:39], v[112:115], v[76:79], v[36:39]
    ds_read_b64_tr_b16 v[126:127], v136 offset:13824
    s_waitcnt lgkmcnt(7)
    v_mfma_f32_16x16x32_bf16 v[40:43], v[112:115], v[80:83], v[40:43]
    ds_read_b128 v[92:95], v135 offset:2048
    s_waitcnt lgkmcnt(7)
    v_mfma_f32_16x16x32_bf16 v[44:47], v[112:115], v[84:87], v[44:47]
    ds_read_b128 v[96:99], v135 offset:4096
    s_waitcnt lgkmcnt(6)
    v_mfma_f32_16x16x32_bf16 v[52:55], v[72:75], v[116:119], v[52:55]
    ds_read_b128 v[100:103], v135 offset:6144
    v_mfma_f32_16x16x32_bf16 v[56:59], v[76:79], v[116:119], v[56:59]
    ds_read_b128 v[104:107], v135 offset:8192
    v_mfma_f32_16x16x32_bf16 v[60:63], v[80:83], v[116:119], v[60:63]
    ds_read_b64_tr_b16 v[128:129], v136 offset:14336
    v_mfma_f32_16x16x32_bf16 v[64:67], v[84:87], v[116:119], v[64:67]
    ds_read_b64_tr_b16 v[130:131], v136 offset:14848
    s_waitcnt lgkmcnt(8)
    v_mfma_f32_16x16x32_bf16 v[12:15], v[108:111], v[72:75], v[12:15]
    ds_read_b64_tr_b16 v[120:121], v136 offset:12288
    v_mfma_f32_16x16x32_bf16 v[16:19], v[108:111], v[76:79], v[16:19]
    ds_read_b64_tr_b16 v[122:123], v136 offset:12800
    v_mfma_f32_16x16x32_bf16 v[20:23], v[108:111], v[80:83], v[20:23]
    ds_read_b64 v[6:7], v3 offset:384
    v_mfma_f32_16x16x32_bf16 v[24:27], v[108:111], v[84:87], v[24:27]
    s_waitcnt lgkmcnt(0)
    v_mfma_f32_16x16x32_bf16 v[44:47], v[124:127], v[104:107], v[44:47]
    v_readfirstlane_b32 s90, v6
    v_readfirstlane_b32 s91, v7
    v_mfma_f32_16x16x32_bf16 v[24:27], v[120:123], v[104:107], v[24:27]
    v_mov_b64 v[70:71], 0
    v_mov_b64 v[74:75], 0
    v_mfma_f32_16x16x32_bf16 v[40:43], v[124:127], v[100:103], v[40:43]
    v_mov_b64 v[78:79], 0
    v_mov_b64 v[82:83], 0
    v_mfma_f32_16x16x32_bf16 v[20:23], v[120:123], v[100:103], v[20:23]
    v_mov_b32 v119, s33
    v_mfma_f32_16x16x32_bf16 v[36:39], v[124:127], v[96:99], v[36:39]
    v_mfma_f32_16x16x32_bf16 v[16:19], v[120:123], v[96:99], v[16:19]
    v_mfma_f32_16x16x32_bf16 v[32:35], v[124:127], v[92:95], v[32:35]
    v_mfma_f32_16x16x32_bf16 v[12:15], v[120:123], v[92:95], v[12:15]
L_gdone:
    s_cmp_lg_u32 s90, s33
    s_cbranch_scc1 L_mslow
L_mback:
    s_cmp_eq_u32 s91, 1
    s_cselect_b32 s99, 0, 15728640
    s_add_u32 s16, s28, s99
    s_addc_u32 s17, s29, 0
    s_add_u32 s18, s16, 13107200
    s_addc_u32 s19, s17, 0
    s_cmp_eq_u32 s91, 1
    s_cselect_b64 s[18:19], s[24:25], s[18:19]
    s_bitcmp0_b32 s45, 7
    s_cbranch_scc1 L_full
    v_mov_b32 v5, 1
    v_cvt_pk_bf16_f32 v84, v44, v45
    v_cvt_pk_bf16_f32 v85, v46, v47
    ds_write_b64 v156, v[84:85] offset:6656
    ds_write_b32 v165, v5 offset:344
    v_cvt_pk_bf16_f32 v80, v40, v41
    v_cvt_pk_bf16_f32 v81, v42, v43
    s_branch L_skip2311
L_padb7:
    s_branch L_padb15
L_skip2311:
    v_cvt_pk_bf16_f32 v76, v36, v37
    v_cvt_pk_bf16_f32 v77, v38, v39
    v_cvt_pk_bf16_f32 v72, v32, v33
    v_cvt_pk_bf16_f32 v73, v34, v35
    s_mov_b32 s100, 0
    s_cmp_eq_u32 s42, 0
    s_cbranch_scc1 L_l_k0
    ds_read_b32 v4, v165 offset:340
    ds_read_b64 v[68:69], v156 offset:4608
    s_branch L_l_k1
L_l_k0:
    v_cvt_pk_bf16_f32 v68, v28, v29
    v_cvt_pk_bf16_f32 v69, v30, v31
    v_mov_b32 v4, 1
L_l_k1:
    s_mov_b64 exec, s[50:51]
    v_cvt_pk_bf16_f32 v82, v24, v25
    v_cvt_pk_bf16_f32 v83, v26, v27
    v_cvt_pk_bf16_f32 v78, v20, v21
    v_cvt_pk_bf16_f32 v79, v22, v23
    v_cvt_pk_bf16_f32 v74, v16, v17
    v_cvt_pk_bf16_f32 v75, v18, v19
    v_cvt_pk_bf16_f32 v70, v12, v13
    v_cvt_pk_bf16_f32 v71, v14, v15
    s_mov_b64 exec, -1
    v_mfma_f32_16x16x16_bf16 v[40:43], v[84:85], v[82:83], v[144:147]
    v_cvt_pk_bf16_f32 v24, v24, v25
    v_cvt_pk_bf16_f32 v25, v26, v27
    v_mfma_f32_16x16x16_bf16 v[124:127], v[80:81], v[82:83], v[148:151]
    v_mfma_f32_16x16x16_bf16 v[36:39], v[80:81], v[78:79], v[144:147]
    v_cvt_pk_bf16_f32 v20, v20, v21
    v_cvt_pk_bf16_f32 v21, v22, v23
    v_mfma_f32_16x16x16_bf16 v[120:123], v[76:77], v[78:79], v[148:151]
    v_mfma_f32_16x16x16_bf16 v[32:35], v[76:77], v[74:75], v[144:147]
    v_cvt_pk_bf16_f32 v16, v16, v17
    v_cvt_pk_bf16_f32 v17, v18, v19
    v_mfma_f32_16x16x16_bf16 v[8:11], v[72:73], v[74:75], v[148:151]
    v_mfma_f32_16x16x16_bf16 v[28:31], v[72:73], v[70:71], v[144:147]
    v_cvt_pk_bf16_f32 v12, v12, v13
    v_cvt_pk_bf16_f32 v13, v14, v15
L_l_kw:
    s_waitcnt lgkmcnt(0)
    v_readfirstlane_b32 s96, v4
    s_cmp_eq_u32 s96, 0
    s_cbranch_scc1 L_l_kslow
L_l_kok:
    v_mfma_f32_16x16x16_bf16 v[44:47], v[68:69], v[70:71], v[140:143]
    ds_write_b64 v156, v[80:81] offset:6144
    ds_write_b64 v156, v[24:25] offset:2048
    v_max3_f32 v114, v40, v41, v124
    v_max3_f32 v115, v42, v43, v126
    v_max_f32 v114, v114, v125
    v_max_f32 v115, v115, v127
    v_perm_b32 v114, v114, v119, s78
    v_perm_b32 v115, v115, v119, s79
    ds_write_b64 v156, v[76:77] offset:5632
    ds_write_b64 v156, v[20:21] offset:1536
    v_max3_f32 v112, v36, v37, v120
    v_max3_f32 v113, v38, v39, v122
    v_max_f32 v112, v112, v121
    v_max_f32 v113, v113, v123
    v_perm_b32 v112, v112, v119, s76
    v_perm_b32 v113, v113, v119, s77
    ds_write_b64 v156, v[72:73] offset:5120
    ds_write_b64 v156, v[16:17] offset:1024
    v_max3_f32 v110, v32, v33, v8
    v_max3_f32 v111, v34, v35, v10
    v_max_f32 v110, v110, v9
    v_max_f32 v111, v111, v11
    v_perm_b32 v110, v110, v119, s78
    v_perm_b32 v111, v111, v119, s79
    ds_write_b64 v156, v[68:69] offset:4608
    ds_write_b64 v156, v[12:13] offset:512
    ds_write_b32 v165, v5 offset:128
    v_max3_f32 v108, v28, v29, v44
    v_max3_f32 v109, v30, v31, v46
    v_max_f32 v108, v108, v45
    v_max_f32 v109, v109, v47
    v_perm_b32 v108, v108, v119, s76
    v_perm_b32 v109, v109, v119, s77
    s_cmp_lg_u32 s91, 1
    s_cbranch_scc1 Ldg_35
    global_store_dwordx4 v158, v[112:115], s[18:19] offset:1024
    global_store_dwordx4 v158, v[108:111], s[18:19] offset:0
    s_branch Ldd_36
Ldg_35:
    global_store_dwordx4 v158, v[112:115], s[18:19] offset:1024 sc1
    global_store_dwordx4 v158, v[108:111], s[18:19] offset:0 sc1
Ldd_36:
    s_setprio 1
    v_mfma_f32_16x16x32_bf16 v[64:67], v[104:107], v[128:131], v[64:67]
    v_mfma_f32_16x16x32_bf16 v[60:63], v[100:103], v[128:131], v[60:63]
    v_mfma_f32_16x16x32_bf16 v[56:59], v[96:99], v[128:131], v[56:59]
    v_mfma_f32_16x16x32_bf16 v[52:55], v[92:95], v[128:131], v[52:55]
    s_cmp_lg_u32 s42, 0
    s_cbranch_scc1 L_nv_l
    v_mfma_f32_16x16x32_bf16 v[48:51], v[88:91], v[128:131], v[48:51]
L_nv_l:
    s_nop 2
    v_cvt_pk_bf16_f32 v88, v64, v65
    v_cvt_pk_bf16_f32 v89, v66, v67
    s_waitcnt lgkmcnt(6)
    ds_write_b64 v156, v[88:89] offset:11264
    v_cvt_pk_bf16_f32 v90, v60, v61
    v_cvt_pk_bf16_f32 v91, v62, v63
    ds_write_b64 v156, v[90:91] offset:10752
    v_cvt_pk_bf16_f32 v92, v56, v57
    v_cvt_pk_bf16_f32 v93, v58, v59
    ds_write_b64 v156, v[92:93] offset:10240
    v_cvt_pk_bf16_f32 v94, v52, v53
    v_cvt_pk_bf16_f32 v95, v54, v55
    ds_write_b64 v156, v[94:95] offset:9728
    s_cmp_lg_u32 s42, 0
    s_cbranch_scc1 L_l_nv0
    v_cvt_pk_bf16_f32 v96, v48, v49
    v_cvt_pk_bf16_f32 v97, v50, v51
    ds_write_b64 v156, v[96:97] offset:9216
    ds_write_b32 v165, v5 offset:160
    s_branch L_l_v0
L_padb8:
    s_branch L_padb16
L_l_nv0:
    ds_write_b32 v165, v5 offset:160
    s_mov_b32 s100, 0
Lm_37:
    ds_read_b32 v4, v163
    s_waitcnt lgkmcnt(0)
    v_cmp_eq_u32 vcc, 0, v4
    s_and_b32 s99, vcc_lo, s49
    s_cbranch_scc0 Lmd_38
    s_add_u32 s100, s100, 1
    s_cmp_lt_u32 s100, 1048576
    s_cbranch_scc1 Lm_37
Lmd_38:
    ds_read_b64 v[96:97], v156 offset:9216
L_l_v0:
    s_setprio 0
    s_mov_b32 s100, 0
L_xp:
    global_load_dwordx4 v[28:31], v159, s[18:19] offset:0 sc1
    global_load_dwordx4 v[32:35], v159, s[18:19] offset:1024 sc1
    s_waitcnt vmcnt(1)
    v_perm_b32 v36, v29, v28, s58
    v_perm_b32 v37, v31, v30, s59
    v_or_b32 v36, v36, v37
    s_waitcnt vmcnt(0)
    v_perm_b32 v38, v33, v32, s58
    v_perm_b32 v39, v35, v34, s59
    v_or_b32 v38, v38, v39
    v_cmp_ne_u32 vcc, s33, v36
    v_cmp_ne_u32 s[60:61], s33, v38
    s_or_b64 vcc, vcc, s[60:61]
    s_cbranch_scc0 L_xpd
    s_add_u32 s100, s100, 1
    s_cmp_lt_u32 s100, 1048576
    s_cbranch_scc1 L_xp
L_xpd:
    s_setprio 2
    ds_write_b32 v165, v5 offset:392
    v_pk_add_f32 v[68:69], v[108:109], v[28:29]
    v_pk_add_f32 v[70:71], v[110:111], v[30:31]
    v_pk_add_f32 v[72:73], v[112:113], v[32:33]
    v_pk_add_f32 v[74:75], v[114:115], v[34:35]
    s_branch L_soft
L_l_kslow:
    ds_read_b32 v4, v165 offset:340
    ds_read_b64 v[68:69], v156 offset:4608
    s_add_u32 s100, s100, 1
    s_cmp_lt_u32 s100, 1048576
    s_cbranch_scc1 L_l_kw
    s_waitcnt lgkmcnt(0)
    s_branch L_l_kok
L_mslow:
    s_lshl_b32 s98, s30, 5
    s_add_u32 s98, s98, s31
    s_lshl_b32 s98, s98, 8
    s_add_u32 s98, s98, 65536
    s_add_u32 s98, s98, 128
    s_mov_b32 s100, 0
Lc_39:
    s_load_dwordx4 s[88:91], s[28:29], s98 glc
    s_waitcnt lgkmcnt(0)
    s_cmp_eq_u32 s90, s33
    s_cbranch_scc1 Lcd_40
    s_sleep 2
    s_add_u32 s100, s100, 1
    s_cmp_lt_u32 s100, 1048576
    s_cbranch_scc1 Lc_39
    s_mov_b32 s91, 2
Lcd_40:
    s_branch L_mback
L_padb9:
    s_branch L_padb17
L_full:
    v_mfma_f32_16x16x32_bf16 v[64:67], v[104:107], v[128:131], v[64:67]
    v_mfma_f32_16x16x32_bf16 v[60:63], v[100:103], v[128:131], v[60:63]
    v_mfma_f32_16x16x32_bf16 v[56:59], v[96:99], v[128:131], v[56:59]
    v_mfma_f32_16x16x32_bf16 v[52:55], v[92:95], v[128:131], v[52:55]
    s_cmp_lg_u32 s42, 0
    s_cbranch_scc1 L_nv_f
    v_mfma_f32_16x16x32_bf16 v[48:51], v[88:91], v[128:131], v[48:51]
L_nv_f:
    s_setprio 2
    v_cvt_pk_bf16_f32 v124, v44, v45
    v_cvt_pk_bf16_f32 v125, v46, v47
    v_cvt_pk_bf16_f32 v120, v40, v41
    v_cvt_pk_bf16_f32 v121, v42, v43
    v_cvt_pk_bf16_f32 v116, v36, v37
    v_cvt_pk_bf16_f32 v117, v38, v39
    v_cvt_pk_bf16_f32 v112, v32, v33
    v_cvt_pk_bf16_f32 v113, v34, v35
    v_cvt_pk_bf16_f32 v68, v12, v13
    v_cvt_pk_bf16_f32 v69, v14, v15
    v_cvt_pk_bf16_f32 v72, v16, v17
    v_cvt_pk_bf16_f32 v73, v18, v19
    v_cvt_pk_bf16_f32 v76, v20, v21
    v_cvt_pk_bf16_f32 v77, v22, v23
    v_cvt_pk_bf16_f32 v80, v24, v25
    v_cvt_pk_bf16_f32 v81, v26, v27
    v_cvt_pk_bf16_f32 v88, v64, v65
    v_cvt_pk_bf16_f32 v89, v66, v67
    s_cmp_lg_u32 s42, 0
    s_cbranch_scc1 L_f_nb
    ds_write_b64 v164, v[124:125]
    ds_write_b64 v164, v[88:89] offset:512
    v_mov_b32 v5, 1
    ds_write_b32 v165, v5 offset:128
    v_cvt_pk_bf16_f32 v108, v28, v29
    v_cvt_pk_bf16_f32 v109, v30, v31
    v_cvt_pk_bf16_f32 v96, v48, v49
    v_cvt_pk_bf16_f32 v97, v50, v51
L_f_nb:
    v_cvt_pk_bf16_f32 v94, v52, v53
    v_cvt_pk_bf16_f32 v95, v54, v55
    v_cvt_pk_bf16_f32 v92, v56, v57
    v_cvt_pk_bf16_f32 v93, v58, v59
    v_cvt_pk_bf16_f32 v90, v60, v61
    v_cvt_pk_bf16_f32 v91, v62, v63
    s_mov_b32 s100, 0
Lm_41:
    ds_read_b32 v4, v163
    s_waitcnt lgkmcnt(0)
    v_cmp_eq_u32 vcc, 0, v4
    s_and_b32 s99, vcc_lo, s48
    s_cbranch_scc0 Lmd_42
    s_add_u32 s100, s100, 1
    s_cmp_lt_u32 s100, 1048576
    s_cbranch_scc1 Lm_41
Lmd_42:
    s_cmp_eq_u32 s42, 0
    s_cbranch_scc1 L_f_nr
    ds_read_b64 v[108:109], v164
    ds_read_b64 v[96:97], v164 offset:512
L_f_nr:
    s_mov_b64 exec, s[52:53]
    ds_read_b64 v[70:71], v156 offset:512
    ds_read_b64 v[74:75], v156 offset:1024
    ds_read_b64 v[78:79], v156 offset:1536
    ds_read_b64 v[82:83], v156 offset:2048
    s_mov_b64 exec, -1
    ds_read_b64 v[110:111], v156 offset:4608
    ds_read_b64 v[114:115], v156 offset:5120
    ds_read_b64 v[118:119], v156 offset:5632
    ds_read_b64 v[122:123], v156 offset:6144
    ds_read_b64 v[126:127], v156 offset:6656
    s_waitcnt lgkmcnt(3)
    v_mfma_f32_16x16x32_bf16 v[8:11], v[112:115], v[68:71], v[144:147]
    v_mfma_f32_16x16x32_bf16 v[24:27], v[108:111], v[68:71], v[140:143]
    s_waitcnt lgkmcnt(2)
    v_mfma_f32_16x16x32_bf16 v[12:15], v[116:119], v[72:75], v[144:147]
    v_mfma_f32_16x16x32_bf16 v[28:31], v[112:115], v[72:75], v[148:151]
    s_waitcnt lgkmcnt(1)
    v_mfma_f32_16x16x32_bf16 v[16:19], v[120:123], v[76:79], v[144:147]
    v_mfma_f32_16x16x32_bf16 v[32:35], v[116:119], v[76:79], v[148:151]
    s_waitcnt lgkmcnt(0)
    v_mfma_f32_16x16x32_bf16 v[20:23], v[124:127], v[80:83], v[144:147]
    v_mfma_f32_16x16x32_bf16 v[36:39], v[120:123], v[80:83], v[148:151]
    v_max3_f32 v68, v8, v9, v24
    v_max3_f32 v69, v10, v11, v26
    v_max_f32 v68, v68, v25
    v_max_f32 v69, v69, v27
    v_max3_f32 v70, v12, v13, v28
    v_max3_f32 v71, v14, v15, v30
    v_max_f32 v70, v70, v29
    v_max_f32 v71, v71, v31
    v_max3_f32 v72, v16, v17, v32
    v_max3_f32 v73, v18, v19, v34
    v_max_f32 v72, v72, v33
    v_max_f32 v73, v73, v35
    v_max3_f32 v74, v20, v21, v36
    v_max3_f32 v75, v22, v23, v38
    v_max_f32 v74, v74, v37
    v_max_f32 v75, v75, v39
L_soft:
    v_max_f32 v76, v68, v69
    v_max_f32 v77, v70, v71
    v_max_f32 v78, v72, v73
    v_max_f32 v79, v74, v75
    v_mov_b32 v84, 0x3f803f80
    v_permlane32_swap_b32 v76, v77
    v_permlane32_swap_b32 v78, v79
    v_max_f32 v76, v76, v77
    v_max_f32 v78, v78, v79
    v_mov_b32 v85, 0x3f803f80
    v_mov_b32 v86, 0x3f803f80
    v_permlane16_swap_b32 v76, v78
    v_max_f32 v76, v76, v78
    v_mul_f32 v78, s54, v76
    v_mul_f32 v76, s54, v76
    v_mov_b32 v87, 0x3f803f80
    v_mov_b32 v4, 1
    v_permlane16_swap_b32 v76, v78
    v_mov_b32 v77, v76
    v_mov_b32 v79, v78
    s_waitcnt lgkmcnt(0)
    v_permlane32_swap_b32 v76, v77
    v_permlane32_swap_b32 v78, v79
    v_fma_f32 v68, v68, s54, -v76
    v_fma_f32 v69, v69, s54, -v76
    v_fma_f32 v70, v70, s54, -v77
    v_fma_f32 v71, v71, s54, -v77
    v_fma_f32 v72, v72, s54, -v78
    v_fma_f32 v73, v73, s54, -v78
    v_fma_f32 v74, v74, s54, -v79
    v_fma_f32 v75, v75, s54, -v79
    s_bitcmp1_b32 s45, 7
    s_cbranch_scc1 L_novx
    ds_read_b32 v6, v163
    ds_read_b64 v[106:107], v162 offset:9216
    ds_read_b64 v[104:105], v162 offset:9728
    ds_read_b64 v[102:103], v162 offset:10240
    ds_read_b64 v[100:101], v162 offset:10752
    ds_read_b64 v[98:99], v162 offset:11264
L_novx:
    v_exp_f32 v68, v68
    v_exp_f32 v69, v69
    v_exp_f32 v70, v70
    v_exp_f32 v71, v71
    v_exp_f32 v72, v72
    v_exp_f32 v73, v73
    v_exp_f32 v74, v74
    v_exp_f32 v75, v75
    v_cvt_pk_bf16_f32 v80, v68, v69
    v_perm_b32 v108, v80, v80, v152
    v_perm_b32 v109, v80, v80, v153
    v_perm_b32 v110, v80, v80, v154
    v_perm_b32 v111, v80, v80, v155
    v_cvt_pk_bf16_f32 v81, v70, v71
    v_perm_b32 v112, v81, v81, v152
    v_perm_b32 v113, v81, v81, v153
    s_branch L_skip2657
L_padb10:
    s_branch L_warmed_b
L_skip2657:
    v_perm_b32 v114, v81, v81, v154
    v_perm_b32 v115, v81, v81, v155
    v_mfma_f32_16x16x32_bf16 v[24:27], v[84:87], v[108:111], 0
    v_mfma_f32_16x16x32_bf16 v[8:11], v[94:97], v[108:111], 0
    v_cvt_pk_bf16_f32 v82, v72, v73
    v_perm_b32 v116, v82, v82, v152
    v_perm_b32 v117, v82, v82, v153
    v_perm_b32 v118, v82, v82, v154
    v_perm_b32 v119, v82, v82, v155
    v_mfma_f32_16x16x32_bf16 v[28:31], v[84:87], v[112:115], 0
    v_mfma_f32_16x16x32_bf16 v[12:15], v[92:95], v[112:115], 0
    v_cvt_pk_bf16_f32 v83, v74, v75
    v_perm_b32 v120, v83, v83, v152
    v_perm_b32 v121, v83, v83, v153
    v_perm_b32 v122, v83, v83, v154
    v_perm_b32 v123, v83, v83, v155
    v_mfma_f32_16x16x32_bf16 v[32:35], v[84:87], v[116:119], 0
    v_mfma_f32_16x16x32_bf16 v[16:19], v[90:93], v[116:119], 0
    s_bitcmp1_b32 s45, 7
    v_mfma_f32_16x16x32_bf16 v[36:39], v[84:87], v[120:123], 0
    v_mfma_f32_16x16x32_bf16 v[20:23], v[88:91], v[120:123], 0
    s_cbranch_scc1 L_norem
    s_mov_b32 s100, 0
L_vxw:
    s_waitcnt lgkmcnt(0)
    v_cmp_eq_u32 vcc, 0, v6
    s_and_b32 s99, vcc_lo, s49
    s_cbranch_scc1 L_vxslow
L_vxok:
    v_mfma_f32_16x16x32_bf16 v[40:43], v[104:107], v[108:111], 0
    v_mfma_f32_16x16x32_bf16 v[44:47], v[102:105], v[112:115], 0
    v_mfma_f32_16x16x32_bf16 v[48:51], v[100:103], v[116:119], 0
    v_mfma_f32_16x16x32_bf16 v[52:55], v[98:101], v[120:123], 0
L_norem:
    s_mov_b64 exec, 1
    ds_add_u32 v3, v4 offset:196
    s_mov_b64 exec, -1
    ds_read_b32 v6, v163 offset:264
    v_rcp_f32 v24, v24
    v_rcp_f32 v28, v28
    v_rcp_f32 v32, v32
    v_rcp_f32 v36, v36
    v_pk_mul_f32 v[8:9], v[8:9], v[24:25] op_sel_hi:[1,0]
    v_pk_mul_f32 v[10:11], v[10:11], v[24:25] op_sel_hi:[1,0]
    v_pk_mul_f32 v[12:13], v[12:13], v[28:29] op_sel_hi:[1,0]
    v_pk_mul_f32 v[14:15], v[14:15], v[28:29] op_sel_hi:[1,0]
    v_pk_mul_f32 v[16:17], v[16:17], v[32:33] op_sel_hi:[1,0]
    v_pk_mul_f32 v[18:19], v[18:19], v[32:33] op_sel_hi:[1,0]
    v_pk_mul_f32 v[20:21], v[20:21], v[36:37] op_sel_hi:[1,0]
    v_pk_mul_f32 v[22:23], v[22:23], v[36:37] op_sel_hi:[1,0]
    v_cvt_pk_bf16_f32 v56, v8, v9
    v_cvt_pk_bf16_f32 v57, v10, v11
    v_cvt_pk_bf16_f32 v58, v12, v13
    v_cvt_pk_bf16_f32 v59, v14, v15
    v_cvt_pk_bf16_f32 v60, v16, v17
    v_cvt_pk_bf16_f32 v61, v18, v19
    v_cvt_pk_bf16_f32 v62, v20, v21
    v_cvt_pk_bf16_f32 v63, v22, v23
    s_mov_b32 s100, 0
L_rxw:
    s_waitcnt lgkmcnt(0)
    v_cmp_eq_u32 vcc, 0, v6
    s_and_b32 s99, vcc_lo, s47
    s_cbranch_scc1 L_rxslow
L_rxok:
    s_mov_b64 exec, s[50:51]
    s_cmp_lg_u32 s91, 1
    s_cbranch_scc1 Ldg_43
    global_store_dwordx2 v160, v[56:57], s[18:19] offset:0
    global_store_dwordx2 v160, v[58:59], s[18:19] offset:1024
    global_store_dwordx2 v157, v[60:61], s[18:19] offset:0
    global_store_dwordx2 v157, v[62:63], s[18:19] offset:1024
    s_branch Ldd_44
Ldg_43:
    global_store_dwordx2 v160, v[56:57], s[18:19] offset:0 sc1
    global_store_dwordx2 v160, v[58:59], s[18:19] offset:1024 sc1
    global_store_dwordx2 v157, v[60:61], s[18:19] offset:0 sc1
    global_store_dwordx2 v157, v[62:63], s[18:19] offset:1024 sc1
Ldd_44:
    s_mov_b64 exec, -1
    s_bitcmp1_b32 s45, 7
    s_cbranch_scc1 L_norem2
    v_pk_mul_f32 v[64:65], v[40:41], v[24:25] op_sel_hi:[1,0]
    v_pk_mul_f32 v[66:67], v[42:43], v[24:25] op_sel_hi:[1,0]
    s_mov_b32 exec_lo, 0xffff0000
    v_pk_mul_f32 v[64:65], v[44:45], v[28:29] op_sel_hi:[1,0]
    v_pk_mul_f32 v[66:67], v[46:47], v[28:29] op_sel_hi:[1,0]
    s_mov_b32 exec_lo, 0
    v_pk_mul_f32 v[64:65], v[48:49], v[32:33] op_sel_hi:[1,0]
    v_pk_mul_f32 v[66:67], v[50:51], v[32:33] op_sel_hi:[1,0]
    s_mov_b32 exec_hi, 0xffff0000
    v_pk_mul_f32 v[64:65], v[52:53], v[36:37] op_sel_hi:[1,0]
    v_pk_mul_f32 v[66:67], v[54:55], v[36:37] op_sel_hi:[1,0]
    s_mov_b64 exec, -1
    v_cvt_pk_bf16_f32 v64, v64, v65
    v_cvt_pk_bf16_f32 v65, v66, v67
    s_cmp_lg_u32 s91, 1
    s_cbranch_scc1 Ldg_45
    global_store_dwordx2 v161, v[64:65], s[18:19]
    s_branch Ldd_46
Ldg_45:
    global_store_dwordx2 v161, v[64:65], s[18:19] sc1
Ldd_46:
L_norem2:
    v_mov_b32 v6, s55
    v_mov_b32 v5, s33
    s_mov_b64 exec, 1
    ds_add_u32 v3, v4 offset:268
    s_waitcnt vmcnt(0)
    s_cmp_lg_u32 s91, 1
    s_cbranch_scc1 Ldg_47
    global_store_dword v6, v5, s[16:17]
    s_branch Ldd_48
L_pada7:
    s_branch L_pada15
L_padb11:
    s_branch L_warmed_b
Ldg_47:
    global_store_dword v6, v5, s[16:17] sc1
Ldd_48:
    s_mov_b64 exec, -1
L_tail:
    s_lshl_b32 s96, s57, 2
    v_add_u32 v136, s96, v3
    s_add_u32 s62, s18, 8192
    s_addc_u32 s63, s19, 0
    s_add_u32 s64, s18, 16384
    s_addc_u32 s65, s19, 0
    s_setprio 2
    s_cmp_eq_u32 s57, 0
    s_cbranch_scc1 L_tp
    s_setprio 1
L_tp:
    v_mov_b32 v135, 0
    v_lshl_add_u32 v137, v0, 4, s84
    s_lshl_b32 s96, s56, 2
    v_add_u32 v160, s96, v3
    s_cmp_lg_u32 s34, 0
    s_cbranch_scc1 L_opa
    s_mov_b32 s100, 0
Lw_49:
    ds_read_b32 v4, v3 offset:268
    s_waitcnt lgkmcnt(0)
    v_readfirstlane_b32 s99, v4
    s_cmp_ge_u32 s99, 64
    s_cbranch_scc1 Lwd_50
    s_add_u32 s100, s100, 1
    s_cmp_lt_u32 s100, 1048576
    s_cbranch_scc1 Lw_49
Lwd_50:
    s_cmp_lg_u32 s57, 0
    s_cbranch_scc1 L_prep
L_opb:
    s_mov_b32 s100, 0
Lw_51:
    ds_read_b32 v4, v136 offset:200
    s_waitcnt lgkmcnt(0)
    v_readfirstlane_b32 s99, v4
    s_cmp_ge_u32 s99, 4
    s_cbranch_scc1 Lwd_52
    s_sleep 1
    s_add_u32 s100, s100, 1
    s_cmp_lt_u32 s100, 1048576
    s_cbranch_scc1 Lw_51
Lwd_52:
    ds_read_b128 v[68:71], v138 offset:0
    ds_read_b128 v[72:75], v138 offset:1024
    ds_read_b128 v[76:79], v138 offset:2048
    ds_read_b128 v[80:83], v138 offset:3072
    ds_read_b128 v[84:87], v138 offset:4096
    ds_read_b128 v[88:91], v138 offset:5120
    ds_read_b128 v[92:95], v138 offset:6144
    ds_read_b128 v[96:99], v138 offset:7168
    ds_read_b128 v[100:103], v138 offset:8192
    ds_read_b128 v[104:107], v138 offset:9216
    ds_read_b128 v[108:111], v138 offset:10240
    ds_read_b128 v[112:115], v138 offset:11264
    s_waitcnt lgkmcnt(8)
    ds_read_b128 v[116:119], v138 offset:12288
    ds_read_b128 v[120:123], v138 offset:13312
    ds_read_b128 v[124:127], v138 offset:14336
    ds_read_b128 v[128:131], v138 offset:15360
    s_cmp_eq_u32 s57, 0
    s_cbranch_scc1 L_opp
L_lgo:
    s_mov_b32 s100, 0
Lw_53:
    ds_read_b32 v4, v160 offset:216
    s_waitcnt lgkmcnt(0)
    v_readfirstlane_b32 s99, v4
    s_cmp_ge_u32 s99, 1
    s_cbranch_scc1 Lwd_54
    s_sleep 1
    s_add_u32 s100, s100, 1
    s_cmp_lt_u32 s100, 1048576
    s_cbranch_scc1 Lw_53
Lwd_54:
    s_branch L_late
L_opp:
    s_mov_b32 exec_hi, 0xfffff
    s_mov_b32 exec_lo, 0xfffff
    s_mov_b32 s100, 0
L_op:
    global_load_dword v4, v166, s[16:17] sc1
    s_waitcnt vmcnt(0)
    v_cmp_ne_u32 vcc, s33, v4
    s_cbranch_vccz L_opd
    s_add_u32 s100, s100, 1
    s_cmp_lt_u32 s100, 1048576
    s_cbranch_scc1 L_op
    s_branch L_opd
L_opa:
    s_cmp_eq_u32 s57, 0
    s_cbranch_scc1 L_opa1
    s_mov_b32 s100, 0
Lw_55:
    ds_read_b32 v4, v3 offset:376
    s_waitcnt lgkmcnt(0)
    v_readfirstlane_b32 s99, v4
    s_cmp_ge_u32 s99, 2
    s_cbranch_scc1 Lwd_56
    s_sleep 1
    s_add_u32 s100, s100, 1
    s_cmp_lt_u32 s100, 1048576
    s_cbranch_scc1 Lw_55
Lwd_56:
    s_setprio 3
    s_branch L_prep
L_pada8:
    s_branch L_pada16
L_padb12:
    s_branch L_warmed_b
L_opa1:
    s_mov_b32 s100, 0
Lw_57:
    ds_read_b32 v4, v3 offset:200
    s_waitcnt lgkmcnt(0)
    v_readfirstlane_b32 s99, v4
    s_cmp_ge_u32 s99, 4
    s_cbranch_scc1 Lwd_58
    s_sleep 1
    s_add_u32 s100, s100, 1
    s_cmp_lt_u32 s100, 1048576
    s_cbranch_scc1 Lw_57
Lwd_58:
    ds_read_b128 v[68:71], v138 offset:0
    ds_read_b128 v[72:75], v138 offset:1024
    ds_read_b128 v[76:79], v138 offset:2048
    ds_read_b128 v[80:83], v138 offset:3072
    ds_read_b128 v[84:87], v138 offset:4096
    ds_read_b128 v[88:91], v138 offset:5120
    ds_read_b128 v[92:95], v138 offset:6144
    ds_read_b128 v[96:99], v138 offset:7168
    ds_read_b128 v[100:103], v138 offset:8192
    ds_read_b128 v[104:107], v138 offset:9216
    ds_read_b128 v[108:111], v138 offset:10240
    ds_read_b128 v[112:115], v138 offset:11264
    s_waitcnt lgkmcnt(8)
    ds_read_b128 v[116:119], v138 offset:12288
    ds_read_b128 v[120:123], v138 offset:13312
    ds_read_b128 v[124:127], v138 offset:14336
    ds_read_b128 v[128:131], v138 offset:15360
    s_mov_b32 s100, 0
Lw_59:
    ds_read_b32 v4, v3 offset:276
    s_waitcnt lgkmcnt(0)
    v_readfirstlane_b32 s99, v4
    s_cmp_ge_u32 s99, 1
    s_cbranch_scc1 Lwd_60
    s_sleep 1
    s_add_u32 s100, s100, 1
    s_cmp_lt_u32 s100, 1048576
    s_cbranch_scc1 Lw_59
Lwd_60:
L_opd:
    s_mov_b64 exec, -1
    s_cmp_eq_u32 s57, 0
    s_cbranch_scc1 L_early
L_late:
    global_load_dwordx4 v[28:31], v139, s[18:19] offset:-4096 sc1
    global_load_dwordx4 v[32:35], v139, s[18:19] offset:-2048 sc1
    global_load_dwordx4 v[36:39], v139, s[18:19] offset:0 sc1
    global_load_dwordx4 v[40:43], v139, s[18:19] offset:2048 sc1
    global_load_dwordx4 v[44:47], v139, s[62:63] offset:-4096 sc1
    global_load_dwordx4 v[48:51], v139, s[62:63] offset:-2048 sc1
    global_load_dwordx4 v[52:55], v139, s[62:63] offset:0 sc1
    global_load_dwordx4 v[56:59], v139, s[62:63] offset:2048 sc1
    global_load_dwordx4 v[60:63], v139, s[64:65] offset:-4096 sc1
    global_load_dwordx4 v[64:67], v139, s[64:65] offset:-2048 sc1
    s_lshr_b32 s96, s56, 1
    s_lshl_b32 s96, s96, 7
    s_add_u32 s96, s96, 3072
    v_add_u32 v166, s96, v166
    v_mov_b32 v134, s33
    s_and_b32 s96, s56, 1
    s_lshl1_add_u32 s96, s96, s57
    s_lshl2_add_u32 s96, s36, s96
    s_lshl_b64 s[66:67], 1, s96
    s_cmp_eq_u32 s34, 0
    s_cbranch_scc1 L_nogq
    s_mov_b32 s100, 0
Lw_61:
    ds_read_b32 v4, v3 offset:204
    s_waitcnt lgkmcnt(0)
    v_readfirstlane_b32 s99, v4
    s_cmp_ge_u32 s99, 4
    s_cbranch_scc1 Lwd_62
    s_sleep 1
    s_add_u32 s100, s100, 1
    s_cmp_lt_u32 s100, 1048576
    s_cbranch_scc1 Lw_61
Lwd_62:
    ds_read_b128 v[68:71], v138 offset:0
    ds_read_b128 v[72:75], v138 offset:1024
    ds_read_b128 v[76:79], v138 offset:2048
    ds_read_b128 v[80:83], v138 offset:3072
    ds_read_b128 v[84:87], v138 offset:4096
    ds_read_b128 v[88:91], v138 offset:5120
    ds_read_b128 v[92:95], v138 offset:6144
    ds_read_b128 v[96:99], v138 offset:7168
    ds_read_b128 v[100:103], v138 offset:8192
    ds_read_b128 v[104:107], v138 offset:9216
    ds_read_b128 v[108:111], v138 offset:10240
    ds_read_b128 v[112:115], v138 offset:11264
    s_waitcnt lgkmcnt(8)
    ds_read_b128 v[116:119], v138 offset:12288
    ds_read_b128 v[120:123], v138 offset:13312
    ds_read_b128 v[124:127], v138 offset:14336
    ds_read_b128 v[128:131], v138 offset:15360
    s_branch L_nogq
L_pada9:
    s_branch L_pada17
L_padb13:
    s_branch L_warmed_b
    s_setprio 3
    s_waitcnt lgkmcnt(6)
L_prep:
    s_lshl_b32 s96, s56, 6
    s_add_u32 s96, s96, 161280
    v_lshl_add_u32 v164, v1, 2, s96
    v_mul_u32_u24 v161, 160, v1
    v_lshl_add_u32 v161, v2, 3, v161
    v_add_u32 v5, s81, v161
    s_mov_b32 s100, 0
Lw_63:
    ds_read_b32 v4, v3 offset:208
    s_waitcnt lgkmcnt(0)
    v_readfirstlane_b32 s99, v4
    s_cmp_ge_u32 s99, 1
    s_cbranch_scc1 Lwd_64
    s_add_u32 s100, s100, 1
    s_cmp_lt_u32 s100, 1048576
    s_cbranch_scc1 Lw_63
Lwd_64:
    ds_read2st64_b32 v[162:163], v164 offset0:0 offset1:1
    ds_read_b64 v[150:151], v5 offset:0
    ds_read_b64 v[152:153], v5 offset:32
    ds_read_b64 v[154:155], v5 offset:64
    ds_read_b64 v[156:157], v5 offset:96
    ds_read_b64 v[158:159], v5 offset:128
    v_add_u32 v161, s84, v161
    v_add_u32 v5, 0, v0
    v_mul_u32_u24 v165, 6554, v5
    v_lshrrev_b32 v165, 16, v165
    v_mul_u32_u24 v165, 1120, v165
    v_lshl_add_u32 v5, v5, 4, s85
    v_add_u32 v165, v165, v5
    v_add_u32 v5, 64, v0
    v_mul_u32_u24 v7, 6554, v5
    v_lshrrev_b32 v7, 16, v7
    v_mul_u32_u24 v7, 1120, v7
    v_lshl_add_u32 v5, v5, 4, s85
    v_add_u32 v7, v7, v5
    v_add_u32 v5, 128, v0
    v_mul_u32_u24 v135, 6554, v5
    v_lshrrev_b32 v135, 16, v135
    v_mul_u32_u24 v135, 1120, v135
    v_lshl_add_u32 v5, v5, 4, s85
    v_add_u32 v135, v135, v5
    v_bfe_u32 v5, v0, 3, 2
    v_xor_b32 v5, s56, v5
    v_lshlrev_b32 v5, 5, v5
    v_lshrrev_b32 v6, 2, v0
    v_lshl_add_u32 v5, v6, 7, v5
    v_and_b32 v6, 3, v0
    v_lshl_add_u32 v5, v6, 3, v5
    v_add_u32 v164, s93, v5
    s_waitcnt lgkmcnt(0)
    v_lshlrev_b32 v140, 16, v150
    v_and_b32 v141, 0xffff0000, v150
    v_lshlrev_b32 v142, 16, v151
    v_and_b32 v143, 0xffff0000, v151
    v_lshlrev_b32 v144, 16, v152
    v_and_b32 v145, 0xffff0000, v152
    v_lshlrev_b32 v146, 16, v153
    v_and_b32 v147, 0xffff0000, v153
    v_lshlrev_b32 v148, 16, v154
    v_and_b32 v149, 0xffff0000, v154
    v_lshlrev_b32 v150, 16, v155
    v_and_b32 v151, 0xffff0000, v155
    v_lshlrev_b32 v152, 16, v156
    v_and_b32 v153, 0xffff0000, v156
    v_lshlrev_b32 v154, 16, v157
    v_and_b32 v155, 0xffff0000, v157
    v_lshlrev_b32 v156, 16, v158
    v_and_b32 v157, 0xffff0000, v158
    v_lshlrev_b32 v158, 16, v159
    v_and_b32 v159, 0xffff0000, v159
    v_pk_mul_f32 v[140:141], v[140:141], v[162:163] op_sel:[0,1] op_sel_hi:[1,1]
    v_pk_mul_f32 v[142:143], v[142:143], v[162:163] op_sel:[0,1] op_sel_hi:[1,1]
    v_pk_mul_f32 v[144:145], v[144:145], v[162:163] op_sel:[0,1] op_sel_hi:[1,1]
    v_pk_mul_f32 v[146:147], v[146:147], v[162:163] op_sel:[0,1] op_sel_hi:[1,1]
    v_pk_mul_f32 v[148:149], v[148:149], v[162:163] op_sel:[0,1] op_sel_hi:[1,1]
    v_pk_mul_f32 v[150:151], v[150:151], v[162:163] op_sel:[0,1] op_sel_hi:[1,1]
    v_pk_mul_f32 v[152:153], v[152:153], v[162:163] op_sel:[0,1] op_sel_hi:[1,1]
    v_pk_mul_f32 v[154:155], v[154:155], v[162:163] op_sel:[0,1] op_sel_hi:[1,1]
    v_pk_mul_f32 v[156:157], v[156:157], v[162:163] op_sel:[0,1] op_sel_hi:[1,1]
    v_pk_mul_f32 v[158:159], v[158:159], v[162:163] op_sel:[0,1] op_sel_hi:[1,1]
    s_setprio 1
    s_cmp_eq_u32 s34, 0
    s_cbranch_scc1 L_opb
    s_branch L_lgo
L_pada10:
    s_branch L_pada18
L_padb14:
    s_branch L_warmed_b
L_nogq:
    s_waitcnt lgkmcnt(0)
    s_waitcnt vmcnt(9)
    v_mfma_f32_16x16x32_bf16 v[8:11], v[68:71], v[28:31], 0
    ds_read_b128 v[68:71], v138 offset:16384
    v_mfma_f32_16x16x32_bf16 v[12:15], v[72:75], v[28:31], 0
    ds_read_b128 v[72:75], v138 offset:17408
    v_mfma_f32_16x16x32_bf16 v[16:19], v[76:79], v[28:31], 0
    ds_read_b128 v[76:79], v138 offset:18432
    v_mfma_f32_16x16x32_bf16 v[20:23], v[80:83], v[28:31], 0
    ds_read_b128 v[80:83], v138 offset:19456
    v_mfma_f32_16x16x32_bf16 v[24:27], v[84:87], v[28:31], 0
    ds_read_b128 v[84:87], v138 offset:20480
    s_waitcnt vmcnt(8)
    v_mfma_f32_16x16x32_bf16 v[8:11], v[88:91], v[32:35], v[8:11]
    ds_read_b128 v[88:91], v138 offset:21504
    v_mfma_f32_16x16x32_bf16 v[12:15], v[92:95], v[32:35], v[12:15]
    ds_read_b128 v[92:95], v138 offset:22528
    v_mfma_f32_16x16x32_bf16 v[16:19], v[96:99], v[32:35], v[16:19]
    ds_read_b128 v[96:99], v138 offset:23552
    v_mfma_f32_16x16x32_bf16 v[20:23], v[100:103], v[32:35], v[20:23]
    ds_read_b128 v[100:103], v138 offset:24576
    v_mfma_f32_16x16x32_bf16 v[24:27], v[104:107], v[32:35], v[24:27]
    ds_read_b128 v[104:107], v138 offset:25600
    s_waitcnt vmcnt(7)
    v_mfma_f32_16x16x32_bf16 v[8:11], v[108:111], v[36:39], v[8:11]
    ds_read_b128 v[108:111], v138 offset:26624
    v_mfma_f32_16x16x32_bf16 v[12:15], v[112:115], v[36:39], v[12:15]
    ds_read_b128 v[112:115], v138 offset:27648
    v_mfma_f32_16x16x32_bf16 v[16:19], v[116:119], v[36:39], v[16:19]
    s_waitcnt lgkmcnt(10)
    ds_read_b128 v[116:119], v138 offset:28672
    v_mfma_f32_16x16x32_bf16 v[20:23], v[120:123], v[36:39], v[20:23]
    ds_read_b128 v[120:123], v138 offset:29696
    v_mfma_f32_16x16x32_bf16 v[24:27], v[124:127], v[36:39], v[24:27]
    s_waitcnt lgkmcnt(10)
    ds_read_b128 v[124:127], v138 offset:30720
    s_waitcnt vmcnt(6)
    v_mfma_f32_16x16x32_bf16 v[8:11], v[128:131], v[40:43], v[8:11]
    ds_read_b128 v[128:131], v138 offset:31744
    v_mfma_f32_16x16x32_bf16 v[12:15], v[68:71], v[40:43], v[12:15]
    s_waitcnt lgkmcnt(10)
    ds_read_b128 v[68:71], v138 offset:32768
    v_mfma_f32_16x16x32_bf16 v[16:19], v[72:75], v[40:43], v[16:19]
    ds_read_b128 v[72:75], v138 offset:33792
    v_mfma_f32_16x16x32_bf16 v[20:23], v[76:79], v[40:43], v[20:23]
    s_waitcnt lgkmcnt(10)
    ds_read_b128 v[76:79], v138 offset:34816
    v_mfma_f32_16x16x32_bf16 v[24:27], v[80:83], v[40:43], v[24:27]
    ds_read_b128 v[80:83], v138 offset:35840
    s_waitcnt vmcnt(5)
    v_mfma_f32_16x16x32_bf16 v[8:11], v[84:87], v[44:47], v[8:11]
    s_waitcnt lgkmcnt(10)
    ds_read_b128 v[84:87], v138 offset:36864
    v_mfma_f32_16x16x32_bf16 v[12:15], v[88:91], v[44:47], v[12:15]
    ds_read_b128 v[88:91], v138 offset:37888
    v_mfma_f32_16x16x32_bf16 v[16:19], v[92:95], v[44:47], v[16:19]
    s_waitcnt lgkmcnt(10)
    ds_read_b128 v[92:95], v138 offset:38912
    v_mfma_f32_16x16x32_bf16 v[20:23], v[96:99], v[44:47], v[20:23]
    ds_read_b128 v[96:99], v138 offset:39936
    v_mfma_f32_16x16x32_bf16 v[24:27], v[100:103], v[44:47], v[24:27]
    s_waitcnt lgkmcnt(10)
    ds_read_b128 v[100:103], v138 offset:40960
    s_waitcnt vmcnt(4)
    v_mfma_f32_16x16x32_bf16 v[8:11], v[104:107], v[48:51], v[8:11]
    ds_read_b128 v[104:107], v138 offset:41984
    v_mfma_f32_16x16x32_bf16 v[12:15], v[108:111], v[48:51], v[12:15]
    s_waitcnt lgkmcnt(10)
    ds_read_b128 v[108:111], v138 offset:43008
    v_mfma_f32_16x16x32_bf16 v[16:19], v[112:115], v[48:51], v[16:19]
    ds_read_b128 v[112:115], v138 offset:44032
    v_mfma_f32_16x16x32_bf16 v[20:23], v[116:119], v[48:51], v[20:23]
    s_waitcnt lgkmcnt(10)
    ds_read_b128 v[116:119], v138 offset:45056
    v_mfma_f32_16x16x32_bf16 v[24:27], v[120:123], v[48:51], v[24:27]
    ds_read_b128 v[120:123], v138 offset:46080
    s_waitcnt vmcnt(3)
    v_mfma_f32_16x16x32_bf16 v[8:11], v[124:127], v[52:55], v[8:11]
    s_waitcnt lgkmcnt(10)
    ds_read_b128 v[124:127], v138 offset:47104
    v_mfma_f32_16x16x32_bf16 v[12:15], v[128:131], v[52:55], v[12:15]
    ds_read_b128 v[128:131], v138 offset:48128
    v_mfma_f32_16x16x32_bf16 v[16:19], v[68:71], v[52:55], v[16:19]
    s_waitcnt lgkmcnt(10)
    ds_read_b128 v[68:71], v138 offset:49152
    v_mfma_f32_16x16x32_bf16 v[20:23], v[72:75], v[52:55], v[20:23]
    ds_read_b128 v[72:75], v138 offset:50176
    v_mfma_f32_16x16x32_bf16 v[24:27], v[76:79], v[52:55], v[24:27]
    s_waitcnt vmcnt(0)
    v_mfma_f32_16x16x32_bf16 v[8:11], v[80:83], v[56:59], v[8:11]
    s_mov_b64 exec, s[66:67]
    global_store_dword v166, v134, s[28:29]
    s_mov_b64 exec, -1
    v_mfma_f32_16x16x32_bf16 v[12:15], v[84:87], v[56:59], v[12:15]
    v_mfma_f32_16x16x32_bf16 v[16:19], v[88:91], v[56:59], v[16:19]
    s_waitcnt lgkmcnt(11)
    v_mfma_f32_16x16x32_bf16 v[20:23], v[92:95], v[56:59], v[20:23]
    s_waitcnt lgkmcnt(10)
    v_mfma_f32_16x16x32_bf16 v[24:27], v[96:99], v[56:59], v[24:27]
    s_waitcnt lgkmcnt(9)
    v_mfma_f32_16x16x32_bf16 v[8:11], v[100:103], v[60:63], v[8:11]
    s_waitcnt lgkmcnt(8)
    v_mfma_f32_16x16x32_bf16 v[12:15], v[104:107], v[60:63], v[12:15]
    s_waitcnt lgkmcnt(7)
    v_mfma_f32_16x16x32_bf16 v[16:19], v[108:111], v[60:63], v[16:19]
    s_waitcnt lgkmcnt(6)
    v_mfma_f32_16x16x32_bf16 v[20:23], v[112:115], v[60:63], v[20:23]
    s_waitcnt lgkmcnt(5)
    v_mfma_f32_16x16x32_bf16 v[24:27], v[116:119], v[60:63], v[24:27]
    s_waitcnt lgkmcnt(4)
    v_mfma_f32_16x16x32_bf16 v[8:11], v[120:123], v[64:67], v[8:11]
    s_waitcnt lgkmcnt(3)
    v_mfma_f32_16x16x32_bf16 v[12:15], v[124:127], v[64:67], v[12:15]
    s_waitcnt lgkmcnt(2)
    v_mfma_f32_16x16x32_bf16 v[16:19], v[128:131], v[64:67], v[16:19]
    s_waitcnt lgkmcnt(1)
    v_mfma_f32_16x16x32_bf16 v[20:23], v[68:71], v[64:67], v[20:23]
    s_waitcnt lgkmcnt(0)
    v_mfma_f32_16x16x32_bf16 v[24:27], v[72:75], v[64:67], v[24:27]
    s_cmp_lg_u32 s101, 0
    s_cbranch_scc1 L_cvl
L_cvdl:
    s_setprio 3
    s_mov_b32 s100, 0
L_fb:
    ds_read_b32 v4, v160 offset:232
    ds_read_b128 v[28:31], v137 offset:0
    ds_read_b128 v[32:35], v137 offset:1024
    ds_read_b128 v[36:39], v137 offset:2048
    ds_read_b128 v[40:43], v137 offset:3072
    ds_read_b128 v[44:47], v137 offset:4096
    ds_read_b32 v5, v3 offset:212
    ds_read_b64_tr_b16 v[48:49], v164 offset:0
    ds_read_b64_tr_b16 v[50:51], v164 offset:2048
    ds_read_b64_tr_b16 v[52:53], v164 offset:4096
    ds_read_b64_tr_b16 v[54:55], v164 offset:6144
    ds_read_b64_tr_b16 v[56:57], v164 offset:8192
    s_waitcnt lgkmcnt(11)
    v_readfirstlane_b32 s96, v4
    s_cmp_lg_u32 s96, 0
    s_cbranch_scc1 L_fp
    s_waitcnt lgkmcnt(0)
    s_add_u32 s100, s100, 1
    s_cmp_lt_u32 s100, 1048576
    s_branch L_skip3212
L_pada11:
    s_branch L_pada19
L_padb15:
    s_branch L_warmed_b
L_skip3212:
    s_cbranch_scc1 L_fb
L_fp:
    s_mov_b64 exec, 0xffffffff
    global_load_dword v6, v166, s[28:29] sc1
    s_mov_b64 exec, -1
    s_waitcnt lgkmcnt(10)
    v_pk_add_f32 v[28:29], v[28:29], v[8:9]
    v_pk_add_f32 v[30:31], v[30:31], v[10:11]
    s_waitcnt lgkmcnt(9)
    v_pk_add_f32 v[32:33], v[32:33], v[12:13]
    v_pk_add_f32 v[34:35], v[34:35], v[14:15]
    s_waitcnt lgkmcnt(8)
    v_pk_add_f32 v[36:37], v[36:37], v[16:17]
    v_pk_add_f32 v[38:39], v[38:39], v[18:19]
    s_waitcnt lgkmcnt(7)
    v_pk_add_f32 v[40:41], v[40:41], v[20:21]
    v_pk_add_f32 v[42:43], v[42:43], v[22:23]
    s_waitcnt lgkmcnt(6)
    v_pk_add_f32 v[44:45], v[44:45], v[24:25]
    v_pk_add_f32 v[46:47], v[46:47], v[26:27]
    v_pk_mul_f32 v[28:29], v[28:29], v[162:163] op_sel_hi:[1,0]
    v_pk_mul_f32 v[30:31], v[30:31], v[162:163] op_sel_hi:[1,0]
    v_pk_mul_f32 v[32:33], v[32:33], v[162:163] op_sel_hi:[1,0]
    v_pk_mul_f32 v[34:35], v[34:35], v[162:163] op_sel_hi:[1,0]
    v_pk_mul_f32 v[36:37], v[36:37], v[162:163] op_sel_hi:[1,0]
    v_pk_mul_f32 v[38:39], v[38:39], v[162:163] op_sel_hi:[1,0]
    v_pk_mul_f32 v[40:41], v[40:41], v[162:163] op_sel_hi:[1,0]
    v_pk_mul_f32 v[42:43], v[42:43], v[162:163] op_sel_hi:[1,0]
    v_pk_mul_f32 v[44:45], v[44:45], v[162:163] op_sel_hi:[1,0]
    v_pk_mul_f32 v[46:47], v[46:47], v[162:163] op_sel_hi:[1,0]
    s_mov_b32 s100, 0
L_fy:
    s_waitcnt lgkmcnt(5)
    v_readfirstlane_b32 s96, v5
    s_cmp_eq_u32 s96, 2
    s_cbranch_scc1 L_fin
    ds_read_b32 v5, v3 offset:212
    ds_read_b64_tr_b16 v[48:49], v164 offset:0
    ds_read_b64_tr_b16 v[50:51], v164 offset:2048
    ds_read_b64_tr_b16 v[52:53], v164 offset:4096
    ds_read_b64_tr_b16 v[54:55], v164 offset:6144
    ds_read_b64_tr_b16 v[56:57], v164 offset:8192
    s_add_u32 s100, s100, 1
    s_cmp_lt_u32 s100, 1048576
    s_cbranch_scc1 L_fy
L_fin:
    s_waitcnt lgkmcnt(4)
    v_lshlrev_b32 v60, 16, v48
    v_and_b32 v61, 0xffff0000, v48
    v_lshlrev_b32 v62, 16, v49
    v_and_b32 v63, 0xffff0000, v49
    v_pk_fma_f32 v[28:29], v[60:61], v[140:141], v[28:29]
    v_pk_fma_f32 v[30:31], v[62:63], v[142:143], v[30:31]
    v_cvt_pk_bf16_f32 v48, v28, v29
    v_cvt_pk_bf16_f32 v49, v30, v31
    ds_write_b64 v161, v[48:49] offset:0
    s_waitcnt lgkmcnt(4)
    v_lshlrev_b32 v60, 16, v50
    v_and_b32 v61, 0xffff0000, v50
    v_lshlrev_b32 v62, 16, v51
    v_and_b32 v63, 0xffff0000, v51
    v_pk_fma_f32 v[32:33], v[60:61], v[144:145], v[32:33]
    v_pk_fma_f32 v[34:35], v[62:63], v[146:147], v[34:35]
    v_cvt_pk_bf16_f32 v50, v32, v33
    v_cvt_pk_bf16_f32 v51, v34, v35
    ds_write_b64 v161, v[50:51] offset:32
    s_waitcnt lgkmcnt(4)
    v_lshlrev_b32 v60, 16, v52
    v_and_b32 v61, 0xffff0000, v52
    v_lshlrev_b32 v62, 16, v53
    v_and_b32 v63, 0xffff0000, v53
    v_pk_fma_f32 v[36:37], v[60:61], v[148:149], v[36:37]
    v_pk_fma_f32 v[38:39], v[62:63], v[150:151], v[38:39]
    v_cvt_pk_bf16_f32 v52, v36, v37
    v_cvt_pk_bf16_f32 v53, v38, v39
    ds_write_b64 v161, v[52:53] offset:64
    s_waitcnt lgkmcnt(4)
    v_lshlrev_b32 v60, 16, v54
    v_and_b32 v61, 0xffff0000, v54
    v_lshlrev_b32 v62, 16, v55
    v_and_b32 v63, 0xffff0000, v55
    v_pk_fma_f32 v[40:41], v[60:61], v[152:153], v[40:41]
    v_pk_fma_f32 v[42:43], v[62:63], v[154:155], v[42:43]
    v_cvt_pk_bf16_f32 v54, v40, v41
    v_cvt_pk_bf16_f32 v55, v42, v43
    ds_write_b64 v161, v[54:55] offset:96
    s_waitcnt lgkmcnt(4)
    v_lshlrev_b32 v60, 16, v56
    v_and_b32 v61, 0xffff0000, v56
    v_lshlrev_b32 v62, 16, v57
    v_and_b32 v63, 0xffff0000, v57
    v_pk_fma_f32 v[44:45], v[60:61], v[156:157], v[44:45]
    v_pk_fma_f32 v[46:47], v[62:63], v[158:159], v[46:47]
    v_cvt_pk_bf16_f32 v56, v44, v45
    v_cvt_pk_bf16_f32 v57, v46, v47
    ds_write_b64 v161, v[56:57] offset:128
    ds_read_b128 v[72:75], v137 offset:0
    ds_read_b128 v[76:79], v137 offset:1024
    ds_read_b128 v[80:83], v137 offset:2048
    s_mov_b32 s100, 0
    s_cmp_lg_u32 s91, 1
    s_cbranch_scc1 L_gout
L_rdw:
    s_waitcnt vmcnt(0)
    v_cmp_ne_u32 vcc, s33, v6
    s_cmp_eq_u32 vcc_lo, 0
    s_cbranch_scc1 L_rdok
    s_mov_b64 exec, 0xffffffff
    global_load_dword v6, v166, s[28:29] sc1
    s_mov_b64 exec, -1
    s_add_u32 s100, s100, 1
    s_cmp_lt_u32 s100, 1048576
    s_cbranch_scc1 L_rdw
L_rdok:
    s_waitcnt lgkmcnt(2)
    global_store_dwordx4 v165, v[72:75], s[24:25]
    s_waitcnt lgkmcnt(1)
    global_store_dwordx4 v7, v[76:79], s[24:25]
    s_waitcnt lgkmcnt(0)
    s_mov_b64 exec, 0xffffffff
    global_store_dwordx4 v135, v[80:83], s[24:25]
    s_endpgm
L_rxslow:
    ds_read_b32 v6, v163 offset:264
    s_add_u32 s100, s100, 1
    s_cmp_lt_u32 s100, 1048576
    s_cbranch_scc1 L_rxw
    s_branch L_rxok
L_vxslow:
    ds_read_b32 v6, v163
    ds_read_b64 v[106:107], v162 offset:9216
    ds_read_b64 v[104:105], v162 offset:9728
    ds_read_b64 v[102:103], v162 offset:10240
    ds_read_b64 v[100:101], v162 offset:10752
    ds_read_b64 v[98:99], v162 offset:11264
    s_add_u32 s100, s100, 1
    s_cmp_lt_u32 s100, 1048576
    s_cbranch_scc1 L_vxw
    s_waitcnt lgkmcnt(0)
    s_branch L_vxok
L_pada12:
    s_branch L_pada20
L_padb16:
    s_branch L_warmed_b
L_early:
    v_mov_b32 v5, 1
    global_load_dwordx4 v[28:31], v139, s[18:19] offset:-4096 sc1
    global_load_dwordx4 v[32:35], v139, s[18:19] offset:-2048 sc1
    global_load_dwordx4 v[36:39], v139, s[18:19] offset:0 sc1
    global_load_dwordx4 v[40:43], v139, s[18:19] offset:2048 sc1
    global_load_dwordx4 v[44:47], v139, s[62:63] offset:-4096 sc1
    s_lshr_b32 s96, s56, 1
    s_lshl_b32 s96, s96, 7
    s_add_u32 s96, s96, 3072
    v_add_u32 v166, s96, v166
    v_mov_b32 v134, s33
    s_and_b32 s96, s56, 1
    s_lshl1_add_u32 s96, s96, s57
    s_lshl2_add_u32 s96, s36, s96
    s_lshl_b64 s[66:67], 1, s96
    s_waitcnt lgkmcnt(0)
    s_waitcnt vmcnt(4)
    v_mfma_f32_16x16x32_bf16 v[8:11], v[68:71], v[28:31], 0
    ds_read_b128 v[68:71], v138 offset:16384
    v_mfma_f32_16x16x32_bf16 v[12:15], v[72:75], v[28:31], 0
    global_load_dwordx4 v[48:51], v139, s[62:63] offset:-2048 sc1
    ds_read_b128 v[72:75], v138 offset:17408
    v_mfma_f32_16x16x32_bf16 v[16:19], v[76:79], v[28:31], 0
    ds_read_b128 v[76:79], v138 offset:18432
    v_mfma_f32_16x16x32_bf16 v[20:23], v[80:83], v[28:31], 0
    global_load_dwordx4 v[52:55], v139, s[62:63] offset:0 sc1
    ds_write_b32 v160, v5 offset:216
    ds_read_b128 v[80:83], v138 offset:19456
    v_mfma_f32_16x16x32_bf16 v[24:27], v[84:87], v[28:31], 0
    ds_read_b128 v[84:87], v138 offset:20480
    s_waitcnt vmcnt(5)
    v_mfma_f32_16x16x32_bf16 v[8:11], v[88:91], v[32:35], v[8:11]
    ds_read_b128 v[88:91], v138 offset:21504
    v_mfma_f32_16x16x32_bf16 v[12:15], v[92:95], v[32:35], v[12:15]
    global_load_dwordx4 v[56:59], v139, s[62:63] offset:2048 sc1
    ds_read_b128 v[92:95], v138 offset:22528
    v_mfma_f32_16x16x32_bf16 v[16:19], v[96:99], v[32:35], v[16:19]
    ds_read_b128 v[96:99], v138 offset:23552
    v_mfma_f32_16x16x32_bf16 v[20:23], v[100:103], v[32:35], v[20:23]
    global_load_dwordx4 v[60:63], v139, s[64:65] offset:-4096 sc1
    ds_read_b128 v[100:103], v138 offset:24576
    v_mfma_f32_16x16x32_bf16 v[24:27], v[104:107], v[32:35], v[24:27]
    ds_read_b128 v[104:107], v138 offset:25600
    s_waitcnt vmcnt(6)
    v_mfma_f32_16x16x32_bf16 v[8:11], v[108:111], v[36:39], v[8:11]
    ds_read_b128 v[108:111], v138 offset:26624
    v_mfma_f32_16x16x32_bf16 v[12:15], v[112:115], v[36:39], v[12:15]
    global_load_dwordx4 v[64:67], v139, s[64:65] offset:-2048 sc1
    s_waitcnt lgkmcnt(9)
    ds_read_b128 v[112:115], v138 offset:27648
    v_mfma_f32_16x16x32_bf16 v[16:19], v[116:119], v[36:39], v[16:19]
    ds_read_b128 v[116:119], v138 offset:28672
    v_mfma_f32_16x16x32_bf16 v[20:23], v[120:123], v[36:39], v[20:23]
    s_waitcnt lgkmcnt(9)
    ds_read_b128 v[120:123], v138 offset:29696
    v_mfma_f32_16x16x32_bf16 v[24:27], v[124:127], v[36:39], v[24:27]
    ds_read_b128 v[124:127], v138 offset:30720
    s_waitcnt vmcnt(6)
    v_mfma_f32_16x16x32_bf16 v[8:11], v[128:131], v[40:43], v[8:11]
    s_waitcnt lgkmcnt(9)
    ds_read_b128 v[128:131], v138 offset:31744
    v_mfma_f32_16x16x32_bf16 v[12:15], v[68:71], v[40:43], v[12:15]
    ds_read_b128 v[68:71], v138 offset:32768
    v_mfma_f32_16x16x32_bf16 v[16:19], v[72:75], v[40:43], v[16:19]
    s_waitcnt lgkmcnt(9)
    ds_read_b128 v[72:75], v138 offset:33792
    v_mfma_f32_16x16x32_bf16 v[20:23], v[76:79], v[40:43], v[20:23]
    ds_read_b128 v[76:79], v138 offset:34816
    v_mfma_f32_16x16x32_bf16 v[24:27], v[80:83], v[40:43], v[24:27]
    s_waitcnt lgkmcnt(9)
    ds_read_b128 v[80:83], v138 offset:35840
    s_waitcnt vmcnt(5)
    v_mfma_f32_16x16x32_bf16 v[8:11], v[84:87], v[44:47], v[8:11]
    ds_read_b128 v[84:87], v138 offset:36864
    v_mfma_f32_16x16x32_bf16 v[12:15], v[88:91], v[44:47], v[12:15]
    s_waitcnt lgkmcnt(9)
    ds_read_b128 v[88:91], v138 offset:37888
    v_mfma_f32_16x16x32_bf16 v[16:19], v[92:95], v[44:47], v[16:19]
    ds_read_b128 v[92:95], v138 offset:38912
    v_mfma_f32_16x16x32_bf16 v[20:23], v[96:99], v[44:47], v[20:23]
    s_waitcnt lgkmcnt(9)
    ds_read_b128 v[96:99], v138 offset:39936
    v_mfma_f32_16x16x32_bf16 v[24:27], v[100:103], v[44:47], v[24:27]
    ds_read_b128 v[100:103], v138 offset:40960
    s_waitcnt vmcnt(4)
    v_mfma_f32_16x16x32_bf16 v[8:11], v[104:107], v[48:51], v[8:11]
    s_waitcnt lgkmcnt(9)
    ds_read_b128 v[104:107], v138 offset:41984
    v_mfma_f32_16x16x32_bf16 v[12:15], v[108:111], v[48:51], v[12:15]
    ds_read_b128 v[108:111], v138 offset:43008
    v_mfma_f32_16x16x32_bf16 v[16:19], v[112:115], v[48:51], v[16:19]
    s_waitcnt lgkmcnt(9)
    ds_read_b128 v[112:115], v138 offset:44032
    v_mfma_f32_16x16x32_bf16 v[20:23], v[116:119], v[48:51], v[20:23]
    ds_read_b128 v[116:119], v138 offset:45056
    v_mfma_f32_16x16x32_bf16 v[24:27], v[120:123], v[48:51], v[24:27]
    s_waitcnt lgkmcnt(9)
    ds_read_b128 v[120:123], v138 offset:46080
    s_waitcnt vmcnt(3)
    v_mfma_f32_16x16x32_bf16 v[8:11], v[124:127], v[52:55], v[8:11]
    ds_read_b128 v[124:127], v138 offset:47104
    v_mfma_f32_16x16x32_bf16 v[12:15], v[128:131], v[52:55], v[12:15]
    s_waitcnt lgkmcnt(9)
    ds_read_b128 v[128:131], v138 offset:48128
    v_mfma_f32_16x16x32_bf16 v[16:19], v[68:71], v[52:55], v[16:19]
    ds_read_b128 v[68:71], v138 offset:49152
    v_mfma_f32_16x16x32_bf16 v[20:23], v[72:75], v[52:55], v[20:23]
    s_waitcnt lgkmcnt(9)
    ds_read_b128 v[72:75], v138 offset:50176
    v_mfma_f32_16x16x32_bf16 v[24:27], v[76:79], v[52:55], v[24:27]
    s_waitcnt vmcnt(0)
    v_mfma_f32_16x16x32_bf16 v[8:11], v[80:83], v[56:59], v[8:11]
    s_mov_b64 exec, s[66:67]
    global_store_dword v166, v134, s[28:29]
    s_mov_b64 exec, -1
    v_mfma_f32_16x16x32_bf16 v[12:15], v[84:87], v[56:59], v[12:15]
    v_mfma_f32_16x16x32_bf16 v[16:19], v[88:91], v[56:59], v[16:19]
    v_mfma_f32_16x16x32_bf16 v[20:23], v[92:95], v[56:59], v[20:23]
    v_mfma_f32_16x16x32_bf16 v[24:27], v[96:99], v[56:59], v[24:27]
    s_waitcnt lgkmcnt(9)
    v_mfma_f32_16x16x32_bf16 v[8:11], v[100:103], v[60:63], v[8:11]
    s_waitcnt lgkmcnt(8)
    v_mfma_f32_16x16x32_bf16 v[12:15], v[104:107], v[60:63], v[12:15]
    s_waitcnt lgkmcnt(7)
    v_mfma_f32_16x16x32_bf16 v[16:19], v[108:111], v[60:63], v[16:19]
    s_waitcnt lgkmcnt(6)
    v_mfma_f32_16x16x32_bf16 v[20:23], v[112:115], v[60:63], v[20:23]
    s_waitcnt lgkmcnt(5)
    v_mfma_f32_16x16x32_bf16 v[24:27], v[116:119], v[60:63], v[24:27]
    s_waitcnt lgkmcnt(4)
    v_mfma_f32_16x16x32_bf16 v[8:11], v[120:123], v[64:67], v[8:11]
    s_waitcnt lgkmcnt(3)
    v_mfma_f32_16x16x32_bf16 v[12:15], v[124:127], v[64:67], v[12:15]
    s_waitcnt lgkmcnt(2)
    v_mfma_f32_16x16x32_bf16 v[16:19], v[128:131], v[64:67], v[16:19]
    s_waitcnt lgkmcnt(1)
    v_mfma_f32_16x16x32_bf16 v[20:23], v[68:71], v[64:67], v[20:23]
    s_waitcnt lgkmcnt(0)
    v_mfma_f32_16x16x32_bf16 v[24:27], v[72:75], v[64:67], v[24:27]
    s_setprio 0
    s_mov_b32 s100, 0
Lw_65:
    ds_read_b32 v4, v3 offset:196
    s_branch L_skip3496
L_pada13:
    s_branch L_warmed_a
L_padb17:
    s_branch L_warmed_b
L_skip3496:
    s_waitcnt lgkmcnt(0)
    v_readfirstlane_b32 s99, v4
    s_cmp_ge_u32 s99, 8
    s_cbranch_scc1 Lwd_66
    s_add_u32 s100, s100, 1
    s_cmp_lt_u32 s100, 1048576
    s_cbranch_scc1 Lw_65
Lwd_66:
    ds_write_b128 v137, v[8:11] offset:0
    ds_write_b128 v137, v[12:15] offset:1024
    ds_write_b128 v137, v[16:19] offset:2048
    ds_write_b128 v137, v[20:23] offset:3072
    ds_write_b128 v137, v[24:27] offset:4096
    v_mov_b32 v4, 2
    ds_write_b32 v160, v4 offset:232
    s_cmp_lg_u32 s101, 0
    s_cbranch_scc1 L_cve
L_cvde:
    s_endpgm
L_gout:
    s_waitcnt lgkmcnt(0)
    global_store_dwordx4 v165, v[72:75], s[24:25] sc1
    global_store_dwordx4 v7, v[76:79], s[24:25] sc1
    s_mov_b64 exec, 0xffffffff
    global_store_dwordx4 v135, v[80:83], s[24:25] sc1
    s_endpgm
L_cvl:
    s_cmp_ge_u32 s31, 26
    s_cselect_b32 s96, 8, 0
    s_lshl_b32 s97, s30, 8
    s_add_u32 s96, s96, s97
    s_add_u32 s96, s96, 65536
    s_and_b32 s98, s33, 0xffffff00
    s_mov_b64 exec, 0xffffffff
    s_mov_b32 s100, 0
L_cwl:
    v_subrev_u32 v132, s98, v133
    v_cmp_le_u32 vcc, 0x600, v132
    s_cbranch_vccz L_cxl
    s_mov_b64 exec, vcc
    v_lshlrev_b32 v68, 2, v0
    v_add_u32 v68, 161792, v68
    ds_read_b32 v70, v68
    v_mov_b32 v71, 0x100
    v_lshl_add_u32 v68, v0, 11, s96
    s_sleep 8
    s_waitcnt lgkmcnt(0)
    global_atomic_add_x2 v[132:133], v68, v[70:71], s[28:29] sc0 sc1
    s_waitcnt vmcnt(0)
    s_add_u32 s100, s100, 1
    s_cmp_lt_u32 s100, 1048576
    s_cbranch_scc1 L_cwl
L_cxl:
    s_mov_b64 exec, -1
    s_branch L_cvdl
L_cve:
    s_cmp_ge_u32 s31, 26
    s_cselect_b32 s96, 8, 0
    s_lshl_b32 s97, s30, 8
    s_add_u32 s96, s96, s97
    s_add_u32 s96, s96, 65536
    s_and_b32 s98, s33, 0xffffff00
    s_mov_b64 exec, 0xffffffff
    s_mov_b32 s100, 0
L_cwe:
    v_subrev_u32 v132, s98, v133
    v_cmp_le_u32 vcc, 0x600, v132
    s_cbranch_vccz L_cxe
    s_mov_b64 exec, vcc
    v_lshlrev_b32 v68, 2, v0
    v_add_u32 v68, 161792, v68
    ds_read_b32 v70, v68
    v_mov_b32 v71, 0x100
    v_lshl_add_u32 v68, v0, 11, s96
    s_sleep 8
    s_waitcnt lgkmcnt(0)
    global_atomic_add_x2 v[132:133], v68, v[70:71], s[28:29] sc0 sc1
    s_waitcnt vmcnt(0)
    s_add_u32 s100, s100, 1
    s_cmp_lt_u32 s100, 1048576
    s_cbranch_scc1 L_cwe
L_cxe:
    s_mov_b64 exec, -1
    s_branch L_cvde
L_awave:
    s_sub_u32 s65, s32, 4
    s_cmp_lt_u32 s38, 5
    s_cbranch_scc1 L_nopack
    s_lshl1_add_u32 s40, s30, s38
    s_sub_u32 s40, s40, 5
    s_lshl4_add_u32 s40, s65, s40
    s_mov_b32 s58, 0
    s_cmp_ge_u32 s40, 100
    s_cbranch_scc1 L_packed
    s_mul_i32 s41, s40, 205
    s_lshr_b32 s41, s41, 11
    s_mul_i32 s42, s41, 10
    s_sub_u32 s42, s40, s42
    v_lshrrev_b32 v4, 3, v0
    v_mul_u32_u24 v4, 1280, v4
    v_and_b32 v5, 7, v0
    v_lshl_add_u32 v4, v5, 4, v4
    s_mul_i32 s43, s41, 81920
    s_lshl_b32 s96, s42, 7
    s_add_u32 s43, s43, s96
    s_lshl_b32 s44, s65, 13
    s_add_u32 s44, s44, 90496
    s_mov_b32 m0, s44
    s_waitcnt lgkmcnt(0)
    s_mov_b32 s48, s20
    s_and_b32 s49, s21, 0xffff
    s_mov_b32 s50, 819200
    s_mov_b32 s51, 0x00020000
    buffer_load_dwordx4 v4, s[48:51], s43 offen lds
    s_addk_i32 m0, 1024
    s_addk_i32 s43, 10240
    buffer_load_dwordx4 v4, s[48:51], s43 offen lds
    s_addk_i32 m0, 1024
    s_addk_i32 s43, 10240
    buffer_load_dwordx4 v4, s[48:51], s43 offen lds
    s_addk_i32 m0, 1024
    s_addk_i32 s43, 10240
    buffer_load_dwordx4 v4, s[48:51], s43 offen lds
    s_addk_i32 m0, 1024
    s_addk_i32 s43, 10240
    buffer_load_dwordx4 v4, s[48:51], s43 offen lds
    s_addk_i32 m0, 1024
    s_addk_i32 s43, 10240
    buffer_load_dwordx4 v4, s[48:51], s43 offen lds
    s_addk_i32 m0, 1024
    s_addk_i32 s43, 10240
    buffer_load_dwordx4 v4, s[48:51], s43 offen lds
    s_addk_i32 m0, 1024
    s_addk_i32 s43, 10240
    buffer_load_dwordx4 v4, s[48:51], s43 offen lds
    s_sub_u32 s45, s41, 5
    s_cselect_b32 s45, s41, s45
    s_mov_b32 s46, 0xf9af5600
    s_cmp_eq_u32 s45, 1
    s_cselect_b32 s46, 0xfeab5500, s46
    s_cmp_eq_u32 s45, 2
    s_cselect_b32 s46, 0xffaa5500, s46
    s_cmp_eq_u32 s45, 3
    s_cselect_b32 s46, 0xffaa1540, s46
    s_cmp_eq_u32 s45, 4
    s_cselect_b32 s46, 0xff6a0590, s46
    v_lshrrev_b32 v4, 2, v0
    v_and_b32 v5, 3, v0
    v_lshlrev_b32 v5, 3, v5
    v_lshl_add_u32 v4, v4, 7, v5
    v_add_u32 v4, s44, v4
    v_lshlrev_b32 v5, 1, v2
    v_bfe_u32 v8, s46, v5, 2
    v_lshl_add_u32 v8, v8, 11, v4
    s_lshr_b32 s46, s46, 8
    v_bfe_u32 v9, s46, v5, 2
    v_lshl_add_u32 v9, v9, 11, v4
    s_lshr_b32 s46, s46, 8
    v_bfe_u32 v10, s46, v5, 2
    v_lshl_add_u32 v10, v10, 11, v4
    s_lshr_b32 s46, s46, 8
    v_bfe_u32 v11, s46, v5, 2
    v_lshl_add_u32 v11, v11, 11, v4
    s_mul_i32 s41, s41, 5120
    s_add_u32 s41, s41, 9437184
    s_lshl2_add_u32 s96, s42, 0
    s_mul_i32 s97, s96, 205
    s_lshr_b32 s97, s97, 10
    s_mul_i32 s97, s97, 97280
    s_lshl_b32 s96, s96, 10
    s_add_u32 s96, s96, s97
    s_add_u32 s96, s96, s41
    v_lshl_add_u32 v12, v0, 4, s96
    s_lshl2_add_u32 s96, s42, 1
    s_mul_i32 s97, s96, 205
    s_lshr_b32 s97, s97, 10
    s_mul_i32 s97, s97, 97280
    s_lshl_b32 s96, s96, 10
    s_add_u32 s96, s96, s97
    s_add_u32 s96, s96, s41
    v_lshl_add_u32 v13, v0, 4, s96
    s_lshl2_add_u32 s96, s42, 2
    s_mul_i32 s97, s96, 205
    s_lshr_b32 s97, s97, 10
    s_mul_i32 s97, s97, 97280
    s_lshl_b32 s96, s96, 10
    s_add_u32 s96, s96, s97
    s_add_u32 s96, s96, s41
    v_lshl_add_u32 v14, v0, 4, s96
    s_lshl2_add_u32 s96, s42, 3
    s_mul_i32 s97, s96, 205
    s_lshr_b32 s97, s97, 10
    s_mul_i32 s97, s97, 97280
    s_lshl_b32 s96, s96, 10
    s_add_u32 s96, s96, s97
    s_add_u32 s96, s96, s41
    v_lshl_add_u32 v15, v0, 4, s96
    s_add_u32 s44, s28, 51200
    s_addc_u32 s45, s29, 0
    s_waitcnt vmcnt(0)
    ds_read_b64_tr_b16 v[48:49], v9 offset:0
    ds_read_b64_tr_b16 v[50:51], v10 offset:0
    ds_read_b64_tr_b16 v[52:53], v9 offset:32
    ds_read_b64_tr_b16 v[54:55], v10 offset:32
    ds_read_b64_tr_b16 v[56:57], v9 offset:64
    ds_read_b64_tr_b16 v[58:59], v10 offset:64
    ds_read_b64_tr_b16 v[60:61], v9 offset:96
    ds_read_b64_tr_b16 v[62:63], v10 offset:96
    s_waitcnt lgkmcnt(4)
    ds_read_b64_tr_b16 v[64:65], v8 offset:0
    ds_read_b64_tr_b16 v[66:67], v11 offset:0
    ds_read_b64_tr_b16 v[68:69], v8 offset:32
    ds_read_b64_tr_b16 v[70:71], v11 offset:32
    ds_read_b64_tr_b16 v[72:73], v8 offset:64
    ds_read_b64_tr_b16 v[74:75], v11 offset:64
    ds_read_b64_tr_b16 v[76:77], v8 offset:96
    ds_read_b64_tr_b16 v[78:79], v11 offset:96
    s_waitcnt lgkmcnt(0)
    global_store_dwordx4 v12, v[48:51], s[28:29] sc1
    global_store_dwordx4 v13, v[52:55], s[28:29] sc1
    global_store_dwordx4 v14, v[56:59], s[28:29] sc1
    global_store_dwordx4 v15, v[60:63], s[28:29] sc1
    global_store_dwordx4 v12, v[64:67], s[44:45] sc1
    global_store_dwordx4 v13, v[68:71], s[44:45] sc1
    global_store_dwordx4 v14, v[72:75], s[44:45] sc1
    global_store_dwordx4 v15, v[76:79], s[44:45] sc1
L_packed:
    s_waitcnt lgkmcnt(0)
    s_branch L_notap
L_nopack:
    s_min_u32 s99, s38, 4
    s_lshl3_add_u32 s58, s99, s65
    s_lshl_b32 s96, s58, 7
    s_add_u32 s97, s96, 64
    v_sub_u32 v4, v1, v2
    v_and_b32 v4, 3, v4
    v_and_or_b32 v4, v1, 12, v4
    v_lshrrev_b32 v5, 1, v4
    v_lshlrev_b32 v4, 4, v4
    s_waitcnt lgkmcnt(0)
    s_load_dwordx16 s[40:55], s[10:11], s96
    s_load_dwordx16 s[76:91], s[10:11], s97
    s_setprio 2
    s_waitcnt lgkmcnt(0)
    v_cmp_eq_u32 vcc, 0, v5
    s_mov_b64 exec, vcc
    v_bfe_u32 v42, s40, v4, 16
    v_bfe_u32 v43, s48, v4, 16
    v_bfe_u32 v44, s76, v4, 16
    v_bfe_u32 v45, s84, v4, 16
    s_mov_b64 exec, -1
    v_cmp_eq_u32 vcc, 1, v5
    s_mov_b64 exec, vcc
    v_bfe_u32 v42, s41, v4, 16
    v_bfe_u32 v43, s49, v4, 16
    v_bfe_u32 v44, s77, v4, 16
    v_bfe_u32 v45, s85, v4, 16
    s_mov_b64 exec, -1
    v_cmp_eq_u32 vcc, 2, v5
    s_mov_b64 exec, vcc
    v_bfe_u32 v42, s42, v4, 16
    v_bfe_u32 v43, s50, v4, 16
    v_bfe_u32 v44, s78, v4, 16
    v_bfe_u32 v45, s86, v4, 16
    s_mov_b64 exec, -1
    v_cmp_eq_u32 vcc, 3, v5
    s_mov_b64 exec, vcc
    v_bfe_u32 v42, s43, v4, 16
    v_bfe_u32 v43, s51, v4, 16
    v_bfe_u32 v44, s79, v4, 16
    v_bfe_u32 v45, s87, v4, 16
    s_mov_b64 exec, -1
    v_cmp_eq_u32 vcc, 4, v5
    s_mov_b64 exec, vcc
    v_bfe_u32 v42, s44, v4, 16
    v_bfe_u32 v43, s52, v4, 16
    v_bfe_u32 v44, s80, v4, 16
    v_bfe_u32 v45, s88, v4, 16
    s_mov_b64 exec, -1
    v_cmp_eq_u32 vcc, 5, v5
    s_mov_b64 exec, vcc
    v_bfe_u32 v42, s45, v4, 16
    v_bfe_u32 v43, s53, v4, 16
    v_bfe_u32 v44, s81, v4, 16
    v_bfe_u32 v45, s89, v4, 16
    s_mov_b64 exec, -1
    v_cmp_eq_u32 vcc, 6, v5
    s_mov_b64 exec, vcc
    v_bfe_u32 v42, s46, v4, 16
    v_bfe_u32 v43, s54, v4, 16
    v_bfe_u32 v44, s82, v4, 16
    v_bfe_u32 v45, s90, v4, 16
    s_mov_b64 exec, -1
    v_cmp_eq_u32 vcc, 7, v5
    s_mov_b64 exec, vcc
    v_bfe_u32 v42, s47, v4, 16
    v_bfe_u32 v43, s55, v4, 16
    v_bfe_u32 v44, s83, v4, 16
    v_bfe_u32 v45, s91, v4, 16
    s_mov_b64 exec, -1
L_notap:
    s_load_dword s33, s[28:29], 0
    s_setprio 2
    s_and_b32 s56, s65, 3
    s_lshr_b32 s57, s65, 2
    s_sub_u32 s96, s31, 20
    s_mul_i32 s97, s96, 43
    s_lshr_b32 s97, s97, 7
    s_mul_i32 s41, s96, 7
    s_sub_u32 s41, s41, s97
    s_mul_i32 s97, s97, 3
    s_sub_u32 s97, s96, s97
    s_cmp_eq_u32 s97, 2
    s_cselect_b32 s64, 6, 7
    s_mul_i32 s97, s30, 80
    s_add_u32 s41, s41, s97
    s_cmp_lt_u32 s65, s64
    s_cselect_b32 s52, 1, 0
    s_cselect_b32 s98, s65, 0
    s_cselect_b32 s20, 7, s64
    s_cselect_b32 s54, 0, 448
    s_add_u32 s41, s41, s98
    s_mul_i32 s42, s98, 8320
    s_mul_i32 s68, s98, 4608
    s_add_u32 s68, s68, 58240
    s_lshl_b32 s55, s41, 12
    v_lshlrev_b32 v8, 4, v0
    v_lshl_add_u32 v5, v1, 3, v2
    s_lshr_b32 s96, s65, 2
    s_mul_i32 s97, s96, 16896
    s_add_u32 s97, s97, 90496
    v_lshl_add_u32 v5, v5, 7, s97
    s_mul_i32 s45, s96, 512
    s_lshl_b32 s96, s65, 1
    v_xor_b32 v6, s96, v1
    v_and_b32 v6, 7, v6
    v_lshl_add_u32 v9, v6, 4, v5
    v_add_u32 v6, 7, v1
    v_xor_b32 v6, s96, v6
    v_and_b32 v6, 7, v6
    v_lshl_add_u32 v11, v6, 4, v5
    v_xor_b32 v10, 16, v9
    v_xor_b32 v12, 16, v11
    v_subrev_u32 v46, s45, v9
    v_subrev_u32 v47, s45, v10
    s_lshl_b32 s96, s58, 16
    s_lshl_b32 s97, s37, 8
    s_add_u32 s96, s96, s97
    s_add_u32 s96, s96, 1048576
    v_lshlrev_b32 v5, 12, v2
    v_lshl_add_u32 v5, v1, 4, v5
    v_add_u32 v14, s96, v5
    s_add_u32 s60, s28, 16384
    s_addc_u32 s61, s29, 0
    s_add_u32 s62, s28, 32768
    s_addc_u32 s63, s29, 0
    s_add_u32 s66, s28, 49152
    s_addc_u32 s67, s29, 0
    s_lshl4_add_u32 s96, s58, s37
    s_lshl_b32 s96, s96, 7
    s_add_u32 s96, s96, 262144
    v_add_u32 v5, v1, v2
    v_lshl_add_u32 v148, v5, 3, s96
    s_lshr_b32 s96, s41, 4
    s_lshl_b32 s96, s96, 11
    s_and_b32 s97, s41, 15
    s_lshl3_add_u32 s96, s97, s96
    s_add_u32 s96, s96, 262144
    v_lshl_add_u32 v149, v1, 7, s96
    s_waitcnt lgkmcnt(0)
    s_mul_i32 s33, s33, 1664525
    s_add_u32 s33, s33, 1013904223
    s_mov_b32 s43, s98
    v_bfe_u32 v5, v1, 2, 1
    v_lshlrev_b32 v5, 4, v5
    v_and_b32 v6, 3, v1
    v_lshrrev_b32 v7, 3, v1
    v_mov_b32 v4, 0x3f80
    v_lshlrev_b32 v4, v5, v4
    v_cmp_eq_u32 vcc, v6, v2
    s_nop 1
    v_cndmask_b32 v4, 0, v4, vcc
    v_cmp_eq_u32 vcc, 0, v7
    s_nop 1
    v_cndmask_b32 v40, 0, v4, vcc
    v_cndmask_b32 v41, v4, 0, vcc
    v_or_b32 v4, 2, v7
    v_cmp_ge_u32 vcc, v6, v2
    s_nop 1
    v_cndmask_b32 v7, v7, v4, vcc
    v_lshlrev_b32 v42, v5, v42
    v_lshlrev_b32 v43, v5, v43
    v_lshlrev_b32 v44, v5, v44
    v_lshlrev_b32 v45, v5, v45
    v_cmp_eq_u32 vcc, 0, v7
    s_nop 1
    v_cndmask_b32 v16, 0, v42, vcc
    v_cndmask_b32 v20, 0, v42, vcc
    v_cndmask_b32 v22, 0, v43, vcc
    v_cndmask_b32 v26, 0, v43, vcc
    v_cndmask_b32 v28, 0, v44, vcc
    v_cndmask_b32 v32, 0, v44, vcc
    v_cndmask_b32 v34, 0, v45, vcc
    v_cndmask_b32 v38, 0, v45, vcc
    v_cmp_eq_u32 vcc, 1, v7
    s_nop 1
    v_cndmask_b32 v17, 0, v42, vcc
    v_cndmask_b32 v21, 0, v42, vcc
    v_cndmask_b32 v23, 0, v43, vcc
    v_cndmask_b32 v27, 0, v43, vcc
    v_cndmask_b32 v29, 0, v44, vcc
    v_cndmask_b32 v33, 0, v44, vcc
    v_cndmask_b32 v35, 0, v45, vcc
    v_cndmask_b32 v39, 0, v45, vcc
    v_cmp_eq_u32 vcc, 2, v7
    s_nop 1
    v_cndmask_b32 v18, 0, v42, vcc
    v_cndmask_b32 v24, 0, v43, vcc
    v_cndmask_b32 v30, 0, v44, vcc
    v_cndmask_b32 v36, 0, v45, vcc
    v_cmp_eq_u32 vcc, 3, v7
    s_nop 1
    v_cndmask_b32 v19, 0, v42, vcc
    v_cndmask_b32 v25, 0, v43, vcc
    v_cndmask_b32 v31, 0, v44, vcc
    v_cndmask_b32 v37, 0, v45, vcc
    s_barrier
    s_cmp_ge_u32 s38, 5
    s_cbranch_scc1 L_nokv
    ds_read_b128 v[48:51], v11
    ds_read_b128 v[52:55], v9 offset:512
    ds_read_b128 v[56:59], v9 offset:1024
    ds_read_b128 v[60:63], v46 offset:33792
    ds_read_b128 v[64:67], v46 offset:34304
    ds_read_b128 v[68:71], v12
    ds_read_b128 v[72:75], v10 offset:512
    ds_read_b128 v[76:79], v10 offset:1024
    ds_read_b128 v[80:83], v47 offset:33792
    ds_read_b128 v[84:87], v47 offset:34304
    s_waitcnt lgkmcnt(8)
    v_swap_b32 v50, v52
    v_swap_b32 v51, v53
    s_nop 1
    v_mfma_f32_16x16x32_bf16 v[88:91], v[16:19], v[48:51], 0
    v_mfma_f32_16x16x32_bf16 v[96:99], v[22:25], v[52:55], 0
    s_waitcnt lgkmcnt(7)
    v_mov_b64 v[48:49], v[56:57]
    v_mov_b64 v[52:53], v[58:59]
    s_nop 0
    v_mfma_f32_16x16x32_bf16 v[92:95], v[18:21], v[48:51], 0
    v_mfma_f32_16x16x32_bf16 v[100:103], v[24:27], v[52:55], 0
    s_waitcnt lgkmcnt(5)
    v_mfma_f32_16x16x16_bf16 v[104:107], v[40:41], v[60:61], 0
    v_mfma_f32_16x16x16_bf16 v[108:111], v[40:41], v[64:65], 0
    v_mfma_f32_16x16x16_bf16 v[112:115], v[40:41], v[62:63], 0
    v_mfma_f32_16x16x16_bf16 v[116:119], v[40:41], v[66:67], 0
    s_waitcnt lgkmcnt(3)
    v_swap_b32 v70, v72
    v_swap_b32 v71, v73
    s_nop 1
    v_mfma_f32_16x16x32_bf16 v[48:51], v[28:31], v[68:71], 0
    v_mfma_f32_16x16x32_bf16 v[56:59], v[34:37], v[72:75], 0
    s_waitcnt lgkmcnt(2)
    v_mov_b64 v[68:69], v[76:77]
    v_mov_b64 v[72:73], v[78:79]
    s_nop 0
    v_mfma_f32_16x16x32_bf16 v[52:55], v[30:33], v[68:71], 0
    v_mfma_f32_16x16x32_bf16 v[60:63], v[36:39], v[72:75], 0
    v_pk_mul_f32 v[88:89], v[88:89], v[104:105]
    v_pk_mul_f32 v[90:91], v[90:91], v[106:107]
    v_pk_mul_f32 v[92:93], v[92:93], v[108:109]
    v_pk_mul_f32 v[94:95], v[94:95], v[110:111]
    v_pk_mul_f32 v[96:97], v[96:97], v[112:113]
    v_pk_mul_f32 v[98:99], v[98:99], v[114:115]
    v_pk_mul_f32 v[100:101], v[100:101], v[116:117]
    v_pk_mul_f32 v[102:103], v[102:103], v[118:119]
    s_waitcnt lgkmcnt(0)
    v_mfma_f32_16x16x16_bf16 v[104:107], v[40:41], v[80:81], 0
    v_mfma_f32_16x16x16_bf16 v[108:111], v[40:41], v[84:85], 0
    v_mfma_f32_16x16x16_bf16 v[112:115], v[40:41], v[82:83], 0
    v_mfma_f32_16x16x16_bf16 v[116:119], v[40:41], v[86:87], 0
    v_cvt_pk_bf16_f32 v120, v88, v89
    v_cvt_pk_bf16_f32 v121, v90, v91
    v_cvt_pk_bf16_f32 v122, v92, v93
    v_cvt_pk_bf16_f32 v123, v94, v95
    global_store_dwordx4 v14, v[120:123], s[28:29] sc1
    v_cvt_pk_bf16_f32 v124, v96, v97
    v_cvt_pk_bf16_f32 v125, v98, v99
    v_cvt_pk_bf16_f32 v126, v100, v101
    v_cvt_pk_bf16_f32 v127, v102, v103
    global_store_dwordx4 v14, v[124:127], s[60:61] sc1
    v_add_u32 v76, v120, v121
    v_add3_u32 v76, v76, v122, v123
    v_add_u32 v77, v124, v125
    v_add3_u32 v77, v77, v126, v127
    v_pk_mul_f32 v[48:49], v[48:49], v[104:105]
    v_pk_mul_f32 v[50:51], v[50:51], v[106:107]
    v_pk_mul_f32 v[52:53], v[52:53], v[108:109]
    v_pk_mul_f32 v[54:55], v[54:55], v[110:111]
    v_pk_mul_f32 v[56:57], v[56:57], v[112:113]
    v_pk_mul_f32 v[58:59], v[58:59], v[114:115]
    v_pk_mul_f32 v[60:61], v[60:61], v[116:117]
    v_pk_mul_f32 v[62:63], v[62:63], v[118:119]
    v_cvt_pk_bf16_f32 v68, v48, v49
    v_cvt_pk_bf16_f32 v69, v50, v51
    v_cvt_pk_bf16_f32 v70, v52, v53
    v_cvt_pk_bf16_f32 v71, v54, v55
    global_store_dwordx4 v14, v[68:71], s[62:63] sc1
    v_cvt_pk_bf16_f32 v72, v56, v57
    v_cvt_pk_bf16_f32 v73, v58, v59
    v_cvt_pk_bf16_f32 v74, v60, v61
    v_cvt_pk_bf16_f32 v75, v62, v63
    global_store_dwordx4 v14, v[72:75], s[66:67] sc1
    v_add_u32 v78, v68, v69
    v_add3_u32 v78, v78, v70, v71
    v_add_u32 v79, v72, v73
    v_add3_u32 v79, v79, v74, v75
    v_add_u32_dpp v80, v76, v76 row_ror:8 row_mask:0xf bank_mask:0xf
    v_add_u32_dpp v81, v77, v77 row_ror:8 row_mask:0xf bank_mask:0xf
    s_nop 0
    v_add_u32_dpp v80, v78, v78 row_ror:8 row_mask:0xf bank_mask:0xc
    v_add_u32_dpp v81, v79, v79 row_ror:8 row_mask:0xf bank_mask:0xc
    v_mov_b32 v76, s33
    v_add_u32_dpp v77, v80, v80 row_half_mirror row_mask:0xf bank_mask:0xf
    s_nop 1
    v_add_u32_dpp v77, v81, v81 row_half_mirror row_mask:0xf bank_mask:0xa
    s_nop 1
    v_add_u32_dpp v77, v77, v77 quad_perm:[1,0,3,2] row_mask:0xf bank_mask:0xf
    s_nop 1
    v_add_u32_dpp v77, v77, v77 quad_perm:[2,3,0,1] row_mask:0xf bank_mask:0xf
    s_mov_b32 exec_lo, 0x11111111
    s_mov_b32 exec_hi, 0x11111111
    global_store_dwordx2 v148, v[76:77], s[28:29] sc1
    s_mov_b64 exec, -1
    s_branch L_kvd
L_pada14:
    s_branch L_warmed_a
L_nokv:
    s_waitcnt vmcnt(0)
L_kvd:
    v_mov_b32 v4, 1
    s_mov_b64 exec, 1
    ds_add_u32 v3, v4 offset:256
    s_mov_b64 exec, -1
    s_setprio 1
    s_mov_b32 s98, s43
    s_add_u32 s96, s55, 1048576
    s_add_u32 s76, s28, s96
    s_addc_u32 s77, s29, 0
    s_and_b32 s77, s77, 0xffff
    s_mov_b32 s78, 4096
    s_mov_b32 s79, 0x00020000
    v_sub_u32 v5, 2031, v1
    v_and_b32 v6, 1, v5
    v_lshrrev_b32 v5, 1, v5
    v_lshl_add_u32 v5, v2, 2, v5
    v_lshlrev_b32 v5, 2, v5
    v_mul_u32_u24 v6, 4160, v6
    s_sub_u32 s96, s42, s54
    v_add3_u32 v5, v5, v6, s96
    v_subrev_u32 v154, 3584, v5
    v_subrev_u32 v155, 2560, v5
    v_subrev_u32 v156, 1536, v5
    v_subrev_u32 v157, 512, v5
    v_lshlrev_b32 v5, 5, v1
    v_lshl_add_u32 v5, v2, 4, v5
    s_sub_u32 s96, s68, s54
    s_add_u32 s96, s96, 480
    v_add_u32 v158, s96, v5
    v_and_b32 v5, 1, v2
    v_lshlrev_b32 v5, 9, v5
    v_lshl_add_u32 v5, v1, 5, v5
    v_lshrrev_b32 v6, 1, v2
    v_lshl_add_u32 v5, v6, 4, v5
    s_add_u32 s96, s55, 4194304
    v_add_u32 v153, s96, v5
    v_and_b32 v5, 28, v0
    v_add_u32 v159, 161792, v5
    s_cmp_ge_u32 s31, 26
    s_cselect_b32 s96, 8, 0
    s_lshl_b32 s97, s30, 8
    s_add_u32 s96, s96, s97
    s_add_u32 s96, s96, 65536
    v_and_b32 v5, 31, v0
    v_lshl_add_u32 v160, v5, 11, s96
    s_mul_i32 s96, s98, 2048
    s_add_u32 s96, s96, 88448
    v_add_u32 v161, s96, v8
    s_lshl_b32 s96, s98, 2
    v_add_u32 v162, s96, v3
    s_mul_i32 s96, s57, 51200
    s_sub_u32 s80, 109568, s96
    s_mul_i32 s81, s56, 2560
    s_add_u32 s81, s81, 48128
    s_mov_b32 s93, 0
    s_mov_b32 s101, 0
    s_and_b32 s98, s35, 3
    s_lshr_b32 s96, s56, 1
    s_lshl1_add_u32 s96, s98, s96
    s_lshl1_add_u32 s96, s96, s57
    s_mul_i32 s96, s96, 20480
    s_and_b32 s97, s56, 1
    s_lshl_b32 s97, s97, 10
    s_add_u32 s96, s96, s97
    s_mul_i32 s97, s30, 327680
    s_add_u32 s96, s96, s97
    s_add_u32 s82, s96, 4096
    s_mul_i32 s96, s30, 262144
    s_lshl_b32 s98, s98, 8
    s_add_u32 s96, s96, s98
    s_add_u32 s83, s96, 7536640
    s_mul_i32 s84, s56, 5120
    s_add_u32 s84, s84, 10240
    s_lshl2_add_u32 s96, s35, s56
    s_mul_i32 s96, s96, 20480
    s_mul_i32 s97, s36, 160
    s_add_u32 s85, s96, s97
    v_and_b32 v5, 1, v1
    v_lshlrev_b32 v5, 4, v5
    v_mov_b32 v6, 0x3f80
    v_lshlrev_b32 v6, v5, v6
    v_lshrrev_b32 v7, 1, v1
    v_lshlrev_b32 v4, 1, v2
    v_sub_u32 v4, v7, v4
    v_cmp_eq_u32 vcc, 0, v4
    s_nop 1
    v_cndmask_b32 v164, 0, v6, vcc
    v_cmp_eq_u32 vcc, 1, v4
    s_nop 1
    v_cndmask_b32 v165, 0, v6, vcc
    s_cmp_eq_u32 s32, 4
    s_cbranch_scc1 L_pada0
    s_cmp_eq_u32 s32, 5
    s_cbranch_scc1 L_pada1
    s_cmp_eq_u32 s32, 6
    s_cbranch_scc1 L_pada2
    s_cmp_eq_u32 s32, 7
    s_cbranch_scc1 L_pada3
    s_cmp_eq_u32 s32, 8
    s_cbranch_scc1 L_pada4
    s_cmp_eq_u32 s32, 9
    s_cbranch_scc1 L_pada5
    s_cmp_eq_u32 s32, 10
    s_cbranch_scc1 L_pada6
    s_branch L_pada7
L_warmed_a:
    s_setprio 2
    s_cmp_lg_u32 s52, 0
    s_cbranch_scc1 L_owner
    s_waitcnt vmcnt(0)
    v_mov_b32 v4, 1
    s_mov_b64 exec, 1
    ds_add_u32 v3, v4 offset:280
    s_mov_b64 exec, -1
    s_cmp_lg_u32 s65, 7
    s_cbranch_scc1 L_cdone
    s_mov_b32 s100, 0
Lw_67:
    ds_read_b32 v4, v3 offset:312
    s_waitcnt lgkmcnt(0)
    v_readfirstlane_b32 s99, v4
    s_cmp_ge_u32 s99, 1
    s_cbranch_scc1 Lwd_68
    s_add_u32 s100, s100, 1
    s_cmp_lt_u32 s100, 1048576
    s_cbranch_scc1 Lw_67
Lwd_68:
    ds_read2_b32 v[48:49], v157 offset0:128 offset1:129
    ds_read2_b32 v[50:51], v157 offset0:130 offset1:131
    ds_read2_b32 v[52:53], v157 offset0:0 offset1:1
    ds_read2_b32 v[54:55], v157 offset0:2 offset1:3
    ds_read2_b32 v[56:57], v156 offset0:128 offset1:129
    ds_read2_b32 v[58:59], v156 offset0:130 offset1:131
    ds_read2_b32 v[60:61], v156 offset0:0 offset1:1
    ds_read2_b32 v[62:63], v156 offset0:2 offset1:3
    ds_read2_b32 v[64:65], v155 offset0:128 offset1:129
    ds_read2_b32 v[66:67], v155 offset0:130 offset1:131
    ds_read2_b32 v[68:69], v155 offset0:0 offset1:1
    ds_read2_b32 v[70:71], v155 offset0:2 offset1:3
    s_waitcnt lgkmcnt(6)
    ds_read2_b32 v[72:73], v154 offset0:128 offset1:129
    ds_read2_b32 v[74:75], v154 offset0:130 offset1:131
    ds_read2_b32 v[76:77], v154 offset0:0 offset1:1
    ds_read2_b32 v[78:79], v154 offset0:2 offset1:3
    s_setprio 3
    v_mov_b32 v5, 1
    s_mov_b32 s100, 0
Lw_69:
    ds_read_b32 v4, v3 offset:280
    s_waitcnt lgkmcnt(0)
    v_readfirstlane_b32 s99, v4
    s_cmp_ge_u32 s99, 8
    s_cbranch_scc1 Lwd_70
    s_add_u32 s100, s100, 1
    s_cmp_lt_u32 s100, 1048576
    s_cbranch_scc1 Lw_69
Lwd_70:
    ds_read_b128 v[80:83], v158 offset:0
    ds_read_b128 v[84:87], v158 offset:512
    ds_read_b128 v[88:91], v158 offset:1024
    ds_read_b128 v[92:95], v158 offset:1536
    ds_read_b128 v[96:99], v158 offset:2048
    ds_read_b128 v[100:103], v158 offset:2560
    ds_read_b128 v[104:107], v158 offset:3072
    ds_read_b128 v[108:111], v158 offset:3584
    s_waitcnt lgkmcnt(0)
    s_setprio 2
    s_branch L_hloop
L_pada15:
    s_branch L_warmed_a
L_owner:
    v_mov_b32 v44, 0
    v_mov_b32 v45, 0
    v_lshl_add_u32 v5, v0, 3, s68
    ds_write_b64 v5, v[44:45]
    s_mov_b64 exec, 0xffff
    s_mov_b32 s100, 0
L_ep:
    global_atomic_or_x2 v[46:47], v149, v[44:45], s[28:29] sc0 sc1
    s_waitcnt vmcnt(0)
    v_cmp_ne_u32 vcc, s33, v46
    s_cbranch_vccz L_epd
    s_mov_b64 exec, vcc
    s_add_u32 s100, s100, 1
    s_cmp_lt_u32 s100, 1048576
    s_cbranch_scc1 L_ep
L_epd:
    s_mov_b64 exec, -1
    s_setprio 3
    s_mov_b32 s100, 0
    s_add_u32 m0, s68, 512
    s_nop 0
    buffer_load_dwordx4 v8, s[76:79], 0 offen offset:0 sc1 lds
    buffer_load_dwordx4 v8, s[76:79], 0 offen offset:1024 sc1 lds
    buffer_load_dwordx4 v8, s[76:79], 0 offen offset:2048 sc1 lds
    buffer_load_dwordx4 v8, s[76:79], 0 offen offset:3072 sc1 lds
    v_add_u32_dpp v47, v47, v47 row_ror:8 row_mask:0xf bank_mask:0xf
    s_nop 1
    v_add_u32_dpp v47, v47, v47 row_ror:4 row_mask:0xf bank_mask:0xf
    s_nop 1
    v_add_u32_dpp v47, v47, v47 row_ror:2 row_mask:0xf bank_mask:0xf
    s_nop 1
    v_add_u32_dpp v47, v47, v47 row_ror:1 row_mask:0xf bank_mask:0xf
    s_nop 0
    v_readfirstlane_b32 s60, v47
    s_mov_b32 s100, 0
Lw_71:
    ds_read_b32 v4, v162 offset:312
    s_waitcnt lgkmcnt(0)
    v_readfirstlane_b32 s99, v4
    s_cmp_ge_u32 s99, 1
    s_cbranch_scc1 Lwd_72
    s_add_u32 s100, s100, 1
    s_cmp_lt_u32 s100, 1048576
    s_cbranch_scc1 Lw_71
Lwd_72:
    ds_read2_b32 v[48:49], v157 offset0:128 offset1:129
    ds_read2_b32 v[50:51], v157 offset0:130 offset1:131
    ds_read2_b32 v[52:53], v157 offset0:0 offset1:1
    ds_read2_b32 v[54:55], v157 offset0:2 offset1:3
    ds_read2_b32 v[56:57], v156 offset0:128 offset1:129
    ds_read2_b32 v[58:59], v156 offset0:130 offset1:131
    ds_read2_b32 v[60:61], v156 offset0:0 offset1:1
    ds_read2_b32 v[62:63], v156 offset0:2 offset1:3
    ds_read2_b32 v[64:65], v155 offset0:128 offset1:129
    ds_read2_b32 v[66:67], v155 offset0:130 offset1:131
    ds_read2_b32 v[68:69], v155 offset0:0 offset1:1
    ds_read2_b32 v[70:71], v155 offset0:2 offset1:3
    s_waitcnt lgkmcnt(6)
    ds_read2_b32 v[72:73], v154 offset0:128 offset1:129
    ds_read2_b32 v[74:75], v154 offset0:130 offset1:131
    ds_read2_b32 v[76:77], v154 offset0:0 offset1:1
    ds_read2_b32 v[78:79], v154 offset0:2 offset1:3
    s_mov_b32 s100, 0
L_uretry:
    s_waitcnt vmcnt(0) lgkmcnt(0)
    ds_read_b128 v[108:111], v158 offset:3584
    ds_read_b128 v[104:107], v158 offset:3072
    ds_read_b128 v[100:103], v158 offset:2560
    ds_read_b128 v[96:99], v158 offset:2048
    ds_read_b128 v[92:95], v158 offset:1536
    ds_read_b128 v[88:91], v158 offset:1024
    ds_read_b128 v[84:87], v158 offset:512
    ds_read_b128 v[80:83], v158 offset:0
    s_waitcnt lgkmcnt(7)
    v_mfma_f32_16x16x32_bf16 v[44:47], v[48:51], v[108:111], 0
    v_add_u32 v9, v108, v109
    v_add3_u32 v9, v9, v110, v111
    s_waitcnt lgkmcnt(6)
    v_mfma_f32_16x16x32_bf16 v[40:43], v[48:51], v[104:107], 0
    v_add3_u32 v9, v9, v104, v105
    v_add3_u32 v9, v9, v106, v107
    s_waitcnt lgkmcnt(5)
    v_mfma_f32_16x16x32_bf16 v[36:39], v[48:51], v[100:103], 0
    v_add3_u32 v9, v9, v100, v101
    v_add3_u32 v9, v9, v102, v103
    s_waitcnt lgkmcnt(4)
    v_mfma_f32_16x16x32_bf16 v[32:35], v[48:51], v[96:99], 0
    v_add3_u32 v9, v9, v96, v97
    v_add3_u32 v9, v9, v98, v99
    s_waitcnt lgkmcnt(3)
    v_mfma_f32_16x16x32_bf16 v[28:31], v[48:51], v[92:95], 0
    v_add3_u32 v9, v9, v92, v93
    v_add3_u32 v9, v9, v94, v95
    s_waitcnt lgkmcnt(2)
    v_mfma_f32_16x16x32_bf16 v[24:27], v[48:51], v[88:91], 0
    v_add3_u32 v9, v9, v88, v89
    v_add3_u32 v9, v9, v90, v91
    s_waitcnt lgkmcnt(1)
    v_mfma_f32_16x16x32_bf16 v[20:23], v[48:51], v[84:87], 0
    v_add3_u32 v9, v9, v84, v85
    v_add3_u32 v9, v9, v86, v87
    s_waitcnt lgkmcnt(0)
    v_mfma_f32_16x16x32_bf16 v[16:19], v[48:51], v[80:83], 0
    v_add3_u32 v9, v9, v80, v81
    v_add3_u32 v9, v9, v82, v83
    s_nop 1
    v_add_u32_dpp v9, v9, v9 row_ror:8 row_mask:0xf bank_mask:0xf
    s_nop 1
    v_add_u32_dpp v9, v9, v9 row_ror:4 row_mask:0xf bank_mask:0xf
    s_nop 1
    v_add_u32_dpp v9, v9, v9 row_ror:2 row_mask:0xf bank_mask:0xf
    s_nop 1
    v_add_u32_dpp v9, v9, v9 row_ror:1 row_mask:0xf bank_mask:0xf
    s_nop 0
    v_readlane_b32 s96, v9, 32
    v_readlane_b32 s97, v9, 48
    v_mov_b32 v4, 1
    s_add_u32 s96, s96, s97
    s_cmp_eq_u32 s96, s60
    s_cbranch_scc1 L_uok
    buffer_load_dwordx4 v8, s[76:79], 0 offen offset:0 sc1 lds
    buffer_load_dwordx4 v8, s[76:79], 0 offen offset:1024 sc1 lds
    buffer_load_dwordx4 v8, s[76:79], 0 offen offset:2048 sc1 lds
    buffer_load_dwordx4 v8, s[76:79], 0 offen offset:3072 sc1 lds
    s_add_u32 s100, s100, 1
    s_cmp_lt_u32 s100, 1048576
    s_cbranch_scc1 L_uretry
L_uok:
    s_mov_b64 exec, 1
    ds_add_u32 v3, v4 offset:280
    s_mov_b64 exec, -1
    s_setprio 2
    v_subrev_u32 v154, 64, v154
    v_subrev_u32 v155, 64, v155
    v_subrev_u32 v156, 64, v156
    v_subrev_u32 v157, 64, v157
    v_subrev_u32 v158, 64, v158
    ds_read_b128 v[140:143], v158 offset:3584
    ds_read_b128 v[136:139], v158 offset:3072
    ds_read_b128 v[132:135], v158 offset:2560
    ds_read_b128 v[128:131], v158 offset:2048
    s_branch L_centry
L_pada16:
    s_branch L_warmed_a
L_cloop:
    s_setprio 2
    s_cmp_gt_u32 s20, 6
    s_cbranch_scc1 Lcp_73
    s_setprio 1
    s_cmp_gt_u32 s20, 2
    s_cbranch_scc1 Lcp_73
    s_setprio 0
Lcp_73:
    v_subrev_u32 v154, 64, v154
    v_subrev_u32 v155, 64, v155
    v_subrev_u32 v156, 64, v156
    v_subrev_u32 v157, 64, v157
    v_subrev_u32 v158, 64, v158
    s_waitcnt lgkmcnt(15)
    v_mfma_f32_16x16x32_bf16 v[44:47], v[48:51], v[108:111], v[44:47]
    v_mfma_f32_16x16x32_bf16 v[40:43], v[48:51], v[104:107], v[40:43]
    s_waitcnt lgkmcnt(12)
    ds_read_b128 v[140:143], v158 offset:3584
    v_mfma_f32_16x16x32_bf16 v[36:39], v[48:51], v[100:103], v[36:39]
    v_mfma_f32_16x16x32_bf16 v[32:35], v[48:51], v[96:99], v[32:35]
    ds_read_b128 v[136:139], v158 offset:3072
    v_mfma_f32_16x16x32_bf16 v[28:31], v[48:51], v[92:95], v[28:31]
    v_mfma_f32_16x16x32_bf16 v[24:27], v[48:51], v[88:91], v[24:27]
    s_waitcnt lgkmcnt(12)
    ds_read_b128 v[132:135], v158 offset:2560
    s_waitcnt lgkmcnt(8)
    v_mfma_f32_16x16x32_bf16 v[20:23], v[48:51], v[84:87], v[20:23]
    s_waitcnt lgkmcnt(7)
    v_mfma_f32_16x16x32_bf16 v[16:19], v[48:51], v[80:83], v[16:19]
    ds_read_b128 v[128:131], v158 offset:2048
L_centry:
    v_mfma_f32_16x16x32_bf16 v[44:47], v[52:55], v[104:107], v[44:47]
    v_mfma_f32_16x16x32_bf16 v[40:43], v[52:55], v[100:103], v[40:43]
    ds_read2_b32 v[48:49], v157 offset0:128 offset1:129
    v_mfma_f32_16x16x32_bf16 v[36:39], v[52:55], v[96:99], v[36:39]
    v_mfma_f32_16x16x32_bf16 v[32:35], v[52:55], v[92:95], v[32:35]
    ds_read2_b32 v[50:51], v157 offset0:130 offset1:131
    v_mfma_f32_16x16x32_bf16 v[28:31], v[52:55], v[88:91], v[28:31]
    v_mfma_f32_16x16x32_bf16 v[24:27], v[52:55], v[84:87], v[24:27]
    ds_read_b128 v[124:127], v158 offset:1536
    v_mfma_f32_16x16x32_bf16 v[20:23], v[52:55], v[80:83], v[20:23]
    v_mfma_f32_16x16x32_bf16 v[44:47], v[56:59], v[100:103], v[44:47]
    v_mfma_f32_16x16x32_bf16 v[40:43], v[56:59], v[96:99], v[40:43]
    ds_read2_b32 v[52:53], v157 offset0:0 offset1:1
    v_mfma_f32_16x16x32_bf16 v[36:39], v[56:59], v[92:95], v[36:39]
    v_mfma_f32_16x16x32_bf16 v[32:35], v[56:59], v[88:91], v[32:35]
    ds_read2_b32 v[54:55], v157 offset0:2 offset1:3
    v_mfma_f32_16x16x32_bf16 v[28:31], v[56:59], v[84:87], v[28:31]
    v_mfma_f32_16x16x32_bf16 v[24:27], v[56:59], v[80:83], v[24:27]
    ds_read_b128 v[120:123], v158 offset:1024
    v_mfma_f32_16x16x32_bf16 v[44:47], v[60:63], v[96:99], v[44:47]
    v_mfma_f32_16x16x32_bf16 v[40:43], v[60:63], v[92:95], v[40:43]
    s_waitcnt lgkmcnt(12)
    ds_read2_b32 v[56:57], v156 offset0:128 offset1:129
    v_mfma_f32_16x16x32_bf16 v[36:39], v[60:63], v[88:91], v[36:39]
    v_mfma_f32_16x16x32_bf16 v[32:35], v[60:63], v[84:87], v[32:35]
    ds_read2_b32 v[58:59], v156 offset0:130 offset1:131
    v_mfma_f32_16x16x32_bf16 v[28:31], v[60:63], v[80:83], v[28:31]
    v_mfma_f32_16x16x32_bf16 v[44:47], v[64:67], v[92:95], v[44:47]
    v_mfma_f32_16x16x32_bf16 v[40:43], v[64:67], v[88:91], v[40:43]
    s_waitcnt lgkmcnt(12)
    ds_read2_b32 v[60:61], v156 offset0:0 offset1:1
    v_mfma_f32_16x16x32_bf16 v[36:39], v[64:67], v[84:87], v[36:39]
    v_mfma_f32_16x16x32_bf16 v[32:35], v[64:67], v[80:83], v[32:35]
    ds_read2_b32 v[62:63], v156 offset0:2 offset1:3
    v_mfma_f32_16x16x32_bf16 v[44:47], v[68:71], v[88:91], v[44:47]
    v_mfma_f32_16x16x32_bf16 v[40:43], v[68:71], v[84:87], v[40:43]
    s_waitcnt lgkmcnt(12)
    ds_read2_b32 v[64:65], v155 offset0:128 offset1:129
    v_mfma_f32_16x16x32_bf16 v[36:39], v[68:71], v[80:83], v[36:39]
    ds_read2_b32 v[68:69], v155 offset0:0 offset1:1
    s_waitcnt lgkmcnt(12)
    ds_read2_b32 v[70:71], v155 offset0:2 offset1:3
    ds_read2_b32 v[66:67], v155 offset0:130 offset1:131
    s_waitcnt lgkmcnt(12)
    ds_read_b128 v[116:119], v158 offset:512
    ds_read_b128 v[112:115], v158 offset:0
    v_mfma_f32_16x16x32_bf16 v[44:47], v[72:75], v[84:87], v[44:47]
    v_mfma_f32_16x16x32_bf16 v[40:43], v[72:75], v[80:83], v[40:43]
    s_waitcnt lgkmcnt(12)
    ds_read2_b32 v[72:73], v154 offset0:128 offset1:129
    ds_read2_b32 v[74:75], v154 offset0:130 offset1:131
    v_mfma_f32_16x16x32_bf16 v[44:47], v[76:79], v[80:83], v[44:47]
    s_waitcnt lgkmcnt(12)
    ds_read2_b32 v[76:77], v154 offset0:0 offset1:1
    ds_read2_b32 v[78:79], v154 offset0:2 offset1:3
    v_subrev_u32 v154, 64, v154
    v_subrev_u32 v155, 64, v155
    v_subrev_u32 v156, 64, v156
    v_subrev_u32 v157, 64, v157
    v_subrev_u32 v158, 64, v158
    v_mfma_f32_16x16x32_bf16 v[44:47], v[48:51], v[140:143], v[44:47]
    v_mfma_f32_16x16x32_bf16 v[40:43], v[48:51], v[136:139], v[40:43]
    s_waitcnt lgkmcnt(12)
    ds_read_b128 v[108:111], v158 offset:3584
    v_mfma_f32_16x16x32_bf16 v[36:39], v[48:51], v[132:135], v[36:39]
    v_mfma_f32_16x16x32_bf16 v[32:35], v[48:51], v[128:131], v[32:35]
    ds_read_b128 v[104:107], v158 offset:3072
    v_mfma_f32_16x16x32_bf16 v[28:31], v[48:51], v[124:127], v[28:31]
    v_mfma_f32_16x16x32_bf16 v[24:27], v[48:51], v[120:123], v[24:27]
    s_waitcnt lgkmcnt(12)
    ds_read_b128 v[100:103], v158 offset:2560
    s_waitcnt lgkmcnt(8)
    v_mfma_f32_16x16x32_bf16 v[20:23], v[48:51], v[116:119], v[20:23]
    s_waitcnt lgkmcnt(7)
    v_mfma_f32_16x16x32_bf16 v[16:19], v[48:51], v[112:115], v[16:19]
    ds_read_b128 v[96:99], v158 offset:2048
    v_mfma_f32_16x16x32_bf16 v[44:47], v[52:55], v[136:139], v[44:47]
    v_mfma_f32_16x16x32_bf16 v[40:43], v[52:55], v[132:135], v[40:43]
    ds_read2_b32 v[48:49], v157 offset0:128 offset1:129
    v_mfma_f32_16x16x32_bf16 v[36:39], v[52:55], v[128:131], v[36:39]
    v_mfma_f32_16x16x32_bf16 v[32:35], v[52:55], v[124:127], v[32:35]
    ds_read2_b32 v[50:51], v157 offset0:130 offset1:131
    v_mfma_f32_16x16x32_bf16 v[28:31], v[52:55], v[120:123], v[28:31]
    v_mfma_f32_16x16x32_bf16 v[24:27], v[52:55], v[116:119], v[24:27]
    ds_read_b128 v[92:95], v158 offset:1536
    v_mfma_f32_16x16x32_bf16 v[20:23], v[52:55], v[112:115], v[20:23]
    v_mfma_f32_16x16x32_bf16 v[44:47], v[56:59], v[132:135], v[44:47]
    v_mfma_f32_16x16x32_bf16 v[40:43], v[56:59], v[128:131], v[40:43]
    ds_read2_b32 v[52:53], v157 offset0:0 offset1:1
    v_mfma_f32_16x16x32_bf16 v[36:39], v[56:59], v[124:127], v[36:39]
    v_mfma_f32_16x16x32_bf16 v[32:35], v[56:59], v[120:123], v[32:35]
    ds_read2_b32 v[54:55], v157 offset0:2 offset1:3
    v_mfma_f32_16x16x32_bf16 v[28:31], v[56:59], v[116:119], v[28:31]
    v_mfma_f32_16x16x32_bf16 v[24:27], v[56:59], v[112:115], v[24:27]
    ds_read_b128 v[88:91], v158 offset:1024
    v_mfma_f32_16x16x32_bf16 v[44:47], v[60:63], v[128:131], v[44:47]
    v_mfma_f32_16x16x32_bf16 v[40:43], v[60:63], v[124:127], v[40:43]
    s_waitcnt lgkmcnt(12)
    ds_read2_b32 v[56:57], v156 offset0:128 offset1:129
    v_mfma_f32_16x16x32_bf16 v[36:39], v[60:63], v[120:123], v[36:39]
    v_mfma_f32_16x16x32_bf16 v[32:35], v[60:63], v[116:119], v[32:35]
    ds_read2_b32 v[58:59], v156 offset0:130 offset1:131
    v_mfma_f32_16x16x32_bf16 v[28:31], v[60:63], v[112:115], v[28:31]
    v_mfma_f32_16x16x32_bf16 v[44:47], v[64:67], v[124:127], v[44:47]
    v_mfma_f32_16x16x32_bf16 v[40:43], v[64:67], v[120:123], v[40:43]
    s_waitcnt lgkmcnt(12)
    ds_read2_b32 v[60:61], v156 offset0:0 offset1:1
    v_mfma_f32_16x16x32_bf16 v[36:39], v[64:67], v[116:119], v[36:39]
    v_mfma_f32_16x16x32_bf16 v[32:35], v[64:67], v[112:115], v[32:35]
    ds_read2_b32 v[62:63], v156 offset0:2 offset1:3
    v_mfma_f32_16x16x32_bf16 v[44:47], v[68:71], v[120:123], v[44:47]
    v_mfma_f32_16x16x32_bf16 v[40:43], v[68:71], v[116:119], v[40:43]
    s_waitcnt lgkmcnt(12)
    ds_read2_b32 v[64:65], v155 offset0:128 offset1:129
    v_mfma_f32_16x16x32_bf16 v[36:39], v[68:71], v[112:115], v[36:39]
    ds_read2_b32 v[68:69], v155 offset0:0 offset1:1
    s_waitcnt lgkmcnt(12)
    ds_read2_b32 v[70:71], v155 offset0:2 offset1:3
    ds_read2_b32 v[66:67], v155 offset0:130 offset1:131
    s_waitcnt lgkmcnt(12)
    ds_read_b128 v[84:87], v158 offset:512
    ds_read_b128 v[80:83], v158 offset:0
    v_mfma_f32_16x16x32_bf16 v[44:47], v[72:75], v[116:119], v[44:47]
    v_mfma_f32_16x16x32_bf16 v[40:43], v[72:75], v[112:115], v[40:43]
    s_waitcnt lgkmcnt(12)
    ds_read2_b32 v[72:73], v154 offset0:128 offset1:129
    ds_read2_b32 v[74:75], v154 offset0:130 offset1:131
    v_mfma_f32_16x16x32_bf16 v[44:47], v[76:79], v[112:115], v[44:47]
    s_waitcnt lgkmcnt(12)
    ds_read2_b32 v[76:77], v154 offset0:0 offset1:1
    ds_read2_b32 v[78:79], v154 offset0:2 offset1:3
    s_sub_u32 s20, s20, 2
    s_cmp_lg_u32 s20, 1
    s_cbranch_scc1 L_cloop
    s_branch L_skip4511
L_pada17:
    s_branch L_warmed_a
L_skip4511:
L_cexit:
    s_setprio 0
    v_subrev_u32 v156, 64, v156
    v_subrev_u32 v157, 64, v157
    v_subrev_u32 v158, 64, v158
    s_mov_b32 s100, 0
Lw_74:
    ds_read_b32 v4, v162 offset:284
    s_waitcnt lgkmcnt(0)
    v_readfirstlane_b32 s99, v4
    s_cmp_ge_u32 s99, 1
    s_cbranch_scc1 Lwd_75
    s_add_u32 s100, s100, 1
    s_cmp_lt_u32 s100, 1048576
    s_cbranch_scc1 Lw_74
Lwd_75:
    ds_read_b128 v[144:147], v161 offset:2048
    ds_read_b128 v[148:151], v161 offset:3072
    ds_read_b128 v[112:115], v158 offset:0
    ds_read2_b32 v[128:129], v157 offset0:128 offset1:129
    ds_read2_b32 v[130:131], v157 offset0:130 offset1:131
    ds_read_b128 v[116:119], v158 offset:512
    ds_read2_b32 v[132:133], v157 offset0:0 offset1:1
    ds_read2_b32 v[134:135], v157 offset0:2 offset1:3
    ds_read_b128 v[120:123], v158 offset:1024
    ds_read2_b32 v[136:137], v156 offset0:128 offset1:129
    ds_read2_b32 v[138:139], v156 offset0:130 offset1:131
    ds_read_b128 v[124:127], v158 offset:1536
    ds_read2_b32 v[140:141], v156 offset0:0 offset1:1
    ds_read2_b32 v[142:143], v156 offset0:2 offset1:3
    s_mov_b32 s62, 0x11111111
    s_mov_b32 s63, 0x11111111
    v_mfma_f32_16x16x32_bf16 v[32:35], v[48:51], v[96:99], v[32:35]
    v_mfma_f32_16x16x32_bf16 v[36:39], v[48:51], v[100:103], v[36:39]
    v_mfma_f32_16x16x32_bf16 v[32:35], v[52:55], v[92:95], v[32:35]
    v_mfma_f32_16x16x32_bf16 v[36:39], v[52:55], v[96:99], v[36:39]
    v_mfma_f32_16x16x32_bf16 v[32:35], v[56:59], v[88:91], v[32:35]
    v_mfma_f32_16x16x32_bf16 v[36:39], v[56:59], v[92:95], v[36:39]
    s_waitcnt lgkmcnt(12)
    v_mfma_f32_16x16x16_bf16 v[40:43], v[164:165], v[148:149], v[40:43]
    v_mfma_f32_16x16x16_bf16 v[44:47], v[164:165], v[150:151], v[44:47]
    v_mfma_f32_16x16x16_bf16 v[32:35], v[164:165], v[144:145], v[32:35]
    v_mfma_f32_16x16x16_bf16 v[36:39], v[164:165], v[146:147], v[36:39]
    v_mfma_f32_16x16x32_bf16 v[32:35], v[60:63], v[84:87], v[32:35]
    v_mfma_f32_16x16x32_bf16 v[36:39], v[60:63], v[88:91], v[36:39]
    v_mfma_f32_16x16x32_bf16 v[32:35], v[64:67], v[80:83], v[32:35]
    v_mfma_f32_16x16x32_bf16 v[36:39], v[64:67], v[84:87], v[36:39]
    v_mfma_f32_16x16x32_bf16 v[36:39], v[68:71], v[80:83], v[36:39]
    s_waitcnt lgkmcnt(0)
    v_mfma_f32_16x16x32_bf16 v[16:19], v[48:51], v[80:83], v[16:19]
    v_mfma_f32_16x16x32_bf16 v[20:23], v[48:51], v[84:87], v[20:23]
    v_mfma_f32_16x16x32_bf16 v[20:23], v[52:55], v[80:83], v[20:23]
    s_nop 1
    v_cvt_pk_bf16_f32 v8, v32, v33
    v_cvt_pk_bf16_f32 v9, v34, v35
    v_mfma_f32_16x16x32_bf16 v[16:19], v[128:131], v[112:115], v[16:19]
    v_cvt_pk_bf16_f32 v10, v36, v37
    v_cvt_pk_bf16_f32 v11, v38, v39
    v_mfma_f32_16x16x32_bf16 v[20:23], v[128:131], v[116:119], v[20:23]
    v_permlane16_swap_b32 v8, v10
    v_permlane16_swap_b32 v9, v11
    v_mfma_f32_16x16x32_bf16 v[20:23], v[132:135], v[112:115], v[20:23]
    global_store_dwordx4 v153, v[8:11], s[28:29] offset:2048 sc1
    v_add_u32 v6, v8, v9
    v_mfma_f32_16x16x32_bf16 v[24:27], v[48:51], v[88:91], v[24:27]
    v_mfma_f32_16x16x32_bf16 v[28:31], v[48:51], v[92:95], v[28:31]
    v_mfma_f32_16x16x32_bf16 v[24:27], v[52:55], v[84:87], v[24:27]
    v_add3_u32 v6, v6, v10, v11
    s_nop 1
    v_add_u32_dpp v6, v6, v6 quad_perm:[1,0,3,2] row_mask:0xf bank_mask:0xf
    v_mfma_f32_16x16x32_bf16 v[28:31], v[52:55], v[88:91], v[28:31]
    s_nop 0
    v_add_u32_dpp v6, v6, v6 quad_perm:[2,3,0,1] row_mask:0xf bank_mask:0xf
    s_mov_b64 exec, s[62:63]
    ds_add_u32 v159, v6 offset:64
    s_mov_b64 exec, -1
    v_mfma_f32_16x16x32_bf16 v[24:27], v[56:59], v[80:83], v[24:27]
    v_cvt_pk_bf16_f32 v12, v16, v17
    v_cvt_pk_bf16_f32 v13, v18, v19
    v_mfma_f32_16x16x32_bf16 v[28:31], v[56:59], v[84:87], v[28:31]
    v_cvt_pk_bf16_f32 v14, v20, v21
    v_cvt_pk_bf16_f32 v15, v22, v23
    v_mfma_f32_16x16x32_bf16 v[28:31], v[60:63], v[80:83], v[28:31]
    v_permlane16_swap_b32 v12, v14
    v_permlane16_swap_b32 v13, v15
    v_mfma_f32_16x16x32_bf16 v[24:27], v[128:131], v[120:123], v[24:27]
    global_store_dwordx4 v153, v[12:15], s[28:29] offset:0 sc1
    v_add_u32 v6, v12, v13
    v_mfma_f32_16x16x32_bf16 v[28:31], v[128:131], v[124:127], v[28:31]
    v_add3_u32 v6, v6, v14, v15
    s_nop 1
    v_add_u32_dpp v6, v6, v6 quad_perm:[1,0,3,2] row_mask:0xf bank_mask:0xf
    v_mfma_f32_16x16x32_bf16 v[24:27], v[132:135], v[116:119], v[24:27]
    s_nop 0
    v_add_u32_dpp v6, v6, v6 quad_perm:[2,3,0,1] row_mask:0xf bank_mask:0xf
    s_mov_b64 exec, s[62:63]
    ds_add_u32 v159, v6 offset:0
    s_mov_b64 exec, -1
    v_mfma_f32_16x16x32_bf16 v[28:31], v[132:135], v[120:123], v[28:31]
    v_mfma_f32_16x16x32_bf16 v[24:27], v[136:139], v[112:115], v[24:27]
    v_mfma_f32_16x16x32_bf16 v[28:31], v[136:139], v[116:119], v[28:31]
    v_mfma_f32_16x16x32_bf16 v[28:31], v[140:143], v[112:115], v[28:31]
    v_mfma_f32_16x16x32_bf16 v[40:43], v[48:51], v[104:107], v[40:43]
    v_mfma_f32_16x16x32_bf16 v[44:47], v[48:51], v[108:111], v[44:47]
    v_mfma_f32_16x16x32_bf16 v[40:43], v[52:55], v[100:103], v[40:43]
    s_nop 2
    v_cvt_pk_bf16_f32 v8, v24, v25
    v_cvt_pk_bf16_f32 v9, v26, v27
    v_mfma_f32_16x16x32_bf16 v[44:47], v[52:55], v[104:107], v[44:47]
    v_cvt_pk_bf16_f32 v10, v28, v29
    v_cvt_pk_bf16_f32 v11, v30, v31
    v_mfma_f32_16x16x32_bf16 v[40:43], v[56:59], v[96:99], v[40:43]
    v_permlane16_swap_b32 v8, v10
    v_permlane16_swap_b32 v9, v11
    v_mfma_f32_16x16x32_bf16 v[44:47], v[56:59], v[100:103], v[44:47]
    global_store_dwordx4 v153, v[8:11], s[28:29] offset:1024 sc1
    v_add_u32 v6, v8, v9
    v_mfma_f32_16x16x32_bf16 v[40:43], v[60:63], v[92:95], v[40:43]
    v_add3_u32 v6, v6, v10, v11
    s_nop 1
    v_add_u32_dpp v6, v6, v6 quad_perm:[1,0,3,2] row_mask:0xf bank_mask:0xf
    v_mfma_f32_16x16x32_bf16 v[44:47], v[60:63], v[96:99], v[44:47]
    s_nop 0
    v_add_u32_dpp v6, v6, v6 quad_perm:[2,3,0,1] row_mask:0xf bank_mask:0xf
    s_mov_b64 exec, s[62:63]
    ds_add_u32 v159, v6 offset:32
    s_mov_b64 exec, -1
    v_mfma_f32_16x16x32_bf16 v[40:43], v[64:67], v[88:91], v[40:43]
    v_mfma_f32_16x16x32_bf16 v[44:47], v[64:67], v[92:95], v[44:47]
    v_mfma_f32_16x16x32_bf16 v[40:43], v[68:71], v[84:87], v[40:43]
    v_mfma_f32_16x16x32_bf16 v[44:47], v[68:71], v[88:91], v[44:47]
    v_mfma_f32_16x16x32_bf16 v[40:43], v[72:75], v[80:83], v[40:43]
    v_mfma_f32_16x16x32_bf16 v[44:47], v[72:75], v[84:87], v[44:47]
    v_mfma_f32_16x16x32_bf16 v[44:47], v[76:79], v[80:83], v[44:47]
    s_setprio 3
    s_nop 4
    v_cvt_pk_bf16_f32 v12, v40, v41
    v_cvt_pk_bf16_f32 v13, v42, v43
    v_cvt_pk_bf16_f32 v14, v44, v45
    v_cvt_pk_bf16_f32 v15, v46, v47
    s_nop 0
    v_permlane16_swap_b32 v12, v14
    v_permlane16_swap_b32 v13, v15
    s_branch L_skip4654
L_pada18:
    s_branch L_warmed_a
L_skip4654:
    global_store_dwordx4 v153, v[12:15], s[28:29] offset:3072 sc1
    v_add_u32 v6, v12, v13
    v_add3_u32 v6, v6, v14, v15
    s_nop 1
    v_add_u32_dpp v6, v6, v6 quad_perm:[1,0,3,2] row_mask:0xf bank_mask:0xf
    s_nop 1
    v_add_u32_dpp v6, v6, v6 quad_perm:[2,3,0,1] row_mask:0xf bank_mask:0xf
    s_mov_b64 exec, s[62:63]
    ds_add_u32 v159, v6 offset:96
    s_mov_b64 exec, -1
    v_mov_b32 v4, 1
    s_mov_b64 exec, 1
    ds_add_u32 v3, v4 offset:196
    ds_add_rtn_u32 v4, v3, v4 offset:252
    s_mov_b64 exec, -1
    v_lshlrev_b32 v5, 2, v0
    v_add_u32 v5, 161792, v5
    ds_read_b32 v30, v5
    v_mov_b32 v31, 0x100
    s_waitcnt lgkmcnt(0)
    v_readfirstlane_b32 s98, v4
    s_add_u32 s98, s98, 1
    s_cmp_lg_u32 s98, s64
    s_cbranch_scc1 L_ynf
    s_mov_b64 exec, 0xffffffff
    global_atomic_add_x2 v[132:133], v160, v[30:31], s[28:29] sc0 sc1
    s_mov_b64 exec, -1
    s_mov_b32 s101, 1
L_ynf:
    s_branch L_cjoin
L_pada19:
    s_branch L_warmed_a
L_hloop:
    v_add_u32 v154, 8320, v154
    v_add_u32 v155, 8320, v155
    v_add_u32 v156, 8320, v156
    v_add_u32 v157, 8320, v157
    v_add_u32 v158, 4608, v158
    s_waitcnt lgkmcnt(15)
    v_mfma_f32_16x16x32_bf16 v[44:47], v[48:51], v[108:111], 0
    v_mfma_f32_16x16x32_bf16 v[40:43], v[48:51], v[104:107], 0
    s_waitcnt lgkmcnt(12)
    ds_read_b128 v[140:143], v158 offset:3584
    v_mfma_f32_16x16x32_bf16 v[36:39], v[48:51], v[100:103], 0
    s_waitcnt lgkmcnt(12)
    v_mfma_f32_16x16x32_bf16 v[32:35], v[48:51], v[96:99], 0
    ds_read_b128 v[136:139], v158 offset:3072
    v_mfma_f32_16x16x32_bf16 v[44:47], v[52:55], v[104:107], v[44:47]
    v_mfma_f32_16x16x32_bf16 v[40:43], v[52:55], v[100:103], v[40:43]
    ds_read2_b32 v[48:49], v157 offset0:128 offset1:129
    v_mfma_f32_16x16x32_bf16 v[36:39], v[52:55], v[96:99], v[36:39]
    s_waitcnt lgkmcnt(13)
    v_mfma_f32_16x16x32_bf16 v[32:35], v[52:55], v[92:95], v[32:35]
    ds_read2_b32 v[50:51], v157 offset0:130 offset1:131
    v_mfma_f32_16x16x32_bf16 v[44:47], v[56:59], v[100:103], v[44:47]
    v_mfma_f32_16x16x32_bf16 v[40:43], v[56:59], v[96:99], v[40:43]
    s_waitcnt lgkmcnt(12)
    ds_read2_b32 v[52:53], v157 offset0:0 offset1:1
    v_mfma_f32_16x16x32_bf16 v[36:39], v[56:59], v[92:95], v[36:39]
    v_mfma_f32_16x16x32_bf16 v[32:35], v[56:59], v[88:91], v[32:35]
    ds_read2_b32 v[54:55], v157 offset0:2 offset1:3
    v_mfma_f32_16x16x32_bf16 v[44:47], v[60:63], v[96:99], v[44:47]
    v_mfma_f32_16x16x32_bf16 v[40:43], v[60:63], v[92:95], v[40:43]
    s_waitcnt lgkmcnt(12)
    ds_read2_b32 v[56:57], v156 offset0:128 offset1:129
    v_mfma_f32_16x16x32_bf16 v[36:39], v[60:63], v[88:91], v[36:39]
    v_mfma_f32_16x16x32_bf16 v[32:35], v[60:63], v[84:87], v[32:35]
    ds_read2_b32 v[58:59], v156 offset0:130 offset1:131
    v_mfma_f32_16x16x32_bf16 v[44:47], v[64:67], v[92:95], v[44:47]
    v_mfma_f32_16x16x32_bf16 v[40:43], v[64:67], v[88:91], v[40:43]
    s_waitcnt lgkmcnt(12)
    ds_read2_b32 v[60:61], v156 offset0:0 offset1:1
    v_mfma_f32_16x16x32_bf16 v[36:39], v[64:67], v[84:87], v[36:39]
    v_mfma_f32_16x16x32_bf16 v[32:35], v[64:67], v[80:83], v[32:35]
    ds_read2_b32 v[62:63], v156 offset0:2 offset1:3
    v_mfma_f32_16x16x32_bf16 v[44:47], v[68:71], v[88:91], v[44:47]
    v_mfma_f32_16x16x32_bf16 v[40:43], v[68:71], v[84:87], v[40:43]
    s_waitcnt lgkmcnt(12)
    ds_read2_b32 v[64:65], v155 offset0:128 offset1:129
    v_mfma_f32_16x16x32_bf16 v[36:39], v[68:71], v[80:83], v[36:39]
    ds_read2_b32 v[68:69], v155 offset0:0 offset1:1
    s_waitcnt lgkmcnt(12)
    ds_read2_b32 v[70:71], v155 offset0:2 offset1:3
    ds_read2_b32 v[66:67], v155 offset0:130 offset1:131
    s_waitcnt lgkmcnt(12)
    ds_read_b128 v[132:135], v158 offset:2560
    ds_read_b128 v[128:131], v158 offset:2048
    s_waitcnt lgkmcnt(12)
    ds_read_b128 v[124:127], v158 offset:1536
    ds_read_b128 v[120:123], v158 offset:1024
    s_waitcnt lgkmcnt(12)
    ds_read_b128 v[116:119], v158 offset:512
    ds_read_b128 v[112:115], v158 offset:0
    v_mfma_f32_16x16x32_bf16 v[44:47], v[72:75], v[84:87], v[44:47]
    v_mfma_f32_16x16x32_bf16 v[40:43], v[72:75], v[80:83], v[40:43]
    s_waitcnt lgkmcnt(12)
    ds_read2_b32 v[72:73], v154 offset0:128 offset1:129
    ds_read2_b32 v[74:75], v154 offset0:130 offset1:131
    v_mfma_f32_16x16x32_bf16 v[44:47], v[76:79], v[80:83], v[44:47]
    s_waitcnt lgkmcnt(12)
    ds_read2_b32 v[76:77], v154 offset0:0 offset1:1
    ds_read2_b32 v[78:79], v154 offset0:2 offset1:3
    v_cvt_pk_bf16_f32 v8, v32, v33
    v_cvt_pk_bf16_f32 v9, v34, v35
    v_cvt_pk_bf16_f32 v10, v36, v37
    v_cvt_pk_bf16_f32 v11, v38, v39
    s_waitcnt lgkmcnt(12)
    ds_write_b128 v161, v[8:11] offset:2048
    v_cvt_pk_bf16_f32 v12, v40, v41
    v_cvt_pk_bf16_f32 v13, v42, v43
    v_cvt_pk_bf16_f32 v14, v44, v45
    v_cvt_pk_bf16_f32 v15, v46, v47
    ds_write_b128 v161, v[12:15] offset:3072
    s_waitcnt lgkmcnt(12)
    ds_write_b32 v162, v5 offset:284
    v_add_u32 v161, 2048, v161
    v_add_u32 v162, 4, v162
    s_sub_u32 s20, s20, 1
    s_cmp_eq_u32 s20, 0
    s_cbranch_scc1 L_hexit
    v_add_u32 v154, 8320, v154
    v_add_u32 v155, 8320, v155
    v_add_u32 v156, 8320, v156
    v_add_u32 v157, 8320, v157
    v_add_u32 v158, 4608, v158
    v_mfma_f32_16x16x32_bf16 v[44:47], v[48:51], v[140:143], 0
    v_mfma_f32_16x16x32_bf16 v[40:43], v[48:51], v[136:139], 0
    ds_read_b128 v[108:111], v158 offset:3584
    s_waitcnt lgkmcnt(13)
    v_mfma_f32_16x16x32_bf16 v[36:39], v[48:51], v[132:135], 0
    s_waitcnt lgkmcnt(12)
    v_mfma_f32_16x16x32_bf16 v[32:35], v[48:51], v[128:131], 0
    ds_read_b128 v[104:107], v158 offset:3072
    v_mfma_f32_16x16x32_bf16 v[44:47], v[52:55], v[136:139], v[44:47]
    v_mfma_f32_16x16x32_bf16 v[40:43], v[52:55], v[132:135], v[40:43]
    ds_read2_b32 v[48:49], v157 offset0:128 offset1:129
    v_mfma_f32_16x16x32_bf16 v[36:39], v[52:55], v[128:131], v[36:39]
    s_waitcnt lgkmcnt(13)
    v_mfma_f32_16x16x32_bf16 v[32:35], v[52:55], v[124:127], v[32:35]
    ds_read2_b32 v[50:51], v157 offset0:130 offset1:131
    v_mfma_f32_16x16x32_bf16 v[44:47], v[56:59], v[132:135], v[44:47]
    v_mfma_f32_16x16x32_bf16 v[40:43], v[56:59], v[128:131], v[40:43]
    s_waitcnt lgkmcnt(12)
    ds_read2_b32 v[52:53], v157 offset0:0 offset1:1
    v_mfma_f32_16x16x32_bf16 v[36:39], v[56:59], v[124:127], v[36:39]
    v_mfma_f32_16x16x32_bf16 v[32:35], v[56:59], v[120:123], v[32:35]
    ds_read2_b32 v[54:55], v157 offset0:2 offset1:3
    v_mfma_f32_16x16x32_bf16 v[44:47], v[60:63], v[128:131], v[44:47]
    v_mfma_f32_16x16x32_bf16 v[40:43], v[60:63], v[124:127], v[40:43]
    s_waitcnt lgkmcnt(12)
    ds_read2_b32 v[56:57], v156 offset0:128 offset1:129
    v_mfma_f32_16x16x32_bf16 v[36:39], v[60:63], v[120:123], v[36:39]
    v_mfma_f32_16x16x32_bf16 v[32:35], v[60:63], v[116:119], v[32:35]
    ds_read2_b32 v[58:59], v156 offset0:130 offset1:131
    v_mfma_f32_16x16x32_bf16 v[44:47], v[64:67], v[124:127], v[44:47]
    v_mfma_f32_16x16x32_bf16 v[40:43], v[64:67], v[120:123], v[40:43]
    s_waitcnt lgkmcnt(12)
    ds_read2_b32 v[60:61], v156 offset0:0 offset1:1
    v_mfma_f32_16x16x32_bf16 v[36:39], v[64:67], v[116:119], v[36:39]
    v_mfma_f32_16x16x32_bf16 v[32:35], v[64:67], v[112:115], v[32:35]
    ds_read2_b32 v[62:63], v156 offset0:2 offset1:3
    v_mfma_f32_16x16x32_bf16 v[44:47], v[68:71], v[120:123], v[44:47]
    v_mfma_f32_16x16x32_bf16 v[40:43], v[68:71], v[116:119], v[40:43]
    s_waitcnt lgkmcnt(12)
    ds_read2_b32 v[64:65], v155 offset0:128 offset1:129
    v_mfma_f32_16x16x32_bf16 v[36:39], v[68:71], v[112:115], v[36:39]
    ds_read2_b32 v[68:69], v155 offset0:0 offset1:1
    s_waitcnt lgkmcnt(12)
    ds_read2_b32 v[70:71], v155 offset0:2 offset1:3
    ds_read2_b32 v[66:67], v155 offset0:130 offset1:131
    s_waitcnt lgkmcnt(12)
    ds_read_b128 v[100:103], v158 offset:2560
    ds_read_b128 v[96:99], v158 offset:2048
    s_waitcnt lgkmcnt(12)
    ds_read_b128 v[92:95], v158 offset:1536
    ds_read_b128 v[88:91], v158 offset:1024
    s_waitcnt lgkmcnt(12)
    ds_read_b128 v[84:87], v158 offset:512
    ds_read_b128 v[80:83], v158 offset:0
    v_mfma_f32_16x16x32_bf16 v[44:47], v[72:75], v[116:119], v[44:47]
    v_mfma_f32_16x16x32_bf16 v[40:43], v[72:75], v[112:115], v[40:43]
    s_waitcnt lgkmcnt(12)
    ds_read2_b32 v[72:73], v154 offset0:128 offset1:129
    ds_read2_b32 v[74:75], v154 offset0:130 offset1:131
    v_mfma_f32_16x16x32_bf16 v[44:47], v[76:79], v[112:115], v[44:47]
    s_waitcnt lgkmcnt(12)
    ds_read2_b32 v[76:77], v154 offset0:0 offset1:1
    ds_read2_b32 v[78:79], v154 offset0:2 offset1:3
    v_cvt_pk_bf16_f32 v8, v32, v33
    v_cvt_pk_bf16_f32 v9, v34, v35
    v_cvt_pk_bf16_f32 v10, v36, v37
    v_cvt_pk_bf16_f32 v11, v38, v39
    s_waitcnt lgkmcnt(12)
    ds_write_b128 v161, v[8:11] offset:2048
    v_cvt_pk_bf16_f32 v12, v40, v41
    v_cvt_pk_bf16_f32 v13, v42, v43
    v_cvt_pk_bf16_f32 v14, v44, v45
    v_cvt_pk_bf16_f32 v15, v46, v47
    ds_write_b128 v161, v[12:15] offset:3072
    s_waitcnt lgkmcnt(12)
    ds_write_b32 v162, v5 offset:284
    v_add_u32 v161, 2048, v161
    v_add_u32 v162, 4, v162
    s_sub_u32 s20, s20, 1
    s_cmp_eq_u32 s20, 0
    s_cbranch_scc0 L_hloop
    s_branch L_skip4858
L_pada20:
    s_branch L_warmed_a
L_skip4858:
L_hexit:
L_cdone:
    s_waitcnt lgkmcnt(0)
    v_mov_b32 v4, 1
    s_mov_b64 exec, 1
    ds_add_u32 v3, v4 offset:196
    s_mov_b64 exec, -1
    s_setprio 0
    s_mov_b32 s100, 0
Lw_76:
    ds_read_b32 v4, v3 offset:196
    s_waitcnt lgkmcnt(0)
    v_readfirstlane_b32 s99, v4
    s_cmp_ge_u32 s99, 4
    s_cbranch_scc1 Lwd_77
    s_sleep 6
    s_add_u32 s100, s100, 1
    s_cmp_lt_u32 s100, 1048576
    s_cbranch_scc1 Lw_76
Lwd_77:
L_cjoin:
    s_setprio 2
    s_mov_b32 s100, 0
Lw_78:
    ds_read_b32 v4, v3 offset:192
    s_waitcnt lgkmcnt(0)
    v_readfirstlane_b32 s99, v4
    s_cmp_ge_u32 s99, 1
    s_cbranch_scc1 Lwd_79
    s_add_u32 s100, s100, 1
    s_cmp_lt_u32 s100, 1048576
    s_cbranch_scc1 Lw_78
Lwd_79:
    s_mov_b32 s91, s99
    s_cmp_eq_u32 s91, 1
    s_cselect_b32 s99, 0, 15728640
    s_add_u32 s16, s28, s99
    s_addc_u32 s17, s29, 0
    s_add_u32 s18, s16, 13107200
    s_addc_u32 s19, s17, 0
    s_cmp_eq_u32 s91, 1
    s_cselect_b64 s[18:19], s[24:25], s[18:19]
    v_lshl_add_u32 v138, v0, 4, s80
    v_lshl_add_u32 v139, v0, 4, s82
    v_lshl_add_u32 v166, v0, 2, s83
    s_branch L_tail
L_end:
    s_endpgm
L_codeend:
.section .rodata,"a"
.p2align 6
.amdhsa_kernel gated_mix__ssm_conv_h3__sliding_local_dilated__prompt_kernel
  .amdhsa_next_free_vgpr 168
  .amdhsa_next_free_sgpr 102
  .amdhsa_accum_offset 168
  .amdhsa_group_segment_fixed_size 0
  .amdhsa_kernarg_size 104
  .amdhsa_user_sgpr_count 2
  .amdhsa_user_sgpr_kernarg_segment_ptr 1
  .amdhsa_system_sgpr_workgroup_id_x 1
.end_amdhsa_kernel
```

```asm
; @launch grid=(256,1,1) block=(768,1,1) lds=163840
.amdgcn_target "amdgcn-amd-amdhsa--gfx950"
.text
.p2align 12
.globl gated_mix__ssm_conv_h3__sliding_local_dilated__prompt_kernel
.p2align 8
.type gated_mix__ssm_conv_h3__sliding_local_dilated__prompt_kernel,@function
gated_mix__ssm_conv_h3__sliding_local_dilated__prompt_kernel:
L_entry:
    s_load_dwordx16 s[4:19], s[0:1], 0
    s_load_dwordx8 s[20:27], s[0:1], 64
    s_load_dwordx2 s[28:29], s[0:1], 96
    s_cmp_ge_u32 s2, 256
    s_cbranch_scc1 L_end
    v_lshrrev_b32 v4, 6, v0
    v_and_b32 v0, 63, v0
    v_readfirstlane_b32 s32, v4
    v_mov_b32 v3, 160768
    s_cmp_eq_u32 s32, 4
    s_cbranch_scc1 L_pf
L_nopf:
    s_lshr_b32 s31, s2, 3
    v_lshrrev_b32 v2, 4, v0
    v_and_b32 v1, 15, v0
    s_and_b32 s30, s2, 7
    s_and_b32 s36, s31, 7
    s_lshr_b32 s35, s31, 3
    s_lshl2_add_u32 s35, s30, s35
    s_cmp_ge_u32 s31, 20
    s_cselect_b32 s34, 1, 0
    s_cselect_b32 s96, 20, 0
    s_cselect_b32 s97, 5, 10
    s_sub_u32 s38, s31, s96
    s_cmp_ge_u32 s38, s97
    s_cselect_b32 s97, s97, 0
    s_cselect_b32 s96, 1, 0
    s_sub_u32 s38, s38, s97
    s_lshl1_add_u32 s37, s30, s96
    s_mul_i32 s39, s37, 163840
    s_cmp_ge_u32 s32, 4
    s_cbranch_scc1 L_cw
    s_setprio 3
    s_cmp_lg_u32 s34, 0
    s_cbranch_scc1 L_aserv
    s_branch L_bserv
L_aserv:
    v_lshrrev_b32 v5, 3, v0
    v_mul_u32_u24 v5, 1280, v5
    v_and_b32 v4, 7, v0
    v_lshl_add_u32 v4, v4, 4, v5
    s_lshl_b32 s96, s38, 8
    v_add_u32 v4, s96, v4
    s_and_b32 s97, s32, 1
    s_lshl_b32 s97, s97, 6
    v_xor_b32 v13, s97, v4
    v_xor_b32 v14, 16, v13
    v_xor_b32 v15, 32, v13
    v_xor_b32 v16, 48, v13
    s_mul_i32 s96, s32, 40960
    s_add_u32 s52, s39, s96
    s_lshl_b32 s53, s32, 12
    s_lshl_b32 s97, s97, 1
    s_add_u32 s96, s39, s97
    s_sub_u32 s96, s96, 5120
    v_xor_b32 v4, 0x70, v4
    v_add_u32 v17, s96, v4
    s_waitcnt lgkmcnt(0)
    s_mov_b32 s84, s6
    s_and_b32 s85, s7, 0xffff
    s_mov_b32 s86, 2621440
    s_mov_b32 s87, 0x00020000
    s_mov_b32 s80, s8
    s_and_b32 s81, s9, 0xffff
    s_mov_b32 s82, 2621440
    s_mov_b32 s83, 0x00020000
    s_load_dword s33, s[28:29], 0
    s_cmp_ge_u32 s38, 5
    s_cbranch_scc1 L_as_nokv
    s_cmp_ge_u32 s32, 2
    s_cbranch_scc1 L_as_nohalo
    s_mul_i32 m0, s32, 16896
    s_add_u32 m0, m0, 90496
    s_mov_b64 exec, 0xffffffff
    buffer_load_dwordx4 v17, s[84:87], 0 offen lds
    s_mov_b64 exec, -1
L_as_nohalo:
    s_add_u32 m0, s53, 91008
    s_mov_b32 s59, s52
    buffer_load_dwordx4 v13, s[84:87], s59 offen lds
    s_addk_i32 m0, 16768
    s_nop 0
    buffer_load_dwordx4 v13, s[84:87], s59 offen offset:128 lds
    s_addk_i32 m0, -15744
    s_addk_i32 s59, 10240
    buffer_load_dwordx4 v14, s[84:87], s59 offen lds
    s_addk_i32 m0, 16768
    s_nop 0
    buffer_load_dwordx4 v14, s[84:87], s59 offen offset:128 lds
    s_addk_i32 m0, -15744
    s_addk_i32 s59, 10240
    buffer_load_dwordx4 v15, s[84:87], s59 offen lds
    s_addk_i32 m0, 16768
    s_nop 0
    buffer_load_dwordx4 v15, s[84:87], s59 offen offset:128 lds
    s_addk_i32 m0, -15744
    s_addk_i32 s59, 10240
    buffer_load_dwordx4 v16, s[84:87], s59 offen lds
    s_addk_i32 m0, 16768
    s_nop 0
    buffer_load_dwordx4 v16, s[84:87], s59 offen offset:128 lds
    s_add_u32 m0, s53, 124288
    s_mov_b32 s59, s52
    buffer_load_dwordx4 v13, s[80:83], s59 offen lds
    s_addk_i32 m0, 16256
    s_nop 0
    buffer_load_dwordx4 v13, s[80:83], s59 offen offset:128 lds
    s_addk_i32 m0, -15232
    s_addk_i32 s59, 10240
    buffer_load_dwordx4 v14, s[80:83], s59 offen lds
    s_addk_i32 m0, 16256
    s_nop 0
    buffer_load_dwordx4 v14, s[80:83], s59 offen offset:128 lds
    s_addk_i32 m0, -15232
    s_addk_i32 s59, 10240
    buffer_load_dwordx4 v15, s[80:83], s59 offen lds
    s_addk_i32 m0, 16256
    s_nop 0
    buffer_load_dwordx4 v15, s[80:83], s59 offen offset:128 lds
    s_addk_i32 m0, -15232
    s_addk_i32 s59, 10240
    buffer_load_dwordx4 v16, s[80:83], s59 offen lds
    s_addk_i32 m0, 16256
    s_nop 0
    buffer_load_dwordx4 v16, s[80:83], s59 offen offset:128 lds
    s_branch L_as_kv
L_cw:
    s_cmp_eq_u32 s34, 0
    s_cbranch_scc1 L_compute
    s_sub_u32 s65, s32, 4
    s_cmp_ge_u32 s38, 5
    s_cbranch_scc1 L_awave
    s_lshl3_add_u32 s58, s38, s65
    s_lshl_b32 s96, s58, 7
    s_add_u32 s97, s96, 64
    s_waitcnt lgkmcnt(0)
    s_load_dword s33, s[28:29], 0
    s_load_dwordx16 s[40:55], s[10:11], s96
    s_load_dwordx16 s[76:91], s[10:11], s97
    s_branch L_nopack
L_pf:
    s_getpc_b64 s[46:47]
L_pc:
    s_lshr_b32 s96, s2, 3
    s_mul_i32 s96, s96, 1152
    v_lshl_add_u32 v4, v0, 7, s96
    v_min_u32 v4, L_codeend-L_pc-4, v4
    s_mov_b64 exec, 0x1ff
    global_load_dword v137, v4, s[46:47]
    s_mov_b64 exec, -1
    v_lshl_add_u32 v5, v0, 3, v3
    v_mov_b32 v6, 0
    v_mov_b32 v7, 0
    ds_write_b64 v5, v[6:7]
    s_branch L_nopf
L_service:
L_bserv:
    v_lshrrev_b32 v4, 3, v0
    v_and_b32 v5, 7, v0
    s_add_u32 s65, s30, s38
    s_mul_i32 s96, s65, 52
    s_lshr_b32 s96, s96, 8
    s_mul_i32 s96, s96, 5
    s_sub_u32 s65, s65, s96
    s_mul_i32 s65, s65, 512
    s_lshr_b32 s65, s65, 8
    s_mov_b32 s67, s65
    s_and_b32 s96, s32, 1
    s_cmp_ge_u32 s32, 2
    s_cbranch_scc1 L_lw
    v_mul_u32_u24 v6, 1280, v4
    v_xor_b32 v7, v5, v2
    v_lshl_add_u32 v13, v7, 4, v6
    s_lshl_b32 s97, s96, 6
    v_xor_b32 v13, s97, v13
    v_xor_b32 v14, 64, v13
    s_sub_u32 s52, s39, 20480
    s_cmp_eq_u32 s37, 0
    s_cselect_b32 s52, 0, s52
    s_add_u32 s97, s39, 71680
    s_add_u32 s98, s39, 92160
    s_cmp_eq_u32 s96, 0
    s_cselect_b32 s52, s52, s97
    s_cselect_b32 s53, s39, s98
    s_mul_i32 s54, s96, 9216
    s_add_u32 s54, s54, 86016
    s_waitcnt lgkmcnt(0)
    s_mov_b32 s40, s4
    s_and_b32 s41, s5, 0xffff
    s_mov_b32 s42, 2621440
    s_mov_b32 s43, 0x00020000
    s_mov_b32 m0, s54
    s_lshl_b32 s67, s67, 7
    s_add_u32 s59, s52, s67
    buffer_load_dwordx4 v13, s[40:43], s59 offen lds
    s_addk_i32 m0, 1024
    s_addk_i32 s59, 10240
    buffer_load_dwordx4 v14, s[40:43], s59 offen lds
    s_addk_i32 m0, 1024
    s_add_u32 s59, s53, s67
    buffer_load_dwordx4 v13, s[40:43], s59 offen lds
    s_addk_i32 m0, 1024
    s_addk_i32 s59, 10240
    buffer_load_dwordx4 v14, s[40:43], s59 offen lds
    s_addk_i32 m0, 1024
    s_addk_i32 s59, 10240
    buffer_load_dwordx4 v13, s[40:43], s59 offen lds
    s_addk_i32 m0, 1024
    s_addk_i32 s59, 10240
    buffer_load_dwordx4 v14, s[40:43], s59 offen lds
    s_addk_i32 m0, 1024
    s_addk_i32 s59, 10240
    buffer_load_dwordx4 v13, s[40:43], s59 offen lds
    s_addk_i32 m0, 1024
    s_addk_i32 s59, 10240
    buffer_load_dwordx4 v14, s[40:43], s59 offen lds
    s_addk_i32 m0, 1024
    s_addk_i32 s59, 10240
    buffer_load_dwordx4 v13, s[40:43], s59 offen lds
    s_branch L_ld_x_c
L_lw:
    v_and_b32 v7, 2, v4
    v_xor_b32 v7, v7, v5
    v_mul_u32_u24 v6, 3840, v4
    v_lshl_add_u32 v13, v7, 4, v6
    s_lshl_b32 s97, s38, 7
    v_add_u32 v13, s97, v13
    v_xor_b32 v14, 64, v13
    s_mul_i32 s54, s96, 12288
    s_add_u32 s54, s54, 104448
    s_mul_i32 s52, s96, 122880
    s_waitcnt lgkmcnt(0)
    s_mov_b32 s44, s18
    s_and_b32 s45, s19, 0xffff
    s_mov_b32 s46, 2457600
    s_mov_b32 s47, 0x00020000
    s_mov_b32 m0, s54
    s_mul_i32 s59, s67, 245760
    s_add_u32 s59, s59, s52
    buffer_load_dwordx4 v13, s[44:47], s59 offen lds
    s_addk_i32 m0, 1024
    s_addk_i32 s59, 1280
    buffer_load_dwordx4 v13, s[44:47], s59 offen lds
    s_addk_i32 m0, 1024
    s_addk_i32 s59, 1280
    buffer_load_dwordx4 v13, s[44:47], s59 offen lds
    s_addk_i32 m0, 1024
    s_addk_i32 s59, 28160
    buffer_load_dwordx4 v14, s[44:47], s59 offen lds
    s_addk_i32 m0, 1024
    s_addk_i32 s59, 1280
    buffer_load_dwordx4 v14, s[44:47], s59 offen lds
    s_addk_i32 m0, 1024
    s_addk_i32 s59, 1280
    buffer_load_dwordx4 v14, s[44:47], s59 offen lds
    s_addk_i32 m0, 1024
    s_addk_i32 s59, 28160
    buffer_load_dwordx4 v13, s[44:47], s59 offen lds
    s_addk_i32 m0, 1024
    s_addk_i32 s59, 1280
    buffer_load_dwordx4 v13, s[44:47], s59 offen lds
    s_addk_i32 m0, 1024
    s_addk_i32 s59, 1280
    buffer_load_dwordx4 v13, s[44:47], s59 offen lds
    s_addk_i32 m0, 1024
    s_addk_i32 s59, 28160
    buffer_load_dwordx4 v14, s[44:47], s59 offen lds
    s_addk_i32 m0, 1024
    s_addk_i32 s59, 1280
    buffer_load_dwordx4 v14, s[44:47], s59 offen lds
    s_addk_i32 m0, 1024
    s_addk_i32 s59, 1280
    buffer_load_dwordx4 v14, s[44:47], s59 offen lds
    s_branch L_ld_w_c
L_padb0:
    s_branch L_padb8
L_ld_x_c:
    s_load_dword s33, s[28:29], 0
    s_mov_b32 s76, s65
    s_mov_b32 s78, s65
    s_mov_b32 s67, s76
    s_add_u32 s76, s76, 1
    s_cmp_eq_u32 s76, 10
    s_cselect_b32 s76, 0, s76
    s_mov_b32 s67, s76
    s_add_u32 s76, s76, 1
    s_cmp_eq_u32 s76, 10
    s_cselect_b32 s76, 0, s76
    s_cmp_lg_u32 s32, 0
    s_cbranch_scc1 L_nogw
    s_mov_b32 s48, s22
    s_and_b32 s49, s23, 0xffff
    s_mov_b32 s50, 1280
    s_mov_b32 s51, 0x00020000
    v_lshlrev_b32 v4, 4, v0
    s_mov_b32 m0, 162048
    s_nop 0
    buffer_load_dwordx4 v4, s[48:51], 0 offen lds
    s_mov_b64 exec, 0xffff
    buffer_load_dwordx4 v4, s[48:51], 0 offen offset:1024 lds
    s_mov_b64 exec, -1
L_nogw:
    s_add_u32 s62, s54, 43008
    s_sub_u32 s54, s54, 86016
    s_mov_b32 s61, s54
    s_mov_b32 s55, 1
    s_mul_i32 s96, s36, 102400
    s_add_u32 s96, s96, 9437184
    s_add_u32 s48, s28, s96
    s_addc_u32 s49, s29, 0
    s_and_b32 s49, s49, 0xffff
    s_mov_b32 s50, 102400
    s_mov_b32 s51, 0x00020000
    v_lshlrev_b32 v19, 4, v0
    s_lshl_b32 s66, s30, 5
    s_add_u32 s66, s66, s31
    s_lshl_b32 s66, s66, 8
    s_add_u32 s66, s66, 65536
    s_add_u32 s66, s66, 128
    v_lshrrev_b32 v5, 1, v1
    v_xor_b32 v5, v5, v2
    v_lshlrev_b32 v5, 4, v5
    v_lshl_add_u32 v5, v1, 7, v5
    s_lshl_b32 s97, s32, 6
    v_xor_b32 v5, s97, v5
    s_and_b32 s96, s38, 7
    s_lshl_b32 s96, s96, 11
    s_add_u32 s96, s96, 2048
    v_add_u32 v18, s96, v5
    s_add_u32 s97, s97, 162048
    v_lshl_add_u32 v17, v2, 4, s97
    s_mov_b32 s64, 86016
    v_mov_b64 v[20:21], 0
    v_mov_b64 v[22:23], 0
    v_mov_b64 v[24:25], 0
    v_mov_b64 v[26:27], 0
    v_mov_b64 v[28:29], 0
    v_mov_b64 v[30:31], 0
    s_lshl1_add_u32 s96, s35, s32
    s_mul_i32 s96, s96, 40960
    s_mul_i32 s97, s36, 160
    s_add_u32 s96, s96, s97
    v_add_u32 v4, 0, v0
    v_mul_u32_u24 v8, 6554, v4
    v_lshrrev_b32 v8, 16, v8
    v_mul_u32_u24 v8, 1120, v8
    v_lshl_add_u32 v4, v4, 4, s96
    v_add_u32 v8, v8, v4
    v_add_u32 v4, 64, v0
    v_mul_u32_u24 v9, 6554, v4
    v_lshrrev_b32 v9, 16, v9
    v_mul_u32_u24 v9, 1120, v9
    v_lshl_add_u32 v4, v4, 4, s96
    v_add_u32 v9, v9, v4
    v_add_u32 v4, 128, v0
    v_mul_u32_u24 v10, 6554, v4
    v_lshrrev_b32 v10, 16, v10
    v_mul_u32_u24 v10, 1120, v10
    v_lshl_add_u32 v4, v4, 4, s96
    v_add_u32 v10, v10, v4
    v_add_u32 v4, 192, v0
    v_mul_u32_u24 v11, 6554, v4
    v_lshrrev_b32 v11, 16, v11
    v_mul_u32_u24 v11, 1120, v11
    v_lshl_add_u32 v4, v4, 4, s96
    v_add_u32 v11, v11, v4
    v_add_u32 v4, 256, v0
    v_mul_u32_u24 v12, 6554, v4
    v_lshrrev_b32 v12, 16, v12
    v_mul_u32_u24 v12, 1120, v12
    v_lshl_add_u32 v4, v4, 4, s96
    v_add_u32 v12, v12, v4
    s_waitcnt lgkmcnt(0)
    s_mul_i32 s33, s33, 1664525
    s_add_u32 s33, s33, 1013904223
    s_branch L_ld_x_i
L_padb1:
    s_branch L_padb9
L_ld_x:
    s_mov_b32 s68, s78
    s_add_u32 s78, s78, 1
    s_cmp_eq_u32 s78, 10
    s_cselect_b32 s78, 0, s78
    s_lshl_b32 s68, s68, 7
    v_add_u32 v15, s64, v18
    v_add_u32 v16, s68, v17
    ds_read_b128 v[24:27], v15
    ds_read_b128 v[28:31], v16
    s_add_u32 s64, s64, 43008
    s_cmp_eq_u32 s64, 129024
    s_cselect_b32 s64, 0, s64
L_ld_x_i:
    s_mov_b32 m0, s54
    s_lshl_b32 s67, s67, 7
    s_add_u32 s59, s52, s67
    buffer_load_dwordx4 v13, s[40:43], s59 offen lds
    s_addk_i32 m0, 1024
    s_addk_i32 s59, 10240
    buffer_load_dwordx4 v14, s[40:43], s59 offen lds
    s_addk_i32 m0, 1024
    s_add_u32 s59, s53, s67
    buffer_load_dwordx4 v13, s[40:43], s59 offen lds
    s_addk_i32 m0, 1024
    s_addk_i32 s59, 10240
    buffer_load_dwordx4 v14, s[40:43], s59 offen lds
    s_addk_i32 m0, 1024
    s_addk_i32 s59, 10240
    buffer_load_dwordx4 v13, s[40:43], s59 offen lds
    s_addk_i32 m0, 1024
    s_addk_i32 s59, 10240
    s_waitcnt lgkmcnt(0)
    v_mfma_f32_16x16x32_bf16 v[20:23], v[28:31], v[24:27], v[20:23]
    s_cmp_lt_u32 s55, 9
    s_cbranch_scc1 Lmp_1
    s_load_dwordx4 s[88:91], s[28:29], s66 glc
Lmp_1:
    buffer_load_dwordx4 v14, s[40:43], s59 offen lds
    s_addk_i32 m0, 1024
    s_addk_i32 s59, 10240
    buffer_load_dwordx4 v13, s[40:43], s59 offen lds
    s_addk_i32 m0, 1024
    s_addk_i32 s59, 10240
    buffer_load_dwordx4 v14, s[40:43], s59 offen lds
    s_addk_i32 m0, 1024
    s_addk_i32 s59, 10240
    buffer_load_dwordx4 v13, s[40:43], s59 offen lds
    s_mov_b32 s67, s76
    s_add_u32 s76, s76, 1
    s_cmp_eq_u32 s76, 10
    s_cselect_b32 s76, 0, s76
    s_add_u32 s54, s54, 43008
    s_cmp_eq_u32 s54, s62
    s_cselect_b32 s54, s61, s54
    s_add_u32 s55, s55, 1
    s_cmp_eq_u32 s55, 2
    s_cbranch_scc1 L_ld_x_e
L_ld_x_w:
    s_waitcnt vmcnt(9)
L_ld_x_b:
    s_barrier
    s_cmp_lt_u32 s55, 10
    s_cbranch_scc1 L_ld_x
    s_mov_b32 s68, s78
    s_add_u32 s78, s78, 1
    s_cmp_eq_u32 s78, 10
    s_cselect_b32 s78, 0, s78
    s_lshl_b32 s68, s68, 7
    v_add_u32 v15, s64, v18
    v_add_u32 v16, s68, v17
    ds_read_b128 v[24:27], v15
    ds_read_b128 v[28:31], v16
    s_add_u32 s64, s64, 43008
    s_cmp_eq_u32 s64, 129024
    s_cselect_b32 s64, 0, s64
    s_waitcnt lgkmcnt(0)
    v_mfma_f32_16x16x32_bf16 v[20:23], v[28:31], v[24:27], v[20:23]
    s_branch L_ld_end
L_ld_w_e:
    s_barrier
    s_branch L_ld_w_w
L_ld_x_e:
    s_barrier
    s_cmp_lg_u32 s32, 1
    s_cbranch_scc1 L_ld_x_w
    s_lshl_b32 s96, s30, 5
    s_add_u32 s96, s96, s31
    s_lshl_b32 s96, s96, 8
    s_add_u32 s96, s96, 65536
    v_lshl_add_u32 v4, v0, 3, s96
    v_mov_b32 v6, 0
    s_and_b32 s97, s33, 0xffffff00
    v_mov_b32 v7, s97
    s_getreg_b32 s97, hwreg(HW_REG_XCC_ID, 0, 4)
    v_writelane_b32 v6, s33, 3
    v_writelane_b32 v7, s97, 3
    s_mov_b64 exec, 0xffff
    global_store_dwordx2 v4, v[6:7], s[28:29] sc1
    s_mov_b64 exec, -1
    s_waitcnt vmcnt(10)
    s_branch L_ld_x_b
.p2align 12
L_padb2:
    s_branch L_padb10
L_ld_w_c:
    s_load_dword s33, s[28:29], 0
    s_mov_b32 s76, s65
    s_mov_b32 s78, s65
    s_mov_b32 s67, s76
    s_add_u32 s76, s76, 1
    s_cmp_eq_u32 s76, 10
    s_cselect_b32 s76, 0, s76
    s_mov_b32 s67, s76
    s_add_u32 s76, s76, 1
    s_cmp_eq_u32 s76, 10
    s_cselect_b32 s76, 0, s76
    s_add_u32 s62, s54, 43008
    s_sub_u32 s54, s54, 86016
    s_mov_b32 s61, s54
    s_mov_b32 s55, 1
    s_mul_i32 s96, s36, 102400
    s_add_u32 s96, s96, 9437184
    s_add_u32 s48, s28, s96
    s_addc_u32 s49, s29, 0
    s_and_b32 s49, s49, 0xffff
    s_mov_b32 s50, 102400
    s_mov_b32 s51, 0x00020000
    v_lshlrev_b32 v19, 4, v0
    s_lshl_b32 s66, s30, 5
    s_add_u32 s66, s66, s31
    s_lshl_b32 s66, s66, 8
    s_add_u32 s66, s66, 65536
    s_add_u32 s66, s66, 128
    v_mov_b32 v8, 0
    v_mov_b32 v9, 0
    v_mov_b32 v10, 0
    v_mov_b32 v11, 0
    v_mov_b32 v12, 0
    s_mov_b32 s40, s4
    s_and_b32 s41, s5, 0xffff
    s_mov_b32 s42, 2621440
    s_mov_b32 s43, 0x00020000
    s_waitcnt lgkmcnt(0)
    s_mul_i32 s33, s33, 1664525
    s_add_u32 s33, s33, 1013904223
L_ld_w:
    s_cmp_lt_u32 s55, 9
    s_cbranch_scc1 Lmp_2
    s_load_dwordx4 s[88:91], s[28:29], s66 glc
Lmp_2:
    s_mov_b32 m0, s54
    s_mul_i32 s59, s67, 245760
    s_add_u32 s59, s59, s52
    buffer_load_dwordx4 v13, s[44:47], s59 offen lds
    s_addk_i32 m0, 1024
    s_addk_i32 s59, 1280
    buffer_load_dwordx4 v13, s[44:47], s59 offen lds
    s_addk_i32 m0, 1024
    s_addk_i32 s59, 1280
    buffer_load_dwordx4 v13, s[44:47], s59 offen lds
    s_addk_i32 m0, 1024
    s_addk_i32 s59, 28160
    buffer_load_dwordx4 v14, s[44:47], s59 offen lds
    s_addk_i32 m0, 1024
    s_addk_i32 s59, 1280
    buffer_load_dwordx4 v14, s[44:47], s59 offen lds
    s_addk_i32 m0, 1024
    s_addk_i32 s59, 1280
    buffer_load_dwordx4 v14, s[44:47], s59 offen lds
    s_addk_i32 m0, 1024
    s_addk_i32 s59, 28160
    buffer_load_dwordx4 v13, s[44:47], s59 offen lds
    s_addk_i32 m0, 1024
    s_addk_i32 s59, 1280
    buffer_load_dwordx4 v13, s[44:47], s59 offen lds
    s_addk_i32 m0, 1024
    s_addk_i32 s59, 1280
    buffer_load_dwordx4 v13, s[44:47], s59 offen lds
    s_addk_i32 m0, 1024
    s_addk_i32 s59, 28160
    buffer_load_dwordx4 v14, s[44:47], s59 offen lds
    s_addk_i32 m0, 1024
    s_addk_i32 s59, 1280
    buffer_load_dwordx4 v14, s[44:47], s59 offen lds
    s_addk_i32 m0, 1024
    s_addk_i32 s59, 1280
    buffer_load_dwordx4 v14, s[44:47], s59 offen lds
    s_mov_b32 s67, s76
    s_add_u32 s76, s76, 1
    s_cmp_eq_u32 s76, 10
    s_cselect_b32 s76, 0, s76
    s_add_u32 s54, s54, 43008
    s_cmp_eq_u32 s54, s62
    s_cselect_b32 s54, s61, s54
    s_add_u32 s55, s55, 1
    s_cmp_eq_u32 s55, 2
    s_cbranch_scc1 L_ld_w_e
L_ld_w_w:
    s_waitcnt vmcnt(12)
L_ld_w_b:
    s_barrier
    s_cmp_lt_u32 s55, 10
    s_cbranch_scc1 L_ld_w
L_ld_end:
    s_waitcnt lgkmcnt(0)
    s_cmp_eq_u32 s90, s33
    s_cbranch_scc1 L_wo_mk
    s_lshl_b32 s98, s30, 5
    s_add_u32 s98, s98, s31
    s_lshl_b32 s98, s98, 8
    s_add_u32 s98, s98, 65536
    s_add_u32 s98, s98, 128
    s_mov_b32 s100, 0
Lc_3:
    s_load_dwordx4 s[88:91], s[28:29], s98 glc
    s_waitcnt lgkmcnt(0)
    s_cmp_eq_u32 s90, s33
    s_cbranch_scc1 Lcd_4
    s_sleep 2
    s_add_u32 s100, s100, 1
    s_cmp_lt_u32 s100, 1048576
    s_cbranch_scc1 Lc_3
    s_mov_b32 s91, 2
Lcd_4:
L_wo_mk:
    s_cmp_eq_u32 s91, 1
    s_cselect_b32 s99, 0, 15728640
    s_add_u32 s16, s28, s99
    s_addc_u32 s17, s29, 0
    s_cmp_lg_u32 s32, 2
    s_cbranch_scc1 L_wo_nc
    s_mov_b32 s44, s28
    s_and_b32 s45, s29, 0xffff
    s_mov_b32 s46, 1048576
    s_mov_b32 s47, 0x00020000
    v_lshlrev_b32 v4, 2, v0
    s_mov_b32 m0, 161152
    s_mov_b64 exec, 3
    s_add_u32 s66, s66, 8
    buffer_load_dword v4, s[44:47], s66 offen sc1 lds
    s_mov_b64 exec, -1
L_wo_nc:
    s_cmp_ge_u32 s32, 2
    s_cbranch_scc1 L_wo_a2
    s_mul_i32 m0, s32, 5120
    s_nop 0
    buffer_load_dwordx4 v8, s[40:43], 0 offen lds
    s_addk_i32 m0, 1024
    s_nop 0
    buffer_load_dwordx4 v9, s[40:43], 0 offen lds
    s_addk_i32 m0, 1024
    s_nop 0
    buffer_load_dwordx4 v10, s[40:43], 0 offen lds
    s_addk_i32 m0, 1024
    s_nop 0
    buffer_load_dwordx4 v11, s[40:43], 0 offen lds
    s_addk_i32 m0, 1024
    s_nop 0
    buffer_load_dwordx4 v12, s[40:43], 0 offen lds
    s_mov_b32 s59, 24576
    s_cmp_eq_u32 s32, 1
    s_cselect_b32 s59, 28672, s59
    s_add_u32 m0, s59, 10240
    s_nop 0
    buffer_load_dwordx4 v19, s[48:51], s59 offen offset:0 sc1 lds
    buffer_load_dwordx4 v19, s[48:51], s59 offen offset:1024 sc1 lds
    buffer_load_dwordx4 v19, s[48:51], s59 offen offset:2048 sc1 lds
    buffer_load_dwordx4 v19, s[48:51], s59 offen offset:3072 sc1 lds
    s_waitcnt vmcnt(9)
    s_branch L_wo_a3
L_padb3:
    s_branch L_padb11
L_wo_a2:
    s_mov_b32 s59, 0
    s_cmp_eq_u32 s32, 1
    s_cselect_b32 s59, 0, s59
    s_cmp_eq_u32 s32, 2
    s_cselect_b32 s59, 0, s59
    s_cmp_eq_u32 s32, 3
    s_cselect_b32 s59, 12288, s59
    s_add_u32 m0, s59, 10240
    s_nop 0
    buffer_load_dwordx4 v19, s[48:51], s59 offen offset:0 sc1 lds
    buffer_load_dwordx4 v19, s[48:51], s59 offen offset:1024 sc1 lds
    buffer_load_dwordx4 v19, s[48:51], s59 offen offset:2048 sc1 lds
    buffer_load_dwordx4 v19, s[48:51], s59 offen offset:3072 sc1 lds
    s_addk_i32 m0, 4096
    s_addk_i32 s59, 4096
    buffer_load_dwordx4 v19, s[48:51], s59 offen offset:0 sc1 lds
    buffer_load_dwordx4 v19, s[48:51], s59 offen offset:1024 sc1 lds
    buffer_load_dwordx4 v19, s[48:51], s59 offen offset:2048 sc1 lds
    buffer_load_dwordx4 v19, s[48:51], s59 offen offset:3072 sc1 lds
    s_addk_i32 m0, 4096
    s_addk_i32 s59, 4096
    buffer_load_dwordx4 v19, s[48:51], s59 offen offset:0 sc1 lds
    buffer_load_dwordx4 v19, s[48:51], s59 offen offset:1024 sc1 lds
    buffer_load_dwordx4 v19, s[48:51], s59 offen offset:2048 sc1 lds
    buffer_load_dwordx4 v19, s[48:51], s59 offen offset:3072 sc1 lds
    s_waitcnt vmcnt(12)
L_wo_a3:
    s_barrier
    s_cmp_ge_u32 s32, 2
    s_cbranch_scc1 L_wo_n9
    s_mov_b32 s68, s78
    s_add_u32 s78, s78, 1
    s_cmp_eq_u32 s78, 10
    s_cselect_b32 s78, 0, s78
    s_lshl_b32 s68, s68, 7
    v_add_u32 v15, s64, v18
    v_add_u32 v16, s68, v17
    ds_read_b128 v[24:27], v15
    ds_read_b128 v[28:31], v16
    s_add_u32 s64, s64, 43008
    s_cmp_eq_u32 s64, 129024
    s_cselect_b32 s64, 0, s64
L_wo_n9:
    s_mov_b32 s59, 32768
    s_cmp_eq_u32 s32, 1
    s_cselect_b32 s59, 36864, s59
    s_cmp_eq_u32 s32, 2
    s_cselect_b32 s59, 41984, s59
    s_cmp_eq_u32 s32, 3
    s_cselect_b32 s59, 46080, s59
    s_add_u32 s96, s59, 10240
    v_add_u32 v32, s96, v19
    buffer_load_dwordx4 v[40:43], v19, s[48:51], s59 offen offset:0 sc1
    buffer_load_dwordx4 v[44:47], v19, s[48:51], s59 offen offset:1024 sc1
    buffer_load_dwordx4 v[48:51], v19, s[48:51], s59 offen offset:2048 sc1
    buffer_load_dwordx4 v[52:55], v19, s[48:51], s59 offen offset:3072 sc1
    s_addk_i32 s59, 4096
    buffer_load_dwordx4 v[56:59], v19, s[48:51], s59 offen offset:0 sc1
    s_mov_b32 s59, 51200
    s_cmp_eq_u32 s32, 1
    s_cselect_b32 s59, 63488, s59
    s_cmp_eq_u32 s32, 2
    s_cselect_b32 s59, 76800, s59
    s_cmp_eq_u32 s32, 3
    s_cselect_b32 s59, 89088, s59
    s_add_u32 s96, s59, 10240
    v_add_u32 v33, s96, v19
    buffer_load_dwordx4 v[60:63], v19, s[48:51], s59 offen offset:0 sc1
    buffer_load_dwordx4 v[64:67], v19, s[48:51], s59 offen offset:1024 sc1
    buffer_load_dwordx4 v[68:71], v19, s[48:51], s59 offen offset:2048 sc1
    buffer_load_dwordx4 v[72:75], v19, s[48:51], s59 offen offset:3072 sc1
    s_addk_i32 s59, 4096
    buffer_load_dwordx4 v[76:79], v19, s[48:51], s59 offen offset:0 sc1
    buffer_load_dwordx4 v[80:83], v19, s[48:51], s59 offen offset:1024 sc1
    buffer_load_dwordx4 v[84:87], v19, s[48:51], s59 offen offset:2048 sc1
    buffer_load_dwordx4 v[88:91], v19, s[48:51], s59 offen offset:3072 sc1
    s_addk_i32 s59, 4096
    buffer_load_dwordx4 v[92:95], v19, s[48:51], s59 offen offset:0 sc1
    buffer_load_dwordx4 v[96:99], v19, s[48:51], s59 offen offset:1024 sc1
    buffer_load_dwordx4 v[100:103], v19, s[48:51], s59 offen offset:2048 sc1
    buffer_load_dwordx4 v[104:107], v19, s[48:51], s59 offen offset:3072 sc1
    s_addk_i32 s59, 4096
    buffer_load_dwordx4 v[108:111], v19, s[48:51], s59 offen offset:0 sc1
    s_waitcnt vmcnt(18)
    s_cmp_lt_u32 s32, 2
    s_cbranch_scc1 L_wo_g
    v_mov_b32 v4, 16
    s_mov_b64 exec, 1
    ds_add_u32 v3, v4 offset:268
    s_mov_b64 exec, -1
    s_branch L_wo_ng
L_padb4:
    s_branch L_padb12
L_wo_g:
    s_waitcnt lgkmcnt(0)
    v_mfma_f32_16x16x32_bf16 v[20:23], v[28:31], v[24:27], v[20:23]
    v_lshlrev_b32 v5, 2, v0
    v_add_u32 v5, 161792, v5
    s_cmp_eq_u32 s32, 0
    s_cbranch_scc1 L_wo_g0
    s_nop 3
    ds_write_b32 v5, v20
    v_mov_b32 v4, 1
    ds_write_b32 v3, v4 offset:172
    v_mov_b32 v4, 16
    s_mov_b64 exec, 1
    ds_add_u32 v3, v4 offset:268
    s_mov_b64 exec, -1
    s_branch L_wo_ng
L_wo_g0:
    v_mov_b32 v4, 16
    s_mov_b64 exec, 1
    ds_add_u32 v3, v4 offset:268
    s_mov_b64 exec, -1
    s_mov_b32 s100, 0
Lw_5:
    ds_read_b32 v4, v3 offset:172
    s_waitcnt lgkmcnt(0)
    v_readfirstlane_b32 s99, v4
    s_cmp_ge_u32 s99, 1
    s_cbranch_scc1 Lwd_6
    s_add_u32 s100, s100, 1
    s_cmp_lt_u32 s100, 1048576
    s_cbranch_scc1 Lw_5
Lwd_6:
    ds_read_b32 v21, v5
    s_waitcnt lgkmcnt(0)
    v_add_f32 v20, v20, v21
    v_cvt_pk_bf16_f32 v20, v20, v20
    v_and_b32 v20, 0xffff0000, v20
    v_mul_f32 v20, 0xbfb8aa3b, v20
    v_exp_f32 v20, v20
    s_nop 0
    v_add_f32 v20, 1.0, v20
    v_rcp_f32 v20, v20
    s_nop 0
    v_cvt_pk_bf16_f32 v20, v20, v20
    v_and_b32 v21, 0xffff0000, v20
    v_mov_b32 v20, s33
    s_and_b32 s96, s37, 1
    s_lshl3_add_u32 s96, s96, s38
    s_lshl_b32 s96, s96, 7
    s_mul_i32 s97, s30, 262144
    s_add_u32 s96, s96, s97
    s_add_u32 s96, s96, 7537664
    v_lshl_add_u32 v5, v1, 3, s96
    s_cmp_ge_u32 s38, 8
    s_cbranch_scc1 L_wo_ng
    s_mov_b64 exec, 0xffff
    s_cmp_lg_u32 s91, 1
    s_cbranch_scc1 Ldg_7
    global_store_dwordx2 v5, v[20:21], s[16:17]
    s_branch Ldd_8
Ldg_7:
    global_store_dwordx2 v5, v[20:21], s[16:17] sc1
Ldd_8:
    s_mov_b64 exec, -1
L_wo_ng:
    s_waitcnt vmcnt(0)
    s_cmp_eq_u32 s32, 3
    s_cbranch_scc1 L_help
L_wo_fl:
    s_lshl_b32 s96, s30, 5
    s_add_u32 s96, s96, s31
    s_lshl_b32 s96, s96, 8
    s_add_u32 s96, s96, 65536
    s_lshl3_add_u32 s96, s32, s96
    s_add_u32 s40, s28, s96
    s_addc_u32 s41, s29, 0
    s_mul_i32 s96, s36, 327680
    s_mul_i32 s97, s32, 163840
    s_add_u32 s96, s96, s97
    s_lshl_b32 s97, s35, 7
    s_add_u32 s96, s96, s97
    s_add_u32 s96, s96, 4194304
    v_lshrrev_b32 v126, 3, v0
    v_and_b32 v127, 7, v0
    v_and_b32 v125, 6, v126
    v_xor_b32 v125, v125, v127
    v_lshlrev_b32 v125, 4, v125
    v_lshl_add_u32 v125, v126, 7, v125
    s_mul_i32 s97, s32, 5120
    s_add_u32 s97, s97, 112640
    v_add_u32 v125, s97, v125
    v_lshlrev_b32 v126, 12, v126
    v_lshl_add_u32 v126, v127, 4, v126
    v_add_u32 v120, s96, v126
    v_add_u32 v121, 32768, v120
    v_add_u32 v122, 65536, v120
    v_add_u32 v123, 98304, v120
    v_add_u32 v124, 131072, v120
    s_and_b32 s44, s33, 0xffffff00
    s_add_u32 s44, s44, 0x600
    s_mov_b32 s100, 0
Lw_9:
    ds_read_b32 v4, v3 offset:196
    s_waitcnt lgkmcnt(0)
    v_readfirstlane_b32 s99, v4
    s_cmp_ge_u32 s99, 0
    s_cbranch_scc1 Lwd_10
    s_sleep 2
    s_add_u32 s100, s100, 1
    s_cmp_lt_u32 s100, 1048576
    s_cbranch_scc1 Lw_9
Lwd_10:
    ds_write_b128 v32, v[40:43] offset:0
    ds_write_b128 v32, v[44:47] offset:1024
    ds_write_b128 v32, v[48:51] offset:2048
    ds_write_b128 v32, v[52:55] offset:3072
    s_waitcnt lgkmcnt(4)
    ds_write_b128 v32, v[56:59] offset:4096
    v_mov_b32 v4, 1
    s_mov_b64 exec, 1
    ds_add_u32 v3, v4 offset:200
    s_mov_b64 exec, -1
    s_mov_b32 s100, 0
Lw_11:
    ds_read_b32 v4, v3 offset:196
    s_waitcnt lgkmcnt(0)
    v_readfirstlane_b32 s99, v4
    s_cmp_ge_u32 s99, 8
    s_cbranch_scc1 Lwd_12
    s_sleep 2
    s_add_u32 s100, s100, 1
    s_cmp_lt_u32 s100, 1048576
    s_cbranch_scc1 Lw_11
Lwd_12:
    s_mov_b32 s100, 0
Lw_13:
    ds_read_b32 v4, v3 offset:268
    s_waitcnt lgkmcnt(0)
    v_readfirstlane_b32 s99, v4
    s_cmp_ge_u32 s99, 72
    s_cbranch_scc1 Lwd_14
    s_sleep 1
    s_add_u32 s100, s100, 1
    s_cmp_lt_u32 s100, 1048576
    s_cbranch_scc1 Lw_13
Lwd_14:
    ds_write_b128 v33, v[60:63] offset:0
    ds_write_b128 v33, v[64:67] offset:1024
    ds_write_b128 v33, v[68:71] offset:2048
    ds_write_b128 v33, v[72:75] offset:3072
    s_waitcnt lgkmcnt(4)
    ds_write_b128 v33, v[76:79] offset:4096
    ds_write_b128 v33, v[80:83] offset:5120
    ds_write_b128 v33, v[84:87] offset:6144
    ds_write_b128 v33, v[88:91] offset:7168
    s_waitcnt lgkmcnt(4)
    ds_write_b128 v33, v[92:95] offset:8192
    ds_write_b128 v33, v[96:99] offset:9216
    ds_write_b128 v33, v[100:103] offset:10240
    ds_write_b128 v33, v[104:107] offset:11264
    s_waitcnt lgkmcnt(4)
    ds_write_b128 v33, v[108:111] offset:12288
    v_mov_b32 v4, 1
    s_mov_b64 exec, 1
    ds_add_u32 v3, v4 offset:204
    s_mov_b64 exec, -1
    s_cmp_lt_u32 s32, 2
    s_cbranch_scc1 L_aux
    s_endpgm
L_pada0:
    s_branch L_pada8
L_padb5:
    s_branch L_padb13
L_help:
    s_and_b32 s96, s35, 3
    s_lshl_b32 s96, s96, 9
    s_mul_i32 s97, s30, 262144
    s_add_u32 s96, s96, s97
    s_add_u32 s96, s96, 7537664
    v_lshl_add_u32 v14, v0, 3, s96
    v_lshl_add_u32 v13, v0, 2, v3
    s_mov_b32 s100, 0
L_gchk:
    global_load_dwordx2 v[18:19], v14, s[16:17] sc1
    s_waitcnt vmcnt(0)
    v_cmp_ne_u32 vcc, s33, v18
    s_cbranch_vccz L_gok
    s_sleep 4
    s_add_u32 s100, s100, 1
    s_cmp_lt_u32 s100, 1048576
    s_cbranch_scc1 L_gchk
L_gok:
    v_sub_f32 v18, 1.0, v19
    ds_write_b32 v13, v19 offset:768
    ds_write_b32 v13, v18 offset:512
    v_mov_b32 v4, 1
    s_mov_b64 exec, 1
    ds_add_u32 v3, v4 offset:208
    s_mov_b64 exec, -1
    s_cmp_eq_u32 s34, 0
    s_cbranch_scc1 L_wo_fl
    s_mul_i32 s96, s30, 262144
    s_and_b32 s97, s35, 3
    s_lshl_b32 s97, s97, 8
    s_add_u32 s96, s96, s97
    s_add_u32 s96, s96, 7536640
    v_lshl_add_u32 v12, v0, 2, s96
    s_mov_b32 exec_hi, 1048575
    s_mov_b32 exec_lo, 0xfffff
    s_mov_b32 s100, 0
L_rl1:
    global_load_dword v5, v12, s[16:17] sc1
    s_waitcnt vmcnt(0)
    v_cmp_ne_u32 vcc, s33, v5
    s_cbranch_vccz L_rd1
    s_sleep 2
    s_add_u32 s100, s100, 1
    s_cmp_lt_u32 s100, 1048576
    s_cbranch_scc1 L_rl1
L_rd1:
    s_mov_b64 exec, -1
    v_mov_b32 v4, 1
    ds_write_b32 v3, v4 offset:276
    s_cmp_lg_u32 s2, 176
    s_cbranch_scc1 L_th_exit
L_th_exit:
    s_endpgm
.p2align 12
L_pada1:
    s_branch L_pada9
L_as_nokv:
L_as_kv:
    s_sub_u32 s96, s31, 20
    s_mul_i32 s97, s96, 43
    s_lshr_b32 s97, s97, 7
    s_mul_i32 s98, s96, 7
    s_sub_u32 s98, s98, s97
    s_lshr_b32 s96, 0x924, s96
    s_and_b32 s96, s96, 1
    s_sub_u32 s64, 7, s96
    s_mul_i32 s97, s30, 80
    s_add_u32 s98, s98, s97
    s_add_u32 s56, s98, s32
    s_lshr_b32 s96, s56, 1
    s_lshl_b32 s96, s96, 2
    s_add_u32 s97, s96, 8
    s_min_u32 s97, s97, 1276
    s_load_dword s57, s[14:15], s96
    s_load_dword s58, s[14:15], s97
    s_lshl_b32 s98, s98, 12
    s_add_u32 s80, s12, s98
    s_addc_u32 s81, s13, 0
    s_and_b32 s81, s81, 0xffff
    s_lshl_b32 s82, s64, 12
    s_lshl_b32 s52, s32, 12
    s_add_u32 s53, s52, 16384
    v_lshlrev_b32 v18, 4, v0
    s_setprio 0
    s_waitcnt vmcnt(8)
    buffer_load_dwordx4 v[24:27], v18, s[80:83], s52 offen offset:0
    buffer_load_dwordx4 v[28:31], v18, s[80:83], s52 offen offset:1024
    buffer_load_dwordx4 v[32:35], v18, s[80:83], s52 offen offset:2048
    buffer_load_dwordx4 v[36:39], v18, s[80:83], s52 offen offset:3072
    buffer_load_dwordx4 v[40:43], v18, s[80:83], s53 offen offset:0
    buffer_load_dwordx4 v[44:47], v18, s[80:83], s53 offen offset:1024
    buffer_load_dwordx4 v[48:51], v18, s[80:83], s53 offen offset:2048
    buffer_load_dwordx4 v[52:55], v18, s[80:83], s53 offen offset:3072
    s_setprio 3
    s_waitcnt vmcnt(8) lgkmcnt(0)
    s_barrier
L_hpost:
    s_mul_i32 s33, s33, 1664525
    s_add_u32 s33, s33, 1013904223
    s_mul_i32 s54, s32, 8320
    s_add_u32 s96, s54, 1008
    v_sub_u32 v19, s96, v18
    v_lshl_add_u32 v20, v1, 2, s54
    s_lshl_b32 s96, s32, 2
    v_add_u32 v21, s96, v3
    v_mov_b32 v22, 0
    s_cmp_ge_u32 s38, 5
    s_cbranch_scc1 L_nohello
    s_mov_b32 s100, 0
Lw_15:
    ds_read_b32 v4, v3 offset:256
    s_waitcnt lgkmcnt(0)
    v_readfirstlane_b32 s99, v4
    s_cmp_ge_u32 s99, 8
    s_cbranch_scc1 Lwd_16
    s_sleep 1
    s_add_u32 s100, s100, 1
    s_cmp_lt_u32 s100, 1048576
    s_cbranch_scc1 Lw_15
Lwd_16:
    s_cmp_lg_u32 s32, 3
    s_cbranch_scc1 L_nohello
    s_waitcnt vmcnt(0)
    s_lshl_b32 s96, s30, 5
    s_add_u32 s96, s96, s31
    s_lshl_b32 s96, s96, 8
    s_add_u32 s96, s96, 65536
    v_lshl_add_u32 v4, v0, 3, s96
    v_mov_b32 v6, 0
    s_and_b32 s97, s33, 0xffffff00
    v_mov_b32 v7, s97
    s_getreg_b32 s97, hwreg(HW_REG_XCC_ID, 0, 4)
    v_writelane_b32 v6, s33, 3
    v_writelane_b32 v7, s97, 3
    s_mov_b64 exec, 0xffff
    global_store_dwordx2 v4, v[6:7], s[28:29] sc1
    s_mov_b64 exec, -1
L_nohello:
    s_mov_b32 s98, 0xffff
    s_lshl_b32 s96, s56, 4
    s_lshr_b32 s96, s57, s96
    s_lshl_b32 s96, s96, 16
    s_waitcnt vmcnt(4)
    s_mov_b64 exec, 1
    v_lshlrev_b32 v4, 16, v24
    v_add_f32 v4, s96, v4
    v_cvt_pk_bf16_f32 v4, v4, v4
    v_bfi_b32 v24, s98, v4, v24
    s_mov_b64 exec, -1
    v_readlane_b32 s60, v27, 63
    v_readlane_b32 s61, v31, 63
    v_readlane_b32 s62, v35, 63
    v_mov_b32_dpp v56, v27 wave_shr:1 row_mask:0xf bank_mask:0xf
    v_mov_b32_dpp v57, v31 wave_shr:1 row_mask:0xf bank_mask:0xf
    v_mov_b32_dpp v58, v35 wave_shr:1 row_mask:0xf bank_mask:0xf
    v_mov_b32_dpp v59, v39 wave_shr:1 row_mask:0xf bank_mask:0xf
    v_writelane_b32 v56, 0, 0
    v_writelane_b32 v57, s60, 0
    v_writelane_b32 v58, s61, 0
    v_writelane_b32 v59, s62, 0
    v_alignbit_b32 v60, v27, v27, 16
    v_bfi_b32 v76, s98, v27, v26
    v_alignbit_b32 v61, v26, v26, 16
    v_bfi_b32 v77, s98, v26, v25
    v_alignbit_b32 v62, v25, v25, 16
    v_bfi_b32 v78, s98, v25, v24
    v_alignbit_b32 v63, v24, v24, 16
    v_bfi_b32 v79, s98, v24, v56
    ds_write_b128 v19, v[60:63] offset:3072
    ds_write_b128 v19, v[76:79] offset:7232
    v_alignbit_b32 v64, v31, v31, 16
    v_bfi_b32 v80, s98, v31, v30
    v_alignbit_b32 v65, v30, v30, 16
    v_bfi_b32 v81, s98, v30, v29
    v_alignbit_b32 v66, v29, v29, 16
    v_bfi_b32 v82, s98, v29, v28
    v_alignbit_b32 v67, v28, v28, 16
    v_bfi_b32 v83, s98, v28, v57
    ds_write_b128 v19, v[64:67] offset:2048
    ds_write_b128 v19, v[80:83] offset:6208
    v_alignbit_b32 v68, v35, v35, 16
    v_bfi_b32 v84, s98, v35, v34
    v_alignbit_b32 v69, v34, v34, 16
    v_bfi_b32 v85, s98, v34, v33
    v_alignbit_b32 v70, v33, v33, 16
    v_bfi_b32 v86, s98, v33, v32
    v_alignbit_b32 v71, v32, v32, 16
    v_bfi_b32 v87, s98, v32, v58
    ds_write_b128 v19, v[68:71] offset:1024
    ds_write_b128 v19, v[84:87] offset:5184
    v_alignbit_b32 v72, v39, v39, 16
    v_bfi_b32 v88, s98, v39, v38
    v_alignbit_b32 v73, v38, v38, 16
    v_bfi_b32 v89, s98, v38, v37
    v_alignbit_b32 v74, v37, v37, 16
    v_bfi_b32 v90, s98, v37, v36
    v_alignbit_b32 v75, v36, v36, 16
    v_bfi_b32 v91, s98, v36, v59
    ds_write_b128 v19, v[72:75] offset:0
    ds_write_b128 v19, v[88:91] offset:4160
    ds_write_b32 v20, v22 offset:4096
    ds_write_b32 v20, v22 offset:8256
    v_mov_b32 v4, 1
    ds_write_b32 v21, v4 offset:312
    s_waitcnt lgkmcnt(0)
    s_add_u32 s96, s32, 4
    s_cmp_ge_u32 s96, s64
    s_cbranch_scc1 L_hb1
    s_lshl_b32 s96, s56, 4
    s_lshr_b32 s96, s58, s96
    s_lshl_b32 s96, s96, 16
    s_waitcnt vmcnt(0)
    s_mov_b64 exec, 1
    v_lshlrev_b32 v4, 16, v40
    v_add_f32 v4, s96, v4
    v_cvt_pk_bf16_f32 v4, v4, v4
    v_bfi_b32 v40, s98, v4, v40
    s_mov_b64 exec, -1
    v_readlane_b32 s60, v43, 63
    v_readlane_b32 s61, v47, 63
    v_readlane_b32 s62, v51, 63
    v_mov_b32_dpp v56, v43 wave_shr:1 row_mask:0xf bank_mask:0xf
    v_mov_b32_dpp v57, v47 wave_shr:1 row_mask:0xf bank_mask:0xf
    v_mov_b32_dpp v58, v51 wave_shr:1 row_mask:0xf bank_mask:0xf
    v_mov_b32_dpp v59, v55 wave_shr:1 row_mask:0xf bank_mask:0xf
    v_writelane_b32 v56, 0, 0
    v_writelane_b32 v57, s60, 0
    v_writelane_b32 v58, s61, 0
    v_writelane_b32 v59, s62, 0
    v_alignbit_b32 v60, v43, v43, 16
    v_bfi_b32 v76, s98, v43, v42
    v_alignbit_b32 v61, v42, v42, 16
    v_bfi_b32 v77, s98, v42, v41
    v_alignbit_b32 v62, v41, v41, 16
    v_bfi_b32 v78, s98, v41, v40
    v_alignbit_b32 v63, v40, v40, 16
    v_bfi_b32 v79, s98, v40, v56
    ds_write_b128 v19, v[60:63] offset:36352
    ds_write_b128 v19, v[76:79] offset:40512
    v_alignbit_b32 v64, v47, v47, 16
    v_bfi_b32 v80, s98, v47, v46
    v_alignbit_b32 v65, v46, v46, 16
    v_bfi_b32 v81, s98, v46, v45
    v_alignbit_b32 v66, v45, v45, 16
    v_bfi_b32 v82, s98, v45, v44
    v_alignbit_b32 v67, v44, v44, 16
    v_bfi_b32 v83, s98, v44, v57
    ds_write_b128 v19, v[64:67] offset:35328
    ds_write_b128 v19, v[80:83] offset:39488
    v_alignbit_b32 v68, v51, v51, 16
    v_bfi_b32 v84, s98, v51, v50
    v_alignbit_b32 v69, v50, v50, 16
    v_bfi_b32 v85, s98, v50, v49
    v_alignbit_b32 v70, v49, v49, 16
    v_bfi_b32 v86, s98, v49, v48
    v_alignbit_b32 v71, v48, v48, 16
    v_bfi_b32 v87, s98, v48, v58
    ds_write_b128 v19, v[68:71] offset:34304
    ds_write_b128 v19, v[84:87] offset:38464
    v_alignbit_b32 v72, v55, v55, 16
    v_bfi_b32 v88, s98, v55, v54
    v_alignbit_b32 v73, v54, v54, 16
    v_bfi_b32 v89, s98, v54, v53
    v_alignbit_b32 v74, v53, v53, 16
    v_bfi_b32 v90, s98, v53, v52
    v_alignbit_b32 v75, v52, v52, 16
    v_bfi_b32 v91, s98, v52, v59
    ds_write_b128 v19, v[72:75] offset:33280
    ds_write_b128 v19, v[88:91] offset:37440
    ds_write_b32 v20, v22 offset:37376
    ds_write_b32 v20, v22 offset:41536
    v_mov_b32 v4, 1
    ds_write_b32 v21, v4 offset:328
    s_waitcnt lgkmcnt(0)
L_hb1:
    s_cmp_eq_u32 s32, 3
    s_cbranch_scc1 L_ahelp
    s_setprio 1
    s_mul_i32 s96, s36, 102400
    s_add_u32 s96, s96, 9437184
    s_add_u32 s48, s28, s96
    s_addc_u32 s49, s29, 0
    s_and_b32 s49, s49, 0xffff
    s_mov_b32 s50, 102400
    s_mov_b32 s51, 0x00020000
    v_lshlrev_b32 v19, 4, v0
    s_lshl1_add_u32 s96, s35, s32
    s_mul_i32 s96, s96, 40960
    s_mul_i32 s97, s36, 160
    s_add_u32 s96, s96, s97
    v_add_u32 v4, 0, v0
    v_mul_u32_u24 v8, 6554, v4
    v_lshrrev_b32 v8, 16, v8
    v_mul_u32_u24 v8, 1120, v8
    v_lshl_add_u32 v4, v4, 4, s96
    v_add_u32 v8, v8, v4
    v_add_u32 v4, 64, v0
    v_mul_u32_u24 v9, 6554, v4
    v_lshrrev_b32 v9, 16, v9
    v_mul_u32_u24 v9, 1120, v9
    v_lshl_add_u32 v4, v4, 4, s96
    v_add_u32 v9, v9, v4
    v_add_u32 v4, 128, v0
    v_mul_u32_u24 v10, 6554, v4
    v_lshrrev_b32 v10, 16, v10
    v_mul_u32_u24 v10, 1120, v10
    v_lshl_add_u32 v4, v4, 4, s96
    v_add_u32 v10, v10, v4
    v_add_u32 v4, 192, v0
    v_mul_u32_u24 v11, 6554, v4
    v_lshrrev_b32 v11, 16, v11
    v_mul_u32_u24 v11, 1120, v11
    v_lshl_add_u32 v4, v4, 4, s96
    v_add_u32 v11, v11, v4
    v_add_u32 v4, 256, v0
    v_mul_u32_u24 v12, 6554, v4
    v_lshrrev_b32 v12, 16, v12
    v_mul_u32_u24 v12, 1120, v12
    v_lshl_add_u32 v4, v4, 4, s96
    v_add_u32 v12, v12, v4
    s_mul_i32 s96, s32, 5120
    s_add_u32 s96, s96, 48128
    v_add_u32 v21, s96, v19
    s_mul_i32 s59, s32, 15360
    s_add_u32 s96, s59, 58368
    v_add_u32 v20, s96, v19
    s_add_u32 s60, s59, 51200
    s_setprio 3
    s_mov_b32 s100, 0
Lw_17:
    ds_read_b32 v4, v3 offset:280
    s_waitcnt lgkmcnt(0)
    v_readfirstlane_b32 s99, v4
    s_cmp_ge_u32 s99, 8
    s_cbranch_scc1 Lwd_18
    s_sleep 4
    s_add_u32 s100, s100, 1
    s_cmp_lt_u32 s100, 1048576
    s_cbranch_scc1 Lw_17
Lwd_18:
    s_mov_b32 s100, 0
Lw_19:
    ds_read_b32 v4, v3 offset:192
    s_waitcnt lgkmcnt(0)
    v_readfirstlane_b32 s99, v4
    s_cmp_ge_u32 s99, 1
    s_cbranch_scc1 Lwd_20
    s_sleep 2
    s_add_u32 s100, s100, 1
    s_cmp_lt_u32 s100, 1048576
    s_cbranch_scc1 Lw_19
Lwd_20:
    s_mov_b32 s59, 0
    s_cmp_eq_u32 s32, 1
    s_cselect_b32 s59, 17408, s59
    s_cmp_eq_u32 s32, 2
    s_cselect_b32 s59, 33792, s59
    s_add_u32 m0, s59, 109568
    s_nop 0
    buffer_load_dwordx4 v19, s[48:51], s59 offen offset:0 sc1 lds
    s_waitcnt vmcnt(3)
    buffer_load_dwordx4 v19, s[48:51], s59 offen offset:1024 sc1 lds
    s_waitcnt vmcnt(3)
    buffer_load_dwordx4 v19, s[48:51], s59 offen offset:2048 sc1 lds
    s_waitcnt vmcnt(3)
    buffer_load_dwordx4 v19, s[48:51], s59 offen offset:3072 sc1 lds
    s_addk_i32 m0, 4096
    s_addk_i32 s59, 4096
    s_waitcnt vmcnt(3)
    buffer_load_dwordx4 v19, s[48:51], s59 offen offset:0 sc1 lds
    s_waitcnt vmcnt(3)
    buffer_load_dwordx4 v19, s[48:51], s59 offen offset:1024 sc1 lds
    s_waitcnt vmcnt(3)
    buffer_load_dwordx4 v19, s[48:51], s59 offen offset:2048 sc1 lds
    s_waitcnt vmcnt(3)
    buffer_load_dwordx4 v19, s[48:51], s59 offen offset:3072 sc1 lds
    s_addk_i32 m0, 4096
    s_addk_i32 s59, 4096
    s_waitcnt vmcnt(3)
    buffer_load_dwordx4 v19, s[48:51], s59 offen offset:0 sc1 lds
    s_waitcnt vmcnt(3)
    buffer_load_dwordx4 v19, s[48:51], s59 offen offset:1024 sc1 lds
    s_waitcnt vmcnt(3)
    buffer_load_dwordx4 v19, s[48:51], s59 offen offset:2048 sc1 lds
    s_waitcnt vmcnt(3)
    buffer_load_dwordx4 v19, s[48:51], s59 offen offset:3072 sc1 lds
    s_addk_i32 m0, 4096
    s_addk_i32 s59, 4096
    s_waitcnt vmcnt(3)
    buffer_load_dwordx4 v19, s[48:51], s59 offen offset:0 sc1 lds
    s_waitcnt vmcnt(3)
    buffer_load_dwordx4 v19, s[48:51], s59 offen offset:1024 sc1 lds
    s_waitcnt vmcnt(3)
    buffer_load_dwordx4 v19, s[48:51], s59 offen offset:2048 sc1 lds
    s_waitcnt vmcnt(3)
    buffer_load_dwordx4 v19, s[48:51], s59 offen offset:3072 sc1 lds
    s_addk_i32 m0, 4096
    s_addk_i32 s59, 4096
    s_waitcnt vmcnt(3)
    buffer_load_dwordx4 v19, s[48:51], s59 offen offset:0 sc1 lds
    s_waitcnt vmcnt(3)
    s_mov_b32 s59, s60
    buffer_load_dwordx4 v[24:27], v19, s[48:51], s59 offen offset:0 sc1
    buffer_load_dwordx4 v[28:31], v19, s[48:51], s59 offen offset:1024 sc1
    buffer_load_dwordx4 v[32:35], v19, s[48:51], s59 offen offset:2048 sc1
    buffer_load_dwordx4 v[36:39], v19, s[48:51], s59 offen offset:3072 sc1
    s_addk_i32 s59, 4096
    buffer_load_dwordx4 v[40:43], v19, s[48:51], s59 offen offset:0 sc1
    buffer_load_dwordx4 v[44:47], v19, s[48:51], s59 offen offset:1024 sc1
    buffer_load_dwordx4 v[48:51], v19, s[48:51], s59 offen offset:2048 sc1
    buffer_load_dwordx4 v[52:55], v19, s[48:51], s59 offen offset:3072 sc1
    s_addk_i32 s59, 4096
    buffer_load_dwordx4 v[56:59], v19, s[48:51], s59 offen offset:0 sc1
    buffer_load_dwordx4 v[60:63], v19, s[48:51], s59 offen offset:1024 sc1
    buffer_load_dwordx4 v[64:67], v19, s[48:51], s59 offen offset:2048 sc1
    buffer_load_dwordx4 v[68:71], v19, s[48:51], s59 offen offset:3072 sc1
    s_addk_i32 s59, 4096
    buffer_load_dwordx4 v[72:75], v19, s[48:51], s59 offen offset:0 sc1
    buffer_load_dwordx4 v[76:79], v19, s[48:51], s59 offen offset:1024 sc1
    buffer_load_dwordx4 v[80:83], v19, s[48:51], s59 offen offset:2048 sc1
    s_cmp_lt_u32 s32, 2
    s_cbranch_scc1 L_ai_x
    s_addk_i32 s59, 3072
    buffer_load_dwordx4 v[84:87], v19, s[48:51], s59 offen offset:0 sc1
    buffer_load_dwordx4 v[88:91], v19, s[48:51], s59 offen offset:1024 sc1
    buffer_load_dwordx4 v[92:95], v19, s[48:51], s59 offen offset:2048 sc1
    buffer_load_dwordx4 v[96:99], v19, s[48:51], s59 offen offset:3072 sc1
    s_addk_i32 s59, 4096
    buffer_load_dwordx4 v[100:103], v19, s[48:51], s59 offen offset:0 sc1
    v_add_u32 v21, 15360, v20
    s_branch L_ai_d
L_pada2:
    s_branch L_pada10
L_ai_x:
    global_load_dwordx4 v[84:87], v8, s[4:5]
    global_load_dwordx4 v[88:91], v9, s[4:5]
    global_load_dwordx4 v[92:95], v10, s[4:5]
    global_load_dwordx4 v[96:99], v11, s[4:5]
    global_load_dwordx4 v[100:103], v12, s[4:5]
L_ai_d:
    s_waitcnt vmcnt(0)
    v_mov_b32 v4, 1
    s_mov_b64 exec, 1
    ds_add_u32 v3, v4 offset:200
    s_mov_b64 exec, -1
    s_lshl_b32 s96, s30, 5
    s_add_u32 s96, s96, s31
    s_lshl_b32 s96, s96, 8
    s_add_u32 s96, s96, 65536
    s_lshl3_add_u32 s96, s32, s96
    s_add_u32 s40, s28, s96
    s_addc_u32 s41, s29, 0
    s_mul_i32 s96, s36, 327680
    s_mul_i32 s97, s32, 163840
    s_add_u32 s96, s96, s97
    s_lshl_b32 s97, s35, 7
    s_add_u32 s96, s96, s97
    s_add_u32 s96, s96, 4194304
    v_lshrrev_b32 v126, 3, v0
    v_and_b32 v127, 7, v0
    v_and_b32 v125, 6, v126
    v_xor_b32 v125, v125, v127
    v_lshlrev_b32 v125, 4, v125
    v_lshl_add_u32 v125, v126, 7, v125
    s_mul_i32 s97, s32, 5120
    s_add_u32 s97, s97, 0
    v_add_u32 v125, s97, v125
    v_lshlrev_b32 v126, 12, v126
    v_lshl_add_u32 v126, v127, 4, v126
    v_add_u32 v120, s96, v126
    v_add_u32 v121, 32768, v120
    v_add_u32 v122, 65536, v120
    v_add_u32 v123, 98304, v120
    v_add_u32 v124, 131072, v120
    s_and_b32 s44, s33, 0xffffff00
    s_add_u32 s44, s44, 0x600
    s_mov_b32 s100, 0
Lw_21:
    ds_read_b32 v4, v3 offset:304
    s_waitcnt lgkmcnt(0)
    v_readfirstlane_b32 s99, v4
    s_cmp_ge_u32 s99, 1
    s_cbranch_scc1 Lwd_22
    s_sleep 8
    s_add_u32 s100, s100, 1
    s_cmp_lt_u32 s100, 1048576
    s_cbranch_scc1 Lw_21
Lwd_22:
    s_mov_b32 s100, 0
Lw_23:
    ds_read_b32 v4, v3 offset:196
    s_waitcnt lgkmcnt(0)
    v_readfirstlane_b32 s99, v4
    s_cmp_ge_u32 s99, 8
    s_cbranch_scc1 Lwd_24
    s_sleep 1
    s_add_u32 s100, s100, 1
    s_cmp_lt_u32 s100, 1048576
    s_cbranch_scc1 Lw_23
Lwd_24:
    ds_write_b128 v21, v[84:87] offset:0
    ds_write_b128 v21, v[88:91] offset:1024
    ds_write_b128 v21, v[92:95] offset:2048
    ds_write_b128 v21, v[96:99] offset:3072
    s_waitcnt lgkmcnt(4)
    ds_write_b128 v21, v[100:103] offset:4096
    s_lshr_b32 s96, s32, 1
    s_xor_b32 s96, s96, 1
    v_mov_b32 v4, s96
    s_mov_b64 exec, 1
    ds_add_u32 v3, v4 offset:376
    s_mov_b64 exec, -1
    s_setprio 0
    ds_write_b128 v20, v[24:27] offset:0
    ds_write_b128 v20, v[28:31] offset:1024
    ds_write_b128 v20, v[32:35] offset:2048
    ds_write_b128 v20, v[36:39] offset:3072
    s_waitcnt lgkmcnt(4)
    ds_write_b128 v20, v[40:43] offset:4096
    ds_write_b128 v20, v[44:47] offset:5120
    ds_write_b128 v20, v[48:51] offset:6144
    ds_write_b128 v20, v[52:55] offset:7168
    s_waitcnt lgkmcnt(4)
    ds_write_b128 v20, v[56:59] offset:8192
    ds_write_b128 v20, v[60:63] offset:9216
    ds_write_b128 v20, v[64:67] offset:10240
    ds_write_b128 v20, v[68:71] offset:11264
    s_waitcnt lgkmcnt(4)
    ds_write_b128 v20, v[72:75] offset:12288
    ds_write_b128 v20, v[76:79] offset:13312
    ds_write_b128 v20, v[80:83] offset:14336
    s_setprio 3
    v_mov_b32 v4, 1
    s_mov_b64 exec, 1
    ds_add_u32 v3, v4 offset:204
    s_mov_b64 exec, -1
    s_cmp_lt_u32 s32, 2
    s_cbranch_scc1 L_aux
    s_endpgm
L_pada3:
    s_branch L_pada11
L_ahelp:
    v_lshlrev_b32 v4, 2, v0
    v_add_u32 v4, 161792, v4
    v_mov_b32 v5, 0
    ds_write_b32 v4, v5
    s_cmp_lt_u32 s38, 5
    s_cbranch_scc1 L_hell2
    s_mov_b32 s100, 0
Lw_25:
    ds_read_b32 v4, v3 offset:256
    s_waitcnt lgkmcnt(0)
    v_readfirstlane_b32 s99, v4
    s_cmp_ge_u32 s99, 8
    s_cbranch_scc1 Lwd_26
    s_sleep 1
    s_add_u32 s100, s100, 1
    s_cmp_lt_u32 s100, 1048576
    s_cbranch_scc1 Lw_25
Lwd_26:
    s_lshl_b32 s96, s30, 5
    s_add_u32 s96, s96, s31
    s_lshl_b32 s96, s96, 8
    s_add_u32 s96, s96, 65536
    v_lshl_add_u32 v4, v0, 3, s96
    v_mov_b32 v6, 0
    s_and_b32 s97, s33, 0xffffff00
    v_mov_b32 v7, s97
    s_getreg_b32 s97, hwreg(HW_REG_XCC_ID, 0, 4)
    v_writelane_b32 v6, s33, 3
    v_writelane_b32 v7, s97, 3
    s_mov_b64 exec, 0xffff
    global_store_dwordx2 v4, v[6:7], s[28:29] sc1
    s_mov_b64 exec, -1
L_hell2:
    s_cmp_lg_u32 s31, 22
    s_cbranch_scc1 L_nocen
    s_mov_b32 s100, 0
Lw_27:
    ds_read_b32 v4, v3 offset:280
    s_waitcnt lgkmcnt(0)
    v_readfirstlane_b32 s99, v4
    s_cmp_ge_u32 s99, 4
    s_cbranch_scc1 Lwd_28
    s_sleep 2
    s_add_u32 s100, s100, 1
    s_cmp_lt_u32 s100, 1048576
    s_cbranch_scc1 Lw_27
Lwd_28:
    s_lshl_b32 s96, s30, 13
    s_add_u32 s96, s96, 65536
    v_and_b32 v4, 31, v0
    v_lshl_add_u32 v20, v4, 8, s96
    v_and_b32 v4, 7, v0
    v_bfe_u32 v5, v0, 3, 1
    v_lshl_add_u32 v4, v4, 5, v5
    v_lshlrev_b32 v4, 8, v4
    s_mov_b32 exec_lo, 0
    v_add_u32 v20, 73216, v4
    s_mov_b32 exec_lo, -1
    v_mov_b32 v24, 0
    v_mov_b32 v25, 0
    s_mov_b32 s60, -1
    s_mov_b32 s61, 0xffff
    s_mov_b64 exec, s[60:61]
    s_mov_b32 s100, 0
L_hpg:
    global_atomic_or_x2 v[26:27], v20, v[24:25], s[28:29] offset:24 sc0 sc1
    s_waitcnt vmcnt(0)
    v_cmp_ne_u32 vcc, s33, v26
    s_cbranch_vccz L_hdg
    s_mov_b64 exec, vcc
    s_sleep 2
    s_add_u32 s100, s100, 1
    s_cmp_lt_u32 s100, 1048576
    s_cbranch_scc1 L_hpg
L_hdg:
    s_mov_b64 exec, -1
    v_readfirstlane_b32 s96, v27
    s_nop 1
    v_cmp_ne_u32 vcc, s96, v27
    s_cmp_eq_u32 vcc_lo, 0
    s_cselect_b32 s96, 1, 2
    v_mov_b32 v22, s33
    v_mov_b32 v23, s96
    s_mov_b64 exec, 0xffffffff
    global_store_dwordx2 v20, v[22:23], s[28:29] offset:136 sc1
    s_mov_b64 exec, -1
L_nocen:
    s_sub_u32 s52, s31, 20
    s_mul_i32 s96, s30, 262144
    s_mul_i32 s97, s52, 384
    s_add_u32 s96, s96, s97
    s_add_u32 s53, s96, 7536640
    s_mul_i32 s96, s30, 327680
    s_mul_i32 s97, s52, 27392
    s_min_u32 s97, s97, 300288
    s_add_u32 s96, s96, s97
    s_add_u32 s54, s96, 0
    s_mul_i32 s55, s36, 102400
    s_add_u32 s55, s55, 9437184
    v_lshlrev_b32 v15, 7, v0
    s_mov_b32 s44, s28
    s_and_b32 s45, s29, 0xffff
    s_mov_b32 s46, 16777216
    s_mov_b32 s47, 0x00020000
    s_mov_b32 s100, 0
Lw_29:
    ds_read_b32 v4, v3 offset:280
    s_waitcnt lgkmcnt(0)
    v_readfirstlane_b32 s99, v4
    s_cmp_ge_u32 s99, 8
    s_cbranch_scc1 Lwd_30
    s_sleep 2
    s_add_u32 s100, s100, 1
    s_cmp_lt_u32 s100, 1048576
    s_cbranch_scc1 Lw_29
Lwd_30:
    s_mov_b64 exec, 0x7
    buffer_load_dword v18, v15, s[44:47], s53 offen sc1
    s_add_u32 s53, s53, 8192
    s_mov_b64 exec, -1
    s_mov_b32 s40, s24
    s_and_b32 s41, s25, 0xffff
    s_mov_b32 s42, 2621440
    s_mov_b32 s43, 0x00020000
    buffer_load_dword v18, v15, s[40:43], s54 offen sc1
    s_add_u32 s54, s54, 8192
    buffer_load_dword v18, v15, s[40:43], s54 offen sc1
    s_add_u32 s54, s54, 8192
    buffer_load_dword v18, v15, s[40:43], s54 offen sc1
    s_add_u32 s54, s54, 8192
    s_mov_b64 exec, 0x3fffff
    buffer_load_dword v18, v15, s[40:43], s54 offen sc1
    s_add_u32 s54, s54, 8192
    s_mov_b64 exec, -1
    s_lshl_b32 s98, s30, 5
    s_add_u32 s98, s98, s31
    s_lshl_b32 s98, s98, 8
    s_add_u32 s98, s98, 65536
    s_add_u32 s98, s98, 128
    s_mov_b32 s100, 0
Lc_31:
    s_load_dwordx4 s[88:91], s[28:29], s98 glc
    s_waitcnt lgkmcnt(0)
    s_cmp_eq_u32 s90, s33
    s_cbranch_scc1 Lcd_32
    s_sleep 2
    s_add_u32 s100, s100, 1
    s_cmp_lt_u32 s100, 1048576
    s_cbranch_scc1 Lc_31
    s_mov_b32 s91, 2
Lcd_32:
    s_cmp_eq_u32 s91, 1
    s_cselect_b32 s99, 0, 15728640
    s_add_u32 s16, s28, s99
    s_addc_u32 s17, s29, 0
    v_mov_b32 v4, s91
    ds_write_b32 v3, v4 offset:192
    s_waitcnt vmcnt(0)
    v_mov_b32 v4, 1
    ds_write_b32 v3, v4 offset:248
    v_mov_b32 v4, 1
    s_mov_b64 exec, 1
    ds_add_u32 v3, v4 offset:200
    s_mov_b64 exec, -1
    v_mov_b32 v4, 1
    s_mov_b64 exec, 1
    ds_add_u32 v3, v4 offset:204
    s_mov_b64 exec, -1
    s_cmp_lg_u32 s2, 176
    s_cbranch_scc1 L_noep
    v_lshlrev_b32 v20, 8, v0
    v_add_u32 v20, 65536, v20
    v_mov_b32 v24, 0
    v_mov_b32 v25, 0
    s_mov_b32 s52, 0
L_epl:
    s_mov_b64 exec, -1
    s_mov_b32 s100, 0
L_hpe:
    global_atomic_or_x2 v[26:27], v20, v[24:25], s[28:29] offset:24 sc0 sc1
    s_waitcnt vmcnt(0)
    v_cmp_ne_u32 vcc, s33, v26
    s_cbranch_vccz L_hde
    s_mov_b64 exec, vcc
    s_sleep 8
    s_add_u32 s100, s100, 1
    s_cmp_lt_u32 s100, 1048576
    s_cbranch_scc1 L_hpe
L_hde:
    s_mov_b64 exec, -1
    v_add_u32 v20, 0x4000, v20
    s_add_u32 s52, s52, 1
    s_cmp_lt_u32 s52, 4
    s_cbranch_scc1 L_epl
    v_mov_b32 v4, 0
    v_mov_b32 v5, s33
    s_mov_b64 exec, 1
    global_store_dword v4, v5, s[28:29] sc1
    s_mov_b64 exec, -1
L_noep:
    s_mov_b32 s100, 0
Lw_33:
    ds_read_b32 v4, v3 offset:304
    s_waitcnt lgkmcnt(0)
    v_readfirstlane_b32 s99, v4
    s_cmp_ge_u32 s99, 1
    s_cbranch_scc1 Lwd_34
    s_sleep 8
    s_add_u32 s100, s100, 1
    s_cmp_lt_u32 s100, 1048576
    s_cbranch_scc1 Lw_33
Lwd_34:
    s_branch L_help
.p2align 12
L_pada4:
    s_branch L_pada12
L_padb6:
    s_branch L_padb14
L_aux:
    s_mov_b32 s100, 0
L_yp:
    s_load_dwordx2 s[42:43], s[40:41], 0 glc
    s_waitcnt lgkmcnt(0)
    s_and_b32 s43, s43, 0xffffff00
    s_cmp_eq_u32 s43, s44
    s_cbranch_scc1 L_ypd
    s_sleep 1
    s_add_u32 s100, s100, 1
    s_cmp_lt_u32 s100, 1048576
    s_cbranch_scc1 L_yp
L_ypd:
    s_mov_b32 s100, 0
L_yretry:
    global_load_dwordx4 v[128:131], v120, s[28:29] sc1
    global_load_dwordx4 v[132:135], v121, s[28:29] sc1
    global_load_dwordx4 v[136:139], v122, s[28:29] sc1
    global_load_dwordx4 v[140:143], v123, s[28:29] sc1
    global_load_dwordx4 v[144:147], v124, s[28:29] sc1
    v_mov_b32 v16, 0
    s_waitcnt vmcnt(4)
    ds_write_b128 v125, v[128:131] offset:0
    v_add3_u32 v16, v16, v128, v129
    v_add3_u32 v16, v16, v130, v131
    s_waitcnt vmcnt(3)
    ds_write_b128 v125, v[132:135] offset:1024
    v_add3_u32 v16, v16, v132, v133
    v_add3_u32 v16, v16, v134, v135
    s_waitcnt vmcnt(2)
    ds_write_b128 v125, v[136:139] offset:2048
    v_add3_u32 v16, v16, v136, v137
    v_add3_u32 v16, v16, v138, v139
    s_waitcnt vmcnt(1)
    ds_write_b128 v125, v[140:143] offset:3072
    v_add3_u32 v16, v16, v140, v141
    v_add3_u32 v16, v16, v142, v143
    s_waitcnt vmcnt(0)
    ds_write_b128 v125, v[144:147] offset:4096
    v_add3_u32 v16, v16, v144, v145
    v_add3_u32 v16, v16, v146, v147
    s_nop 1
    v_add_u32_dpp v16, v16, v16 row_ror:8 row_mask:0xf bank_mask:0xf
    s_nop 1
    v_add_u32_dpp v16, v16, v16 row_ror:4 row_mask:0xf bank_mask:0xf
    s_nop 1
    v_add_u32_dpp v16, v16, v16 row_ror:2 row_mask:0xf bank_mask:0xf
    s_nop 1
    v_add_u32_dpp v16, v16, v16 row_ror:1 row_mask:0xf bank_mask:0xf
    s_nop 0
    v_readlane_b32 s96, v16, 0
    v_readlane_b32 s97, v16, 16
    v_readlane_b32 s98, v16, 32
    v_readlane_b32 s99, v16, 48
    s_add_u32 s96, s96, s97
    s_add_u32 s98, s98, s99
    s_add_u32 s96, s96, s98
    s_cmp_eq_u32 s96, s42
    s_cbranch_scc1 L_yok
    s_sleep 2
    s_add_u32 s100, s100, 1
    s_cmp_lt_u32 s100, 1048576
    s_cbranch_scc1 L_yretry
L_yok:
    v_mov_b32 v4, 1
    s_mov_b64 exec, 1
    ds_add_u32 v3, v4 offset:212
    s_mov_b64 exec, -1
    s_endpgm
L_compute:
    s_waitcnt lgkmcnt(0)
    s_load_dword s33, s[28:29], 0
    s_setprio 2
    s_sub_u32 s40, s32, 4
    s_lshr_b32 s42, s40, 2
    s_and_b32 s56, s40, 3
    s_xor_b32 s41, s56, s42
    s_sub_u32 s46, s38, 5
    s_cselect_b32 s46, s38, s46
    s_mov_b32 s96, 0xf9af5600
    s_mov_b32 s45, 0x886f5f4f
    s_cmp_eq_u32 s46, 1
    s_cselect_b32 s96, 0xfeab5500, s96
    s_cselect_b32 s45, 0x8c5f4f8f, s45
    s_cmp_eq_u32 s46, 2
    s_cselect_b32 s96, 0xffaa5500, s96
    s_cselect_b32 s45, 0x8e4f3f87, s45
    s_cmp_eq_u32 s46, 3
    s_cselect_b32 s96, 0xffaa1540, s96
    s_cselect_b32 s45, 0x8f3f2f83, s45
    s_cmp_eq_u32 s46, 4
    s_cselect_b32 s96, 0xff6a0590, s96
    s_cselect_b32 s45, 0x3f2f1f81, s45
    s_lshl_b32 s97, s41, 3
    s_lshr_b32 s96, s96, s97
    s_lshr_b32 s45, s45, s97
    s_and_b32 s45, s45, 0xff
    v_lshrrev_b32 v5, 1, v1
    v_xor_b32 v5, v5, v2
    v_lshlrev_b32 v5, 4, v5
    v_lshl_add_u32 v132, v1, 7, v5
    s_lshl_b32 s97, s42, 13
    v_add_u32 v132, s97, v132
    v_and_b32 v4, 3, v0
    v_lshlrev_b32 v5, 1, v4
    v_bfe_u32 v5, s96, v5, 2
    v_bfe_u32 v6, v0, 3, 2
    v_xor_b32 v5, v5, v6
    v_lshl_add_u32 v5, v5, 2, v4
    v_bfe_u32 v6, v0, 2, 2
    v_mad_u32_u24 v6, v2, 24, v6
    v_lshlrev_b32 v6, 7, v6
    v_lshl_add_u32 v133, v5, 3, v6
    v_add_u32 v133, 18432, v133
    v_mov_b32 v8, 0
    v_mov_b32 v9, 0
    v_mov_b32 v10, 0
    v_mov_b32 v11, 0
    v_mov_b32 v12, 0
    v_mov_b32 v13, 0
    v_mov_b32 v14, 0
    v_mov_b32 v15, 0
    v_mov_b32 v16, 0
    v_mov_b32 v17, 0
    v_mov_b32 v18, 0
    v_mov_b32 v19, 0
    v_mov_b32 v20, 0
    v_mov_b32 v21, 0
    v_mov_b32 v22, 0
    v_mov_b32 v23, 0
    v_mov_b32 v24, 0
    v_mov_b32 v25, 0
    v_mov_b32 v26, 0
    v_mov_b32 v27, 0
    v_mov_b32 v28, 0
    v_mov_b32 v29, 0
    v_mov_b32 v30, 0
    v_mov_b32 v31, 0
    v_mov_b32 v32, 0
    v_mov_b32 v33, 0
    v_mov_b32 v34, 0
    v_mov_b32 v35, 0
    v_mov_b32 v36, 0
    v_mov_b32 v37, 0
    v_mov_b32 v38, 0
    v_mov_b32 v39, 0
    v_mov_b32 v40, 0
    v_mov_b32 v41, 0
    v_mov_b32 v42, 0
    v_mov_b32 v43, 0
    v_mov_b32 v44, 0
    v_mov_b32 v45, 0
    v_mov_b32 v46, 0
    v_mov_b32 v47, 0
    v_mov_b32 v48, 0
    v_mov_b32 v49, 0
    v_mov_b32 v50, 0
    v_mov_b32 v51, 0
    v_mov_b32 v52, 0
    v_mov_b32 v53, 0
    v_mov_b32 v54, 0
    v_mov_b32 v55, 0
    v_mov_b32 v56, 0
    v_mov_b32 v57, 0
    v_mov_b32 v58, 0
    v_mov_b32 v59, 0
    v_mov_b32 v60, 0
    v_mov_b32 v61, 0
    v_mov_b32 v62, 0
    v_mov_b32 v63, 0
    v_mov_b32 v64, 0
    v_mov_b32 v65, 0
    v_mov_b32 v66, 0
    v_mov_b32 v67, 0
    s_mov_b32 s43, 0
    s_mov_b32 s44, 86016
    v_add_u32 v134, 86016, v132
    v_xor_b32 v135, 64, v134
    v_add_u32 v136, 86016, v133
    v_mov_b32 v7, 0xf149f2ca
    v_lshlrev_b32 v4, 2, v2
    v_sub_u32 v4, v1, v4
    v_subrev_u32 v5, 0, v4
    v_and_b32 v5, 0x80000001, v5
    v_cmp_eq_u32 vcc, 0, v5
    s_nop 1
    v_cndmask_b32 v144, v7, 0, vcc
    v_cmp_eq_u32 vcc, 0x80000000, v5
    s_nop 1
    v_cndmask_b32 v148, v7, 0, vcc
    v_subrev_u32 v5, 1, v4
    v_and_b32 v5, 0x80000001, v5
    v_cmp_eq_u32 vcc, 0, v5
    s_nop 1
    v_cndmask_b32 v145, v7, 0, vcc
    v_cmp_eq_u32 vcc, 0x80000000, v5
    s_nop 1
    v_cndmask_b32 v149, v7, 0, vcc
    v_subrev_u32 v5, 2, v4
    v_and_b32 v5, 0x80000001, v5
    v_cmp_eq_u32 vcc, 0, v5
    s_nop 1
    v_cndmask_b32 v146, v7, 0, vcc
    v_cmp_eq_u32 vcc, 0x80000000, v5
    s_nop 1
    v_cndmask_b32 v150, v7, 0, vcc
    v_subrev_u32 v5, 3, v4
    v_and_b32 v5, 0x80000001, v5
    v_cmp_eq_u32 vcc, 0, v5
    s_nop 1
    v_cndmask_b32 v147, v7, 0, vcc
    v_cmp_eq_u32 vcc, 0x80000000, v5
    s_nop 1
    v_cndmask_b32 v151, v7, 0, vcc
    v_and_b32 v5, 1, v1
    v_lshlrev_b32 v6, 4, v5
    v_mov_b32 v7, 0xffff
    v_lshlrev_b32 v7, v6, v7
    v_sub_u32 v5, v4, v5
    v_cmp_le_i32 vcc, 0, v5
    s_nop 1
    v_cndmask_b32 v152, 0, v7, vcc
    v_cndmask_b32 v154, v7, 0, vcc
    v_cmp_le_i32 vcc, 2, v5
    s_nop 1
    v_cndmask_b32 v153, 0, v7, vcc
    v_cndmask_b32 v155, v7, 0, vcc
    v_mov_b32 v7, 0x0c0c0c0c
    s_mov_b32 s96, 0x1000100
    v_bfi_b32 v152, v152, s96, v7
    s_mov_b32 s96, 0x3020302
    v_bfi_b32 v153, v153, s96, v7
    s_mov_b32 s96, 0x1000100
    v_bfi_b32 v154, v154, s96, v7
    s_mov_b32 s96, 0x3020302
    v_bfi_b32 v155, v155, s96, v7
    s_or_b32 s96, s37, s42
    s_cmp_eq_u32 s96, 0
    s_cselect_b32 s96, 0xf149f2ca, 0
    v_add_f32 v140, s96, v148
    v_add_f32 v141, s96, v149
    v_add_f32 v142, s96, v150
    v_add_f32 v143, s96, v151
    s_mov_b32 s54, 0x3ea52b5c
    v_bfe_i32 v157, s45, v2, 1
    v_cmp_ne_u32 s[50:51], 0, v157
    s_bfe_u32 s60, s45, 131076
    v_cmp_eq_u32 s[52:53], s60, v2
    s_bfe_u32 s61, s45, 65542
    s_lshr_b32 s62, s41, 1
    s_add_u32 s96, s41, 1
    s_bfe_u32 s96, s96, 65537
    s_xor_b32 s57, s96, 1
    s_bitcmp1_b32 s45, 7
    s_cselect_b32 s63, s62, s61
    s_mul_i32 s96, s63, 13824
    s_lshl_b32 s97, s42, 11
    s_add_u32 s96, s96, s97
    s_add_u32 s96, s96, 129024
    v_lshl_add_u32 v156, v0, 3, s96
    v_and_b32 v4, 0x33, v0
    s_lshl_b32 s97, s60, 5
    s_add_u32 s96, s96, s97
    v_lshl_add_u32 v162, v4, 3, s96
    s_lshl_b32 s96, s41, 10
    s_add_u32 s96, s96, 156672
    v_lshl_add_u32 v164, v0, 3, s96
    v_min_u32 v4, 16, v0
    v_lshl_add_u32 v163, v4, 2, v3
    v_add_u32 v163, 128, v163
    s_lshl1_add_u32 s96, s41, s42
    s_lshl_b32 s96, s96, 2
    v_add_u32 v165, s96, v3
    s_lshl_b32 s96, s41, 1
    s_lshl_b32 s96, s42, s96
    s_lshl1_add_u32 s97, s42, 1
    s_mul_i32 s98, s61, 6
    s_lshl_b32 s97, s97, s98
    s_or_b32 s98, s96, s97
    s_bitcmp1_b32 s45, 7
    s_cselect_b32 s48, s96, s98
    s_cselect_b32 s49, s96, s97
    s_lshl_b32 s49, s49, 8
    s_and_b32 s64, s37, 1
    s_lshl1_add_u32 s65, s64, s42
    s_mul_i32 s96, s65, 81920
    s_mul_i32 s97, s30, 327680
    s_add_u32 s96, s96, s97
    s_lshl_b32 s97, s38, 11
    s_add_u32 s96, s96, s97
    s_add_u32 s67, s96, 20480
    s_mul_i32 s97, s57, 20480
    s_lshl3_add_u32 s97, s62, s97
    s_add_u32 s97, s97, s96
    v_lshl_add_u32 v160, v0, 4, s97
    s_lshl_b32 s97, s60, 8
    s_lshl3_add_u32 s97, s61, s97
    s_add_u32 s97, s97, 20480
    s_add_u32 s97, s97, s96
    v_lshrrev_b32 v4, 1, v2
    v_mul_u32_u24 v4, 38912, v4
    v_lshl_add_u32 v4, v2, 10, v4
    v_lshl_add_u32 v4, v1, 4, v4
    v_add_u32 v161, s97, v4
    s_mul_i32 s66, s30, 262144
    s_add_u32 s66, s66, 7340032
    s_lshl_b32 s96, s65, 8
    s_lshl_b32 s97, s57, 7
    s_add_u32 s96, s96, s97
    s_lshl1_add_u32 s97, s38, s62
    s_lshl2_add_u32 s96, s97, s96
    s_add_u32 s96, s96, s66
    s_add_u32 s55, s96, 196608
    s_mul_i32 s96, s62, 40960
    s_add_u32 s96, s96, s67
    v_lshl_add_u32 v159, v0, 4, s96
    s_mul_i32 s96, s62, 77824
    s_sub_u32 s96, 38912, s96
    v_add_u32 v158, s96, v159
    s_cmp_gt_u32 s46, 0
    s_cselect_b32 s96, 1, 0
    s_cmp_lt_u32 s46, 4
    s_cselect_b32 s97, 64, 0
    s_or_b32 s96, s96, s97
    s_lshl_b32 s47, s96, s42
    s_mov_b32 s76, 0x7060500
    s_mov_b32 s77, 0x7060501
    s_mov_b32 s78, 0x7060502
    s_mov_b32 s79, 0x7060503
    s_mov_b32 s58, 0x0c0c0400
    s_mov_b32 s59, 0x04000c0c
    v_add_u32 v157, 40960, v160
    s_mul_i32 s96, s57, 51200
    s_add_u32 s80, s96, 10240
    s_mul_i32 s81, s56, 2560
    s_add_u32 s81, s81, 0
    s_mov_b32 s93, 112640
    s_mov_b32 s101, 0
    s_and_b32 s98, s35, 3
    s_lshr_b32 s96, s56, 1
    s_lshl1_add_u32 s96, s98, s96
    s_lshl1_add_u32 s96, s96, s57
    s_mul_i32 s96, s96, 20480
    s_and_b32 s97, s56, 1
    s_lshl_b32 s97, s97, 10
    s_add_u32 s96, s96, s97
    s_mul_i32 s97, s30, 327680
    s_add_u32 s96, s96, s97
    s_add_u32 s82, s96, 4096
    s_mul_i32 s96, s30, 262144
    s_lshl_b32 s98, s98, 8
    s_add_u32 s96, s96, s98
    s_add_u32 s83, s96, 7536640
    s_mul_i32 s84, s56, 5120
    s_add_u32 s84, s84, 129024
    s_lshl2_add_u32 s96, s35, s56
    s_mul_i32 s96, s96, 20480
    s_mul_i32 s97, s36, 160
    s_add_u32 s85, s96, s97
    v_lshl_add_u32 v138, v0, 4, s80
    v_lshl_add_u32 v139, v0, 4, s82
    v_lshl_add_u32 v166, v0, 2, s83
    s_waitcnt lgkmcnt(0)
    s_mul_i32 s33, s33, 1664525
    s_add_u32 s33, s33, 1013904223
    s_cmp_eq_u32 s32, 4
    s_cbranch_scc1 L_padb0
    s_cmp_eq_u32 s32, 5
    s_cbranch_scc1 L_padb1
    s_cmp_eq_u32 s32, 6
    s_cbranch_scc1 L_padb2
    s_cmp_eq_u32 s32, 7
    s_cbranch_scc1 L_padb3
    s_cmp_eq_u32 s32, 8
    s_cbranch_scc1 L_padb4
    s_cmp_eq_u32 s32, 9
    s_cbranch_scc1 L_padb5
    s_cmp_eq_u32 s32, 10
    s_cbranch_scc1 L_padb6
    s_branch L_padb7
L_padb7:
    s_branch L_padb15
L_warmed_b:
    s_barrier
    s_cmp_lg_u32 s42, 0
    s_cbranch_scc1 L_gemm_40
L_gemm_50:
    s_barrier
    ds_read_b64_tr_b16 v[112:113], v136 offset:1024
    ds_read_b64_tr_b16 v[114:115], v136 offset:1536
    ds_read_b128 v[68:71], v134 offset:0
    ds_read_b128 v[72:75], v134 offset:2048
    ds_read_b128 v[76:79], v134 offset:4096
    ds_read_b128 v[80:83], v134 offset:6144
    ds_read_b128 v[84:87], v134 offset:8192
    ds_read_b64_tr_b16 v[116:117], v136 offset:2048
    ds_read_b64_tr_b16 v[118:119], v136 offset:2560
    ds_read_b64_tr_b16 v[108:109], v136 offset:0
    ds_read_b64_tr_b16 v[110:111], v136 offset:512
L_gemm_5:
    s_waitcnt lgkmcnt(8)
    v_mfma_f32_16x16x32_bf16 v[28:31], v[112:115], v[68:71], v[28:31]
    s_setprio 2
    ds_read_b64_tr_b16 v[124:125], v136 offset:13312
    s_waitcnt lgkmcnt(8)
    v_mfma_f32_16x16x32_bf16 v[32:35], v[112:115], v[72:75], v[32:35]
    ds_read_b64_tr_b16 v[126:127], v136 offset:13824
    s_waitcnt lgkmcnt(8)
    v_mfma_f32_16x16x32_bf16 v[36:39], v[112:115], v[76:79], v[36:39]
    ds_read_b128 v[88:91], v135 offset:0
    s_waitcnt lgkmcnt(8)
    v_mfma_f32_16x16x32_bf16 v[40:43], v[112:115], v[80:83], v[40:43]
    ds_read_b128 v[92:95], v135 offset:2048
    s_waitcnt lgkmcnt(8)
    v_mfma_f32_16x16x32_bf16 v[44:47], v[112:115], v[84:87], v[44:47]
    ds_read_b128 v[96:99], v135 offset:4096
    s_waitcnt lgkmcnt(7)
    v_mfma_f32_16x16x32_bf16 v[48:51], v[68:71], v[116:119], v[48:51]
    ds_read_b128 v[100:103], v135 offset:6144
    v_mfma_f32_16x16x32_bf16 v[52:55], v[72:75], v[116:119], v[52:55]
    ds_read_b128 v[104:107], v135 offset:8192
    v_mfma_f32_16x16x32_bf16 v[56:59], v[76:79], v[116:119], v[56:59]
    ds_read_b64_tr_b16 v[128:129], v136 offset:14336
    v_mfma_f32_16x16x32_bf16 v[60:63], v[80:83], v[116:119], v[60:63]
    ds_read_b64_tr_b16 v[130:131], v136 offset:14848
    v_mfma_f32_16x16x32_bf16 v[64:67], v[84:87], v[116:119], v[64:67]
    ds_read_b64_tr_b16 v[120:121], v136 offset:12288
    s_waitcnt lgkmcnt(10)
    v_mfma_f32_16x16x32_bf16 v[12:15], v[108:111], v[72:75], v[12:15]
    ds_read_b64_tr_b16 v[122:123], v136 offset:12800
    v_mfma_f32_16x16x32_bf16 v[16:19], v[108:111], v[76:79], v[16:19]
    v_mfma_f32_16x16x32_bf16 v[20:23], v[108:111], v[80:83], v[20:23]
    v_mfma_f32_16x16x32_bf16 v[24:27], v[108:111], v[84:87], v[24:27]
    s_waitcnt lgkmcnt(8)
    v_mfma_f32_16x16x32_bf16 v[28:31], v[124:127], v[88:91], v[28:31]
    s_add_u32 s44, s44, 43008
    s_cmp_eq_u32 s44, 129024
    s_cselect_b32 s44, 0, s44
    v_add_u32 v134, s44, v132
    v_add_u32 v136, s44, v133
    s_waitcnt lgkmcnt(7)
    v_mfma_f32_16x16x32_bf16 v[32:35], v[124:127], v[92:95], v[32:35]
    s_waitcnt lgkmcnt(0)
    s_barrier
    s_setprio 1
    ds_read_b64_tr_b16 v[112:113], v136 offset:1024
    v_mfma_f32_16x16x32_bf16 v[36:39], v[124:127], v[96:99], v[36:39]
    ds_read_b64_tr_b16 v[114:115], v136 offset:1536
    v_mfma_f32_16x16x32_bf16 v[40:43], v[124:127], v[100:103], v[40:43]
    v_xor_b32 v135, 64, v134
    ds_read_b128 v[68:71], v134 offset:0
    v_mfma_f32_16x16x32_bf16 v[44:47], v[124:127], v[104:107], v[44:47]
    ds_read_b128 v[72:75], v134 offset:2048
    v_mfma_f32_16x16x32_bf16 v[48:51], v[88:91], v[128:131], v[48:51]
    ds_read_b128 v[76:79], v134 offset:4096
    v_mfma_f32_16x16x32_bf16 v[52:55], v[92:95], v[128:131], v[52:55]
    ds_read_b128 v[80:83], v134 offset:6144
    v_mfma_f32_16x16x32_bf16 v[56:59], v[96:99], v[128:131], v[56:59]
    ds_read_b128 v[84:87], v134 offset:8192
    v_mfma_f32_16x16x32_bf16 v[60:63], v[100:103], v[128:131], v[60:63]
    ds_read_b64_tr_b16 v[116:117], v136 offset:2048
    v_mfma_f32_16x16x32_bf16 v[64:67], v[104:107], v[128:131], v[64:67]
    ds_read_b64_tr_b16 v[118:119], v136 offset:2560
    v_mfma_f32_16x16x32_bf16 v[12:15], v[120:123], v[92:95], v[12:15]
    ds_read_b64_tr_b16 v[108:109], v136 offset:0
    v_mfma_f32_16x16x32_bf16 v[16:19], v[120:123], v[96:99], v[16:19]
    s_add_u32 s43, s43, 1
    ds_read_b64_tr_b16 v[110:111], v136 offset:512
    v_mfma_f32_16x16x32_bf16 v[20:23], v[120:123], v[100:103], v[20:23]
    s_cmp_lt_u32 s43, 9
    v_mfma_f32_16x16x32_bf16 v[24:27], v[120:123], v[104:107], v[24:27]
    s_cbranch_scc1 L_gemm_5
    s_waitcnt lgkmcnt(8)
    v_mfma_f32_16x16x32_bf16 v[28:31], v[112:115], v[68:71], v[28:31]
    s_bitcmp1_b32 s45, 7
    s_setprio 3
    s_cbranch_scc1 Llp_35
    s_setprio 1
Llp_35:
    ds_read_b64_tr_b16 v[124:125], v136 offset:13312
    s_waitcnt lgkmcnt(8)
    v_mfma_f32_16x16x32_bf16 v[32:35], v[112:115], v[72:75], v[32:35]
    ds_read_b64_tr_b16 v[126:127], v136 offset:13824
    s_waitcnt lgkmcnt(8)
    v_mfma_f32_16x16x32_bf16 v[36:39], v[112:115], v[76:79], v[36:39]
    ds_read_b128 v[88:91], v135 offset:0
    s_waitcnt lgkmcnt(8)
    v_mfma_f32_16x16x32_bf16 v[40:43], v[112:115], v[80:83], v[40:43]
    ds_read_b128 v[92:95], v135 offset:2048
    s_waitcnt lgkmcnt(8)
    v_mfma_f32_16x16x32_bf16 v[44:47], v[112:115], v[84:87], v[44:47]
    ds_read_b128 v[96:99], v135 offset:4096
    s_waitcnt lgkmcnt(7)
    v_mfma_f32_16x16x32_bf16 v[48:51], v[68:71], v[116:119], v[48:51]
    ds_read_b128 v[100:103], v135 offset:6144
    v_mfma_f32_16x16x32_bf16 v[52:55], v[72:75], v[116:119], v[52:55]
    ds_read_b128 v[104:107], v135 offset:8192
    v_mfma_f32_16x16x32_bf16 v[56:59], v[76:79], v[116:119], v[56:59]
    ds_read_b64_tr_b16 v[128:129], v136 offset:14336
    v_mfma_f32_16x16x32_bf16 v[60:63], v[80:83], v[116:119], v[60:63]
    ds_read_b64_tr_b16 v[130:131], v136 offset:14848
    v_mfma_f32_16x16x32_bf16 v[64:67], v[84:87], v[116:119], v[64:67]
    ds_read_b64_tr_b16 v[120:121], v136 offset:12288
    s_waitcnt lgkmcnt(10)
    v_mfma_f32_16x16x32_bf16 v[12:15], v[108:111], v[72:75], v[12:15]
    ds_read_b64_tr_b16 v[122:123], v136 offset:12800
    v_mfma_f32_16x16x32_bf16 v[16:19], v[108:111], v[76:79], v[16:19]
    ds_read_b64 v[6:7], v3 offset:384
    v_mfma_f32_16x16x32_bf16 v[20:23], v[108:111], v[80:83], v[20:23]
    v_mfma_f32_16x16x32_bf16 v[24:27], v[108:111], v[84:87], v[24:27]
    s_waitcnt lgkmcnt(0)
    v_mfma_f32_16x16x32_bf16 v[44:47], v[124:127], v[104:107], v[44:47]
    v_readfirstlane_b32 s90, v6
    v_readfirstlane_b32 s91, v7
    v_mfma_f32_16x16x32_bf16 v[24:27], v[120:123], v[104:107], v[24:27]
    v_mov_b64 v[70:71], 0
    v_mov_b64 v[74:75], 0
    v_mfma_f32_16x16x32_bf16 v[40:43], v[124:127], v[100:103], v[40:43]
    v_mov_b64 v[78:79], 0
    v_mov_b64 v[82:83], 0
    v_mfma_f32_16x16x32_bf16 v[20:23], v[120:123], v[100:103], v[20:23]
    v_mov_b32 v119, s33
    v_mfma_f32_16x16x32_bf16 v[36:39], v[124:127], v[96:99], v[36:39]
    v_mfma_f32_16x16x32_bf16 v[16:19], v[120:123], v[96:99], v[16:19]
    v_mfma_f32_16x16x32_bf16 v[32:35], v[124:127], v[92:95], v[32:35]
    v_mfma_f32_16x16x32_bf16 v[12:15], v[120:123], v[92:95], v[12:15]
    v_mfma_f32_16x16x32_bf16 v[28:31], v[124:127], v[88:91], v[28:31]
    s_branch L_gdone
.p2align 12
L_padb8:
    s_branch L_padb16
L_gemm_40:
    s_barrier
    ds_read_b64_tr_b16 v[112:113], v136 offset:1024
    ds_read_b64_tr_b16 v[114:115], v136 offset:1536
    ds_read_b128 v[72:75], v134 offset:2048
    ds_read_b128 v[76:79], v134 offset:4096
    ds_read_b128 v[80:83], v134 offset:6144
    ds_read_b128 v[84:87], v134 offset:8192
    ds_read_b64_tr_b16 v[116:117], v136 offset:2048
    ds_read_b64_tr_b16 v[118:119], v136 offset:2560
    ds_read_b64_tr_b16 v[108:109], v136 offset:0
    ds_read_b64_tr_b16 v[110:111], v136 offset:512
L_gemm_4:
    s_waitcnt lgkmcnt(7)
    v_mfma_f32_16x16x32_bf16 v[32:35], v[112:115], v[72:75], v[32:35]
    s_setprio 1
    ds_read_b64_tr_b16 v[124:125], v136 offset:13312
    s_waitcnt lgkmcnt(7)
    v_mfma_f32_16x16x32_bf16 v[36:39], v[112:115], v[76:79], v[36:39]
    ds_read_b64_tr_b16 v[126:127], v136 offset:13824
    s_waitcnt lgkmcnt(7)
    v_mfma_f32_16x16x32_bf16 v[40:43], v[112:115], v[80:83], v[40:43]
    ds_read_b128 v[92:95], v135 offset:2048
    s_waitcnt lgkmcnt(7)
    v_mfma_f32_16x16x32_bf16 v[44:47], v[112:115], v[84:87], v[44:47]
    ds_read_b128 v[96:99], v135 offset:4096
    s_waitcnt lgkmcnt(6)
    v_mfma_f32_16x16x32_bf16 v[52:55], v[72:75], v[116:119], v[52:55]
    ds_read_b128 v[100:103], v135 offset:6144
    v_mfma_f32_16x16x32_bf16 v[56:59], v[76:79], v[116:119], v[56:59]
    ds_read_b128 v[104:107], v135 offset:8192
    v_mfma_f32_16x16x32_bf16 v[60:63], v[80:83], v[116:119], v[60:63]
    ds_read_b64_tr_b16 v[128:129], v136 offset:14336
    v_mfma_f32_16x16x32_bf16 v[64:67], v[84:87], v[116:119], v[64:67]
    ds_read_b64_tr_b16 v[130:131], v136 offset:14848
    s_waitcnt lgkmcnt(8)
    v_mfma_f32_16x16x32_bf16 v[12:15], v[108:111], v[72:75], v[12:15]
    ds_read_b64_tr_b16 v[120:121], v136 offset:12288
    v_mfma_f32_16x16x32_bf16 v[16:19], v[108:111], v[76:79], v[16:19]
    ds_read_b64_tr_b16 v[122:123], v136 offset:12800
    v_mfma_f32_16x16x32_bf16 v[20:23], v[108:111], v[80:83], v[20:23]
    v_mfma_f32_16x16x32_bf16 v[24:27], v[108:111], v[84:87], v[24:27]
    s_waitcnt lgkmcnt(7)
    v_mfma_f32_16x16x32_bf16 v[32:35], v[124:127], v[92:95], v[32:35]
    s_add_u32 s44, s44, 43008
    s_cmp_eq_u32 s44, 129024
    s_cselect_b32 s44, 0, s44
    v_add_u32 v134, s44, v132
    v_add_u32 v136, s44, v133
    s_waitcnt lgkmcnt(6)
    v_mfma_f32_16x16x32_bf16 v[36:39], v[124:127], v[96:99], v[36:39]
    s_waitcnt lgkmcnt(0)
    s_barrier
    s_setprio 2
    ds_read_b64_tr_b16 v[112:113], v136 offset:1024
    v_mfma_f32_16x16x32_bf16 v[40:43], v[124:127], v[100:103], v[40:43]
    ds_read_b64_tr_b16 v[114:115], v136 offset:1536
    v_mfma_f32_16x16x32_bf16 v[44:47], v[124:127], v[104:107], v[44:47]
    v_xor_b32 v135, 64, v134
    ds_read_b128 v[72:75], v134 offset:2048
    v_mfma_f32_16x16x32_bf16 v[52:55], v[92:95], v[128:131], v[52:55]
    ds_read_b128 v[76:79], v134 offset:4096
    v_mfma_f32_16x16x32_bf16 v[56:59], v[96:99], v[128:131], v[56:59]
    ds_read_b128 v[80:83], v134 offset:6144
    v_mfma_f32_16x16x32_bf16 v[60:63], v[100:103], v[128:131], v[60:63]
    ds_read_b128 v[84:87], v134 offset:8192
    v_mfma_f32_16x16x32_bf16 v[64:67], v[104:107], v[128:131], v[64:67]
    ds_read_b64_tr_b16 v[116:117], v136 offset:2048
    v_mfma_f32_16x16x32_bf16 v[12:15], v[120:123], v[92:95], v[12:15]
    ds_read_b64_tr_b16 v[118:119], v136 offset:2560
    v_mfma_f32_16x16x32_bf16 v[16:19], v[120:123], v[96:99], v[16:19]
    s_add_u32 s43, s43, 1
    ds_read_b64_tr_b16 v[108:109], v136 offset:0
    v_mfma_f32_16x16x32_bf16 v[20:23], v[120:123], v[100:103], v[20:23]
    s_cmp_lt_u32 s43, 9
    ds_read_b64_tr_b16 v[110:111], v136 offset:512
    v_mfma_f32_16x16x32_bf16 v[24:27], v[120:123], v[104:107], v[24:27]
    s_cbranch_scc1 L_gemm_4
    s_waitcnt lgkmcnt(7)
    v_mfma_f32_16x16x32_bf16 v[32:35], v[112:115], v[72:75], v[32:35]
    s_bitcmp1_b32 s45, 7
    s_setprio 3
    s_cbranch_scc1 Llp_36
    s_setprio 1
Llp_36:
    ds_read_b64_tr_b16 v[124:125], v136 offset:13312
    s_waitcnt lgkmcnt(7)
    v_mfma_f32_16x16x32_bf16 v[36:39], v[112:115], v[76:79], v[36:39]
    ds_read_b64_tr_b16 v[126:127], v136 offset:13824
    s_waitcnt lgkmcnt(7)
    v_mfma_f32_16x16x32_bf16 v[40:43], v[112:115], v[80:83], v[40:43]
    ds_read_b128 v[92:95], v135 offset:2048
    s_waitcnt lgkmcnt(7)
    v_mfma_f32_16x16x32_bf16 v[44:47], v[112:115], v[84:87], v[44:47]
    ds_read_b128 v[96:99], v135 offset:4096
    s_waitcnt lgkmcnt(6)
    v_mfma_f32_16x16x32_bf16 v[52:55], v[72:75], v[116:119], v[52:55]
    ds_read_b128 v[100:103], v135 offset:6144
    v_mfma_f32_16x16x32_bf16 v[56:59], v[76:79], v[116:119], v[56:59]
    ds_read_b128 v[104:107], v135 offset:8192
    v_mfma_f32_16x16x32_bf16 v[60:63], v[80:83], v[116:119], v[60:63]
    ds_read_b64_tr_b16 v[128:129], v136 offset:14336
    v_mfma_f32_16x16x32_bf16 v[64:67], v[84:87], v[116:119], v[64:67]
    ds_read_b64_tr_b16 v[130:131], v136 offset:14848
    s_waitcnt lgkmcnt(8)
    v_mfma_f32_16x16x32_bf16 v[12:15], v[108:111], v[72:75], v[12:15]
    ds_read_b64_tr_b16 v[120:121], v136 offset:12288
    v_mfma_f32_16x16x32_bf16 v[16:19], v[108:111], v[76:79], v[16:19]
    ds_read_b64_tr_b16 v[122:123], v136 offset:12800
    v_mfma_f32_16x16x32_bf16 v[20:23], v[108:111], v[80:83], v[20:23]
    ds_read_b64 v[6:7], v3 offset:384
    v_mfma_f32_16x16x32_bf16 v[24:27], v[108:111], v[84:87], v[24:27]
    s_waitcnt lgkmcnt(0)
    v_mfma_f32_16x16x32_bf16 v[44:47], v[124:127], v[104:107], v[44:47]
    v_readfirstlane_b32 s90, v6
    v_readfirstlane_b32 s91, v7
    v_mfma_f32_16x16x32_bf16 v[24:27], v[120:123], v[104:107], v[24:27]
    v_mov_b64 v[70:71], 0
    v_mov_b64 v[74:75], 0
    v_mfma_f32_16x16x32_bf16 v[40:43], v[124:127], v[100:103], v[40:43]
    v_mov_b64 v[78:79], 0
    v_mov_b64 v[82:83], 0
    v_mfma_f32_16x16x32_bf16 v[20:23], v[120:123], v[100:103], v[20:23]
    v_mov_b32 v119, s33
    v_mfma_f32_16x16x32_bf16 v[36:39], v[124:127], v[96:99], v[36:39]
    v_mfma_f32_16x16x32_bf16 v[16:19], v[120:123], v[96:99], v[16:19]
    v_mfma_f32_16x16x32_bf16 v[32:35], v[124:127], v[92:95], v[32:35]
    v_mfma_f32_16x16x32_bf16 v[12:15], v[120:123], v[92:95], v[12:15]
L_gdone:
    s_cmp_lg_u32 s90, s33
    s_cbranch_scc1 L_mslow
L_mback:
    s_cmp_eq_u32 s91, 1
    s_cselect_b32 s99, 0, 15728640
    s_add_u32 s16, s28, s99
    s_addc_u32 s17, s29, 0
    s_add_u32 s18, s16, 13107200
    s_addc_u32 s19, s17, 0
    s_cmp_eq_u32 s91, 1
    s_cselect_b64 s[18:19], s[24:25], s[18:19]
    s_bitcmp0_b32 s45, 7
    s_cbranch_scc1 L_full
    v_mov_b32 v5, 1
    v_cvt_pk_bf16_f32 v84, v44, v45
    v_cvt_pk_bf16_f32 v85, v46, v47
    ds_write_b64 v156, v[84:85] offset:6656
    ds_write_b32 v165, v5 offset:344
    v_cvt_pk_bf16_f32 v80, v40, v41
    v_cvt_pk_bf16_f32 v81, v42, v43
    v_cvt_pk_bf16_f32 v76, v36, v37
    v_cvt_pk_bf16_f32 v77, v38, v39
    v_cvt_pk_bf16_f32 v72, v32, v33
    v_cvt_pk_bf16_f32 v73, v34, v35
    s_mov_b32 s100, 0
    s_cmp_eq_u32 s42, 0
    s_cbranch_scc1 L_l_k0
    ds_read_b32 v4, v165 offset:340
    ds_read_b64 v[68:69], v156 offset:4608
    s_branch L_l_k1
L_padb9:
    s_branch L_padb17
L_l_k0:
    v_cvt_pk_bf16_f32 v68, v28, v29
    v_cvt_pk_bf16_f32 v69, v30, v31
    v_mov_b32 v4, 1
L_l_k1:
    s_mov_b64 exec, s[50:51]
    v_cvt_pk_bf16_f32 v82, v24, v25
    v_cvt_pk_bf16_f32 v83, v26, v27
    v_cvt_pk_bf16_f32 v78, v20, v21
    v_cvt_pk_bf16_f32 v79, v22, v23
    v_cvt_pk_bf16_f32 v74, v16, v17
    v_cvt_pk_bf16_f32 v75, v18, v19
    v_cvt_pk_bf16_f32 v70, v12, v13
    v_cvt_pk_bf16_f32 v71, v14, v15
    s_mov_b64 exec, -1
    v_mfma_f32_16x16x16_bf16 v[40:43], v[84:85], v[82:83], v[144:147]
    v_cvt_pk_bf16_f32 v24, v24, v25
    v_cvt_pk_bf16_f32 v25, v26, v27
    v_mfma_f32_16x16x16_bf16 v[124:127], v[80:81], v[82:83], v[148:151]
    v_mfma_f32_16x16x16_bf16 v[36:39], v[80:81], v[78:79], v[144:147]
    v_cvt_pk_bf16_f32 v20, v20, v21
    v_cvt_pk_bf16_f32 v21, v22, v23
    v_mfma_f32_16x16x16_bf16 v[120:123], v[76:77], v[78:79], v[148:151]
    v_mfma_f32_16x16x16_bf16 v[32:35], v[76:77], v[74:75], v[144:147]
    v_cvt_pk_bf16_f32 v16, v16, v17
    v_cvt_pk_bf16_f32 v17, v18, v19
    v_mfma_f32_16x16x16_bf16 v[8:11], v[72:73], v[74:75], v[148:151]
    v_mfma_f32_16x16x16_bf16 v[28:31], v[72:73], v[70:71], v[144:147]
    v_cvt_pk_bf16_f32 v12, v12, v13
    v_cvt_pk_bf16_f32 v13, v14, v15
L_l_kw:
    s_waitcnt lgkmcnt(0)
    v_readfirstlane_b32 s96, v4
    s_cmp_eq_u32 s96, 0
    s_cbranch_scc1 L_l_kslow
L_l_kok:
    v_mfma_f32_16x16x16_bf16 v[44:47], v[68:69], v[70:71], v[140:143]
    ds_write_b64 v156, v[80:81] offset:6144
    ds_write_b64 v156, v[24:25] offset:2048
    v_max3_f32 v114, v40, v41, v124
    v_max3_f32 v115, v42, v43, v126
    v_max_f32 v114, v114, v125
    v_max_f32 v115, v115, v127
    v_perm_b32 v114, v114, v119, s78
    v_perm_b32 v115, v115, v119, s79
    ds_write_b64 v156, v[76:77] offset:5632
    ds_write_b64 v156, v[20:21] offset:1536
    v_max3_f32 v112, v36, v37, v120
    v_max3_f32 v113, v38, v39, v122
    v_max_f32 v112, v112, v121
    v_max_f32 v113, v113, v123
    v_perm_b32 v112, v112, v119, s76
    v_perm_b32 v113, v113, v119, s77
    ds_write_b64 v156, v[72:73] offset:5120
    ds_write_b64 v156, v[16:17] offset:1024
    v_max3_f32 v110, v32, v33, v8
    v_max3_f32 v111, v34, v35, v10
    v_max_f32 v110, v110, v9
    v_max_f32 v111, v111, v11
    v_perm_b32 v110, v110, v119, s78
    v_perm_b32 v111, v111, v119, s79
    ds_write_b64 v156, v[68:69] offset:4608
    ds_write_b64 v156, v[12:13] offset:512
    ds_write_b32 v165, v5 offset:128
    v_max3_f32 v108, v28, v29, v44
    v_max3_f32 v109, v30, v31, v46
    v_max_f32 v108, v108, v45
    v_max_f32 v109, v109, v47
    v_perm_b32 v108, v108, v119, s76
    v_perm_b32 v109, v109, v119, s77
    s_cmp_lg_u32 s91, 1
    s_cbranch_scc1 Ldg_37
    global_store_dwordx4 v158, v[112:115], s[18:19] offset:1024
    global_store_dwordx4 v158, v[108:111], s[18:19] offset:0
    s_branch Ldd_38
L_padb10:
    s_branch L_padb18
Ldg_37:
    global_store_dwordx4 v158, v[112:115], s[18:19] offset:1024 sc1
    global_store_dwordx4 v158, v[108:111], s[18:19] offset:0 sc1
Ldd_38:
    s_setprio 1
    v_mfma_f32_16x16x32_bf16 v[64:67], v[104:107], v[128:131], v[64:67]
    v_mfma_f32_16x16x32_bf16 v[60:63], v[100:103], v[128:131], v[60:63]
    v_mfma_f32_16x16x32_bf16 v[56:59], v[96:99], v[128:131], v[56:59]
    v_mfma_f32_16x16x32_bf16 v[52:55], v[92:95], v[128:131], v[52:55]
    s_cmp_lg_u32 s42, 0
    s_cbranch_scc1 L_nv_l
    v_mfma_f32_16x16x32_bf16 v[48:51], v[88:91], v[128:131], v[48:51]
L_nv_l:
    s_nop 2
    v_cvt_pk_bf16_f32 v88, v64, v65
    v_cvt_pk_bf16_f32 v89, v66, v67
    s_waitcnt lgkmcnt(6)
    ds_write_b64 v156, v[88:89] offset:11264
    v_cvt_pk_bf16_f32 v90, v60, v61
    v_cvt_pk_bf16_f32 v91, v62, v63
    ds_write_b64 v156, v[90:91] offset:10752
    v_cvt_pk_bf16_f32 v92, v56, v57
    v_cvt_pk_bf16_f32 v93, v58, v59
    ds_write_b64 v156, v[92:93] offset:10240
    v_cvt_pk_bf16_f32 v94, v52, v53
    v_cvt_pk_bf16_f32 v95, v54, v55
    ds_write_b64 v156, v[94:95] offset:9728
    s_cmp_lg_u32 s42, 0
    s_cbranch_scc1 L_l_nv0
    v_cvt_pk_bf16_f32 v96, v48, v49
    v_cvt_pk_bf16_f32 v97, v50, v51
    ds_write_b64 v156, v[96:97] offset:9216
    ds_write_b32 v165, v5 offset:160
    s_branch L_l_v0
L_l_nv0:
    ds_write_b32 v165, v5 offset:160
    s_mov_b32 s100, 0
Lm_39:
    ds_read_b32 v4, v163
    s_waitcnt lgkmcnt(0)
    v_cmp_eq_u32 vcc, 0, v4
    s_and_b32 s99, vcc_lo, s49
    s_cbranch_scc0 Lmd_40
    s_add_u32 s100, s100, 1
    s_cmp_lt_u32 s100, 1048576
    s_cbranch_scc1 Lm_39
Lmd_40:
    ds_read_b64 v[96:97], v156 offset:9216
L_l_v0:
    s_setprio 0
    s_mov_b32 s100, 0
L_xp:
    global_load_dwordx4 v[28:31], v159, s[18:19] offset:0 sc1
    global_load_dwordx4 v[32:35], v159, s[18:19] offset:1024 sc1
    s_waitcnt vmcnt(1)
    v_perm_b32 v36, v29, v28, s58
    v_perm_b32 v37, v31, v30, s59
    v_or_b32 v36, v36, v37
    s_waitcnt vmcnt(0)
    v_perm_b32 v38, v33, v32, s58
    v_perm_b32 v39, v35, v34, s59
    v_or_b32 v38, v38, v39
    v_cmp_ne_u32 vcc, s33, v36
    v_cmp_ne_u32 s[60:61], s33, v38
    s_or_b64 vcc, vcc, s[60:61]
    s_cbranch_scc0 L_xpd
    s_add_u32 s100, s100, 1
    s_cmp_lt_u32 s100, 1048576
    s_cbranch_scc1 L_xp
L_xpd:
    s_setprio 2
    ds_write_b32 v165, v5 offset:392
    v_pk_add_f32 v[68:69], v[108:109], v[28:29]
    v_pk_add_f32 v[70:71], v[110:111], v[30:31]
    v_pk_add_f32 v[72:73], v[112:113], v[32:33]
    v_pk_add_f32 v[74:75], v[114:115], v[34:35]
    s_branch L_soft
L_padb11:
    s_branch L_padb19
L_l_kslow:
    ds_read_b32 v4, v165 offset:340
    ds_read_b64 v[68:69], v156 offset:4608
    s_add_u32 s100, s100, 1
    s_cmp_lt_u32 s100, 1048576
    s_cbranch_scc1 L_l_kw
    s_waitcnt lgkmcnt(0)
    s_branch L_l_kok
L_mslow:
    s_lshl_b32 s98, s30, 5
    s_add_u32 s98, s98, s31
    s_lshl_b32 s98, s98, 8
    s_add_u32 s98, s98, 65536
    s_add_u32 s98, s98, 128
    s_mov_b32 s100, 0
Lc_41:
    s_load_dwordx4 s[88:91], s[28:29], s98 glc
    s_waitcnt lgkmcnt(0)
    s_cmp_eq_u32 s90, s33
    s_cbranch_scc1 Lcd_42
    s_sleep 2
    s_add_u32 s100, s100, 1
    s_cmp_lt_u32 s100, 1048576
    s_cbranch_scc1 Lc_41
    s_mov_b32 s91, 2
Lcd_42:
    s_branch L_mback
L_full:
    v_mfma_f32_16x16x32_bf16 v[64:67], v[104:107], v[128:131], v[64:67]
    v_mfma_f32_16x16x32_bf16 v[60:63], v[100:103], v[128:131], v[60:63]
    v_mfma_f32_16x16x32_bf16 v[56:59], v[96:99], v[128:131], v[56:59]
    v_mfma_f32_16x16x32_bf16 v[52:55], v[92:95], v[128:131], v[52:55]
    s_cmp_lg_u32 s42, 0
    s_cbranch_scc1 L_nv_f
    v_mfma_f32_16x16x32_bf16 v[48:51], v[88:91], v[128:131], v[48:51]
L_nv_f:
    s_setprio 2
    v_cvt_pk_bf16_f32 v124, v44, v45
    v_cvt_pk_bf16_f32 v125, v46, v47
    v_cvt_pk_bf16_f32 v120, v40, v41
    v_cvt_pk_bf16_f32 v121, v42, v43
    v_cvt_pk_bf16_f32 v116, v36, v37
    v_cvt_pk_bf16_f32 v117, v38, v39
    v_cvt_pk_bf16_f32 v112, v32, v33
    v_cvt_pk_bf16_f32 v113, v34, v35
    v_cvt_pk_bf16_f32 v68, v12, v13
    v_cvt_pk_bf16_f32 v69, v14, v15
    v_cvt_pk_bf16_f32 v72, v16, v17
    v_cvt_pk_bf16_f32 v73, v18, v19
    v_cvt_pk_bf16_f32 v76, v20, v21
    v_cvt_pk_bf16_f32 v77, v22, v23
    v_cvt_pk_bf16_f32 v80, v24, v25
    v_cvt_pk_bf16_f32 v81, v26, v27
    v_cvt_pk_bf16_f32 v88, v64, v65
    v_cvt_pk_bf16_f32 v89, v66, v67
    s_cmp_lg_u32 s42, 0
    s_cbranch_scc1 L_f_nb
    ds_write_b64 v164, v[124:125]
    ds_write_b64 v164, v[88:89] offset:512
    v_mov_b32 v5, 1
    ds_write_b32 v165, v5 offset:128
    v_cvt_pk_bf16_f32 v108, v28, v29
    v_cvt_pk_bf16_f32 v109, v30, v31
    v_cvt_pk_bf16_f32 v96, v48, v49
    v_cvt_pk_bf16_f32 v97, v50, v51
L_f_nb:
    v_cvt_pk_bf16_f32 v94, v52, v53
    v_cvt_pk_bf16_f32 v95, v54, v55
    v_cvt_pk_bf16_f32 v92, v56, v57
    v_cvt_pk_bf16_f32 v93, v58, v59
    v_cvt_pk_bf16_f32 v90, v60, v61
    v_cvt_pk_bf16_f32 v91, v62, v63
    s_mov_b32 s100, 0
Lm_43:
    ds_read_b32 v4, v163
    s_waitcnt lgkmcnt(0)
    v_cmp_eq_u32 vcc, 0, v4
    s_and_b32 s99, vcc_lo, s48
    s_cbranch_scc0 Lmd_44
    s_add_u32 s100, s100, 1
    s_cmp_lt_u32 s100, 1048576
    s_cbranch_scc1 Lm_43
Lmd_44:
    s_cmp_eq_u32 s42, 0
    s_cbranch_scc1 L_f_nr
    ds_read_b64 v[108:109], v164
    ds_read_b64 v[96:97], v164 offset:512
L_f_nr:
    s_mov_b64 exec, s[52:53]
    ds_read_b64 v[70:71], v156 offset:512
    ds_read_b64 v[74:75], v156 offset:1024
    ds_read_b64 v[78:79], v156 offset:1536
    ds_read_b64 v[82:83], v156 offset:2048
    s_mov_b64 exec, -1
    ds_read_b64 v[110:111], v156 offset:4608
    ds_read_b64 v[114:115], v156 offset:5120
    ds_read_b64 v[118:119], v156 offset:5632
    ds_read_b64 v[122:123], v156 offset:6144
    ds_read_b64 v[126:127], v156 offset:6656
    s_waitcnt lgkmcnt(3)
    v_mfma_f32_16x16x32_bf16 v[8:11], v[112:115], v[68:71], v[144:147]
    v_mfma_f32_16x16x32_bf16 v[24:27], v[108:111], v[68:71], v[140:143]
    s_waitcnt lgkmcnt(2)
    v_mfma_f32_16x16x32_bf16 v[12:15], v[116:119], v[72:75], v[144:147]
    v_mfma_f32_16x16x32_bf16 v[28:31], v[112:115], v[72:75], v[148:151]
    s_waitcnt lgkmcnt(1)
    v_mfma_f32_16x16x32_bf16 v[16:19], v[120:123], v[76:79], v[144:147]
    v_mfma_f32_16x16x32_bf16 v[32:35], v[116:119], v[76:79], v[148:151]
    s_waitcnt lgkmcnt(0)
    v_mfma_f32_16x16x32_bf16 v[20:23], v[124:127], v[80:83], v[144:147]
    v_mfma_f32_16x16x32_bf16 v[36:39], v[120:123], v[80:83], v[148:151]
    v_max3_f32 v68, v8, v9, v24
    v_max3_f32 v69, v10, v11, v26
    v_max_f32 v68, v68, v25
    v_max_f32 v69, v69, v27
    v_max3_f32 v70, v12, v13, v28
    v_max3_f32 v71, v14, v15, v30
    v_max_f32 v70, v70, v29
    v_max_f32 v71, v71, v31
    v_max3_f32 v72, v16, v17, v32
    v_max3_f32 v73, v18, v19, v34
    v_max_f32 v72, v72, v33
    v_max_f32 v73, v73, v35
    v_max3_f32 v74, v20, v21, v36
    v_max3_f32 v75, v22, v23, v38
    v_max_f32 v74, v74, v37
    v_max_f32 v75, v75, v39
L_soft:
    v_max_f32 v76, v68, v69
    v_max_f32 v77, v70, v71
    v_max_f32 v78, v72, v73
    v_max_f32 v79, v74, v75
    v_mov_b32 v84, 0x3f803f80
    v_permlane32_swap_b32 v76, v77
    v_permlane32_swap_b32 v78, v79
    v_max_f32 v76, v76, v77
    v_max_f32 v78, v78, v79
    v_mov_b32 v85, 0x3f803f80
    v_mov_b32 v86, 0x3f803f80
    v_permlane16_swap_b32 v76, v78
    v_max_f32 v76, v76, v78
    v_mul_f32 v78, s54, v76
    v_mul_f32 v76, s54, v76
    v_mov_b32 v87, 0x3f803f80
    v_mov_b32 v4, 1
    v_permlane16_swap_b32 v76, v78
    v_mov_b32 v77, v76
    v_mov_b32 v79, v78
    s_waitcnt lgkmcnt(0)
    v_permlane32_swap_b32 v76, v77
    v_permlane32_swap_b32 v78, v79
    v_fma_f32 v68, v68, s54, -v76
    v_fma_f32 v69, v69, s54, -v76
    v_fma_f32 v70, v70, s54, -v77
    v_fma_f32 v71, v71, s54, -v77
    v_fma_f32 v72, v72, s54, -v78
    v_fma_f32 v73, v73, s54, -v78
    v_fma_f32 v74, v74, s54, -v79
    v_fma_f32 v75, v75, s54, -v79
    s_bitcmp1_b32 s45, 7
    s_cbranch_scc1 L_novx
    ds_read_b32 v6, v163
    ds_read_b64 v[106:107], v162 offset:9216
    ds_read_b64 v[104:105], v162 offset:9728
    ds_read_b64 v[102:103], v162 offset:10240
    ds_read_b64 v[100:101], v162 offset:10752
    ds_read_b64 v[98:99], v162 offset:11264
L_novx:
    v_exp_f32 v68, v68
    v_exp_f32 v69, v69
    v_exp_f32 v70, v70
    v_exp_f32 v71, v71
    v_exp_f32 v72, v72
    v_exp_f32 v73, v73
    v_exp_f32 v74, v74
    v_exp_f32 v75, v75
    v_cvt_pk_bf16_f32 v80, v68, v69
    v_perm_b32 v108, v80, v80, v152
    v_perm_b32 v109, v80, v80, v153
    v_perm_b32 v110, v80, v80, v154
    v_perm_b32 v111, v80, v80, v155
    v_cvt_pk_bf16_f32 v81, v70, v71
    v_perm_b32 v112, v81, v81, v152
    v_perm_b32 v113, v81, v81, v153
    v_perm_b32 v114, v81, v81, v154
    v_perm_b32 v115, v81, v81, v155
    v_mfma_f32_16x16x32_bf16 v[24:27], v[84:87], v[108:111], 0
    v_mfma_f32_16x16x32_bf16 v[8:11], v[94:97], v[108:111], 0
    v_cvt_pk_bf16_f32 v82, v72, v73
    v_perm_b32 v116, v82, v82, v152
    v_perm_b32 v117, v82, v82, v153
    v_perm_b32 v118, v82, v82, v154
    v_perm_b32 v119, v82, v82, v155
    v_mfma_f32_16x16x32_bf16 v[28:31], v[84:87], v[112:115], 0
    v_mfma_f32_16x16x32_bf16 v[12:15], v[92:95], v[112:115], 0
    v_cvt_pk_bf16_f32 v83, v74, v75
    v_perm_b32 v120, v83, v83, v152
    v_perm_b32 v121, v83, v83, v153
    v_perm_b32 v122, v83, v83, v154
    v_perm_b32 v123, v83, v83, v155
    v_mfma_f32_16x16x32_bf16 v[32:35], v[84:87], v[116:119], 0
    v_mfma_f32_16x16x32_bf16 v[16:19], v[90:93], v[116:119], 0
    s_bitcmp1_b32 s45, 7
    v_mfma_f32_16x16x32_bf16 v[36:39], v[84:87], v[120:123], 0
    v_mfma_f32_16x16x32_bf16 v[20:23], v[88:91], v[120:123], 0
    s_cbranch_scc1 L_norem
    s_mov_b32 s100, 0
L_vxw:
    s_waitcnt lgkmcnt(0)
    v_cmp_eq_u32 vcc, 0, v6
    s_and_b32 s99, vcc_lo, s49
    s_cbranch_scc1 L_vxslow
L_vxok:
    v_mfma_f32_16x16x32_bf16 v[40:43], v[104:107], v[108:111], 0
    v_mfma_f32_16x16x32_bf16 v[44:47], v[102:105], v[112:115], 0
    v_mfma_f32_16x16x32_bf16 v[48:51], v[100:103], v[116:119], 0
    v_mfma_f32_16x16x32_bf16 v[52:55], v[98:101], v[120:123], 0
L_norem:
    s_mov_b64 exec, 1
    ds_add_u32 v3, v4 offset:196
    s_mov_b64 exec, -1
    ds_read_b32 v6, v163 offset:264
    v_rcp_f32 v24, v24
    v_rcp_f32 v28, v28
    v_rcp_f32 v32, v32
    v_rcp_f32 v36, v36
    v_pk_mul_f32 v[8:9], v[8:9], v[24:25] op_sel_hi:[1,0]
    v_pk_mul_f32 v[10:11], v[10:11], v[24:25] op_sel_hi:[1,0]
    v_pk_mul_f32 v[12:13], v[12:13], v[28:29] op_sel_hi:[1,0]
    v_pk_mul_f32 v[14:15], v[14:15], v[28:29] op_sel_hi:[1,0]
    v_pk_mul_f32 v[16:17], v[16:17], v[32:33] op_sel_hi:[1,0]
    v_pk_mul_f32 v[18:19], v[18:19], v[32:33] op_sel_hi:[1,0]
    v_pk_mul_f32 v[20:21], v[20:21], v[36:37] op_sel_hi:[1,0]
    v_pk_mul_f32 v[22:23], v[22:23], v[36:37] op_sel_hi:[1,0]
    v_cvt_pk_bf16_f32 v56, v8, v9
    v_cvt_pk_bf16_f32 v57, v10, v11
    v_cvt_pk_bf16_f32 v58, v12, v13
    v_cvt_pk_bf16_f32 v59, v14, v15
    v_cvt_pk_bf16_f32 v60, v16, v17
    v_cvt_pk_bf16_f32 v61, v18, v19
    v_cvt_pk_bf16_f32 v62, v20, v21
    v_cvt_pk_bf16_f32 v63, v22, v23
    s_mov_b32 s100, 0
L_rxw:
    s_waitcnt lgkmcnt(0)
    v_cmp_eq_u32 vcc, 0, v6
    s_and_b32 s99, vcc_lo, s47
    s_cbranch_scc1 L_rxslow
L_rxok:
    s_mov_b64 exec, s[50:51]
    s_cmp_lg_u32 s91, 1
    s_cbranch_scc1 Ldg_45
    global_store_dwordx2 v160, v[56:57], s[18:19] offset:0
    global_store_dwordx2 v160, v[58:59], s[18:19] offset:1024
    global_store_dwordx2 v157, v[60:61], s[18:19] offset:0
    global_store_dwordx2 v157, v[62:63], s[18:19] offset:1024
    s_branch Ldd_46
L_padb12:
    s_branch L_warmed_b
Ldg_45:
    global_store_dwordx2 v160, v[56:57], s[18:19] offset:0 sc1
    global_store_dwordx2 v160, v[58:59], s[18:19] offset:1024 sc1
    global_store_dwordx2 v157, v[60:61], s[18:19] offset:0 sc1
    global_store_dwordx2 v157, v[62:63], s[18:19] offset:1024 sc1
Ldd_46:
    s_mov_b64 exec, -1
    s_bitcmp1_b32 s45, 7
    s_cbranch_scc1 L_norem2
    v_pk_mul_f32 v[64:65], v[40:41], v[24:25] op_sel_hi:[1,0]
    v_pk_mul_f32 v[66:67], v[42:43], v[24:25] op_sel_hi:[1,0]
    s_mov_b32 exec_lo, 0xffff0000
    v_pk_mul_f32 v[64:65], v[44:45], v[28:29] op_sel_hi:[1,0]
    v_pk_mul_f32 v[66:67], v[46:47], v[28:29] op_sel_hi:[1,0]
    s_mov_b32 exec_lo, 0
    v_pk_mul_f32 v[64:65], v[48:49], v[32:33] op_sel_hi:[1,0]
    v_pk_mul_f32 v[66:67], v[50:51], v[32:33] op_sel_hi:[1,0]
    s_mov_b32 exec_hi, 0xffff0000
    v_pk_mul_f32 v[64:65], v[52:53], v[36:37] op_sel_hi:[1,0]
    v_pk_mul_f32 v[66:67], v[54:55], v[36:37] op_sel_hi:[1,0]
    s_mov_b64 exec, -1
    v_cvt_pk_bf16_f32 v64, v64, v65
    v_cvt_pk_bf16_f32 v65, v66, v67
    s_cmp_lg_u32 s91, 1
    s_cbranch_scc1 Ldg_47
    global_store_dwordx2 v161, v[64:65], s[18:19]
    s_branch Ldd_48
Ldg_47:
    global_store_dwordx2 v161, v[64:65], s[18:19] sc1
Ldd_48:
L_norem2:
    v_mov_b32 v6, s55
    v_mov_b32 v5, s33
    s_mov_b64 exec, 1
    ds_add_u32 v3, v4 offset:268
    s_waitcnt vmcnt(0)
    s_cmp_lg_u32 s91, 1
    s_cbranch_scc1 Ldg_49
    global_store_dword v6, v5, s[16:17]
    s_branch Ldd_50
.p2align 12
L_pada5:
    s_branch L_pada13
L_padb13:
    s_branch L_warmed_b
Ldg_49:
    global_store_dword v6, v5, s[16:17] sc1
Ldd_50:
    s_mov_b64 exec, -1
L_tail:
    s_lshl_b32 s96, s57, 2
    v_add_u32 v136, s96, v3
    s_add_u32 s62, s18, 8192
    s_addc_u32 s63, s19, 0
    s_add_u32 s64, s18, 16384
    s_addc_u32 s65, s19, 0
    s_setprio 2
    s_cmp_eq_u32 s57, 0
    s_cbranch_scc1 L_tp
    s_setprio 1
L_tp:
    v_mov_b32 v135, 0
    v_lshl_add_u32 v137, v0, 4, s84
    s_lshl_b32 s96, s56, 2
    v_add_u32 v160, s96, v3
    s_cmp_lg_u32 s34, 0
    s_cbranch_scc1 L_opa
    s_mov_b32 s100, 0
Lw_51:
    ds_read_b32 v4, v3 offset:268
    s_waitcnt lgkmcnt(0)
    v_readfirstlane_b32 s99, v4
    s_cmp_ge_u32 s99, 64
    s_cbranch_scc1 Lwd_52
    s_add_u32 s100, s100, 1
    s_cmp_lt_u32 s100, 1048576
    s_cbranch_scc1 Lw_51
Lwd_52:
    s_cmp_lg_u32 s57, 0
    s_cbranch_scc1 L_prep
L_opb:
    s_mov_b32 s100, 0
Lw_53:
    ds_read_b32 v4, v136 offset:200
    s_waitcnt lgkmcnt(0)
    v_readfirstlane_b32 s99, v4
    s_cmp_ge_u32 s99, 4
    s_cbranch_scc1 Lwd_54
    s_sleep 1
    s_add_u32 s100, s100, 1
    s_cmp_lt_u32 s100, 1048576
    s_cbranch_scc1 Lw_53
Lwd_54:
    ds_read_b128 v[68:71], v138 offset:0
    ds_read_b128 v[72:75], v138 offset:1024
    ds_read_b128 v[76:79], v138 offset:2048
    ds_read_b128 v[80:83], v138 offset:3072
    ds_read_b128 v[84:87], v138 offset:4096
    ds_read_b128 v[88:91], v138 offset:5120
    ds_read_b128 v[92:95], v138 offset:6144
    ds_read_b128 v[96:99], v138 offset:7168
    ds_read_b128 v[100:103], v138 offset:8192
    ds_read_b128 v[104:107], v138 offset:9216
    ds_read_b128 v[108:111], v138 offset:10240
    ds_read_b128 v[112:115], v138 offset:11264
    s_waitcnt lgkmcnt(8)
    ds_read_b128 v[116:119], v138 offset:12288
    ds_read_b128 v[120:123], v138 offset:13312
    ds_read_b128 v[124:127], v138 offset:14336
    ds_read_b128 v[128:131], v138 offset:15360
    s_cmp_eq_u32 s57, 0
    s_cbranch_scc1 L_opp
L_lgo:
    s_mov_b32 s100, 0
Lw_55:
    ds_read_b32 v4, v160 offset:216
    s_waitcnt lgkmcnt(0)
    v_readfirstlane_b32 s99, v4
    s_cmp_ge_u32 s99, 1
    s_cbranch_scc1 Lwd_56
    s_sleep 1
    s_add_u32 s100, s100, 1
    s_cmp_lt_u32 s100, 1048576
    s_cbranch_scc1 Lw_55
Lwd_56:
    s_branch L_late
L_opp:
    s_mov_b32 exec_hi, 0xfffff
    s_mov_b32 exec_lo, 0xfffff
    s_mov_b32 s100, 0
L_op:
    global_load_dword v4, v166, s[16:17] sc1
    s_waitcnt vmcnt(0)
    v_cmp_ne_u32 vcc, s33, v4
    s_cbranch_vccz L_opd
    s_add_u32 s100, s100, 1
    s_cmp_lt_u32 s100, 1048576
    s_cbranch_scc1 L_op
    s_branch L_opd
L_pada6:
    s_branch L_pada14
L_padb14:
    s_branch L_warmed_b
L_opa:
    s_cmp_eq_u32 s57, 0
    s_cbranch_scc1 L_opa1
    s_mov_b32 s100, 0
Lw_57:
    ds_read_b32 v4, v3 offset:376
    s_waitcnt lgkmcnt(0)
    v_readfirstlane_b32 s99, v4
    s_cmp_ge_u32 s99, 2
    s_cbranch_scc1 Lwd_58
    s_sleep 1
    s_add_u32 s100, s100, 1
    s_cmp_lt_u32 s100, 1048576
    s_cbranch_scc1 Lw_57
Lwd_58:
    s_setprio 3
    s_branch L_prep
L_opa1:
    s_mov_b32 s100, 0
Lw_59:
    ds_read_b32 v4, v3 offset:200
    s_waitcnt lgkmcnt(0)
    v_readfirstlane_b32 s99, v4
    s_cmp_ge_u32 s99, 4
    s_cbranch_scc1 Lwd_60
    s_sleep 1
    s_add_u32 s100, s100, 1
    s_cmp_lt_u32 s100, 1048576
    s_cbranch_scc1 Lw_59
Lwd_60:
    ds_read_b128 v[68:71], v138 offset:0
    ds_read_b128 v[72:75], v138 offset:1024
    ds_read_b128 v[76:79], v138 offset:2048
    ds_read_b128 v[80:83], v138 offset:3072
    ds_read_b128 v[84:87], v138 offset:4096
    ds_read_b128 v[88:91], v138 offset:5120
    ds_read_b128 v[92:95], v138 offset:6144
    ds_read_b128 v[96:99], v138 offset:7168
    ds_read_b128 v[100:103], v138 offset:8192
    ds_read_b128 v[104:107], v138 offset:9216
    ds_read_b128 v[108:111], v138 offset:10240
    ds_read_b128 v[112:115], v138 offset:11264
    s_waitcnt lgkmcnt(8)
    ds_read_b128 v[116:119], v138 offset:12288
    ds_read_b128 v[120:123], v138 offset:13312
    ds_read_b128 v[124:127], v138 offset:14336
    ds_read_b128 v[128:131], v138 offset:15360
    s_mov_b32 s100, 0
Lw_61:
    ds_read_b32 v4, v3 offset:276
    s_waitcnt lgkmcnt(0)
    v_readfirstlane_b32 s99, v4
    s_cmp_ge_u32 s99, 1
    s_cbranch_scc1 Lwd_62
    s_sleep 1
    s_add_u32 s100, s100, 1
    s_cmp_lt_u32 s100, 1048576
    s_cbranch_scc1 Lw_61
Lwd_62:
L_opd:
    s_mov_b64 exec, -1
    s_cmp_eq_u32 s57, 0
    s_cbranch_scc1 L_early
L_late:
    global_load_dwordx4 v[28:31], v139, s[18:19] offset:-4096 sc1
    global_load_dwordx4 v[32:35], v139, s[18:19] offset:-2048 sc1
    global_load_dwordx4 v[36:39], v139, s[18:19] offset:0 sc1
    global_load_dwordx4 v[40:43], v139, s[18:19] offset:2048 sc1
    global_load_dwordx4 v[44:47], v139, s[62:63] offset:-4096 sc1
    global_load_dwordx4 v[48:51], v139, s[62:63] offset:-2048 sc1
    global_load_dwordx4 v[52:55], v139, s[62:63] offset:0 sc1
    global_load_dwordx4 v[56:59], v139, s[62:63] offset:2048 sc1
    global_load_dwordx4 v[60:63], v139, s[64:65] offset:-4096 sc1
    global_load_dwordx4 v[64:67], v139, s[64:65] offset:-2048 sc1
    s_lshr_b32 s96, s56, 1
    s_lshl_b32 s96, s96, 7
    s_add_u32 s96, s96, 3072
    v_add_u32 v166, s96, v166
    v_mov_b32 v134, s33
    s_and_b32 s96, s56, 1
    s_lshl1_add_u32 s96, s96, s57
    s_lshl2_add_u32 s96, s36, s96
    s_lshl_b64 s[66:67], 1, s96
    s_cmp_eq_u32 s34, 0
    s_cbranch_scc1 L_nogq
    s_mov_b32 s100, 0
Lw_63:
    ds_read_b32 v4, v3 offset:204
    s_waitcnt lgkmcnt(0)
    v_readfirstlane_b32 s99, v4
    s_cmp_ge_u32 s99, 4
    s_cbranch_scc1 Lwd_64
    s_sleep 1
    s_add_u32 s100, s100, 1
    s_cmp_lt_u32 s100, 1048576
    s_cbranch_scc1 Lw_63
Lwd_64:
    ds_read_b128 v[68:71], v138 offset:0
    ds_read_b128 v[72:75], v138 offset:1024
    ds_read_b128 v[76:79], v138 offset:2048
    ds_read_b128 v[80:83], v138 offset:3072
    ds_read_b128 v[84:87], v138 offset:4096
    ds_read_b128 v[88:91], v138 offset:5120
    ds_read_b128 v[92:95], v138 offset:6144
    ds_read_b128 v[96:99], v138 offset:7168
    ds_read_b128 v[100:103], v138 offset:8192
    ds_read_b128 v[104:107], v138 offset:9216
    ds_read_b128 v[108:111], v138 offset:10240
    ds_read_b128 v[112:115], v138 offset:11264
    s_waitcnt lgkmcnt(8)
    ds_read_b128 v[116:119], v138 offset:12288
    ds_read_b128 v[120:123], v138 offset:13312
    ds_read_b128 v[124:127], v138 offset:14336
    ds_read_b128 v[128:131], v138 offset:15360
    s_branch L_nogq
L_pada7:
    s_branch L_warmed_a
L_padb15:
    s_branch L_warmed_b
    s_setprio 3
    s_waitcnt lgkmcnt(6)
L_prep:
    s_lshl_b32 s96, s56, 6
    s_add_u32 s96, s96, 161280
    v_lshl_add_u32 v164, v1, 2, s96
    v_mul_u32_u24 v161, 160, v1
    v_lshl_add_u32 v161, v2, 3, v161
    v_add_u32 v5, s81, v161
    s_mov_b32 s100, 0
Lw_65:
    ds_read_b32 v4, v3 offset:208
    s_waitcnt lgkmcnt(0)
    v_readfirstlane_b32 s99, v4
    s_cmp_ge_u32 s99, 1
    s_cbranch_scc1 Lwd_66
    s_add_u32 s100, s100, 1
    s_cmp_lt_u32 s100, 1048576
    s_cbranch_scc1 Lw_65
Lwd_66:
    ds_read2st64_b32 v[162:163], v164 offset0:0 offset1:1
    ds_read_b64 v[150:151], v5 offset:0
    ds_read_b64 v[152:153], v5 offset:32
    ds_read_b64 v[154:155], v5 offset:64
    ds_read_b64 v[156:157], v5 offset:96
    ds_read_b64 v[158:159], v5 offset:128
    v_add_u32 v161, s84, v161
    v_add_u32 v5, 0, v0
    v_mul_u32_u24 v165, 6554, v5
    v_lshrrev_b32 v165, 16, v165
    v_mul_u32_u24 v165, 1120, v165
    v_lshl_add_u32 v5, v5, 4, s85
    v_add_u32 v165, v165, v5
    v_add_u32 v5, 64, v0
    v_mul_u32_u24 v7, 6554, v5
    v_lshrrev_b32 v7, 16, v7
    v_mul_u32_u24 v7, 1120, v7
    v_lshl_add_u32 v5, v5, 4, s85
    v_add_u32 v7, v7, v5
    v_add_u32 v5, 128, v0
    v_mul_u32_u24 v135, 6554, v5
    v_lshrrev_b32 v135, 16, v135
    v_mul_u32_u24 v135, 1120, v135
    v_lshl_add_u32 v5, v5, 4, s85
    v_add_u32 v135, v135, v5
    v_bfe_u32 v5, v0, 3, 2
    v_xor_b32 v5, s56, v5
    v_lshlrev_b32 v5, 5, v5
    v_lshrrev_b32 v6, 2, v0
    v_lshl_add_u32 v5, v6, 7, v5
    v_and_b32 v6, 3, v0
    v_lshl_add_u32 v5, v6, 3, v5
    v_add_u32 v164, s93, v5
    s_waitcnt lgkmcnt(0)
    v_lshlrev_b32 v140, 16, v150
    v_and_b32 v141, 0xffff0000, v150
    v_lshlrev_b32 v142, 16, v151
    v_and_b32 v143, 0xffff0000, v151
    v_lshlrev_b32 v144, 16, v152
    v_and_b32 v145, 0xffff0000, v152
    v_lshlrev_b32 v146, 16, v153
    v_and_b32 v147, 0xffff0000, v153
    v_lshlrev_b32 v148, 16, v154
    v_and_b32 v149, 0xffff0000, v154
    v_lshlrev_b32 v150, 16, v155
    v_and_b32 v151, 0xffff0000, v155
    v_lshlrev_b32 v152, 16, v156
    v_and_b32 v153, 0xffff0000, v156
    v_lshlrev_b32 v154, 16, v157
    v_and_b32 v155, 0xffff0000, v157
    v_lshlrev_b32 v156, 16, v158
    v_and_b32 v157, 0xffff0000, v158
    v_lshlrev_b32 v158, 16, v159
    v_and_b32 v159, 0xffff0000, v159
    v_pk_mul_f32 v[140:141], v[140:141], v[162:163] op_sel:[0,1] op_sel_hi:[1,1]
    v_pk_mul_f32 v[142:143], v[142:143], v[162:163] op_sel:[0,1] op_sel_hi:[1,1]
    v_pk_mul_f32 v[144:145], v[144:145], v[162:163] op_sel:[0,1] op_sel_hi:[1,1]
    v_pk_mul_f32 v[146:147], v[146:147], v[162:163] op_sel:[0,1] op_sel_hi:[1,1]
    v_pk_mul_f32 v[148:149], v[148:149], v[162:163] op_sel:[0,1] op_sel_hi:[1,1]
    v_pk_mul_f32 v[150:151], v[150:151], v[162:163] op_sel:[0,1] op_sel_hi:[1,1]
    v_pk_mul_f32 v[152:153], v[152:153], v[162:163] op_sel:[0,1] op_sel_hi:[1,1]
    v_pk_mul_f32 v[154:155], v[154:155], v[162:163] op_sel:[0,1] op_sel_hi:[1,1]
    v_pk_mul_f32 v[156:157], v[156:157], v[162:163] op_sel:[0,1] op_sel_hi:[1,1]
    v_pk_mul_f32 v[158:159], v[158:159], v[162:163] op_sel:[0,1] op_sel_hi:[1,1]
    s_setprio 1
    s_cmp_eq_u32 s34, 0
    s_cbranch_scc1 L_opb
    s_branch L_lgo
L_pada8:
    s_branch L_warmed_a
L_padb16:
    s_branch L_warmed_b
L_nogq:
    s_waitcnt lgkmcnt(0)
    s_waitcnt vmcnt(9)
    v_mfma_f32_16x16x32_bf16 v[8:11], v[68:71], v[28:31], 0
    ds_read_b128 v[68:71], v138 offset:16384
    v_mfma_f32_16x16x32_bf16 v[12:15], v[72:75], v[28:31], 0
    ds_read_b128 v[72:75], v138 offset:17408
    v_mfma_f32_16x16x32_bf16 v[16:19], v[76:79], v[28:31], 0
    ds_read_b128 v[76:79], v138 offset:18432
    v_mfma_f32_16x16x32_bf16 v[20:23], v[80:83], v[28:31], 0
    ds_read_b128 v[80:83], v138 offset:19456
    v_mfma_f32_16x16x32_bf16 v[24:27], v[84:87], v[28:31], 0
    ds_read_b128 v[84:87], v138 offset:20480
    s_waitcnt vmcnt(8)
    v_mfma_f32_16x16x32_bf16 v[8:11], v[88:91], v[32:35], v[8:11]
    ds_read_b128 v[88:91], v138 offset:21504
    v_mfma_f32_16x16x32_bf16 v[12:15], v[92:95], v[32:35], v[12:15]
    ds_read_b128 v[92:95], v138 offset:22528
    v_mfma_f32_16x16x32_bf16 v[16:19], v[96:99], v[32:35], v[16:19]
    ds_read_b128 v[96:99], v138 offset:23552
    v_mfma_f32_16x16x32_bf16 v[20:23], v[100:103], v[32:35], v[20:23]
    ds_read_b128 v[100:103], v138 offset:24576
    v_mfma_f32_16x16x32_bf16 v[24:27], v[104:107], v[32:35], v[24:27]
    ds_read_b128 v[104:107], v138 offset:25600
    s_waitcnt vmcnt(7)
    v_mfma_f32_16x16x32_bf16 v[8:11], v[108:111], v[36:39], v[8:11]
    ds_read_b128 v[108:111], v138 offset:26624
    v_mfma_f32_16x16x32_bf16 v[12:15], v[112:115], v[36:39], v[12:15]
    ds_read_b128 v[112:115], v138 offset:27648
    v_mfma_f32_16x16x32_bf16 v[16:19], v[116:119], v[36:39], v[16:19]
    s_waitcnt lgkmcnt(10)
    ds_read_b128 v[116:119], v138 offset:28672
    v_mfma_f32_16x16x32_bf16 v[20:23], v[120:123], v[36:39], v[20:23]
    ds_read_b128 v[120:123], v138 offset:29696
    v_mfma_f32_16x16x32_bf16 v[24:27], v[124:127], v[36:39], v[24:27]
    s_waitcnt lgkmcnt(10)
    ds_read_b128 v[124:127], v138 offset:30720
    s_waitcnt vmcnt(6)
    v_mfma_f32_16x16x32_bf16 v[8:11], v[128:131], v[40:43], v[8:11]
    ds_read_b128 v[128:131], v138 offset:31744
    v_mfma_f32_16x16x32_bf16 v[12:15], v[68:71], v[40:43], v[12:15]
    s_waitcnt lgkmcnt(10)
    ds_read_b128 v[68:71], v138 offset:32768
    v_mfma_f32_16x16x32_bf16 v[16:19], v[72:75], v[40:43], v[16:19]
    ds_read_b128 v[72:75], v138 offset:33792
    v_mfma_f32_16x16x32_bf16 v[20:23], v[76:79], v[40:43], v[20:23]
    s_waitcnt lgkmcnt(10)
    ds_read_b128 v[76:79], v138 offset:34816
    v_mfma_f32_16x16x32_bf16 v[24:27], v[80:83], v[40:43], v[24:27]
    ds_read_b128 v[80:83], v138 offset:35840
    s_waitcnt vmcnt(5)
    v_mfma_f32_16x16x32_bf16 v[8:11], v[84:87], v[44:47], v[8:11]
    s_waitcnt lgkmcnt(10)
    ds_read_b128 v[84:87], v138 offset:36864
    v_mfma_f32_16x16x32_bf16 v[12:15], v[88:91], v[44:47], v[12:15]
    ds_read_b128 v[88:91], v138 offset:37888
    v_mfma_f32_16x16x32_bf16 v[16:19], v[92:95], v[44:47], v[16:19]
    s_waitcnt lgkmcnt(10)
    ds_read_b128 v[92:95], v138 offset:38912
    v_mfma_f32_16x16x32_bf16 v[20:23], v[96:99], v[44:47], v[20:23]
    ds_read_b128 v[96:99], v138 offset:39936
    v_mfma_f32_16x16x32_bf16 v[24:27], v[100:103], v[44:47], v[24:27]
    s_waitcnt lgkmcnt(10)
    ds_read_b128 v[100:103], v138 offset:40960
    s_waitcnt vmcnt(4)
    v_mfma_f32_16x16x32_bf16 v[8:11], v[104:107], v[48:51], v[8:11]
    ds_read_b128 v[104:107], v138 offset:41984
    v_mfma_f32_16x16x32_bf16 v[12:15], v[108:111], v[48:51], v[12:15]
    s_waitcnt lgkmcnt(10)
    ds_read_b128 v[108:111], v138 offset:43008
    v_mfma_f32_16x16x32_bf16 v[16:19], v[112:115], v[48:51], v[16:19]
    ds_read_b128 v[112:115], v138 offset:44032
    v_mfma_f32_16x16x32_bf16 v[20:23], v[116:119], v[48:51], v[20:23]
    s_waitcnt lgkmcnt(10)
    ds_read_b128 v[116:119], v138 offset:45056
    v_mfma_f32_16x16x32_bf16 v[24:27], v[120:123], v[48:51], v[24:27]
    ds_read_b128 v[120:123], v138 offset:46080
    s_waitcnt vmcnt(3)
    v_mfma_f32_16x16x32_bf16 v[8:11], v[124:127], v[52:55], v[8:11]
    s_waitcnt lgkmcnt(10)
    ds_read_b128 v[124:127], v138 offset:47104
    v_mfma_f32_16x16x32_bf16 v[12:15], v[128:131], v[52:55], v[12:15]
    ds_read_b128 v[128:131], v138 offset:48128
    v_mfma_f32_16x16x32_bf16 v[16:19], v[68:71], v[52:55], v[16:19]
    s_waitcnt lgkmcnt(10)
    ds_read_b128 v[68:71], v138 offset:49152
    v_mfma_f32_16x16x32_bf16 v[20:23], v[72:75], v[52:55], v[20:23]
    ds_read_b128 v[72:75], v138 offset:50176
    v_mfma_f32_16x16x32_bf16 v[24:27], v[76:79], v[52:55], v[24:27]
    s_waitcnt vmcnt(0)
    v_mfma_f32_16x16x32_bf16 v[8:11], v[80:83], v[56:59], v[8:11]
    s_mov_b64 exec, s[66:67]
    global_store_dword v166, v134, s[28:29]
    s_mov_b64 exec, -1
    v_mfma_f32_16x16x32_bf16 v[12:15], v[84:87], v[56:59], v[12:15]
    v_mfma_f32_16x16x32_bf16 v[16:19], v[88:91], v[56:59], v[16:19]
    s_waitcnt lgkmcnt(11)
    v_mfma_f32_16x16x32_bf16 v[20:23], v[92:95], v[56:59], v[20:23]
    s_waitcnt lgkmcnt(10)
    v_mfma_f32_16x16x32_bf16 v[24:27], v[96:99], v[56:59], v[24:27]
    s_waitcnt lgkmcnt(9)
    v_mfma_f32_16x16x32_bf16 v[8:11], v[100:103], v[60:63], v[8:11]
    s_waitcnt lgkmcnt(8)
    v_mfma_f32_16x16x32_bf16 v[12:15], v[104:107], v[60:63], v[12:15]
    s_waitcnt lgkmcnt(7)
    v_mfma_f32_16x16x32_bf16 v[16:19], v[108:111], v[60:63], v[16:19]
    s_waitcnt lgkmcnt(6)
    v_mfma_f32_16x16x32_bf16 v[20:23], v[112:115], v[60:63], v[20:23]
    s_waitcnt lgkmcnt(5)
    v_mfma_f32_16x16x32_bf16 v[24:27], v[116:119], v[60:63], v[24:27]
    s_waitcnt lgkmcnt(4)
    v_mfma_f32_16x16x32_bf16 v[8:11], v[120:123], v[64:67], v[8:11]
    s_waitcnt lgkmcnt(3)
    v_mfma_f32_16x16x32_bf16 v[12:15], v[124:127], v[64:67], v[12:15]
    s_waitcnt lgkmcnt(2)
    v_mfma_f32_16x16x32_bf16 v[16:19], v[128:131], v[64:67], v[16:19]
    s_waitcnt lgkmcnt(1)
    v_mfma_f32_16x16x32_bf16 v[20:23], v[68:71], v[64:67], v[20:23]
    s_waitcnt lgkmcnt(0)
    v_mfma_f32_16x16x32_bf16 v[24:27], v[72:75], v[64:67], v[24:27]
    s_cmp_lg_u32 s101, 0
    s_cbranch_scc1 L_cvl
L_cvdl:
    s_setprio 3
    s_mov_b32 s100, 0
L_fb:
    ds_read_b32 v4, v160 offset:232
    ds_read_b128 v[28:31], v137 offset:0
    ds_read_b128 v[32:35], v137 offset:1024
    ds_read_b128 v[36:39], v137 offset:2048
    ds_read_b128 v[40:43], v137 offset:3072
    ds_read_b128 v[44:47], v137 offset:4096
    ds_read_b32 v5, v3 offset:212
    ds_read_b64_tr_b16 v[48:49], v164 offset:0
    ds_read_b64_tr_b16 v[50:51], v164 offset:2048
    ds_read_b64_tr_b16 v[52:53], v164 offset:4096
    ds_read_b64_tr_b16 v[54:55], v164 offset:6144
    ds_read_b64_tr_b16 v[56:57], v164 offset:8192
    s_waitcnt lgkmcnt(11)
    v_readfirstlane_b32 s96, v4
    s_cmp_lg_u32 s96, 0
    s_cbranch_scc1 L_fp
    s_waitcnt lgkmcnt(0)
    s_add_u32 s100, s100, 1
    s_cmp_lt_u32 s100, 1048576
    s_cbranch_scc1 L_fb
L_fp:
    s_mov_b64 exec, 0xffffffff
    global_load_dword v6, v166, s[28:29] sc1
    s_mov_b64 exec, -1
    s_waitcnt lgkmcnt(10)
    v_pk_add_f32 v[28:29], v[28:29], v[8:9]
    v_pk_add_f32 v[30:31], v[30:31], v[10:11]
    s_waitcnt lgkmcnt(9)
    v_pk_add_f32 v[32:33], v[32:33], v[12:13]
    v_pk_add_f32 v[34:35], v[34:35], v[14:15]
    s_waitcnt lgkmcnt(8)
    v_pk_add_f32 v[36:37], v[36:37], v[16:17]
    v_pk_add_f32 v[38:39], v[38:39], v[18:19]
    s_waitcnt lgkmcnt(7)
    v_pk_add_f32 v[40:41], v[40:41], v[20:21]
    v_pk_add_f32 v[42:43], v[42:43], v[22:23]
    s_waitcnt lgkmcnt(6)
    v_pk_add_f32 v[44:45], v[44:45], v[24:25]
    v_pk_add_f32 v[46:47], v[46:47], v[26:27]
    v_pk_mul_f32 v[28:29], v[28:29], v[162:163] op_sel_hi:[1,0]
    v_pk_mul_f32 v[30:31], v[30:31], v[162:163] op_sel_hi:[1,0]
    v_pk_mul_f32 v[32:33], v[32:33], v[162:163] op_sel_hi:[1,0]
    v_pk_mul_f32 v[34:35], v[34:35], v[162:163] op_sel_hi:[1,0]
    v_pk_mul_f32 v[36:37], v[36:37], v[162:163] op_sel_hi:[1,0]
    v_pk_mul_f32 v[38:39], v[38:39], v[162:163] op_sel_hi:[1,0]
    v_pk_mul_f32 v[40:41], v[40:41], v[162:163] op_sel_hi:[1,0]
    v_pk_mul_f32 v[42:43], v[42:43], v[162:163] op_sel_hi:[1,0]
    v_pk_mul_f32 v[44:45], v[44:45], v[162:163] op_sel_hi:[1,0]
    v_pk_mul_f32 v[46:47], v[46:47], v[162:163] op_sel_hi:[1,0]
    s_mov_b32 s100, 0
L_fy:
    s_waitcnt lgkmcnt(5)
    v_readfirstlane_b32 s96, v5
    s_cmp_eq_u32 s96, 2
    s_cbranch_scc1 L_fin
    ds_read_b32 v5, v3 offset:212
    ds_read_b64_tr_b16 v[48:49], v164 offset:0
    ds_read_b64_tr_b16 v[50:51], v164 offset:2048
    ds_read_b64_tr_b16 v[52:53], v164 offset:4096
    ds_read_b64_tr_b16 v[54:55], v164 offset:6144
    ds_read_b64_tr_b16 v[56:57], v164 offset:8192
    s_add_u32 s100, s100, 1
    s_cmp_lt_u32 s100, 1048576
    s_cbranch_scc1 L_fy
L_fin:
    s_waitcnt lgkmcnt(4)
    v_lshlrev_b32 v60, 16, v48
    v_and_b32 v61, 0xffff0000, v48
    v_lshlrev_b32 v62, 16, v49
    v_and_b32 v63, 0xffff0000, v49
    v_pk_fma_f32 v[28:29], v[60:61], v[140:141], v[28:29]
    v_pk_fma_f32 v[30:31], v[62:63], v[142:143], v[30:31]
    v_cvt_pk_bf16_f32 v48, v28, v29
    v_cvt_pk_bf16_f32 v49, v30, v31
    ds_write_b64 v161, v[48:49] offset:0
    s_waitcnt lgkmcnt(4)
    v_lshlrev_b32 v60, 16, v50
    v_and_b32 v61, 0xffff0000, v50
    v_lshlrev_b32 v62, 16, v51
    v_and_b32 v63, 0xffff0000, v51
    v_pk_fma_f32 v[32:33], v[60:61], v[144:145], v[32:33]
    v_pk_fma_f32 v[34:35], v[62:63], v[146:147], v[34:35]
    v_cvt_pk_bf16_f32 v50, v32, v33
    v_cvt_pk_bf16_f32 v51, v34, v35
    ds_write_b64 v161, v[50:51] offset:32
    s_waitcnt lgkmcnt(4)
    v_lshlrev_b32 v60, 16, v52
    v_and_b32 v61, 0xffff0000, v52
    v_lshlrev_b32 v62, 16, v53
    v_and_b32 v63, 0xffff0000, v53
    v_pk_fma_f32 v[36:37], v[60:61], v[148:149], v[36:37]
    v_pk_fma_f32 v[38:39], v[62:63], v[150:151], v[38:39]
    v_cvt_pk_bf16_f32 v52, v36, v37
    v_cvt_pk_bf16_f32 v53, v38, v39
    ds_write_b64 v161, v[52:53] offset:64
    s_waitcnt lgkmcnt(4)
    v_lshlrev_b32 v60, 16, v54
    v_and_b32 v61, 0xffff0000, v54
    v_lshlrev_b32 v62, 16, v55
    v_and_b32 v63, 0xffff0000, v55
    v_pk_fma_f32 v[40:41], v[60:61], v[152:153], v[40:41]
    v_pk_fma_f32 v[42:43], v[62:63], v[154:155], v[42:43]
    v_cvt_pk_bf16_f32 v54, v40, v41
    v_cvt_pk_bf16_f32 v55, v42, v43
    ds_write_b64 v161, v[54:55] offset:96
    s_waitcnt lgkmcnt(4)
    v_lshlrev_b32 v60, 16, v56
    v_and_b32 v61, 0xffff0000, v56
    v_lshlrev_b32 v62, 16, v57
    v_and_b32 v63, 0xffff0000, v57
    v_pk_fma_f32 v[44:45], v[60:61], v[156:157], v[44:45]
    v_pk_fma_f32 v[46:47], v[62:63], v[158:159], v[46:47]
    v_cvt_pk_bf16_f32 v56, v44, v45
    v_cvt_pk_bf16_f32 v57, v46, v47
    ds_write_b64 v161, v[56:57] offset:128
    ds_read_b128 v[72:75], v137 offset:0
    ds_read_b128 v[76:79], v137 offset:1024
    ds_read_b128 v[80:83], v137 offset:2048
    s_mov_b32 s100, 0
    s_cmp_lg_u32 s91, 1
    s_cbranch_scc1 L_gout
L_rdw:
    s_waitcnt vmcnt(0)
    v_cmp_ne_u32 vcc, s33, v6
    s_cmp_eq_u32 vcc_lo, 0
    s_cbranch_scc1 L_rdok
    s_mov_b64 exec, 0xffffffff
    global_load_dword v6, v166, s[28:29] sc1
    s_mov_b64 exec, -1
    s_add_u32 s100, s100, 1
    s_cmp_lt_u32 s100, 1048576
    s_cbranch_scc1 L_rdw
L_rdok:
    s_waitcnt lgkmcnt(2)
    global_store_dwordx4 v165, v[72:75], s[24:25]
    s_waitcnt lgkmcnt(1)
    global_store_dwordx4 v7, v[76:79], s[24:25]
    s_waitcnt lgkmcnt(0)
    s_mov_b64 exec, 0xffffffff
    global_store_dwordx4 v135, v[80:83], s[24:25]
    s_endpgm
L_pada9:
    s_branch L_warmed_a
L_padb17:
    s_branch L_warmed_b
L_rxslow:
    ds_read_b32 v6, v163 offset:264
    s_add_u32 s100, s100, 1
    s_cmp_lt_u32 s100, 1048576
    s_cbranch_scc1 L_rxw
    s_branch L_rxok
L_vxslow:
    ds_read_b32 v6, v163
    ds_read_b64 v[106:107], v162 offset:9216
    ds_read_b64 v[104:105], v162 offset:9728
    ds_read_b64 v[102:103], v162 offset:10240
    ds_read_b64 v[100:101], v162 offset:10752
    ds_read_b64 v[98:99], v162 offset:11264
    s_add_u32 s100, s100, 1
    s_cmp_lt_u32 s100, 1048576
    s_cbranch_scc1 L_vxw
    s_waitcnt lgkmcnt(0)
    s_branch L_vxok
.p2align 12
L_pada10:
    s_branch L_warmed_a
L_padb18:
    s_branch L_warmed_b
L_early:
    v_mov_b32 v5, 1
    global_load_dwordx4 v[28:31], v139, s[18:19] offset:-4096 sc1
    global_load_dwordx4 v[32:35], v139, s[18:19] offset:-2048 sc1
    global_load_dwordx4 v[36:39], v139, s[18:19] offset:0 sc1
    global_load_dwordx4 v[40:43], v139, s[18:19] offset:2048 sc1
    global_load_dwordx4 v[44:47], v139, s[62:63] offset:-4096 sc1
    s_lshr_b32 s96, s56, 1
    s_lshl_b32 s96, s96, 7
    s_add_u32 s96, s96, 3072
    v_add_u32 v166, s96, v166
    v_mov_b32 v134, s33
    s_and_b32 s96, s56, 1
    s_lshl1_add_u32 s96, s96, s57
    s_lshl2_add_u32 s96, s36, s96
    s_lshl_b64 s[66:67], 1, s96
    s_waitcnt lgkmcnt(0)
    s_waitcnt vmcnt(4)
    v_mfma_f32_16x16x32_bf16 v[8:11], v[68:71], v[28:31], 0
    ds_read_b128 v[68:71], v138 offset:16384
    v_mfma_f32_16x16x32_bf16 v[12:15], v[72:75], v[28:31], 0
    global_load_dwordx4 v[48:51], v139, s[62:63] offset:-2048 sc1
    ds_read_b128 v[72:75], v138 offset:17408
    v_mfma_f32_16x16x32_bf16 v[16:19], v[76:79], v[28:31], 0
    ds_read_b128 v[76:79], v138 offset:18432
    v_mfma_f32_16x16x32_bf16 v[20:23], v[80:83], v[28:31], 0
    global_load_dwordx4 v[52:55], v139, s[62:63] offset:0 sc1
    ds_write_b32 v160, v5 offset:216
    ds_read_b128 v[80:83], v138 offset:19456
    v_mfma_f32_16x16x32_bf16 v[24:27], v[84:87], v[28:31], 0
    ds_read_b128 v[84:87], v138 offset:20480
    s_waitcnt vmcnt(5)
    v_mfma_f32_16x16x32_bf16 v[8:11], v[88:91], v[32:35], v[8:11]
    ds_read_b128 v[88:91], v138 offset:21504
    v_mfma_f32_16x16x32_bf16 v[12:15], v[92:95], v[32:35], v[12:15]
    global_load_dwordx4 v[56:59], v139, s[62:63] offset:2048 sc1
    ds_read_b128 v[92:95], v138 offset:22528
    v_mfma_f32_16x16x32_bf16 v[16:19], v[96:99], v[32:35], v[16:19]
    ds_read_b128 v[96:99], v138 offset:23552
    v_mfma_f32_16x16x32_bf16 v[20:23], v[100:103], v[32:35], v[20:23]
    global_load_dwordx4 v[60:63], v139, s[64:65] offset:-4096 sc1
    ds_read_b128 v[100:103], v138 offset:24576
    v_mfma_f32_16x16x32_bf16 v[24:27], v[104:107], v[32:35], v[24:27]
    ds_read_b128 v[104:107], v138 offset:25600
    s_waitcnt vmcnt(6)
    v_mfma_f32_16x16x32_bf16 v[8:11], v[108:111], v[36:39], v[8:11]
    ds_read_b128 v[108:111], v138 offset:26624
    v_mfma_f32_16x16x32_bf16 v[12:15], v[112:115], v[36:39], v[12:15]
    global_load_dwordx4 v[64:67], v139, s[64:65] offset:-2048 sc1
    s_waitcnt lgkmcnt(9)
    ds_read_b128 v[112:115], v138 offset:27648
    v_mfma_f32_16x16x32_bf16 v[16:19], v[116:119], v[36:39], v[16:19]
    ds_read_b128 v[116:119], v138 offset:28672
    v_mfma_f32_16x16x32_bf16 v[20:23], v[120:123], v[36:39], v[20:23]
    s_waitcnt lgkmcnt(9)
    ds_read_b128 v[120:123], v138 offset:29696
    v_mfma_f32_16x16x32_bf16 v[24:27], v[124:127], v[36:39], v[24:27]
    ds_read_b128 v[124:127], v138 offset:30720
    s_waitcnt vmcnt(6)
    v_mfma_f32_16x16x32_bf16 v[8:11], v[128:131], v[40:43], v[8:11]
    s_waitcnt lgkmcnt(9)
    ds_read_b128 v[128:131], v138 offset:31744
    v_mfma_f32_16x16x32_bf16 v[12:15], v[68:71], v[40:43], v[12:15]
    ds_read_b128 v[68:71], v138 offset:32768
    v_mfma_f32_16x16x32_bf16 v[16:19], v[72:75], v[40:43], v[16:19]
    s_waitcnt lgkmcnt(9)
    ds_read_b128 v[72:75], v138 offset:33792
    v_mfma_f32_16x16x32_bf16 v[20:23], v[76:79], v[40:43], v[20:23]
    ds_read_b128 v[76:79], v138 offset:34816
    v_mfma_f32_16x16x32_bf16 v[24:27], v[80:83], v[40:43], v[24:27]
    s_waitcnt lgkmcnt(9)
    ds_read_b128 v[80:83], v138 offset:35840
    s_waitcnt vmcnt(5)
    v_mfma_f32_16x16x32_bf16 v[8:11], v[84:87], v[44:47], v[8:11]
    ds_read_b128 v[84:87], v138 offset:36864
    v_mfma_f32_16x16x32_bf16 v[12:15], v[88:91], v[44:47], v[12:15]
    s_waitcnt lgkmcnt(9)
    ds_read_b128 v[88:91], v138 offset:37888
    v_mfma_f32_16x16x32_bf16 v[16:19], v[92:95], v[44:47], v[16:19]
    ds_read_b128 v[92:95], v138 offset:38912
    v_mfma_f32_16x16x32_bf16 v[20:23], v[96:99], v[44:47], v[20:23]
    s_waitcnt lgkmcnt(9)
    ds_read_b128 v[96:99], v138 offset:39936
    v_mfma_f32_16x16x32_bf16 v[24:27], v[100:103], v[44:47], v[24:27]
    ds_read_b128 v[100:103], v138 offset:40960
    s_waitcnt vmcnt(4)
    v_mfma_f32_16x16x32_bf16 v[8:11], v[104:107], v[48:51], v[8:11]
    s_waitcnt lgkmcnt(9)
    ds_read_b128 v[104:107], v138 offset:41984
    v_mfma_f32_16x16x32_bf16 v[12:15], v[108:111], v[48:51], v[12:15]
    ds_read_b128 v[108:111], v138 offset:43008
    v_mfma_f32_16x16x32_bf16 v[16:19], v[112:115], v[48:51], v[16:19]
    s_waitcnt lgkmcnt(9)
    ds_read_b128 v[112:115], v138 offset:44032
    v_mfma_f32_16x16x32_bf16 v[20:23], v[116:119], v[48:51], v[20:23]
    ds_read_b128 v[116:119], v138 offset:45056
    v_mfma_f32_16x16x32_bf16 v[24:27], v[120:123], v[48:51], v[24:27]
    s_waitcnt lgkmcnt(9)
    ds_read_b128 v[120:123], v138 offset:46080
    s_waitcnt vmcnt(3)
    v_mfma_f32_16x16x32_bf16 v[8:11], v[124:127], v[52:55], v[8:11]
    ds_read_b128 v[124:127], v138 offset:47104
    v_mfma_f32_16x16x32_bf16 v[12:15], v[128:131], v[52:55], v[12:15]
    s_waitcnt lgkmcnt(9)
    ds_read_b128 v[128:131], v138 offset:48128
    v_mfma_f32_16x16x32_bf16 v[16:19], v[68:71], v[52:55], v[16:19]
    ds_read_b128 v[68:71], v138 offset:49152
    v_mfma_f32_16x16x32_bf16 v[20:23], v[72:75], v[52:55], v[20:23]
    s_waitcnt lgkmcnt(9)
    ds_read_b128 v[72:75], v138 offset:50176
    v_mfma_f32_16x16x32_bf16 v[24:27], v[76:79], v[52:55], v[24:27]
    s_waitcnt vmcnt(0)
    v_mfma_f32_16x16x32_bf16 v[8:11], v[80:83], v[56:59], v[8:11]
    s_mov_b64 exec, s[66:67]
    global_store_dword v166, v134, s[28:29]
    s_mov_b64 exec, -1
    v_mfma_f32_16x16x32_bf16 v[12:15], v[84:87], v[56:59], v[12:15]
    v_mfma_f32_16x16x32_bf16 v[16:19], v[88:91], v[56:59], v[16:19]
    v_mfma_f32_16x16x32_bf16 v[20:23], v[92:95], v[56:59], v[20:23]
    v_mfma_f32_16x16x32_bf16 v[24:27], v[96:99], v[56:59], v[24:27]
    s_waitcnt lgkmcnt(9)
    v_mfma_f32_16x16x32_bf16 v[8:11], v[100:103], v[60:63], v[8:11]
    s_waitcnt lgkmcnt(8)
    v_mfma_f32_16x16x32_bf16 v[12:15], v[104:107], v[60:63], v[12:15]
    s_waitcnt lgkmcnt(7)
    v_mfma_f32_16x16x32_bf16 v[16:19], v[108:111], v[60:63], v[16:19]
    s_waitcnt lgkmcnt(6)
    v_mfma_f32_16x16x32_bf16 v[20:23], v[112:115], v[60:63], v[20:23]
    s_waitcnt lgkmcnt(5)
    v_mfma_f32_16x16x32_bf16 v[24:27], v[116:119], v[60:63], v[24:27]
    s_waitcnt lgkmcnt(4)
    v_mfma_f32_16x16x32_bf16 v[8:11], v[120:123], v[64:67], v[8:11]
    s_waitcnt lgkmcnt(3)
    v_mfma_f32_16x16x32_bf16 v[12:15], v[124:127], v[64:67], v[12:15]
    s_waitcnt lgkmcnt(2)
    v_mfma_f32_16x16x32_bf16 v[16:19], v[128:131], v[64:67], v[16:19]
    s_waitcnt lgkmcnt(1)
    v_mfma_f32_16x16x32_bf16 v[20:23], v[68:71], v[64:67], v[20:23]
    s_waitcnt lgkmcnt(0)
    v_mfma_f32_16x16x32_bf16 v[24:27], v[72:75], v[64:67], v[24:27]
    s_setprio 0
    s_mov_b32 s100, 0
Lw_67:
    ds_read_b32 v4, v3 offset:196
    s_waitcnt lgkmcnt(0)
    v_readfirstlane_b32 s99, v4
    s_cmp_ge_u32 s99, 8
    s_cbranch_scc1 Lwd_68
    s_add_u32 s100, s100, 1
    s_cmp_lt_u32 s100, 1048576
    s_cbranch_scc1 Lw_67
Lwd_68:
    ds_write_b128 v137, v[8:11] offset:0
    ds_write_b128 v137, v[12:15] offset:1024
    ds_write_b128 v137, v[16:19] offset:2048
    ds_write_b128 v137, v[20:23] offset:3072
    ds_write_b128 v137, v[24:27] offset:4096
    v_mov_b32 v4, 2
    ds_write_b32 v160, v4 offset:232
    s_cmp_lg_u32 s101, 0
    s_cbranch_scc1 L_cve
L_cvde:
    s_endpgm
L_pada11:
    s_branch L_warmed_a
L_padb19:
    s_branch L_warmed_b
L_gout:
    s_waitcnt lgkmcnt(0)
    global_store_dwordx4 v165, v[72:75], s[24:25] sc1
    global_store_dwordx4 v7, v[76:79], s[24:25] sc1
    s_mov_b64 exec, 0xffffffff
    global_store_dwordx4 v135, v[80:83], s[24:25] sc1
    s_endpgm
L_cvl:
    s_cmp_ge_u32 s31, 26
    s_cselect_b32 s96, 8, 0
    s_lshl_b32 s97, s30, 8
    s_add_u32 s96, s96, s97
    s_add_u32 s96, s96, 65536
    s_and_b32 s98, s33, 0xffffff00
    s_mov_b64 exec, 0xffffffff
    s_mov_b32 s100, 0
L_cwl:
    v_subrev_u32 v132, s98, v133
    v_cmp_le_u32 vcc, 0x600, v132
    s_cbranch_vccz L_cxl
    s_mov_b64 exec, vcc
    v_lshlrev_b32 v68, 2, v0
    v_add_u32 v68, 161792, v68
    ds_read_b32 v70, v68
    v_mov_b32 v71, 0x100
    v_lshl_add_u32 v68, v0, 11, s96
    s_sleep 8
    s_waitcnt lgkmcnt(0)
    global_atomic_add_x2 v[132:133], v68, v[70:71], s[28:29] sc0 sc1
    s_waitcnt vmcnt(0)
    s_add_u32 s100, s100, 1
    s_cmp_lt_u32 s100, 1048576
    s_cbranch_scc1 L_cwl
L_cxl:
    s_mov_b64 exec, -1
    s_branch L_cvdl
L_cve:
    s_cmp_ge_u32 s31, 26
    s_cselect_b32 s96, 8, 0
    s_lshl_b32 s97, s30, 8
    s_add_u32 s96, s96, s97
    s_add_u32 s96, s96, 65536
    s_and_b32 s98, s33, 0xffffff00
    s_mov_b64 exec, 0xffffffff
    s_mov_b32 s100, 0
L_cwe:
    v_subrev_u32 v132, s98, v133
    v_cmp_le_u32 vcc, 0x600, v132
    s_cbranch_vccz L_cxe
    s_mov_b64 exec, vcc
    v_lshlrev_b32 v68, 2, v0
    v_add_u32 v68, 161792, v68
    ds_read_b32 v70, v68
    v_mov_b32 v71, 0x100
    v_lshl_add_u32 v68, v0, 11, s96
    s_sleep 8
    s_waitcnt lgkmcnt(0)
    global_atomic_add_x2 v[132:133], v68, v[70:71], s[28:29] sc0 sc1
    s_waitcnt vmcnt(0)
    s_add_u32 s100, s100, 1
    s_cmp_lt_u32 s100, 1048576
    s_cbranch_scc1 L_cwe
L_cxe:
    s_mov_b64 exec, -1
    s_branch L_cvde
L_awave:
    s_mov_b32 s58, 0
    s_waitcnt lgkmcnt(0)
    s_load_dword s33, s[28:29], 0
    s_lshl1_add_u32 s40, s30, s38
    s_sub_u32 s40, s40, 5
    s_lshl4_add_u32 s40, s65, s40
    s_cmp_ge_u32 s40, 100
    s_cbranch_scc1 L_nounit
    s_mul_i32 s41, s40, 205
    s_lshr_b32 s41, s41, 11
    s_mul_i32 s42, s41, 10
    s_sub_u32 s42, s40, s42
    v_lshrrev_b32 v4, 3, v0
    v_mul_u32_u24 v4, 1280, v4
    v_and_b32 v5, 7, v0
    v_lshl_add_u32 v4, v5, 4, v4
    s_mul_i32 s43, s41, 81920
    s_lshl_b32 s96, s42, 7
    s_add_u32 s43, s43, s96
    s_lshl_b32 s44, s65, 13
    s_add_u32 s44, s44, 90496
    s_mov_b32 m0, s44
    s_mov_b32 s48, s20
    s_and_b32 s49, s21, 0xffff
    s_mov_b32 s50, 819200
    s_mov_b32 s51, 0x00020000
    buffer_load_dwordx4 v4, s[48:51], s43 offen lds
    s_addk_i32 m0, 1024
    s_addk_i32 s43, 10240
    buffer_load_dwordx4 v4, s[48:51], s43 offen lds
    s_addk_i32 m0, 1024
    s_addk_i32 s43, 10240
    buffer_load_dwordx4 v4, s[48:51], s43 offen lds
    s_addk_i32 m0, 1024
    s_addk_i32 s43, 10240
    buffer_load_dwordx4 v4, s[48:51], s43 offen lds
    s_addk_i32 m0, 1024
    s_addk_i32 s43, 10240
    buffer_load_dwordx4 v4, s[48:51], s43 offen lds
    s_addk_i32 m0, 1024
    s_addk_i32 s43, 10240
    buffer_load_dwordx4 v4, s[48:51], s43 offen lds
    s_addk_i32 m0, 1024
    s_addk_i32 s43, 10240
    buffer_load_dwordx4 v4, s[48:51], s43 offen lds
    s_addk_i32 m0, 1024
    s_addk_i32 s43, 10240
    buffer_load_dwordx4 v4, s[48:51], s43 offen lds
    s_sub_u32 s45, s41, 5
    s_cselect_b32 s45, s41, s45
    s_mov_b32 s46, 0xf9af5600
    s_cmp_eq_u32 s45, 1
    s_cselect_b32 s46, 0xfeab5500, s46
    s_cmp_eq_u32 s45, 2
    s_cselect_b32 s46, 0xffaa5500, s46
    s_cmp_eq_u32 s45, 3
    s_cselect_b32 s46, 0xffaa1540, s46
    s_cmp_eq_u32 s45, 4
    s_cselect_b32 s46, 0xff6a0590, s46
    v_lshrrev_b32 v4, 2, v0
    v_and_b32 v5, 3, v0
    v_lshlrev_b32 v5, 3, v5
    v_lshl_add_u32 v4, v4, 7, v5
    v_add_u32 v4, s44, v4
    v_lshlrev_b32 v5, 1, v2
    v_bfe_u32 v8, s46, v5, 2
    v_lshl_add_u32 v8, v8, 11, v4
    s_lshr_b32 s46, s46, 8
    v_bfe_u32 v9, s46, v5, 2
    v_lshl_add_u32 v9, v9, 11, v4
    s_lshr_b32 s46, s46, 8
    v_bfe_u32 v10, s46, v5, 2
    v_lshl_add_u32 v10, v10, 11, v4
    s_lshr_b32 s46, s46, 8
    v_bfe_u32 v11, s46, v5, 2
    v_lshl_add_u32 v11, v11, 11, v4
    s_mul_i32 s41, s41, 5120
    s_add_u32 s41, s41, 9437184
    s_lshl2_add_u32 s96, s42, 0
    s_mul_i32 s97, s96, 205
    s_lshr_b32 s97, s97, 10
    s_mul_i32 s97, s97, 97280
    s_lshl_b32 s96, s96, 10
    s_add_u32 s96, s96, s97
    s_add_u32 s96, s96, s41
    v_lshl_add_u32 v12, v0, 4, s96
    s_lshl2_add_u32 s96, s42, 1
    s_mul_i32 s97, s96, 205
    s_lshr_b32 s97, s97, 10
    s_mul_i32 s97, s97, 97280
    s_lshl_b32 s96, s96, 10
    s_add_u32 s96, s96, s97
    s_add_u32 s96, s96, s41
    v_lshl_add_u32 v13, v0, 4, s96
    s_lshl2_add_u32 s96, s42, 2
    s_mul_i32 s97, s96, 205
    s_lshr_b32 s97, s97, 10
    s_mul_i32 s97, s97, 97280
    s_lshl_b32 s96, s96, 10
    s_add_u32 s96, s96, s97
    s_add_u32 s96, s96, s41
    v_lshl_add_u32 v14, v0, 4, s96
    s_lshl2_add_u32 s96, s42, 3
    s_mul_i32 s97, s96, 205
    s_lshr_b32 s97, s97, 10
    s_mul_i32 s97, s97, 97280
    s_lshl_b32 s96, s96, 10
    s_add_u32 s96, s96, s97
    s_add_u32 s96, s96, s41
    v_lshl_add_u32 v15, v0, 4, s96
    s_add_u32 s44, s28, 51200
    s_addc_u32 s45, s29, 0
    s_waitcnt vmcnt(8) lgkmcnt(0)
    s_barrier
    s_waitcnt vmcnt(0)
    ds_read_b64_tr_b16 v[48:49], v9 offset:0
    ds_read_b64_tr_b16 v[50:51], v10 offset:0
    ds_read_b64_tr_b16 v[52:53], v9 offset:32
    ds_read_b64_tr_b16 v[54:55], v10 offset:32
    ds_read_b64_tr_b16 v[56:57], v9 offset:64
    ds_read_b64_tr_b16 v[58:59], v10 offset:64
    ds_read_b64_tr_b16 v[60:61], v9 offset:96
    ds_read_b64_tr_b16 v[62:63], v10 offset:96
    s_waitcnt lgkmcnt(4)
    ds_read_b64_tr_b16 v[64:65], v8 offset:0
    ds_read_b64_tr_b16 v[66:67], v11 offset:0
    ds_read_b64_tr_b16 v[68:69], v8 offset:32
    ds_read_b64_tr_b16 v[70:71], v11 offset:32
    ds_read_b64_tr_b16 v[72:73], v8 offset:64
    ds_read_b64_tr_b16 v[74:75], v11 offset:64
    ds_read_b64_tr_b16 v[76:77], v8 offset:96
    ds_read_b64_tr_b16 v[78:79], v11 offset:96
    s_waitcnt lgkmcnt(0)
    global_store_dwordx4 v12, v[48:51], s[28:29] sc1
    global_store_dwordx4 v13, v[52:55], s[28:29] sc1
    global_store_dwordx4 v14, v[56:59], s[28:29] sc1
    global_store_dwordx4 v15, v[60:63], s[28:29] sc1
    global_store_dwordx4 v12, v[64:67], s[44:45] sc1
    global_store_dwordx4 v13, v[68:71], s[44:45] sc1
    global_store_dwordx4 v14, v[72:75], s[44:45] sc1
    global_store_dwordx4 v15, v[76:79], s[44:45] sc1
    s_branch L_notap
L_nounit:
    s_waitcnt lgkmcnt(0)
    s_barrier
    s_branch L_notap
.p2align 12
L_nopack:
    v_sub_u32 v4, v1, v2
    v_and_b32 v4, 3, v4
    v_and_or_b32 v4, v1, 12, v4
    v_lshrrev_b32 v5, 1, v4
    v_lshlrev_b32 v4, 4, v4
    s_setprio 2
    s_waitcnt lgkmcnt(0)
    v_cmp_eq_u32 vcc, 0, v5
    s_mov_b64 exec, vcc
    v_bfe_u32 v42, s40, v4, 16
    v_bfe_u32 v43, s48, v4, 16
    v_bfe_u32 v44, s76, v4, 16
    v_bfe_u32 v45, s84, v4, 16
    s_mov_b64 exec, -1
    v_cmp_eq_u32 vcc, 1, v5
    s_mov_b64 exec, vcc
    v_bfe_u32 v42, s41, v4, 16
    v_bfe_u32 v43, s49, v4, 16
    v_bfe_u32 v44, s77, v4, 16
    v_bfe_u32 v45, s85, v4, 16
    s_mov_b64 exec, -1
    v_cmp_eq_u32 vcc, 2, v5
    s_mov_b64 exec, vcc
    v_bfe_u32 v42, s42, v4, 16
    v_bfe_u32 v43, s50, v4, 16
    v_bfe_u32 v44, s78, v4, 16
    v_bfe_u32 v45, s86, v4, 16
    s_mov_b64 exec, -1
    v_cmp_eq_u32 vcc, 3, v5
    s_mov_b64 exec, vcc
    v_bfe_u32 v42, s43, v4, 16
    v_bfe_u32 v43, s51, v4, 16
    v_bfe_u32 v44, s79, v4, 16
    v_bfe_u32 v45, s87, v4, 16
    s_mov_b64 exec, -1
    v_cmp_eq_u32 vcc, 4, v5
    s_mov_b64 exec, vcc
    v_bfe_u32 v42, s44, v4, 16
    v_bfe_u32 v43, s52, v4, 16
    v_bfe_u32 v44, s80, v4, 16
    v_bfe_u32 v45, s88, v4, 16
    s_mov_b64 exec, -1
    v_cmp_eq_u32 vcc, 5, v5
    s_mov_b64 exec, vcc
    v_bfe_u32 v42, s45, v4, 16
    v_bfe_u32 v43, s53, v4, 16
    v_bfe_u32 v44, s81, v4, 16
    v_bfe_u32 v45, s89, v4, 16
    s_mov_b64 exec, -1
    v_cmp_eq_u32 vcc, 6, v5
    s_mov_b64 exec, vcc
    v_bfe_u32 v42, s46, v4, 16
    v_bfe_u32 v43, s54, v4, 16
    v_bfe_u32 v44, s82, v4, 16
    v_bfe_u32 v45, s90, v4, 16
    s_mov_b64 exec, -1
    v_cmp_eq_u32 vcc, 7, v5
    s_mov_b64 exec, vcc
    v_bfe_u32 v42, s47, v4, 16
    v_bfe_u32 v43, s55, v4, 16
    v_bfe_u32 v44, s83, v4, 16
    v_bfe_u32 v45, s91, v4, 16
    s_mov_b64 exec, -1
L_notap:
    s_setprio 2
    s_and_b32 s56, s65, 3
    s_lshr_b32 s57, s65, 2
    s_sub_u32 s96, s31, 20
    s_mul_i32 s97, s96, 43
    s_lshr_b32 s97, s97, 7
    s_mul_i32 s41, s96, 7
    s_sub_u32 s41, s41, s97
    s_mul_i32 s97, s97, 3
    s_sub_u32 s97, s96, s97
    s_cmp_eq_u32 s97, 2
    s_cselect_b32 s64, 6, 7
    s_mul_i32 s97, s30, 80
    s_add_u32 s41, s41, s97
    s_cmp_lt_u32 s65, s64
    s_cselect_b32 s52, 1, 0
    s_cselect_b32 s98, s65, 0
    s_cselect_b32 s20, 7, s64
    s_cselect_b32 s54, 0, 448
    s_add_u32 s41, s41, s98
    s_mul_i32 s42, s98, 8320
    s_mul_i32 s68, s98, 4608
    s_add_u32 s68, s68, 58240
    s_lshl_b32 s55, s41, 12
    v_lshlrev_b32 v8, 4, v0
    v_lshl_add_u32 v5, v1, 3, v2
    s_lshr_b32 s96, s65, 2
    s_mul_i32 s97, s96, 16896
    s_add_u32 s97, s97, 90496
    v_lshl_add_u32 v5, v5, 7, s97
    s_mul_i32 s45, s96, 512
    s_lshl_b32 s96, s65, 1
    v_xor_b32 v6, s96, v1
    v_and_b32 v6, 7, v6
    v_lshl_add_u32 v9, v6, 4, v5
    v_add_u32 v6, 7, v1
    v_xor_b32 v6, s96, v6
    v_and_b32 v6, 7, v6
    v_lshl_add_u32 v11, v6, 4, v5
    v_xor_b32 v10, 16, v9
    v_xor_b32 v12, 16, v11
    v_subrev_u32 v46, s45, v9
    v_subrev_u32 v47, s45, v10
    s_lshl_b32 s96, s58, 16
    s_lshl_b32 s97, s37, 8
    s_add_u32 s96, s96, s97
    s_add_u32 s96, s96, 1048576
    v_lshlrev_b32 v5, 12, v2
    v_lshl_add_u32 v5, v1, 4, v5
    v_add_u32 v14, s96, v5
    s_add_u32 s60, s28, 16384
    s_addc_u32 s61, s29, 0
    s_add_u32 s62, s28, 32768
    s_addc_u32 s63, s29, 0
    s_add_u32 s66, s28, 49152
    s_addc_u32 s67, s29, 0
    s_lshl4_add_u32 s96, s58, s37
    s_lshl_b32 s96, s96, 7
    s_add_u32 s96, s96, 262144
    v_add_u32 v5, v1, v2
    v_lshl_add_u32 v148, v5, 3, s96
    s_lshr_b32 s96, s41, 4
    s_lshl_b32 s96, s96, 11
    s_and_b32 s97, s41, 15
    s_lshl3_add_u32 s96, s97, s96
    s_add_u32 s96, s96, 262144
    v_lshl_add_u32 v149, v1, 7, s96
    s_waitcnt lgkmcnt(0)
    s_mul_i32 s33, s33, 1664525
    s_add_u32 s33, s33, 1013904223
    s_mov_b32 s43, s98
    v_bfe_u32 v5, v1, 2, 1
    v_lshlrev_b32 v5, 4, v5
    v_and_b32 v6, 3, v1
    v_lshrrev_b32 v7, 3, v1
    v_mov_b32 v4, 0x3f80
    v_lshlrev_b32 v4, v5, v4
    v_cmp_eq_u32 vcc, v6, v2
    s_nop 1
    v_cndmask_b32 v4, 0, v4, vcc
    v_cmp_eq_u32 vcc, 0, v7
    s_nop 1
    v_cndmask_b32 v40, 0, v4, vcc
    v_cndmask_b32 v41, v4, 0, vcc
    v_or_b32 v4, 2, v7
    v_cmp_ge_u32 vcc, v6, v2
    s_nop 1
    v_cndmask_b32 v7, v7, v4, vcc
    v_lshlrev_b32 v42, v5, v42
    v_lshlrev_b32 v43, v5, v43
    v_lshlrev_b32 v44, v5, v44
    v_lshlrev_b32 v45, v5, v45
    v_cmp_eq_u32 vcc, 0, v7
    s_nop 1
    v_cndmask_b32 v16, 0, v42, vcc
    v_cndmask_b32 v20, 0, v42, vcc
    v_cndmask_b32 v22, 0, v43, vcc
    v_cndmask_b32 v26, 0, v43, vcc
    v_cndmask_b32 v28, 0, v44, vcc
    v_cndmask_b32 v32, 0, v44, vcc
    v_cndmask_b32 v34, 0, v45, vcc
    v_cndmask_b32 v38, 0, v45, vcc
    v_cmp_eq_u32 vcc, 1, v7
    s_nop 1
    v_cndmask_b32 v17, 0, v42, vcc
    v_cndmask_b32 v21, 0, v42, vcc
    v_cndmask_b32 v23, 0, v43, vcc
    v_cndmask_b32 v27, 0, v43, vcc
    v_cndmask_b32 v29, 0, v44, vcc
    v_cndmask_b32 v33, 0, v44, vcc
    v_cndmask_b32 v35, 0, v45, vcc
    v_cndmask_b32 v39, 0, v45, vcc
    v_cmp_eq_u32 vcc, 2, v7
    s_nop 1
    v_cndmask_b32 v18, 0, v42, vcc
    v_cndmask_b32 v24, 0, v43, vcc
    v_cndmask_b32 v30, 0, v44, vcc
    v_cndmask_b32 v36, 0, v45, vcc
    v_cmp_eq_u32 vcc, 3, v7
    s_nop 1
    v_cndmask_b32 v19, 0, v42, vcc
    v_cndmask_b32 v25, 0, v43, vcc
    v_cndmask_b32 v31, 0, v44, vcc
    v_cndmask_b32 v37, 0, v45, vcc
    s_cmp_ge_u32 s38, 5
    s_cbranch_scc1 L_nokv
    s_barrier
    s_cmp_ge_u32 s38, 5
    s_cbranch_scc1 L_nokv
    ds_read_b128 v[48:51], v11
    ds_read_b128 v[52:55], v9 offset:512
    ds_read_b128 v[56:59], v9 offset:1024
    ds_read_b128 v[60:63], v46 offset:33792
    ds_read_b128 v[64:67], v46 offset:34304
    ds_read_b128 v[68:71], v12
    ds_read_b128 v[72:75], v10 offset:512
    ds_read_b128 v[76:79], v10 offset:1024
    ds_read_b128 v[80:83], v47 offset:33792
    ds_read_b128 v[84:87], v47 offset:34304
    s_waitcnt lgkmcnt(8)
    v_swap_b32 v50, v52
    v_swap_b32 v51, v53
    s_nop 1
    v_mfma_f32_16x16x32_bf16 v[88:91], v[16:19], v[48:51], 0
    v_mfma_f32_16x16x32_bf16 v[96:99], v[22:25], v[52:55], 0
    s_waitcnt lgkmcnt(7)
    v_mov_b64 v[48:49], v[56:57]
    v_mov_b64 v[52:53], v[58:59]
    s_nop 0
    v_mfma_f32_16x16x32_bf16 v[92:95], v[18:21], v[48:51], 0
    v_mfma_f32_16x16x32_bf16 v[100:103], v[24:27], v[52:55], 0
    s_waitcnt lgkmcnt(5)
    v_mfma_f32_16x16x16_bf16 v[104:107], v[40:41], v[60:61], 0
    v_mfma_f32_16x16x16_bf16 v[108:111], v[40:41], v[64:65], 0
    v_mfma_f32_16x16x16_bf16 v[112:115], v[40:41], v[62:63], 0
    v_mfma_f32_16x16x16_bf16 v[116:119], v[40:41], v[66:67], 0
    s_waitcnt lgkmcnt(3)
    v_swap_b32 v70, v72
    v_swap_b32 v71, v73
    s_nop 1
    v_mfma_f32_16x16x32_bf16 v[48:51], v[28:31], v[68:71], 0
    v_mfma_f32_16x16x32_bf16 v[56:59], v[34:37], v[72:75], 0
    s_waitcnt lgkmcnt(2)
    v_mov_b64 v[68:69], v[76:77]
    v_mov_b64 v[72:73], v[78:79]
    s_nop 0
    v_mfma_f32_16x16x32_bf16 v[52:55], v[30:33], v[68:71], 0
    v_mfma_f32_16x16x32_bf16 v[60:63], v[36:39], v[72:75], 0
    v_pk_mul_f32 v[88:89], v[88:89], v[104:105]
    v_pk_mul_f32 v[90:91], v[90:91], v[106:107]
    v_pk_mul_f32 v[92:93], v[92:93], v[108:109]
    v_pk_mul_f32 v[94:95], v[94:95], v[110:111]
    v_pk_mul_f32 v[96:97], v[96:97], v[112:113]
    v_pk_mul_f32 v[98:99], v[98:99], v[114:115]
    v_pk_mul_f32 v[100:101], v[100:101], v[116:117]
    v_pk_mul_f32 v[102:103], v[102:103], v[118:119]
    s_waitcnt lgkmcnt(0)
    v_mfma_f32_16x16x16_bf16 v[104:107], v[40:41], v[80:81], 0
    v_mfma_f32_16x16x16_bf16 v[108:111], v[40:41], v[84:85], 0
    v_mfma_f32_16x16x16_bf16 v[112:115], v[40:41], v[82:83], 0
    v_mfma_f32_16x16x16_bf16 v[116:119], v[40:41], v[86:87], 0
    v_cvt_pk_bf16_f32 v120, v88, v89
    v_cvt_pk_bf16_f32 v121, v90, v91
    v_cvt_pk_bf16_f32 v122, v92, v93
    v_cvt_pk_bf16_f32 v123, v94, v95
    global_store_dwordx4 v14, v[120:123], s[28:29] sc1
    v_cvt_pk_bf16_f32 v124, v96, v97
    v_cvt_pk_bf16_f32 v125, v98, v99
    v_cvt_pk_bf16_f32 v126, v100, v101
    v_cvt_pk_bf16_f32 v127, v102, v103
    global_store_dwordx4 v14, v[124:127], s[60:61] sc1
    v_add_u32 v76, v120, v121
    v_add3_u32 v76, v76, v122, v123
    v_add_u32 v77, v124, v125
    v_add3_u32 v77, v77, v126, v127
    v_pk_mul_f32 v[48:49], v[48:49], v[104:105]
    v_pk_mul_f32 v[50:51], v[50:51], v[106:107]
    v_pk_mul_f32 v[52:53], v[52:53], v[108:109]
    v_pk_mul_f32 v[54:55], v[54:55], v[110:111]
    v_pk_mul_f32 v[56:57], v[56:57], v[112:113]
    v_pk_mul_f32 v[58:59], v[58:59], v[114:115]
    v_pk_mul_f32 v[60:61], v[60:61], v[116:117]
    v_pk_mul_f32 v[62:63], v[62:63], v[118:119]
    v_cvt_pk_bf16_f32 v68, v48, v49
    v_cvt_pk_bf16_f32 v69, v50, v51
    v_cvt_pk_bf16_f32 v70, v52, v53
    v_cvt_pk_bf16_f32 v71, v54, v55
    global_store_dwordx4 v14, v[68:71], s[62:63] sc1
    v_cvt_pk_bf16_f32 v72, v56, v57
    v_cvt_pk_bf16_f32 v73, v58, v59
    v_cvt_pk_bf16_f32 v74, v60, v61
    v_cvt_pk_bf16_f32 v75, v62, v63
    global_store_dwordx4 v14, v[72:75], s[66:67] sc1
    v_add_u32 v78, v68, v69
    v_add3_u32 v78, v78, v70, v71
    v_add_u32 v79, v72, v73
    v_add3_u32 v79, v79, v74, v75
    v_add_u32_dpp v80, v76, v76 row_ror:8 row_mask:0xf bank_mask:0xf
    v_add_u32_dpp v81, v77, v77 row_ror:8 row_mask:0xf bank_mask:0xf
    s_nop 0
    v_add_u32_dpp v80, v78, v78 row_ror:8 row_mask:0xf bank_mask:0xc
    v_add_u32_dpp v81, v79, v79 row_ror:8 row_mask:0xf bank_mask:0xc
    v_mov_b32 v76, s33
    v_add_u32_dpp v77, v80, v80 row_half_mirror row_mask:0xf bank_mask:0xf
    s_nop 1
    v_add_u32_dpp v77, v81, v81 row_half_mirror row_mask:0xf bank_mask:0xa
    s_nop 1
    v_add_u32_dpp v77, v77, v77 quad_perm:[1,0,3,2] row_mask:0xf bank_mask:0xf
    s_nop 1
    v_add_u32_dpp v77, v77, v77 quad_perm:[2,3,0,1] row_mask:0xf bank_mask:0xf
    s_mov_b32 exec_lo, 0x11111111
    s_mov_b32 exec_hi, 0x11111111
    global_store_dwordx2 v148, v[76:77], s[28:29] sc1
    s_mov_b64 exec, -1
    v_mov_b32 v4, 1
    s_mov_b64 exec, 1
    ds_add_u32 v3, v4 offset:256
    s_mov_b64 exec, -1
L_nokv:
    s_setprio 1
    s_mov_b32 s98, s43
    s_add_u32 s96, s55, 1048576
    s_add_u32 s76, s28, s96
    s_addc_u32 s77, s29, 0
    s_and_b32 s77, s77, 0xffff
    s_mov_b32 s78, 4096
    s_mov_b32 s79, 0x00020000
    v_sub_u32 v5, 2031, v1
    v_and_b32 v6, 1, v5
    v_lshrrev_b32 v5, 1, v5
    v_lshl_add_u32 v5, v2, 2, v5
    v_lshlrev_b32 v5, 2, v5
    v_mul_u32_u24 v6, 4160, v6
    s_sub_u32 s96, s42, s54
    v_add3_u32 v5, v5, v6, s96
    v_subrev_u32 v154, 3584, v5
    v_subrev_u32 v155, 2560, v5
    v_subrev_u32 v156, 1536, v5
    v_subrev_u32 v157, 512, v5
    v_lshlrev_b32 v5, 5, v1
    v_lshl_add_u32 v5, v2, 4, v5
    s_sub_u32 s96, s68, s54
    s_add_u32 s96, s96, 480
    v_add_u32 v158, s96, v5
    v_and_b32 v5, 1, v2
    v_lshlrev_b32 v5, 9, v5
    v_lshl_add_u32 v5, v1, 5, v5
    v_lshrrev_b32 v6, 1, v2
    v_lshl_add_u32 v5, v6, 4, v5
    s_add_u32 s96, s55, 4194304
    v_add_u32 v153, s96, v5
    v_and_b32 v5, 28, v0
    v_add_u32 v159, 161792, v5
    s_cmp_ge_u32 s31, 26
    s_cselect_b32 s96, 8, 0
    s_lshl_b32 s97, s30, 8
    s_add_u32 s96, s96, s97
    s_add_u32 s96, s96, 65536
    v_and_b32 v5, 31, v0
    v_lshl_add_u32 v160, v5, 11, s96
    s_mul_i32 s96, s98, 2048
    s_add_u32 s96, s96, 88448
    v_add_u32 v161, s96, v8
    s_lshl_b32 s96, s98, 2
    v_add_u32 v162, s96, v3
    s_mul_i32 s96, s57, 51200
    s_sub_u32 s80, 109568, s96
    s_mul_i32 s81, s56, 2560
    s_add_u32 s81, s81, 48128
    s_mov_b32 s93, 0
    s_mov_b32 s101, 0
    s_and_b32 s98, s35, 3
    s_lshr_b32 s96, s56, 1
    s_lshl1_add_u32 s96, s98, s96
    s_lshl1_add_u32 s96, s96, s57
    s_mul_i32 s96, s96, 20480
    s_and_b32 s97, s56, 1
    s_lshl_b32 s97, s97, 10
    s_add_u32 s96, s96, s97
    s_mul_i32 s97, s30, 327680
    s_add_u32 s96, s96, s97
    s_add_u32 s82, s96, 4096
    s_mul_i32 s96, s30, 262144
    s_lshl_b32 s98, s98, 8
    s_add_u32 s96, s96, s98
    s_add_u32 s83, s96, 7536640
    s_mul_i32 s84, s56, 5120
    s_add_u32 s84, s84, 10240
    s_lshl2_add_u32 s96, s35, s56
    s_mul_i32 s96, s96, 20480
    s_mul_i32 s97, s36, 160
    s_add_u32 s85, s96, s97
    v_and_b32 v5, 1, v1
    v_lshlrev_b32 v5, 4, v5
    v_mov_b32 v6, 0x3f80
    v_lshlrev_b32 v6, v5, v6
    v_lshrrev_b32 v7, 1, v1
    v_lshlrev_b32 v4, 1, v2
    v_sub_u32 v4, v7, v4
    v_cmp_eq_u32 vcc, 0, v4
    s_nop 1
    v_cndmask_b32 v164, 0, v6, vcc
    v_cmp_eq_u32 vcc, 1, v4
    s_nop 1
    v_cndmask_b32 v165, 0, v6, vcc
    s_cmp_eq_u32 s32, 4
    s_cbranch_scc1 L_pada0
    s_cmp_eq_u32 s32, 5
    s_cbranch_scc1 L_pada1
    s_cmp_eq_u32 s32, 6
    s_cbranch_scc1 L_pada2
    s_cmp_eq_u32 s32, 7
    s_cbranch_scc1 L_pada3
    s_cmp_eq_u32 s32, 8
    s_cbranch_scc1 L_pada4
    s_cmp_eq_u32 s32, 9
    s_cbranch_scc1 L_pada5
    s_cmp_eq_u32 s32, 10
    s_cbranch_scc1 L_pada6
    s_branch L_pada7
L_pada12:
    s_branch L_warmed_a
L_warmed_a:
    s_cmp_lt_u32 s38, 5
    s_cbranch_scc1 L_kvd
    s_waitcnt vmcnt(0)
    v_mov_b32 v4, 1
    s_mov_b64 exec, 1
    ds_add_u32 v3, v4 offset:256
    s_mov_b64 exec, -1
L_kvd:
    s_setprio 2
    s_cmp_lg_u32 s52, 0
    s_cbranch_scc1 L_owner
    s_waitcnt vmcnt(0)
    v_mov_b32 v4, 1
    s_mov_b64 exec, 1
    ds_add_u32 v3, v4 offset:280
    s_mov_b64 exec, -1
    s_cmp_lg_u32 s65, 7
    s_cbranch_scc1 L_cdone
    s_mov_b32 s100, 0
Lw_69:
    ds_read_b32 v4, v3 offset:312
    s_waitcnt lgkmcnt(0)
    v_readfirstlane_b32 s99, v4
    s_cmp_ge_u32 s99, 1
    s_cbranch_scc1 Lwd_70
    s_add_u32 s100, s100, 1
    s_cmp_lt_u32 s100, 1048576
    s_cbranch_scc1 Lw_69
Lwd_70:
    ds_read2_b32 v[48:49], v157 offset0:128 offset1:129
    ds_read2_b32 v[50:51], v157 offset0:130 offset1:131
    ds_read2_b32 v[52:53], v157 offset0:0 offset1:1
    ds_read2_b32 v[54:55], v157 offset0:2 offset1:3
    ds_read2_b32 v[56:57], v156 offset0:128 offset1:129
    ds_read2_b32 v[58:59], v156 offset0:130 offset1:131
    ds_read2_b32 v[60:61], v156 offset0:0 offset1:1
    ds_read2_b32 v[62:63], v156 offset0:2 offset1:3
    ds_read2_b32 v[64:65], v155 offset0:128 offset1:129
    ds_read2_b32 v[66:67], v155 offset0:130 offset1:131
    ds_read2_b32 v[68:69], v155 offset0:0 offset1:1
    ds_read2_b32 v[70:71], v155 offset0:2 offset1:3
    s_waitcnt lgkmcnt(6)
    ds_read2_b32 v[72:73], v154 offset0:128 offset1:129
    ds_read2_b32 v[74:75], v154 offset0:130 offset1:131
    ds_read2_b32 v[76:77], v154 offset0:0 offset1:1
    ds_read2_b32 v[78:79], v154 offset0:2 offset1:3
    s_setprio 3
    v_mov_b32 v5, 1
    s_mov_b32 s100, 0
Lw_71:
    ds_read_b32 v4, v3 offset:280
    s_waitcnt lgkmcnt(0)
    v_readfirstlane_b32 s99, v4
    s_cmp_ge_u32 s99, 8
    s_cbranch_scc1 Lwd_72
    s_add_u32 s100, s100, 1
    s_cmp_lt_u32 s100, 1048576
    s_cbranch_scc1 Lw_71
Lwd_72:
    ds_read_b128 v[80:83], v158 offset:0
    ds_read_b128 v[84:87], v158 offset:512
    ds_read_b128 v[88:91], v158 offset:1024
    ds_read_b128 v[92:95], v158 offset:1536
    ds_read_b128 v[96:99], v158 offset:2048
    ds_read_b128 v[100:103], v158 offset:2560
    ds_read_b128 v[104:107], v158 offset:3072
    ds_read_b128 v[108:111], v158 offset:3584
    s_waitcnt lgkmcnt(0)
    s_setprio 2
    s_branch L_hloop
L_owner:
    v_mov_b32 v44, 0
    v_mov_b32 v45, 0
    v_lshl_add_u32 v5, v0, 3, s68
    ds_write_b64 v5, v[44:45]
    s_mov_b64 exec, 0xffff
    s_mov_b32 s100, 0
L_ep:
    global_atomic_or_x2 v[46:47], v149, v[44:45], s[28:29] sc0 sc1
    s_waitcnt vmcnt(0)
    v_cmp_ne_u32 vcc, s33, v46
    s_cbranch_vccz L_epd
    s_mov_b64 exec, vcc
    s_add_u32 s100, s100, 1
    s_cmp_lt_u32 s100, 1048576
    s_cbranch_scc1 L_ep
L_epd:
    s_mov_b64 exec, -1
    s_setprio 3
    s_mov_b32 s100, 0
    s_add_u32 m0, s68, 512
    s_nop 0
    buffer_load_dwordx4 v8, s[76:79], 0 offen offset:0 sc1 lds
    buffer_load_dwordx4 v8, s[76:79], 0 offen offset:1024 sc1 lds
    buffer_load_dwordx4 v8, s[76:79], 0 offen offset:2048 sc1 lds
    buffer_load_dwordx4 v8, s[76:79], 0 offen offset:3072 sc1 lds
    v_add_u32_dpp v47, v47, v47 row_ror:8 row_mask:0xf bank_mask:0xf
    s_nop 1
    v_add_u32_dpp v47, v47, v47 row_ror:4 row_mask:0xf bank_mask:0xf
    s_nop 1
    v_add_u32_dpp v47, v47, v47 row_ror:2 row_mask:0xf bank_mask:0xf
    s_nop 1
    v_add_u32_dpp v47, v47, v47 row_ror:1 row_mask:0xf bank_mask:0xf
    s_nop 0
    v_readfirstlane_b32 s60, v47
    s_mov_b32 s100, 0
Lw_73:
    ds_read_b32 v4, v162 offset:312
    s_waitcnt lgkmcnt(0)
    v_readfirstlane_b32 s99, v4
    s_cmp_ge_u32 s99, 1
    s_cbranch_scc1 Lwd_74
    s_add_u32 s100, s100, 1
    s_cmp_lt_u32 s100, 1048576
    s_cbranch_scc1 Lw_73
Lwd_74:
    ds_read2_b32 v[48:49], v157 offset0:128 offset1:129
    ds_read2_b32 v[50:51], v157 offset0:130 offset1:131
    ds_read2_b32 v[52:53], v157 offset0:0 offset1:1
    ds_read2_b32 v[54:55], v157 offset0:2 offset1:3
    ds_read2_b32 v[56:57], v156 offset0:128 offset1:129
    ds_read2_b32 v[58:59], v156 offset0:130 offset1:131
    ds_read2_b32 v[60:61], v156 offset0:0 offset1:1
    ds_read2_b32 v[62:63], v156 offset0:2 offset1:3
    ds_read2_b32 v[64:65], v155 offset0:128 offset1:129
    ds_read2_b32 v[66:67], v155 offset0:130 offset1:131
    ds_read2_b32 v[68:69], v155 offset0:0 offset1:1
    ds_read2_b32 v[70:71], v155 offset0:2 offset1:3
    s_waitcnt lgkmcnt(6)
    ds_read2_b32 v[72:73], v154 offset0:128 offset1:129
    ds_read2_b32 v[74:75], v154 offset0:130 offset1:131
    ds_read2_b32 v[76:77], v154 offset0:0 offset1:1
    ds_read2_b32 v[78:79], v154 offset0:2 offset1:3
    v_mov_b64 v[32:33], 0
    v_mov_b64 v[34:35], 0
    v_mov_b64 v[36:37], 0
    v_mov_b64 v[38:39], 0
    v_mov_b64 v[40:41], 0
    v_mov_b64 v[42:43], 0
    v_mov_b64 v[44:45], 0
    v_mov_b64 v[46:47], 0
    s_mov_b32 s100, 0
L_uretry:
    s_waitcnt vmcnt(0) lgkmcnt(0)
    ds_read_b128 v[80:83], v158 offset:0
    ds_read_b128 v[84:87], v158 offset:512
    ds_read_b128 v[88:91], v158 offset:1024
    ds_read_b128 v[92:95], v158 offset:1536
    ds_read_b128 v[96:99], v158 offset:2048
    ds_read_b128 v[100:103], v158 offset:2560
    ds_read_b128 v[104:107], v158 offset:3072
    ds_read_b128 v[108:111], v158 offset:3584
    s_waitcnt lgkmcnt(7)
    v_mfma_f32_16x16x32_bf16 v[16:19], v[48:51], v[80:83], 0
    v_add_u32 v9, v80, v81
    v_add3_u32 v9, v9, v82, v83
    s_waitcnt lgkmcnt(6)
    v_mfma_f32_16x16x32_bf16 v[20:23], v[48:51], v[84:87], 0
    v_add3_u32 v9, v9, v84, v85
    v_mfma_f32_16x16x32_bf16 v[20:23], v[52:55], v[80:83], v[20:23]
    v_add3_u32 v9, v9, v86, v87
    s_waitcnt lgkmcnt(5)
    v_mfma_f32_16x16x32_bf16 v[24:27], v[48:51], v[88:91], 0
    v_add3_u32 v9, v9, v88, v89
    v_mfma_f32_16x16x32_bf16 v[24:27], v[52:55], v[84:87], v[24:27]
    v_add3_u32 v9, v9, v90, v91
    s_waitcnt lgkmcnt(4)
    v_mfma_f32_16x16x32_bf16 v[24:27], v[56:59], v[80:83], v[24:27]
    v_add3_u32 v9, v9, v92, v93
    v_mfma_f32_16x16x32_bf16 v[28:31], v[48:51], v[92:95], 0
    v_add3_u32 v9, v9, v94, v95
    s_waitcnt lgkmcnt(3)
    v_mfma_f32_16x16x32_bf16 v[28:31], v[52:55], v[88:91], v[28:31]
    v_add3_u32 v9, v9, v96, v97
    v_mfma_f32_16x16x32_bf16 v[28:31], v[56:59], v[84:87], v[28:31]
    v_add3_u32 v9, v9, v98, v99
    s_waitcnt lgkmcnt(2)
    v_mfma_f32_16x16x32_bf16 v[28:31], v[60:63], v[80:83], v[28:31]
    v_add3_u32 v9, v9, v100, v101
    v_add3_u32 v9, v9, v102, v103
    s_waitcnt lgkmcnt(1)
    v_add3_u32 v9, v9, v104, v105
    v_add3_u32 v9, v9, v106, v107
    s_waitcnt lgkmcnt(0)
    v_add3_u32 v9, v9, v108, v109
    v_add3_u32 v9, v9, v110, v111
    s_nop 1
    v_add_u32_dpp v9, v9, v9 row_ror:8 row_mask:0xf bank_mask:0xf
    s_nop 1
    v_add_u32_dpp v9, v9, v9 row_ror:4 row_mask:0xf bank_mask:0xf
    s_nop 1
    v_add_u32_dpp v9, v9, v9 row_ror:2 row_mask:0xf bank_mask:0xf
    s_nop 1
    v_add_u32_dpp v9, v9, v9 row_ror:1 row_mask:0xf bank_mask:0xf
    s_nop 0
    v_readlane_b32 s96, v9, 32
    v_readlane_b32 s97, v9, 48
    v_mov_b32 v4, 1
    s_add_u32 s96, s96, s97
    s_cmp_eq_u32 s96, s60
    s_cbranch_scc1 L_uok
    buffer_load_dwordx4 v8, s[76:79], 0 offen offset:0 sc1 lds
    buffer_load_dwordx4 v8, s[76:79], 0 offen offset:1024 sc1 lds
    buffer_load_dwordx4 v8, s[76:79], 0 offen offset:2048 sc1 lds
    buffer_load_dwordx4 v8, s[76:79], 0 offen offset:3072 sc1 lds
    s_add_u32 s100, s100, 1
    s_cmp_lt_u32 s100, 1048576
    s_cbranch_scc1 L_uretry
L_uok:
    s_mov_b64 exec, 1
    ds_add_u32 v3, v4 offset:280
    s_mov_b64 exec, -1
    s_setprio 2
    v_subrev_u32 v154, 64, v154
    v_subrev_u32 v155, 64, v155
    v_subrev_u32 v156, 64, v156
    v_subrev_u32 v157, 64, v157
    v_subrev_u32 v158, 64, v158
    ds_read_b128 v[112:115], v158 offset:0
    ds_read_b128 v[116:119], v158 offset:512
    ds_read_b128 v[120:123], v158 offset:1024
    ds_read_b128 v[124:127], v158 offset:1536
    s_branch L_centry
.p2align 12
L_pada13:
    s_branch L_warmed_a
L_cloop:
    s_setprio 2
    s_cmp_gt_u32 s20, 6
    s_cbranch_scc1 Lcp_75
    s_setprio 1
    s_cmp_gt_u32 s20, 2
    s_cbranch_scc1 Lcp_75
    s_setprio 0
Lcp_75:
    v_subrev_u32 v154, 64, v154
    v_subrev_u32 v155, 64, v155
    v_subrev_u32 v156, 64, v156
    v_subrev_u32 v157, 64, v157
    v_subrev_u32 v158, 64, v158
    s_waitcnt lgkmcnt(14)
    v_mfma_f32_16x16x32_bf16 v[16:19], v[48:51], v[80:83], v[16:19]
    v_mfma_f32_16x16x32_bf16 v[20:23], v[48:51], v[84:87], v[20:23]
    s_waitcnt lgkmcnt(12)
    v_mfma_f32_16x16x32_bf16 v[20:23], v[52:55], v[80:83], v[20:23]
    v_mfma_f32_16x16x32_bf16 v[24:27], v[48:51], v[88:91], v[24:27]
    ds_read_b128 v[112:115], v158 offset:0
    v_mfma_f32_16x16x32_bf16 v[24:27], v[52:55], v[84:87], v[24:27]
    s_waitcnt lgkmcnt(11)
    v_mfma_f32_16x16x32_bf16 v[24:27], v[56:59], v[80:83], v[24:27]
    ds_read_b128 v[116:119], v158 offset:512
    v_mfma_f32_16x16x32_bf16 v[28:31], v[48:51], v[92:95], v[28:31]
    v_mfma_f32_16x16x32_bf16 v[28:31], v[52:55], v[88:91], v[28:31]
    ds_read_b128 v[120:123], v158 offset:1024
    v_mfma_f32_16x16x32_bf16 v[28:31], v[56:59], v[84:87], v[28:31]
    s_waitcnt lgkmcnt(11)
    v_mfma_f32_16x16x32_bf16 v[28:31], v[60:63], v[80:83], v[28:31]
    ds_read_b128 v[124:127], v158 offset:1536
L_centry:
    v_mfma_f32_16x16x32_bf16 v[32:35], v[48:51], v[96:99], v[32:35]
    v_mfma_f32_16x16x32_bf16 v[32:35], v[52:55], v[92:95], v[32:35]
    ds_read_b128 v[128:131], v158 offset:2048
    v_mfma_f32_16x16x32_bf16 v[32:35], v[56:59], v[88:91], v[32:35]
    v_mfma_f32_16x16x32_bf16 v[32:35], v[60:63], v[84:87], v[32:35]
    ds_read_b128 v[132:135], v158 offset:2560
    s_waitcnt lgkmcnt(12)
    v_mfma_f32_16x16x32_bf16 v[32:35], v[64:67], v[80:83], v[32:35]
    v_mfma_f32_16x16x32_bf16 v[36:39], v[48:51], v[100:103], v[36:39]
    ds_read_b128 v[136:139], v158 offset:3072
    v_mfma_f32_16x16x32_bf16 v[36:39], v[52:55], v[96:99], v[36:39]
    v_mfma_f32_16x16x32_bf16 v[36:39], v[56:59], v[92:95], v[36:39]
    ds_read_b128 v[140:143], v158 offset:3584
    v_mfma_f32_16x16x32_bf16 v[36:39], v[60:63], v[88:91], v[36:39]
    v_mfma_f32_16x16x32_bf16 v[36:39], v[64:67], v[84:87], v[36:39]
    s_waitcnt lgkmcnt(12)
    v_mfma_f32_16x16x32_bf16 v[36:39], v[68:71], v[80:83], v[36:39]
    v_mfma_f32_16x16x32_bf16 v[40:43], v[48:51], v[104:107], v[40:43]
    v_mfma_f32_16x16x32_bf16 v[40:43], v[52:55], v[100:103], v[40:43]
    v_mfma_f32_16x16x32_bf16 v[40:43], v[56:59], v[96:99], v[40:43]
    v_mfma_f32_16x16x32_bf16 v[40:43], v[60:63], v[92:95], v[40:43]
    v_mfma_f32_16x16x32_bf16 v[40:43], v[64:67], v[88:91], v[40:43]
    v_mfma_f32_16x16x32_bf16 v[40:43], v[68:71], v[84:87], v[40:43]
    s_waitcnt lgkmcnt(10)
    v_mfma_f32_16x16x32_bf16 v[40:43], v[72:75], v[80:83], v[40:43]
    v_mfma_f32_16x16x32_bf16 v[44:47], v[48:51], v[108:111], v[44:47]
    ds_read2_b32 v[48:49], v157 offset0:128 offset1:129
    ds_read2_b32 v[50:51], v157 offset0:130 offset1:131
    v_mfma_f32_16x16x32_bf16 v[44:47], v[52:55], v[104:107], v[44:47]
    ds_read2_b32 v[52:53], v157 offset0:0 offset1:1
    ds_read2_b32 v[54:55], v157 offset0:2 offset1:3
    v_mfma_f32_16x16x32_bf16 v[44:47], v[56:59], v[100:103], v[44:47]
    s_waitcnt lgkmcnt(12)
    ds_read2_b32 v[56:57], v156 offset0:128 offset1:129
    ds_read2_b32 v[58:59], v156 offset0:130 offset1:131
    v_mfma_f32_16x16x32_bf16 v[44:47], v[60:63], v[96:99], v[44:47]
    s_waitcnt lgkmcnt(12)
    ds_read2_b32 v[60:61], v156 offset0:0 offset1:1
    ds_read2_b32 v[62:63], v156 offset0:2 offset1:3
    v_mfma_f32_16x16x32_bf16 v[44:47], v[64:67], v[92:95], v[44:47]
    s_waitcnt lgkmcnt(12)
    ds_read2_b32 v[64:65], v155 offset0:128 offset1:129
    ds_read2_b32 v[66:67], v155 offset0:130 offset1:131
    v_mfma_f32_16x16x32_bf16 v[44:47], v[68:71], v[88:91], v[44:47]
    s_waitcnt lgkmcnt(12)
    ds_read2_b32 v[68:69], v155 offset0:0 offset1:1
    ds_read2_b32 v[70:71], v155 offset0:2 offset1:3
    v_mfma_f32_16x16x32_bf16 v[44:47], v[72:75], v[84:87], v[44:47]
    s_waitcnt lgkmcnt(12)
    ds_read2_b32 v[72:73], v154 offset0:128 offset1:129
    ds_read2_b32 v[74:75], v154 offset0:130 offset1:131
    v_mfma_f32_16x16x32_bf16 v[44:47], v[76:79], v[80:83], v[44:47]
    s_waitcnt lgkmcnt(12)
    ds_read2_b32 v[76:77], v154 offset0:0 offset1:1
    ds_read2_b32 v[78:79], v154 offset0:2 offset1:3
    v_subrev_u32 v154, 64, v154
    v_subrev_u32 v155, 64, v155
    v_subrev_u32 v156, 64, v156
    v_subrev_u32 v157, 64, v157
    v_subrev_u32 v158, 64, v158
    v_mfma_f32_16x16x32_bf16 v[16:19], v[48:51], v[112:115], v[16:19]
    v_mfma_f32_16x16x32_bf16 v[20:23], v[48:51], v[116:119], v[20:23]
    s_waitcnt lgkmcnt(12)
    v_mfma_f32_16x16x32_bf16 v[20:23], v[52:55], v[112:115], v[20:23]
    v_mfma_f32_16x16x32_bf16 v[24:27], v[48:51], v[120:123], v[24:27]
    ds_read_b128 v[80:83], v158 offset:0
    v_mfma_f32_16x16x32_bf16 v[24:27], v[52:55], v[116:119], v[24:27]
    s_waitcnt lgkmcnt(11)
    v_mfma_f32_16x16x32_bf16 v[24:27], v[56:59], v[112:115], v[24:27]
    ds_read_b128 v[84:87], v158 offset:512
    v_mfma_f32_16x16x32_bf16 v[28:31], v[48:51], v[124:127], v[28:31]
    v_mfma_f32_16x16x32_bf16 v[28:31], v[52:55], v[120:123], v[28:31]
    ds_read_b128 v[88:91], v158 offset:1024
    v_mfma_f32_16x16x32_bf16 v[28:31], v[56:59], v[116:119], v[28:31]
    s_waitcnt lgkmcnt(11)
    v_mfma_f32_16x16x32_bf16 v[28:31], v[60:63], v[112:115], v[28:31]
    ds_read_b128 v[92:95], v158 offset:1536
    v_mfma_f32_16x16x32_bf16 v[32:35], v[48:51], v[128:131], v[32:35]
    v_mfma_f32_16x16x32_bf16 v[32:35], v[52:55], v[124:127], v[32:35]
    ds_read_b128 v[96:99], v158 offset:2048
    v_mfma_f32_16x16x32_bf16 v[32:35], v[56:59], v[120:123], v[32:35]
    v_mfma_f32_16x16x32_bf16 v[32:35], v[60:63], v[116:119], v[32:35]
    ds_read_b128 v[100:103], v158 offset:2560
    s_waitcnt lgkmcnt(12)
    v_mfma_f32_16x16x32_bf16 v[32:35], v[64:67], v[112:115], v[32:35]
    v_mfma_f32_16x16x32_bf16 v[36:39], v[48:51], v[132:135], v[36:39]
    ds_read_b128 v[104:107], v158 offset:3072
    v_mfma_f32_16x16x32_bf16 v[36:39], v[52:55], v[128:131], v[36:39]
    v_mfma_f32_16x16x32_bf16 v[36:39], v[56:59], v[124:127], v[36:39]
    ds_read_b128 v[108:111], v158 offset:3584
    v_mfma_f32_16x16x32_bf16 v[36:39], v[60:63], v[120:123], v[36:39]
    v_mfma_f32_16x16x32_bf16 v[36:39], v[64:67], v[116:119], v[36:39]
    s_waitcnt lgkmcnt(12)
    v_mfma_f32_16x16x32_bf16 v[36:39], v[68:71], v[112:115], v[36:39]
    v_mfma_f32_16x16x32_bf16 v[40:43], v[48:51], v[136:139], v[40:43]
    v_mfma_f32_16x16x32_bf16 v[40:43], v[52:55], v[132:135], v[40:43]
    v_mfma_f32_16x16x32_bf16 v[40:43], v[56:59], v[128:131], v[40:43]
    v_mfma_f32_16x16x32_bf16 v[40:43], v[60:63], v[124:127], v[40:43]
    v_mfma_f32_16x16x32_bf16 v[40:43], v[64:67], v[120:123], v[40:43]
    v_mfma_f32_16x16x32_bf16 v[40:43], v[68:71], v[116:119], v[40:43]
    s_waitcnt lgkmcnt(10)
    v_mfma_f32_16x16x32_bf16 v[40:43], v[72:75], v[112:115], v[40:43]
    v_mfma_f32_16x16x32_bf16 v[44:47], v[48:51], v[140:143], v[44:47]
    ds_read2_b32 v[48:49], v157 offset0:128 offset1:129
    ds_read2_b32 v[50:51], v157 offset0:130 offset1:131
    v_mfma_f32_16x16x32_bf16 v[44:47], v[52:55], v[136:139], v[44:47]
    ds_read2_b32 v[52:53], v157 offset0:0 offset1:1
    ds_read2_b32 v[54:55], v157 offset0:2 offset1:3
    v_mfma_f32_16x16x32_bf16 v[44:47], v[56:59], v[132:135], v[44:47]
    s_waitcnt lgkmcnt(12)
    ds_read2_b32 v[56:57], v156 offset0:128 offset1:129
    ds_read2_b32 v[58:59], v156 offset0:130 offset1:131
    v_mfma_f32_16x16x32_bf16 v[44:47], v[60:63], v[128:131], v[44:47]
    s_waitcnt lgkmcnt(12)
    ds_read2_b32 v[60:61], v156 offset0:0 offset1:1
    ds_read2_b32 v[62:63], v156 offset0:2 offset1:3
    v_mfma_f32_16x16x32_bf16 v[44:47], v[64:67], v[124:127], v[44:47]
    s_waitcnt lgkmcnt(12)
    ds_read2_b32 v[64:65], v155 offset0:128 offset1:129
    ds_read2_b32 v[66:67], v155 offset0:130 offset1:131
    v_mfma_f32_16x16x32_bf16 v[44:47], v[68:71], v[120:123], v[44:47]
    s_waitcnt lgkmcnt(12)
    ds_read2_b32 v[68:69], v155 offset0:0 offset1:1
    ds_read2_b32 v[70:71], v155 offset0:2 offset1:3
    v_mfma_f32_16x16x32_bf16 v[44:47], v[72:75], v[116:119], v[44:47]
    s_waitcnt lgkmcnt(12)
    ds_read2_b32 v[72:73], v154 offset0:128 offset1:129
    ds_read2_b32 v[74:75], v154 offset0:130 offset1:131
    v_mfma_f32_16x16x32_bf16 v[44:47], v[76:79], v[112:115], v[44:47]
    s_waitcnt lgkmcnt(12)
    ds_read2_b32 v[76:77], v154 offset0:0 offset1:1
    ds_read2_b32 v[78:79], v154 offset0:2 offset1:3
    s_sub_u32 s20, s20, 2
    s_cmp_lg_u32 s20, 1
    s_cbranch_scc1 L_cloop
L_cexit:
    s_setprio 0
    v_subrev_u32 v156, 64, v156
    v_subrev_u32 v157, 64, v157
    v_subrev_u32 v158, 64, v158
    s_mov_b32 s100, 0
Lw_76:
    ds_read_b32 v4, v162 offset:284
    s_waitcnt lgkmcnt(0)
    v_readfirstlane_b32 s99, v4
    s_cmp_ge_u32 s99, 1
    s_cbranch_scc1 Lwd_77
    s_add_u32 s100, s100, 1
    s_cmp_lt_u32 s100, 1048576
    s_cbranch_scc1 Lw_76
Lwd_77:
    ds_read_b128 v[144:147], v161 offset:2048
    ds_read_b128 v[148:151], v161 offset:3072
    ds_read_b128 v[112:115], v158 offset:0
    ds_read2_b32 v[128:129], v157 offset0:128 offset1:129
    ds_read2_b32 v[130:131], v157 offset0:130 offset1:131
    ds_read_b128 v[116:119], v158 offset:512
    ds_read2_b32 v[132:133], v157 offset0:0 offset1:1
    ds_read2_b32 v[134:135], v157 offset0:2 offset1:3
    ds_read_b128 v[120:123], v158 offset:1024
    ds_read2_b32 v[136:137], v156 offset0:128 offset1:129
    ds_read2_b32 v[138:139], v156 offset0:130 offset1:131
    ds_read_b128 v[124:127], v158 offset:1536
    ds_read2_b32 v[140:141], v156 offset0:0 offset1:1
    ds_read2_b32 v[142:143], v156 offset0:2 offset1:3
    s_mov_b32 s62, 0x11111111
    s_mov_b32 s63, 0x11111111
    v_mfma_f32_16x16x32_bf16 v[32:35], v[48:51], v[96:99], v[32:35]
    v_mfma_f32_16x16x32_bf16 v[32:35], v[52:55], v[92:95], v[32:35]
    v_mfma_f32_16x16x32_bf16 v[32:35], v[56:59], v[88:91], v[32:35]
    v_mfma_f32_16x16x32_bf16 v[32:35], v[60:63], v[84:87], v[32:35]
    v_mfma_f32_16x16x32_bf16 v[32:35], v[64:67], v[80:83], v[32:35]
    v_mfma_f32_16x16x32_bf16 v[36:39], v[48:51], v[100:103], v[36:39]
    v_mfma_f32_16x16x32_bf16 v[36:39], v[52:55], v[96:99], v[36:39]
    v_mfma_f32_16x16x32_bf16 v[36:39], v[56:59], v[92:95], v[36:39]
    v_mfma_f32_16x16x32_bf16 v[36:39], v[60:63], v[88:91], v[36:39]
    v_mfma_f32_16x16x32_bf16 v[36:39], v[64:67], v[84:87], v[36:39]
    v_mfma_f32_16x16x32_bf16 v[36:39], v[68:71], v[80:83], v[36:39]
    s_waitcnt lgkmcnt(12)
    v_mfma_f32_16x16x16_bf16 v[32:35], v[164:165], v[144:145], v[32:35]
    v_mfma_f32_16x16x16_bf16 v[40:43], v[164:165], v[148:149], v[40:43]
    v_mfma_f32_16x16x16_bf16 v[44:47], v[164:165], v[150:151], v[44:47]
    s_nop 1
    v_mfma_f32_16x16x16_bf16 v[36:39], v[164:165], v[146:147], v[36:39]
    s_waitcnt lgkmcnt(0)
    v_mfma_f32_16x16x32_bf16 v[16:19], v[48:51], v[80:83], v[16:19]
    v_mfma_f32_16x16x32_bf16 v[16:19], v[128:131], v[112:115], v[16:19]
    v_mfma_f32_16x16x32_bf16 v[20:23], v[48:51], v[84:87], v[20:23]
    v_cvt_pk_bf16_f32 v8, v32, v33
    v_cvt_pk_bf16_f32 v9, v34, v35
    v_mfma_f32_16x16x32_bf16 v[20:23], v[52:55], v[80:83], v[20:23]
    s_nop 0
    v_cvt_pk_bf16_f32 v10, v36, v37
    v_cvt_pk_bf16_f32 v11, v38, v39
    v_mfma_f32_16x16x32_bf16 v[20:23], v[128:131], v[116:119], v[20:23]
    v_permlane16_swap_b32 v8, v10
    v_permlane16_swap_b32 v9, v11
    v_mfma_f32_16x16x32_bf16 v[20:23], v[132:135], v[112:115], v[20:23]
    global_store_dwordx4 v153, v[8:11], s[28:29] offset:2048 sc1
    v_add_u32 v6, v8, v9
    v_mfma_f32_16x16x32_bf16 v[24:27], v[48:51], v[88:91], v[24:27]
    v_mfma_f32_16x16x32_bf16 v[24:27], v[52:55], v[84:87], v[24:27]
    v_mfma_f32_16x16x32_bf16 v[24:27], v[56:59], v[80:83], v[24:27]
    v_add3_u32 v6, v6, v10, v11
    s_nop 1
    v_add_u32_dpp v6, v6, v6 quad_perm:[1,0,3,2] row_mask:0xf bank_mask:0xf
    v_mfma_f32_16x16x32_bf16 v[24:27], v[128:131], v[120:123], v[24:27]
    s_nop 0
    v_add_u32_dpp v6, v6, v6 quad_perm:[2,3,0,1] row_mask:0xf bank_mask:0xf
    s_mov_b64 exec, s[62:63]
    ds_add_u32 v159, v6 offset:64
    s_mov_b64 exec, -1
    v_mfma_f32_16x16x32_bf16 v[24:27], v[132:135], v[116:119], v[24:27]
    v_cvt_pk_bf16_f32 v12, v16, v17
    v_cvt_pk_bf16_f32 v13, v18, v19
    v_mfma_f32_16x16x32_bf16 v[24:27], v[136:139], v[112:115], v[24:27]
    v_cvt_pk_bf16_f32 v14, v20, v21
    v_cvt_pk_bf16_f32 v15, v22, v23
    v_mfma_f32_16x16x32_bf16 v[28:31], v[48:51], v[92:95], v[28:31]
    v_permlane16_swap_b32 v12, v14
    v_permlane16_swap_b32 v13, v15
    v_mfma_f32_16x16x32_bf16 v[28:31], v[52:55], v[88:91], v[28:31]
    global_store_dwordx4 v153, v[12:15], s[28:29] offset:0 sc1
    v_add_u32 v6, v12, v13
    v_mfma_f32_16x16x32_bf16 v[28:31], v[56:59], v[84:87], v[28:31]
    v_add3_u32 v6, v6, v14, v15
    s_nop 1
    v_add_u32_dpp v6, v6, v6 quad_perm:[1,0,3,2] row_mask:0xf bank_mask:0xf
    v_mfma_f32_16x16x32_bf16 v[28:31], v[60:63], v[80:83], v[28:31]
    s_nop 0
    v_add_u32_dpp v6, v6, v6 quad_perm:[2,3,0,1] row_mask:0xf bank_mask:0xf
    s_mov_b64 exec, s[62:63]
    ds_add_u32 v159, v6 offset:0
    s_mov_b64 exec, -1
    v_mfma_f32_16x16x32_bf16 v[28:31], v[128:131], v[124:127], v[28:31]
    v_mfma_f32_16x16x32_bf16 v[28:31], v[132:135], v[120:123], v[28:31]
    v_mfma_f32_16x16x32_bf16 v[28:31], v[136:139], v[116:119], v[28:31]
    v_mfma_f32_16x16x32_bf16 v[28:31], v[140:143], v[112:115], v[28:31]
    v_mfma_f32_16x16x32_bf16 v[40:43], v[48:51], v[104:107], v[40:43]
    v_mfma_f32_16x16x32_bf16 v[40:43], v[52:55], v[100:103], v[40:43]
    v_mfma_f32_16x16x32_bf16 v[40:43], v[56:59], v[96:99], v[40:43]
    v_cvt_pk_bf16_f32 v8, v24, v25
    v_cvt_pk_bf16_f32 v9, v26, v27
    v_mfma_f32_16x16x32_bf16 v[40:43], v[60:63], v[92:95], v[40:43]
    s_nop 1
    v_cvt_pk_bf16_f32 v10, v28, v29
    v_cvt_pk_bf16_f32 v11, v30, v31
    v_mfma_f32_16x16x32_bf16 v[40:43], v[64:67], v[88:91], v[40:43]
    v_permlane16_swap_b32 v8, v10
    v_permlane16_swap_b32 v9, v11
    v_mfma_f32_16x16x32_bf16 v[40:43], v[68:71], v[84:87], v[40:43]
    global_store_dwordx4 v153, v[8:11], s[28:29] offset:1024 sc1
    v_add_u32 v6, v8, v9
    v_mfma_f32_16x16x32_bf16 v[40:43], v[72:75], v[80:83], v[40:43]
    v_add3_u32 v6, v6, v10, v11
    s_nop 1
    v_add_u32_dpp v6, v6, v6 quad_perm:[1,0,3,2] row_mask:0xf bank_mask:0xf
    v_mfma_f32_16x16x32_bf16 v[44:47], v[48:51], v[108:111], v[44:47]
    s_nop 0
    v_add_u32_dpp v6, v6, v6 quad_perm:[2,3,0,1] row_mask:0xf bank_mask:0xf
    s_mov_b64 exec, s[62:63]
    ds_add_u32 v159, v6 offset:32
    s_mov_b64 exec, -1
    v_mfma_f32_16x16x32_bf16 v[44:47], v[52:55], v[104:107], v[44:47]
    v_mfma_f32_16x16x32_bf16 v[44:47], v[56:59], v[100:103], v[44:47]
    v_mfma_f32_16x16x32_bf16 v[44:47], v[60:63], v[96:99], v[44:47]
    v_mfma_f32_16x16x32_bf16 v[44:47], v[64:67], v[92:95], v[44:47]
    v_mfma_f32_16x16x32_bf16 v[44:47], v[68:71], v[88:91], v[44:47]
    v_mfma_f32_16x16x32_bf16 v[44:47], v[72:75], v[84:87], v[44:47]
    v_mfma_f32_16x16x32_bf16 v[44:47], v[76:79], v[80:83], v[44:47]
    s_setprio 3
    v_cvt_pk_bf16_f32 v12, v40, v41
    v_cvt_pk_bf16_f32 v13, v42, v43
    s_nop 4
    v_cvt_pk_bf16_f32 v14, v44, v45
    v_cvt_pk_bf16_f32 v15, v46, v47
    s_nop 0
    v_permlane16_swap_b32 v12, v14
    v_permlane16_swap_b32 v13, v15
    global_store_dwordx4 v153, v[12:15], s[28:29] offset:3072 sc1
    v_add_u32 v6, v12, v13
    v_add3_u32 v6, v6, v14, v15
    s_nop 1
    v_add_u32_dpp v6, v6, v6 quad_perm:[1,0,3,2] row_mask:0xf bank_mask:0xf
    s_nop 1
    v_add_u32_dpp v6, v6, v6 quad_perm:[2,3,0,1] row_mask:0xf bank_mask:0xf
    s_mov_b64 exec, s[62:63]
    ds_add_u32 v159, v6 offset:96
    s_mov_b64 exec, -1
    v_mov_b32 v4, 1
    s_mov_b64 exec, 1
    ds_add_u32 v3, v4 offset:196
    ds_add_rtn_u32 v4, v3, v4 offset:252
    s_mov_b64 exec, -1
    v_lshlrev_b32 v5, 2, v0
    v_add_u32 v5, 161792, v5
    ds_read_b32 v30, v5
    v_mov_b32 v31, 0x100
    s_waitcnt lgkmcnt(0)
    v_readfirstlane_b32 s98, v4
    s_add_u32 s98, s98, 1
    s_cmp_lg_u32 s98, s64
    s_cbranch_scc1 L_ynf
    s_mov_b64 exec, 0xffffffff
    global_atomic_add_x2 v[132:133], v160, v[30:31], s[28:29] sc0 sc1
    s_mov_b64 exec, -1
    s_mov_b32 s101, 1
L_ynf:
    s_branch L_cjoin
L_pada14:
    s_branch L_warmed_a
L_hloop:
    v_add_u32 v154, 8320, v154
    v_add_u32 v155, 8320, v155
    v_add_u32 v156, 8320, v156
    v_add_u32 v157, 8320, v157
    v_add_u32 v158, 4608, v158
    s_waitcnt lgkmcnt(15)
    v_mfma_f32_16x16x32_bf16 v[32:35], v[48:51], v[96:99], 0
    s_waitcnt lgkmcnt(14)
    v_mfma_f32_16x16x32_bf16 v[32:35], v[52:55], v[92:95], v[32:35]
    s_waitcnt lgkmcnt(12)
    ds_read_b128 v[112:115], v158 offset:0
    v_mfma_f32_16x16x32_bf16 v[32:35], v[56:59], v[88:91], v[32:35]
    s_waitcnt lgkmcnt(11)
    v_mfma_f32_16x16x32_bf16 v[32:35], v[60:63], v[84:87], v[32:35]
    ds_read_b128 v[116:119], v158 offset:512
    s_waitcnt lgkmcnt(10)
    v_mfma_f32_16x16x32_bf16 v[32:35], v[64:67], v[80:83], v[32:35]
    v_mfma_f32_16x16x32_bf16 v[36:39], v[48:51], v[100:103], 0
    ds_read_b128 v[120:123], v158 offset:1024
    v_mfma_f32_16x16x32_bf16 v[36:39], v[52:55], v[96:99], v[36:39]
    v_mfma_f32_16x16x32_bf16 v[36:39], v[56:59], v[92:95], v[36:39]
    ds_read_b128 v[124:127], v158 offset:1536
    v_mfma_f32_16x16x32_bf16 v[36:39], v[60:63], v[88:91], v[36:39]
    v_mfma_f32_16x16x32_bf16 v[36:39], v[64:67], v[84:87], v[36:39]
    ds_read_b128 v[128:131], v158 offset:2048
    s_waitcnt lgkmcnt(11)
    v_mfma_f32_16x16x32_bf16 v[36:39], v[68:71], v[80:83], v[36:39]
    v_mfma_f32_16x16x32_bf16 v[40:43], v[48:51], v[104:107], 0
    ds_read_b128 v[132:135], v158 offset:2560
    v_mfma_f32_16x16x32_bf16 v[40:43], v[52:55], v[100:103], v[40:43]
    v_mfma_f32_16x16x32_bf16 v[40:43], v[56:59], v[96:99], v[40:43]
    ds_read_b128 v[136:139], v158 offset:3072
    v_cvt_pk_bf16_f32 v8, v32, v33
    v_cvt_pk_bf16_f32 v9, v34, v35
    v_mfma_f32_16x16x32_bf16 v[40:43], v[60:63], v[92:95], v[40:43]
    v_cvt_pk_bf16_f32 v10, v36, v37
    v_cvt_pk_bf16_f32 v11, v38, v39
    v_mfma_f32_16x16x32_bf16 v[40:43], v[64:67], v[88:91], v[40:43]
    ds_read_b128 v[140:143], v158 offset:3584
    s_waitcnt lgkmcnt(12)
    ds_write_b128 v161, v[8:11] offset:2048
    v_mfma_f32_16x16x32_bf16 v[40:43], v[68:71], v[84:87], v[40:43]
    v_mfma_f32_16x16x32_bf16 v[40:43], v[72:75], v[80:83], v[40:43]
    v_mfma_f32_16x16x32_bf16 v[44:47], v[48:51], v[108:111], 0
    ds_read2_b32 v[48:49], v157 offset0:128 offset1:129
    s_waitcnt lgkmcnt(12)
    ds_read2_b32 v[50:51], v157 offset0:130 offset1:131
    v_mfma_f32_16x16x32_bf16 v[44:47], v[52:55], v[104:107], v[44:47]
    ds_read2_b32 v[52:53], v157 offset0:0 offset1:1
    s_waitcnt lgkmcnt(12)
    ds_read2_b32 v[54:55], v157 offset0:2 offset1:3
    v_mfma_f32_16x16x32_bf16 v[44:47], v[56:59], v[100:103], v[44:47]
    ds_read2_b32 v[56:57], v156 offset0:128 offset1:129
    s_waitcnt lgkmcnt(12)
    ds_read2_b32 v[58:59], v156 offset0:130 offset1:131
    v_mfma_f32_16x16x32_bf16 v[44:47], v[60:63], v[96:99], v[44:47]
    ds_read2_b32 v[60:61], v156 offset0:0 offset1:1
    s_waitcnt lgkmcnt(12)
    ds_read2_b32 v[62:63], v156 offset0:2 offset1:3
    v_mfma_f32_16x16x32_bf16 v[44:47], v[64:67], v[92:95], v[44:47]
    ds_read2_b32 v[64:65], v155 offset0:128 offset1:129
    s_waitcnt lgkmcnt(12)
    ds_read2_b32 v[66:67], v155 offset0:130 offset1:131
    v_mfma_f32_16x16x32_bf16 v[44:47], v[68:71], v[88:91], v[44:47]
    ds_read2_b32 v[68:69], v155 offset0:0 offset1:1
    s_waitcnt lgkmcnt(12)
    ds_read2_b32 v[70:71], v155 offset0:2 offset1:3
    v_mfma_f32_16x16x32_bf16 v[44:47], v[72:75], v[84:87], v[44:47]
    ds_read2_b32 v[72:73], v154 offset0:128 offset1:129
    s_waitcnt lgkmcnt(12)
    ds_read2_b32 v[74:75], v154 offset0:130 offset1:131
    v_mfma_f32_16x16x32_bf16 v[44:47], v[76:79], v[80:83], v[44:47]
    ds_read2_b32 v[76:77], v154 offset0:0 offset1:1
    s_waitcnt lgkmcnt(12)
    ds_read2_b32 v[78:79], v154 offset0:2 offset1:3
    v_cvt_pk_bf16_f32 v12, v40, v41
    v_cvt_pk_bf16_f32 v13, v42, v43
    s_nop 2
    v_cvt_pk_bf16_f32 v14, v44, v45
    v_cvt_pk_bf16_f32 v15, v46, v47
    ds_write_b128 v161, v[12:15] offset:3072
    s_waitcnt lgkmcnt(12)
    ds_write_b32 v162, v5 offset:284
    v_add_u32 v161, 2048, v161
    v_add_u32 v162, 4, v162
    s_sub_u32 s20, s20, 1
    s_cmp_eq_u32 s20, 0
    s_cbranch_scc1 L_hexit
    v_add_u32 v154, 8320, v154
    v_add_u32 v155, 8320, v155
    v_add_u32 v156, 8320, v156
    v_add_u32 v157, 8320, v157
    v_add_u32 v158, 4608, v158
    v_mfma_f32_16x16x32_bf16 v[32:35], v[48:51], v[128:131], 0
    v_mfma_f32_16x16x32_bf16 v[32:35], v[52:55], v[124:127], v[32:35]
    ds_read_b128 v[80:83], v158 offset:0
    s_waitcnt lgkmcnt(13)
    v_mfma_f32_16x16x32_bf16 v[32:35], v[56:59], v[120:123], v[32:35]
    s_waitcnt lgkmcnt(11)
    v_mfma_f32_16x16x32_bf16 v[32:35], v[60:63], v[116:119], v[32:35]
    ds_read_b128 v[84:87], v158 offset:512
    s_waitcnt lgkmcnt(10)
    v_mfma_f32_16x16x32_bf16 v[32:35], v[64:67], v[112:115], v[32:35]
    v_mfma_f32_16x16x32_bf16 v[36:39], v[48:51], v[132:135], 0
    ds_read_b128 v[88:91], v158 offset:1024
    v_mfma_f32_16x16x32_bf16 v[36:39], v[52:55], v[128:131], v[36:39]
    v_mfma_f32_16x16x32_bf16 v[36:39], v[56:59], v[124:127], v[36:39]
    ds_read_b128 v[92:95], v158 offset:1536
    v_mfma_f32_16x16x32_bf16 v[36:39], v[60:63], v[120:123], v[36:39]
    v_mfma_f32_16x16x32_bf16 v[36:39], v[64:67], v[116:119], v[36:39]
    ds_read_b128 v[96:99], v158 offset:2048
    s_waitcnt lgkmcnt(11)
    v_mfma_f32_16x16x32_bf16 v[36:39], v[68:71], v[112:115], v[36:39]
    v_mfma_f32_16x16x32_bf16 v[40:43], v[48:51], v[136:139], 0
    ds_read_b128 v[100:103], v158 offset:2560
    v_mfma_f32_16x16x32_bf16 v[40:43], v[52:55], v[132:135], v[40:43]
    v_mfma_f32_16x16x32_bf16 v[40:43], v[56:59], v[128:131], v[40:43]
    ds_read_b128 v[104:107], v158 offset:3072
    v_cvt_pk_bf16_f32 v8, v32, v33
    v_cvt_pk_bf16_f32 v9, v34, v35
    v_mfma_f32_16x16x32_bf16 v[40:43], v[60:63], v[124:127], v[40:43]
    v_cvt_pk_bf16_f32 v10, v36, v37
    v_cvt_pk_bf16_f32 v11, v38, v39
    v_mfma_f32_16x16x32_bf16 v[40:43], v[64:67], v[120:123], v[40:43]
    ds_read_b128 v[108:111], v158 offset:3584
    s_waitcnt lgkmcnt(12)
    ds_write_b128 v161, v[8:11] offset:2048
    v_mfma_f32_16x16x32_bf16 v[40:43], v[68:71], v[116:119], v[40:43]
    v_mfma_f32_16x16x32_bf16 v[40:43], v[72:75], v[112:115], v[40:43]
    v_mfma_f32_16x16x32_bf16 v[44:47], v[48:51], v[140:143], 0
    ds_read2_b32 v[48:49], v157 offset0:128 offset1:129
    s_waitcnt lgkmcnt(12)
    ds_read2_b32 v[50:51], v157 offset0:130 offset1:131
    v_mfma_f32_16x16x32_bf16 v[44:47], v[52:55], v[136:139], v[44:47]
    ds_read2_b32 v[52:53], v157 offset0:0 offset1:1
    s_waitcnt lgkmcnt(12)
    ds_read2_b32 v[54:55], v157 offset0:2 offset1:3
    v_mfma_f32_16x16x32_bf16 v[44:47], v[56:59], v[132:135], v[44:47]
    ds_read2_b32 v[56:57], v156 offset0:128 offset1:129
    s_waitcnt lgkmcnt(12)
    ds_read2_b32 v[58:59], v156 offset0:130 offset1:131
    v_mfma_f32_16x16x32_bf16 v[44:47], v[60:63], v[128:131], v[44:47]
    ds_read2_b32 v[60:61], v156 offset0:0 offset1:1
    s_waitcnt lgkmcnt(12)
    ds_read2_b32 v[62:63], v156 offset0:2 offset1:3
    v_mfma_f32_16x16x32_bf16 v[44:47], v[64:67], v[124:127], v[44:47]
    ds_read2_b32 v[64:65], v155 offset0:128 offset1:129
    s_waitcnt lgkmcnt(12)
    ds_read2_b32 v[66:67], v155 offset0:130 offset1:131
    v_mfma_f32_16x16x32_bf16 v[44:47], v[68:71], v[120:123], v[44:47]
    ds_read2_b32 v[68:69], v155 offset0:0 offset1:1
    s_waitcnt lgkmcnt(12)
    ds_read2_b32 v[70:71], v155 offset0:2 offset1:3
    v_mfma_f32_16x16x32_bf16 v[44:47], v[72:75], v[116:119], v[44:47]
    ds_read2_b32 v[72:73], v154 offset0:128 offset1:129
    s_waitcnt lgkmcnt(12)
    ds_read2_b32 v[74:75], v154 offset0:130 offset1:131
    v_mfma_f32_16x16x32_bf16 v[44:47], v[76:79], v[112:115], v[44:47]
    ds_read2_b32 v[76:77], v154 offset0:0 offset1:1
    s_waitcnt lgkmcnt(12)
    ds_read2_b32 v[78:79], v154 offset0:2 offset1:3
    v_cvt_pk_bf16_f32 v12, v40, v41
    v_cvt_pk_bf16_f32 v13, v42, v43
    s_nop 2
    v_cvt_pk_bf16_f32 v14, v44, v45
    v_cvt_pk_bf16_f32 v15, v46, v47
    ds_write_b128 v161, v[12:15] offset:3072
    s_waitcnt lgkmcnt(12)
    ds_write_b32 v162, v5 offset:284
    v_add_u32 v161, 2048, v161
    v_add_u32 v162, 4, v162
    s_sub_u32 s20, s20, 1
    s_cmp_eq_u32 s20, 0
    s_cbranch_scc0 L_hloop
L_hexit:
L_cdone:
    s_waitcnt lgkmcnt(0)
    v_mov_b32 v4, 1
    s_mov_b64 exec, 1
    ds_add_u32 v3, v4 offset:196
    s_mov_b64 exec, -1
    s_setprio 0
    s_mov_b32 s100, 0
Lw_78:
    ds_read_b32 v4, v3 offset:196
    s_waitcnt lgkmcnt(0)
    v_readfirstlane_b32 s99, v4
    s_cmp_ge_u32 s99, 4
    s_cbranch_scc1 Lwd_79
    s_sleep 6
    s_add_u32 s100, s100, 1
    s_cmp_lt_u32 s100, 1048576
    s_cbranch_scc1 Lw_78
Lwd_79:
L_cjoin:
    s_setprio 2
    s_mov_b32 s100, 0
Lw_80:
    ds_read_b32 v4, v3 offset:192
    s_waitcnt lgkmcnt(0)
    v_readfirstlane_b32 s99, v4
    s_cmp_ge_u32 s99, 1
    s_cbranch_scc1 Lwd_81
    s_add_u32 s100, s100, 1
    s_cmp_lt_u32 s100, 1048576
    s_cbranch_scc1 Lw_80
Lwd_81:
    s_mov_b32 s91, s99
    s_cmp_eq_u32 s91, 1
    s_cselect_b32 s99, 0, 15728640
    s_add_u32 s16, s28, s99
    s_addc_u32 s17, s29, 0
    s_add_u32 s18, s16, 13107200
    s_addc_u32 s19, s17, 0
    s_cmp_eq_u32 s91, 1
    s_cselect_b64 s[18:19], s[24:25], s[18:19]
    v_lshl_add_u32 v138, v0, 4, s80
    v_lshl_add_u32 v139, v0, 4, s82
    v_lshl_add_u32 v166, v0, 2, s83
    s_branch L_tail
L_end:
    s_endpgm
L_codeend:
.section .rodata,"a"
.p2align 6
.amdhsa_kernel gated_mix__ssm_conv_h3__sliding_local_dilated__prompt_kernel
  .amdhsa_next_free_vgpr 168
  .amdhsa_next_free_sgpr 102
  .amdhsa_accum_offset 168
  .amdhsa_group_segment_fixed_size 0
  .amdhsa_kernarg_size 104
  .amdhsa_user_sgpr_count 2
  .amdhsa_user_sgpr_kernarg_segment_ptr 1
  .amdhsa_system_sgpr_workgroup_id_x 1
.end_amdhsa_kernel
```

```asm
; @launch grid=(256,1,1) block=(768,1,1) lds=163840
.amdgcn_target "amdgcn-amd-amdhsa--gfx950"
.text
.p2align 12
.globl gated_mix__ssm_conv_h3__sliding_local_dilated__prompt_kernel
.p2align 8
.type gated_mix__ssm_conv_h3__sliding_local_dilated__prompt_kernel,@function
gated_mix__ssm_conv_h3__sliding_local_dilated__prompt_kernel:
L_entry:
    s_load_dwordx16 s[4:19], s[0:1], 0
    s_load_dwordx8 s[20:27], s[0:1], 64
    s_load_dwordx2 s[28:29], s[0:1], 96
    s_cmp_ge_u32 s2, 256
    s_cbranch_scc1 L_end
    v_lshrrev_b32 v4, 6, v0
    v_and_b32 v0, 63, v0
    v_readfirstlane_b32 s32, v4
    v_mov_b32 v3, 160768
    s_cmp_eq_u32 s32, 4
    s_cbranch_scc1 L_pf
L_nopf:
    s_lshr_b32 s31, s2, 3
    v_lshrrev_b32 v2, 4, v0
    v_and_b32 v1, 15, v0
    s_and_b32 s30, s2, 7
    s_and_b32 s36, s31, 7
    s_lshr_b32 s35, s31, 3
    s_lshl2_add_u32 s35, s30, s35
    s_cmp_ge_u32 s31, 20
    s_cselect_b32 s34, 1, 0
    s_cselect_b32 s96, 20, 0
    s_cselect_b32 s97, 5, 10
    s_sub_u32 s38, s31, s96
    s_cmp_ge_u32 s38, s97
    s_cselect_b32 s97, s97, 0
    s_cselect_b32 s96, 1, 0
    s_sub_u32 s38, s38, s97
    s_lshl1_add_u32 s37, s30, s96
    s_mul_i32 s39, s37, 163840
    s_cmp_ge_u32 s32, 4
    s_cbranch_scc1 L_cw
    s_setprio 3
    s_cmp_lg_u32 s34, 0
    s_cbranch_scc1 L_aserv
    s_branch L_bserv
L_aserv:
    v_lshrrev_b32 v5, 3, v0
    v_mul_u32_u24 v5, 1280, v5
    v_and_b32 v4, 7, v0
    v_lshl_add_u32 v4, v4, 4, v5
    s_lshl_b32 s96, s38, 8
    v_add_u32 v4, s96, v4
    s_and_b32 s97, s32, 1
    s_lshl_b32 s97, s97, 6
    v_xor_b32 v13, s97, v4
    v_xor_b32 v14, 16, v13
    v_xor_b32 v15, 32, v13
    v_xor_b32 v16, 48, v13
    s_mul_i32 s96, s32, 40960
    s_add_u32 s52, s39, s96
    s_lshl_b32 s53, s32, 12
    s_lshl_b32 s97, s97, 1
    s_add_u32 s96, s39, s97
    s_sub_u32 s96, s96, 5120
    v_xor_b32 v4, 0x70, v4
    v_add_u32 v17, s96, v4
    s_waitcnt lgkmcnt(0)
    s_mov_b32 s84, s6
    s_and_b32 s85, s7, 0xffff
    s_mov_b32 s86, 2621440
    s_mov_b32 s87, 0x00020000
    s_mov_b32 s80, s8
    s_and_b32 s81, s9, 0xffff
    s_mov_b32 s82, 2621440
    s_mov_b32 s83, 0x00020000
    s_load_dword s33, s[28:29], 0
    s_cmp_ge_u32 s38, 5
    s_cbranch_scc1 L_as_nokv
    s_cmp_ge_u32 s32, 2
    s_cbranch_scc1 L_as_nohalo
    s_mul_i32 m0, s32, 16896
    s_add_u32 m0, m0, 90496
    s_mov_b64 exec, 0xffffffff
    buffer_load_dwordx4 v17, s[84:87], 0 offen lds
    s_mov_b64 exec, -1
L_as_nohalo:
    s_add_u32 m0, s53, 91008
    s_mov_b32 s59, s52
    buffer_load_dwordx4 v13, s[84:87], s59 offen lds
    s_addk_i32 m0, 16768
    s_nop 0
    buffer_load_dwordx4 v13, s[84:87], s59 offen offset:128 lds
    s_addk_i32 m0, -15744
    s_addk_i32 s59, 10240
    buffer_load_dwordx4 v14, s[84:87], s59 offen lds
    s_addk_i32 m0, 16768
    s_nop 0
    buffer_load_dwordx4 v14, s[84:87], s59 offen offset:128 lds
    s_addk_i32 m0, -15744
    s_addk_i32 s59, 10240
    buffer_load_dwordx4 v15, s[84:87], s59 offen lds
    s_addk_i32 m0, 16768
    s_nop 0
    buffer_load_dwordx4 v15, s[84:87], s59 offen offset:128 lds
    s_addk_i32 m0, -15744
    s_addk_i32 s59, 10240
    buffer_load_dwordx4 v16, s[84:87], s59 offen lds
    s_addk_i32 m0, 16768
    s_nop 0
    buffer_load_dwordx4 v16, s[84:87], s59 offen offset:128 lds
    s_add_u32 m0, s53, 124288
    s_mov_b32 s59, s52
    buffer_load_dwordx4 v13, s[80:83], s59 offen lds
    s_addk_i32 m0, 16256
    s_nop 0
    buffer_load_dwordx4 v13, s[80:83], s59 offen offset:128 lds
    s_addk_i32 m0, -15232
    s_addk_i32 s59, 10240
    buffer_load_dwordx4 v14, s[80:83], s59 offen lds
    s_addk_i32 m0, 16256
    s_nop 0
    buffer_load_dwordx4 v14, s[80:83], s59 offen offset:128 lds
    s_addk_i32 m0, -15232
    s_addk_i32 s59, 10240
    buffer_load_dwordx4 v15, s[80:83], s59 offen lds
    s_addk_i32 m0, 16256
    s_nop 0
    buffer_load_dwordx4 v15, s[80:83], s59 offen offset:128 lds
    s_addk_i32 m0, -15232
    s_addk_i32 s59, 10240
    buffer_load_dwordx4 v16, s[80:83], s59 offen lds
    s_addk_i32 m0, 16256
    s_nop 0
    buffer_load_dwordx4 v16, s[80:83], s59 offen offset:128 lds
    s_branch L_as_kv
L_cw:
    s_cmp_eq_u32 s34, 0
    s_cbranch_scc1 L_compute
    s_sub_u32 s65, s32, 4
    s_cmp_ge_u32 s38, 5
    s_cbranch_scc1 L_awave
    s_lshl3_add_u32 s58, s38, s65
    s_lshl_b32 s96, s58, 7
    s_add_u32 s97, s96, 64
    s_waitcnt lgkmcnt(0)
    s_load_dword s33, s[28:29], 0
    s_load_dwordx16 s[40:55], s[10:11], s96
    s_load_dwordx16 s[76:91], s[10:11], s97
    s_branch L_nopack
L_pf:
    s_getpc_b64 s[46:47]
L_pc:
    s_lshr_b32 s96, s2, 3
    s_mul_i32 s96, s96, 1280
    v_lshl_add_u32 v4, v0, 7, s96
    v_min_u32 v4, L_codeend-L_pc-4, v4
    s_mov_b64 exec, 0x3ff
    global_load_dword v137, v4, s[46:47]
    s_mov_b64 exec, -1
    v_lshl_add_u32 v5, v0, 3, v3
    v_mov_b32 v6, 0
    v_mov_b32 v7, 0
    ds_write_b64 v5, v[6:7]
    s_branch L_nopf
L_service:
L_bserv:
    v_lshrrev_b32 v4, 3, v0
    v_and_b32 v5, 7, v0
    s_add_u32 s65, s30, s38
    s_mul_i32 s96, s65, 52
    s_lshr_b32 s96, s96, 8
    s_mul_i32 s96, s96, 5
    s_sub_u32 s65, s65, s96
    s_mul_i32 s65, s65, 512
    s_lshr_b32 s65, s65, 8
    s_mov_b32 s67, s65
    s_and_b32 s96, s32, 1
    s_cmp_ge_u32 s32, 2
    s_cbranch_scc1 L_lw
    v_mul_u32_u24 v6, 1280, v4
    v_xor_b32 v7, v5, v2
    v_lshl_add_u32 v13, v7, 4, v6
    s_lshl_b32 s97, s96, 6
    v_xor_b32 v13, s97, v13
    v_xor_b32 v14, 64, v13
    s_sub_u32 s52, s39, 20480
    s_cmp_eq_u32 s37, 0
    s_cselect_b32 s52, 0, s52
    s_add_u32 s97, s39, 71680
    s_add_u32 s98, s39, 92160
    s_cmp_eq_u32 s96, 0
    s_cselect_b32 s52, s52, s97
    s_cselect_b32 s53, s39, s98
    s_mul_i32 s54, s96, 9216
    s_add_u32 s54, s54, 86016
    s_waitcnt lgkmcnt(0)
    s_mov_b32 s40, s4
    s_and_b32 s41, s5, 0xffff
    s_mov_b32 s42, 2621440
    s_mov_b32 s43, 0x00020000
    s_mov_b32 m0, s54
    s_lshl_b32 s67, s67, 7
    s_add_u32 s59, s52, s67
    buffer_load_dwordx4 v13, s[40:43], s59 offen lds
    s_addk_i32 m0, 1024
    s_addk_i32 s59, 10240
    buffer_load_dwordx4 v14, s[40:43], s59 offen lds
    s_addk_i32 m0, 1024
    s_add_u32 s59, s53, s67
    buffer_load_dwordx4 v13, s[40:43], s59 offen lds
    s_addk_i32 m0, 1024
    s_addk_i32 s59, 10240
    buffer_load_dwordx4 v14, s[40:43], s59 offen lds
    s_addk_i32 m0, 1024
    s_addk_i32 s59, 10240
    buffer_load_dwordx4 v13, s[40:43], s59 offen lds
    s_addk_i32 m0, 1024
    s_addk_i32 s59, 10240
    buffer_load_dwordx4 v14, s[40:43], s59 offen lds
    s_addk_i32 m0, 1024
    s_addk_i32 s59, 10240
    buffer_load_dwordx4 v13, s[40:43], s59 offen lds
    s_addk_i32 m0, 1024
    s_addk_i32 s59, 10240
    buffer_load_dwordx4 v14, s[40:43], s59 offen lds
    s_addk_i32 m0, 1024
    s_addk_i32 s59, 10240
    buffer_load_dwordx4 v13, s[40:43], s59 offen lds
    s_branch L_ld_x_c
L_lw:
    v_and_b32 v7, 2, v4
    v_xor_b32 v7, v7, v5
    v_mul_u32_u24 v6, 3840, v4
    v_lshl_add_u32 v13, v7, 4, v6
    s_lshl_b32 s97, s38, 7
    v_add_u32 v13, s97, v13
    v_xor_b32 v14, 64, v13
    s_mul_i32 s54, s96, 12288
    s_add_u32 s54, s54, 104448
    s_mul_i32 s52, s96, 122880
    s_waitcnt lgkmcnt(0)
    s_mov_b32 s44, s18
    s_and_b32 s45, s19, 0xffff
    s_mov_b32 s46, 2457600
    s_mov_b32 s47, 0x00020000
    s_mov_b32 m0, s54
    s_mul_i32 s59, s67, 245760
    s_add_u32 s59, s59, s52
    buffer_load_dwordx4 v13, s[44:47], s59 offen lds
    s_addk_i32 m0, 1024
    s_addk_i32 s59, 1280
    buffer_load_dwordx4 v13, s[44:47], s59 offen lds
    s_addk_i32 m0, 1024
    s_addk_i32 s59, 1280
    buffer_load_dwordx4 v13, s[44:47], s59 offen lds
    s_addk_i32 m0, 1024
    s_addk_i32 s59, 28160
    buffer_load_dwordx4 v14, s[44:47], s59 offen lds
    s_addk_i32 m0, 1024
    s_addk_i32 s59, 1280
    buffer_load_dwordx4 v14, s[44:47], s59 offen lds
    s_addk_i32 m0, 1024
    s_addk_i32 s59, 1280
    buffer_load_dwordx4 v14, s[44:47], s59 offen lds
    s_addk_i32 m0, 1024
    s_addk_i32 s59, 28160
    buffer_load_dwordx4 v13, s[44:47], s59 offen lds
    s_addk_i32 m0, 1024
    s_addk_i32 s59, 1280
    buffer_load_dwordx4 v13, s[44:47], s59 offen lds
    s_addk_i32 m0, 1024
    s_addk_i32 s59, 1280
    buffer_load_dwordx4 v13, s[44:47], s59 offen lds
    s_addk_i32 m0, 1024
    s_addk_i32 s59, 28160
    buffer_load_dwordx4 v14, s[44:47], s59 offen lds
    s_addk_i32 m0, 1024
    s_addk_i32 s59, 1280
    buffer_load_dwordx4 v14, s[44:47], s59 offen lds
    s_addk_i32 m0, 1024
    s_addk_i32 s59, 1280
    buffer_load_dwordx4 v14, s[44:47], s59 offen lds
    s_branch L_ld_w_c
L_padb0:
    s_branch L_padb8
L_ld_x_c:
    s_load_dword s33, s[28:29], 0
    s_mov_b32 s76, s65
    s_mov_b32 s78, s65
    s_mov_b32 s67, s76
    s_add_u32 s76, s76, 1
    s_cmp_eq_u32 s76, 10
    s_cselect_b32 s76, 0, s76
    s_mov_b32 s67, s76
    s_add_u32 s76, s76, 1
    s_cmp_eq_u32 s76, 10
    s_cselect_b32 s76, 0, s76
    s_cmp_lg_u32 s32, 0
    s_cbranch_scc1 L_nogw
    s_mov_b32 s48, s22
    s_and_b32 s49, s23, 0xffff
    s_mov_b32 s50, 1280
    s_mov_b32 s51, 0x00020000
    v_lshlrev_b32 v4, 4, v0
    s_mov_b32 m0, 162048
    s_nop 0
    buffer_load_dwordx4 v4, s[48:51], 0 offen lds
    s_mov_b64 exec, 0xffff
    buffer_load_dwordx4 v4, s[48:51], 0 offen offset:1024 lds
    s_mov_b64 exec, -1
L_nogw:
    s_add_u32 s62, s54, 43008
    s_sub_u32 s54, s54, 86016
    s_mov_b32 s61, s54
    s_mov_b32 s55, 1
    s_mul_i32 s96, s36, 102400
    s_add_u32 s96, s96, 9437184
    s_add_u32 s48, s28, s96
    s_addc_u32 s49, s29, 0
    s_and_b32 s49, s49, 0xffff
    s_mov_b32 s50, 102400
    s_mov_b32 s51, 0x00020000
    v_lshlrev_b32 v19, 4, v0
    s_lshl_b32 s66, s30, 5
    s_add_u32 s66, s66, s31
    s_lshl_b32 s66, s66, 8
    s_add_u32 s66, s66, 65536
    s_add_u32 s66, s66, 128
    v_lshrrev_b32 v5, 1, v1
    v_xor_b32 v5, v5, v2
    v_lshlrev_b32 v5, 4, v5
    v_lshl_add_u32 v5, v1, 7, v5
    s_lshl_b32 s97, s32, 6
    v_xor_b32 v5, s97, v5
    s_and_b32 s96, s38, 7
    s_lshl_b32 s96, s96, 11
    s_add_u32 s96, s96, 2048
    v_add_u32 v18, s96, v5
    s_add_u32 s97, s97, 162048
    v_lshl_add_u32 v17, v2, 4, s97
    s_mov_b32 s64, 86016
    v_mov_b64 v[20:21], 0
    v_mov_b64 v[22:23], 0
    v_mov_b64 v[24:25], 0
    v_mov_b64 v[26:27], 0
    v_mov_b64 v[28:29], 0
    v_mov_b64 v[30:31], 0
    s_lshl1_add_u32 s96, s35, s32
    s_mul_i32 s96, s96, 40960
    s_mul_i32 s97, s36, 160
    s_add_u32 s96, s96, s97
    v_add_u32 v4, 0, v0
    v_mul_u32_u24 v8, 6554, v4
    v_lshrrev_b32 v8, 16, v8
    v_mul_u32_u24 v8, 1120, v8
    v_lshl_add_u32 v4, v4, 4, s96
    v_add_u32 v8, v8, v4
    v_add_u32 v4, 64, v0
    v_mul_u32_u24 v9, 6554, v4
    v_lshrrev_b32 v9, 16, v9
    v_mul_u32_u24 v9, 1120, v9
    v_lshl_add_u32 v4, v4, 4, s96
    v_add_u32 v9, v9, v4
    v_add_u32 v4, 128, v0
    v_mul_u32_u24 v10, 6554, v4
    v_lshrrev_b32 v10, 16, v10
    v_mul_u32_u24 v10, 1120, v10
    v_lshl_add_u32 v4, v4, 4, s96
    v_add_u32 v10, v10, v4
    v_add_u32 v4, 192, v0
    v_mul_u32_u24 v11, 6554, v4
    v_lshrrev_b32 v11, 16, v11
    v_mul_u32_u24 v11, 1120, v11
    v_lshl_add_u32 v4, v4, 4, s96
    v_add_u32 v11, v11, v4
    v_add_u32 v4, 256, v0
    v_mul_u32_u24 v12, 6554, v4
    v_lshrrev_b32 v12, 16, v12
    v_mul_u32_u24 v12, 1120, v12
    v_lshl_add_u32 v4, v4, 4, s96
    v_add_u32 v12, v12, v4
    s_waitcnt lgkmcnt(0)
    s_mul_i32 s33, s33, 1664525
    s_add_u32 s33, s33, 1013904223
    s_branch L_ld_x_i
L_padb1:
    s_branch L_padb9
L_ld_x:
    s_mov_b32 s68, s78
    s_add_u32 s78, s78, 1
    s_cmp_eq_u32 s78, 10
    s_cselect_b32 s78, 0, s78
    s_lshl_b32 s68, s68, 7
    v_add_u32 v15, s64, v18
    v_add_u32 v16, s68, v17
    ds_read_b128 v[24:27], v15
    ds_read_b128 v[28:31], v16
    s_add_u32 s64, s64, 43008
    s_cmp_eq_u32 s64, 129024
    s_cselect_b32 s64, 0, s64
L_ld_x_i:
    s_mov_b32 m0, s54
    s_lshl_b32 s67, s67, 7
    s_add_u32 s59, s52, s67
    buffer_load_dwordx4 v13, s[40:43], s59 offen lds
    s_addk_i32 m0, 1024
    s_addk_i32 s59, 10240
    buffer_load_dwordx4 v14, s[40:43], s59 offen lds
    s_addk_i32 m0, 1024
    s_add_u32 s59, s53, s67
    buffer_load_dwordx4 v13, s[40:43], s59 offen lds
    s_addk_i32 m0, 1024
    s_addk_i32 s59, 10240
    buffer_load_dwordx4 v14, s[40:43], s59 offen lds
    s_addk_i32 m0, 1024
    s_addk_i32 s59, 10240
    buffer_load_dwordx4 v13, s[40:43], s59 offen lds
    s_addk_i32 m0, 1024
    s_addk_i32 s59, 10240
    s_waitcnt lgkmcnt(0)
    v_mfma_f32_16x16x32_bf16 v[20:23], v[28:31], v[24:27], v[20:23]
    s_cmp_lt_u32 s55, 9
    s_cbranch_scc1 Lmp_1
    s_load_dwordx4 s[88:91], s[28:29], s66 glc
Lmp_1:
    buffer_load_dwordx4 v14, s[40:43], s59 offen lds
    s_addk_i32 m0, 1024
    s_addk_i32 s59, 10240
    buffer_load_dwordx4 v13, s[40:43], s59 offen lds
    s_addk_i32 m0, 1024
    s_addk_i32 s59, 10240
    buffer_load_dwordx4 v14, s[40:43], s59 offen lds
    s_addk_i32 m0, 1024
    s_addk_i32 s59, 10240
    buffer_load_dwordx4 v13, s[40:43], s59 offen lds
    s_mov_b32 s67, s76
    s_add_u32 s76, s76, 1
    s_cmp_eq_u32 s76, 10
    s_cselect_b32 s76, 0, s76
    s_add_u32 s54, s54, 43008
    s_cmp_eq_u32 s54, s62
    s_cselect_b32 s54, s61, s54
    s_add_u32 s55, s55, 1
    s_cmp_eq_u32 s55, 2
    s_cbranch_scc1 L_ld_x_e
L_ld_x_w:
    s_waitcnt vmcnt(9)
L_ld_x_b:
    s_barrier
    s_cmp_lt_u32 s55, 10
    s_cbranch_scc1 L_ld_x
    s_mov_b32 s68, s78
    s_add_u32 s78, s78, 1
    s_cmp_eq_u32 s78, 10
    s_cselect_b32 s78, 0, s78
    s_lshl_b32 s68, s68, 7
    v_add_u32 v15, s64, v18
    v_add_u32 v16, s68, v17
    ds_read_b128 v[24:27], v15
    ds_read_b128 v[28:31], v16
    s_add_u32 s64, s64, 43008
    s_cmp_eq_u32 s64, 129024
    s_cselect_b32 s64, 0, s64
    s_waitcnt lgkmcnt(0)
    v_mfma_f32_16x16x32_bf16 v[20:23], v[28:31], v[24:27], v[20:23]
    s_branch L_ld_end
L_ld_w_e:
    s_barrier
    s_branch L_ld_w_w
L_ld_x_e:
    s_barrier
    s_cmp_lg_u32 s32, 1
    s_cbranch_scc1 L_ld_x_w
    s_lshl_b32 s96, s30, 5
    s_add_u32 s96, s96, s31
    s_lshl_b32 s96, s96, 8
    s_add_u32 s96, s96, 65536
    v_lshl_add_u32 v4, v0, 3, s96
    v_mov_b32 v6, 0
    s_and_b32 s97, s33, 0xffffff00
    v_mov_b32 v7, s97
    s_getreg_b32 s97, hwreg(HW_REG_XCC_ID, 0, 4)
    v_writelane_b32 v6, s33, 3
    v_writelane_b32 v7, s97, 3
    s_mov_b64 exec, 0xffff
    global_store_dwordx2 v4, v[6:7], s[28:29] sc1
    s_mov_b64 exec, -1
    s_waitcnt vmcnt(10)
    s_branch L_ld_x_b
.p2align 12
L_padb2:
    s_branch L_padb10
L_ld_w_c:
    s_load_dword s33, s[28:29], 0
    s_mov_b32 s76, s65
    s_mov_b32 s78, s65
    s_mov_b32 s67, s76
    s_add_u32 s76, s76, 1
    s_cmp_eq_u32 s76, 10
    s_cselect_b32 s76, 0, s76
    s_mov_b32 s67, s76
    s_add_u32 s76, s76, 1
    s_cmp_eq_u32 s76, 10
    s_cselect_b32 s76, 0, s76
    s_add_u32 s62, s54, 43008
    s_sub_u32 s54, s54, 86016
    s_mov_b32 s61, s54
    s_mov_b32 s55, 1
    s_mul_i32 s96, s36, 102400
    s_add_u32 s96, s96, 9437184
    s_add_u32 s48, s28, s96
    s_addc_u32 s49, s29, 0
    s_and_b32 s49, s49, 0xffff
    s_mov_b32 s50, 102400
    s_mov_b32 s51, 0x00020000
    v_lshlrev_b32 v19, 4, v0
    s_lshl_b32 s66, s30, 5
    s_add_u32 s66, s66, s31
    s_lshl_b32 s66, s66, 8
    s_add_u32 s66, s66, 65536
    s_add_u32 s66, s66, 128
    v_mov_b32 v8, 0
    v_mov_b32 v9, 0
    v_mov_b32 v10, 0
    v_mov_b32 v11, 0
    v_mov_b32 v12, 0
    s_mov_b32 s40, s4
    s_and_b32 s41, s5, 0xffff
    s_mov_b32 s42, 2621440
    s_mov_b32 s43, 0x00020000
    s_waitcnt lgkmcnt(0)
    s_mul_i32 s33, s33, 1664525
    s_add_u32 s33, s33, 1013904223
L_ld_w:
    s_cmp_lt_u32 s55, 9
    s_cbranch_scc1 Lmp_2
    s_load_dwordx4 s[88:91], s[28:29], s66 glc
Lmp_2:
    s_mov_b32 m0, s54
    s_mul_i32 s59, s67, 245760
    s_add_u32 s59, s59, s52
    buffer_load_dwordx4 v13, s[44:47], s59 offen lds
    s_addk_i32 m0, 1024
    s_addk_i32 s59, 1280
    buffer_load_dwordx4 v13, s[44:47], s59 offen lds
    s_addk_i32 m0, 1024
    s_addk_i32 s59, 1280
    buffer_load_dwordx4 v13, s[44:47], s59 offen lds
    s_addk_i32 m0, 1024
    s_addk_i32 s59, 28160
    buffer_load_dwordx4 v14, s[44:47], s59 offen lds
    s_addk_i32 m0, 1024
    s_addk_i32 s59, 1280
    buffer_load_dwordx4 v14, s[44:47], s59 offen lds
    s_addk_i32 m0, 1024
    s_addk_i32 s59, 1280
    buffer_load_dwordx4 v14, s[44:47], s59 offen lds
    s_addk_i32 m0, 1024
    s_addk_i32 s59, 28160
    buffer_load_dwordx4 v13, s[44:47], s59 offen lds
    s_addk_i32 m0, 1024
    s_addk_i32 s59, 1280
    buffer_load_dwordx4 v13, s[44:47], s59 offen lds
    s_addk_i32 m0, 1024
    s_addk_i32 s59, 1280
    buffer_load_dwordx4 v13, s[44:47], s59 offen lds
    s_addk_i32 m0, 1024
    s_addk_i32 s59, 28160
    buffer_load_dwordx4 v14, s[44:47], s59 offen lds
    s_addk_i32 m0, 1024
    s_addk_i32 s59, 1280
    buffer_load_dwordx4 v14, s[44:47], s59 offen lds
    s_addk_i32 m0, 1024
    s_addk_i32 s59, 1280
    buffer_load_dwordx4 v14, s[44:47], s59 offen lds
    s_mov_b32 s67, s76
    s_add_u32 s76, s76, 1
    s_cmp_eq_u32 s76, 10
    s_cselect_b32 s76, 0, s76
    s_add_u32 s54, s54, 43008
    s_cmp_eq_u32 s54, s62
    s_cselect_b32 s54, s61, s54
    s_add_u32 s55, s55, 1
    s_cmp_eq_u32 s55, 2
    s_cbranch_scc1 L_ld_w_e
L_ld_w_w:
    s_waitcnt vmcnt(12)
L_ld_w_b:
    s_barrier
    s_cmp_lt_u32 s55, 10
    s_cbranch_scc1 L_ld_w
L_ld_end:
    s_waitcnt lgkmcnt(0)
    s_cmp_eq_u32 s90, s33
    s_cbranch_scc1 L_wo_mk
    s_lshl_b32 s98, s30, 5
    s_add_u32 s98, s98, s31
    s_lshl_b32 s98, s98, 8
    s_add_u32 s98, s98, 65536
    s_add_u32 s98, s98, 128
    s_mov_b32 s100, 0
Lc_3:
    s_load_dwordx4 s[88:91], s[28:29], s98 glc
    s_waitcnt lgkmcnt(0)
    s_cmp_eq_u32 s90, s33
    s_cbranch_scc1 Lcd_4
    s_sleep 2
    s_add_u32 s100, s100, 1
    s_cmp_lt_u32 s100, 1048576
    s_cbranch_scc1 Lc_3
    s_mov_b32 s91, 2
Lcd_4:
L_wo_mk:
    s_cmp_eq_u32 s91, 1
    s_cselect_b32 s99, 0, 15728640
    s_add_u32 s16, s28, s99
    s_addc_u32 s17, s29, 0
    s_cmp_lg_u32 s32, 2
    s_cbranch_scc1 L_wo_nc
    s_mov_b32 s44, s28
    s_and_b32 s45, s29, 0xffff
    s_mov_b32 s46, 1048576
    s_mov_b32 s47, 0x00020000
    v_lshlrev_b32 v4, 2, v0
    s_mov_b32 m0, 161152
    s_mov_b64 exec, 3
    s_add_u32 s66, s66, 8
    buffer_load_dword v4, s[44:47], s66 offen sc1 lds
    s_mov_b64 exec, -1
L_wo_nc:
    s_cmp_ge_u32 s32, 2
    s_cbranch_scc1 L_wo_a2
    s_mul_i32 m0, s32, 5120
    s_nop 0
    buffer_load_dwordx4 v8, s[40:43], 0 offen lds
    s_addk_i32 m0, 1024
    s_nop 0
    buffer_load_dwordx4 v9, s[40:43], 0 offen lds
    s_addk_i32 m0, 1024
    s_nop 0
    buffer_load_dwordx4 v10, s[40:43], 0 offen lds
    s_addk_i32 m0, 1024
    s_nop 0
    buffer_load_dwordx4 v11, s[40:43], 0 offen lds
    s_addk_i32 m0, 1024
    s_nop 0
    buffer_load_dwordx4 v12, s[40:43], 0 offen lds
    s_mov_b32 s59, 24576
    s_cmp_eq_u32 s32, 1
    s_cselect_b32 s59, 28672, s59
    s_add_u32 m0, s59, 10240
    s_nop 0
    buffer_load_dwordx4 v19, s[48:51], s59 offen offset:0 sc1 lds
    buffer_load_dwordx4 v19, s[48:51], s59 offen offset:1024 sc1 lds
    buffer_load_dwordx4 v19, s[48:51], s59 offen offset:2048 sc1 lds
    buffer_load_dwordx4 v19, s[48:51], s59 offen offset:3072 sc1 lds
    s_waitcnt vmcnt(9)
    s_branch L_wo_a3
L_padb3:
    s_branch L_padb11
L_wo_a2:
    s_mov_b32 s59, 0
    s_cmp_eq_u32 s32, 1
    s_cselect_b32 s59, 0, s59
    s_cmp_eq_u32 s32, 2
    s_cselect_b32 s59, 0, s59
    s_cmp_eq_u32 s32, 3
    s_cselect_b32 s59, 12288, s59
    s_add_u32 m0, s59, 10240
    s_nop 0
    buffer_load_dwordx4 v19, s[48:51], s59 offen offset:0 sc1 lds
    buffer_load_dwordx4 v19, s[48:51], s59 offen offset:1024 sc1 lds
    buffer_load_dwordx4 v19, s[48:51], s59 offen offset:2048 sc1 lds
    buffer_load_dwordx4 v19, s[48:51], s59 offen offset:3072 sc1 lds
    s_addk_i32 m0, 4096
    s_addk_i32 s59, 4096
    buffer_load_dwordx4 v19, s[48:51], s59 offen offset:0 sc1 lds
    buffer_load_dwordx4 v19, s[48:51], s59 offen offset:1024 sc1 lds
    buffer_load_dwordx4 v19, s[48:51], s59 offen offset:2048 sc1 lds
    buffer_load_dwordx4 v19, s[48:51], s59 offen offset:3072 sc1 lds
    s_addk_i32 m0, 4096
    s_addk_i32 s59, 4096
    buffer_load_dwordx4 v19, s[48:51], s59 offen offset:0 sc1 lds
    buffer_load_dwordx4 v19, s[48:51], s59 offen offset:1024 sc1 lds
    buffer_load_dwordx4 v19, s[48:51], s59 offen offset:2048 sc1 lds
    buffer_load_dwordx4 v19, s[48:51], s59 offen offset:3072 sc1 lds
    s_waitcnt vmcnt(12)
L_wo_a3:
    s_barrier
    s_cmp_ge_u32 s32, 2
    s_cbranch_scc1 L_wo_n9
    s_mov_b32 s68, s78
    s_add_u32 s78, s78, 1
    s_cmp_eq_u32 s78, 10
    s_cselect_b32 s78, 0, s78
    s_lshl_b32 s68, s68, 7
    v_add_u32 v15, s64, v18
    v_add_u32 v16, s68, v17
    ds_read_b128 v[24:27], v15
    ds_read_b128 v[28:31], v16
    s_add_u32 s64, s64, 43008
    s_cmp_eq_u32 s64, 129024
    s_cselect_b32 s64, 0, s64
L_wo_n9:
    s_mov_b32 s59, 32768
    s_cmp_eq_u32 s32, 1
    s_cselect_b32 s59, 36864, s59
    s_cmp_eq_u32 s32, 2
    s_cselect_b32 s59, 41984, s59
    s_cmp_eq_u32 s32, 3
    s_cselect_b32 s59, 46080, s59
    s_add_u32 s96, s59, 10240
    v_add_u32 v32, s96, v19
    buffer_load_dwordx4 v[40:43], v19, s[48:51], s59 offen offset:0 sc1
    buffer_load_dwordx4 v[44:47], v19, s[48:51], s59 offen offset:1024 sc1
    buffer_load_dwordx4 v[48:51], v19, s[48:51], s59 offen offset:2048 sc1
    buffer_load_dwordx4 v[52:55], v19, s[48:51], s59 offen offset:3072 sc1
    s_addk_i32 s59, 4096
    buffer_load_dwordx4 v[56:59], v19, s[48:51], s59 offen offset:0 sc1
    s_mov_b32 s59, 51200
    s_cmp_eq_u32 s32, 1
    s_cselect_b32 s59, 63488, s59
    s_cmp_eq_u32 s32, 2
    s_cselect_b32 s59, 76800, s59
    s_cmp_eq_u32 s32, 3
    s_cselect_b32 s59, 89088, s59
    s_add_u32 s96, s59, 10240
    v_add_u32 v33, s96, v19
    buffer_load_dwordx4 v[60:63], v19, s[48:51], s59 offen offset:0 sc1
    buffer_load_dwordx4 v[64:67], v19, s[48:51], s59 offen offset:1024 sc1
    buffer_load_dwordx4 v[68:71], v19, s[48:51], s59 offen offset:2048 sc1
    buffer_load_dwordx4 v[72:75], v19, s[48:51], s59 offen offset:3072 sc1
    s_addk_i32 s59, 4096
    buffer_load_dwordx4 v[76:79], v19, s[48:51], s59 offen offset:0 sc1
    buffer_load_dwordx4 v[80:83], v19, s[48:51], s59 offen offset:1024 sc1
    buffer_load_dwordx4 v[84:87], v19, s[48:51], s59 offen offset:2048 sc1
    buffer_load_dwordx4 v[88:91], v19, s[48:51], s59 offen offset:3072 sc1
    s_addk_i32 s59, 4096
    buffer_load_dwordx4 v[92:95], v19, s[48:51], s59 offen offset:0 sc1
    buffer_load_dwordx4 v[96:99], v19, s[48:51], s59 offen offset:1024 sc1
    buffer_load_dwordx4 v[100:103], v19, s[48:51], s59 offen offset:2048 sc1
    buffer_load_dwordx4 v[104:107], v19, s[48:51], s59 offen offset:3072 sc1
    s_addk_i32 s59, 4096
    buffer_load_dwordx4 v[108:111], v19, s[48:51], s59 offen offset:0 sc1
    s_waitcnt vmcnt(18)
    s_cmp_lt_u32 s32, 2
    s_cbranch_scc1 L_wo_g
    v_mov_b32 v4, 16
    s_mov_b64 exec, 1
    ds_add_u32 v3, v4 offset:268
    s_mov_b64 exec, -1
    s_branch L_wo_ng
L_padb4:
    s_branch L_padb12
L_wo_g:
    s_waitcnt lgkmcnt(0)
    v_mfma_f32_16x16x32_bf16 v[20:23], v[28:31], v[24:27], v[20:23]
    v_lshlrev_b32 v5, 2, v0
    v_add_u32 v5, 161792, v5
    s_cmp_eq_u32 s32, 0
    s_cbranch_scc1 L_wo_g0
    s_nop 3
    ds_write_b32 v5, v20
    v_mov_b32 v4, 1
    ds_write_b32 v3, v4 offset:172
    v_mov_b32 v4, 16
    s_mov_b64 exec, 1
    ds_add_u32 v3, v4 offset:268
    s_mov_b64 exec, -1
    s_branch L_wo_ng
L_wo_g0:
    v_mov_b32 v4, 16
    s_mov_b64 exec, 1
    ds_add_u32 v3, v4 offset:268
    s_mov_b64 exec, -1
    s_mov_b32 s100, 0
Lw_5:
    ds_read_b32 v4, v3 offset:172
    s_waitcnt lgkmcnt(0)
    v_readfirstlane_b32 s99, v4
    s_cmp_ge_u32 s99, 1
    s_cbranch_scc1 Lwd_6
    s_add_u32 s100, s100, 1
    s_cmp_lt_u32 s100, 1048576
    s_cbranch_scc1 Lw_5
Lwd_6:
    ds_read_b32 v21, v5
    s_waitcnt lgkmcnt(0)
    v_add_f32 v20, v20, v21
    v_cvt_pk_bf16_f32 v20, v20, v20
    v_and_b32 v20, 0xffff0000, v20
    v_mul_f32 v20, 0xbfb8aa3b, v20
    v_exp_f32 v20, v20
    s_nop 0
    v_add_f32 v20, 1.0, v20
    v_rcp_f32 v20, v20
    s_nop 0
    v_cvt_pk_bf16_f32 v20, v20, v20
    v_and_b32 v21, 0xffff0000, v20
    v_mov_b32 v20, s33
    s_and_b32 s96, s37, 1
    s_lshl3_add_u32 s96, s96, s38
    s_lshl_b32 s96, s96, 7
    s_mul_i32 s97, s30, 262144
    s_add_u32 s96, s96, s97
    s_add_u32 s96, s96, 7537664
    v_lshl_add_u32 v5, v1, 3, s96
    s_cmp_ge_u32 s38, 8
    s_cbranch_scc1 L_wo_ng
    s_mov_b64 exec, 0xffff
    s_cmp_lg_u32 s91, 1
    s_cbranch_scc1 Ldg_7
    global_store_dwordx2 v5, v[20:21], s[16:17]
    s_branch Ldd_8
Ldg_7:
    global_store_dwordx2 v5, v[20:21], s[16:17] sc1
Ldd_8:
    s_mov_b64 exec, -1
L_wo_ng:
    s_waitcnt vmcnt(0)
    s_cmp_eq_u32 s32, 3
    s_cbranch_scc1 L_help
L_wo_fl:
    s_lshl_b32 s96, s30, 5
    s_add_u32 s96, s96, s31
    s_lshl_b32 s96, s96, 8
    s_add_u32 s96, s96, 65536
    s_lshl3_add_u32 s96, s32, s96
    s_add_u32 s40, s28, s96
    s_addc_u32 s41, s29, 0
    s_mul_i32 s96, s36, 327680
    s_mul_i32 s97, s32, 163840
    s_add_u32 s96, s96, s97
    s_lshl_b32 s97, s35, 7
    s_add_u32 s96, s96, s97
    s_add_u32 s96, s96, 4194304
    v_lshrrev_b32 v126, 3, v0
    v_and_b32 v127, 7, v0
    v_and_b32 v125, 6, v126
    v_xor_b32 v125, v125, v127
    v_lshlrev_b32 v125, 4, v125
    v_lshl_add_u32 v125, v126, 7, v125
    s_mul_i32 s97, s32, 5120
    s_add_u32 s97, s97, 112640
    v_add_u32 v125, s97, v125
    v_lshlrev_b32 v126, 12, v126
    v_lshl_add_u32 v126, v127, 4, v126
    v_add_u32 v120, s96, v126
    v_add_u32 v121, 32768, v120
    v_add_u32 v122, 65536, v120
    v_add_u32 v123, 98304, v120
    v_add_u32 v124, 131072, v120
    s_and_b32 s44, s33, 0xffffff00
    s_add_u32 s44, s44, 0x600
    s_mov_b32 s100, 0
Lw_9:
    ds_read_b32 v4, v3 offset:196
    s_waitcnt lgkmcnt(0)
    v_readfirstlane_b32 s99, v4
    s_cmp_ge_u32 s99, 0
    s_cbranch_scc1 Lwd_10
    s_sleep 2
    s_add_u32 s100, s100, 1
    s_cmp_lt_u32 s100, 1048576
    s_cbranch_scc1 Lw_9
Lwd_10:
    ds_write_b128 v32, v[40:43] offset:0
    ds_write_b128 v32, v[44:47] offset:1024
    ds_write_b128 v32, v[48:51] offset:2048
    ds_write_b128 v32, v[52:55] offset:3072
    s_waitcnt lgkmcnt(4)
    ds_write_b128 v32, v[56:59] offset:4096
    v_mov_b32 v4, 1
    s_mov_b64 exec, 1
    ds_add_u32 v3, v4 offset:200
    s_mov_b64 exec, -1
    s_mov_b32 s100, 0
Lw_11:
    ds_read_b32 v4, v3 offset:196
    s_waitcnt lgkmcnt(0)
    v_readfirstlane_b32 s99, v4
    s_cmp_ge_u32 s99, 8
    s_cbranch_scc1 Lwd_12
    s_sleep 2
    s_add_u32 s100, s100, 1
    s_cmp_lt_u32 s100, 1048576
    s_cbranch_scc1 Lw_11
Lwd_12:
    s_mov_b32 s100, 0
Lw_13:
    ds_read_b32 v4, v3 offset:268
    s_waitcnt lgkmcnt(0)
    v_readfirstlane_b32 s99, v4
    s_cmp_ge_u32 s99, 72
    s_cbranch_scc1 Lwd_14
    s_sleep 1
    s_add_u32 s100, s100, 1
    s_cmp_lt_u32 s100, 1048576
    s_cbranch_scc1 Lw_13
Lwd_14:
    ds_write_b128 v33, v[60:63] offset:0
    ds_write_b128 v33, v[64:67] offset:1024
    ds_write_b128 v33, v[68:71] offset:2048
    ds_write_b128 v33, v[72:75] offset:3072
    s_waitcnt lgkmcnt(4)
    ds_write_b128 v33, v[76:79] offset:4096
    ds_write_b128 v33, v[80:83] offset:5120
    ds_write_b128 v33, v[84:87] offset:6144
    ds_write_b128 v33, v[88:91] offset:7168
    s_waitcnt lgkmcnt(4)
    ds_write_b128 v33, v[92:95] offset:8192
    ds_write_b128 v33, v[96:99] offset:9216
    ds_write_b128 v33, v[100:103] offset:10240
    ds_write_b128 v33, v[104:107] offset:11264
    s_waitcnt lgkmcnt(4)
    ds_write_b128 v33, v[108:111] offset:12288
    v_mov_b32 v4, 1
    s_mov_b64 exec, 1
    ds_add_u32 v3, v4 offset:204
    s_mov_b64 exec, -1
    s_cmp_lt_u32 s32, 2
    s_cbranch_scc1 L_aux
    s_endpgm
L_pada0:
    s_branch L_pada8
L_padb5:
    s_branch L_padb13
L_help:
    s_and_b32 s96, s35, 3
    s_lshl_b32 s96, s96, 9
    s_mul_i32 s97, s30, 262144
    s_add_u32 s96, s96, s97
    s_add_u32 s96, s96, 7537664
    v_lshl_add_u32 v14, v0, 3, s96
    v_lshl_add_u32 v13, v0, 2, v3
    s_mov_b32 s100, 0
L_gchk:
    global_load_dwordx2 v[18:19], v14, s[16:17] sc1
    s_waitcnt vmcnt(0)
    v_cmp_ne_u32 vcc, s33, v18
    s_cbranch_vccz L_gok
    s_sleep 4
    s_add_u32 s100, s100, 1
    s_cmp_lt_u32 s100, 1048576
    s_cbranch_scc1 L_gchk
L_gok:
    v_sub_f32 v18, 1.0, v19
    ds_write_b32 v13, v19 offset:768
    ds_write_b32 v13, v18 offset:512
    v_mov_b32 v4, 1
    s_mov_b64 exec, 1
    ds_add_u32 v3, v4 offset:208
    s_mov_b64 exec, -1
    s_cmp_eq_u32 s34, 0
    s_cbranch_scc1 L_wo_fl
    s_mul_i32 s96, s30, 262144
    s_and_b32 s97, s35, 3
    s_lshl_b32 s97, s97, 8
    s_add_u32 s96, s96, s97
    s_add_u32 s96, s96, 7536640
    v_lshl_add_u32 v12, v0, 2, s96
    s_mov_b32 exec_hi, 1048575
    s_mov_b32 exec_lo, 0xfffff
    s_mov_b32 s100, 0
L_rl1:
    global_load_dword v5, v12, s[16:17] sc1
    s_waitcnt vmcnt(0)
    v_cmp_ne_u32 vcc, s33, v5
    s_cbranch_vccz L_rd1
    s_sleep 2
    s_add_u32 s100, s100, 1
    s_cmp_lt_u32 s100, 1048576
    s_cbranch_scc1 L_rl1
L_rd1:
    s_mov_b64 exec, -1
    v_mov_b32 v4, 1
    ds_write_b32 v3, v4 offset:276
    s_cmp_lg_u32 s2, 176
    s_cbranch_scc1 L_th_exit
L_th_exit:
    s_endpgm
.p2align 12
L_pada1:
    s_branch L_pada9
L_as_nokv:
L_as_kv:
    s_sub_u32 s96, s31, 20
    s_mul_i32 s97, s96, 43
    s_lshr_b32 s97, s97, 7
    s_mul_i32 s98, s96, 7
    s_sub_u32 s98, s98, s97
    s_lshr_b32 s96, 0x924, s96
    s_and_b32 s96, s96, 1
    s_sub_u32 s64, 7, s96
    s_mul_i32 s97, s30, 80
    s_add_u32 s98, s98, s97
    s_add_u32 s56, s98, s32
    s_lshr_b32 s96, s56, 1
    s_lshl_b32 s96, s96, 2
    s_add_u32 s97, s96, 8
    s_min_u32 s97, s97, 1276
    s_load_dword s57, s[14:15], s96
    s_load_dword s58, s[14:15], s97
    s_lshl_b32 s98, s98, 12
    s_add_u32 s80, s12, s98
    s_addc_u32 s81, s13, 0
    s_and_b32 s81, s81, 0xffff
    s_lshl_b32 s82, s64, 12
    s_lshl_b32 s52, s32, 12
    s_add_u32 s53, s52, 16384
    v_lshlrev_b32 v18, 4, v0
    s_setprio 0
    s_waitcnt vmcnt(8)
    buffer_load_dwordx4 v[24:27], v18, s[80:83], s52 offen offset:0
    buffer_load_dwordx4 v[28:31], v18, s[80:83], s52 offen offset:1024
    buffer_load_dwordx4 v[32:35], v18, s[80:83], s52 offen offset:2048
    buffer_load_dwordx4 v[36:39], v18, s[80:83], s52 offen offset:3072
    buffer_load_dwordx4 v[40:43], v18, s[80:83], s53 offen offset:0
    buffer_load_dwordx4 v[44:47], v18, s[80:83], s53 offen offset:1024
    buffer_load_dwordx4 v[48:51], v18, s[80:83], s53 offen offset:2048
    buffer_load_dwordx4 v[52:55], v18, s[80:83], s53 offen offset:3072
    s_setprio 3
    s_waitcnt vmcnt(8) lgkmcnt(0)
    s_barrier
L_hpost:
    s_mul_i32 s33, s33, 1664525
    s_add_u32 s33, s33, 1013904223
    s_mul_i32 s54, s32, 8320
    s_add_u32 s96, s54, 1008
    v_sub_u32 v19, s96, v18
    v_lshl_add_u32 v20, v1, 2, s54
    s_lshl_b32 s96, s32, 2
    v_add_u32 v21, s96, v3
    v_mov_b32 v22, 0
    s_cmp_ge_u32 s38, 5
    s_cbranch_scc1 L_nohello
    s_mov_b32 s100, 0
Lw_15:
    ds_read_b32 v4, v3 offset:256
    s_waitcnt lgkmcnt(0)
    v_readfirstlane_b32 s99, v4
    s_cmp_ge_u32 s99, 8
    s_cbranch_scc1 Lwd_16
    s_sleep 1
    s_add_u32 s100, s100, 1
    s_cmp_lt_u32 s100, 1048576
    s_cbranch_scc1 Lw_15
Lwd_16:
    s_cmp_lg_u32 s32, 3
    s_cbranch_scc1 L_nohello
    s_waitcnt vmcnt(0)
    s_lshl_b32 s96, s30, 5
    s_add_u32 s96, s96, s31
    s_lshl_b32 s96, s96, 8
    s_add_u32 s96, s96, 65536
    v_lshl_add_u32 v4, v0, 3, s96
    v_mov_b32 v6, 0
    s_and_b32 s97, s33, 0xffffff00
    v_mov_b32 v7, s97
    s_getreg_b32 s97, hwreg(HW_REG_XCC_ID, 0, 4)
    v_writelane_b32 v6, s33, 3
    v_writelane_b32 v7, s97, 3
    s_mov_b64 exec, 0xffff
    global_store_dwordx2 v4, v[6:7], s[28:29] sc1
    s_mov_b64 exec, -1
L_nohello:
    s_mov_b32 s98, 0xffff
    s_lshl_b32 s96, s56, 4
    s_lshr_b32 s96, s57, s96
    s_lshl_b32 s96, s96, 16
    s_waitcnt vmcnt(4)
    s_mov_b64 exec, 1
    v_lshlrev_b32 v4, 16, v24
    v_add_f32 v4, s96, v4
    v_cvt_pk_bf16_f32 v4, v4, v4
    v_bfi_b32 v24, s98, v4, v24
    s_mov_b64 exec, -1
    v_readlane_b32 s60, v27, 63
    v_readlane_b32 s61, v31, 63
    v_readlane_b32 s62, v35, 63
    v_mov_b32_dpp v56, v27 wave_shr:1 row_mask:0xf bank_mask:0xf
    v_mov_b32_dpp v57, v31 wave_shr:1 row_mask:0xf bank_mask:0xf
    v_mov_b32_dpp v58, v35 wave_shr:1 row_mask:0xf bank_mask:0xf
    v_mov_b32_dpp v59, v39 wave_shr:1 row_mask:0xf bank_mask:0xf
    v_writelane_b32 v56, 0, 0
    v_writelane_b32 v57, s60, 0
    v_writelane_b32 v58, s61, 0
    v_writelane_b32 v59, s62, 0
    v_alignbit_b32 v60, v27, v27, 16
    v_bfi_b32 v76, s98, v27, v26
    v_alignbit_b32 v61, v26, v26, 16
    v_bfi_b32 v77, s98, v26, v25
    v_alignbit_b32 v62, v25, v25, 16
    v_bfi_b32 v78, s98, v25, v24
    v_alignbit_b32 v63, v24, v24, 16
    v_bfi_b32 v79, s98, v24, v56
    ds_write_b128 v19, v[60:63] offset:3072
    ds_write_b128 v19, v[76:79] offset:7232
    v_alignbit_b32 v64, v31, v31, 16
    v_bfi_b32 v80, s98, v31, v30
    v_alignbit_b32 v65, v30, v30, 16
    v_bfi_b32 v81, s98, v30, v29
    v_alignbit_b32 v66, v29, v29, 16
    v_bfi_b32 v82, s98, v29, v28
    v_alignbit_b32 v67, v28, v28, 16
    v_bfi_b32 v83, s98, v28, v57
    ds_write_b128 v19, v[64:67] offset:2048
    ds_write_b128 v19, v[80:83] offset:6208
    v_alignbit_b32 v68, v35, v35, 16
    v_bfi_b32 v84, s98, v35, v34
    v_alignbit_b32 v69, v34, v34, 16
    v_bfi_b32 v85, s98, v34, v33
    v_alignbit_b32 v70, v33, v33, 16
    v_bfi_b32 v86, s98, v33, v32
    v_alignbit_b32 v71, v32, v32, 16
    v_bfi_b32 v87, s98, v32, v58
    ds_write_b128 v19, v[68:71] offset:1024
    ds_write_b128 v19, v[84:87] offset:5184
    v_alignbit_b32 v72, v39, v39, 16
    v_bfi_b32 v88, s98, v39, v38
    v_alignbit_b32 v73, v38, v38, 16
    v_bfi_b32 v89, s98, v38, v37
    v_alignbit_b32 v74, v37, v37, 16
    v_bfi_b32 v90, s98, v37, v36
    v_alignbit_b32 v75, v36, v36, 16
    v_bfi_b32 v91, s98, v36, v59
    ds_write_b128 v19, v[72:75] offset:0
    ds_write_b128 v19, v[88:91] offset:4160
    ds_write_b32 v20, v22 offset:4096
    ds_write_b32 v20, v22 offset:8256
    v_mov_b32 v4, 1
    ds_write_b32 v21, v4 offset:312
    s_waitcnt lgkmcnt(0)
    s_add_u32 s96, s32, 4
    s_cmp_ge_u32 s96, s64
    s_cbranch_scc1 L_hb1
    s_lshl_b32 s96, s56, 4
    s_lshr_b32 s96, s58, s96
    s_lshl_b32 s96, s96, 16
    s_waitcnt vmcnt(0)
    s_mov_b64 exec, 1
    v_lshlrev_b32 v4, 16, v40
    v_add_f32 v4, s96, v4
    v_cvt_pk_bf16_f32 v4, v4, v4
    v_bfi_b32 v40, s98, v4, v40
    s_mov_b64 exec, -1
    v_readlane_b32 s60, v43, 63
    v_readlane_b32 s61, v47, 63
    v_readlane_b32 s62, v51, 63
    v_mov_b32_dpp v56, v43 wave_shr:1 row_mask:0xf bank_mask:0xf
    v_mov_b32_dpp v57, v47 wave_shr:1 row_mask:0xf bank_mask:0xf
    v_mov_b32_dpp v58, v51 wave_shr:1 row_mask:0xf bank_mask:0xf
    v_mov_b32_dpp v59, v55 wave_shr:1 row_mask:0xf bank_mask:0xf
    v_writelane_b32 v56, 0, 0
    v_writelane_b32 v57, s60, 0
    v_writelane_b32 v58, s61, 0
    v_writelane_b32 v59, s62, 0
    v_alignbit_b32 v60, v43, v43, 16
    v_bfi_b32 v76, s98, v43, v42
    v_alignbit_b32 v61, v42, v42, 16
    v_bfi_b32 v77, s98, v42, v41
    v_alignbit_b32 v62, v41, v41, 16
    v_bfi_b32 v78, s98, v41, v40
    v_alignbit_b32 v63, v40, v40, 16
    v_bfi_b32 v79, s98, v40, v56
    ds_write_b128 v19, v[60:63] offset:36352
    ds_write_b128 v19, v[76:79] offset:40512
    v_alignbit_b32 v64, v47, v47, 16
    v_bfi_b32 v80, s98, v47, v46
    v_alignbit_b32 v65, v46, v46, 16
    v_bfi_b32 v81, s98, v46, v45
    v_alignbit_b32 v66, v45, v45, 16
    v_bfi_b32 v82, s98, v45, v44
    v_alignbit_b32 v67, v44, v44, 16
    v_bfi_b32 v83, s98, v44, v57
    ds_write_b128 v19, v[64:67] offset:35328
    ds_write_b128 v19, v[80:83] offset:39488
    v_alignbit_b32 v68, v51, v51, 16
    v_bfi_b32 v84, s98, v51, v50
    v_alignbit_b32 v69, v50, v50, 16
    v_bfi_b32 v85, s98, v50, v49
    v_alignbit_b32 v70, v49, v49, 16
    v_bfi_b32 v86, s98, v49, v48
    v_alignbit_b32 v71, v48, v48, 16
    v_bfi_b32 v87, s98, v48, v58
    ds_write_b128 v19, v[68:71] offset:34304
    ds_write_b128 v19, v[84:87] offset:38464
    v_alignbit_b32 v72, v55, v55, 16
    v_bfi_b32 v88, s98, v55, v54
    v_alignbit_b32 v73, v54, v54, 16
    v_bfi_b32 v89, s98, v54, v53
    v_alignbit_b32 v74, v53, v53, 16
    v_bfi_b32 v90, s98, v53, v52
    v_alignbit_b32 v75, v52, v52, 16
    v_bfi_b32 v91, s98, v52, v59
    ds_write_b128 v19, v[72:75] offset:33280
    ds_write_b128 v19, v[88:91] offset:37440
    ds_write_b32 v20, v22 offset:37376
    ds_write_b32 v20, v22 offset:41536
    v_mov_b32 v4, 1
    ds_write_b32 v21, v4 offset:328
    s_waitcnt lgkmcnt(0)
L_hb1:
    s_cmp_eq_u32 s32, 3
    s_cbranch_scc1 L_ahelp
    s_setprio 1
    s_mul_i32 s96, s36, 102400
    s_add_u32 s96, s96, 9437184
    s_add_u32 s48, s28, s96
    s_addc_u32 s49, s29, 0
    s_and_b32 s49, s49, 0xffff
    s_mov_b32 s50, 102400
    s_mov_b32 s51, 0x00020000
    v_lshlrev_b32 v19, 4, v0
    s_lshl1_add_u32 s96, s35, s32
    s_mul_i32 s96, s96, 40960
    s_mul_i32 s97, s36, 160
    s_add_u32 s96, s96, s97
    v_add_u32 v4, 0, v0
    v_mul_u32_u24 v8, 6554, v4
    v_lshrrev_b32 v8, 16, v8
    v_mul_u32_u24 v8, 1120, v8
    v_lshl_add_u32 v4, v4, 4, s96
    v_add_u32 v8, v8, v4
    v_add_u32 v4, 64, v0
    v_mul_u32_u24 v9, 6554, v4
    v_lshrrev_b32 v9, 16, v9
    v_mul_u32_u24 v9, 1120, v9
    v_lshl_add_u32 v4, v4, 4, s96
    v_add_u32 v9, v9, v4
    v_add_u32 v4, 128, v0
    v_mul_u32_u24 v10, 6554, v4
    v_lshrrev_b32 v10, 16, v10
    v_mul_u32_u24 v10, 1120, v10
    v_lshl_add_u32 v4, v4, 4, s96
    v_add_u32 v10, v10, v4
    v_add_u32 v4, 192, v0
    v_mul_u32_u24 v11, 6554, v4
    v_lshrrev_b32 v11, 16, v11
    v_mul_u32_u24 v11, 1120, v11
    v_lshl_add_u32 v4, v4, 4, s96
    v_add_u32 v11, v11, v4
    v_add_u32 v4, 256, v0
    v_mul_u32_u24 v12, 6554, v4
    v_lshrrev_b32 v12, 16, v12
    v_mul_u32_u24 v12, 1120, v12
    v_lshl_add_u32 v4, v4, 4, s96
    v_add_u32 v12, v12, v4
    s_mul_i32 s96, s32, 5120
    s_add_u32 s96, s96, 48128
    v_add_u32 v21, s96, v19
    s_mul_i32 s59, s32, 9216
    s_add_u32 s96, s59, 58368
    v_add_u32 v20, s96, v19
    s_add_u32 s60, s59, 51200
    s_setprio 3
    s_mov_b32 s100, 0
Lw_17:
    ds_read_b32 v4, v3 offset:280
    s_waitcnt lgkmcnt(0)
    v_readfirstlane_b32 s99, v4
    s_cmp_ge_u32 s99, 8
    s_cbranch_scc1 Lwd_18
    s_sleep 4
    s_add_u32 s100, s100, 1
    s_cmp_lt_u32 s100, 1048576
    s_cbranch_scc1 Lw_17
Lwd_18:
    s_mov_b32 s100, 0
Lw_19:
    ds_read_b32 v4, v3 offset:192
    s_waitcnt lgkmcnt(0)
    v_readfirstlane_b32 s99, v4
    s_cmp_ge_u32 s99, 1
    s_cbranch_scc1 Lwd_20
    s_sleep 2
    s_add_u32 s100, s100, 1
    s_cmp_lt_u32 s100, 1048576
    s_cbranch_scc1 Lw_19
Lwd_20:
    s_mov_b32 s59, 0
    s_cmp_eq_u32 s32, 1
    s_cselect_b32 s59, 17408, s59
    s_cmp_eq_u32 s32, 2
    s_cselect_b32 s59, 33792, s59
    s_add_u32 m0, s59, 109568
    s_nop 0
    buffer_load_dwordx4 v19, s[48:51], s59 offen offset:0 sc1 lds
    s_waitcnt vmcnt(3)
    buffer_load_dwordx4 v19, s[48:51], s59 offen offset:1024 sc1 lds
    s_waitcnt vmcnt(3)
    buffer_load_dwordx4 v19, s[48:51], s59 offen offset:2048 sc1 lds
    s_waitcnt vmcnt(3)
    buffer_load_dwordx4 v19, s[48:51], s59 offen offset:3072 sc1 lds
    s_addk_i32 m0, 4096
    s_addk_i32 s59, 4096
    s_waitcnt vmcnt(3)
    buffer_load_dwordx4 v19, s[48:51], s59 offen offset:0 sc1 lds
    s_waitcnt vmcnt(3)
    buffer_load_dwordx4 v19, s[48:51], s59 offen offset:1024 sc1 lds
    s_waitcnt vmcnt(3)
    buffer_load_dwordx4 v19, s[48:51], s59 offen offset:2048 sc1 lds
    s_waitcnt vmcnt(3)
    buffer_load_dwordx4 v19, s[48:51], s59 offen offset:3072 sc1 lds
    s_addk_i32 m0, 4096
    s_addk_i32 s59, 4096
    s_waitcnt vmcnt(3)
    buffer_load_dwordx4 v19, s[48:51], s59 offen offset:0 sc1 lds
    s_waitcnt vmcnt(3)
    buffer_load_dwordx4 v19, s[48:51], s59 offen offset:1024 sc1 lds
    s_waitcnt vmcnt(3)
    buffer_load_dwordx4 v19, s[48:51], s59 offen offset:2048 sc1 lds
    s_waitcnt vmcnt(3)
    buffer_load_dwordx4 v19, s[48:51], s59 offen offset:3072 sc1 lds
    s_addk_i32 m0, 4096
    s_addk_i32 s59, 4096
    s_waitcnt vmcnt(3)
    buffer_load_dwordx4 v19, s[48:51], s59 offen offset:0 sc1 lds
    s_waitcnt vmcnt(3)
    buffer_load_dwordx4 v19, s[48:51], s59 offen offset:1024 sc1 lds
    s_waitcnt vmcnt(3)
    buffer_load_dwordx4 v19, s[48:51], s59 offen offset:2048 sc1 lds
    s_waitcnt vmcnt(3)
    buffer_load_dwordx4 v19, s[48:51], s59 offen offset:3072 sc1 lds
    s_addk_i32 m0, 4096
    s_addk_i32 s59, 4096
    s_waitcnt vmcnt(3)
    buffer_load_dwordx4 v19, s[48:51], s59 offen offset:0 sc1 lds
    s_waitcnt vmcnt(3)
    s_mov_b32 s59, s60
    buffer_load_dwordx4 v[24:27], v19, s[48:51], s59 offen offset:0 sc1
    buffer_load_dwordx4 v[28:31], v19, s[48:51], s59 offen offset:1024 sc1
    buffer_load_dwordx4 v[32:35], v19, s[48:51], s59 offen offset:2048 sc1
    buffer_load_dwordx4 v[36:39], v19, s[48:51], s59 offen offset:3072 sc1
    s_addk_i32 s59, 4096
    buffer_load_dwordx4 v[40:43], v19, s[48:51], s59 offen offset:0 sc1
    buffer_load_dwordx4 v[44:47], v19, s[48:51], s59 offen offset:1024 sc1
    buffer_load_dwordx4 v[48:51], v19, s[48:51], s59 offen offset:2048 sc1
    buffer_load_dwordx4 v[52:55], v19, s[48:51], s59 offen offset:3072 sc1
    s_addk_i32 s59, 4096
    buffer_load_dwordx4 v[56:59], v19, s[48:51], s59 offen offset:0 sc1
    s_cmp_lt_u32 s32, 2
    s_cbranch_scc1 L_ai_x
    s_addk_i32 s59, 1024
    buffer_load_dwordx4 v[84:87], v19, s[48:51], s59 offen offset:0 sc1
    buffer_load_dwordx4 v[88:91], v19, s[48:51], s59 offen offset:1024 sc1
    buffer_load_dwordx4 v[92:95], v19, s[48:51], s59 offen offset:2048 sc1
    buffer_load_dwordx4 v[96:99], v19, s[48:51], s59 offen offset:3072 sc1
    s_addk_i32 s59, 4096
    buffer_load_dwordx4 v[100:103], v19, s[48:51], s59 offen offset:0 sc1
    v_add_u32 v21, 9216, v20
    s_branch L_ai_d
L_pada2:
    s_branch L_pada10
L_ai_x:
    global_load_dwordx4 v[84:87], v8, s[4:5]
    global_load_dwordx4 v[88:91], v9, s[4:5]
    global_load_dwordx4 v[92:95], v10, s[4:5]
    global_load_dwordx4 v[96:99], v11, s[4:5]
    global_load_dwordx4 v[100:103], v12, s[4:5]
L_ai_d:
    s_waitcnt vmcnt(0)
    v_mov_b32 v4, 1
    s_mov_b64 exec, 1
    ds_add_u32 v3, v4 offset:200
    s_mov_b64 exec, -1
    s_lshl_b32 s96, s30, 5
    s_add_u32 s96, s96, s31
    s_lshl_b32 s96, s96, 8
    s_add_u32 s96, s96, 65536
    s_lshl3_add_u32 s96, s32, s96
    s_add_u32 s40, s28, s96
    s_addc_u32 s41, s29, 0
    s_mul_i32 s96, s36, 327680
    s_mul_i32 s97, s32, 163840
    s_add_u32 s96, s96, s97
    s_lshl_b32 s97, s35, 7
    s_add_u32 s96, s96, s97
    s_add_u32 s96, s96, 4194304
    v_lshrrev_b32 v126, 3, v0
    v_and_b32 v127, 7, v0
    v_and_b32 v125, 6, v126
    v_xor_b32 v125, v125, v127
    v_lshlrev_b32 v125, 4, v125
    v_lshl_add_u32 v125, v126, 7, v125
    s_mul_i32 s97, s32, 5120
    s_add_u32 s97, s97, 0
    v_add_u32 v125, s97, v125
    v_lshlrev_b32 v126, 12, v126
    v_lshl_add_u32 v126, v127, 4, v126
    v_add_u32 v120, s96, v126
    v_add_u32 v121, 32768, v120
    v_add_u32 v122, 65536, v120
    v_add_u32 v123, 98304, v120
    v_add_u32 v124, 131072, v120
    s_and_b32 s44, s33, 0xffffff00
    s_add_u32 s44, s44, 0x600
    s_mov_b32 s100, 0
Lw_21:
    ds_read_b32 v4, v3 offset:304
    s_waitcnt lgkmcnt(0)
    v_readfirstlane_b32 s99, v4
    s_cmp_ge_u32 s99, 1
    s_cbranch_scc1 Lwd_22
    s_sleep 8
    s_add_u32 s100, s100, 1
    s_cmp_lt_u32 s100, 1048576
    s_cbranch_scc1 Lw_21
Lwd_22:
    s_mov_b32 s100, 0
Lw_23:
    ds_read_b32 v4, v3 offset:196
    s_waitcnt lgkmcnt(0)
    v_readfirstlane_b32 s99, v4
    s_cmp_ge_u32 s99, 8
    s_cbranch_scc1 Lwd_24
    s_sleep 1
    s_add_u32 s100, s100, 1
    s_cmp_lt_u32 s100, 1048576
    s_cbranch_scc1 Lw_23
Lwd_24:
    ds_write_b128 v21, v[84:87] offset:0
    ds_write_b128 v21, v[88:91] offset:1024
    ds_write_b128 v21, v[92:95] offset:2048
    ds_write_b128 v21, v[96:99] offset:3072
    s_waitcnt lgkmcnt(4)
    ds_write_b128 v21, v[100:103] offset:4096
    s_lshr_b32 s96, s32, 1
    s_xor_b32 s96, s96, 1
    v_mov_b32 v4, s96
    s_mov_b64 exec, 1
    ds_add_u32 v3, v4 offset:376
    s_mov_b64 exec, -1
    s_setprio 0
    ds_write_b128 v20, v[24:27] offset:0
    ds_write_b128 v20, v[28:31] offset:1024
    ds_write_b128 v20, v[32:35] offset:2048
    ds_write_b128 v20, v[36:39] offset:3072
    s_waitcnt lgkmcnt(4)
    ds_write_b128 v20, v[40:43] offset:4096
    ds_write_b128 v20, v[44:47] offset:5120
    ds_write_b128 v20, v[48:51] offset:6144
    ds_write_b128 v20, v[52:55] offset:7168
    s_waitcnt lgkmcnt(4)
    ds_write_b128 v20, v[56:59] offset:8192
    s_setprio 3
    v_mov_b32 v4, 1
    s_mov_b64 exec, 1
    ds_add_u32 v3, v4 offset:204
    s_mov_b64 exec, -1
    s_cmp_lt_u32 s32, 2
    s_cbranch_scc1 L_aux
    s_endpgm
L_pada3:
    s_branch L_pada11
L_ahelp:
    v_lshlrev_b32 v4, 2, v0
    v_add_u32 v4, 161792, v4
    v_mov_b32 v5, 0
    ds_write_b32 v4, v5
    s_cmp_lt_u32 s38, 5
    s_cbranch_scc1 L_hell2
    s_mov_b32 s100, 0
Lw_25:
    ds_read_b32 v4, v3 offset:256
    s_waitcnt lgkmcnt(0)
    v_readfirstlane_b32 s99, v4
    s_cmp_ge_u32 s99, 8
    s_cbranch_scc1 Lwd_26
    s_sleep 1
    s_add_u32 s100, s100, 1
    s_cmp_lt_u32 s100, 1048576
    s_cbranch_scc1 Lw_25
Lwd_26:
    s_lshl_b32 s96, s30, 5
    s_add_u32 s96, s96, s31
    s_lshl_b32 s96, s96, 8
    s_add_u32 s96, s96, 65536
    v_lshl_add_u32 v4, v0, 3, s96
    v_mov_b32 v6, 0
    s_and_b32 s97, s33, 0xffffff00
    v_mov_b32 v7, s97
    s_getreg_b32 s97, hwreg(HW_REG_XCC_ID, 0, 4)
    v_writelane_b32 v6, s33, 3
    v_writelane_b32 v7, s97, 3
    s_mov_b64 exec, 0xffff
    global_store_dwordx2 v4, v[6:7], s[28:29] sc1
    s_mov_b64 exec, -1
L_hell2:
    s_cmp_lg_u32 s31, 22
    s_cbranch_scc1 L_nocen
    s_mov_b32 s100, 0
Lw_27:
    ds_read_b32 v4, v3 offset:280
    s_waitcnt lgkmcnt(0)
    v_readfirstlane_b32 s99, v4
    s_cmp_ge_u32 s99, 4
    s_cbranch_scc1 Lwd_28
    s_sleep 2
    s_add_u32 s100, s100, 1
    s_cmp_lt_u32 s100, 1048576
    s_cbranch_scc1 Lw_27
Lwd_28:
    s_lshl_b32 s96, s30, 13
    s_add_u32 s96, s96, 65536
    v_and_b32 v4, 31, v0
    v_lshl_add_u32 v20, v4, 8, s96
    v_and_b32 v4, 7, v0
    v_bfe_u32 v5, v0, 3, 1
    v_lshl_add_u32 v4, v4, 5, v5
    v_lshlrev_b32 v4, 8, v4
    s_mov_b32 exec_lo, 0
    v_add_u32 v20, 73216, v4
    s_mov_b32 exec_lo, -1
    v_mov_b32 v24, 0
    v_mov_b32 v25, 0
    s_mov_b32 s60, -1
    s_mov_b32 s61, 0xffff
    s_mov_b64 exec, s[60:61]
    s_mov_b32 s100, 0
L_hpg:
    global_atomic_or_x2 v[26:27], v20, v[24:25], s[28:29] offset:24 sc0 sc1
    s_waitcnt vmcnt(0)
    v_cmp_ne_u32 vcc, s33, v26
    s_cbranch_vccz L_hdg
    s_mov_b64 exec, vcc
    s_sleep 2
    s_add_u32 s100, s100, 1
    s_cmp_lt_u32 s100, 1048576
    s_cbranch_scc1 L_hpg
L_hdg:
    s_mov_b64 exec, -1
    v_readfirstlane_b32 s96, v27
    s_nop 1
    v_cmp_ne_u32 vcc, s96, v27
    s_cmp_eq_u32 vcc_lo, 0
    s_cselect_b32 s96, 1, 2
    v_mov_b32 v22, s33
    v_mov_b32 v23, s96
    s_mov_b64 exec, 0xffffffff
    global_store_dwordx2 v20, v[22:23], s[28:29] offset:136 sc1
    s_mov_b64 exec, -1
L_nocen:
    s_sub_u32 s52, s31, 20
    s_mul_i32 s96, s30, 262144
    s_mul_i32 s97, s52, 384
    s_add_u32 s96, s96, s97
    s_add_u32 s53, s96, 7536640
    s_mul_i32 s96, s30, 327680
    s_mul_i32 s97, s52, 27392
    s_min_u32 s97, s97, 300288
    s_add_u32 s96, s96, s97
    s_add_u32 s54, s96, 0
    s_mul_i32 s55, s36, 102400
    s_add_u32 s55, s55, 9437184
    v_lshlrev_b32 v15, 7, v0
    s_mov_b32 s44, s28
    s_and_b32 s45, s29, 0xffff
    s_mov_b32 s46, 16777216
    s_mov_b32 s47, 0x00020000
    s_mov_b32 s100, 0
Lw_29:
    ds_read_b32 v4, v3 offset:280
    s_waitcnt lgkmcnt(0)
    v_readfirstlane_b32 s99, v4
    s_cmp_ge_u32 s99, 8
    s_cbranch_scc1 Lwd_30
    s_sleep 2
    s_add_u32 s100, s100, 1
    s_cmp_lt_u32 s100, 1048576
    s_cbranch_scc1 Lw_29
Lwd_30:
    s_mov_b64 exec, 0x7
    buffer_load_dword v18, v15, s[44:47], s53 offen sc1
    s_add_u32 s53, s53, 8192
    s_mov_b64 exec, -1
    s_mov_b32 s40, s24
    s_and_b32 s41, s25, 0xffff
    s_mov_b32 s42, 2621440
    s_mov_b32 s43, 0x00020000
    buffer_load_dword v18, v15, s[40:43], s54 offen sc1
    s_add_u32 s54, s54, 8192
    buffer_load_dword v18, v15, s[40:43], s54 offen sc1
    s_add_u32 s54, s54, 8192
    buffer_load_dword v18, v15, s[40:43], s54 offen sc1
    s_add_u32 s54, s54, 8192
    s_mov_b64 exec, 0x3fffff
    buffer_load_dword v18, v15, s[40:43], s54 offen sc1
    s_add_u32 s54, s54, 8192
    s_mov_b64 exec, -1
    s_lshl_b32 s98, s30, 5
    s_add_u32 s98, s98, s31
    s_lshl_b32 s98, s98, 8
    s_add_u32 s98, s98, 65536
    s_add_u32 s98, s98, 128
    s_mov_b32 s100, 0
Lc_31:
    s_load_dwordx4 s[88:91], s[28:29], s98 glc
    s_waitcnt lgkmcnt(0)
    s_cmp_eq_u32 s90, s33
    s_cbranch_scc1 Lcd_32
    s_sleep 2
    s_add_u32 s100, s100, 1
    s_cmp_lt_u32 s100, 1048576
    s_cbranch_scc1 Lc_31
    s_mov_b32 s91, 2
Lcd_32:
    s_cmp_eq_u32 s91, 1
    s_cselect_b32 s99, 0, 15728640
    s_add_u32 s16, s28, s99
    s_addc_u32 s17, s29, 0
    v_mov_b32 v4, s91
    ds_write_b32 v3, v4 offset:192
    s_waitcnt vmcnt(0)
    v_mov_b32 v4, 1
    ds_write_b32 v3, v4 offset:248
    v_mov_b32 v4, 1
    s_mov_b64 exec, 1
    ds_add_u32 v3, v4 offset:200
    s_mov_b64 exec, -1
    s_cmp_lg_u32 s2, 176
    s_cbranch_scc1 L_noep
    v_lshlrev_b32 v20, 8, v0
    v_add_u32 v20, 65536, v20
    v_mov_b32 v24, 0
    v_mov_b32 v25, 0
    s_mov_b32 s52, 0
L_epl:
    s_mov_b64 exec, -1
    s_mov_b32 s100, 0
L_hpe:
    global_atomic_or_x2 v[26:27], v20, v[24:25], s[28:29] offset:24 sc0 sc1
    s_waitcnt vmcnt(0)
    v_cmp_ne_u32 vcc, s33, v26
    s_cbranch_vccz L_hde
    s_mov_b64 exec, vcc
    s_sleep 8
    s_add_u32 s100, s100, 1
    s_cmp_lt_u32 s100, 1048576
    s_cbranch_scc1 L_hpe
L_hde:
    s_mov_b64 exec, -1
    v_add_u32 v20, 0x4000, v20
    s_add_u32 s52, s52, 1
    s_cmp_lt_u32 s52, 4
    s_cbranch_scc1 L_epl
    v_mov_b32 v4, 0
    v_mov_b32 v5, s33
    s_mov_b64 exec, 1
    global_store_dword v4, v5, s[28:29] sc1
    s_mov_b64 exec, -1
L_noep:
    s_mov_b32 s100, 0
Lw_33:
    ds_read_b32 v4, v3 offset:304
    s_waitcnt lgkmcnt(0)
    v_readfirstlane_b32 s99, v4
    s_cmp_ge_u32 s99, 1
    s_cbranch_scc1 Lwd_34
    s_sleep 8
    s_add_u32 s100, s100, 1
    s_cmp_lt_u32 s100, 1048576
    s_cbranch_scc1 Lw_33
Lwd_34:
    s_branch L_help
.p2align 12
L_pada4:
    s_branch L_pada12
L_padb6:
    s_branch L_padb14
L_aux:
    s_mov_b32 s100, 0
L_yp:
    s_load_dwordx2 s[42:43], s[40:41], 0 glc
    s_waitcnt lgkmcnt(0)
    s_and_b32 s43, s43, 0xffffff00
    s_cmp_eq_u32 s43, s44
    s_cbranch_scc1 L_ypd
    s_sleep 1
    s_add_u32 s100, s100, 1
    s_cmp_lt_u32 s100, 1048576
    s_cbranch_scc1 L_yp
L_ypd:
    s_mov_b32 s100, 0
L_yretry:
    global_load_dwordx4 v[128:131], v120, s[28:29] sc1
    global_load_dwordx4 v[132:135], v121, s[28:29] sc1
    global_load_dwordx4 v[136:139], v122, s[28:29] sc1
    global_load_dwordx4 v[140:143], v123, s[28:29] sc1
    global_load_dwordx4 v[144:147], v124, s[28:29] sc1
    v_mov_b32 v16, 0
    s_waitcnt vmcnt(4)
    ds_write_b128 v125, v[128:131] offset:0
    v_add3_u32 v16, v16, v128, v129
    v_add3_u32 v16, v16, v130, v131
    s_waitcnt vmcnt(3)
    ds_write_b128 v125, v[132:135] offset:1024
    v_add3_u32 v16, v16, v132, v133
    v_add3_u32 v16, v16, v134, v135
    s_waitcnt vmcnt(2)
    ds_write_b128 v125, v[136:139] offset:2048
    v_add3_u32 v16, v16, v136, v137
    v_add3_u32 v16, v16, v138, v139
    s_waitcnt vmcnt(1)
    ds_write_b128 v125, v[140:143] offset:3072
    v_add3_u32 v16, v16, v140, v141
    v_add3_u32 v16, v16, v142, v143
    s_waitcnt vmcnt(0)
    ds_write_b128 v125, v[144:147] offset:4096
    v_add3_u32 v16, v16, v144, v145
    v_add3_u32 v16, v16, v146, v147
    s_nop 1
    v_add_u32_dpp v16, v16, v16 row_ror:8 row_mask:0xf bank_mask:0xf
    s_nop 1
    v_add_u32_dpp v16, v16, v16 row_ror:4 row_mask:0xf bank_mask:0xf
    s_nop 1
    v_add_u32_dpp v16, v16, v16 row_ror:2 row_mask:0xf bank_mask:0xf
    s_nop 1
    v_add_u32_dpp v16, v16, v16 row_ror:1 row_mask:0xf bank_mask:0xf
    s_nop 0
    v_readlane_b32 s96, v16, 0
    v_readlane_b32 s97, v16, 16
    v_readlane_b32 s98, v16, 32
    v_readlane_b32 s99, v16, 48
    s_add_u32 s96, s96, s97
    s_add_u32 s98, s98, s99
    s_add_u32 s96, s96, s98
    s_cmp_eq_u32 s96, s42
    s_cbranch_scc1 L_yok
    s_sleep 2
    s_add_u32 s100, s100, 1
    s_cmp_lt_u32 s100, 1048576
    s_cbranch_scc1 L_yretry
L_yok:
    v_mov_b32 v4, 1
    s_mov_b64 exec, 1
    ds_add_u32 v3, v4 offset:212
    s_mov_b64 exec, -1
    s_endpgm
L_compute:
    s_waitcnt lgkmcnt(0)
    s_load_dword s33, s[28:29], 0
    s_setprio 2
    s_sub_u32 s40, s32, 4
    s_lshr_b32 s42, s40, 2
    s_and_b32 s56, s40, 3
    s_xor_b32 s41, s56, s42
    s_sub_u32 s46, s38, 5
    s_cselect_b32 s46, s38, s46
    s_mov_b32 s96, 0xf9af5600
    s_mov_b32 s45, 0x886f5f4f
    s_cmp_eq_u32 s46, 1
    s_cselect_b32 s96, 0xfeab5500, s96
    s_cselect_b32 s45, 0x8c5f4f8f, s45
    s_cmp_eq_u32 s46, 2
    s_cselect_b32 s96, 0xffaa5500, s96
    s_cselect_b32 s45, 0x8e4f3f87, s45
    s_cmp_eq_u32 s46, 3
    s_cselect_b32 s96, 0xffaa1540, s96
    s_cselect_b32 s45, 0x8f3f2f83, s45
    s_cmp_eq_u32 s46, 4
    s_cselect_b32 s96, 0xff6a0590, s96
    s_cselect_b32 s45, 0x3f2f1f81, s45
    s_lshl_b32 s97, s41, 3
    s_lshr_b32 s96, s96, s97
    s_lshr_b32 s45, s45, s97
    s_and_b32 s45, s45, 0xff
    v_lshrrev_b32 v5, 1, v1
    v_xor_b32 v5, v5, v2
    v_lshlrev_b32 v5, 4, v5
    v_lshl_add_u32 v132, v1, 7, v5
    s_lshl_b32 s97, s42, 13
    v_add_u32 v132, s97, v132
    v_and_b32 v4, 3, v0
    v_lshlrev_b32 v5, 1, v4
    v_bfe_u32 v5, s96, v5, 2
    v_bfe_u32 v6, v0, 3, 2
    v_xor_b32 v5, v5, v6
    v_lshl_add_u32 v5, v5, 2, v4
    v_bfe_u32 v6, v0, 2, 2
    v_mad_u32_u24 v6, v2, 24, v6
    v_lshlrev_b32 v6, 7, v6
    v_lshl_add_u32 v133, v5, 3, v6
    v_add_u32 v133, 18432, v133
    v_mov_b32 v8, 0
    v_mov_b32 v9, 0
    v_mov_b32 v10, 0
    v_mov_b32 v11, 0
    v_mov_b32 v12, 0
    v_mov_b32 v13, 0
    v_mov_b32 v14, 0
    v_mov_b32 v15, 0
    v_mov_b32 v16, 0
    v_mov_b32 v17, 0
    v_mov_b32 v18, 0
    v_mov_b32 v19, 0
    v_mov_b32 v20, 0
    v_mov_b32 v21, 0
    v_mov_b32 v22, 0
    v_mov_b32 v23, 0
    v_mov_b32 v24, 0
    v_mov_b32 v25, 0
    v_mov_b32 v26, 0
    v_mov_b32 v27, 0
    v_mov_b32 v28, 0
    v_mov_b32 v29, 0
    v_mov_b32 v30, 0
    v_mov_b32 v31, 0
    v_mov_b32 v32, 0
    v_mov_b32 v33, 0
    v_mov_b32 v34, 0
    v_mov_b32 v35, 0
    v_mov_b32 v36, 0
    v_mov_b32 v37, 0
    v_mov_b32 v38, 0
    v_mov_b32 v39, 0
    v_mov_b32 v40, 0
    v_mov_b32 v41, 0
    v_mov_b32 v42, 0
    v_mov_b32 v43, 0
    v_mov_b32 v44, 0
    v_mov_b32 v45, 0
    v_mov_b32 v46, 0
    v_mov_b32 v47, 0
    v_mov_b32 v48, 0
    v_mov_b32 v49, 0
    v_mov_b32 v50, 0
    v_mov_b32 v51, 0
    v_mov_b32 v52, 0
    v_mov_b32 v53, 0
    v_mov_b32 v54, 0
    v_mov_b32 v55, 0
    v_mov_b32 v56, 0
    v_mov_b32 v57, 0
    v_mov_b32 v58, 0
    v_mov_b32 v59, 0
    v_mov_b32 v60, 0
    v_mov_b32 v61, 0
    v_mov_b32 v62, 0
    v_mov_b32 v63, 0
    v_mov_b32 v64, 0
    v_mov_b32 v65, 0
    v_mov_b32 v66, 0
    v_mov_b32 v67, 0
    s_mov_b32 s43, 0
    s_mov_b32 s44, 86016
    v_add_u32 v134, 86016, v132
    v_xor_b32 v135, 64, v134
    v_add_u32 v136, 86016, v133
    v_mov_b32 v7, 0xf149f2ca
    v_lshlrev_b32 v4, 2, v2
    v_sub_u32 v4, v1, v4
    v_subrev_u32 v5, 0, v4
    v_and_b32 v5, 0x80000001, v5
    v_cmp_eq_u32 vcc, 0, v5
    s_nop 1
    v_cndmask_b32 v144, v7, 0, vcc
    v_cmp_eq_u32 vcc, 0x80000000, v5
    s_nop 1
    v_cndmask_b32 v148, v7, 0, vcc
    v_subrev_u32 v5, 1, v4
    v_and_b32 v5, 0x80000001, v5
    v_cmp_eq_u32 vcc, 0, v5
    s_nop 1
    v_cndmask_b32 v145, v7, 0, vcc
    v_cmp_eq_u32 vcc, 0x80000000, v5
    s_nop 1
    v_cndmask_b32 v149, v7, 0, vcc
    v_subrev_u32 v5, 2, v4
    v_and_b32 v5, 0x80000001, v5
    v_cmp_eq_u32 vcc, 0, v5
    s_nop 1
    v_cndmask_b32 v146, v7, 0, vcc
    v_cmp_eq_u32 vcc, 0x80000000, v5
    s_nop 1
    v_cndmask_b32 v150, v7, 0, vcc
    v_subrev_u32 v5, 3, v4
    v_and_b32 v5, 0x80000001, v5
    v_cmp_eq_u32 vcc, 0, v5
    s_nop 1
    v_cndmask_b32 v147, v7, 0, vcc
    v_cmp_eq_u32 vcc, 0x80000000, v5
    s_nop 1
    v_cndmask_b32 v151, v7, 0, vcc
    v_and_b32 v5, 1, v1
    v_lshlrev_b32 v6, 4, v5
    v_mov_b32 v7, 0xffff
    v_lshlrev_b32 v7, v6, v7
    v_sub_u32 v5, v4, v5
    v_cmp_le_i32 vcc, 0, v5
    s_nop 1
    v_cndmask_b32 v152, 0, v7, vcc
    v_cndmask_b32 v154, v7, 0, vcc
    v_cmp_le_i32 vcc, 2, v5
    s_nop 1
    v_cndmask_b32 v153, 0, v7, vcc
    v_cndmask_b32 v155, v7, 0, vcc
    v_mov_b32 v7, 0x0c0c0c0c
    s_mov_b32 s96, 0x1000100
    v_bfi_b32 v152, v152, s96, v7
    s_mov_b32 s96, 0x3020302
    v_bfi_b32 v153, v153, s96, v7
    s_mov_b32 s96, 0x1000100
    v_bfi_b32 v154, v154, s96, v7
    s_mov_b32 s96, 0x3020302
    v_bfi_b32 v155, v155, s96, v7
    s_or_b32 s96, s37, s42
    s_cmp_eq_u32 s96, 0
    s_cselect_b32 s96, 0xf149f2ca, 0
    v_add_f32 v140, s96, v148
    v_add_f32 v141, s96, v149
    v_add_f32 v142, s96, v150
    v_add_f32 v143, s96, v151
    s_mov_b32 s54, 0x3ea52b5c
    v_bfe_i32 v157, s45, v2, 1
    v_cmp_ne_u32 s[50:51], 0, v157
    s_bfe_u32 s60, s45, 131076
    v_cmp_eq_u32 s[52:53], s60, v2
    s_bfe_u32 s61, s45, 65542
    s_lshr_b32 s62, s41, 1
    s_add_u32 s96, s41, 1
    s_bfe_u32 s96, s96, 65537
    s_xor_b32 s57, s96, 1
    s_bitcmp1_b32 s45, 7
    s_cselect_b32 s63, s62, s61
    s_mul_i32 s96, s63, 13824
    s_lshl_b32 s97, s42, 11
    s_add_u32 s96, s96, s97
    s_add_u32 s96, s96, 129024
    v_lshl_add_u32 v156, v0, 3, s96
    v_and_b32 v4, 0x33, v0
    s_lshl_b32 s97, s60, 5
    s_add_u32 s96, s96, s97
    v_lshl_add_u32 v162, v4, 3, s96
    s_lshl_b32 s96, s41, 10
    s_add_u32 s96, s96, 156672
    v_lshl_add_u32 v164, v0, 3, s96
    v_min_u32 v4, 16, v0
    v_lshl_add_u32 v163, v4, 2, v3
    v_add_u32 v163, 128, v163
    s_lshl1_add_u32 s96, s41, s42
    s_lshl_b32 s96, s96, 2
    v_add_u32 v165, s96, v3
    s_lshl_b32 s96, s41, 1
    s_lshl_b32 s96, s42, s96
    s_lshl1_add_u32 s97, s42, 1
    s_mul_i32 s98, s61, 6
    s_lshl_b32 s97, s97, s98
    s_or_b32 s98, s96, s97
    s_bitcmp1_b32 s45, 7
    s_cselect_b32 s48, s96, s98
    s_cselect_b32 s49, s96, s97
    s_lshl_b32 s49, s49, 8
    s_and_b32 s64, s37, 1
    s_lshl1_add_u32 s65, s64, s42
    s_mul_i32 s96, s65, 81920
    s_mul_i32 s97, s30, 327680
    s_add_u32 s96, s96, s97
    s_lshl_b32 s97, s38, 11
    s_add_u32 s96, s96, s97
    s_add_u32 s67, s96, 20480
    s_mul_i32 s97, s57, 20480
    s_lshl3_add_u32 s97, s62, s97
    s_add_u32 s97, s97, s96
    v_lshl_add_u32 v160, v0, 4, s97
    s_lshl_b32 s97, s60, 8
    s_lshl3_add_u32 s97, s61, s97
    s_add_u32 s97, s97, 20480
    s_add_u32 s97, s97, s96
    v_lshrrev_b32 v4, 1, v2
    v_mul_u32_u24 v4, 38912, v4
    v_lshl_add_u32 v4, v2, 10, v4
    v_lshl_add_u32 v4, v1, 4, v4
    v_add_u32 v161, s97, v4
    s_mul_i32 s66, s30, 262144
    s_add_u32 s66, s66, 7340032
    s_lshl_b32 s96, s65, 8
    s_lshl_b32 s97, s57, 7
    s_add_u32 s96, s96, s97
    s_lshl1_add_u32 s97, s38, s62
    s_lshl2_add_u32 s96, s97, s96
    s_add_u32 s96, s96, s66
    s_add_u32 s55, s96, 196608
    s_mul_i32 s96, s62, 40960
    s_add_u32 s96, s96, s67
    v_lshl_add_u32 v159, v0, 4, s96
    s_mul_i32 s96, s62, 77824
    s_sub_u32 s96, 38912, s96
    v_add_u32 v158, s96, v159
    s_cmp_gt_u32 s46, 0
    s_cselect_b32 s96, 1, 0
    s_cmp_lt_u32 s46, 4
    s_cselect_b32 s97, 64, 0
    s_or_b32 s96, s96, s97
    s_lshl_b32 s47, s96, s42
    s_mov_b32 s76, 0x7060500
    s_mov_b32 s77, 0x7060501
    s_mov_b32 s78, 0x7060502
    s_mov_b32 s79, 0x7060503
    s_mov_b32 s58, 0x0c0c0400
    s_mov_b32 s59, 0x04000c0c
    v_add_u32 v157, 40960, v160
    s_mul_i32 s96, s57, 51200
    s_add_u32 s80, s96, 10240
    s_mul_i32 s81, s56, 2560
    s_add_u32 s81, s81, 0
    s_mov_b32 s93, 112640
    s_mov_b32 s101, 0
    s_and_b32 s98, s35, 3
    s_lshr_b32 s96, s56, 1
    s_lshl1_add_u32 s96, s98, s96
    s_lshl1_add_u32 s96, s96, s57
    s_mul_i32 s96, s96, 20480
    s_and_b32 s97, s56, 1
    s_lshl_b32 s97, s97, 10
    s_add_u32 s96, s96, s97
    s_mul_i32 s97, s30, 327680
    s_add_u32 s96, s96, s97
    s_add_u32 s82, s96, 4096
    s_mul_i32 s96, s30, 262144
    s_lshl_b32 s98, s98, 8
    s_add_u32 s96, s96, s98
    s_add_u32 s83, s96, 7536640
    s_mul_i32 s84, s56, 5120
    s_add_u32 s84, s84, 129024
    s_lshl2_add_u32 s96, s35, s56
    s_mul_i32 s96, s96, 20480
    s_mul_i32 s97, s36, 160
    s_add_u32 s85, s96, s97
    s_waitcnt lgkmcnt(0)
    s_mul_i32 s33, s33, 1664525
    s_add_u32 s33, s33, 1013904223
    s_cmp_eq_u32 s32, 4
    s_cbranch_scc1 L_padb0
    s_cmp_eq_u32 s32, 5
    s_cbranch_scc1 L_padb1
    s_cmp_eq_u32 s32, 6
    s_cbranch_scc1 L_padb2
    s_cmp_eq_u32 s32, 7
    s_cbranch_scc1 L_padb3
    s_cmp_eq_u32 s32, 8
    s_cbranch_scc1 L_padb4
    s_cmp_eq_u32 s32, 9
    s_cbranch_scc1 L_padb5
    s_cmp_eq_u32 s32, 10
    s_cbranch_scc1 L_padb6
    s_branch L_padb7
L_padb7:
    s_branch L_padb15
L_warmed_b:
    s_barrier
    s_cmp_lg_u32 s42, 0
    s_cbranch_scc1 L_gemm_40
L_gemm_50:
    s_barrier
    ds_read_b64_tr_b16 v[112:113], v136 offset:1024
    ds_read_b64_tr_b16 v[114:115], v136 offset:1536
    ds_read_b128 v[68:71], v134 offset:0
    ds_read_b128 v[72:75], v134 offset:2048
    ds_read_b128 v[76:79], v134 offset:4096
    ds_read_b128 v[80:83], v134 offset:6144
    ds_read_b128 v[84:87], v134 offset:8192
    ds_read_b64_tr_b16 v[116:117], v136 offset:2048
    ds_read_b64_tr_b16 v[118:119], v136 offset:2560
    ds_read_b64_tr_b16 v[108:109], v136 offset:0
    ds_read_b64_tr_b16 v[110:111], v136 offset:512
L_gemm_5:
    s_waitcnt lgkmcnt(8)
    v_mfma_f32_16x16x32_bf16 v[28:31], v[112:115], v[68:71], v[28:31]
    s_setprio 2
    ds_read_b64_tr_b16 v[124:125], v136 offset:13312
    s_waitcnt lgkmcnt(8)
    v_mfma_f32_16x16x32_bf16 v[32:35], v[112:115], v[72:75], v[32:35]
    ds_read_b64_tr_b16 v[126:127], v136 offset:13824
    s_waitcnt lgkmcnt(8)
    v_mfma_f32_16x16x32_bf16 v[36:39], v[112:115], v[76:79], v[36:39]
    ds_read_b128 v[88:91], v135 offset:0
    s_waitcnt lgkmcnt(8)
    v_mfma_f32_16x16x32_bf16 v[40:43], v[112:115], v[80:83], v[40:43]
    ds_read_b128 v[92:95], v135 offset:2048
    s_waitcnt lgkmcnt(8)
    v_mfma_f32_16x16x32_bf16 v[44:47], v[112:115], v[84:87], v[44:47]
    ds_read_b128 v[96:99], v135 offset:4096
    s_waitcnt lgkmcnt(7)
    v_mfma_f32_16x16x32_bf16 v[48:51], v[68:71], v[116:119], v[48:51]
    ds_read_b128 v[100:103], v135 offset:6144
    v_mfma_f32_16x16x32_bf16 v[52:55], v[72:75], v[116:119], v[52:55]
    ds_read_b128 v[104:107], v135 offset:8192
    v_mfma_f32_16x16x32_bf16 v[56:59], v[76:79], v[116:119], v[56:59]
    ds_read_b64_tr_b16 v[128:129], v136 offset:14336
    v_mfma_f32_16x16x32_bf16 v[60:63], v[80:83], v[116:119], v[60:63]
    ds_read_b64_tr_b16 v[130:131], v136 offset:14848
    v_mfma_f32_16x16x32_bf16 v[64:67], v[84:87], v[116:119], v[64:67]
    ds_read_b64_tr_b16 v[120:121], v136 offset:12288
    s_waitcnt lgkmcnt(10)
    v_mfma_f32_16x16x32_bf16 v[12:15], v[108:111], v[72:75], v[12:15]
    ds_read_b64_tr_b16 v[122:123], v136 offset:12800
    v_mfma_f32_16x16x32_bf16 v[16:19], v[108:111], v[76:79], v[16:19]
    v_mfma_f32_16x16x32_bf16 v[20:23], v[108:111], v[80:83], v[20:23]
    v_mfma_f32_16x16x32_bf16 v[24:27], v[108:111], v[84:87], v[24:27]
    s_waitcnt lgkmcnt(8)
    v_mfma_f32_16x16x32_bf16 v[28:31], v[124:127], v[88:91], v[28:31]
    s_add_u32 s44, s44, 43008
    s_cmp_eq_u32 s44, 129024
    s_cselect_b32 s44, 0, s44
    v_add_u32 v134, s44, v132
    v_add_u32 v136, s44, v133
    s_waitcnt lgkmcnt(7)
    v_mfma_f32_16x16x32_bf16 v[32:35], v[124:127], v[92:95], v[32:35]
    s_waitcnt lgkmcnt(0)
    s_barrier
    s_setprio 1
    ds_read_b64_tr_b16 v[112:113], v136 offset:1024
    v_mfma_f32_16x16x32_bf16 v[36:39], v[124:127], v[96:99], v[36:39]
    ds_read_b64_tr_b16 v[114:115], v136 offset:1536
    v_mfma_f32_16x16x32_bf16 v[40:43], v[124:127], v[100:103], v[40:43]
    v_xor_b32 v135, 64, v134
    ds_read_b128 v[68:71], v134 offset:0
    v_mfma_f32_16x16x32_bf16 v[44:47], v[124:127], v[104:107], v[44:47]
    ds_read_b128 v[72:75], v134 offset:2048
    v_mfma_f32_16x16x32_bf16 v[48:51], v[88:91], v[128:131], v[48:51]
    ds_read_b128 v[76:79], v134 offset:4096
    v_mfma_f32_16x16x32_bf16 v[52:55], v[92:95], v[128:131], v[52:55]
    ds_read_b128 v[80:83], v134 offset:6144
    v_mfma_f32_16x16x32_bf16 v[56:59], v[96:99], v[128:131], v[56:59]
    ds_read_b128 v[84:87], v134 offset:8192
    v_mfma_f32_16x16x32_bf16 v[60:63], v[100:103], v[128:131], v[60:63]
    ds_read_b64_tr_b16 v[116:117], v136 offset:2048
    v_mfma_f32_16x16x32_bf16 v[64:67], v[104:107], v[128:131], v[64:67]
    ds_read_b64_tr_b16 v[118:119], v136 offset:2560
    v_mfma_f32_16x16x32_bf16 v[12:15], v[120:123], v[92:95], v[12:15]
    ds_read_b64_tr_b16 v[108:109], v136 offset:0
    v_mfma_f32_16x16x32_bf16 v[16:19], v[120:123], v[96:99], v[16:19]
    s_add_u32 s43, s43, 1
    ds_read_b64_tr_b16 v[110:111], v136 offset:512
    v_mfma_f32_16x16x32_bf16 v[20:23], v[120:123], v[100:103], v[20:23]
    s_cmp_lt_u32 s43, 9
    v_mfma_f32_16x16x32_bf16 v[24:27], v[120:123], v[104:107], v[24:27]
    s_cbranch_scc1 L_gemm_5
    s_waitcnt lgkmcnt(8)
    v_mfma_f32_16x16x32_bf16 v[28:31], v[112:115], v[68:71], v[28:31]
    s_bitcmp1_b32 s45, 7
    s_setprio 3
    s_cbranch_scc1 Llp_35
    s_setprio 1
Llp_35:
    ds_read_b64_tr_b16 v[124:125], v136 offset:13312
    s_waitcnt lgkmcnt(8)
    v_mfma_f32_16x16x32_bf16 v[32:35], v[112:115], v[72:75], v[32:35]
    ds_read_b64_tr_b16 v[126:127], v136 offset:13824
    s_waitcnt lgkmcnt(8)
    v_mfma_f32_16x16x32_bf16 v[36:39], v[112:115], v[76:79], v[36:39]
    ds_read_b128 v[88:91], v135 offset:0
    s_waitcnt lgkmcnt(8)
    v_mfma_f32_16x16x32_bf16 v[40:43], v[112:115], v[80:83], v[40:43]
    ds_read_b128 v[92:95], v135 offset:2048
    s_waitcnt lgkmcnt(8)
    v_mfma_f32_16x16x32_bf16 v[44:47], v[112:115], v[84:87], v[44:47]
    ds_read_b128 v[96:99], v135 offset:4096
    s_waitcnt lgkmcnt(7)
    v_mfma_f32_16x16x32_bf16 v[48:51], v[68:71], v[116:119], v[48:51]
    ds_read_b128 v[100:103], v135 offset:6144
    v_mfma_f32_16x16x32_bf16 v[52:55], v[72:75], v[116:119], v[52:55]
    ds_read_b128 v[104:107], v135 offset:8192
    v_mfma_f32_16x16x32_bf16 v[56:59], v[76:79], v[116:119], v[56:59]
    ds_read_b64_tr_b16 v[128:129], v136 offset:14336
    v_mfma_f32_16x16x32_bf16 v[60:63], v[80:83], v[116:119], v[60:63]
    ds_read_b64_tr_b16 v[130:131], v136 offset:14848
    v_mfma_f32_16x16x32_bf16 v[64:67], v[84:87], v[116:119], v[64:67]
    ds_read_b64_tr_b16 v[120:121], v136 offset:12288
    s_waitcnt lgkmcnt(10)
    v_mfma_f32_16x16x32_bf16 v[12:15], v[108:111], v[72:75], v[12:15]
    ds_read_b64_tr_b16 v[122:123], v136 offset:12800
    v_mfma_f32_16x16x32_bf16 v[16:19], v[108:111], v[76:79], v[16:19]
    ds_read_b64 v[6:7], v3 offset:384
    v_mfma_f32_16x16x32_bf16 v[20:23], v[108:111], v[80:83], v[20:23]
    v_mfma_f32_16x16x32_bf16 v[24:27], v[108:111], v[84:87], v[24:27]
    s_waitcnt lgkmcnt(0)
    v_mfma_f32_16x16x32_bf16 v[44:47], v[124:127], v[104:107], v[44:47]
    v_readfirstlane_b32 s90, v6
    v_readfirstlane_b32 s91, v7
    v_mfma_f32_16x16x32_bf16 v[24:27], v[120:123], v[104:107], v[24:27]
    v_mov_b64 v[70:71], 0
    v_mov_b64 v[74:75], 0
    v_mfma_f32_16x16x32_bf16 v[40:43], v[124:127], v[100:103], v[40:43]
    v_mov_b64 v[78:79], 0
    v_mov_b64 v[82:83], 0
    v_mfma_f32_16x16x32_bf16 v[20:23], v[120:123], v[100:103], v[20:23]
    v_mov_b32 v119, s33
    v_mfma_f32_16x16x32_bf16 v[36:39], v[124:127], v[96:99], v[36:39]
    v_mfma_f32_16x16x32_bf16 v[16:19], v[120:123], v[96:99], v[16:19]
    v_mfma_f32_16x16x32_bf16 v[32:35], v[124:127], v[92:95], v[32:35]
    v_mfma_f32_16x16x32_bf16 v[12:15], v[120:123], v[92:95], v[12:15]
    v_mfma_f32_16x16x32_bf16 v[28:31], v[124:127], v[88:91], v[28:31]
    s_branch L_gdone
.p2align 12
L_padb8:
    s_branch L_padb16
L_gemm_40:
    s_barrier
    ds_read_b64_tr_b16 v[112:113], v136 offset:1024
    ds_read_b64_tr_b16 v[114:115], v136 offset:1536
    ds_read_b128 v[72:75], v134 offset:2048
    ds_read_b128 v[76:79], v134 offset:4096
    ds_read_b128 v[80:83], v134 offset:6144
    ds_read_b128 v[84:87], v134 offset:8192
    ds_read_b64_tr_b16 v[116:117], v136 offset:2048
    ds_read_b64_tr_b16 v[118:119], v136 offset:2560
    ds_read_b64_tr_b16 v[108:109], v136 offset:0
    ds_read_b64_tr_b16 v[110:111], v136 offset:512
L_gemm_4:
    s_waitcnt lgkmcnt(7)
    v_mfma_f32_16x16x32_bf16 v[32:35], v[112:115], v[72:75], v[32:35]
    s_setprio 1
    ds_read_b64_tr_b16 v[124:125], v136 offset:13312
    s_waitcnt lgkmcnt(7)
    v_mfma_f32_16x16x32_bf16 v[36:39], v[112:115], v[76:79], v[36:39]
    ds_read_b64_tr_b16 v[126:127], v136 offset:13824
    s_waitcnt lgkmcnt(7)
    v_mfma_f32_16x16x32_bf16 v[40:43], v[112:115], v[80:83], v[40:43]
    ds_read_b128 v[92:95], v135 offset:2048
    s_waitcnt lgkmcnt(7)
    v_mfma_f32_16x16x32_bf16 v[44:47], v[112:115], v[84:87], v[44:47]
    ds_read_b128 v[96:99], v135 offset:4096
    s_waitcnt lgkmcnt(6)
    v_mfma_f32_16x16x32_bf16 v[52:55], v[72:75], v[116:119], v[52:55]
    ds_read_b128 v[100:103], v135 offset:6144
    v_mfma_f32_16x16x32_bf16 v[56:59], v[76:79], v[116:119], v[56:59]
    ds_read_b128 v[104:107], v135 offset:8192
    v_mfma_f32_16x16x32_bf16 v[60:63], v[80:83], v[116:119], v[60:63]
    ds_read_b64_tr_b16 v[128:129], v136 offset:14336
    v_mfma_f32_16x16x32_bf16 v[64:67], v[84:87], v[116:119], v[64:67]
    ds_read_b64_tr_b16 v[130:131], v136 offset:14848
    s_waitcnt lgkmcnt(8)
    v_mfma_f32_16x16x32_bf16 v[12:15], v[108:111], v[72:75], v[12:15]
    ds_read_b64_tr_b16 v[120:121], v136 offset:12288
    v_mfma_f32_16x16x32_bf16 v[16:19], v[108:111], v[76:79], v[16:19]
    ds_read_b64_tr_b16 v[122:123], v136 offset:12800
    v_mfma_f32_16x16x32_bf16 v[20:23], v[108:111], v[80:83], v[20:23]
    v_mfma_f32_16x16x32_bf16 v[24:27], v[108:111], v[84:87], v[24:27]
    s_waitcnt lgkmcnt(7)
    v_mfma_f32_16x16x32_bf16 v[32:35], v[124:127], v[92:95], v[32:35]
    s_add_u32 s44, s44, 43008
    s_cmp_eq_u32 s44, 129024
    s_cselect_b32 s44, 0, s44
    v_add_u32 v134, s44, v132
    v_add_u32 v136, s44, v133
    s_waitcnt lgkmcnt(6)
    v_mfma_f32_16x16x32_bf16 v[36:39], v[124:127], v[96:99], v[36:39]
    s_waitcnt lgkmcnt(0)
    s_barrier
    s_setprio 2
    ds_read_b64_tr_b16 v[112:113], v136 offset:1024
    v_mfma_f32_16x16x32_bf16 v[40:43], v[124:127], v[100:103], v[40:43]
    ds_read_b64_tr_b16 v[114:115], v136 offset:1536
    v_mfma_f32_16x16x32_bf16 v[44:47], v[124:127], v[104:107], v[44:47]
    v_xor_b32 v135, 64, v134
    ds_read_b128 v[72:75], v134 offset:2048
    v_mfma_f32_16x16x32_bf16 v[52:55], v[92:95], v[128:131], v[52:55]
    ds_read_b128 v[76:79], v134 offset:4096
    v_mfma_f32_16x16x32_bf16 v[56:59], v[96:99], v[128:131], v[56:59]
    ds_read_b128 v[80:83], v134 offset:6144
    v_mfma_f32_16x16x32_bf16 v[60:63], v[100:103], v[128:131], v[60:63]
    ds_read_b128 v[84:87], v134 offset:8192
    v_mfma_f32_16x16x32_bf16 v[64:67], v[104:107], v[128:131], v[64:67]
    ds_read_b64_tr_b16 v[116:117], v136 offset:2048
    v_mfma_f32_16x16x32_bf16 v[12:15], v[120:123], v[92:95], v[12:15]
    ds_read_b64_tr_b16 v[118:119], v136 offset:2560
    v_mfma_f32_16x16x32_bf16 v[16:19], v[120:123], v[96:99], v[16:19]
    s_add_u32 s43, s43, 1
    ds_read_b64_tr_b16 v[108:109], v136 offset:0
    v_mfma_f32_16x16x32_bf16 v[20:23], v[120:123], v[100:103], v[20:23]
    s_cmp_lt_u32 s43, 9
    ds_read_b64_tr_b16 v[110:111], v136 offset:512
    v_mfma_f32_16x16x32_bf16 v[24:27], v[120:123], v[104:107], v[24:27]
    s_cbranch_scc1 L_gemm_4
    s_waitcnt lgkmcnt(7)
    v_mfma_f32_16x16x32_bf16 v[32:35], v[112:115], v[72:75], v[32:35]
    s_bitcmp1_b32 s45, 7
    s_setprio 3
    s_cbranch_scc1 Llp_36
    s_setprio 1
Llp_36:
    ds_read_b64_tr_b16 v[124:125], v136 offset:13312
    s_waitcnt lgkmcnt(7)
    v_mfma_f32_16x16x32_bf16 v[36:39], v[112:115], v[76:79], v[36:39]
    ds_read_b64_tr_b16 v[126:127], v136 offset:13824
    s_waitcnt lgkmcnt(7)
    v_mfma_f32_16x16x32_bf16 v[40:43], v[112:115], v[80:83], v[40:43]
    ds_read_b128 v[92:95], v135 offset:2048
    s_waitcnt lgkmcnt(7)
    v_mfma_f32_16x16x32_bf16 v[44:47], v[112:115], v[84:87], v[44:47]
    ds_read_b128 v[96:99], v135 offset:4096
    s_waitcnt lgkmcnt(6)
    v_mfma_f32_16x16x32_bf16 v[52:55], v[72:75], v[116:119], v[52:55]
    ds_read_b128 v[100:103], v135 offset:6144
    v_mfma_f32_16x16x32_bf16 v[56:59], v[76:79], v[116:119], v[56:59]
    ds_read_b128 v[104:107], v135 offset:8192
    v_mfma_f32_16x16x32_bf16 v[60:63], v[80:83], v[116:119], v[60:63]
    ds_read_b64_tr_b16 v[128:129], v136 offset:14336
    v_mfma_f32_16x16x32_bf16 v[64:67], v[84:87], v[116:119], v[64:67]
    ds_read_b64_tr_b16 v[130:131], v136 offset:14848
    s_waitcnt lgkmcnt(8)
    v_mfma_f32_16x16x32_bf16 v[12:15], v[108:111], v[72:75], v[12:15]
    ds_read_b64_tr_b16 v[120:121], v136 offset:12288
    v_mfma_f32_16x16x32_bf16 v[16:19], v[108:111], v[76:79], v[16:19]
    ds_read_b64_tr_b16 v[122:123], v136 offset:12800
    v_mfma_f32_16x16x32_bf16 v[20:23], v[108:111], v[80:83], v[20:23]
    ds_read_b64 v[6:7], v3 offset:384
    v_mfma_f32_16x16x32_bf16 v[24:27], v[108:111], v[84:87], v[24:27]
    s_waitcnt lgkmcnt(0)
    v_mfma_f32_16x16x32_bf16 v[44:47], v[124:127], v[104:107], v[44:47]
    v_readfirstlane_b32 s90, v6
    v_readfirstlane_b32 s91, v7
    v_mfma_f32_16x16x32_bf16 v[24:27], v[120:123], v[104:107], v[24:27]
    v_mov_b64 v[70:71], 0
    v_mov_b64 v[74:75], 0
    v_mfma_f32_16x16x32_bf16 v[40:43], v[124:127], v[100:103], v[40:43]
    v_mov_b64 v[78:79], 0
    v_mov_b64 v[82:83], 0
    v_mfma_f32_16x16x32_bf16 v[20:23], v[120:123], v[100:103], v[20:23]
    v_mov_b32 v119, s33
    v_mfma_f32_16x16x32_bf16 v[36:39], v[124:127], v[96:99], v[36:39]
    v_mfma_f32_16x16x32_bf16 v[16:19], v[120:123], v[96:99], v[16:19]
    v_mfma_f32_16x16x32_bf16 v[32:35], v[124:127], v[92:95], v[32:35]
    v_mfma_f32_16x16x32_bf16 v[12:15], v[120:123], v[92:95], v[12:15]
L_gdone:
    s_cmp_lg_u32 s90, s33
    s_cbranch_scc1 L_mslow
L_mback:
    s_cmp_eq_u32 s91, 1
    s_cselect_b32 s99, 0, 15728640
    s_add_u32 s16, s28, s99
    s_addc_u32 s17, s29, 0
    s_add_u32 s18, s16, 13107200
    s_addc_u32 s19, s17, 0
    s_cmp_eq_u32 s91, 1
    s_cselect_b64 s[18:19], s[24:25], s[18:19]
    s_bitcmp0_b32 s45, 7
    s_cbranch_scc1 L_full
    v_mov_b32 v5, 1
    v_cvt_pk_bf16_f32 v84, v44, v45
    v_cvt_pk_bf16_f32 v85, v46, v47
    ds_write_b64 v156, v[84:85] offset:6656
    ds_write_b32 v165, v5 offset:344
    v_cvt_pk_bf16_f32 v80, v40, v41
    v_cvt_pk_bf16_f32 v81, v42, v43
    v_cvt_pk_bf16_f32 v76, v36, v37
    v_cvt_pk_bf16_f32 v77, v38, v39
    v_cvt_pk_bf16_f32 v72, v32, v33
    v_cvt_pk_bf16_f32 v73, v34, v35
    s_mov_b32 s100, 0
    s_cmp_eq_u32 s42, 0
    s_cbranch_scc1 L_l_k0
    ds_read_b32 v4, v165 offset:340
    ds_read_b64 v[68:69], v156 offset:4608
    s_branch L_l_k1
L_padb9:
    s_branch L_padb17
L_l_k0:
    v_cvt_pk_bf16_f32 v68, v28, v29
    v_cvt_pk_bf16_f32 v69, v30, v31
    v_mov_b32 v4, 1
L_l_k1:
    s_mov_b64 exec, s[50:51]
    v_cvt_pk_bf16_f32 v82, v24, v25
    v_cvt_pk_bf16_f32 v83, v26, v27
    v_cvt_pk_bf16_f32 v78, v20, v21
    v_cvt_pk_bf16_f32 v79, v22, v23
    v_cvt_pk_bf16_f32 v74, v16, v17
    v_cvt_pk_bf16_f32 v75, v18, v19
    v_cvt_pk_bf16_f32 v70, v12, v13
    v_cvt_pk_bf16_f32 v71, v14, v15
    s_mov_b64 exec, -1
    v_mfma_f32_16x16x16_bf16 v[40:43], v[84:85], v[82:83], v[144:147]
    v_cvt_pk_bf16_f32 v24, v24, v25
    v_cvt_pk_bf16_f32 v25, v26, v27
    v_mfma_f32_16x16x16_bf16 v[124:127], v[80:81], v[82:83], v[148:151]
    v_mfma_f32_16x16x16_bf16 v[36:39], v[80:81], v[78:79], v[144:147]
    v_cvt_pk_bf16_f32 v20, v20, v21
    v_cvt_pk_bf16_f32 v21, v22, v23
    v_mfma_f32_16x16x16_bf16 v[120:123], v[76:77], v[78:79], v[148:151]
    v_mfma_f32_16x16x16_bf16 v[32:35], v[76:77], v[74:75], v[144:147]
    v_cvt_pk_bf16_f32 v16, v16, v17
    v_cvt_pk_bf16_f32 v17, v18, v19
    v_mfma_f32_16x16x16_bf16 v[8:11], v[72:73], v[74:75], v[148:151]
    v_mfma_f32_16x16x16_bf16 v[28:31], v[72:73], v[70:71], v[144:147]
    v_cvt_pk_bf16_f32 v12, v12, v13
    v_cvt_pk_bf16_f32 v13, v14, v15
L_l_kw:
    s_waitcnt lgkmcnt(0)
    v_readfirstlane_b32 s96, v4
    s_cmp_eq_u32 s96, 0
    s_cbranch_scc1 L_l_kslow
L_l_kok:
    v_mfma_f32_16x16x16_bf16 v[44:47], v[68:69], v[70:71], v[140:143]
    ds_write_b64 v156, v[80:81] offset:6144
    ds_write_b64 v156, v[24:25] offset:2048
    v_max3_f32 v114, v40, v41, v124
    v_max3_f32 v115, v42, v43, v126
    v_max_f32 v114, v114, v125
    v_max_f32 v115, v115, v127
    v_perm_b32 v114, v114, v119, s78
    v_perm_b32 v115, v115, v119, s79
    ds_write_b64 v156, v[76:77] offset:5632
    ds_write_b64 v156, v[20:21] offset:1536
    v_max3_f32 v112, v36, v37, v120
    v_max3_f32 v113, v38, v39, v122
    v_max_f32 v112, v112, v121
    v_max_f32 v113, v113, v123
    v_perm_b32 v112, v112, v119, s76
    v_perm_b32 v113, v113, v119, s77
    ds_write_b64 v156, v[72:73] offset:5120
    ds_write_b64 v156, v[16:17] offset:1024
    v_max3_f32 v110, v32, v33, v8
    v_max3_f32 v111, v34, v35, v10
    v_max_f32 v110, v110, v9
    v_max_f32 v111, v111, v11
    v_perm_b32 v110, v110, v119, s78
    v_perm_b32 v111, v111, v119, s79
    ds_write_b64 v156, v[68:69] offset:4608
    ds_write_b64 v156, v[12:13] offset:512
    ds_write_b32 v165, v5 offset:128
    v_max3_f32 v108, v28, v29, v44
    v_max3_f32 v109, v30, v31, v46
    v_max_f32 v108, v108, v45
    v_max_f32 v109, v109, v47
    v_perm_b32 v108, v108, v119, s76
    v_perm_b32 v109, v109, v119, s77
    s_cmp_lg_u32 s91, 1
    s_cbranch_scc1 Ldg_37
    global_store_dwordx4 v158, v[112:115], s[18:19] offset:1024
    global_store_dwordx4 v158, v[108:111], s[18:19] offset:0
    s_branch Ldd_38
L_padb10:
    s_branch L_padb18
Ldg_37:
    global_store_dwordx4 v158, v[112:115], s[18:19] offset:1024 sc1
    global_store_dwordx4 v158, v[108:111], s[18:19] offset:0 sc1
Ldd_38:
    s_setprio 1
    v_mfma_f32_16x16x32_bf16 v[64:67], v[104:107], v[128:131], v[64:67]
    v_mfma_f32_16x16x32_bf16 v[60:63], v[100:103], v[128:131], v[60:63]
    v_mfma_f32_16x16x32_bf16 v[56:59], v[96:99], v[128:131], v[56:59]
    v_mfma_f32_16x16x32_bf16 v[52:55], v[92:95], v[128:131], v[52:55]
    s_cmp_lg_u32 s42, 0
    s_cbranch_scc1 L_nv_l
    v_mfma_f32_16x16x32_bf16 v[48:51], v[88:91], v[128:131], v[48:51]
L_nv_l:
    s_nop 2
    v_cvt_pk_bf16_f32 v88, v64, v65
    v_cvt_pk_bf16_f32 v89, v66, v67
    s_waitcnt lgkmcnt(6)
    ds_write_b64 v156, v[88:89] offset:11264
    v_cvt_pk_bf16_f32 v90, v60, v61
    v_cvt_pk_bf16_f32 v91, v62, v63
    ds_write_b64 v156, v[90:91] offset:10752
    v_cvt_pk_bf16_f32 v92, v56, v57
    v_cvt_pk_bf16_f32 v93, v58, v59
    ds_write_b64 v156, v[92:93] offset:10240
    v_cvt_pk_bf16_f32 v94, v52, v53
    v_cvt_pk_bf16_f32 v95, v54, v55
    ds_write_b64 v156, v[94:95] offset:9728
    s_cmp_lg_u32 s42, 0
    s_cbranch_scc1 L_l_nv0
    v_cvt_pk_bf16_f32 v96, v48, v49
    v_cvt_pk_bf16_f32 v97, v50, v51
    ds_write_b64 v156, v[96:97] offset:9216
    ds_write_b32 v165, v5 offset:160
    s_branch L_l_v0
L_l_nv0:
    ds_write_b32 v165, v5 offset:160
    s_mov_b32 s100, 0
Lm_39:
    ds_read_b32 v4, v163
    s_waitcnt lgkmcnt(0)
    v_cmp_eq_u32 vcc, 0, v4
    s_and_b32 s99, vcc_lo, s49
    s_cbranch_scc0 Lmd_40
    s_add_u32 s100, s100, 1
    s_cmp_lt_u32 s100, 1048576
    s_cbranch_scc1 Lm_39
Lmd_40:
    ds_read_b64 v[96:97], v156 offset:9216
L_l_v0:
    s_setprio 0
    s_mov_b32 s100, 0
L_xp:
    global_load_dwordx4 v[28:31], v159, s[18:19] offset:0 sc1
    global_load_dwordx4 v[32:35], v159, s[18:19] offset:1024 sc1
    s_waitcnt vmcnt(1)
    v_perm_b32 v36, v29, v28, s58
    v_perm_b32 v37, v31, v30, s59
    v_or_b32 v36, v36, v37
    s_waitcnt vmcnt(0)
    v_perm_b32 v38, v33, v32, s58
    v_perm_b32 v39, v35, v34, s59
    v_or_b32 v38, v38, v39
    v_cmp_ne_u32 vcc, s33, v36
    v_cmp_ne_u32 s[60:61], s33, v38
    s_or_b64 vcc, vcc, s[60:61]
    s_cbranch_scc0 L_xpd
    s_add_u32 s100, s100, 1
    s_cmp_lt_u32 s100, 1048576
    s_cbranch_scc1 L_xp
L_xpd:
    s_setprio 2
    ds_write_b32 v165, v5 offset:392
    v_pk_add_f32 v[68:69], v[108:109], v[28:29]
    v_pk_add_f32 v[70:71], v[110:111], v[30:31]
    v_pk_add_f32 v[72:73], v[112:113], v[32:33]
    v_pk_add_f32 v[74:75], v[114:115], v[34:35]
    s_branch L_soft
L_padb11:
    s_branch L_padb19
L_l_kslow:
    ds_read_b32 v4, v165 offset:340
    ds_read_b64 v[68:69], v156 offset:4608
    s_add_u32 s100, s100, 1
    s_cmp_lt_u32 s100, 1048576
    s_cbranch_scc1 L_l_kw
    s_waitcnt lgkmcnt(0)
    s_branch L_l_kok
L_mslow:
    s_lshl_b32 s98, s30, 5
    s_add_u32 s98, s98, s31
    s_lshl_b32 s98, s98, 8
    s_add_u32 s98, s98, 65536
    s_add_u32 s98, s98, 128
    s_mov_b32 s100, 0
Lc_41:
    s_load_dwordx4 s[88:91], s[28:29], s98 glc
    s_waitcnt lgkmcnt(0)
    s_cmp_eq_u32 s90, s33
    s_cbranch_scc1 Lcd_42
    s_sleep 2
    s_add_u32 s100, s100, 1
    s_cmp_lt_u32 s100, 1048576
    s_cbranch_scc1 Lc_41
    s_mov_b32 s91, 2
Lcd_42:
    s_branch L_mback
L_full:
    v_mfma_f32_16x16x32_bf16 v[64:67], v[104:107], v[128:131], v[64:67]
    v_mfma_f32_16x16x32_bf16 v[60:63], v[100:103], v[128:131], v[60:63]
    v_mfma_f32_16x16x32_bf16 v[56:59], v[96:99], v[128:131], v[56:59]
    v_mfma_f32_16x16x32_bf16 v[52:55], v[92:95], v[128:131], v[52:55]
    s_cmp_lg_u32 s42, 0
    s_cbranch_scc1 L_nv_f
    v_mfma_f32_16x16x32_bf16 v[48:51], v[88:91], v[128:131], v[48:51]
L_nv_f:
    s_setprio 2
    v_cvt_pk_bf16_f32 v124, v44, v45
    v_cvt_pk_bf16_f32 v125, v46, v47
    v_cvt_pk_bf16_f32 v120, v40, v41
    v_cvt_pk_bf16_f32 v121, v42, v43
    v_cvt_pk_bf16_f32 v116, v36, v37
    v_cvt_pk_bf16_f32 v117, v38, v39
    v_cvt_pk_bf16_f32 v112, v32, v33
    v_cvt_pk_bf16_f32 v113, v34, v35
    v_cvt_pk_bf16_f32 v68, v12, v13
    v_cvt_pk_bf16_f32 v69, v14, v15
    v_cvt_pk_bf16_f32 v72, v16, v17
    v_cvt_pk_bf16_f32 v73, v18, v19
    v_cvt_pk_bf16_f32 v76, v20, v21
    v_cvt_pk_bf16_f32 v77, v22, v23
    v_cvt_pk_bf16_f32 v80, v24, v25
    v_cvt_pk_bf16_f32 v81, v26, v27
    v_cvt_pk_bf16_f32 v88, v64, v65
    v_cvt_pk_bf16_f32 v89, v66, v67
    s_cmp_lg_u32 s42, 0
    s_cbranch_scc1 L_f_nb
    ds_write_b64 v164, v[124:125]
    ds_write_b64 v164, v[88:89] offset:512
    v_mov_b32 v5, 1
    ds_write_b32 v165, v5 offset:128
    v_cvt_pk_bf16_f32 v108, v28, v29
    v_cvt_pk_bf16_f32 v109, v30, v31
    v_cvt_pk_bf16_f32 v96, v48, v49
    v_cvt_pk_bf16_f32 v97, v50, v51
L_f_nb:
    v_cvt_pk_bf16_f32 v94, v52, v53
    v_cvt_pk_bf16_f32 v95, v54, v55
    v_cvt_pk_bf16_f32 v92, v56, v57
    v_cvt_pk_bf16_f32 v93, v58, v59
    v_cvt_pk_bf16_f32 v90, v60, v61
    v_cvt_pk_bf16_f32 v91, v62, v63
    s_mov_b32 s100, 0
Lm_43:
    ds_read_b32 v4, v163
    s_waitcnt lgkmcnt(0)
    v_cmp_eq_u32 vcc, 0, v4
    s_and_b32 s99, vcc_lo, s48
    s_cbranch_scc0 Lmd_44
    s_add_u32 s100, s100, 1
    s_cmp_lt_u32 s100, 1048576
    s_cbranch_scc1 Lm_43
Lmd_44:
    s_cmp_eq_u32 s42, 0
    s_cbranch_scc1 L_f_nr
    ds_read_b64 v[108:109], v164
    ds_read_b64 v[96:97], v164 offset:512
L_f_nr:
    s_mov_b64 exec, s[52:53]
    ds_read_b64 v[70:71], v156 offset:512
    ds_read_b64 v[74:75], v156 offset:1024
    ds_read_b64 v[78:79], v156 offset:1536
    ds_read_b64 v[82:83], v156 offset:2048
    s_mov_b64 exec, -1
    ds_read_b64 v[110:111], v156 offset:4608
    ds_read_b64 v[114:115], v156 offset:5120
    ds_read_b64 v[118:119], v156 offset:5632
    ds_read_b64 v[122:123], v156 offset:6144
    ds_read_b64 v[126:127], v156 offset:6656
    s_waitcnt lgkmcnt(3)
    v_mfma_f32_16x16x32_bf16 v[8:11], v[112:115], v[68:71], v[144:147]
    v_mfma_f32_16x16x32_bf16 v[24:27], v[108:111], v[68:71], v[140:143]
    s_waitcnt lgkmcnt(2)
    v_mfma_f32_16x16x32_bf16 v[12:15], v[116:119], v[72:75], v[144:147]
    v_mfma_f32_16x16x32_bf16 v[28:31], v[112:115], v[72:75], v[148:151]
    s_waitcnt lgkmcnt(1)
    v_mfma_f32_16x16x32_bf16 v[16:19], v[120:123], v[76:79], v[144:147]
    v_mfma_f32_16x16x32_bf16 v[32:35], v[116:119], v[76:79], v[148:151]
    s_waitcnt lgkmcnt(0)
    v_mfma_f32_16x16x32_bf16 v[20:23], v[124:127], v[80:83], v[144:147]
    v_mfma_f32_16x16x32_bf16 v[36:39], v[120:123], v[80:83], v[148:151]
    v_max3_f32 v68, v8, v9, v24
    v_max3_f32 v69, v10, v11, v26
    v_max_f32 v68, v68, v25
    v_max_f32 v69, v69, v27
    v_max3_f32 v70, v12, v13, v28
    v_max3_f32 v71, v14, v15, v30
    v_max_f32 v70, v70, v29
    v_max_f32 v71, v71, v31
    v_max3_f32 v72, v16, v17, v32
    v_max3_f32 v73, v18, v19, v34
    v_max_f32 v72, v72, v33
    v_max_f32 v73, v73, v35
    v_max3_f32 v74, v20, v21, v36
    v_max3_f32 v75, v22, v23, v38
    v_max_f32 v74, v74, v37
    v_max_f32 v75, v75, v39
L_soft:
    v_max_f32 v76, v68, v69
    v_max_f32 v77, v70, v71
    v_max_f32 v78, v72, v73
    v_max_f32 v79, v74, v75
    v_mov_b32 v84, 0x3f803f80
    v_permlane32_swap_b32 v76, v77
    v_permlane32_swap_b32 v78, v79
    v_max_f32 v76, v76, v77
    v_max_f32 v78, v78, v79
    v_mov_b32 v85, 0x3f803f80
    v_mov_b32 v86, 0x3f803f80
    v_permlane16_swap_b32 v76, v78
    v_max_f32 v76, v76, v78
    v_mul_f32 v78, s54, v76
    v_mul_f32 v76, s54, v76
    v_mov_b32 v87, 0x3f803f80
    v_mov_b32 v4, 1
    v_permlane16_swap_b32 v76, v78
    v_mov_b32 v77, v76
    v_mov_b32 v79, v78
    s_waitcnt lgkmcnt(0)
    v_permlane32_swap_b32 v76, v77
    v_permlane32_swap_b32 v78, v79
    v_fma_f32 v68, v68, s54, -v76
    v_fma_f32 v69, v69, s54, -v76
    v_fma_f32 v70, v70, s54, -v77
    v_fma_f32 v71, v71, s54, -v77
    v_fma_f32 v72, v72, s54, -v78
    v_fma_f32 v73, v73, s54, -v78
    v_fma_f32 v74, v74, s54, -v79
    v_fma_f32 v75, v75, s54, -v79
    s_bitcmp1_b32 s45, 7
    s_cbranch_scc1 L_novx
    ds_read_b32 v6, v163
    ds_read_b64 v[106:107], v162 offset:9216
    ds_read_b64 v[104:105], v162 offset:9728
    ds_read_b64 v[102:103], v162 offset:10240
    ds_read_b64 v[100:101], v162 offset:10752
    ds_read_b64 v[98:99], v162 offset:11264
L_novx:
    v_exp_f32 v68, v68
    v_exp_f32 v69, v69
    v_exp_f32 v70, v70
    v_exp_f32 v71, v71
    v_exp_f32 v72, v72
    v_exp_f32 v73, v73
    v_exp_f32 v74, v74
    v_exp_f32 v75, v75
    v_cvt_pk_bf16_f32 v80, v68, v69
    v_perm_b32 v108, v80, v80, v152
    v_perm_b32 v109, v80, v80, v153
    v_perm_b32 v110, v80, v80, v154
    v_perm_b32 v111, v80, v80, v155
    v_cvt_pk_bf16_f32 v81, v70, v71
    v_perm_b32 v112, v81, v81, v152
    v_perm_b32 v113, v81, v81, v153
    v_perm_b32 v114, v81, v81, v154
    v_perm_b32 v115, v81, v81, v155
    v_mfma_f32_16x16x32_bf16 v[24:27], v[84:87], v[108:111], 0
    v_mfma_f32_16x16x32_bf16 v[8:11], v[94:97], v[108:111], 0
    v_cvt_pk_bf16_f32 v82, v72, v73
    v_perm_b32 v116, v82, v82, v152
    v_perm_b32 v117, v82, v82, v153
    v_perm_b32 v118, v82, v82, v154
    v_perm_b32 v119, v82, v82, v155
    v_mfma_f32_16x16x32_bf16 v[28:31], v[84:87], v[112:115], 0
    v_mfma_f32_16x16x32_bf16 v[12:15], v[92:95], v[112:115], 0
    v_cvt_pk_bf16_f32 v83, v74, v75
    v_perm_b32 v120, v83, v83, v152
    v_perm_b32 v121, v83, v83, v153
    v_perm_b32 v122, v83, v83, v154
    v_perm_b32 v123, v83, v83, v155
    v_mfma_f32_16x16x32_bf16 v[32:35], v[84:87], v[116:119], 0
    v_mfma_f32_16x16x32_bf16 v[16:19], v[90:93], v[116:119], 0
    s_bitcmp1_b32 s45, 7
    v_mfma_f32_16x16x32_bf16 v[36:39], v[84:87], v[120:123], 0
    v_mfma_f32_16x16x32_bf16 v[20:23], v[88:91], v[120:123], 0
    s_cbranch_scc1 L_norem
    s_mov_b32 s100, 0
L_vxw:
    s_waitcnt lgkmcnt(0)
    v_cmp_eq_u32 vcc, 0, v6
    s_and_b32 s99, vcc_lo, s49
    s_cbranch_scc1 L_vxslow
L_vxok:
    v_mfma_f32_16x16x32_bf16 v[40:43], v[104:107], v[108:111], 0
    v_mfma_f32_16x16x32_bf16 v[44:47], v[102:105], v[112:115], 0
    v_mfma_f32_16x16x32_bf16 v[48:51], v[100:103], v[116:119], 0
    v_mfma_f32_16x16x32_bf16 v[52:55], v[98:101], v[120:123], 0
L_norem:
    s_mov_b64 exec, 1
    ds_add_u32 v3, v4 offset:196
    s_mov_b64 exec, -1
    ds_read_b32 v6, v163 offset:264
    v_rcp_f32 v24, v24
    v_rcp_f32 v28, v28
    v_rcp_f32 v32, v32
    v_rcp_f32 v36, v36
    v_pk_mul_f32 v[8:9], v[8:9], v[24:25] op_sel_hi:[1,0]
    v_pk_mul_f32 v[10:11], v[10:11], v[24:25] op_sel_hi:[1,0]
    v_pk_mul_f32 v[12:13], v[12:13], v[28:29] op_sel_hi:[1,0]
    v_pk_mul_f32 v[14:15], v[14:15], v[28:29] op_sel_hi:[1,0]
    v_pk_mul_f32 v[16:17], v[16:17], v[32:33] op_sel_hi:[1,0]
    v_pk_mul_f32 v[18:19], v[18:19], v[32:33] op_sel_hi:[1,0]
    v_pk_mul_f32 v[20:21], v[20:21], v[36:37] op_sel_hi:[1,0]
    v_pk_mul_f32 v[22:23], v[22:23], v[36:37] op_sel_hi:[1,0]
    v_cvt_pk_bf16_f32 v56, v8, v9
    v_cvt_pk_bf16_f32 v57, v10, v11
    v_cvt_pk_bf16_f32 v58, v12, v13
    v_cvt_pk_bf16_f32 v59, v14, v15
    v_cvt_pk_bf16_f32 v60, v16, v17
    v_cvt_pk_bf16_f32 v61, v18, v19
    v_cvt_pk_bf16_f32 v62, v20, v21
    v_cvt_pk_bf16_f32 v63, v22, v23
    s_mov_b32 s100, 0
L_rxw:
    s_waitcnt lgkmcnt(0)
    v_cmp_eq_u32 vcc, 0, v6
    s_and_b32 s99, vcc_lo, s47
    s_cbranch_scc1 L_rxslow
L_rxok:
    s_mov_b64 exec, s[50:51]
    s_cmp_lg_u32 s91, 1
    s_cbranch_scc1 Ldg_45
    global_store_dwordx2 v160, v[56:57], s[18:19] offset:0
    global_store_dwordx2 v160, v[58:59], s[18:19] offset:1024
    global_store_dwordx2 v157, v[60:61], s[18:19] offset:0
    global_store_dwordx2 v157, v[62:63], s[18:19] offset:1024
    s_branch Ldd_46
L_padb12:
    s_branch L_warmed_b
Ldg_45:
    global_store_dwordx2 v160, v[56:57], s[18:19] offset:0 sc1
    global_store_dwordx2 v160, v[58:59], s[18:19] offset:1024 sc1
    global_store_dwordx2 v157, v[60:61], s[18:19] offset:0 sc1
    global_store_dwordx2 v157, v[62:63], s[18:19] offset:1024 sc1
Ldd_46:
    s_mov_b64 exec, -1
    s_bitcmp1_b32 s45, 7
    s_cbranch_scc1 L_norem2
    v_pk_mul_f32 v[64:65], v[40:41], v[24:25] op_sel_hi:[1,0]
    v_pk_mul_f32 v[66:67], v[42:43], v[24:25] op_sel_hi:[1,0]
    s_mov_b32 exec_lo, 0xffff0000
    v_pk_mul_f32 v[64:65], v[44:45], v[28:29] op_sel_hi:[1,0]
    v_pk_mul_f32 v[66:67], v[46:47], v[28:29] op_sel_hi:[1,0]
    s_mov_b32 exec_lo, 0
    v_pk_mul_f32 v[64:65], v[48:49], v[32:33] op_sel_hi:[1,0]
    v_pk_mul_f32 v[66:67], v[50:51], v[32:33] op_sel_hi:[1,0]
    s_mov_b32 exec_hi, 0xffff0000
    v_pk_mul_f32 v[64:65], v[52:53], v[36:37] op_sel_hi:[1,0]
    v_pk_mul_f32 v[66:67], v[54:55], v[36:37] op_sel_hi:[1,0]
    s_mov_b64 exec, -1
    v_cvt_pk_bf16_f32 v64, v64, v65
    v_cvt_pk_bf16_f32 v65, v66, v67
    s_cmp_lg_u32 s91, 1
    s_cbranch_scc1 Ldg_47
    global_store_dwordx2 v161, v[64:65], s[18:19]
    s_branch Ldd_48
Ldg_47:
    global_store_dwordx2 v161, v[64:65], s[18:19] sc1
Ldd_48:
L_norem2:
    v_lshl_add_u32 v132, v0, 4, s80
    v_lshl_add_u32 v133, v0, 4, s82
    v_lshl_add_u32 v166, v0, 2, s83
    v_mov_b32 v6, s55
    v_mov_b32 v5, s33
    s_mov_b64 exec, 1
    ds_add_u32 v3, v4 offset:268
    s_waitcnt vmcnt(0)
    s_cmp_lg_u32 s91, 1
    s_cbranch_scc1 Ldg_49
    global_store_dword v6, v5, s[16:17]
    s_branch Ldd_50
.p2align 12
L_pada5:
    s_branch L_pada13
L_padb13:
    s_branch L_warmed_b
Ldg_49:
    global_store_dword v6, v5, s[16:17] sc1
Ldd_50:
    s_mov_b64 exec, -1
L_tail:
    s_lshl_b32 s96, s57, 2
    v_add_u32 v136, s96, v3
    s_add_u32 s62, s18, 8192
    s_addc_u32 s63, s19, 0
    s_add_u32 s64, s18, 16384
    s_addc_u32 s65, s19, 0
    s_setprio 2
    s_cmp_eq_u32 s57, 0
    s_cbranch_scc1 L_tp
    s_setprio 1
L_tp:
    v_mov_b32 v135, 0
    v_lshl_add_u32 v137, v0, 4, s84
    s_lshl_b32 s96, s56, 2
    v_add_u32 v160, s96, v3
    s_cmp_lg_u32 s34, 0
    s_cbranch_scc1 L_opa
    s_mov_b32 s100, 0
Lw_51:
    ds_read_b32 v4, v3 offset:268
    s_waitcnt lgkmcnt(0)
    v_readfirstlane_b32 s99, v4
    s_cmp_ge_u32 s99, 64
    s_cbranch_scc1 Lwd_52
    s_add_u32 s100, s100, 1
    s_cmp_lt_u32 s100, 1048576
    s_cbranch_scc1 Lw_51
Lwd_52:
    s_cmp_lg_u32 s57, 0
    s_cbranch_scc1 L_prep
L_opb:
    s_mov_b32 s100, 0
Lw_53:
    ds_read_b32 v4, v136 offset:200
    s_waitcnt lgkmcnt(0)
    v_readfirstlane_b32 s99, v4
    s_cmp_ge_u32 s99, 4
    s_cbranch_scc1 Lwd_54
    s_sleep 1
    s_add_u32 s100, s100, 1
    s_cmp_lt_u32 s100, 1048576
    s_cbranch_scc1 Lw_53
Lwd_54:
    ds_read_b128 v[68:71], v132 offset:0
    ds_read_b128 v[72:75], v132 offset:1024
    ds_read_b128 v[76:79], v132 offset:2048
    ds_read_b128 v[80:83], v132 offset:3072
    ds_read_b128 v[84:87], v132 offset:4096
    ds_read_b128 v[88:91], v132 offset:5120
    ds_read_b128 v[92:95], v132 offset:6144
    ds_read_b128 v[96:99], v132 offset:7168
    ds_read_b128 v[100:103], v132 offset:8192
    ds_read_b128 v[104:107], v132 offset:9216
    ds_read_b128 v[108:111], v132 offset:10240
    ds_read_b128 v[112:115], v132 offset:11264
    s_waitcnt lgkmcnt(8)
    ds_read_b128 v[116:119], v132 offset:12288
    ds_read_b128 v[120:123], v132 offset:13312
    ds_read_b128 v[124:127], v132 offset:14336
    ds_read_b128 v[128:131], v132 offset:15360
    s_cmp_eq_u32 s57, 0
    s_cbranch_scc1 L_opp
L_lgo:
    s_mov_b32 s100, 0
Lw_55:
    ds_read_b32 v4, v160 offset:216
    s_waitcnt lgkmcnt(0)
    v_readfirstlane_b32 s99, v4
    s_cmp_ge_u32 s99, 1
    s_cbranch_scc1 Lwd_56
    s_sleep 1
    s_add_u32 s100, s100, 1
    s_cmp_lt_u32 s100, 1048576
    s_cbranch_scc1 Lw_55
Lwd_56:
    s_branch L_late
L_opp:
    s_mov_b32 exec_hi, 0xfffff
    s_mov_b32 exec_lo, 0xfffff
    s_mov_b32 s100, 0
L_op:
    global_load_dword v4, v166, s[16:17] sc1
    s_waitcnt vmcnt(0)
    v_cmp_ne_u32 vcc, s33, v4
    s_cbranch_vccz L_opd
    s_add_u32 s100, s100, 1
    s_cmp_lt_u32 s100, 1048576
    s_cbranch_scc1 L_op
    s_branch L_opd
L_pada6:
    s_branch L_pada14
L_padb14:
    s_branch L_warmed_b
L_opa:
    s_cmp_eq_u32 s57, 0
    s_cbranch_scc1 L_opa1
    s_mov_b32 s100, 0
Lw_57:
    ds_read_b32 v4, v3 offset:376
    s_waitcnt lgkmcnt(0)
    v_readfirstlane_b32 s99, v4
    s_cmp_ge_u32 s99, 2
    s_cbranch_scc1 Lwd_58
    s_sleep 1
    s_add_u32 s100, s100, 1
    s_cmp_lt_u32 s100, 1048576
    s_cbranch_scc1 Lw_57
Lwd_58:
    s_setprio 3
    s_branch L_prep
L_opa1:
    s_mov_b32 s100, 0
Lw_59:
    ds_read_b32 v4, v3 offset:200
    s_waitcnt lgkmcnt(0)
    v_readfirstlane_b32 s99, v4
    s_cmp_ge_u32 s99, 4
    s_cbranch_scc1 Lwd_60
    s_sleep 1
    s_add_u32 s100, s100, 1
    s_cmp_lt_u32 s100, 1048576
    s_cbranch_scc1 Lw_59
Lwd_60:
    ds_read_b128 v[68:71], v132 offset:0
    ds_read_b128 v[72:75], v132 offset:1024
    ds_read_b128 v[76:79], v132 offset:2048
    ds_read_b128 v[80:83], v132 offset:3072
    ds_read_b128 v[84:87], v132 offset:4096
    ds_read_b128 v[88:91], v132 offset:5120
    ds_read_b128 v[92:95], v132 offset:6144
    ds_read_b128 v[96:99], v132 offset:7168
    ds_read_b128 v[100:103], v132 offset:8192
    ds_read_b128 v[104:107], v132 offset:9216
    ds_read_b128 v[108:111], v132 offset:10240
    ds_read_b128 v[112:115], v132 offset:11264
    s_waitcnt lgkmcnt(8)
    ds_read_b128 v[116:119], v132 offset:12288
    ds_read_b128 v[120:123], v132 offset:13312
    ds_read_b128 v[124:127], v132 offset:14336
    ds_read_b128 v[128:131], v132 offset:15360
    s_mov_b32 s100, 0
Lw_61:
    ds_read_b32 v4, v3 offset:276
    s_waitcnt lgkmcnt(0)
    v_readfirstlane_b32 s99, v4
    s_cmp_ge_u32 s99, 1
    s_cbranch_scc1 Lwd_62
    s_sleep 1
    s_add_u32 s100, s100, 1
    s_cmp_lt_u32 s100, 1048576
    s_cbranch_scc1 Lw_61
Lwd_62:
L_opd:
    s_mov_b64 exec, -1
    s_cmp_eq_u32 s57, 0
    s_cbranch_scc1 L_early
L_late:
    global_load_dwordx4 v[28:31], v133, s[18:19] offset:-4096 sc1
    global_load_dwordx4 v[32:35], v133, s[18:19] offset:-2048 sc1
    global_load_dwordx4 v[36:39], v133, s[18:19] offset:0 sc1
    global_load_dwordx4 v[40:43], v133, s[18:19] offset:2048 sc1
    global_load_dwordx4 v[44:47], v133, s[62:63] offset:-4096 sc1
    global_load_dwordx4 v[48:51], v133, s[62:63] offset:-2048 sc1
    global_load_dwordx4 v[52:55], v133, s[62:63] offset:0 sc1
    global_load_dwordx4 v[56:59], v133, s[62:63] offset:2048 sc1
    global_load_dwordx4 v[60:63], v133, s[64:65] offset:-4096 sc1
    global_load_dwordx4 v[64:67], v133, s[64:65] offset:-2048 sc1
    s_lshr_b32 s96, s56, 1
    s_lshl_b32 s96, s96, 7
    s_add_u32 s96, s96, 3072
    v_add_u32 v166, s96, v166
    v_mov_b32 v134, s33
    s_and_b32 s96, s56, 1
    s_lshl1_add_u32 s96, s96, s57
    s_lshl2_add_u32 s96, s36, s96
    s_lshl_b64 s[66:67], 1, s96
    s_cmp_eq_u32 s34, 0
    s_cbranch_scc1 L_nogq
    s_mov_b32 s100, 0
Lw_63:
    ds_read_b32 v4, v3 offset:204
    s_waitcnt lgkmcnt(0)
    v_readfirstlane_b32 s99, v4
    s_cmp_ge_u32 s99, 4
    s_cbranch_scc1 Lwd_64
    s_sleep 1
    s_add_u32 s100, s100, 1
    s_cmp_lt_u32 s100, 1048576
    s_cbranch_scc1 Lw_63
Lwd_64:
    ds_read_b128 v[68:71], v132 offset:0
    ds_read_b128 v[72:75], v132 offset:1024
    ds_read_b128 v[76:79], v132 offset:2048
    ds_read_b128 v[80:83], v132 offset:3072
    ds_read_b128 v[84:87], v132 offset:4096
    ds_read_b128 v[88:91], v132 offset:5120
    ds_read_b128 v[92:95], v132 offset:6144
    ds_read_b128 v[96:99], v132 offset:7168
    ds_read_b128 v[100:103], v132 offset:8192
    ds_read_b128 v[104:107], v132 offset:9216
    ds_read_b128 v[108:111], v132 offset:10240
    ds_read_b128 v[112:115], v132 offset:11264
    s_waitcnt lgkmcnt(8)
    ds_read_b128 v[116:119], v132 offset:12288
    ds_read_b128 v[120:123], v132 offset:13312
    ds_read_b128 v[124:127], v132 offset:14336
    ds_read_b128 v[128:131], v132 offset:15360
    s_branch L_nogq
L_pada7:
    s_branch L_pada15
L_padb15:
    s_branch L_warmed_b
    s_setprio 3
    s_waitcnt lgkmcnt(6)
L_prep:
    s_lshl_b32 s96, s56, 6
    s_add_u32 s96, s96, 161280
    v_lshl_add_u32 v164, v1, 2, s96
    v_mul_u32_u24 v161, 160, v1
    v_lshl_add_u32 v161, v2, 3, v161
    v_add_u32 v5, s81, v161
    s_mov_b32 s100, 0
Lw_65:
    ds_read_b32 v4, v3 offset:208
    s_waitcnt lgkmcnt(0)
    v_readfirstlane_b32 s99, v4
    s_cmp_ge_u32 s99, 1
    s_cbranch_scc1 Lwd_66
    s_add_u32 s100, s100, 1
    s_cmp_lt_u32 s100, 1048576
    s_cbranch_scc1 Lw_65
Lwd_66:
    ds_read2st64_b32 v[162:163], v164 offset0:0 offset1:1
    ds_read_b64 v[148:149], v5 offset:0
    ds_read_b64 v[150:151], v5 offset:32
    ds_read_b64 v[152:153], v5 offset:64
    ds_read_b64 v[154:155], v5 offset:96
    ds_read_b64 v[156:157], v5 offset:128
    v_add_u32 v161, s84, v161
    v_add_u32 v5, 0, v0
    v_mul_u32_u24 v165, 6554, v5
    v_lshrrev_b32 v165, 16, v165
    v_mul_u32_u24 v165, 1120, v165
    v_lshl_add_u32 v5, v5, 4, s85
    v_add_u32 v165, v165, v5
    v_add_u32 v5, 64, v0
    v_mul_u32_u24 v7, 6554, v5
    v_lshrrev_b32 v7, 16, v7
    v_mul_u32_u24 v7, 1120, v7
    v_lshl_add_u32 v5, v5, 4, s85
    v_add_u32 v7, v7, v5
    v_add_u32 v5, 128, v0
    v_mul_u32_u24 v135, 6554, v5
    v_lshrrev_b32 v135, 16, v135
    v_mul_u32_u24 v135, 1120, v135
    v_lshl_add_u32 v5, v5, 4, s85
    v_add_u32 v135, v135, v5
    v_bfe_u32 v5, v0, 3, 2
    v_xor_b32 v5, s56, v5
    v_lshlrev_b32 v5, 5, v5
    v_lshrrev_b32 v6, 2, v0
    v_lshl_add_u32 v5, v6, 7, v5
    v_and_b32 v6, 3, v0
    v_lshl_add_u32 v5, v6, 3, v5
    v_add_u32 v164, s93, v5
    s_waitcnt lgkmcnt(0)
    v_lshlrev_b32 v138, 16, v148
    v_and_b32 v139, 0xffff0000, v148
    v_lshlrev_b32 v140, 16, v149
    v_and_b32 v141, 0xffff0000, v149
    v_lshlrev_b32 v142, 16, v150
    v_and_b32 v143, 0xffff0000, v150
    v_lshlrev_b32 v144, 16, v151
    v_and_b32 v145, 0xffff0000, v151
    v_lshlrev_b32 v146, 16, v152
    v_and_b32 v147, 0xffff0000, v152
    v_lshlrev_b32 v148, 16, v153
    v_and_b32 v149, 0xffff0000, v153
    v_lshlrev_b32 v150, 16, v154
    v_and_b32 v151, 0xffff0000, v154
    v_lshlrev_b32 v152, 16, v155
    v_and_b32 v153, 0xffff0000, v155
    v_lshlrev_b32 v154, 16, v156
    v_and_b32 v155, 0xffff0000, v156
    v_lshlrev_b32 v156, 16, v157
    v_and_b32 v157, 0xffff0000, v157
    v_pk_mul_f32 v[138:139], v[138:139], v[162:163] op_sel:[0,1] op_sel_hi:[1,1]
    v_pk_mul_f32 v[140:141], v[140:141], v[162:163] op_sel:[0,1] op_sel_hi:[1,1]
    v_pk_mul_f32 v[142:143], v[142:143], v[162:163] op_sel:[0,1] op_sel_hi:[1,1]
    v_pk_mul_f32 v[144:145], v[144:145], v[162:163] op_sel:[0,1] op_sel_hi:[1,1]
    v_pk_mul_f32 v[146:147], v[146:147], v[162:163] op_sel:[0,1] op_sel_hi:[1,1]
    v_pk_mul_f32 v[148:149], v[148:149], v[162:163] op_sel:[0,1] op_sel_hi:[1,1]
    v_pk_mul_f32 v[150:151], v[150:151], v[162:163] op_sel:[0,1] op_sel_hi:[1,1]
    v_pk_mul_f32 v[152:153], v[152:153], v[162:163] op_sel:[0,1] op_sel_hi:[1,1]
    v_pk_mul_f32 v[154:155], v[154:155], v[162:163] op_sel:[0,1] op_sel_hi:[1,1]
    v_pk_mul_f32 v[156:157], v[156:157], v[162:163] op_sel:[0,1] op_sel_hi:[1,1]
    s_setprio 1
    s_cmp_eq_u32 s34, 0
    s_cbranch_scc1 L_opb
    s_branch L_lgo
L_pada8:
    s_branch L_warmed_a
L_padb16:
    s_branch L_warmed_b
L_nogq:
    s_waitcnt lgkmcnt(0)
    s_waitcnt vmcnt(9)
    v_mfma_f32_16x16x32_bf16 v[8:11], v[68:71], v[28:31], 0
    ds_read_b128 v[68:71], v132 offset:16384
    v_mfma_f32_16x16x32_bf16 v[12:15], v[72:75], v[28:31], 0
    ds_read_b128 v[72:75], v132 offset:17408
    v_mfma_f32_16x16x32_bf16 v[16:19], v[76:79], v[28:31], 0
    ds_read_b128 v[76:79], v132 offset:18432
    v_mfma_f32_16x16x32_bf16 v[20:23], v[80:83], v[28:31], 0
    ds_read_b128 v[80:83], v132 offset:19456
    v_mfma_f32_16x16x32_bf16 v[24:27], v[84:87], v[28:31], 0
    ds_read_b128 v[84:87], v132 offset:20480
    s_waitcnt vmcnt(8)
    v_mfma_f32_16x16x32_bf16 v[8:11], v[88:91], v[32:35], v[8:11]
    ds_read_b128 v[88:91], v132 offset:21504
    v_mfma_f32_16x16x32_bf16 v[12:15], v[92:95], v[32:35], v[12:15]
    ds_read_b128 v[92:95], v132 offset:22528
    v_mfma_f32_16x16x32_bf16 v[16:19], v[96:99], v[32:35], v[16:19]
    ds_read_b128 v[96:99], v132 offset:23552
    v_mfma_f32_16x16x32_bf16 v[20:23], v[100:103], v[32:35], v[20:23]
    ds_read_b128 v[100:103], v132 offset:24576
    v_mfma_f32_16x16x32_bf16 v[24:27], v[104:107], v[32:35], v[24:27]
    ds_read_b128 v[104:107], v132 offset:25600
    s_waitcnt vmcnt(7)
    v_mfma_f32_16x16x32_bf16 v[8:11], v[108:111], v[36:39], v[8:11]
    ds_read_b128 v[108:111], v132 offset:26624
    v_mfma_f32_16x16x32_bf16 v[12:15], v[112:115], v[36:39], v[12:15]
    ds_read_b128 v[112:115], v132 offset:27648
    v_mfma_f32_16x16x32_bf16 v[16:19], v[116:119], v[36:39], v[16:19]
    s_waitcnt lgkmcnt(10)
    ds_read_b128 v[116:119], v132 offset:28672
    v_mfma_f32_16x16x32_bf16 v[20:23], v[120:123], v[36:39], v[20:23]
    ds_read_b128 v[120:123], v132 offset:29696
    v_mfma_f32_16x16x32_bf16 v[24:27], v[124:127], v[36:39], v[24:27]
    s_waitcnt lgkmcnt(10)
    ds_read_b128 v[124:127], v132 offset:30720
    s_waitcnt vmcnt(6)
    v_mfma_f32_16x16x32_bf16 v[8:11], v[128:131], v[40:43], v[8:11]
    ds_read_b128 v[128:131], v132 offset:31744
    v_mfma_f32_16x16x32_bf16 v[12:15], v[68:71], v[40:43], v[12:15]
    s_waitcnt lgkmcnt(10)
    ds_read_b128 v[68:71], v132 offset:32768
    v_mfma_f32_16x16x32_bf16 v[16:19], v[72:75], v[40:43], v[16:19]
    ds_read_b128 v[72:75], v132 offset:33792
    v_mfma_f32_16x16x32_bf16 v[20:23], v[76:79], v[40:43], v[20:23]
    s_waitcnt lgkmcnt(10)
    ds_read_b128 v[76:79], v132 offset:34816
    v_mfma_f32_16x16x32_bf16 v[24:27], v[80:83], v[40:43], v[24:27]
    ds_read_b128 v[80:83], v132 offset:35840
    s_waitcnt vmcnt(5)
    v_mfma_f32_16x16x32_bf16 v[8:11], v[84:87], v[44:47], v[8:11]
    s_waitcnt lgkmcnt(10)
    ds_read_b128 v[84:87], v132 offset:36864
    v_mfma_f32_16x16x32_bf16 v[12:15], v[88:91], v[44:47], v[12:15]
    ds_read_b128 v[88:91], v132 offset:37888
    v_mfma_f32_16x16x32_bf16 v[16:19], v[92:95], v[44:47], v[16:19]
    s_waitcnt lgkmcnt(10)
    ds_read_b128 v[92:95], v132 offset:38912
    v_mfma_f32_16x16x32_bf16 v[20:23], v[96:99], v[44:47], v[20:23]
    ds_read_b128 v[96:99], v132 offset:39936
    v_mfma_f32_16x16x32_bf16 v[24:27], v[100:103], v[44:47], v[24:27]
    s_waitcnt lgkmcnt(10)
    ds_read_b128 v[100:103], v132 offset:40960
    s_waitcnt vmcnt(4)
    v_mfma_f32_16x16x32_bf16 v[8:11], v[104:107], v[48:51], v[8:11]
    ds_read_b128 v[104:107], v132 offset:41984
    v_mfma_f32_16x16x32_bf16 v[12:15], v[108:111], v[48:51], v[12:15]
    s_waitcnt lgkmcnt(10)
    ds_read_b128 v[108:111], v132 offset:43008
    v_mfma_f32_16x16x32_bf16 v[16:19], v[112:115], v[48:51], v[16:19]
    ds_read_b128 v[112:115], v132 offset:44032
    v_mfma_f32_16x16x32_bf16 v[20:23], v[116:119], v[48:51], v[20:23]
    s_waitcnt lgkmcnt(10)
    ds_read_b128 v[116:119], v132 offset:45056
    v_mfma_f32_16x16x32_bf16 v[24:27], v[120:123], v[48:51], v[24:27]
    ds_read_b128 v[120:123], v132 offset:46080
    s_waitcnt vmcnt(3)
    v_mfma_f32_16x16x32_bf16 v[8:11], v[124:127], v[52:55], v[8:11]
    s_waitcnt lgkmcnt(10)
    ds_read_b128 v[124:127], v132 offset:47104
    v_mfma_f32_16x16x32_bf16 v[12:15], v[128:131], v[52:55], v[12:15]
    ds_read_b128 v[128:131], v132 offset:48128
    v_mfma_f32_16x16x32_bf16 v[16:19], v[68:71], v[52:55], v[16:19]
    s_waitcnt lgkmcnt(10)
    ds_read_b128 v[68:71], v132 offset:49152
    v_mfma_f32_16x16x32_bf16 v[20:23], v[72:75], v[52:55], v[20:23]
    ds_read_b128 v[72:75], v132 offset:50176
    v_mfma_f32_16x16x32_bf16 v[24:27], v[76:79], v[52:55], v[24:27]
    s_waitcnt vmcnt(0)
    v_mfma_f32_16x16x32_bf16 v[8:11], v[80:83], v[56:59], v[8:11]
    s_mov_b64 exec, s[66:67]
    global_store_dword v166, v134, s[28:29]
    s_mov_b64 exec, -1
    v_mfma_f32_16x16x32_bf16 v[12:15], v[84:87], v[56:59], v[12:15]
    v_mfma_f32_16x16x32_bf16 v[16:19], v[88:91], v[56:59], v[16:19]
    s_waitcnt lgkmcnt(11)
    v_mfma_f32_16x16x32_bf16 v[20:23], v[92:95], v[56:59], v[20:23]
    s_waitcnt lgkmcnt(10)
    v_mfma_f32_16x16x32_bf16 v[24:27], v[96:99], v[56:59], v[24:27]
    s_waitcnt lgkmcnt(9)
    v_mfma_f32_16x16x32_bf16 v[8:11], v[100:103], v[60:63], v[8:11]
    s_waitcnt lgkmcnt(8)
    v_mfma_f32_16x16x32_bf16 v[12:15], v[104:107], v[60:63], v[12:15]
    s_waitcnt lgkmcnt(7)
    v_mfma_f32_16x16x32_bf16 v[16:19], v[108:111], v[60:63], v[16:19]
    s_waitcnt lgkmcnt(6)
    v_mfma_f32_16x16x32_bf16 v[20:23], v[112:115], v[60:63], v[20:23]
    s_waitcnt lgkmcnt(5)
    v_mfma_f32_16x16x32_bf16 v[24:27], v[116:119], v[60:63], v[24:27]
    s_waitcnt lgkmcnt(4)
    v_mfma_f32_16x16x32_bf16 v[8:11], v[120:123], v[64:67], v[8:11]
    s_waitcnt lgkmcnt(3)
    v_mfma_f32_16x16x32_bf16 v[12:15], v[124:127], v[64:67], v[12:15]
    s_waitcnt lgkmcnt(2)
    v_mfma_f32_16x16x32_bf16 v[16:19], v[128:131], v[64:67], v[16:19]
    s_waitcnt lgkmcnt(1)
    v_mfma_f32_16x16x32_bf16 v[20:23], v[68:71], v[64:67], v[20:23]
    s_waitcnt lgkmcnt(0)
    v_mfma_f32_16x16x32_bf16 v[24:27], v[72:75], v[64:67], v[24:27]
    s_cmp_lg_u32 s101, 0
    s_cbranch_scc1 L_cvl
L_cvdl:
    s_setprio 3
    s_mov_b32 s100, 0
L_fb:
    ds_read_b32 v4, v160 offset:232
    ds_read_b128 v[28:31], v137 offset:0
    ds_read_b128 v[32:35], v137 offset:1024
    ds_read_b128 v[36:39], v137 offset:2048
    ds_read_b128 v[40:43], v137 offset:3072
    ds_read_b128 v[44:47], v137 offset:4096
    ds_read_b32 v5, v3 offset:212
    ds_read_b64_tr_b16 v[48:49], v164 offset:0
    ds_read_b64_tr_b16 v[50:51], v164 offset:2048
    ds_read_b64_tr_b16 v[52:53], v164 offset:4096
    ds_read_b64_tr_b16 v[54:55], v164 offset:6144
    ds_read_b64_tr_b16 v[56:57], v164 offset:8192
    s_waitcnt lgkmcnt(11)
    v_readfirstlane_b32 s96, v4
    s_cmp_lg_u32 s96, 0
    s_cbranch_scc1 L_fp
    s_waitcnt lgkmcnt(0)
    s_add_u32 s100, s100, 1
    s_cmp_lt_u32 s100, 1048576
    s_cbranch_scc1 L_fb
L_fp:
    s_mov_b64 exec, 0xffffffff
    global_load_dword v6, v166, s[28:29] sc1
    s_mov_b64 exec, -1
    s_waitcnt lgkmcnt(10)
    v_pk_add_f32 v[28:29], v[28:29], v[8:9]
    v_pk_add_f32 v[30:31], v[30:31], v[10:11]
    s_waitcnt lgkmcnt(9)
    v_pk_add_f32 v[32:33], v[32:33], v[12:13]
    v_pk_add_f32 v[34:35], v[34:35], v[14:15]
    s_waitcnt lgkmcnt(8)
    v_pk_add_f32 v[36:37], v[36:37], v[16:17]
    v_pk_add_f32 v[38:39], v[38:39], v[18:19]
    s_waitcnt lgkmcnt(7)
    v_pk_add_f32 v[40:41], v[40:41], v[20:21]
    v_pk_add_f32 v[42:43], v[42:43], v[22:23]
    s_waitcnt lgkmcnt(6)
    v_pk_add_f32 v[44:45], v[44:45], v[24:25]
    v_pk_add_f32 v[46:47], v[46:47], v[26:27]
    v_pk_mul_f32 v[28:29], v[28:29], v[162:163] op_sel_hi:[1,0]
    v_pk_mul_f32 v[30:31], v[30:31], v[162:163] op_sel_hi:[1,0]
    v_pk_mul_f32 v[32:33], v[32:33], v[162:163] op_sel_hi:[1,0]
    v_pk_mul_f32 v[34:35], v[34:35], v[162:163] op_sel_hi:[1,0]
    v_pk_mul_f32 v[36:37], v[36:37], v[162:163] op_sel_hi:[1,0]
    v_pk_mul_f32 v[38:39], v[38:39], v[162:163] op_sel_hi:[1,0]
    v_pk_mul_f32 v[40:41], v[40:41], v[162:163] op_sel_hi:[1,0]
    v_pk_mul_f32 v[42:43], v[42:43], v[162:163] op_sel_hi:[1,0]
    v_pk_mul_f32 v[44:45], v[44:45], v[162:163] op_sel_hi:[1,0]
    v_pk_mul_f32 v[46:47], v[46:47], v[162:163] op_sel_hi:[1,0]
    s_mov_b32 s100, 0
L_fy:
    s_waitcnt lgkmcnt(5)
    v_readfirstlane_b32 s96, v5
    s_cmp_eq_u32 s96, 2
    s_cbranch_scc1 L_fin
    ds_read_b32 v5, v3 offset:212
    ds_read_b64_tr_b16 v[48:49], v164 offset:0
    ds_read_b64_tr_b16 v[50:51], v164 offset:2048
    ds_read_b64_tr_b16 v[52:53], v164 offset:4096
    ds_read_b64_tr_b16 v[54:55], v164 offset:6144
    ds_read_b64_tr_b16 v[56:57], v164 offset:8192
    s_add_u32 s100, s100, 1
    s_cmp_lt_u32 s100, 1048576
    s_cbranch_scc1 L_fy
L_fin:
    s_waitcnt lgkmcnt(4)
    v_lshlrev_b32 v60, 16, v48
    v_and_b32 v61, 0xffff0000, v48
    v_lshlrev_b32 v62, 16, v49
    v_and_b32 v63, 0xffff0000, v49
    v_pk_fma_f32 v[28:29], v[60:61], v[138:139], v[28:29]
    v_pk_fma_f32 v[30:31], v[62:63], v[140:141], v[30:31]
    v_cvt_pk_bf16_f32 v48, v28, v29
    v_cvt_pk_bf16_f32 v49, v30, v31
    ds_write_b64 v161, v[48:49] offset:0
    s_waitcnt lgkmcnt(4)
    v_lshlrev_b32 v60, 16, v50
    v_and_b32 v61, 0xffff0000, v50
    v_lshlrev_b32 v62, 16, v51
    v_and_b32 v63, 0xffff0000, v51
    v_pk_fma_f32 v[32:33], v[60:61], v[142:143], v[32:33]
    v_pk_fma_f32 v[34:35], v[62:63], v[144:145], v[34:35]
    v_cvt_pk_bf16_f32 v50, v32, v33
    v_cvt_pk_bf16_f32 v51, v34, v35
    ds_write_b64 v161, v[50:51] offset:32
    s_waitcnt lgkmcnt(4)
    v_lshlrev_b32 v60, 16, v52
    v_and_b32 v61, 0xffff0000, v52
    v_lshlrev_b32 v62, 16, v53
    v_and_b32 v63, 0xffff0000, v53
    v_pk_fma_f32 v[36:37], v[60:61], v[146:147], v[36:37]
    v_pk_fma_f32 v[38:39], v[62:63], v[148:149], v[38:39]
    v_cvt_pk_bf16_f32 v52, v36, v37
    v_cvt_pk_bf16_f32 v53, v38, v39
    ds_write_b64 v161, v[52:53] offset:64
    s_waitcnt lgkmcnt(4)
    v_lshlrev_b32 v60, 16, v54
    v_and_b32 v61, 0xffff0000, v54
    v_lshlrev_b32 v62, 16, v55
    v_and_b32 v63, 0xffff0000, v55
    v_pk_fma_f32 v[40:41], v[60:61], v[150:151], v[40:41]
    v_pk_fma_f32 v[42:43], v[62:63], v[152:153], v[42:43]
    v_cvt_pk_bf16_f32 v54, v40, v41
    v_cvt_pk_bf16_f32 v55, v42, v43
    ds_write_b64 v161, v[54:55] offset:96
    s_waitcnt lgkmcnt(4)
    v_lshlrev_b32 v60, 16, v56
    v_and_b32 v61, 0xffff0000, v56
    v_lshlrev_b32 v62, 16, v57
    v_and_b32 v63, 0xffff0000, v57
    v_pk_fma_f32 v[44:45], v[60:61], v[154:155], v[44:45]
    v_pk_fma_f32 v[46:47], v[62:63], v[156:157], v[46:47]
    v_cvt_pk_bf16_f32 v56, v44, v45
    v_cvt_pk_bf16_f32 v57, v46, v47
    ds_write_b64 v161, v[56:57] offset:128
    ds_read_b128 v[72:75], v137 offset:0
    ds_read_b128 v[76:79], v137 offset:1024
    ds_read_b128 v[80:83], v137 offset:2048
    s_mov_b32 s100, 0
    s_cmp_lg_u32 s91, 1
    s_cbranch_scc1 L_gout
L_rdw:
    s_waitcnt vmcnt(0)
    v_cmp_ne_u32 vcc, s33, v6
    s_cmp_eq_u32 vcc_lo, 0
    s_cbranch_scc1 L_rdok
    s_mov_b64 exec, 0xffffffff
    global_load_dword v6, v166, s[28:29] sc1
    s_mov_b64 exec, -1
    s_add_u32 s100, s100, 1
    s_cmp_lt_u32 s100, 1048576
    s_cbranch_scc1 L_rdw
L_rdok:
    s_waitcnt lgkmcnt(2)
    global_store_dwordx4 v165, v[72:75], s[24:25]
    s_waitcnt lgkmcnt(1)
    global_store_dwordx4 v7, v[76:79], s[24:25]
    s_waitcnt lgkmcnt(0)
    s_mov_b64 exec, 0xffffffff
    global_store_dwordx4 v135, v[80:83], s[24:25]
    s_endpgm
L_pada9:
    s_branch L_warmed_a
L_padb17:
    s_branch L_warmed_b
L_rxslow:
    ds_read_b32 v6, v163 offset:264
    s_add_u32 s100, s100, 1
    s_cmp_lt_u32 s100, 1048576
    s_cbranch_scc1 L_rxw
    s_branch L_rxok
L_vxslow:
    ds_read_b32 v6, v163
    ds_read_b64 v[106:107], v162 offset:9216
    ds_read_b64 v[104:105], v162 offset:9728
    ds_read_b64 v[102:103], v162 offset:10240
    ds_read_b64 v[100:101], v162 offset:10752
    ds_read_b64 v[98:99], v162 offset:11264
    s_add_u32 s100, s100, 1
    s_cmp_lt_u32 s100, 1048576
    s_cbranch_scc1 L_vxw
    s_waitcnt lgkmcnt(0)
    s_branch L_vxok
.p2align 12
L_pada10:
    s_branch L_warmed_a
L_padb18:
    s_branch L_warmed_b
L_early:
    v_mov_b32 v5, 1
    global_load_dwordx4 v[28:31], v133, s[18:19] offset:-4096 sc1
    global_load_dwordx4 v[32:35], v133, s[18:19] offset:-2048 sc1
    global_load_dwordx4 v[36:39], v133, s[18:19] offset:0 sc1
    global_load_dwordx4 v[40:43], v133, s[18:19] offset:2048 sc1
    global_load_dwordx4 v[44:47], v133, s[62:63] offset:-4096 sc1
    s_lshr_b32 s96, s56, 1
    s_lshl_b32 s96, s96, 7
    s_add_u32 s96, s96, 3072
    v_add_u32 v166, s96, v166
    v_mov_b32 v134, s33
    s_and_b32 s96, s56, 1
    s_lshl1_add_u32 s96, s96, s57
    s_lshl2_add_u32 s96, s36, s96
    s_lshl_b64 s[66:67], 1, s96
    s_waitcnt lgkmcnt(0)
    s_waitcnt vmcnt(4)
    v_mfma_f32_16x16x32_bf16 v[8:11], v[68:71], v[28:31], 0
    ds_read_b128 v[68:71], v132 offset:16384
    v_mfma_f32_16x16x32_bf16 v[12:15], v[72:75], v[28:31], 0
    global_load_dwordx4 v[48:51], v133, s[62:63] offset:-2048 sc1
    ds_read_b128 v[72:75], v132 offset:17408
    v_mfma_f32_16x16x32_bf16 v[16:19], v[76:79], v[28:31], 0
    ds_read_b128 v[76:79], v132 offset:18432
    v_mfma_f32_16x16x32_bf16 v[20:23], v[80:83], v[28:31], 0
    global_load_dwordx4 v[52:55], v133, s[62:63] offset:0 sc1
    ds_write_b32 v160, v5 offset:216
    ds_read_b128 v[80:83], v132 offset:19456
    v_mfma_f32_16x16x32_bf16 v[24:27], v[84:87], v[28:31], 0
    ds_read_b128 v[84:87], v132 offset:20480
    s_waitcnt vmcnt(5)
    v_mfma_f32_16x16x32_bf16 v[8:11], v[88:91], v[32:35], v[8:11]
    ds_read_b128 v[88:91], v132 offset:21504
    v_mfma_f32_16x16x32_bf16 v[12:15], v[92:95], v[32:35], v[12:15]
    global_load_dwordx4 v[56:59], v133, s[62:63] offset:2048 sc1
    ds_read_b128 v[92:95], v132 offset:22528
    v_mfma_f32_16x16x32_bf16 v[16:19], v[96:99], v[32:35], v[16:19]
    ds_read_b128 v[96:99], v132 offset:23552
    v_mfma_f32_16x16x32_bf16 v[20:23], v[100:103], v[32:35], v[20:23]
    global_load_dwordx4 v[60:63], v133, s[64:65] offset:-4096 sc1
    ds_read_b128 v[100:103], v132 offset:24576
    v_mfma_f32_16x16x32_bf16 v[24:27], v[104:107], v[32:35], v[24:27]
    ds_read_b128 v[104:107], v132 offset:25600
    s_waitcnt vmcnt(6)
    v_mfma_f32_16x16x32_bf16 v[8:11], v[108:111], v[36:39], v[8:11]
    ds_read_b128 v[108:111], v132 offset:26624
    v_mfma_f32_16x16x32_bf16 v[12:15], v[112:115], v[36:39], v[12:15]
    global_load_dwordx4 v[64:67], v133, s[64:65] offset:-2048 sc1
    s_waitcnt lgkmcnt(9)
    ds_read_b128 v[112:115], v132 offset:27648
    v_mfma_f32_16x16x32_bf16 v[16:19], v[116:119], v[36:39], v[16:19]
    ds_read_b128 v[116:119], v132 offset:28672
    v_mfma_f32_16x16x32_bf16 v[20:23], v[120:123], v[36:39], v[20:23]
    s_waitcnt lgkmcnt(9)
    ds_read_b128 v[120:123], v132 offset:29696
    v_mfma_f32_16x16x32_bf16 v[24:27], v[124:127], v[36:39], v[24:27]
    ds_read_b128 v[124:127], v132 offset:30720
    s_waitcnt vmcnt(6)
    v_mfma_f32_16x16x32_bf16 v[8:11], v[128:131], v[40:43], v[8:11]
    s_waitcnt lgkmcnt(9)
    ds_read_b128 v[128:131], v132 offset:31744
    v_mfma_f32_16x16x32_bf16 v[12:15], v[68:71], v[40:43], v[12:15]
    ds_read_b128 v[68:71], v132 offset:32768
    v_mfma_f32_16x16x32_bf16 v[16:19], v[72:75], v[40:43], v[16:19]
    s_waitcnt lgkmcnt(9)
    ds_read_b128 v[72:75], v132 offset:33792
    v_mfma_f32_16x16x32_bf16 v[20:23], v[76:79], v[40:43], v[20:23]
    ds_read_b128 v[76:79], v132 offset:34816
    v_mfma_f32_16x16x32_bf16 v[24:27], v[80:83], v[40:43], v[24:27]
    s_waitcnt lgkmcnt(9)
    ds_read_b128 v[80:83], v132 offset:35840
    s_waitcnt vmcnt(5)
    v_mfma_f32_16x16x32_bf16 v[8:11], v[84:87], v[44:47], v[8:11]
    ds_read_b128 v[84:87], v132 offset:36864
    v_mfma_f32_16x16x32_bf16 v[12:15], v[88:91], v[44:47], v[12:15]
    s_waitcnt lgkmcnt(9)
    ds_read_b128 v[88:91], v132 offset:37888
    v_mfma_f32_16x16x32_bf16 v[16:19], v[92:95], v[44:47], v[16:19]
    ds_read_b128 v[92:95], v132 offset:38912
    v_mfma_f32_16x16x32_bf16 v[20:23], v[96:99], v[44:47], v[20:23]
    s_waitcnt lgkmcnt(9)
    ds_read_b128 v[96:99], v132 offset:39936
    v_mfma_f32_16x16x32_bf16 v[24:27], v[100:103], v[44:47], v[24:27]
    ds_read_b128 v[100:103], v132 offset:40960
    s_waitcnt vmcnt(4)
    v_mfma_f32_16x16x32_bf16 v[8:11], v[104:107], v[48:51], v[8:11]
    s_waitcnt lgkmcnt(9)
    ds_read_b128 v[104:107], v132 offset:41984
    v_mfma_f32_16x16x32_bf16 v[12:15], v[108:111], v[48:51], v[12:15]
    ds_read_b128 v[108:111], v132 offset:43008
    v_mfma_f32_16x16x32_bf16 v[16:19], v[112:115], v[48:51], v[16:19]
    s_waitcnt lgkmcnt(9)
    ds_read_b128 v[112:115], v132 offset:44032
    v_mfma_f32_16x16x32_bf16 v[20:23], v[116:119], v[48:51], v[20:23]
    ds_read_b128 v[116:119], v132 offset:45056
    v_mfma_f32_16x16x32_bf16 v[24:27], v[120:123], v[48:51], v[24:27]
    s_waitcnt lgkmcnt(9)
    ds_read_b128 v[120:123], v132 offset:46080
    s_waitcnt vmcnt(3)
    v_mfma_f32_16x16x32_bf16 v[8:11], v[124:127], v[52:55], v[8:11]
    ds_read_b128 v[124:127], v132 offset:47104
    v_mfma_f32_16x16x32_bf16 v[12:15], v[128:131], v[52:55], v[12:15]
    s_waitcnt lgkmcnt(9)
    ds_read_b128 v[128:131], v132 offset:48128
    v_mfma_f32_16x16x32_bf16 v[16:19], v[68:71], v[52:55], v[16:19]
    ds_read_b128 v[68:71], v132 offset:49152
    v_mfma_f32_16x16x32_bf16 v[20:23], v[72:75], v[52:55], v[20:23]
    s_waitcnt lgkmcnt(9)
    ds_read_b128 v[72:75], v132 offset:50176
    v_mfma_f32_16x16x32_bf16 v[24:27], v[76:79], v[52:55], v[24:27]
    s_waitcnt vmcnt(0)
    v_mfma_f32_16x16x32_bf16 v[8:11], v[80:83], v[56:59], v[8:11]
    s_mov_b64 exec, s[66:67]
    global_store_dword v166, v134, s[28:29]
    s_mov_b64 exec, -1
    v_mfma_f32_16x16x32_bf16 v[12:15], v[84:87], v[56:59], v[12:15]
    v_mfma_f32_16x16x32_bf16 v[16:19], v[88:91], v[56:59], v[16:19]
    v_mfma_f32_16x16x32_bf16 v[20:23], v[92:95], v[56:59], v[20:23]
    v_mfma_f32_16x16x32_bf16 v[24:27], v[96:99], v[56:59], v[24:27]
    s_waitcnt lgkmcnt(9)
    v_mfma_f32_16x16x32_bf16 v[8:11], v[100:103], v[60:63], v[8:11]
    s_waitcnt lgkmcnt(8)
    v_mfma_f32_16x16x32_bf16 v[12:15], v[104:107], v[60:63], v[12:15]
    s_waitcnt lgkmcnt(7)
    v_mfma_f32_16x16x32_bf16 v[16:19], v[108:111], v[60:63], v[16:19]
    s_waitcnt lgkmcnt(6)
    v_mfma_f32_16x16x32_bf16 v[20:23], v[112:115], v[60:63], v[20:23]
    s_waitcnt lgkmcnt(5)
    v_mfma_f32_16x16x32_bf16 v[24:27], v[116:119], v[60:63], v[24:27]
    s_waitcnt lgkmcnt(4)
    v_mfma_f32_16x16x32_bf16 v[8:11], v[120:123], v[64:67], v[8:11]
    s_waitcnt lgkmcnt(3)
    v_mfma_f32_16x16x32_bf16 v[12:15], v[124:127], v[64:67], v[12:15]
    s_waitcnt lgkmcnt(2)
    v_mfma_f32_16x16x32_bf16 v[16:19], v[128:131], v[64:67], v[16:19]
    s_waitcnt lgkmcnt(1)
    v_mfma_f32_16x16x32_bf16 v[20:23], v[68:71], v[64:67], v[20:23]
    s_waitcnt lgkmcnt(0)
    v_mfma_f32_16x16x32_bf16 v[24:27], v[72:75], v[64:67], v[24:27]
    s_setprio 0
    s_mov_b32 s100, 0
Lw_67:
    ds_read_b32 v4, v3 offset:196
    s_waitcnt lgkmcnt(0)
    v_readfirstlane_b32 s99, v4
    s_cmp_ge_u32 s99, 8
    s_cbranch_scc1 Lwd_68
    s_add_u32 s100, s100, 1
    s_cmp_lt_u32 s100, 1048576
    s_cbranch_scc1 Lw_67
Lwd_68:
    ds_write_b128 v137, v[8:11] offset:0
    ds_write_b128 v137, v[12:15] offset:1024
    ds_write_b128 v137, v[16:19] offset:2048
    ds_write_b128 v137, v[20:23] offset:3072
    ds_write_b128 v137, v[24:27] offset:4096
    v_mov_b32 v4, 2
    ds_write_b32 v160, v4 offset:232
    s_cmp_lg_u32 s101, 0
    s_cbranch_scc1 L_cve
L_cvde:
    s_endpgm
L_pada11:
    s_branch L_warmed_a
L_padb19:
    s_branch L_warmed_b
L_gout:
    s_waitcnt lgkmcnt(0)
    global_store_dwordx4 v165, v[72:75], s[24:25] sc1
    global_store_dwordx4 v7, v[76:79], s[24:25] sc1
    s_mov_b64 exec, 0xffffffff
    global_store_dwordx4 v135, v[80:83], s[24:25] sc1
    s_endpgm
L_cvl:
    s_cmp_ge_u32 s31, 26
    s_cselect_b32 s96, 8, 0
    s_lshl_b32 s97, s30, 8
    s_add_u32 s96, s96, s97
    s_add_u32 s96, s96, 65536
    s_and_b32 s98, s33, 0xffffff00
    s_mov_b32 exec_lo, s101
    s_mov_b32 exec_hi, 0
    s_mov_b32 s100, 0
L_cwl:
    v_subrev_u32 v158, s98, v159
    v_cmp_le_u32 vcc, 0x600, v158
    s_cbranch_vccz L_cxl
    s_mov_b64 exec, vcc
    v_lshlrev_b32 v68, 2, v0
    v_add_u32 v68, 161792, v68
    ds_read_b32 v70, v68
    v_mov_b32 v71, 0x100
    v_lshl_add_u32 v68, v0, 11, s96
    s_sleep 8
    s_waitcnt lgkmcnt(0)
    global_atomic_add_x2 v[158:159], v68, v[70:71], s[28:29] sc0 sc1
    s_waitcnt vmcnt(0)
    s_add_u32 s100, s100, 1
    s_cmp_lt_u32 s100, 1048576
    s_cbranch_scc1 L_cwl
L_cxl:
    s_mov_b64 exec, -1
    s_branch L_cvdl
L_cve:
    s_cmp_ge_u32 s31, 26
    s_cselect_b32 s96, 8, 0
    s_lshl_b32 s97, s30, 8
    s_add_u32 s96, s96, s97
    s_add_u32 s96, s96, 65536
    s_and_b32 s98, s33, 0xffffff00
    s_mov_b32 exec_lo, s101
    s_mov_b32 exec_hi, 0
    s_mov_b32 s100, 0
L_cwe:
    v_subrev_u32 v158, s98, v159
    v_cmp_le_u32 vcc, 0x600, v158
    s_cbranch_vccz L_cxe
    s_mov_b64 exec, vcc
    v_lshlrev_b32 v68, 2, v0
    v_add_u32 v68, 161792, v68
    ds_read_b32 v70, v68
    v_mov_b32 v71, 0x100
    v_lshl_add_u32 v68, v0, 11, s96
    s_sleep 8
    s_waitcnt lgkmcnt(0)
    global_atomic_add_x2 v[158:159], v68, v[70:71], s[28:29] sc0 sc1
    s_waitcnt vmcnt(0)
    s_add_u32 s100, s100, 1
    s_cmp_lt_u32 s100, 1048576
    s_cbranch_scc1 L_cwe
L_cxe:
    s_mov_b64 exec, -1
    s_branch L_cvde
L_awave:
    s_mov_b32 s58, 0
    s_waitcnt lgkmcnt(0)
    s_load_dword s33, s[28:29], 0
    s_lshl1_add_u32 s40, s30, s38
    s_sub_u32 s40, s40, 5
    s_lshl4_add_u32 s40, s65, s40
    s_cmp_ge_u32 s40, 100
    s_cbranch_scc1 L_nounit
    s_mul_i32 s41, s40, 205
    s_lshr_b32 s41, s41, 11
    s_mul_i32 s42, s41, 10
    s_sub_u32 s42, s40, s42
    v_lshrrev_b32 v4, 3, v0
    v_mul_u32_u24 v4, 1280, v4
    v_and_b32 v5, 7, v0
    v_lshl_add_u32 v4, v5, 4, v4
    s_mul_i32 s43, s41, 81920
    s_lshl_b32 s96, s42, 7
    s_add_u32 s43, s43, s96
    s_lshl_b32 s44, s65, 13
    s_add_u32 s44, s44, 90496
    s_mov_b32 m0, s44
    s_mov_b32 s48, s20
    s_and_b32 s49, s21, 0xffff
    s_mov_b32 s50, 819200
    s_mov_b32 s51, 0x00020000
    buffer_load_dwordx4 v4, s[48:51], s43 offen lds
    s_addk_i32 m0, 1024
    s_addk_i32 s43, 10240
    buffer_load_dwordx4 v4, s[48:51], s43 offen lds
    s_addk_i32 m0, 1024
    s_addk_i32 s43, 10240
    buffer_load_dwordx4 v4, s[48:51], s43 offen lds
    s_addk_i32 m0, 1024
    s_addk_i32 s43, 10240
    buffer_load_dwordx4 v4, s[48:51], s43 offen lds
    s_addk_i32 m0, 1024
    s_addk_i32 s43, 10240
    buffer_load_dwordx4 v4, s[48:51], s43 offen lds
    s_addk_i32 m0, 1024
    s_addk_i32 s43, 10240
    buffer_load_dwordx4 v4, s[48:51], s43 offen lds
    s_addk_i32 m0, 1024
    s_addk_i32 s43, 10240
    buffer_load_dwordx4 v4, s[48:51], s43 offen lds
    s_addk_i32 m0, 1024
    s_addk_i32 s43, 10240
    buffer_load_dwordx4 v4, s[48:51], s43 offen lds
    s_sub_u32 s45, s41, 5
    s_cselect_b32 s45, s41, s45
    s_mov_b32 s46, 0xf9af5600
    s_cmp_eq_u32 s45, 1
    s_cselect_b32 s46, 0xfeab5500, s46
    s_cmp_eq_u32 s45, 2
    s_cselect_b32 s46, 0xffaa5500, s46
    s_cmp_eq_u32 s45, 3
    s_cselect_b32 s46, 0xffaa1540, s46
    s_cmp_eq_u32 s45, 4
    s_cselect_b32 s46, 0xff6a0590, s46
    v_lshrrev_b32 v4, 2, v0
    v_and_b32 v5, 3, v0
    v_lshlrev_b32 v5, 3, v5
    v_lshl_add_u32 v4, v4, 7, v5
    v_add_u32 v4, s44, v4
    v_lshlrev_b32 v5, 1, v2
    v_bfe_u32 v8, s46, v5, 2
    v_lshl_add_u32 v8, v8, 11, v4
    s_lshr_b32 s46, s46, 8
    v_bfe_u32 v9, s46, v5, 2
    v_lshl_add_u32 v9, v9, 11, v4
    s_lshr_b32 s46, s46, 8
    v_bfe_u32 v10, s46, v5, 2
    v_lshl_add_u32 v10, v10, 11, v4
    s_lshr_b32 s46, s46, 8
    v_bfe_u32 v11, s46, v5, 2
    v_lshl_add_u32 v11, v11, 11, v4
    s_mul_i32 s41, s41, 5120
    s_add_u32 s41, s41, 9437184
    s_lshl2_add_u32 s96, s42, 0
    s_mul_i32 s97, s96, 205
    s_lshr_b32 s97, s97, 10
    s_mul_i32 s97, s97, 97280
    s_lshl_b32 s96, s96, 10
    s_add_u32 s96, s96, s97
    s_add_u32 s96, s96, s41
    v_lshl_add_u32 v12, v0, 4, s96
    s_lshl2_add_u32 s96, s42, 1
    s_mul_i32 s97, s96, 205
    s_lshr_b32 s97, s97, 10
    s_mul_i32 s97, s97, 97280
    s_lshl_b32 s96, s96, 10
    s_add_u32 s96, s96, s97
    s_add_u32 s96, s96, s41
    v_lshl_add_u32 v13, v0, 4, s96
    s_lshl2_add_u32 s96, s42, 2
    s_mul_i32 s97, s96, 205
    s_lshr_b32 s97, s97, 10
    s_mul_i32 s97, s97, 97280
    s_lshl_b32 s96, s96, 10
    s_add_u32 s96, s96, s97
    s_add_u32 s96, s96, s41
    v_lshl_add_u32 v14, v0, 4, s96
    s_lshl2_add_u32 s96, s42, 3
    s_mul_i32 s97, s96, 205
    s_lshr_b32 s97, s97, 10
    s_mul_i32 s97, s97, 97280
    s_lshl_b32 s96, s96, 10
    s_add_u32 s96, s96, s97
    s_add_u32 s96, s96, s41
    v_lshl_add_u32 v15, v0, 4, s96
    s_add_u32 s44, s28, 51200
    s_addc_u32 s45, s29, 0
    s_waitcnt vmcnt(8) lgkmcnt(0)
    s_barrier
    s_waitcnt vmcnt(0)
    ds_read_b64_tr_b16 v[48:49], v9 offset:0
    ds_read_b64_tr_b16 v[50:51], v10 offset:0
    ds_read_b64_tr_b16 v[52:53], v9 offset:32
    ds_read_b64_tr_b16 v[54:55], v10 offset:32
    ds_read_b64_tr_b16 v[56:57], v9 offset:64
    ds_read_b64_tr_b16 v[58:59], v10 offset:64
    ds_read_b64_tr_b16 v[60:61], v9 offset:96
    ds_read_b64_tr_b16 v[62:63], v10 offset:96
    s_waitcnt lgkmcnt(4)
    ds_read_b64_tr_b16 v[64:65], v8 offset:0
    ds_read_b64_tr_b16 v[66:67], v11 offset:0
    ds_read_b64_tr_b16 v[68:69], v8 offset:32
    ds_read_b64_tr_b16 v[70:71], v11 offset:32
    ds_read_b64_tr_b16 v[72:73], v8 offset:64
    ds_read_b64_tr_b16 v[74:75], v11 offset:64
    ds_read_b64_tr_b16 v[76:77], v8 offset:96
    ds_read_b64_tr_b16 v[78:79], v11 offset:96
    s_waitcnt lgkmcnt(0)
    global_store_dwordx4 v12, v[48:51], s[28:29] sc1
    global_store_dwordx4 v13, v[52:55], s[28:29] sc1
    global_store_dwordx4 v14, v[56:59], s[28:29] sc1
    global_store_dwordx4 v15, v[60:63], s[28:29] sc1
    global_store_dwordx4 v12, v[64:67], s[44:45] sc1
    global_store_dwordx4 v13, v[68:71], s[44:45] sc1
    global_store_dwordx4 v14, v[72:75], s[44:45] sc1
    global_store_dwordx4 v15, v[76:79], s[44:45] sc1
    s_branch L_notap
L_nounit:
    s_waitcnt lgkmcnt(0)
    s_barrier
    s_branch L_notap
.p2align 12
L_nopack:
    v_sub_u32 v4, v1, v2
    v_and_b32 v4, 3, v4
    v_and_or_b32 v4, v1, 12, v4
    v_lshrrev_b32 v5, 1, v4
    v_lshlrev_b32 v4, 4, v4
    s_setprio 2
    s_waitcnt lgkmcnt(0)
    v_cmp_eq_u32 vcc, 0, v5
    s_mov_b64 exec, vcc
    v_bfe_u32 v42, s40, v4, 16
    v_bfe_u32 v43, s48, v4, 16
    v_bfe_u32 v44, s76, v4, 16
    v_bfe_u32 v45, s84, v4, 16
    s_mov_b64 exec, -1
    v_cmp_eq_u32 vcc, 1, v5
    s_mov_b64 exec, vcc
    v_bfe_u32 v42, s41, v4, 16
    v_bfe_u32 v43, s49, v4, 16
    v_bfe_u32 v44, s77, v4, 16
    v_bfe_u32 v45, s85, v4, 16
    s_mov_b64 exec, -1
    v_cmp_eq_u32 vcc, 2, v5
    s_mov_b64 exec, vcc
    v_bfe_u32 v42, s42, v4, 16
    v_bfe_u32 v43, s50, v4, 16
    v_bfe_u32 v44, s78, v4, 16
    v_bfe_u32 v45, s86, v4, 16
    s_mov_b64 exec, -1
    v_cmp_eq_u32 vcc, 3, v5
    s_mov_b64 exec, vcc
    v_bfe_u32 v42, s43, v4, 16
    v_bfe_u32 v43, s51, v4, 16
    v_bfe_u32 v44, s79, v4, 16
    v_bfe_u32 v45, s87, v4, 16
    s_mov_b64 exec, -1
    v_cmp_eq_u32 vcc, 4, v5
    s_mov_b64 exec, vcc
    v_bfe_u32 v42, s44, v4, 16
    v_bfe_u32 v43, s52, v4, 16
    v_bfe_u32 v44, s80, v4, 16
    v_bfe_u32 v45, s88, v4, 16
    s_mov_b64 exec, -1
    v_cmp_eq_u32 vcc, 5, v5
    s_mov_b64 exec, vcc
    v_bfe_u32 v42, s45, v4, 16
    v_bfe_u32 v43, s53, v4, 16
    v_bfe_u32 v44, s81, v4, 16
    v_bfe_u32 v45, s89, v4, 16
    s_mov_b64 exec, -1
    v_cmp_eq_u32 vcc, 6, v5
    s_mov_b64 exec, vcc
    v_bfe_u32 v42, s46, v4, 16
    v_bfe_u32 v43, s54, v4, 16
    v_bfe_u32 v44, s82, v4, 16
    v_bfe_u32 v45, s90, v4, 16
    s_mov_b64 exec, -1
    v_cmp_eq_u32 vcc, 7, v5
    s_mov_b64 exec, vcc
    v_bfe_u32 v42, s47, v4, 16
    v_bfe_u32 v43, s55, v4, 16
    v_bfe_u32 v44, s83, v4, 16
    v_bfe_u32 v45, s91, v4, 16
    s_mov_b64 exec, -1
L_notap:
    s_setprio 2
    s_and_b32 s56, s65, 3
    s_lshr_b32 s57, s65, 2
    s_sub_u32 s96, s31, 20
    s_mul_i32 s97, s96, 43
    s_lshr_b32 s97, s97, 7
    s_mul_i32 s41, s96, 7
    s_sub_u32 s41, s41, s97
    s_mul_i32 s97, s97, 3
    s_sub_u32 s97, s96, s97
    s_cmp_eq_u32 s97, 2
    s_cselect_b32 s64, 6, 7
    s_mul_i32 s97, s30, 80
    s_add_u32 s41, s41, s97
    s_cmp_lt_u32 s65, s64
    s_cselect_b32 s52, 1, 0
    s_cselect_b32 s98, s65, 0
    s_cselect_b32 s20, 7, s64
    s_cselect_b32 s54, 0, 448
    s_add_u32 s41, s41, s98
    s_mul_i32 s42, s98, 8320
    s_mul_i32 s68, s98, 4608
    s_add_u32 s68, s68, 58240
    s_lshl_b32 s55, s41, 12
    v_lshlrev_b32 v8, 4, v0
    v_lshl_add_u32 v5, v1, 3, v2
    s_lshr_b32 s96, s65, 2
    s_mul_i32 s97, s96, 16896
    s_add_u32 s97, s97, 90496
    v_lshl_add_u32 v5, v5, 7, s97
    s_mul_i32 s45, s96, 512
    s_lshl_b32 s96, s65, 1
    v_xor_b32 v6, s96, v1
    v_and_b32 v6, 7, v6
    v_lshl_add_u32 v9, v6, 4, v5
    v_add_u32 v6, 7, v1
    v_xor_b32 v6, s96, v6
    v_and_b32 v6, 7, v6
    v_lshl_add_u32 v11, v6, 4, v5
    v_xor_b32 v10, 16, v9
    v_xor_b32 v12, 16, v11
    v_subrev_u32 v46, s45, v9
    v_subrev_u32 v47, s45, v10
    s_lshl_b32 s96, s58, 16
    s_lshl_b32 s97, s37, 8
    s_add_u32 s96, s96, s97
    s_add_u32 s96, s96, 1048576
    v_lshlrev_b32 v5, 12, v2
    v_lshl_add_u32 v5, v1, 4, v5
    v_add_u32 v14, s96, v5
    s_add_u32 s60, s28, 16384
    s_addc_u32 s61, s29, 0
    s_add_u32 s62, s28, 32768
    s_addc_u32 s63, s29, 0
    s_add_u32 s66, s28, 49152
    s_addc_u32 s67, s29, 0
    s_lshl4_add_u32 s96, s58, s37
    s_lshl_b32 s96, s96, 7
    s_add_u32 s96, s96, 262144
    v_add_u32 v5, v1, v2
    v_lshl_add_u32 v148, v5, 3, s96
    s_lshr_b32 s96, s41, 4
    s_lshl_b32 s96, s96, 11
    s_and_b32 s97, s41, 15
    s_lshl3_add_u32 s96, s97, s96
    s_add_u32 s96, s96, 262144
    v_lshl_add_u32 v149, v1, 7, s96
    s_waitcnt lgkmcnt(0)
    s_mul_i32 s33, s33, 1664525
    s_add_u32 s33, s33, 1013904223
    s_mov_b32 s43, s98
    v_bfe_u32 v5, v1, 2, 1
    v_lshlrev_b32 v5, 4, v5
    v_and_b32 v6, 3, v1
    v_lshrrev_b32 v7, 3, v1
    v_mov_b32 v4, 0x3f80
    v_lshlrev_b32 v4, v5, v4
    v_cmp_eq_u32 vcc, v6, v2
    s_nop 1
    v_cndmask_b32 v4, 0, v4, vcc
    v_cmp_eq_u32 vcc, 0, v7
    s_nop 1
    v_cndmask_b32 v40, 0, v4, vcc
    v_cndmask_b32 v41, v4, 0, vcc
    v_or_b32 v4, 2, v7
    v_cmp_ge_u32 vcc, v6, v2
    s_nop 1
    v_cndmask_b32 v7, v7, v4, vcc
    v_lshlrev_b32 v42, v5, v42
    v_lshlrev_b32 v43, v5, v43
    v_lshlrev_b32 v44, v5, v44
    v_lshlrev_b32 v45, v5, v45
    v_cmp_eq_u32 vcc, 0, v7
    s_nop 1
    v_cndmask_b32 v16, 0, v42, vcc
    v_cndmask_b32 v20, 0, v42, vcc
    v_cndmask_b32 v22, 0, v43, vcc
    v_cndmask_b32 v26, 0, v43, vcc
    v_cndmask_b32 v28, 0, v44, vcc
    v_cndmask_b32 v32, 0, v44, vcc
    v_cndmask_b32 v34, 0, v45, vcc
    v_cndmask_b32 v38, 0, v45, vcc
    v_cmp_eq_u32 vcc, 1, v7
    s_nop 1
    v_cndmask_b32 v17, 0, v42, vcc
    v_cndmask_b32 v21, 0, v42, vcc
    v_cndmask_b32 v23, 0, v43, vcc
    v_cndmask_b32 v27, 0, v43, vcc
    v_cndmask_b32 v29, 0, v44, vcc
    v_cndmask_b32 v33, 0, v44, vcc
    v_cndmask_b32 v35, 0, v45, vcc
    v_cndmask_b32 v39, 0, v45, vcc
    v_cmp_eq_u32 vcc, 2, v7
    s_nop 1
    v_cndmask_b32 v18, 0, v42, vcc
    v_cndmask_b32 v24, 0, v43, vcc
    v_cndmask_b32 v30, 0, v44, vcc
    v_cndmask_b32 v36, 0, v45, vcc
    v_cmp_eq_u32 vcc, 3, v7
    s_nop 1
    v_cndmask_b32 v19, 0, v42, vcc
    v_cndmask_b32 v25, 0, v43, vcc
    v_cndmask_b32 v31, 0, v44, vcc
    v_cndmask_b32 v37, 0, v45, vcc
    s_cmp_ge_u32 s38, 5
    s_cbranch_scc1 L_nokv
    s_barrier
    s_cmp_ge_u32 s38, 5
    s_cbranch_scc1 L_nokv
    ds_read_b128 v[48:51], v11
    ds_read_b128 v[52:55], v9 offset:512
    ds_read_b128 v[56:59], v9 offset:1024
    ds_read_b128 v[60:63], v46 offset:33792
    ds_read_b128 v[64:67], v46 offset:34304
    ds_read_b128 v[68:71], v12
    ds_read_b128 v[72:75], v10 offset:512
    ds_read_b128 v[76:79], v10 offset:1024
    ds_read_b128 v[80:83], v47 offset:33792
    ds_read_b128 v[84:87], v47 offset:34304
    s_waitcnt lgkmcnt(8)
    v_swap_b32 v50, v52
    v_swap_b32 v51, v53
    s_nop 1
    v_mfma_f32_16x16x32_bf16 v[88:91], v[16:19], v[48:51], 0
    v_mfma_f32_16x16x32_bf16 v[96:99], v[22:25], v[52:55], 0
    s_waitcnt lgkmcnt(7)
    v_mov_b64 v[48:49], v[56:57]
    v_mov_b64 v[52:53], v[58:59]
    s_nop 0
    v_mfma_f32_16x16x32_bf16 v[92:95], v[18:21], v[48:51], 0
    v_mfma_f32_16x16x32_bf16 v[100:103], v[24:27], v[52:55], 0
    s_waitcnt lgkmcnt(5)
    v_mfma_f32_16x16x16_bf16 v[104:107], v[40:41], v[60:61], 0
    v_mfma_f32_16x16x16_bf16 v[108:111], v[40:41], v[64:65], 0
    v_mfma_f32_16x16x16_bf16 v[112:115], v[40:41], v[62:63], 0
    v_mfma_f32_16x16x16_bf16 v[116:119], v[40:41], v[66:67], 0
    s_waitcnt lgkmcnt(3)
    v_swap_b32 v70, v72
    v_swap_b32 v71, v73
    s_nop 1
    v_mfma_f32_16x16x32_bf16 v[48:51], v[28:31], v[68:71], 0
    v_mfma_f32_16x16x32_bf16 v[56:59], v[34:37], v[72:75], 0
    s_waitcnt lgkmcnt(2)
    v_mov_b64 v[68:69], v[76:77]
    v_mov_b64 v[72:73], v[78:79]
    s_nop 0
    v_mfma_f32_16x16x32_bf16 v[52:55], v[30:33], v[68:71], 0
    v_mfma_f32_16x16x32_bf16 v[60:63], v[36:39], v[72:75], 0
    v_pk_mul_f32 v[88:89], v[88:89], v[104:105]
    v_pk_mul_f32 v[90:91], v[90:91], v[106:107]
    v_pk_mul_f32 v[92:93], v[92:93], v[108:109]
    v_pk_mul_f32 v[94:95], v[94:95], v[110:111]
    v_pk_mul_f32 v[96:97], v[96:97], v[112:113]
    v_pk_mul_f32 v[98:99], v[98:99], v[114:115]
    v_pk_mul_f32 v[100:101], v[100:101], v[116:117]
    v_pk_mul_f32 v[102:103], v[102:103], v[118:119]
    s_waitcnt lgkmcnt(0)
    v_mfma_f32_16x16x16_bf16 v[104:107], v[40:41], v[80:81], 0
    v_mfma_f32_16x16x16_bf16 v[108:111], v[40:41], v[84:85], 0
    v_mfma_f32_16x16x16_bf16 v[112:115], v[40:41], v[82:83], 0
    v_mfma_f32_16x16x16_bf16 v[116:119], v[40:41], v[86:87], 0
    v_cvt_pk_bf16_f32 v120, v88, v89
    v_cvt_pk_bf16_f32 v121, v90, v91
    v_cvt_pk_bf16_f32 v122, v92, v93
    v_cvt_pk_bf16_f32 v123, v94, v95
    global_store_dwordx4 v14, v[120:123], s[28:29] sc1
    v_cvt_pk_bf16_f32 v124, v96, v97
    v_cvt_pk_bf16_f32 v125, v98, v99
    v_cvt_pk_bf16_f32 v126, v100, v101
    v_cvt_pk_bf16_f32 v127, v102, v103
    global_store_dwordx4 v14, v[124:127], s[60:61] sc1
    v_add_u32 v76, v120, v121
    v_add3_u32 v76, v76, v122, v123
    v_add_u32 v77, v124, v125
    v_add3_u32 v77, v77, v126, v127
    v_pk_mul_f32 v[48:49], v[48:49], v[104:105]
    v_pk_mul_f32 v[50:51], v[50:51], v[106:107]
    v_pk_mul_f32 v[52:53], v[52:53], v[108:109]
    v_pk_mul_f32 v[54:55], v[54:55], v[110:111]
    v_pk_mul_f32 v[56:57], v[56:57], v[112:113]
    v_pk_mul_f32 v[58:59], v[58:59], v[114:115]
    v_pk_mul_f32 v[60:61], v[60:61], v[116:117]
    v_pk_mul_f32 v[62:63], v[62:63], v[118:119]
    v_cvt_pk_bf16_f32 v68, v48, v49
    v_cvt_pk_bf16_f32 v69, v50, v51
    v_cvt_pk_bf16_f32 v70, v52, v53
    v_cvt_pk_bf16_f32 v71, v54, v55
    global_store_dwordx4 v14, v[68:71], s[62:63] sc1
    v_cvt_pk_bf16_f32 v72, v56, v57
    v_cvt_pk_bf16_f32 v73, v58, v59
    v_cvt_pk_bf16_f32 v74, v60, v61
    v_cvt_pk_bf16_f32 v75, v62, v63
    global_store_dwordx4 v14, v[72:75], s[66:67] sc1
    v_add_u32 v78, v68, v69
    v_add3_u32 v78, v78, v70, v71
    v_add_u32 v79, v72, v73
    v_add3_u32 v79, v79, v74, v75
    v_add_u32_dpp v80, v76, v76 row_ror:8 row_mask:0xf bank_mask:0xf
    v_add_u32_dpp v81, v77, v77 row_ror:8 row_mask:0xf bank_mask:0xf
    s_nop 0
    v_add_u32_dpp v80, v78, v78 row_ror:8 row_mask:0xf bank_mask:0xc
    v_add_u32_dpp v81, v79, v79 row_ror:8 row_mask:0xf bank_mask:0xc
    v_mov_b32 v76, s33
    v_add_u32_dpp v77, v80, v80 row_half_mirror row_mask:0xf bank_mask:0xf
    s_nop 1
    v_add_u32_dpp v77, v81, v81 row_half_mirror row_mask:0xf bank_mask:0xa
    s_nop 1
    v_add_u32_dpp v77, v77, v77 quad_perm:[1,0,3,2] row_mask:0xf bank_mask:0xf
    s_nop 1
    v_add_u32_dpp v77, v77, v77 quad_perm:[2,3,0,1] row_mask:0xf bank_mask:0xf
    s_mov_b32 exec_lo, 0x11111111
    s_mov_b32 exec_hi, 0x11111111
    global_store_dwordx2 v148, v[76:77], s[28:29] sc1
    s_mov_b64 exec, -1
    v_mov_b32 v4, 1
    s_mov_b64 exec, 1
    ds_add_u32 v3, v4 offset:256
    s_mov_b64 exec, -1
L_nokv:
    s_setprio 1
    s_mov_b32 s98, s43
    s_add_u32 s96, s55, 1048576
    s_add_u32 s76, s28, s96
    s_addc_u32 s77, s29, 0
    s_and_b32 s77, s77, 0xffff
    s_mov_b32 s78, 4096
    s_mov_b32 s79, 0x00020000
    v_sub_u32 v5, 2031, v1
    v_and_b32 v6, 1, v5
    v_lshrrev_b32 v5, 1, v5
    v_lshl_add_u32 v5, v2, 2, v5
    v_lshlrev_b32 v5, 2, v5
    v_mul_u32_u24 v6, 4160, v6
    s_sub_u32 s96, s42, s54
    v_add3_u32 v5, v5, v6, s96
    v_subrev_u32 v154, 3584, v5
    v_subrev_u32 v155, 2560, v5
    v_subrev_u32 v156, 1536, v5
    v_subrev_u32 v157, 512, v5
    v_lshlrev_b32 v5, 5, v1
    v_lshl_add_u32 v5, v2, 4, v5
    s_sub_u32 s96, s68, s54
    s_add_u32 s96, s96, 480
    v_add_u32 v158, s96, v5
    v_and_b32 v5, 1, v2
    v_lshlrev_b32 v5, 9, v5
    v_lshl_add_u32 v5, v1, 5, v5
    v_lshrrev_b32 v6, 1, v2
    v_lshl_add_u32 v5, v6, 4, v5
    s_add_u32 s96, s55, 4194304
    v_add_u32 v153, s96, v5
    v_and_b32 v5, 28, v0
    v_add_u32 v152, 161792, v5
    s_cmp_ge_u32 s31, 26
    s_cselect_b32 s96, 8, 0
    s_lshl_b32 s97, s30, 8
    s_add_u32 s96, s96, s97
    s_add_u32 s96, s96, 65536
    v_and_b32 v5, 31, v0
    v_lshl_add_u32 v160, v5, 11, s96
    s_mul_i32 s96, s98, 2048
    s_add_u32 s96, s96, 88448
    v_add_u32 v161, s96, v8
    s_lshl_b32 s96, s98, 2
    v_add_u32 v162, s96, v3
    s_mul_i32 s96, s57, 51200
    s_sub_u32 s80, 109568, s96
    s_mul_i32 s81, s56, 2560
    s_add_u32 s81, s81, 48128
    s_mov_b32 s93, 0
    s_mov_b32 s101, 0
    s_and_b32 s98, s35, 3
    s_lshr_b32 s96, s56, 1
    s_lshl1_add_u32 s96, s98, s96
    s_lshl1_add_u32 s96, s96, s57
    s_mul_i32 s96, s96, 20480
    s_and_b32 s97, s56, 1
    s_lshl_b32 s97, s97, 10
    s_add_u32 s96, s96, s97
    s_mul_i32 s97, s30, 327680
    s_add_u32 s96, s96, s97
    s_add_u32 s82, s96, 4096
    s_mul_i32 s96, s30, 262144
    s_lshl_b32 s98, s98, 8
    s_add_u32 s96, s96, s98
    s_add_u32 s83, s96, 7536640
    s_mul_i32 s84, s56, 5120
    s_add_u32 s84, s84, 10240
    s_lshl2_add_u32 s96, s35, s56
    s_mul_i32 s96, s96, 20480
    s_mul_i32 s97, s36, 160
    s_add_u32 s85, s96, s97
    v_and_b32 v5, 1, v1
    v_lshlrev_b32 v5, 4, v5
    v_mov_b32 v6, 0x3f80
    v_lshlrev_b32 v6, v5, v6
    v_lshrrev_b32 v7, 1, v1
    v_lshlrev_b32 v4, 1, v2
    v_sub_u32 v4, v7, v4
    v_cmp_eq_u32 vcc, 0, v4
    s_nop 1
    v_cndmask_b32 v164, 0, v6, vcc
    v_cmp_eq_u32 vcc, 1, v4
    s_nop 1
    v_cndmask_b32 v165, 0, v6, vcc
    s_cmp_eq_u32 s32, 4
    s_cbranch_scc1 L_pada0
    s_cmp_eq_u32 s32, 5
    s_cbranch_scc1 L_pada1
    s_cmp_eq_u32 s32, 6
    s_cbranch_scc1 L_pada2
    s_cmp_eq_u32 s32, 7
    s_cbranch_scc1 L_pada3
    s_cmp_eq_u32 s32, 8
    s_cbranch_scc1 L_pada4
    s_cmp_eq_u32 s32, 9
    s_cbranch_scc1 L_pada5
    s_cmp_eq_u32 s32, 10
    s_cbranch_scc1 L_pada6
    s_branch L_pada7
L_pada12:
    s_branch L_warmed_a
L_warmed_a:
    s_cmp_lt_u32 s38, 5
    s_cbranch_scc1 L_kvd
    s_waitcnt vmcnt(0)
    v_mov_b32 v4, 1
    s_mov_b64 exec, 1
    ds_add_u32 v3, v4 offset:256
    s_mov_b64 exec, -1
L_kvd:
    s_setprio 2
    s_cmp_lg_u32 s52, 0
    s_cbranch_scc1 L_owner
    s_waitcnt vmcnt(0)
    v_mov_b32 v4, 1
    s_mov_b64 exec, 1
    ds_add_u32 v3, v4 offset:280
    s_mov_b64 exec, -1
    s_cmp_lg_u32 s65, 7
    s_cbranch_scc1 L_cdone
    s_mov_b32 s100, 0
Lw_69:
    ds_read_b32 v4, v3 offset:312
    s_waitcnt lgkmcnt(0)
    v_readfirstlane_b32 s99, v4
    s_cmp_ge_u32 s99, 1
    s_cbranch_scc1 Lwd_70
    s_add_u32 s100, s100, 1
    s_cmp_lt_u32 s100, 1048576
    s_cbranch_scc1 Lw_69
Lwd_70:
    ds_read2_b32 v[48:49], v157 offset0:128 offset1:129
    ds_read2_b32 v[50:51], v157 offset0:130 offset1:131
    ds_read2_b32 v[52:53], v157 offset0:0 offset1:1
    ds_read2_b32 v[54:55], v157 offset0:2 offset1:3
    ds_read2_b32 v[56:57], v156 offset0:128 offset1:129
    ds_read2_b32 v[58:59], v156 offset0:130 offset1:131
    ds_read2_b32 v[60:61], v156 offset0:0 offset1:1
    ds_read2_b32 v[62:63], v156 offset0:2 offset1:3
    ds_read2_b32 v[64:65], v155 offset0:128 offset1:129
    ds_read2_b32 v[66:67], v155 offset0:130 offset1:131
    ds_read2_b32 v[68:69], v155 offset0:0 offset1:1
    ds_read2_b32 v[70:71], v155 offset0:2 offset1:3
    s_waitcnt lgkmcnt(6)
    ds_read2_b32 v[72:73], v154 offset0:128 offset1:129
    ds_read2_b32 v[74:75], v154 offset0:130 offset1:131
    ds_read2_b32 v[76:77], v154 offset0:0 offset1:1
    ds_read2_b32 v[78:79], v154 offset0:2 offset1:3
    s_setprio 3
    v_mov_b32 v5, 1
    s_mov_b32 s100, 0
Lw_71:
    ds_read_b32 v4, v3 offset:280
    s_waitcnt lgkmcnt(0)
    v_readfirstlane_b32 s99, v4
    s_cmp_ge_u32 s99, 8
    s_cbranch_scc1 Lwd_72
    s_add_u32 s100, s100, 1
    s_cmp_lt_u32 s100, 1048576
    s_cbranch_scc1 Lw_71
Lwd_72:
    ds_read_b128 v[80:83], v158 offset:0
    ds_read_b128 v[84:87], v158 offset:512
    ds_read_b128 v[88:91], v158 offset:1024
    ds_read_b128 v[92:95], v158 offset:1536
    ds_read_b128 v[96:99], v158 offset:2048
    ds_read_b128 v[100:103], v158 offset:2560
    ds_read_b128 v[104:107], v158 offset:3072
    ds_read_b128 v[108:111], v158 offset:3584
    s_waitcnt lgkmcnt(0)
    s_setprio 2
    s_branch L_hloop
L_owner:
    v_mov_b32 v44, 0
    v_mov_b32 v45, 0
    v_lshl_add_u32 v5, v0, 3, s68
    ds_write_b64 v5, v[44:45]
    s_mov_b64 exec, 0xffff
    s_mov_b32 s100, 0
L_ep:
    global_atomic_or_x2 v[46:47], v149, v[44:45], s[28:29] sc0 sc1
    s_waitcnt vmcnt(0)
    v_cmp_ne_u32 vcc, s33, v46
    s_cbranch_vccz L_epd
    s_mov_b64 exec, vcc
    s_add_u32 s100, s100, 1
    s_cmp_lt_u32 s100, 1048576
    s_cbranch_scc1 L_ep
L_epd:
    s_mov_b64 exec, -1
    s_setprio 3
    s_mov_b32 s100, 0
    s_add_u32 m0, s68, 512
    s_nop 0
    buffer_load_dwordx4 v8, s[76:79], 0 offen offset:0 sc1 lds
    buffer_load_dwordx4 v8, s[76:79], 0 offen offset:1024 sc1 lds
    buffer_load_dwordx4 v8, s[76:79], 0 offen offset:2048 sc1 lds
    buffer_load_dwordx4 v8, s[76:79], 0 offen offset:3072 sc1 lds
    v_add_u32_dpp v47, v47, v47 row_ror:8 row_mask:0xf bank_mask:0xf
    s_nop 1
    v_add_u32_dpp v47, v47, v47 row_ror:4 row_mask:0xf bank_mask:0xf
    s_nop 1
    v_add_u32_dpp v47, v47, v47 row_ror:2 row_mask:0xf bank_mask:0xf
    s_nop 1
    v_add_u32_dpp v47, v47, v47 row_ror:1 row_mask:0xf bank_mask:0xf
    s_nop 0
    v_readfirstlane_b32 s60, v47
    s_mov_b32 s100, 0
Lw_73:
    ds_read_b32 v4, v162 offset:312
    s_waitcnt lgkmcnt(0)
    v_readfirstlane_b32 s99, v4
    s_cmp_ge_u32 s99, 1
    s_cbranch_scc1 Lwd_74
    s_add_u32 s100, s100, 1
    s_cmp_lt_u32 s100, 1048576
    s_cbranch_scc1 Lw_73
Lwd_74:
    ds_read2_b32 v[48:49], v157 offset0:128 offset1:129
    ds_read2_b32 v[50:51], v157 offset0:130 offset1:131
    ds_read2_b32 v[52:53], v157 offset0:0 offset1:1
    ds_read2_b32 v[54:55], v157 offset0:2 offset1:3
    ds_read2_b32 v[56:57], v156 offset0:128 offset1:129
    ds_read2_b32 v[58:59], v156 offset0:130 offset1:131
    ds_read2_b32 v[60:61], v156 offset0:0 offset1:1
    ds_read2_b32 v[62:63], v156 offset0:2 offset1:3
    ds_read2_b32 v[64:65], v155 offset0:128 offset1:129
    ds_read2_b32 v[66:67], v155 offset0:130 offset1:131
    ds_read2_b32 v[68:69], v155 offset0:0 offset1:1
    ds_read2_b32 v[70:71], v155 offset0:2 offset1:3
    s_waitcnt lgkmcnt(6)
    ds_read2_b32 v[72:73], v154 offset0:128 offset1:129
    ds_read2_b32 v[74:75], v154 offset0:130 offset1:131
    ds_read2_b32 v[76:77], v154 offset0:0 offset1:1
    ds_read2_b32 v[78:79], v154 offset0:2 offset1:3
    v_mov_b64 v[32:33], 0
    v_mov_b64 v[34:35], 0
    v_mov_b64 v[36:37], 0
    v_mov_b64 v[38:39], 0
    v_mov_b64 v[40:41], 0
    v_mov_b64 v[42:43], 0
    v_mov_b64 v[44:45], 0
    v_mov_b64 v[46:47], 0
    s_mov_b32 s100, 0
L_uretry:
    s_waitcnt vmcnt(0) lgkmcnt(0)
    ds_read_b128 v[80:83], v158 offset:0
    ds_read_b128 v[84:87], v158 offset:512
    ds_read_b128 v[88:91], v158 offset:1024
    ds_read_b128 v[92:95], v158 offset:1536
    ds_read_b128 v[96:99], v158 offset:2048
    ds_read_b128 v[100:103], v158 offset:2560
    ds_read_b128 v[104:107], v158 offset:3072
    ds_read_b128 v[108:111], v158 offset:3584
    s_waitcnt lgkmcnt(7)
    v_mfma_f32_16x16x32_bf16 v[16:19], v[48:51], v[80:83], 0
    v_add_u32 v9, v80, v81
    v_add3_u32 v9, v9, v82, v83
    s_waitcnt lgkmcnt(6)
    v_mfma_f32_16x16x32_bf16 v[20:23], v[48:51], v[84:87], 0
    v_add3_u32 v9, v9, v84, v85
    v_mfma_f32_16x16x32_bf16 v[20:23], v[52:55], v[80:83], v[20:23]
    v_add3_u32 v9, v9, v86, v87
    s_waitcnt lgkmcnt(5)
    v_mfma_f32_16x16x32_bf16 v[24:27], v[48:51], v[88:91], 0
    v_add3_u32 v9, v9, v88, v89
    v_mfma_f32_16x16x32_bf16 v[24:27], v[52:55], v[84:87], v[24:27]
    v_add3_u32 v9, v9, v90, v91
    s_waitcnt lgkmcnt(4)
    v_mfma_f32_16x16x32_bf16 v[24:27], v[56:59], v[80:83], v[24:27]
    v_add3_u32 v9, v9, v92, v93
    v_mfma_f32_16x16x32_bf16 v[28:31], v[48:51], v[92:95], 0
    v_add3_u32 v9, v9, v94, v95
    s_waitcnt lgkmcnt(3)
    v_mfma_f32_16x16x32_bf16 v[28:31], v[52:55], v[88:91], v[28:31]
    v_add3_u32 v9, v9, v96, v97
    v_mfma_f32_16x16x32_bf16 v[28:31], v[56:59], v[84:87], v[28:31]
    v_add3_u32 v9, v9, v98, v99
    s_waitcnt lgkmcnt(2)
    v_mfma_f32_16x16x32_bf16 v[28:31], v[60:63], v[80:83], v[28:31]
    v_add3_u32 v9, v9, v100, v101
    v_add3_u32 v9, v9, v102, v103
    s_waitcnt lgkmcnt(1)
    v_add3_u32 v9, v9, v104, v105
    v_add3_u32 v9, v9, v106, v107
    s_waitcnt lgkmcnt(0)
    v_add3_u32 v9, v9, v108, v109
    v_add3_u32 v9, v9, v110, v111
    s_nop 1
    v_add_u32_dpp v9, v9, v9 row_ror:8 row_mask:0xf bank_mask:0xf
    s_nop 1
    v_add_u32_dpp v9, v9, v9 row_ror:4 row_mask:0xf bank_mask:0xf
    s_nop 1
    v_add_u32_dpp v9, v9, v9 row_ror:2 row_mask:0xf bank_mask:0xf
    s_nop 1
    v_add_u32_dpp v9, v9, v9 row_ror:1 row_mask:0xf bank_mask:0xf
    s_nop 0
    v_readlane_b32 s96, v9, 32
    v_readlane_b32 s97, v9, 48
    v_mov_b32 v4, 1
    s_add_u32 s96, s96, s97
    s_cmp_eq_u32 s96, s60
    s_cbranch_scc1 L_uok
    buffer_load_dwordx4 v8, s[76:79], 0 offen offset:0 sc1 lds
    buffer_load_dwordx4 v8, s[76:79], 0 offen offset:1024 sc1 lds
    buffer_load_dwordx4 v8, s[76:79], 0 offen offset:2048 sc1 lds
    buffer_load_dwordx4 v8, s[76:79], 0 offen offset:3072 sc1 lds
    s_add_u32 s100, s100, 1
    s_cmp_lt_u32 s100, 1048576
    s_cbranch_scc1 L_uretry
L_uok:
    s_mov_b64 exec, 1
    ds_add_u32 v3, v4 offset:280
    s_mov_b64 exec, -1
    s_setprio 2
    v_subrev_u32 v154, 64, v154
    v_subrev_u32 v155, 64, v155
    v_subrev_u32 v156, 64, v156
    v_subrev_u32 v157, 64, v157
    v_subrev_u32 v158, 64, v158
    ds_read_b128 v[112:115], v158 offset:0
    ds_read_b128 v[116:119], v158 offset:512
    ds_read_b128 v[120:123], v158 offset:1024
    ds_read_b128 v[124:127], v158 offset:1536
    s_branch L_centry
.p2align 12
L_pada13:
    s_branch L_warmed_a
L_cloop:
    s_setprio 2
    s_cmp_gt_u32 s20, 6
    s_cbranch_scc1 Lcp_75
    s_setprio 1
    s_cmp_gt_u32 s20, 2
    s_cbranch_scc1 Lcp_75
    s_setprio 0
Lcp_75:
    v_subrev_u32 v154, 64, v154
    v_subrev_u32 v155, 64, v155
    v_subrev_u32 v156, 64, v156
    v_subrev_u32 v157, 64, v157
    v_subrev_u32 v158, 64, v158
    s_waitcnt lgkmcnt(14)
    v_mfma_f32_16x16x32_bf16 v[16:19], v[48:51], v[80:83], v[16:19]
    v_mfma_f32_16x16x32_bf16 v[20:23], v[48:51], v[84:87], v[20:23]
    s_waitcnt lgkmcnt(12)
    v_mfma_f32_16x16x32_bf16 v[20:23], v[52:55], v[80:83], v[20:23]
    v_mfma_f32_16x16x32_bf16 v[24:27], v[48:51], v[88:91], v[24:27]
    ds_read_b128 v[112:115], v158 offset:0
    v_mfma_f32_16x16x32_bf16 v[24:27], v[52:55], v[84:87], v[24:27]
    s_waitcnt lgkmcnt(11)
    v_mfma_f32_16x16x32_bf16 v[24:27], v[56:59], v[80:83], v[24:27]
    ds_read_b128 v[116:119], v158 offset:512
    v_mfma_f32_16x16x32_bf16 v[28:31], v[48:51], v[92:95], v[28:31]
    v_mfma_f32_16x16x32_bf16 v[28:31], v[52:55], v[88:91], v[28:31]
    ds_read_b128 v[120:123], v158 offset:1024
    v_mfma_f32_16x16x32_bf16 v[28:31], v[56:59], v[84:87], v[28:31]
    s_waitcnt lgkmcnt(11)
    v_mfma_f32_16x16x32_bf16 v[28:31], v[60:63], v[80:83], v[28:31]
    ds_read_b128 v[124:127], v158 offset:1536
L_centry:
    v_mfma_f32_16x16x32_bf16 v[32:35], v[48:51], v[96:99], v[32:35]
    v_mfma_f32_16x16x32_bf16 v[32:35], v[52:55], v[92:95], v[32:35]
    ds_read_b128 v[128:131], v158 offset:2048
    v_mfma_f32_16x16x32_bf16 v[32:35], v[56:59], v[88:91], v[32:35]
    v_mfma_f32_16x16x32_bf16 v[32:35], v[60:63], v[84:87], v[32:35]
    ds_read_b128 v[132:135], v158 offset:2560
    s_waitcnt lgkmcnt(12)
    v_mfma_f32_16x16x32_bf16 v[32:35], v[64:67], v[80:83], v[32:35]
    v_mfma_f32_16x16x32_bf16 v[36:39], v[48:51], v[100:103], v[36:39]
    ds_read_b128 v[136:139], v158 offset:3072
    v_mfma_f32_16x16x32_bf16 v[36:39], v[52:55], v[96:99], v[36:39]
    v_mfma_f32_16x16x32_bf16 v[36:39], v[56:59], v[92:95], v[36:39]
    ds_read_b128 v[140:143], v158 offset:3584
    v_mfma_f32_16x16x32_bf16 v[36:39], v[60:63], v[88:91], v[36:39]
    v_mfma_f32_16x16x32_bf16 v[36:39], v[64:67], v[84:87], v[36:39]
    s_waitcnt lgkmcnt(12)
    v_mfma_f32_16x16x32_bf16 v[36:39], v[68:71], v[80:83], v[36:39]
    v_mfma_f32_16x16x32_bf16 v[40:43], v[48:51], v[104:107], v[40:43]
    v_mfma_f32_16x16x32_bf16 v[40:43], v[52:55], v[100:103], v[40:43]
    v_mfma_f32_16x16x32_bf16 v[40:43], v[56:59], v[96:99], v[40:43]
    v_mfma_f32_16x16x32_bf16 v[40:43], v[60:63], v[92:95], v[40:43]
    v_mfma_f32_16x16x32_bf16 v[40:43], v[64:67], v[88:91], v[40:43]
    v_mfma_f32_16x16x32_bf16 v[40:43], v[68:71], v[84:87], v[40:43]
    s_waitcnt lgkmcnt(10)
    v_mfma_f32_16x16x32_bf16 v[40:43], v[72:75], v[80:83], v[40:43]
    v_mfma_f32_16x16x32_bf16 v[44:47], v[48:51], v[108:111], v[44:47]
    ds_read2_b32 v[48:49], v157 offset0:128 offset1:129
    ds_read2_b32 v[50:51], v157 offset0:130 offset1:131
    v_mfma_f32_16x16x32_bf16 v[44:47], v[52:55], v[104:107], v[44:47]
    ds_read2_b32 v[52:53], v157 offset0:0 offset1:1
    ds_read2_b32 v[54:55], v157 offset0:2 offset1:3
    v_mfma_f32_16x16x32_bf16 v[44:47], v[56:59], v[100:103], v[44:47]
    s_waitcnt lgkmcnt(12)
    ds_read2_b32 v[56:57], v156 offset0:128 offset1:129
    ds_read2_b32 v[58:59], v156 offset0:130 offset1:131
    v_mfma_f32_16x16x32_bf16 v[44:47], v[60:63], v[96:99], v[44:47]
    s_waitcnt lgkmcnt(12)
    ds_read2_b32 v[60:61], v156 offset0:0 offset1:1
    ds_read2_b32 v[62:63], v156 offset0:2 offset1:3
    v_mfma_f32_16x16x32_bf16 v[44:47], v[64:67], v[92:95], v[44:47]
    s_waitcnt lgkmcnt(12)
    ds_read2_b32 v[64:65], v155 offset0:128 offset1:129
    ds_read2_b32 v[66:67], v155 offset0:130 offset1:131
    v_mfma_f32_16x16x32_bf16 v[44:47], v[68:71], v[88:91], v[44:47]
    s_waitcnt lgkmcnt(12)
    ds_read2_b32 v[68:69], v155 offset0:0 offset1:1
    ds_read2_b32 v[70:71], v155 offset0:2 offset1:3
    v_mfma_f32_16x16x32_bf16 v[44:47], v[72:75], v[84:87], v[44:47]
    s_waitcnt lgkmcnt(12)
    ds_read2_b32 v[72:73], v154 offset0:128 offset1:129
    ds_read2_b32 v[74:75], v154 offset0:130 offset1:131
    v_mfma_f32_16x16x32_bf16 v[44:47], v[76:79], v[80:83], v[44:47]
    s_waitcnt lgkmcnt(12)
    ds_read2_b32 v[76:77], v154 offset0:0 offset1:1
    ds_read2_b32 v[78:79], v154 offset0:2 offset1:3
    v_subrev_u32 v154, 64, v154
    v_subrev_u32 v155, 64, v155
    v_subrev_u32 v156, 64, v156
    v_subrev_u32 v157, 64, v157
    v_subrev_u32 v158, 64, v158
    v_mfma_f32_16x16x32_bf16 v[16:19], v[48:51], v[112:115], v[16:19]
    v_mfma_f32_16x16x32_bf16 v[20:23], v[48:51], v[116:119], v[20:23]
    s_waitcnt lgkmcnt(12)
    v_mfma_f32_16x16x32_bf16 v[20:23], v[52:55], v[112:115], v[20:23]
    v_mfma_f32_16x16x32_bf16 v[24:27], v[48:51], v[120:123], v[24:27]
    ds_read_b128 v[80:83], v158 offset:0
    v_mfma_f32_16x16x32_bf16 v[24:27], v[52:55], v[116:119], v[24:27]
    s_waitcnt lgkmcnt(11)
    v_mfma_f32_16x16x32_bf16 v[24:27], v[56:59], v[112:115], v[24:27]
    ds_read_b128 v[84:87], v158 offset:512
    v_mfma_f32_16x16x32_bf16 v[28:31], v[48:51], v[124:127], v[28:31]
    v_mfma_f32_16x16x32_bf16 v[28:31], v[52:55], v[120:123], v[28:31]
    ds_read_b128 v[88:91], v158 offset:1024
    v_mfma_f32_16x16x32_bf16 v[28:31], v[56:59], v[116:119], v[28:31]
    s_waitcnt lgkmcnt(11)
    v_mfma_f32_16x16x32_bf16 v[28:31], v[60:63], v[112:115], v[28:31]
    ds_read_b128 v[92:95], v158 offset:1536
    v_mfma_f32_16x16x32_bf16 v[32:35], v[48:51], v[128:131], v[32:35]
    v_mfma_f32_16x16x32_bf16 v[32:35], v[52:55], v[124:127], v[32:35]
    ds_read_b128 v[96:99], v158 offset:2048
    v_mfma_f32_16x16x32_bf16 v[32:35], v[56:59], v[120:123], v[32:35]
    v_mfma_f32_16x16x32_bf16 v[32:35], v[60:63], v[116:119], v[32:35]
    ds_read_b128 v[100:103], v158 offset:2560
    s_waitcnt lgkmcnt(12)
    v_mfma_f32_16x16x32_bf16 v[32:35], v[64:67], v[112:115], v[32:35]
    v_mfma_f32_16x16x32_bf16 v[36:39], v[48:51], v[132:135], v[36:39]
    ds_read_b128 v[104:107], v158 offset:3072
    v_mfma_f32_16x16x32_bf16 v[36:39], v[52:55], v[128:131], v[36:39]
    v_mfma_f32_16x16x32_bf16 v[36:39], v[56:59], v[124:127], v[36:39]
    ds_read_b128 v[108:111], v158 offset:3584
    v_mfma_f32_16x16x32_bf16 v[36:39], v[60:63], v[120:123], v[36:39]
    v_mfma_f32_16x16x32_bf16 v[36:39], v[64:67], v[116:119], v[36:39]
    s_waitcnt lgkmcnt(12)
    v_mfma_f32_16x16x32_bf16 v[36:39], v[68:71], v[112:115], v[36:39]
    v_mfma_f32_16x16x32_bf16 v[40:43], v[48:51], v[136:139], v[40:43]
    v_mfma_f32_16x16x32_bf16 v[40:43], v[52:55], v[132:135], v[40:43]
    v_mfma_f32_16x16x32_bf16 v[40:43], v[56:59], v[128:131], v[40:43]
    v_mfma_f32_16x16x32_bf16 v[40:43], v[60:63], v[124:127], v[40:43]
    v_mfma_f32_16x16x32_bf16 v[40:43], v[64:67], v[120:123], v[40:43]
    v_mfma_f32_16x16x32_bf16 v[40:43], v[68:71], v[116:119], v[40:43]
    s_waitcnt lgkmcnt(10)
    v_mfma_f32_16x16x32_bf16 v[40:43], v[72:75], v[112:115], v[40:43]
    v_mfma_f32_16x16x32_bf16 v[44:47], v[48:51], v[140:143], v[44:47]
    ds_read2_b32 v[48:49], v157 offset0:128 offset1:129
    ds_read2_b32 v[50:51], v157 offset0:130 offset1:131
    v_mfma_f32_16x16x32_bf16 v[44:47], v[52:55], v[136:139], v[44:47]
    ds_read2_b32 v[52:53], v157 offset0:0 offset1:1
    ds_read2_b32 v[54:55], v157 offset0:2 offset1:3
    v_mfma_f32_16x16x32_bf16 v[44:47], v[56:59], v[132:135], v[44:47]
    s_waitcnt lgkmcnt(12)
    ds_read2_b32 v[56:57], v156 offset0:128 offset1:129
    ds_read2_b32 v[58:59], v156 offset0:130 offset1:131
    v_mfma_f32_16x16x32_bf16 v[44:47], v[60:63], v[128:131], v[44:47]
    s_waitcnt lgkmcnt(12)
    ds_read2_b32 v[60:61], v156 offset0:0 offset1:1
    ds_read2_b32 v[62:63], v156 offset0:2 offset1:3
    v_mfma_f32_16x16x32_bf16 v[44:47], v[64:67], v[124:127], v[44:47]
    s_waitcnt lgkmcnt(12)
    ds_read2_b32 v[64:65], v155 offset0:128 offset1:129
    ds_read2_b32 v[66:67], v155 offset0:130 offset1:131
    v_mfma_f32_16x16x32_bf16 v[44:47], v[68:71], v[120:123], v[44:47]
    s_waitcnt lgkmcnt(12)
    ds_read2_b32 v[68:69], v155 offset0:0 offset1:1
    ds_read2_b32 v[70:71], v155 offset0:2 offset1:3
    v_mfma_f32_16x16x32_bf16 v[44:47], v[72:75], v[116:119], v[44:47]
    s_waitcnt lgkmcnt(12)
    ds_read2_b32 v[72:73], v154 offset0:128 offset1:129
    ds_read2_b32 v[74:75], v154 offset0:130 offset1:131
    v_mfma_f32_16x16x32_bf16 v[44:47], v[76:79], v[112:115], v[44:47]
    s_waitcnt lgkmcnt(12)
    ds_read2_b32 v[76:77], v154 offset0:0 offset1:1
    ds_read2_b32 v[78:79], v154 offset0:2 offset1:3
    s_sub_u32 s20, s20, 2
    s_cmp_lg_u32 s20, 1
    s_cbranch_scc1 L_cloop
L_cexit:
    s_setprio 0
    v_subrev_u32 v156, 64, v156
    v_subrev_u32 v157, 64, v157
    v_subrev_u32 v158, 64, v158
    s_mov_b32 s100, 0
Lw_76:
    ds_read_b32 v4, v162 offset:284
    s_waitcnt lgkmcnt(0)
    v_readfirstlane_b32 s99, v4
    s_cmp_ge_u32 s99, 1
    s_cbranch_scc1 Lwd_77
    s_add_u32 s100, s100, 1
    s_cmp_lt_u32 s100, 1048576
    s_cbranch_scc1 Lw_76
Lwd_77:
    ds_read_b128 v[144:147], v161 offset:2048
    ds_read_b128 v[148:151], v161 offset:3072
    ds_read_b128 v[112:115], v158 offset:0
    ds_read2_b32 v[128:129], v157 offset0:128 offset1:129
    ds_read2_b32 v[130:131], v157 offset0:130 offset1:131
    ds_read_b128 v[116:119], v158 offset:512
    ds_read2_b32 v[132:133], v157 offset0:0 offset1:1
    ds_read2_b32 v[134:135], v157 offset0:2 offset1:3
    ds_read_b128 v[120:123], v158 offset:1024
    ds_read2_b32 v[136:137], v156 offset0:128 offset1:129
    ds_read2_b32 v[138:139], v156 offset0:130 offset1:131
    ds_read_b128 v[124:127], v158 offset:1536
    ds_read2_b32 v[140:141], v156 offset0:0 offset1:1
    ds_read2_b32 v[142:143], v156 offset0:2 offset1:3
    s_mov_b32 s62, 0x11111111
    s_mov_b32 s63, 0x11111111
    v_mfma_f32_16x16x32_bf16 v[32:35], v[48:51], v[96:99], v[32:35]
    v_mfma_f32_16x16x32_bf16 v[32:35], v[52:55], v[92:95], v[32:35]
    v_mfma_f32_16x16x32_bf16 v[32:35], v[56:59], v[88:91], v[32:35]
    v_mfma_f32_16x16x32_bf16 v[32:35], v[60:63], v[84:87], v[32:35]
    v_mfma_f32_16x16x32_bf16 v[32:35], v[64:67], v[80:83], v[32:35]
    v_mfma_f32_16x16x32_bf16 v[36:39], v[48:51], v[100:103], v[36:39]
    v_mfma_f32_16x16x32_bf16 v[36:39], v[52:55], v[96:99], v[36:39]
    v_mfma_f32_16x16x32_bf16 v[36:39], v[56:59], v[92:95], v[36:39]
    v_mfma_f32_16x16x32_bf16 v[36:39], v[60:63], v[88:91], v[36:39]
    v_mfma_f32_16x16x32_bf16 v[36:39], v[64:67], v[84:87], v[36:39]
    v_mfma_f32_16x16x32_bf16 v[36:39], v[68:71], v[80:83], v[36:39]
    s_waitcnt lgkmcnt(12)
    v_mfma_f32_16x16x16_bf16 v[32:35], v[164:165], v[144:145], v[32:35]
    v_mfma_f32_16x16x16_bf16 v[40:43], v[164:165], v[148:149], v[40:43]
    v_mfma_f32_16x16x16_bf16 v[44:47], v[164:165], v[150:151], v[44:47]
    s_nop 1
    v_mfma_f32_16x16x16_bf16 v[36:39], v[164:165], v[146:147], v[36:39]
    s_waitcnt lgkmcnt(0)
    v_mfma_f32_16x16x32_bf16 v[16:19], v[48:51], v[80:83], v[16:19]
    v_mfma_f32_16x16x32_bf16 v[16:19], v[128:131], v[112:115], v[16:19]
    v_mov_b32 v4, 1
    s_mov_b64 exec, 1
    ds_add_u32 v3, v4 offset:264
    s_mov_b64 exec, -1
    v_mfma_f32_16x16x32_bf16 v[20:23], v[48:51], v[84:87], v[20:23]
    v_cvt_pk_bf16_f32 v8, v32, v33
    v_cvt_pk_bf16_f32 v9, v34, v35
    v_mfma_f32_16x16x32_bf16 v[20:23], v[52:55], v[80:83], v[20:23]
    v_mfma_f32_16x16x32_bf16 v[20:23], v[128:131], v[116:119], v[20:23]
    v_cvt_pk_bf16_f32 v10, v36, v37
    v_cvt_pk_bf16_f32 v11, v38, v39
    v_mfma_f32_16x16x32_bf16 v[20:23], v[132:135], v[112:115], v[20:23]
    v_mfma_f32_16x16x32_bf16 v[24:27], v[48:51], v[88:91], v[24:27]
    v_permlane16_swap_b32 v8, v10
    v_permlane16_swap_b32 v9, v11
    v_mfma_f32_16x16x32_bf16 v[24:27], v[52:55], v[84:87], v[24:27]
    global_store_dwordx4 v153, v[8:11], s[28:29] offset:2048 sc1
    v_add_u32 v6, v8, v9
    v_mfma_f32_16x16x32_bf16 v[24:27], v[56:59], v[80:83], v[24:27]
    v_add3_u32 v6, v6, v10, v11
    v_mfma_f32_16x16x32_bf16 v[24:27], v[128:131], v[120:123], v[24:27]
    v_mfma_f32_16x16x32_bf16 v[24:27], v[132:135], v[116:119], v[24:27]
    v_add_u32_dpp v6, v6, v6 quad_perm:[1,0,3,2] row_mask:0xf bank_mask:0xf
    v_mfma_f32_16x16x32_bf16 v[24:27], v[136:139], v[112:115], v[24:27]
    v_mfma_f32_16x16x32_bf16 v[28:31], v[48:51], v[92:95], v[28:31]
    v_add_u32_dpp v6, v6, v6 quad_perm:[2,3,0,1] row_mask:0xf bank_mask:0xf
    s_mov_b64 exec, s[62:63]
    ds_add_u32 v152, v6 offset:64
    s_mov_b64 exec, -1
    v_mfma_f32_16x16x32_bf16 v[28:31], v[52:55], v[88:91], v[28:31]
    v_cvt_pk_bf16_f32 v12, v16, v17
    v_cvt_pk_bf16_f32 v13, v18, v19
    v_mfma_f32_16x16x32_bf16 v[28:31], v[56:59], v[84:87], v[28:31]
    v_cvt_pk_bf16_f32 v14, v20, v21
    v_cvt_pk_bf16_f32 v15, v22, v23
    v_mfma_f32_16x16x32_bf16 v[28:31], v[60:63], v[80:83], v[28:31]
    v_mfma_f32_16x16x32_bf16 v[28:31], v[128:131], v[124:127], v[28:31]
    v_permlane16_swap_b32 v12, v14
    v_permlane16_swap_b32 v13, v15
    v_mfma_f32_16x16x32_bf16 v[28:31], v[132:135], v[120:123], v[28:31]
    global_store_dwordx4 v153, v[12:15], s[28:29] offset:0 sc1
    v_add_u32 v6, v12, v13
    v_mfma_f32_16x16x32_bf16 v[28:31], v[136:139], v[116:119], v[28:31]
    v_add3_u32 v6, v6, v14, v15
    v_mfma_f32_16x16x32_bf16 v[28:31], v[140:143], v[112:115], v[28:31]
    s_setprio 3
    v_mfma_f32_16x16x32_bf16 v[40:43], v[48:51], v[104:107], v[40:43]
    v_add_u32_dpp v6, v6, v6 quad_perm:[1,0,3,2] row_mask:0xf bank_mask:0xf
    v_mfma_f32_16x16x32_bf16 v[40:43], v[52:55], v[100:103], v[40:43]
    v_mfma_f32_16x16x32_bf16 v[40:43], v[56:59], v[96:99], v[40:43]
    v_add_u32_dpp v6, v6, v6 quad_perm:[2,3,0,1] row_mask:0xf bank_mask:0xf
    s_mov_b64 exec, s[62:63]
    ds_add_u32 v152, v6 offset:0
    s_mov_b64 exec, -1
    v_mfma_f32_16x16x32_bf16 v[40:43], v[60:63], v[92:95], v[40:43]
    v_cvt_pk_bf16_f32 v8, v24, v25
    v_cvt_pk_bf16_f32 v9, v26, v27
    v_mfma_f32_16x16x32_bf16 v[40:43], v[64:67], v[88:91], v[40:43]
    v_cvt_pk_bf16_f32 v10, v28, v29
    v_cvt_pk_bf16_f32 v11, v30, v31
    v_mfma_f32_16x16x32_bf16 v[40:43], v[68:71], v[84:87], v[40:43]
    v_mfma_f32_16x16x32_bf16 v[40:43], v[72:75], v[80:83], v[40:43]
    v_permlane16_swap_b32 v8, v10
    v_permlane16_swap_b32 v9, v11
    v_mfma_f32_16x16x32_bf16 v[44:47], v[48:51], v[108:111], v[44:47]
    global_store_dwordx4 v153, v[8:11], s[28:29] offset:1024 sc1
    v_add_u32 v6, v8, v9
    v_mfma_f32_16x16x32_bf16 v[44:47], v[52:55], v[104:107], v[44:47]
    v_add3_u32 v6, v6, v10, v11
    v_mfma_f32_16x16x32_bf16 v[44:47], v[56:59], v[100:103], v[44:47]
    v_mfma_f32_16x16x32_bf16 v[44:47], v[60:63], v[96:99], v[44:47]
    v_add_u32_dpp v6, v6, v6 quad_perm:[1,0,3,2] row_mask:0xf bank_mask:0xf
    v_mfma_f32_16x16x32_bf16 v[44:47], v[64:67], v[92:95], v[44:47]
    v_mfma_f32_16x16x32_bf16 v[44:47], v[68:71], v[88:91], v[44:47]
    v_add_u32_dpp v6, v6, v6 quad_perm:[2,3,0,1] row_mask:0xf bank_mask:0xf
    s_mov_b64 exec, s[62:63]
    ds_add_u32 v152, v6 offset:32
    s_mov_b64 exec, -1
    v_mfma_f32_16x16x32_bf16 v[44:47], v[72:75], v[84:87], v[44:47]
    v_mfma_f32_16x16x32_bf16 v[44:47], v[76:79], v[80:83], v[44:47]
    s_setprio 3
    v_cvt_pk_bf16_f32 v12, v40, v41
    v_cvt_pk_bf16_f32 v13, v42, v43
    s_nop 4
    v_cvt_pk_bf16_f32 v14, v44, v45
    v_cvt_pk_bf16_f32 v15, v46, v47
    s_nop 0
    v_permlane16_swap_b32 v12, v14
    v_permlane16_swap_b32 v13, v15
    global_store_dwordx4 v153, v[12:15], s[28:29] offset:3072 sc1
    v_add_u32 v6, v12, v13
    v_add3_u32 v6, v6, v14, v15
    s_nop 1
    v_add_u32_dpp v6, v6, v6 quad_perm:[1,0,3,2] row_mask:0xf bank_mask:0xf
    s_nop 1
    v_add_u32_dpp v6, v6, v6 quad_perm:[2,3,0,1] row_mask:0xf bank_mask:0xf
    s_mov_b64 exec, s[62:63]
    ds_add_u32 v152, v6 offset:96
    s_mov_b64 exec, -1
    v_mov_b32 v4, 1
    s_mov_b64 exec, 1
    ds_add_u32 v3, v4 offset:196
    ds_add_rtn_u32 v4, v3, v4 offset:252
    s_mov_b64 exec, -1
    v_lshlrev_b32 v5, 2, v0
    v_add_u32 v5, 161792, v5
    ds_read_b32 v30, v5
    v_mov_b32 v31, 0x100
    s_waitcnt lgkmcnt(0)
    v_readfirstlane_b32 s98, v4
    s_add_u32 s98, s98, 1
    s_cmp_lg_u32 s98, s64
    s_cbranch_scc1 L_ynf
    s_mov_b64 exec, 0xffffffff
    global_atomic_add_x2 v[158:159], v160, v[30:31], s[28:29] sc0 sc1
    s_mov_b64 exec, -1
    s_mov_b32 s101, -1
L_ynf:
    s_branch L_cjoin
.p2align 12
L_pada14:
    s_branch L_warmed_a
L_hloop:
    v_add_u32 v154, 8320, v154
    v_add_u32 v155, 8320, v155
    v_add_u32 v156, 8320, v156
    v_add_u32 v157, 8320, v157
    v_add_u32 v158, 4608, v158
    s_waitcnt lgkmcnt(15)
    v_mfma_f32_16x16x32_bf16 v[32:35], v[48:51], v[96:99], 0
    s_waitcnt lgkmcnt(14)
    v_mfma_f32_16x16x32_bf16 v[32:35], v[52:55], v[92:95], v[32:35]
    s_waitcnt lgkmcnt(12)
    ds_read_b128 v[112:115], v158 offset:0
    v_mfma_f32_16x16x32_bf16 v[32:35], v[56:59], v[88:91], v[32:35]
    s_waitcnt lgkmcnt(11)
    v_mfma_f32_16x16x32_bf16 v[32:35], v[60:63], v[84:87], v[32:35]
    ds_read_b128 v[116:119], v158 offset:512
    s_waitcnt lgkmcnt(10)
    v_mfma_f32_16x16x32_bf16 v[32:35], v[64:67], v[80:83], v[32:35]
    v_mfma_f32_16x16x32_bf16 v[36:39], v[48:51], v[100:103], 0
    ds_read_b128 v[120:123], v158 offset:1024
    v_mfma_f32_16x16x32_bf16 v[36:39], v[52:55], v[96:99], v[36:39]
    v_mfma_f32_16x16x32_bf16 v[36:39], v[56:59], v[92:95], v[36:39]
    ds_read_b128 v[124:127], v158 offset:1536
    v_mfma_f32_16x16x32_bf16 v[36:39], v[60:63], v[88:91], v[36:39]
    v_mfma_f32_16x16x32_bf16 v[36:39], v[64:67], v[84:87], v[36:39]
    ds_read_b128 v[128:131], v158 offset:2048
    s_waitcnt lgkmcnt(11)
    v_mfma_f32_16x16x32_bf16 v[36:39], v[68:71], v[80:83], v[36:39]
    v_mfma_f32_16x16x32_bf16 v[40:43], v[48:51], v[104:107], 0
    ds_read_b128 v[132:135], v158 offset:2560
    v_mfma_f32_16x16x32_bf16 v[40:43], v[52:55], v[100:103], v[40:43]
    v_mfma_f32_16x16x32_bf16 v[40:43], v[56:59], v[96:99], v[40:43]
    ds_read_b128 v[136:139], v158 offset:3072
    v_cvt_pk_bf16_f32 v8, v32, v33
    v_cvt_pk_bf16_f32 v9, v34, v35
    v_mfma_f32_16x16x32_bf16 v[40:43], v[60:63], v[92:95], v[40:43]
    v_cvt_pk_bf16_f32 v10, v36, v37
    v_cvt_pk_bf16_f32 v11, v38, v39
    v_mfma_f32_16x16x32_bf16 v[40:43], v[64:67], v[88:91], v[40:43]
    ds_read_b128 v[140:143], v158 offset:3584
    s_waitcnt lgkmcnt(12)
    ds_write_b128 v161, v[8:11] offset:2048
    v_mfma_f32_16x16x32_bf16 v[40:43], v[68:71], v[84:87], v[40:43]
    v_mfma_f32_16x16x32_bf16 v[40:43], v[72:75], v[80:83], v[40:43]
    v_mfma_f32_16x16x32_bf16 v[44:47], v[48:51], v[108:111], 0
    ds_read2_b32 v[48:49], v157 offset0:128 offset1:129
    s_waitcnt lgkmcnt(12)
    ds_read2_b32 v[50:51], v157 offset0:130 offset1:131
    v_mfma_f32_16x16x32_bf16 v[44:47], v[52:55], v[104:107], v[44:47]
    ds_read2_b32 v[52:53], v157 offset0:0 offset1:1
    s_waitcnt lgkmcnt(12)
    ds_read2_b32 v[54:55], v157 offset0:2 offset1:3
    v_mfma_f32_16x16x32_bf16 v[44:47], v[56:59], v[100:103], v[44:47]
    ds_read2_b32 v[56:57], v156 offset0:128 offset1:129
    s_waitcnt lgkmcnt(12)
    ds_read2_b32 v[58:59], v156 offset0:130 offset1:131
    v_mfma_f32_16x16x32_bf16 v[44:47], v[60:63], v[96:99], v[44:47]
    ds_read2_b32 v[60:61], v156 offset0:0 offset1:1
    s_waitcnt lgkmcnt(12)
    ds_read2_b32 v[62:63], v156 offset0:2 offset1:3
    v_mfma_f32_16x16x32_bf16 v[44:47], v[64:67], v[92:95], v[44:47]
    ds_read2_b32 v[64:65], v155 offset0:128 offset1:129
    s_waitcnt lgkmcnt(12)
    ds_read2_b32 v[66:67], v155 offset0:130 offset1:131
    v_mfma_f32_16x16x32_bf16 v[44:47], v[68:71], v[88:91], v[44:47]
    ds_read2_b32 v[68:69], v155 offset0:0 offset1:1
    s_waitcnt lgkmcnt(12)
    ds_read2_b32 v[70:71], v155 offset0:2 offset1:3
    v_mfma_f32_16x16x32_bf16 v[44:47], v[72:75], v[84:87], v[44:47]
    ds_read2_b32 v[72:73], v154 offset0:128 offset1:129
    s_waitcnt lgkmcnt(12)
    ds_read2_b32 v[74:75], v154 offset0:130 offset1:131
    v_mfma_f32_16x16x32_bf16 v[44:47], v[76:79], v[80:83], v[44:47]
    ds_read2_b32 v[76:77], v154 offset0:0 offset1:1
    s_waitcnt lgkmcnt(12)
    ds_read2_b32 v[78:79], v154 offset0:2 offset1:3
    v_cvt_pk_bf16_f32 v12, v40, v41
    v_cvt_pk_bf16_f32 v13, v42, v43
    s_nop 2
    v_cvt_pk_bf16_f32 v14, v44, v45
    v_cvt_pk_bf16_f32 v15, v46, v47
    ds_write_b128 v161, v[12:15] offset:3072
    s_waitcnt lgkmcnt(12)
    ds_write_b32 v162, v5 offset:284
    v_add_u32 v161, 2048, v161
    v_add_u32 v162, 4, v162
    s_sub_u32 s20, s20, 1
    s_cmp_eq_u32 s20, 0
    s_cbranch_scc1 L_hexit
    v_add_u32 v154, 8320, v154
    v_add_u32 v155, 8320, v155
    v_add_u32 v156, 8320, v156
    v_add_u32 v157, 8320, v157
    v_add_u32 v158, 4608, v158
    v_mfma_f32_16x16x32_bf16 v[32:35], v[48:51], v[128:131], 0
    v_mfma_f32_16x16x32_bf16 v[32:35], v[52:55], v[124:127], v[32:35]
    ds_read_b128 v[80:83], v158 offset:0
    s_waitcnt lgkmcnt(13)
    v_mfma_f32_16x16x32_bf16 v[32:35], v[56:59], v[120:123], v[32:35]
    s_waitcnt lgkmcnt(11)
    v_mfma_f32_16x16x32_bf16 v[32:35], v[60:63], v[116:119], v[32:35]
    ds_read_b128 v[84:87], v158 offset:512
    s_waitcnt lgkmcnt(10)
    v_mfma_f32_16x16x32_bf16 v[32:35], v[64:67], v[112:115], v[32:35]
    v_mfma_f32_16x16x32_bf16 v[36:39], v[48:51], v[132:135], 0
    ds_read_b128 v[88:91], v158 offset:1024
    v_mfma_f32_16x16x32_bf16 v[36:39], v[52:55], v[128:131], v[36:39]
    v_mfma_f32_16x16x32_bf16 v[36:39], v[56:59], v[124:127], v[36:39]
    ds_read_b128 v[92:95], v158 offset:1536
    v_mfma_f32_16x16x32_bf16 v[36:39], v[60:63], v[120:123], v[36:39]
    v_mfma_f32_16x16x32_bf16 v[36:39], v[64:67], v[116:119], v[36:39]
    ds_read_b128 v[96:99], v158 offset:2048
    s_waitcnt lgkmcnt(11)
    v_mfma_f32_16x16x32_bf16 v[36:39], v[68:71], v[112:115], v[36:39]
    v_mfma_f32_16x16x32_bf16 v[40:43], v[48:51], v[136:139], 0
    ds_read_b128 v[100:103], v158 offset:2560
    v_mfma_f32_16x16x32_bf16 v[40:43], v[52:55], v[132:135], v[40:43]
    v_mfma_f32_16x16x32_bf16 v[40:43], v[56:59], v[128:131], v[40:43]
    ds_read_b128 v[104:107], v158 offset:3072
    v_cvt_pk_bf16_f32 v8, v32, v33
    v_cvt_pk_bf16_f32 v9, v34, v35
    v_mfma_f32_16x16x32_bf16 v[40:43], v[60:63], v[124:127], v[40:43]
    v_cvt_pk_bf16_f32 v10, v36, v37
    v_cvt_pk_bf16_f32 v11, v38, v39
    v_mfma_f32_16x16x32_bf16 v[40:43], v[64:67], v[120:123], v[40:43]
    ds_read_b128 v[108:111], v158 offset:3584
    s_waitcnt lgkmcnt(12)
    ds_write_b128 v161, v[8:11] offset:2048
    v_mfma_f32_16x16x32_bf16 v[40:43], v[68:71], v[116:119], v[40:43]
    v_mfma_f32_16x16x32_bf16 v[40:43], v[72:75], v[112:115], v[40:43]
    v_mfma_f32_16x16x32_bf16 v[44:47], v[48:51], v[140:143], 0
    ds_read2_b32 v[48:49], v157 offset0:128 offset1:129
    s_waitcnt lgkmcnt(12)
    ds_read2_b32 v[50:51], v157 offset0:130 offset1:131
    v_mfma_f32_16x16x32_bf16 v[44:47], v[52:55], v[136:139], v[44:47]
    ds_read2_b32 v[52:53], v157 offset0:0 offset1:1
    s_waitcnt lgkmcnt(12)
    ds_read2_b32 v[54:55], v157 offset0:2 offset1:3
    v_mfma_f32_16x16x32_bf16 v[44:47], v[56:59], v[132:135], v[44:47]
    ds_read2_b32 v[56:57], v156 offset0:128 offset1:129
    s_waitcnt lgkmcnt(12)
    ds_read2_b32 v[58:59], v156 offset0:130 offset1:131
    v_mfma_f32_16x16x32_bf16 v[44:47], v[60:63], v[128:131], v[44:47]
    ds_read2_b32 v[60:61], v156 offset0:0 offset1:1
    s_waitcnt lgkmcnt(12)
    ds_read2_b32 v[62:63], v156 offset0:2 offset1:3
    v_mfma_f32_16x16x32_bf16 v[44:47], v[64:67], v[124:127], v[44:47]
    ds_read2_b32 v[64:65], v155 offset0:128 offset1:129
    s_waitcnt lgkmcnt(12)
    ds_read2_b32 v[66:67], v155 offset0:130 offset1:131
    v_mfma_f32_16x16x32_bf16 v[44:47], v[68:71], v[120:123], v[44:47]
    ds_read2_b32 v[68:69], v155 offset0:0 offset1:1
    s_waitcnt lgkmcnt(12)
    ds_read2_b32 v[70:71], v155 offset0:2 offset1:3
    v_mfma_f32_16x16x32_bf16 v[44:47], v[72:75], v[116:119], v[44:47]
    ds_read2_b32 v[72:73], v154 offset0:128 offset1:129
    s_waitcnt lgkmcnt(12)
    ds_read2_b32 v[74:75], v154 offset0:130 offset1:131
    v_mfma_f32_16x16x32_bf16 v[44:47], v[76:79], v[112:115], v[44:47]
    ds_read2_b32 v[76:77], v154 offset0:0 offset1:1
    s_waitcnt lgkmcnt(12)
    ds_read2_b32 v[78:79], v154 offset0:2 offset1:3
    v_cvt_pk_bf16_f32 v12, v40, v41
    v_cvt_pk_bf16_f32 v13, v42, v43
    s_nop 2
    v_cvt_pk_bf16_f32 v14, v44, v45
    v_cvt_pk_bf16_f32 v15, v46, v47
    ds_write_b128 v161, v[12:15] offset:3072
    s_waitcnt lgkmcnt(12)
    ds_write_b32 v162, v5 offset:284
    v_add_u32 v161, 2048, v161
    v_add_u32 v162, 4, v162
    s_sub_u32 s20, s20, 1
    s_cmp_eq_u32 s20, 0
    s_cbranch_scc0 L_hloop
L_hexit:
    s_waitcnt lgkmcnt(0)
    v_mov_b32 v4, 1
    s_mov_b64 exec, 1
    ds_add_u32 v3, v4 offset:196
    s_mov_b64 exec, -1
    s_setprio 0
    s_mul_i32 s96, s36, 102400
    s_add_u32 s96, s96, 9437184
    s_add_u32 s48, s28, s96
    s_addc_u32 s49, s29, 0
    s_and_b32 s49, s49, 0xffff
    s_mov_b32 s50, 102400
    s_mov_b32 s51, 0x00020000
    v_lshlrev_b32 v19, 4, v0
    s_mov_b32 s59, 83968
    v_add_u32 v20, 91136, v19
    s_mov_b32 s100, 0
Lw_78:
    ds_read_b32 v4, v3 offset:192
    s_waitcnt lgkmcnt(0)
    v_readfirstlane_b32 s99, v4
    s_cmp_ge_u32 s99, 1
    s_cbranch_scc1 Lwd_79
    s_sleep 4
    s_add_u32 s100, s100, 1
    s_cmp_lt_u32 s100, 1048576
    s_cbranch_scc1 Lw_78
Lwd_79:
    buffer_load_dwordx4 v[24:27], v19, s[48:51], s59 offen offset:0 sc1
    buffer_load_dwordx4 v[28:31], v19, s[48:51], s59 offen offset:1024 sc1
    buffer_load_dwordx4 v[32:35], v19, s[48:51], s59 offen offset:2048 sc1
    buffer_load_dwordx4 v[36:39], v19, s[48:51], s59 offen offset:3072 sc1
    s_addk_i32 s59, 4096
    buffer_load_dwordx4 v[40:43], v19, s[48:51], s59 offen offset:0 sc1
    buffer_load_dwordx4 v[44:47], v19, s[48:51], s59 offen offset:1024 sc1
    buffer_load_dwordx4 v[48:51], v19, s[48:51], s59 offen offset:2048 sc1
    buffer_load_dwordx4 v[52:55], v19, s[48:51], s59 offen offset:3072 sc1
    s_addk_i32 s59, 4096
    buffer_load_dwordx4 v[56:59], v19, s[48:51], s59 offen offset:0 sc1
    buffer_load_dwordx4 v[60:63], v19, s[48:51], s59 offen offset:1024 sc1
    buffer_load_dwordx4 v[64:67], v19, s[48:51], s59 offen offset:2048 sc1
    buffer_load_dwordx4 v[68:71], v19, s[48:51], s59 offen offset:3072 sc1
    s_addk_i32 s59, 4096
    buffer_load_dwordx4 v[72:75], v19, s[48:51], s59 offen offset:0 sc1
    buffer_load_dwordx4 v[76:79], v19, s[48:51], s59 offen offset:1024 sc1
    buffer_load_dwordx4 v[80:83], v19, s[48:51], s59 offen offset:2048 sc1
    buffer_load_dwordx4 v[84:87], v19, s[48:51], s59 offen offset:3072 sc1
    s_addk_i32 s59, 4096
    buffer_load_dwordx4 v[88:91], v19, s[48:51], s59 offen offset:0 sc1
    buffer_load_dwordx4 v[92:95], v19, s[48:51], s59 offen offset:1024 sc1
    s_waitcnt vmcnt(0)
    s_mov_b32 s100, 0
Lw_80:
    ds_read_b32 v4, v3 offset:264
    s_waitcnt lgkmcnt(0)
    v_readfirstlane_b32 s99, v4
    s_cmp_ge_u32 s99, s64
    s_cbranch_scc1 Lwd_81
    s_sleep 2
    s_add_u32 s100, s100, 1
    s_cmp_lt_u32 s100, 1048576
    s_cbranch_scc1 Lw_80
Lwd_81:
    ds_write_b128 v20, v[24:27] offset:0
    ds_write_b128 v20, v[28:31] offset:1024
    ds_write_b128 v20, v[32:35] offset:2048
    ds_write_b128 v20, v[36:39] offset:3072
    s_waitcnt lgkmcnt(4)
    ds_write_b128 v20, v[40:43] offset:4096
    ds_write_b128 v20, v[44:47] offset:5120
    ds_write_b128 v20, v[48:51] offset:6144
    ds_write_b128 v20, v[52:55] offset:7168
    s_waitcnt lgkmcnt(4)
    ds_write_b128 v20, v[56:59] offset:8192
    ds_write_b128 v20, v[60:63] offset:9216
    ds_write_b128 v20, v[64:67] offset:10240
    ds_write_b128 v20, v[68:71] offset:11264
    s_waitcnt lgkmcnt(4)
    ds_write_b128 v20, v[72:75] offset:12288
    ds_write_b128 v20, v[76:79] offset:13312
    ds_write_b128 v20, v[80:83] offset:14336
    ds_write_b128 v20, v[84:87] offset:15360
    s_waitcnt lgkmcnt(4)
    ds_write_b128 v20, v[88:91] offset:16384
    ds_write_b128 v20, v[92:95] offset:17408
    v_mov_b32 v4, 1
    s_mov_b64 exec, 1
    ds_add_u32 v3, v4 offset:204
    s_mov_b64 exec, -1
    s_branch L_cjoin
L_pada15:
    s_branch L_warmed_a
L_cdone:
    s_waitcnt lgkmcnt(0)
    v_mov_b32 v4, 1
    s_mov_b64 exec, 1
    ds_add_u32 v3, v4 offset:196
    s_mov_b64 exec, -1
    s_setprio 0
    s_mov_b32 s100, 0
Lw_82:
    ds_read_b32 v4, v3 offset:196
    s_waitcnt lgkmcnt(0)
    v_readfirstlane_b32 s99, v4
    s_cmp_ge_u32 s99, 4
    s_cbranch_scc1 Lwd_83
    s_sleep 6
    s_add_u32 s100, s100, 1
    s_cmp_lt_u32 s100, 1048576
    s_cbranch_scc1 Lw_82
Lwd_83:
L_cjoin:
    s_setprio 2
    s_mov_b32 s100, 0
Lw_84:
    ds_read_b32 v4, v3 offset:192
    s_waitcnt lgkmcnt(0)
    v_readfirstlane_b32 s99, v4
    s_cmp_ge_u32 s99, 1
    s_cbranch_scc1 Lwd_85
    s_add_u32 s100, s100, 1
    s_cmp_lt_u32 s100, 1048576
    s_cbranch_scc1 Lw_84
Lwd_85:
    s_mov_b32 s91, s99
    s_cmp_eq_u32 s91, 1
    s_cselect_b32 s99, 0, 15728640
    s_add_u32 s16, s28, s99
    s_addc_u32 s17, s29, 0
    s_add_u32 s18, s16, 13107200
    s_addc_u32 s19, s17, 0
    s_cmp_eq_u32 s91, 1
    s_cselect_b64 s[18:19], s[24:25], s[18:19]
    v_lshl_add_u32 v132, v0, 4, s80
    v_lshl_add_u32 v133, v0, 4, s82
    v_lshl_add_u32 v166, v0, 2, s83
    s_branch L_tail
L_end:
    s_endpgm
L_codeend:
.section .rodata,"a"
.p2align 6
.amdhsa_kernel gated_mix__ssm_conv_h3__sliding_local_dilated__prompt_kernel
  .amdhsa_next_free_vgpr 168
  .amdhsa_next_free_sgpr 102
  .amdhsa_accum_offset 168
  .amdhsa_group_segment_fixed_size 0
  .amdhsa_kernarg_size 104
  .amdhsa_user_sgpr_count 2
  .amdhsa_user_sgpr_kernarg_segment_ptr 1
  .amdhsa_system_sgpr_workgroup_id_x 1
.end_amdhsa_kernel
```
